```python
import torch

def _softmax(x, axis=-1):
    return torch.softmax(x, dim=axis)
def _gelu(x):
    return torch.nn.functional.gelu(x, approximate="tanh")
def _silu(x):
    return torch.nn.functional.silu(x)
def _sigmoid(x):
    return torch.sigmoid(x)
def _layernorm(x, axis=-1, eps=1e-5):
    m = x.mean(dim=axis, keepdim=True)
    v = x.var(dim=axis, keepdim=True, unbiased=False)
    return (x - m) / torch.sqrt(v + eps)
def _scatter_add(tgt, idx, src, axis=0):
    return tgt.clone().index_add_(axis, idx, src)
def _segment_sum(src, seg, n):
    out = torch.zeros((n,) + src.shape[1:], dtype=src.dtype)
    return out.index_add_(0, seg, src)
def _pad(x, pw):
    flat = tuple(v for pair in reversed(pw) for v in pair)
    return torch.nn.functional.pad(x, flat)

kernel_name = 'concat_heads__compressed_kv_cla__linear_attn_block__prompt'

def setup_inputs():

    _w = (lambda a: (lambda t: t.to(torch.bfloat16) if t.is_floating_point() else t)(torch.as_tensor(a)))
    def _A_setup():
        B, H, Sq, Sk, D, M = 1, 32, 2048, 2048, 128, 576
        Dc = 4 * D
        return {
            "x": _w((lambda *s: torch.randn(*s, dtype=torch.bfloat16) * 1.6)(B, Sq, M)),
            "c_kv": _w((lambda *s: torch.randn(*s, dtype=torch.bfloat16) * 0.2)(B, Sk, Dc)),
            "w_q": _w((lambda *s: torch.randn(*s, dtype=torch.bfloat16) * 3.2)(M, H, D) * (M ** -0.5)),
            "w_uk": _w((lambda *s: torch.randn(*s, dtype=torch.bfloat16) * 3.2)(Dc, H, D) * (Dc ** -0.5)),
            "w_uv": _w((lambda *s: torch.randn(*s, dtype=torch.bfloat16) * 0.2)(Dc, H, D) * (Dc ** -0.5)),
            "w_o": _w((lambda *s: torch.randn(*s, dtype=torch.bfloat16) * 0.2)(H, D, M) * ((H * D) ** -0.5)),
        }
    _A_in = _A_setup()

    def _B_setup():
        B, S, D = 1, 2048, 576
        return {
            "x": _w((lambda *s: torch.randn(*s, dtype=torch.bfloat16) * 0.05)(B, S, D)),
            "wqkv": _w((lambda *s: torch.randn(*s, dtype=torch.bfloat16) * 0.4)(D, 3 * D)),
            "wo": _w((lambda *s: torch.randn(*s, dtype=torch.bfloat16) * 0.05)(D, D)),
        }
    _B_in = _B_setup()

    return {
        "A_x": _A_in["x"],
        "A_c_kv": _A_in["c_kv"],
        "A_w_q": _A_in["w_q"],
        "A_w_uk": _A_in["w_uk"],
        "A_w_uv": _A_in["w_uv"],
        "A_w_o": _A_in["w_o"],
        "B_x": _B_in["x"],
        "B_wqkv": _B_in["wqkv"],
        "B_wo": _B_in["wo"],
    }

def reference(A_x, A_c_kv, A_w_q, A_w_uk, A_w_uv, A_w_o, B_x, B_wqkv, B_wo):
    def _A_ref(x, c_kv, w_q, w_uk, w_uv, w_o):
        B, Sq, M = x.shape[0], x.shape[1], x.shape[2]
        Sk = c_kv.shape[1]
        H, D = w_q.shape[1], w_q.shape[2]
        q = torch.einsum("bqm,mhd->bhqd", x, w_q)
        k = torch.einsum("bkc,chd->bhkd", c_kv, w_uk)
        v = torch.einsum("bkc,chd->bhkd", c_kv, w_uv)
        scores = torch.einsum("bhqd,bhkd->bhqk", q, k) * (D ** -0.5)
        off = Sk - Sq
        qi = torch.arange(Sq)[:, None]
        kj = torch.arange(Sk)[None, :]
        cmask = kj <= (qi + off)
        scores = torch.where(cmask[None, None], scores, -1e9)
        p = _softmax(scores, axis=-1)
        ctx = torch.einsum("bhqk,bhkd->bhqd", p, v)
        return torch.einsum("bhqd,hdm->bqm", ctx, w_o)

    def _B_ref(x, wqkv, wo):
        B, S, D = x.shape
        H = 32; Dh = D // H
        qkv = (lambda x, *d: x.permute(*d))((x @ wqkv).reshape(B, S, 3, H, Dh), 2, 0, 3, 1, 4)
        q, k, v = qkv[0], qkv[1], qkv[2]
        phi = lambda t: torch.where(t > 0, t + 1, torch.exp(t)) + 1e-6
        pq, pk = phi(q), phi(k)
        kv = torch.einsum("bhsd,bhse->bhde", pk, v)
        z = torch.einsum("bhsd->bhd", pk)
        num = torch.einsum("bhqd,bhde->bhqe", pq, kv)
        den = torch.einsum("bhqd,bhd->bhq", pq, z)[..., None] + 1e-6
        o = num / den
        return (lambda x, *d: x.permute(*d))(o, 0, 2, 1, 3).reshape(B, S, D) @ wo

    a = _A_ref(A_x, A_c_kv, A_w_q, A_w_uk, A_w_uv, A_w_o)
    b = _B_ref(B_x, B_wqkv, B_wo)
    return torch.concatenate([a, b], axis=-1)
```

```asm
; @launch grid=(256,1,1) block=(256,1,1) lds=163840
.amdgcn_target "amdgcn-amd-amdhsa--gfx950"
.text
.globl concat_heads__compressed_kv_cla__linear_attn_block__prompt_kernel
.p2align 8
.type concat_heads__compressed_kv_cla__linear_attn_block__prompt_kernel,@function
concat_heads__compressed_kv_cla__linear_attn_block__prompt_kernel:
L_main:
s_cmp_ge_u32 s2, 0x100
s_cbranch_scc1 L_end
s_getpc_b64 s[98:99]
L_pc:
v_lshlrev_b32 v30, 7, v0
global_load_dword v29, v30, s[98:99]
s_load_dwordx2 s[8:9], s[0:1], 8
s_load_dwordx2 s[12:13], s[0:1], 24
s_load_dwordx2 s[94:95], s[0:1], 32
s_load_dwordx2 s[4:5], s[0:1], 88
s_load_dwordx2 s[16:17], s[0:1], 48
s_load_dwordx2 s[20:21], s[0:1], 56
s_load_dwordx2 s[24:25], s[0:1], 0
s_load_dwordx2 s[28:29], s[0:1], 16
s_load_dwordx2 s[32:33], s[0:1], 40
s_load_dwordx2 s[36:37], s[0:1], 64
s_load_dwordx2 s[40:41], s[0:1], 72
s_load_dwordx2 s[44:45], s[0:1], 80
v_lshrrev_b32 v32, 6, v0
v_and_b32 v0, 63, v0
v_readfirstlane_b32 s48, v32
s_and_b32 s51, s2, 7
s_lshr_b32 s50, s2, 5
s_bfe_u32 s52, s2, 0x20003
s_lshl_b32 s49, s51, 2
s_add_u32 s49, s49, s52
v_and_b32 v32, 15, v0
v_lshrrev_b32 v33, 4, v0
v_lshlrev_b32 v1, 4, v0
v_lshrrev_b32 v36, 3, v0
v_and_b32 v37, 7, v0
v_xor_b32 v37, v37, v33
v_lshlrev_b32 v37, 4, v37
v_lshl_add_u32 v2, v36, 10, v37
v_xor_b32 v3, 64, v2
v_add_u32 v3, 0x2000, v3
s_lshl_b32 s72, s48, 13
s_add_u32 s72, s72, 0x18000
s_and_b32 s75, s48, 1
s_lshl_b32 s76, s75, 2
v_or_b32 v38, s76, v33
v_lshrrev_b32 v39, 1, v32
v_xor_b32 v38, v38, v39
v_and_b32 v39, 1, v0
v_lshl_add_u32 v38, v38, 1, v39
v_lshlrev_b32 v39, 13, v33
v_lshl_add_u32 v4, v38, 4, v39
s_add_u32 s3, s50, 1
s_and_b32 s3, s3, 7
s_lshl_b32 s77, s3, 8
s_lshl_b32 s78, s48, 6
s_add_u32 s77, s77, s78
s_lshl_b32 s55, s77, 10
s_add_u32 s56, s55, 0x4000
s_add_u32 s57, s55, 0x8000
s_add_u32 s58, s55, 0xc000
s_lshl_b32 s67, s49, 8
s_lshl_b32 s76, s75, 16
s_add_u32 s67, s67, s76
s_lshr_b32 s78, s48, 1
s_lshl_b32 s68, s78, 14
s_lshl_b32 s76, s75, 11
s_add_u32 s68, s68, s76
s_waitcnt lgkmcnt(0)
s_cmp_ge_u32 s48, 2
s_cselect_b32 s12, s94, s12
s_cselect_b32 s13, s95, s13
s_mov_b32 s10, 0x200000
s_mov_b32 s11, 0x20000
s_mov_b32 s14, 0x400000
s_mov_b32 s15, 0x20000
s_mov_b32 s6, 0x10000000
s_mov_b32 s7, 0x20000
s_add_u32 m0, s68, 0
s_add_u32 s75, s67, 0
buffer_load_dwordx4 v4, s[12:15], s75 offen lds
s_add_u32 m0, s68, 0x400
s_add_u32 s75, s67, 0x8000
buffer_load_dwordx4 v4, s[12:15], s75 offen lds
s_add_u32 m0, s68, 0x1000
s_add_u32 s75, s67, 0x20000
buffer_load_dwordx4 v4, s[12:15], s75 offen lds
s_add_u32 m0, s68, 0x1400
s_add_u32 s75, s67, 0x28000
buffer_load_dwordx4 v4, s[12:15], s75 offen lds
s_add_u32 m0, s68, 0x2000
s_add_u32 s75, s67, 0x40000
buffer_load_dwordx4 v4, s[12:15], s75 offen lds
s_add_u32 m0, s68, 0x2400
s_add_u32 s75, s67, 0x48000
buffer_load_dwordx4 v4, s[12:15], s75 offen lds
s_add_u32 m0, s68, 0x3000
s_add_u32 s75, s67, 0x60000
buffer_load_dwordx4 v4, s[12:15], s75 offen lds
s_add_u32 m0, s68, 0x3400
s_add_u32 s75, s67, 0x68000
buffer_load_dwordx4 v4, s[12:15], s75 offen lds
s_add_u32 m0, s72, 0
s_nop 0
buffer_load_dwordx4 v2, s[8:11], s55 offen lds
s_add_u32 m0, s72, 0x400
s_nop 0
buffer_load_dwordx4 v3, s[8:11], s55 offen lds
s_add_u32 m0, s72, 0x800
s_nop 0
buffer_load_dwordx4 v2, s[8:11], s56 offen lds
s_add_u32 m0, s72, 0xc00
s_nop 0
buffer_load_dwordx4 v3, s[8:11], s56 offen lds
s_add_u32 m0, s72, 0x1000
s_nop 0
buffer_load_dwordx4 v2, s[8:11], s57 offen lds
s_add_u32 m0, s72, 0x1400
s_nop 0
buffer_load_dwordx4 v3, s[8:11], s57 offen lds
s_add_u32 m0, s72, 0x1800
s_nop 0
buffer_load_dwordx4 v2, s[8:11], s58 offen lds
s_add_u32 m0, s72, 0x1c00
s_nop 0
buffer_load_dwordx4 v3, s[8:11], s58 offen lds
s_add_u32 m0, s68, 0x8000
s_add_u32 s75, s67, 0x80000
buffer_load_dwordx4 v4, s[12:15], s75 offen lds
s_add_u32 m0, s68, 0x8400
s_add_u32 s75, s67, 0x88000
buffer_load_dwordx4 v4, s[12:15], s75 offen lds
s_add_u32 m0, s68, 0x9000
s_add_u32 s75, s67, 0xa0000
buffer_load_dwordx4 v4, s[12:15], s75 offen lds
s_add_u32 m0, s68, 0x9400
s_add_u32 s75, s67, 0xa8000
buffer_load_dwordx4 v4, s[12:15], s75 offen lds
s_add_u32 m0, s68, 0xa000
s_add_u32 s75, s67, 0xc0000
buffer_load_dwordx4 v4, s[12:15], s75 offen lds
s_add_u32 m0, s68, 0xa400
s_add_u32 s75, s67, 0xc8000
buffer_load_dwordx4 v4, s[12:15], s75 offen lds
s_add_u32 m0, s68, 0xb000
s_add_u32 s75, s67, 0xe0000
buffer_load_dwordx4 v4, s[12:15], s75 offen lds
s_add_u32 m0, s68, 0xb400
s_add_u32 s75, s67, 0xe8000
buffer_load_dwordx4 v4, s[12:15], s75 offen lds
s_add_u32 m0, s72, 0x7f80
s_nop 0
buffer_load_dwordx4 v2, s[8:11], s55 offen offset:128 lds
s_add_u32 m0, s72, 0x8380
s_nop 0
buffer_load_dwordx4 v3, s[8:11], s55 offen offset:128 lds
s_add_u32 m0, s72, 0x8780
s_nop 0
buffer_load_dwordx4 v2, s[8:11], s56 offen offset:128 lds
s_add_u32 m0, s72, 0x8b80
s_nop 0
buffer_load_dwordx4 v3, s[8:11], s56 offen offset:128 lds
s_add_u32 m0, s72, 0x8f80
s_nop 0
buffer_load_dwordx4 v2, s[8:11], s57 offen offset:128 lds
s_add_u32 m0, s72, 0x9380
s_nop 0
buffer_load_dwordx4 v3, s[8:11], s57 offen offset:128 lds
s_add_u32 m0, s72, 0x9780
s_nop 0
buffer_load_dwordx4 v2, s[8:11], s58 offen offset:128 lds
s_add_u32 m0, s72, 0x9b80
s_nop 0
buffer_load_dwordx4 v3, s[8:11], s58 offen offset:128 lds
s_mov_b32 s18, 0x240000
s_mov_b32 s19, 0x20000
s_mov_b32 s22, 0x1e6000
s_mov_b32 s23, 0x20000
s_mov_b32 s26, 0x240000
s_mov_b32 s27, 0x20000
s_mov_b32 s30, 0x480000
s_mov_b32 s31, 0x20000
s_mov_b32 s34, 0x480000
s_mov_b32 s35, 0x20000
s_mov_b32 s38, 0xa2000
s_mov_b32 s39, 0x20000
s_mov_b32 s42, 0x480000
s_mov_b32 s43, 0x20000
s_mov_b32 s46, 0x100
s_mov_b32 s47, 0x20000
v_cmp_eq_u32 vcc, 0, v0
v_mov_b32 v40, 0x40000000
v_lshrrev_b32 v34, 2, v32
v_cndmask_b32_e64 v20, v40, 0, vcc
s_or_b32 s76, s2, s48
s_cbranch_scc1 L_nononce
s_memrealtime s[80:81]
s_waitcnt lgkmcnt(0)
s_or_b32 s80, s80, 1
v_mov_b32 v18, s80
buffer_store_dword v18, v20, s[44:47], 0 offen sc1
L_nononce:
v_and_b32 v35, 3, v32
v_mul_u32_u24 v41, 0x480, v36
v_add_u32 v22, v41, v37
v_xor_b32 v37, 64, v37
v_add_u32 v23, v41, v37
v_add_u32 v23, 0x2400, v23
v_lshrrev_b32 v41, 1, v32
v_xor_b32 v41, v41, v33
v_lshlrev_b32 v41, 4, v41
v_lshl_add_u32 v41, v32, 7, v41
v_add_u32 v24, s72, v41
v_xor_b32 v25, 64, v24
v_lshrrev_b32 v39, 2, v38
v_and_b32 v37, 3, v38
v_mul_u32_u24 v5, 0xd80, v33
v_lshl_add_u32 v5, v37, 4, v5
v_cmp_eq_u32 vcc, 3, v37
v_cmp_eq_u32_e64 s[80:81], 3, v39
v_cmp_gt_u32_e64 s[82:83], 2, v39
s_or_b64 vcc, vcc, s[80:81]
v_xor_b32 v41, 1, v39
v_cndmask_b32_e64 v39, v39, v41, s[82:83]
v_mul_u32_u24 v39, 0x480, v39
v_add_u32 v5, v5, v39
v_cndmask_b32 v5, v5, v40, vcc
v_lshl_add_u32 v37, v33, 3, v34
v_lshlrev_b32 v37, 8, v37
v_and_b32 v39, 1, v33
v_lshl_or_b32 v39, v39, 2, v34
v_lshl_add_u32 v41, v35, 3, v37
v_xor_b32 v6, 0, v39
v_lshl_add_u32 v6, v6, 5, v41
v_xor_b32 v7, 1, v39
v_lshl_add_u32 v7, v7, 5, v41
v_xor_b32 v8, 2, v39
v_lshl_add_u32 v8, v8, 5, v41
v_xor_b32 v9, 3, v39
v_lshl_add_u32 v9, v9, 5, v41
v_xor_b32 v10, 4, v39
v_lshl_add_u32 v10, v10, 5, v41
v_xor_b32 v11, 5, v39
v_lshl_add_u32 v11, v11, 5, v41
v_xor_b32 v12, 6, v39
v_lshl_add_u32 v12, v12, 5, v41
v_xor_b32 v13, 7, v39
v_lshl_add_u32 v13, v13, 5, v41
v_lshlrev_b32 v41, 3, v35
v_mov_b32 v14, 0x18100800
v_bfe_u32 v14, v14, v41, 8
v_lshrrev_b32 v41, 5, v14
v_xor_b32 v41, v41, v39
v_and_b32 v14, 31, v14
v_lshl_add_u32 v14, v41, 5, v14
v_add_u32 v14, v14, v37
v_lshlrev_b32 v41, 3, v35
v_mov_b32 v15, 0x50484020
v_bfe_u32 v15, v15, v41, 8
v_lshrrev_b32 v41, 5, v15
v_xor_b32 v41, v41, v39
v_and_b32 v15, 31, v15
v_lshl_add_u32 v15, v41, 5, v15
v_add_u32 v15, v15, v37
v_lshlrev_b32 v41, 3, v35
v_mov_b32 v16, 0x98908880
v_bfe_u32 v16, v16, v41, 8
v_lshrrev_b32 v41, 5, v16
v_xor_b32 v41, v41, v39
v_and_b32 v16, 31, v16
v_lshl_add_u32 v16, v41, 5, v16
v_add_u32 v16, v16, v37
v_lshlrev_b32 v41, 3, v35
v_mov_b32 v17, 0x6058c0a0
v_bfe_u32 v17, v17, v41, 8
v_lshrrev_b32 v41, 5, v17
v_xor_b32 v41, v41, v39
v_and_b32 v17, 31, v17
v_lshl_add_u32 v17, v41, 5, v17
v_add_u32 v17, v17, v37
v_and_b32 v21, 31, v0
v_lshlrev_b32 v21, 2, v21
s_and_b32 s75, s51, 3
s_lshl_b32 s54, s75, 1
s_and_b32 s75, s52, 1
s_add_u32 s54, s54, s75
s_lshr_b32 s75, s51, 2
s_lshl_b32 s53, s75, 4
s_lshr_b32 s75, s2, 4
s_add_u32 s53, s53, s75
s_lshl_b32 s77, s54, 2
s_add_u32 s77, s77, s48
s_mul_i32 s59, s77, 0x12000
s_add_u32 s60, s59, 0x4800
s_add_u32 s61, s59, 0x9000
s_add_u32 s62, s59, 0xd800
s_lshr_b32 s78, s48, 1
s_and_b32 s75, s48, 1
s_mul_i32 s76, s78, 16
s_lshl_b32 s77, s75, 3
s_add_u32 s76, s76, s77
s_lshl_b32 s71, s76, 8
s_mul_i32 s69, s76, 0xd80
s_mul_i32 s77, s53, 36
s_add_u32 s69, s69, s77
s_lshl_b32 s70, s76, 13
s_lshl_b32 s77, s49, 8
s_add_u32 s70, s70, s77
s_lshl_b32 s76, s50, 3
s_sub_u32 s77, 0x78, s76
s_sub_u32 s78, 7, s48
s_add_u32 s63, s76, s48
s_mul_i32 s63, s63, 0x4800
s_add_u32 s64, s76, s78
s_mul_i32 s64, s64, 0x4800
s_add_u32 s65, s77, s48
s_mul_i32 s65, s65, 0x4800
s_add_u32 s66, s77, s78
s_mul_i32 s66, s66, 0x4800
s_lshl_b32 s76, s3, 2
s_add_u32 s76, s76, s48
s_lshl_b32 s76, s76, 14
s_lshl_b32 s77, s49, 19
s_add_u32 s73, s76, s77
s_cmp_le_u32 s3, 1
s_cselect_b32 s0, s73, 0x40000000
s_cselect_b32 s73, 0x40000000, s73
s_add_u32 s1, s73, 0x1000000
s_lshl_b32 s76, s48, 12
s_add_u32 s89, s77, s76
s_add_u32 s90, s89, 0x1000000
s_mov_b32 s84, 0x3e0293ee
s_mov_b32 s85, 0x3fb8aa3b
s_mov_b32 s86, 0x358637bd
s_cmp_ge_u32 s2, 8
s_cbranch_scc1 L_nofar
s_lshl_b32 s88, s48, 13
s_add_u32 s88, s88, L_pc+32768-L_pc
v_lshlrev_b32 v32, 7, v0
v_add_u32 v32, s88, v32
v_min_u32 v32, L_codeend-L_pc-4, v32
global_load_dword v29, v32, s[98:99]
s_lshl_b32 s88, s48, 13
s_add_u32 s88, s88, L_pc+65536-L_pc
v_lshlrev_b32 v32, 7, v0
v_add_u32 v32, s88, v32
v_min_u32 v32, L_codeend-L_pc-4, v32
global_load_dword v29, v32, s[98:99]
s_lshl_b32 s88, s48, 13
s_add_u32 s88, s88, L_pc+98304-L_pc
v_lshlrev_b32 v32, 7, v0
v_add_u32 v32, s88, v32
v_min_u32 v32, L_codeend-L_pc-4, v32
global_load_dword v29, v32, s[98:99]
L_nofar:
s_lshl_b32 s92, s2, 2
s_add_u32 s92, s92, s48
v_lshlrev_b32 v26, 7, v0
s_waitcnt vmcnt(16)
s_barrier
ds_read_b64_tr_b16 a[160:161], v6 offset:16384
ds_read_b64_tr_b16 a[162:163], v6 offset:17408
ds_read_b64_tr_b16 a[164:165], v6 offset:24576
ds_read_b64_tr_b16 a[166:167], v6 offset:25600
ds_read_b128 a[64:67], v24
ds_read_b128 a[80:83], v25
ds_read_b128 a[68:71], v24 offset:2048
ds_read_b128 a[84:87], v25 offset:2048
ds_read_b128 a[72:75], v24 offset:4096
ds_read_b128 a[88:91], v25 offset:4096
ds_read_b128 a[76:79], v24 offset:6144
ds_read_b128 a[92:95], v25 offset:6144
s_waitcnt lgkmcnt(7)
v_mfma_f32_16x16x32_bf16 v[64:67], a[64:67], a[160:163], 0
s_waitcnt lgkmcnt(6)
s_add_u32 m0, s68, 0x10000
ds_read_b64_tr_b16 a[168:169], v7 offset:16384
v_mfma_f32_16x16x32_bf16 v[64:67], a[80:83], a[164:167], v[64:67]
s_waitcnt lgkmcnt(5)
s_add_u32 s75, s67, 0x100000
ds_read_b64_tr_b16 a[170:171], v7 offset:17408
v_mfma_f32_16x16x32_bf16 v[68:71], a[84:87], a[164:167], 0
ds_read_b64_tr_b16 a[172:173], v7 offset:24576
ds_read_b64_tr_b16 a[174:175], v7 offset:25600
v_mfma_f32_16x16x32_bf16 v[68:71], a[68:71], a[160:163], v[68:71]
s_waitcnt lgkmcnt(7)
s_sub_u32 s88, s92, 0x2bc
s_cmp_ge_u32 s88, 0x80
s_cbranch_scc1 L_tch6
s_add_u32 s88, s88, 0
s_lshl_b32 s88, s88, 13
buffer_load_dword v29, v26, s[8:11], s88 offen
L_tch6:
buffer_load_dwordx4 v4, s[12:15], s75 offen lds
v_mfma_f32_16x16x32_bf16 v[72:75], a[72:75], a[160:163], 0
s_waitcnt lgkmcnt(6)
ds_read_b64_tr_b16 a[176:177], v8 offset:16384
v_mfma_f32_16x16x32_bf16 v[72:75], a[88:91], a[164:167], v[72:75]
s_waitcnt lgkmcnt(5)
s_add_u32 m0, s68, 0x10400
ds_read_b64_tr_b16 a[178:179], v8 offset:17408
v_mfma_f32_16x16x32_bf16 v[76:79], a[92:95], a[164:167], 0
s_add_u32 s75, s67, 0x108000
ds_read_b64_tr_b16 a[180:181], v8 offset:24576
v_mfma_f32_16x16x32_bf16 v[76:79], a[76:79], a[160:163], v[76:79]
s_waitcnt lgkmcnt(5)
buffer_load_dwordx4 v4, s[12:15], s75 offen lds
ds_read_b64_tr_b16 a[182:183], v8 offset:25600
v_mfma_f32_16x16x32_bf16 v[92:95], a[76:79], a[168:171], 0
s_waitcnt lgkmcnt(4)
ds_read_b64_tr_b16 a[184:185], v9 offset:16384
v_mfma_f32_16x16x32_bf16 v[92:95], a[92:95], a[172:175], v[92:95]
ds_read_b64_tr_b16 a[186:187], v9 offset:17408
v_mfma_f32_16x16x32_bf16 v[88:91], a[88:91], a[172:175], 0
ds_read_b64_tr_b16 a[188:189], v9 offset:24576
v_mfma_f32_16x16x32_bf16 v[88:91], a[72:75], a[168:171], v[88:91]
s_add_u32 m0, s68, 0x11000
ds_read_b64_tr_b16 a[190:191], v9 offset:25600
v_mfma_f32_16x16x32_bf16 v[84:87], a[68:71], a[168:171], 0
s_add_u32 s75, s67, 0x120000
ds_read_b64_tr_b16 a[160:161], v10 offset:16384
v_mfma_f32_16x16x32_bf16 v[84:87], a[84:87], a[172:175], v[84:87]
buffer_load_dwordx4 v4, s[12:15], s75 offen lds
ds_read_b64_tr_b16 a[162:163], v10 offset:17408
v_mfma_f32_16x16x32_bf16 v[80:83], a[80:83], a[172:175], 0
ds_read_b64_tr_b16 a[164:165], v10 offset:24576
v_mfma_f32_16x16x32_bf16 v[80:83], a[64:67], a[168:171], v[80:83]
s_waitcnt lgkmcnt(7)
ds_read_b64_tr_b16 a[166:167], v10 offset:25600
v_mfma_f32_16x16x32_bf16 v[96:99], a[64:67], a[176:179], 0
s_add_u32 m0, s68, 0x11400
ds_read_b64_tr_b16 a[168:169], v11 offset:16384
v_mfma_f32_16x16x32_bf16 v[96:99], a[80:83], a[180:183], v[96:99]
s_add_u32 s75, s67, 0x128000
ds_read_b64_tr_b16 a[170:171], v11 offset:17408
v_mfma_f32_16x16x32_bf16 v[100:103], a[84:87], a[180:183], 0
buffer_load_dwordx4 v4, s[12:15], s75 offen lds
ds_read_b64_tr_b16 a[172:173], v11 offset:24576
v_mfma_f32_16x16x32_bf16 v[100:103], a[68:71], a[176:179], v[100:103]
ds_read_b64_tr_b16 a[174:175], v11 offset:25600
v_mfma_f32_16x16x32_bf16 v[104:107], a[72:75], a[176:179], 0
v_mfma_f32_16x16x32_bf16 v[104:107], a[88:91], a[180:183], v[104:107]
s_waitcnt lgkmcnt(8)
v_mfma_f32_16x16x32_bf16 v[108:111], a[92:95], a[180:183], 0
s_add_u32 m0, s68, 0x12000
v_mfma_f32_16x16x32_bf16 v[108:111], a[76:79], a[176:179], v[108:111]
s_add_u32 s75, s67, 0x140000
v_mfma_f32_16x16x32_bf16 v[124:127], a[76:79], a[184:187], 0
buffer_load_dwordx4 v4, s[12:15], s75 offen lds
ds_read_b64_tr_b16 a[176:177], v12 offset:16384
v_mfma_f32_16x16x32_bf16 v[124:127], a[92:95], a[188:191], v[124:127]
ds_read_b64_tr_b16 a[178:179], v12 offset:17408
v_mfma_f32_16x16x32_bf16 v[120:123], a[88:91], a[188:191], 0
ds_read_b64_tr_b16 a[180:181], v12 offset:24576
v_mfma_f32_16x16x32_bf16 v[120:123], a[72:75], a[184:187], v[120:123]
s_add_u32 m0, s68, 0x12400
ds_read_b64_tr_b16 a[182:183], v12 offset:25600
v_mfma_f32_16x16x32_bf16 v[116:119], a[68:71], a[184:187], 0
s_add_u32 s75, s67, 0x148000
v_mfma_f32_16x16x32_bf16 v[116:119], a[84:87], a[188:191], v[116:119]
buffer_load_dwordx4 v4, s[12:15], s75 offen lds
v_mfma_f32_16x16x32_bf16 v[112:115], a[80:83], a[188:191], 0
v_mfma_f32_16x16x32_bf16 v[112:115], a[64:67], a[184:187], v[112:115]
s_waitcnt lgkmcnt(8)
v_mfma_f32_16x16x32_bf16 v[128:131], a[64:67], a[160:163], 0
ds_read_b64_tr_b16 a[184:185], v13 offset:16384
v_mfma_f32_16x16x32_bf16 v[128:131], a[80:83], a[164:167], v[128:131]
s_add_u32 m0, s68, 0x13000
ds_read_b64_tr_b16 a[186:187], v13 offset:17408
v_mfma_f32_16x16x32_bf16 v[132:135], a[84:87], a[164:167], 0
s_sub_u32 s88, s92, 0x33c
s_cmp_ge_u32 s88, 0x80
s_cbranch_scc1 L_tch7
s_add_u32 s88, s88, 0x80
s_lshl_b32 s88, s88, 13
buffer_load_dword v29, v26, s[8:11], s88 offen
L_tch7:
v_mfma_f32_16x16x32_bf16 v[132:135], a[68:71], a[160:163], v[132:135]
s_add_u32 s75, s67, 0x160000
ds_read_b64_tr_b16 a[188:189], v13 offset:24576
v_mfma_f32_16x16x32_bf16 v[136:139], a[72:75], a[160:163], 0
buffer_load_dwordx4 v4, s[12:15], s75 offen lds
ds_read_b64_tr_b16 a[190:191], v13 offset:25600
v_mfma_f32_16x16x32_bf16 v[136:139], a[88:91], a[164:167], v[136:139]
s_waitcnt lgkmcnt(8)
v_mfma_f32_16x16x32_bf16 v[140:143], a[92:95], a[164:167], 0
s_add_u32 m0, s68, 0x13400
v_mfma_f32_16x16x32_bf16 v[140:143], a[76:79], a[160:163], v[140:143]
s_add_u32 s75, s67, 0x168000
v_mfma_f32_16x16x32_bf16 v[156:159], a[76:79], a[168:171], 0
buffer_load_dwordx4 v4, s[12:15], s75 offen lds
ds_read_b64_tr_b16 a[160:161], v6
v_mfma_f32_16x16x32_bf16 v[156:159], a[92:95], a[172:175], v[156:159]
ds_read_b64_tr_b16 a[162:163], v6 offset:1024
v_mfma_f32_16x16x32_bf16 v[152:155], a[88:91], a[172:175], 0
ds_read_b64_tr_b16 a[164:165], v6 offset:8192
v_mfma_f32_16x16x32_bf16 v[152:155], a[72:75], a[168:171], v[152:155]
ds_read_b64_tr_b16 a[166:167], v6 offset:9216
v_mfma_f32_16x16x32_bf16 v[148:151], a[68:71], a[168:171], 0
v_mfma_f32_16x16x32_bf16 v[148:151], a[84:87], a[172:175], v[148:151]
s_add_u32 m0, s72, 0xffffff00
v_mfma_f32_16x16x32_bf16 v[144:147], a[80:83], a[172:175], 0
buffer_load_dwordx4 v2, s[8:11], s55 offen offset:256 lds
v_mfma_f32_16x16x32_bf16 v[144:147], a[64:67], a[168:171], v[144:147]
s_waitcnt lgkmcnt(8)
v_mfma_f32_16x16x32_bf16 v[160:163], a[64:67], a[176:179], 0
ds_read_b64_tr_b16 a[168:169], v7
v_mfma_f32_16x16x32_bf16 v[160:163], a[80:83], a[180:183], v[160:163]
ds_read_b64_tr_b16 a[170:171], v7 offset:1024
v_mfma_f32_16x16x32_bf16 v[164:167], a[84:87], a[180:183], 0
s_add_u32 m0, s72, 0x300
ds_read_b64_tr_b16 a[172:173], v7 offset:8192
v_mfma_f32_16x16x32_bf16 v[164:167], a[68:71], a[176:179], v[164:167]
buffer_load_dwordx4 v3, s[8:11], s55 offen offset:256 lds
ds_read_b64_tr_b16 a[174:175], v7 offset:9216
v_mfma_f32_16x16x32_bf16 v[168:171], a[72:75], a[176:179], 0
v_mfma_f32_16x16x32_bf16 v[168:171], a[88:91], a[180:183], v[168:171]
v_mfma_f32_16x16x32_bf16 v[172:175], a[92:95], a[180:183], 0
v_mfma_f32_16x16x32_bf16 v[172:175], a[76:79], a[176:179], v[172:175]
s_waitcnt lgkmcnt(8)
v_mfma_f32_16x16x32_bf16 v[188:191], a[76:79], a[184:187], 0
s_add_u32 m0, s72, 0x700
ds_read_b64_tr_b16 a[176:177], v8
v_mfma_f32_16x16x32_bf16 v[188:191], a[92:95], a[188:191], v[188:191]
buffer_load_dwordx4 v2, s[8:11], s56 offen offset:256 lds
ds_read_b64_tr_b16 a[178:179], v8 offset:1024
v_mfma_f32_16x16x32_bf16 v[184:187], a[88:91], a[188:191], 0
ds_read_b64_tr_b16 a[180:181], v8 offset:8192
v_mfma_f32_16x16x32_bf16 v[184:187], a[72:75], a[184:187], v[184:187]
ds_read_b64_tr_b16 a[182:183], v8 offset:9216
v_mfma_f32_16x16x32_bf16 v[180:183], a[68:71], a[184:187], 0
v_mov_b32 v27, s86
v_accvgpr_write_b32 a192, v27
v_mfma_f32_16x16x32_bf16 v[180:183], a[84:87], a[188:191], v[180:183]
s_add_u32 m0, s72, 0xb00
v_accvgpr_write_b32 a193, v27
v_accvgpr_write_b32 a194, v27
v_mfma_f32_16x16x32_bf16 v[176:179], a[80:83], a[188:191], 0
buffer_load_dwordx4 v3, s[8:11], s56 offen offset:256 lds
v_accvgpr_write_b32 a195, v27
v_mfma_f32_16x16x32_bf16 v[176:179], a[64:67], a[184:187], v[176:179]
s_waitcnt lgkmcnt(8)
v_accvgpr_write_b32 a196, v27
v_accvgpr_write_b32 a197, v27
v_mfma_f32_16x16x32_bf16 v[192:195], a[160:163], a[64:67], 0
ds_read_b64_tr_b16 a[184:185], v9
v_accvgpr_write_b32 a198, v27
v_mfma_f32_16x16x32_bf16 v[192:195], a[164:167], a[80:83], v[192:195]
ds_read_b64_tr_b16 a[186:187], v9 offset:1024
v_accvgpr_write_b32 a199, v27
v_mfma_f32_16x16x32_bf16 v[196:199], a[164:167], a[84:87], 0
s_lshl_b32 s88, s2, 1
s_and_b32 s78, s48, 1
s_add_u32 s88, s88, s78
s_sub_u32 s88, s88, 0
s_and_b32 s88, s88, 0x1ff
s_cmp_ge_u32 s88, 0x46
s_cbranch_scc1 L_tch1
s_add_u32 s88, s88, 0xc0
s_lshl_b32 s88, s88, 13
buffer_load_dword v29, v26, s[12:15], s88 offen
L_tch1:
v_mfma_f32_16x16x32_bf16 v[196:199], a[160:163], a[68:71], v[196:199]
s_add_u32 m0, s72, 0xf00
ds_read_b64_tr_b16 a[188:189], v9 offset:8192
v_accvgpr_write_b32 a200, v27
v_mfma_f32_16x16x32_bf16 v[200:203], a[160:163], a[72:75], 0
buffer_load_dwordx4 v2, s[8:11], s57 offen offset:256 lds
ds_read_b64_tr_b16 a[190:191], v9 offset:9216
v_mfma_f32_16x16x32_bf16 v[200:203], a[164:167], a[88:91], v[200:203]
v_accvgpr_write_b32 a201, v27
v_accvgpr_write_b32 a202, v27
v_mfma_f32_16x16x32_bf16 v[204:207], a[164:167], a[92:95], 0
v_accvgpr_write_b32 a203, v27
v_accvgpr_write_b32 a204, v27
v_mfma_f32_16x16x32_bf16 v[204:207], a[160:163], a[76:79], v[204:207]
s_waitcnt lgkmcnt(8)
v_accvgpr_write_b32 a205, v27
v_accvgpr_write_b32 a206, v27
v_mfma_f32_16x16x32_bf16 v[220:223], a[168:171], a[76:79], 0
s_add_u32 m0, s72, 0x1300
ds_read_b64_tr_b16 a[160:161], v10
v_accvgpr_write_b32 a207, v27
v_mfma_f32_16x16x32_bf16 v[220:223], a[172:175], a[92:95], v[220:223]
buffer_load_dwordx4 v3, s[8:11], s57 offen offset:256 lds
ds_read_b64_tr_b16 a[162:163], v10 offset:1024
v_mfma_f32_16x16x32_bf16 v[216:219], a[172:175], a[88:91], 0
ds_read_b64_tr_b16 a[164:165], v10 offset:8192
v_accvgpr_write_b32 a208, v27
v_mfma_f32_16x16x32_bf16 v[216:219], a[168:171], a[72:75], v[216:219]
ds_read_b64_tr_b16 a[166:167], v10 offset:9216
v_accvgpr_write_b32 a209, v27
v_mfma_f32_16x16x32_bf16 v[212:215], a[168:171], a[68:71], 0
v_accvgpr_write_b32 a210, v27
v_accvgpr_write_b32 a211, v27
v_mfma_f32_16x16x32_bf16 v[212:215], a[172:175], a[84:87], v[212:215]
v_accvgpr_write_b32 a212, v27
v_accvgpr_write_b32 a213, v27
v_mfma_f32_16x16x32_bf16 v[208:211], a[172:175], a[80:83], 0
s_add_u32 m0, s72, 0x1700
v_accvgpr_write_b32 a214, v27
v_accvgpr_write_b32 a215, v27
v_mfma_f32_16x16x32_bf16 v[208:211], a[168:171], a[64:67], v[208:211]
s_waitcnt lgkmcnt(8)
buffer_load_dwordx4 v2, s[8:11], s58 offen offset:256 lds
v_accvgpr_write_b32 a216, v27
v_mfma_f32_16x16x32_bf16 v[224:227], a[176:179], a[64:67], 0
ds_read_b64_tr_b16 a[168:169], v11
v_accvgpr_write_b32 a217, v27
v_mfma_f32_16x16x32_bf16 v[224:227], a[180:183], a[80:83], v[224:227]
ds_read_b64_tr_b16 a[170:171], v11 offset:1024
v_accvgpr_write_b32 a218, v27
v_mfma_f32_16x16x32_bf16 v[228:231], a[180:183], a[84:87], 0
ds_read_b64_tr_b16 a[172:173], v11 offset:8192
v_accvgpr_write_b32 a219, v27
v_mfma_f32_16x16x32_bf16 v[228:231], a[176:179], a[68:71], v[228:231]
s_add_u32 m0, s72, 0x1b00
ds_read_b64_tr_b16 a[174:175], v11 offset:9216
v_accvgpr_write_b32 a220, v27
v_mfma_f32_16x16x32_bf16 v[232:235], a[176:179], a[72:75], 0
buffer_load_dwordx4 v3, s[8:11], s58 offen offset:256 lds
v_accvgpr_write_b32 a221, v27
v_mfma_f32_16x16x32_bf16 v[232:235], a[180:183], a[88:91], v[232:235]
v_accvgpr_write_b32 a222, v27
v_accvgpr_write_b32 a223, v27
v_mfma_f32_16x16x32_bf16 v[236:239], a[180:183], a[92:95], 0
v_mfma_f32_16x16x32_bf16 v[236:239], a[176:179], a[76:79], v[236:239]
s_waitcnt lgkmcnt(8)
v_mfma_f32_16x16x32_bf16 v[252:255], a[184:187], a[76:79], 0
ds_read_b64_tr_b16 a[176:177], v12
v_mfma_f32_16x16x32_bf16 v[252:255], a[188:191], a[92:95], v[252:255]
ds_read_b64_tr_b16 a[178:179], v12 offset:1024
v_mfma_f32_16x16x32_bf16 v[248:251], a[188:191], a[88:91], 0
ds_read_b64_tr_b16 a[180:181], v12 offset:8192
v_mfma_f32_16x16x32_bf16 v[248:251], a[184:187], a[72:75], v[248:251]
ds_read_b64_tr_b16 a[182:183], v12 offset:9216
v_mfma_f32_16x16x32_bf16 v[244:247], a[184:187], a[68:71], 0
v_mfma_f32_16x16x32_bf16 v[244:247], a[188:191], a[84:87], v[244:247]
v_mfma_f32_16x16x32_bf16 v[240:243], a[188:191], a[80:83], 0
v_mfma_f32_16x16x32_bf16 v[240:243], a[184:187], a[64:67], v[240:243]
s_waitcnt lgkmcnt(8)
v_mfma_f32_16x16x32_bf16 a[0:3], a[160:163], a[64:67], 0
ds_read_b64_tr_b16 a[184:185], v13
v_mfma_f32_16x16x32_bf16 a[0:3], a[164:167], a[80:83], a[0:3]
ds_read_b64_tr_b16 a[186:187], v13 offset:1024
v_mfma_f32_16x16x32_bf16 a[4:7], a[164:167], a[84:87], 0
s_sub_u32 s88, s92, 0x64
s_cmp_ge_u32 s88, 0x60
s_cbranch_scc1 L_tch8
s_add_u32 s88, s88, 0
s_lshl_b32 s88, s88, 13
buffer_load_dword v29, v26, s[16:19], s88 offen
L_tch8:
v_mfma_f32_16x16x32_bf16 a[4:7], a[160:163], a[68:71], a[4:7]
ds_read_b64_tr_b16 a[188:189], v13 offset:8192
v_mfma_f32_16x16x32_bf16 a[8:11], a[160:163], a[72:75], 0
ds_read_b64_tr_b16 a[190:191], v13 offset:9216
v_mfma_f32_16x16x32_bf16 a[8:11], a[164:167], a[88:91], a[8:11]
v_mfma_f32_16x16x32_bf16 a[12:15], a[164:167], a[92:95], 0
v_mfma_f32_16x16x32_bf16 a[12:15], a[160:163], a[76:79], a[12:15]
s_waitcnt lgkmcnt(8)
v_mfma_f32_16x16x32_bf16 a[28:31], a[168:171], a[76:79], 0
v_mfma_f32_16x16x32_bf16 a[28:31], a[172:175], a[92:95], a[28:31]
v_mfma_f32_16x16x32_bf16 a[24:27], a[172:175], a[88:91], 0
v_mfma_f32_16x16x32_bf16 a[24:27], a[168:171], a[72:75], a[24:27]
v_mfma_f32_16x16x32_bf16 a[20:23], a[168:171], a[68:71], 0
v_mfma_f32_16x16x32_bf16 a[20:23], a[172:175], a[84:87], a[20:23]
v_mfma_f32_16x16x32_bf16 a[16:19], a[172:175], a[80:83], 0
s_waitcnt vmcnt(18)
ds_read_b128 a[96:99], v24 offset:32768
v_mfma_f32_16x16x32_bf16 a[16:19], a[168:171], a[64:67], a[16:19]
s_waitcnt lgkmcnt(1)
ds_read_b128 a[112:115], v25 offset:32768
v_mfma_f32_16x16x32_bf16 a[32:35], a[176:179], a[64:67], 0
s_barrier
v_mfma_f32_16x16x32_bf16 a[32:35], a[180:183], a[80:83], a[32:35]
s_add_u32 m0, s71, 0
ds_read_b128 a[100:103], v24 offset:34816
v_mfma_f32_16x16x32_bf16 a[36:39], a[180:183], a[84:87], 0
s_add_u32 s75, s69, 0
ds_read_b128 a[116:119], v25 offset:34816
v_mfma_f32_16x16x32_bf16 a[36:39], a[176:179], a[68:71], a[36:39]
buffer_load_dwordx4 v5, s[20:23], s75 offen lds
ds_read_b128 a[104:107], v24 offset:36864
v_mfma_f32_16x16x32_bf16 a[40:43], a[176:179], a[72:75], 0
ds_read_b128 a[120:123], v25 offset:36864
v_mfma_f32_16x16x32_bf16 a[40:43], a[180:183], a[88:91], a[40:43]
s_waitcnt vmcnt(17)
ds_read_b128 a[108:111], v24 offset:38912
v_mfma_f32_16x16x32_bf16 a[44:47], a[180:183], a[92:95], 0
s_add_u32 m0, s71, 0x400
ds_read_b128 a[124:127], v25 offset:38912
v_mfma_f32_16x16x32_bf16 a[44:47], a[176:179], a[76:79], a[44:47]
s_add_u32 s75, s69, 0x3600
ds_read_b64_tr_b16 a[160:161], v6 offset:49152
v_mfma_f32_16x16x32_bf16 a[60:63], a[184:187], a[76:79], 0
ds_read_b64_tr_b16 a[162:163], v6 offset:50176
buffer_load_dwordx4 v5, s[20:23], s75 offen lds
v_mfma_f32_16x16x32_bf16 a[60:63], a[188:191], a[92:95], a[60:63]
ds_read_b64_tr_b16 a[164:165], v6 offset:57344
v_mfma_f32_16x16x32_bf16 a[56:59], a[188:191], a[88:91], 0
ds_read_b64_tr_b16 a[166:167], v6 offset:58368
v_mfma_f32_16x16x32_bf16 a[56:59], a[184:187], a[72:75], a[56:59]
ds_read_b64_tr_b16 a[168:169], v7 offset:49152
v_mfma_f32_16x16x32_bf16 a[52:55], a[184:187], a[68:71], 0
s_add_u32 m0, s71, 0x2000
ds_read_b64_tr_b16 a[170:171], v7 offset:50176
v_mfma_f32_16x16x32_bf16 a[52:55], a[188:191], a[84:87], a[52:55]
s_add_u32 s75, s69, 0x1b000
ds_read_b64_tr_b16 a[172:173], v7 offset:57344
v_mfma_f32_16x16x32_bf16 a[48:51], a[188:191], a[80:83], 0
buffer_load_dwordx4 v5, s[20:23], s75 offen lds
ds_read_b64_tr_b16 a[174:175], v7 offset:58368
v_mfma_f32_16x16x32_bf16 a[48:51], a[184:187], a[64:67], a[48:51]
s_waitcnt lgkmcnt(6)
ds_read_b64_tr_b16 a[176:177], v8 offset:49152
v_mfma_f32_16x16x32_bf16 v[64:67], a[96:99], a[160:163], v[64:67]
s_waitcnt lgkmcnt(5)
ds_read_b64_tr_b16 a[178:179], v8 offset:50176
v_mfma_f32_16x16x32_bf16 v[64:67], a[112:115], a[164:167], v[64:67]
s_sub_u32 s88, s92, 0xc4
s_cmp_ge_u32 s88, 0x60
s_cbranch_scc1 L_tch9
s_add_u32 s88, s88, 0x60
s_lshl_b32 s88, s88, 13
buffer_load_dword v29, v26, s[16:19], s88 offen
L_tch9:
v_mfma_f32_16x16x32_bf16 v[68:71], a[116:119], a[164:167], v[68:71]
s_add_u32 m0, s71, 0x2400
ds_read_b64_tr_b16 a[180:181], v8 offset:57344
v_mfma_f32_16x16x32_bf16 v[68:71], a[100:103], a[160:163], v[68:71]
s_add_u32 s75, s69, 0x1e600
ds_read_b64_tr_b16 a[182:183], v8 offset:58368
v_mfma_f32_16x16x32_bf16 v[72:75], a[104:107], a[160:163], v[72:75]
buffer_load_dwordx4 v5, s[20:23], s75 offen lds
ds_read_b64_tr_b16 a[184:185], v9 offset:49152
v_mfma_f32_16x16x32_bf16 v[72:75], a[120:123], a[164:167], v[72:75]
ds_read_b64_tr_b16 a[186:187], v9 offset:50176
v_mfma_f32_16x16x32_bf16 v[76:79], a[124:127], a[164:167], v[76:79]
s_waitcnt lgkmcnt(6)
ds_read_b64_tr_b16 a[188:189], v9 offset:57344
v_mfma_f32_16x16x32_bf16 v[76:79], a[108:111], a[160:163], v[76:79]
s_add_u32 m0, s71, 0x4000
ds_read_b64_tr_b16 a[190:191], v9 offset:58368
v_mfma_f32_16x16x32_bf16 v[92:95], a[108:111], a[168:171], v[92:95]
s_add_u32 s75, s69, 0x36000
ds_read_b64_tr_b16 a[160:161], v10 offset:49152
v_mfma_f32_16x16x32_bf16 v[92:95], a[124:127], a[172:175], v[92:95]
buffer_load_dwordx4 v5, s[20:23], s75 offen lds
ds_read_b64_tr_b16 a[162:163], v10 offset:50176
v_mfma_f32_16x16x32_bf16 v[88:91], a[120:123], a[172:175], v[88:91]
ds_read_b64_tr_b16 a[164:165], v10 offset:57344
v_mfma_f32_16x16x32_bf16 v[88:91], a[104:107], a[168:171], v[88:91]
ds_read_b64_tr_b16 a[166:167], v10 offset:58368
v_mfma_f32_16x16x32_bf16 v[84:87], a[100:103], a[168:171], v[84:87]
s_add_u32 m0, s71, 0x4400
v_mfma_f32_16x16x32_bf16 v[84:87], a[116:119], a[172:175], v[84:87]
s_add_u32 s75, s69, 0x39600
v_mfma_f32_16x16x32_bf16 v[80:83], a[112:115], a[172:175], v[80:83]
buffer_load_dwordx4 v5, s[20:23], s75 offen lds
v_mfma_f32_16x16x32_bf16 v[80:83], a[96:99], a[168:171], v[80:83]
s_waitcnt lgkmcnt(8)
v_mfma_f32_16x16x32_bf16 v[96:99], a[96:99], a[176:179], v[96:99]
ds_read_b64_tr_b16 a[168:169], v11 offset:49152
v_mfma_f32_16x16x32_bf16 v[96:99], a[112:115], a[180:183], v[96:99]
ds_read_b64_tr_b16 a[170:171], v11 offset:50176
v_mfma_f32_16x16x32_bf16 v[100:103], a[116:119], a[180:183], v[100:103]
s_add_u32 m0, s71, 0x6000
ds_read_b64_tr_b16 a[172:173], v11 offset:57344
v_mfma_f32_16x16x32_bf16 v[100:103], a[100:103], a[176:179], v[100:103]
s_add_u32 s75, s69, 0x51000
ds_read_b64_tr_b16 a[174:175], v11 offset:58368
v_mfma_f32_16x16x32_bf16 v[104:107], a[104:107], a[176:179], v[104:107]
buffer_load_dwordx4 v5, s[20:23], s75 offen lds
v_mfma_f32_16x16x32_bf16 v[104:107], a[120:123], a[180:183], v[104:107]
v_mfma_f32_16x16x32_bf16 v[108:111], a[124:127], a[180:183], v[108:111]
s_waitcnt lgkmcnt(8)
v_mfma_f32_16x16x32_bf16 v[108:111], a[108:111], a[176:179], v[108:111]
s_add_u32 m0, s71, 0x6400
v_mfma_f32_16x16x32_bf16 v[124:127], a[108:111], a[184:187], v[124:127]
s_add_u32 s75, s69, 0x54600
ds_read_b64_tr_b16 a[176:177], v12 offset:49152
v_mfma_f32_16x16x32_bf16 v[124:127], a[124:127], a[188:191], v[124:127]
buffer_load_dwordx4 v5, s[20:23], s75 offen lds
ds_read_b64_tr_b16 a[178:179], v12 offset:50176
v_mfma_f32_16x16x32_bf16 v[120:123], a[120:123], a[188:191], v[120:123]
ds_read_b64_tr_b16 a[180:181], v12 offset:57344
v_mfma_f32_16x16x32_bf16 v[120:123], a[104:107], a[184:187], v[120:123]
ds_read_b64_tr_b16 a[182:183], v12 offset:58368
v_mfma_f32_16x16x32_bf16 v[116:119], a[100:103], a[184:187], v[116:119]
v_mfma_f32_16x16x32_bf16 v[116:119], a[116:119], a[188:191], v[116:119]
v_mfma_f32_16x16x32_bf16 v[112:115], a[112:115], a[188:191], v[112:115]
s_add_u32 m0, s72, 0x8000
v_mfma_f32_16x16x32_bf16 v[112:115], a[96:99], a[184:187], v[112:115]
s_waitcnt lgkmcnt(8)
buffer_load_dwordx4 v22, s[16:19], s59 offen lds
v_mfma_f32_16x16x32_bf16 v[128:131], a[96:99], a[160:163], v[128:131]
ds_read_b64_tr_b16 a[184:185], v13 offset:49152
v_mfma_f32_16x16x32_bf16 v[128:131], a[112:115], a[164:167], v[128:131]
s_sub_u32 s88, s92, 0x124
s_cmp_ge_u32 s88, 0x60
s_cbranch_scc1 L_tch10
s_add_u32 s88, s88, 0xc0
s_lshl_b32 s88, s88, 13
buffer_load_dword v29, v26, s[16:19], s88 offen
L_tch10:
v_mfma_f32_16x16x32_bf16 v[132:135], a[116:119], a[164:167], v[132:135]
ds_read_b64_tr_b16 a[186:187], v13 offset:50176
v_mfma_f32_16x16x32_bf16 v[132:135], a[100:103], a[160:163], v[132:135]
s_add_u32 m0, s72, 0x8400
ds_read_b64_tr_b16 a[188:189], v13 offset:57344
v_mfma_f32_16x16x32_bf16 v[136:139], a[104:107], a[160:163], v[136:139]
buffer_load_dwordx4 v23, s[16:19], s59 offen lds
ds_read_b64_tr_b16 a[190:191], v13 offset:58368
v_mfma_f32_16x16x32_bf16 v[136:139], a[120:123], a[164:167], v[136:139]
v_mfma_f32_16x16x32_bf16 v[140:143], a[124:127], a[164:167], v[140:143]
v_mfma_f32_16x16x32_bf16 v[140:143], a[108:111], a[160:163], v[140:143]
s_waitcnt lgkmcnt(8)
v_mfma_f32_16x16x32_bf16 v[156:159], a[108:111], a[168:171], v[156:159]
ds_read_b64_tr_b16 a[160:161], v6 offset:32768
v_mfma_f32_16x16x32_bf16 v[156:159], a[124:127], a[172:175], v[156:159]
s_add_u32 m0, s72, 0x8800
ds_read_b64_tr_b16 a[162:163], v6 offset:33792
v_mfma_f32_16x16x32_bf16 v[152:155], a[120:123], a[172:175], v[152:155]
buffer_load_dwordx4 v22, s[16:19], s60 offen lds
ds_read_b64_tr_b16 a[164:165], v6 offset:40960
v_mfma_f32_16x16x32_bf16 v[152:155], a[104:107], a[168:171], v[152:155]
ds_read_b64_tr_b16 a[166:167], v6 offset:41984
v_mfma_f32_16x16x32_bf16 v[148:151], a[100:103], a[168:171], v[148:151]
v_mfma_f32_16x16x32_bf16 v[148:151], a[116:119], a[172:175], v[148:151]
v_mfma_f32_16x16x32_bf16 v[144:147], a[112:115], a[172:175], v[144:147]
s_add_u32 m0, s72, 0x8c00
v_mfma_f32_16x16x32_bf16 v[144:147], a[96:99], a[168:171], v[144:147]
s_waitcnt lgkmcnt(8)
buffer_load_dwordx4 v23, s[16:19], s60 offen lds
v_mfma_f32_16x16x32_bf16 v[160:163], a[96:99], a[176:179], v[160:163]
ds_read_b64_tr_b16 a[168:169], v7 offset:32768
v_mfma_f32_16x16x32_bf16 v[160:163], a[112:115], a[180:183], v[160:163]
ds_read_b64_tr_b16 a[170:171], v7 offset:33792
v_mfma_f32_16x16x32_bf16 v[164:167], a[116:119], a[180:183], v[164:167]
ds_read_b64_tr_b16 a[172:173], v7 offset:40960
v_mfma_f32_16x16x32_bf16 v[164:167], a[100:103], a[176:179], v[164:167]
ds_read_b64_tr_b16 a[174:175], v7 offset:41984
v_mfma_f32_16x16x32_bf16 v[168:171], a[104:107], a[176:179], v[168:171]
s_add_u32 m0, s72, 0x9000
v_mfma_f32_16x16x32_bf16 v[168:171], a[120:123], a[180:183], v[168:171]
buffer_load_dwordx4 v22, s[16:19], s61 offen lds
v_mfma_f32_16x16x32_bf16 v[172:175], a[124:127], a[180:183], v[172:175]
v_mfma_f32_16x16x32_bf16 v[172:175], a[108:111], a[176:179], v[172:175]
s_waitcnt lgkmcnt(8)
v_mfma_f32_16x16x32_bf16 v[188:191], a[108:111], a[184:187], v[188:191]
ds_read_b64_tr_b16 a[176:177], v8 offset:32768
v_mfma_f32_16x16x32_bf16 v[188:191], a[124:127], a[188:191], v[188:191]
s_add_u32 m0, s72, 0x9400
ds_read_b64_tr_b16 a[178:179], v8 offset:33792
v_mfma_f32_16x16x32_bf16 v[184:187], a[120:123], a[188:191], v[184:187]
buffer_load_dwordx4 v23, s[16:19], s61 offen lds
ds_read_b64_tr_b16 a[180:181], v8 offset:40960
v_mfma_f32_16x16x32_bf16 v[184:187], a[104:107], a[184:187], v[184:187]
ds_read_b64_tr_b16 a[182:183], v8 offset:41984
v_mfma_f32_16x16x32_bf16 v[180:183], a[100:103], a[184:187], v[180:183]
v_mfma_f32_16x16x32_bf16 v[180:183], a[116:119], a[188:191], v[180:183]
v_mfma_f32_16x16x32_bf16 v[176:179], a[112:115], a[188:191], v[176:179]
s_waitcnt lgkmcnt(8)
v_mfma_f32_16x16x32_bf16 v[176:179], a[96:99], a[184:187], v[176:179]
s_add_u32 m0, s72, 0x9800
v_mfma_f32_16x16x32_bf16 v[192:195], a[160:163], a[96:99], v[192:195]
buffer_load_dwordx4 v22, s[16:19], s62 offen lds
ds_read_b64_tr_b16 a[184:185], v9 offset:32768
v_mfma_f32_16x16x32_bf16 v[192:195], a[164:167], a[112:115], v[192:195]
s_sub_u32 s88, s92, 0x184
s_cmp_ge_u32 s88, 0x79
s_cbranch_scc1 L_tch11
s_add_u32 s88, s88, 0
s_lshl_b32 s88, s88, 13
buffer_load_dword v29, v26, s[20:23], s88 offen
L_tch11:
v_mfma_f32_16x16x32_bf16 v[196:199], a[164:167], a[116:119], v[196:199]
ds_read_b64_tr_b16 a[186:187], v9 offset:33792
v_mfma_f32_16x16x32_bf16 v[196:199], a[160:163], a[100:103], v[196:199]
ds_read_b64_tr_b16 a[188:189], v9 offset:40960
v_mfma_f32_16x16x32_bf16 v[200:203], a[160:163], a[104:107], v[200:203]
s_add_u32 m0, s72, 0x9c00
ds_read_b64_tr_b16 a[190:191], v9 offset:41984
v_mfma_f32_16x16x32_bf16 v[200:203], a[164:167], a[120:123], v[200:203]
buffer_load_dwordx4 v23, s[16:19], s62 offen lds
v_mfma_f32_16x16x32_bf16 v[204:207], a[164:167], a[124:127], v[204:207]
v_mfma_f32_16x16x32_bf16 v[204:207], a[160:163], a[108:111], v[204:207]
s_waitcnt lgkmcnt(8)
v_mfma_f32_16x16x32_bf16 v[220:223], a[168:171], a[108:111], v[220:223]
ds_read_b64_tr_b16 a[160:161], v10 offset:32768
v_mfma_f32_16x16x32_bf16 v[220:223], a[172:175], a[124:127], v[220:223]
ds_read_b64_tr_b16 a[162:163], v10 offset:33792
v_mfma_f32_16x16x32_bf16 v[216:219], a[172:175], a[120:123], v[216:219]
ds_read_b64_tr_b16 a[164:165], v10 offset:40960
v_mfma_f32_16x16x32_bf16 v[216:219], a[168:171], a[104:107], v[216:219]
ds_read_b64_tr_b16 a[166:167], v10 offset:41984
v_mfma_f32_16x16x32_bf16 v[212:215], a[168:171], a[100:103], v[212:215]
v_mfma_f32_16x16x32_bf16 v[212:215], a[172:175], a[116:119], v[212:215]
v_mfma_f32_16x16x32_bf16 v[208:211], a[172:175], a[112:115], v[208:211]
v_mfma_f32_16x16x32_bf16 v[208:211], a[168:171], a[96:99], v[208:211]
s_waitcnt lgkmcnt(8)
v_mfma_f32_16x16x32_bf16 v[224:227], a[176:179], a[96:99], v[224:227]
ds_read_b64_tr_b16 a[168:169], v11 offset:32768
v_mfma_f32_16x16x32_bf16 v[224:227], a[180:183], a[112:115], v[224:227]
ds_read_b64_tr_b16 a[170:171], v11 offset:33792
v_mfma_f32_16x16x32_bf16 v[228:231], a[180:183], a[116:119], v[228:231]
ds_read_b64_tr_b16 a[172:173], v11 offset:40960
v_mfma_f32_16x16x32_bf16 v[228:231], a[176:179], a[100:103], v[228:231]
ds_read_b64_tr_b16 a[174:175], v11 offset:41984
v_mfma_f32_16x16x32_bf16 v[232:235], a[176:179], a[104:107], v[232:235]
v_mfma_f32_16x16x32_bf16 v[232:235], a[180:183], a[120:123], v[232:235]
v_mfma_f32_16x16x32_bf16 v[236:239], a[180:183], a[124:127], v[236:239]
v_mfma_f32_16x16x32_bf16 v[236:239], a[176:179], a[108:111], v[236:239]
s_waitcnt lgkmcnt(8)
v_mfma_f32_16x16x32_bf16 v[252:255], a[184:187], a[108:111], v[252:255]
ds_read_b64_tr_b16 a[176:177], v12 offset:32768
v_mfma_f32_16x16x32_bf16 v[252:255], a[188:191], a[124:127], v[252:255]
ds_read_b64_tr_b16 a[178:179], v12 offset:33792
v_mfma_f32_16x16x32_bf16 v[248:251], a[188:191], a[120:123], v[248:251]
ds_read_b64_tr_b16 a[180:181], v12 offset:40960
v_mfma_f32_16x16x32_bf16 v[248:251], a[184:187], a[104:107], v[248:251]
ds_read_b64_tr_b16 a[182:183], v12 offset:41984
v_mfma_f32_16x16x32_bf16 v[244:247], a[184:187], a[100:103], v[244:247]
v_mfma_f32_16x16x32_bf16 v[244:247], a[188:191], a[116:119], v[244:247]
v_mfma_f32_16x16x32_bf16 v[240:243], a[188:191], a[112:115], v[240:243]
v_mfma_f32_16x16x32_bf16 v[240:243], a[184:187], a[96:99], v[240:243]
s_waitcnt lgkmcnt(8)
v_mfma_f32_16x16x32_bf16 a[0:3], a[160:163], a[96:99], a[0:3]
s_sub_u32 s88, s92, 0x1fd
s_cmp_ge_u32 s88, 0x7a
s_cbranch_scc1 L_tch12
s_add_u32 s88, s88, 0x79
s_lshl_b32 s88, s88, 13
buffer_load_dword v29, v26, s[20:23], s88 offen
L_tch12:
v_mfma_f32_16x16x32_bf16 a[0:3], a[164:167], a[112:115], a[0:3]
ds_read_b64_tr_b16 a[184:185], v13 offset:32768
v_mfma_f32_16x16x32_bf16 a[4:7], a[164:167], a[116:119], a[4:7]
ds_read_b64_tr_b16 a[186:187], v13 offset:33792
v_mfma_f32_16x16x32_bf16 a[4:7], a[160:163], a[100:103], a[4:7]
ds_read_b64_tr_b16 a[188:189], v13 offset:40960
v_mfma_f32_16x16x32_bf16 a[8:11], a[160:163], a[104:107], a[8:11]
ds_read_b64_tr_b16 a[190:191], v13 offset:41984
v_mfma_f32_16x16x32_bf16 a[8:11], a[164:167], a[120:123], a[8:11]
v_mfma_f32_16x16x32_bf16 a[12:15], a[164:167], a[124:127], a[12:15]
v_mfma_f32_16x16x32_bf16 a[12:15], a[160:163], a[108:111], a[12:15]
s_waitcnt lgkmcnt(8)
v_mfma_f32_16x16x32_bf16 a[28:31], a[168:171], a[108:111], a[28:31]
v_mfma_f32_16x16x32_bf16 a[28:31], a[172:175], a[124:127], a[28:31]
v_mfma_f32_16x16x32_bf16 a[24:27], a[172:175], a[120:123], a[24:27]
v_mfma_f32_16x16x32_bf16 a[24:27], a[168:171], a[104:107], a[24:27]
v_mfma_f32_16x16x32_bf16 a[20:23], a[168:171], a[100:103], a[20:23]
v_mfma_f32_16x16x32_bf16 a[20:23], a[172:175], a[116:119], a[20:23]
v_mfma_f32_16x16x32_bf16 a[16:19], a[172:175], a[112:115], a[16:19]
s_waitcnt vmcnt(20)
ds_read_b128 a[128:131], v24
v_mfma_f32_16x16x32_bf16 a[16:19], a[168:171], a[96:99], a[16:19]
s_waitcnt lgkmcnt(1)
ds_read_b128 a[144:147], v25
v_mfma_f32_16x16x32_bf16 a[32:35], a[176:179], a[96:99], a[32:35]
s_barrier
v_mfma_f32_16x16x32_bf16 a[32:35], a[180:183], a[112:115], a[32:35]
s_add_u32 m0, s68, 0x8000
ds_read_b128 a[132:135], v24 offset:2048
v_add_u32 v6, 0x8000, v6
v_mfma_f32_16x16x32_bf16 a[36:39], a[180:183], a[116:119], a[36:39]
s_add_u32 s75, s67, 0x180000
ds_read_b128 a[148:151], v25 offset:2048
v_mfma_f32_16x16x32_bf16 a[36:39], a[176:179], a[100:103], a[36:39]
buffer_load_dwordx4 v4, s[12:15], s75 offen lds
s_waitcnt vmcnt(5)
ds_read_b128 a[136:139], v24 offset:4096
v_mfma_f32_16x16x32_bf16 a[40:43], a[176:179], a[104:107], a[40:43]
ds_read_b128 a[152:155], v25 offset:4096
v_mfma_f32_16x16x32_bf16 a[40:43], a[180:183], a[120:123], a[40:43]
ds_read_b128 a[140:143], v24 offset:6144
v_mfma_f32_16x16x32_bf16 a[44:47], a[180:183], a[124:127], a[44:47]
s_add_u32 m0, s68, 0x8400
ds_read_b128 a[156:159], v25 offset:6144
v_mfma_f32_16x16x32_bf16 a[44:47], a[176:179], a[108:111], a[44:47]
s_add_u32 s75, s67, 0x188000
ds_read_b128 a[64:67], v24 offset:32768
ds_read_b128 a[80:83], v25 offset:32768
v_mfma_f32_16x16x32_bf16 a[60:63], a[184:187], a[108:111], a[60:63]
ds_read_b128 a[68:71], v24 offset:34816
ds_read_b128 a[84:87], v25 offset:34816
v_mfma_f32_16x16x32_bf16 a[60:63], a[188:191], a[124:127], a[60:63]
ds_read_b64_tr_b16 a[160:161], v6 offset:49152
ds_read_b64_tr_b16 a[162:163], v6 offset:50176
buffer_load_dwordx4 v4, s[12:15], s75 offen lds
v_mfma_f32_16x16x32_bf16 a[56:59], a[188:191], a[120:123], a[56:59]
ds_read_b64_tr_b16 a[164:165], v6 offset:57344
ds_read_b64_tr_b16 a[166:167], v6 offset:58368
v_mfma_f32_16x16x32_bf16 a[56:59], a[184:187], a[104:107], a[56:59]
v_add_u32 v7, 0x8000, v7
ds_read_b64_tr_b16 a[168:169], v7 offset:49152
v_mfma_f32_16x16x32_bf16 a[52:55], a[184:187], a[100:103], a[52:55]
s_add_u32 m0, s68, 0x9000
ds_read_b64_tr_b16 a[170:171], v7 offset:50176
v_mfma_f32_16x16x32_bf16 a[52:55], a[188:191], a[116:119], a[52:55]
s_add_u32 s75, s67, 0x1a0000
ds_read_b64_tr_b16 a[172:173], v7 offset:57344
v_mfma_f32_16x16x32_bf16 a[48:51], a[188:191], a[112:115], a[48:51]
buffer_load_dwordx4 v4, s[12:15], s75 offen lds
ds_read_b64_tr_b16 a[174:175], v7 offset:58368
v_mfma_f32_16x16x32_bf16 a[48:51], a[184:187], a[96:99], a[48:51]
s_waitcnt lgkmcnt(6)
v_add_u32 v8, 0x8000, v8
ds_read_b64_tr_b16 a[176:177], v8 offset:49152
v_mfma_f32_16x16x32_bf16 v[64:67], a[128:131], a[160:163], v[64:67]
s_waitcnt lgkmcnt(5)
s_lshl_b32 s88, s2, 1
s_and_b32 s78, s48, 1
s_add_u32 s88, s88, s78
s_sub_u32 s88, s88, 0x46
s_and_b32 s88, s88, 0x1ff
s_cmp_ge_u32 s88, 0x46
s_cbranch_scc1 L_tch2
s_add_u32 s88, s88, 0x106
s_lshl_b32 s88, s88, 13
buffer_load_dword v29, v26, s[12:15], s88 offen
L_tch2:
v_mfma_f32_16x16x32_bf16 v[64:67], a[144:147], a[164:167], v[64:67]
s_add_u32 m0, s68, 0x9400
s_waitcnt vmcnt(5)
ds_read_b128 a[72:75], v24 offset:36864
v_mfma_f32_16x16x32_bf16 v[68:71], a[148:151], a[164:167], v[68:71]
s_add_u32 s75, s67, 0x1a8000
ds_read_b128 a[88:91], v25 offset:36864
v_mfma_f32_16x16x32_bf16 v[68:71], a[132:135], a[160:163], v[68:71]
buffer_load_dwordx4 v4, s[12:15], s75 offen lds
ds_read_b64_tr_b16 a[178:179], v8 offset:50176
v_mfma_f32_16x16x32_bf16 v[72:75], a[136:139], a[160:163], v[72:75]
ds_read_b64_tr_b16 a[180:181], v8 offset:57344
v_mfma_f32_16x16x32_bf16 v[72:75], a[152:155], a[164:167], v[72:75]
ds_read_b64_tr_b16 a[182:183], v8 offset:58368
v_add_u32 v9, 0x8000, v9
v_mfma_f32_16x16x32_bf16 v[76:79], a[156:159], a[164:167], v[76:79]
ds_read_b64_tr_b16 a[184:185], v9 offset:49152
v_mfma_f32_16x16x32_bf16 v[76:79], a[140:143], a[160:163], v[76:79]
s_waitcnt lgkmcnt(7)
ds_read_b64_tr_b16 a[186:187], v9 offset:50176
v_mfma_f32_16x16x32_bf16 v[92:95], a[140:143], a[168:171], v[92:95]
s_add_u32 m0, s72, 0xffffff80
ds_read_b64_tr_b16 a[188:189], v9 offset:57344
v_mfma_f32_16x16x32_bf16 v[92:95], a[156:159], a[172:175], v[92:95]
buffer_load_dwordx4 v22, s[16:19], s59 offen offset:128 lds
ds_read_b64_tr_b16 a[190:191], v9 offset:58368
v_mfma_f32_16x16x32_bf16 v[88:91], a[152:155], a[172:175], v[88:91]
v_add_u32 v10, 0x8000, v10
ds_read_b64_tr_b16 a[160:161], v10 offset:49152
v_mfma_f32_16x16x32_bf16 v[88:91], a[136:139], a[168:171], v[88:91]
s_waitcnt vmcnt(5)
ds_read_b128 a[76:79], v24 offset:38912
v_mfma_f32_16x16x32_bf16 v[84:87], a[132:135], a[168:171], v[84:87]
s_add_u32 m0, s68, 0xa000
ds_read_b128 a[92:95], v25 offset:38912
v_mfma_f32_16x16x32_bf16 v[84:87], a[148:151], a[172:175], v[84:87]
s_add_u32 s75, s67, 0x1c0000
ds_read_b64_tr_b16 a[162:163], v10 offset:50176
v_mfma_f32_16x16x32_bf16 v[80:83], a[144:147], a[172:175], v[80:83]
buffer_load_dwordx4 v4, s[12:15], s75 offen lds
ds_read_b64_tr_b16 a[164:165], v10 offset:57344
v_mfma_f32_16x16x32_bf16 v[80:83], a[128:131], a[168:171], v[80:83]
s_waitcnt lgkmcnt(9)
ds_read_b64_tr_b16 a[166:167], v10 offset:58368
v_add_u32 v11, 0x8000, v11
v_mfma_f32_16x16x32_bf16 v[96:99], a[128:131], a[176:179], v[96:99]
ds_read_b64_tr_b16 a[168:169], v11 offset:49152
v_mfma_f32_16x16x32_bf16 v[96:99], a[144:147], a[180:183], v[96:99]
ds_read_b64_tr_b16 a[170:171], v11 offset:50176
v_mfma_f32_16x16x32_bf16 v[100:103], a[148:151], a[180:183], v[100:103]
ds_read_b64_tr_b16 a[172:173], v11 offset:57344
v_mfma_f32_16x16x32_bf16 v[100:103], a[132:135], a[176:179], v[100:103]
s_add_u32 m0, s72, 0x380
ds_read_b64_tr_b16 a[174:175], v11 offset:58368
v_add_u32 v12, 0x8000, v12
v_mfma_f32_16x16x32_bf16 v[104:107], a[136:139], a[176:179], v[104:107]
buffer_load_dwordx4 v23, s[16:19], s59 offen offset:128 lds
v_mfma_f32_16x16x32_bf16 v[104:107], a[152:155], a[180:183], v[104:107]
v_mfma_f32_16x16x32_bf16 v[108:111], a[156:159], a[180:183], v[108:111]
v_mfma_f32_16x16x32_bf16 v[108:111], a[140:143], a[176:179], v[108:111]
s_waitcnt lgkmcnt(10)
v_mfma_f32_16x16x32_bf16 v[124:127], a[140:143], a[184:187], v[124:127]
s_add_u32 m0, s72, 0x780
ds_read_b64_tr_b16 a[176:177], v12 offset:49152
v_mfma_f32_16x16x32_bf16 v[124:127], a[156:159], a[188:191], v[124:127]
buffer_load_dwordx4 v22, s[16:19], s60 offen offset:128 lds
ds_read_b64_tr_b16 a[178:179], v12 offset:50176
v_mfma_f32_16x16x32_bf16 v[120:123], a[152:155], a[188:191], v[120:123]
ds_read_b64_tr_b16 a[180:181], v12 offset:57344
v_mfma_f32_16x16x32_bf16 v[120:123], a[136:139], a[184:187], v[120:123]
ds_read_b64_tr_b16 a[182:183], v12 offset:58368
v_add_u32 v13, 0x8000, v13
v_mfma_f32_16x16x32_bf16 v[116:119], a[132:135], a[184:187], v[116:119]
v_mfma_f32_16x16x32_bf16 v[116:119], a[148:151], a[188:191], v[116:119]
v_mfma_f32_16x16x32_bf16 v[112:115], a[144:147], a[188:191], v[112:115]
s_add_u32 m0, s72, 0xb80
v_mfma_f32_16x16x32_bf16 v[112:115], a[128:131], a[184:187], v[112:115]
s_waitcnt lgkmcnt(8)
buffer_load_dwordx4 v23, s[16:19], s60 offen offset:128 lds
v_mfma_f32_16x16x32_bf16 v[128:131], a[128:131], a[160:163], v[128:131]
s_lshl_b32 s88, s2, 1
s_and_b32 s78, s48, 1
s_add_u32 s88, s88, s78
s_sub_u32 s88, s88, 0x8c
s_and_b32 s88, s88, 0x1ff
s_cmp_ge_u32 s88, 0x46
s_cbranch_scc1 L_tch3
s_add_u32 s88, s88, 0x14c
s_lshl_b32 s88, s88, 13
buffer_load_dword v29, v26, s[12:15], s88 offen
L_tch3:
v_mfma_f32_16x16x32_bf16 v[128:131], a[144:147], a[164:167], v[128:131]
ds_read_b64_tr_b16 a[184:185], v13 offset:49152
v_mfma_f32_16x16x32_bf16 v[132:135], a[148:151], a[164:167], v[132:135]
ds_read_b64_tr_b16 a[186:187], v13 offset:50176
v_mfma_f32_16x16x32_bf16 v[132:135], a[132:135], a[160:163], v[132:135]
s_add_u32 m0, s72, 0xf80
ds_read_b64_tr_b16 a[188:189], v13 offset:57344
v_mfma_f32_16x16x32_bf16 v[136:139], a[136:139], a[160:163], v[136:139]
buffer_load_dwordx4 v22, s[16:19], s61 offen offset:128 lds
ds_read_b64_tr_b16 a[190:191], v13 offset:58368
v_mfma_f32_16x16x32_bf16 v[136:139], a[152:155], a[164:167], v[136:139]
v_mfma_f32_16x16x32_bf16 v[140:143], a[156:159], a[164:167], v[140:143]
v_mfma_f32_16x16x32_bf16 v[140:143], a[140:143], a[160:163], v[140:143]
s_waitcnt lgkmcnt(8)
v_mfma_f32_16x16x32_bf16 v[156:159], a[140:143], a[168:171], v[156:159]
s_add_u32 m0, s68, 0xa400
ds_read_b64_tr_b16 a[160:161], v6 offset:32768
v_mfma_f32_16x16x32_bf16 v[156:159], a[156:159], a[172:175], v[156:159]
s_add_u32 s75, s67, 0x1c8000
ds_read_b64_tr_b16 a[162:163], v6 offset:33792
v_mfma_f32_16x16x32_bf16 v[152:155], a[152:155], a[172:175], v[152:155]
buffer_load_dwordx4 v4, s[12:15], s75 offen lds
ds_read_b64_tr_b16 a[164:165], v6 offset:40960
v_mfma_f32_16x16x32_bf16 v[152:155], a[136:139], a[168:171], v[152:155]
ds_read_b64_tr_b16 a[166:167], v6 offset:41984
v_mfma_f32_16x16x32_bf16 v[148:151], a[132:135], a[168:171], v[148:151]
v_mfma_f32_16x16x32_bf16 v[148:151], a[148:151], a[172:175], v[148:151]
v_mfma_f32_16x16x32_bf16 v[144:147], a[144:147], a[172:175], v[144:147]
s_add_u32 m0, s72, 0x1380
v_mfma_f32_16x16x32_bf16 v[144:147], a[128:131], a[168:171], v[144:147]
s_waitcnt lgkmcnt(8)
buffer_load_dwordx4 v23, s[16:19], s61 offen offset:128 lds
v_mfma_f32_16x16x32_bf16 v[160:163], a[128:131], a[176:179], v[160:163]
ds_read_b64_tr_b16 a[168:169], v7 offset:32768
v_mfma_f32_16x16x32_bf16 v[160:163], a[144:147], a[180:183], v[160:163]
ds_read_b64_tr_b16 a[170:171], v7 offset:33792
v_mfma_f32_16x16x32_bf16 v[164:167], a[148:151], a[180:183], v[164:167]
ds_read_b64_tr_b16 a[172:173], v7 offset:40960
v_mfma_f32_16x16x32_bf16 v[164:167], a[132:135], a[176:179], v[164:167]
ds_read_b64_tr_b16 a[174:175], v7 offset:41984
v_mfma_f32_16x16x32_bf16 v[168:171], a[136:139], a[176:179], v[168:171]
s_add_u32 m0, s72, 0x1780
v_mfma_f32_16x16x32_bf16 v[168:171], a[152:155], a[180:183], v[168:171]
buffer_load_dwordx4 v22, s[16:19], s62 offen offset:128 lds
v_mfma_f32_16x16x32_bf16 v[172:175], a[156:159], a[180:183], v[172:175]
v_mfma_f32_16x16x32_bf16 v[172:175], a[140:143], a[176:179], v[172:175]
s_waitcnt lgkmcnt(8)
v_mfma_f32_16x16x32_bf16 v[188:191], a[140:143], a[184:187], v[188:191]
ds_read_b64_tr_b16 a[176:177], v8 offset:32768
v_mfma_f32_16x16x32_bf16 v[188:191], a[156:159], a[188:191], v[188:191]
s_add_u32 m0, s72, 0x1b80
ds_read_b64_tr_b16 a[178:179], v8 offset:33792
v_mfma_f32_16x16x32_bf16 v[184:187], a[152:155], a[188:191], v[184:187]
buffer_load_dwordx4 v23, s[16:19], s62 offen offset:128 lds
ds_read_b64_tr_b16 a[180:181], v8 offset:40960
v_mfma_f32_16x16x32_bf16 v[184:187], a[136:139], a[184:187], v[184:187]
ds_read_b64_tr_b16 a[182:183], v8 offset:41984
v_mfma_f32_16x16x32_bf16 v[180:183], a[132:135], a[184:187], v[180:183]
v_mfma_f32_16x16x32_bf16 v[180:183], a[148:151], a[188:191], v[180:183]
s_waitcnt lgkmcnt(8)
v_mfma_f32_16x16x32_bf16 v[176:179], a[144:147], a[188:191], v[176:179]
s_add_u32 m0, s68, 0xb000
v_mfma_f32_16x16x32_bf16 v[176:179], a[128:131], a[184:187], v[176:179]
s_lshl_b32 s88, s2, 1
s_and_b32 s78, s48, 1
s_add_u32 s88, s88, s78
s_sub_u32 s88, s88, 0xd2
s_and_b32 s88, s88, 0x1ff
s_cmp_ge_u32 s88, 0x46
s_cbranch_scc1 L_tch4
s_add_u32 s88, s88, 0x192
s_lshl_b32 s88, s88, 13
buffer_load_dword v29, v26, s[12:15], s88 offen
L_tch4:
v_mfma_f32_16x16x32_bf16 v[192:195], a[160:163], a[128:131], v[192:195]
s_add_u32 s75, s67, 0x1e0000
ds_read_b64_tr_b16 a[184:185], v9 offset:32768
v_mfma_f32_16x16x32_bf16 v[192:195], a[164:167], a[144:147], v[192:195]
buffer_load_dwordx4 v4, s[12:15], s75 offen lds
ds_read_b64_tr_b16 a[186:187], v9 offset:33792
v_mfma_f32_16x16x32_bf16 v[196:199], a[164:167], a[148:151], v[196:199]
ds_read_b64_tr_b16 a[188:189], v9 offset:40960
v_mfma_f32_16x16x32_bf16 v[196:199], a[160:163], a[132:135], v[196:199]
s_add_u32 m0, s68, 0xb400
ds_read_b64_tr_b16 a[190:191], v9 offset:41984
v_mfma_f32_16x16x32_bf16 v[200:203], a[160:163], a[136:139], v[200:203]
s_add_u32 s75, s67, 0x1e8000
v_mfma_f32_16x16x32_bf16 v[200:203], a[164:167], a[152:155], v[200:203]
buffer_load_dwordx4 v4, s[12:15], s75 offen lds
v_mfma_f32_16x16x32_bf16 v[204:207], a[164:167], a[156:159], v[204:207]
v_mfma_f32_16x16x32_bf16 v[204:207], a[160:163], a[140:143], v[204:207]
s_waitcnt lgkmcnt(8)
v_mfma_f32_16x16x32_bf16 v[220:223], a[168:171], a[140:143], v[220:223]
ds_read_b64_tr_b16 a[160:161], v10 offset:32768
v_mfma_f32_16x16x32_bf16 v[220:223], a[172:175], a[156:159], v[220:223]
ds_read_b64_tr_b16 a[162:163], v10 offset:33792
v_mfma_f32_16x16x32_bf16 v[216:219], a[172:175], a[152:155], v[216:219]
s_add_u32 m0, s72, 0x7e80
ds_read_b64_tr_b16 a[164:165], v10 offset:40960
v_mfma_f32_16x16x32_bf16 v[216:219], a[168:171], a[136:139], v[216:219]
buffer_load_dwordx4 v2, s[8:11], s55 offen offset:384 lds
ds_read_b64_tr_b16 a[166:167], v10 offset:41984
v_mfma_f32_16x16x32_bf16 v[212:215], a[168:171], a[132:135], v[212:215]
v_mfma_f32_16x16x32_bf16 v[212:215], a[172:175], a[148:151], v[212:215]
v_mfma_f32_16x16x32_bf16 v[208:211], a[172:175], a[144:147], v[208:211]
s_waitcnt lgkmcnt(8)
v_mfma_f32_16x16x32_bf16 v[208:211], a[168:171], a[128:131], v[208:211]
s_add_u32 m0, s72, 0x8280
v_mfma_f32_16x16x32_bf16 v[224:227], a[176:179], a[128:131], v[224:227]
buffer_load_dwordx4 v3, s[8:11], s55 offen offset:384 lds
ds_read_b64_tr_b16 a[168:169], v11 offset:32768
v_mfma_f32_16x16x32_bf16 v[224:227], a[180:183], a[144:147], v[224:227]
ds_read_b64_tr_b16 a[170:171], v11 offset:33792
v_mfma_f32_16x16x32_bf16 v[228:231], a[180:183], a[148:151], v[228:231]
ds_read_b64_tr_b16 a[172:173], v11 offset:40960
v_mfma_f32_16x16x32_bf16 v[228:231], a[176:179], a[132:135], v[228:231]
ds_read_b64_tr_b16 a[174:175], v11 offset:41984
v_mfma_f32_16x16x32_bf16 v[232:235], a[176:179], a[136:139], v[232:235]
v_mfma_f32_16x16x32_bf16 v[232:235], a[180:183], a[152:155], v[232:235]
s_add_u32 m0, s72, 0x8680
v_mfma_f32_16x16x32_bf16 v[236:239], a[180:183], a[156:159], v[236:239]
buffer_load_dwordx4 v2, s[8:11], s56 offen offset:384 lds
v_mfma_f32_16x16x32_bf16 v[236:239], a[176:179], a[140:143], v[236:239]
s_waitcnt lgkmcnt(8)
v_mfma_f32_16x16x32_bf16 v[252:255], a[184:187], a[140:143], v[252:255]
ds_read_b64_tr_b16 a[176:177], v12 offset:32768
v_mfma_f32_16x16x32_bf16 v[252:255], a[188:191], a[156:159], v[252:255]
ds_read_b64_tr_b16 a[178:179], v12 offset:33792
v_mfma_f32_16x16x32_bf16 v[248:251], a[188:191], a[152:155], v[248:251]
s_add_u32 m0, s72, 0x8a80
s_waitcnt vmcnt(12)
ds_read_b128 a[96:99], v24
v_mfma_f32_16x16x32_bf16 v[248:251], a[184:187], a[136:139], v[248:251]
buffer_load_dwordx4 v3, s[8:11], s56 offen offset:384 lds
ds_read_b128 a[112:115], v25
v_mfma_f32_16x16x32_bf16 v[244:247], a[184:187], a[132:135], v[244:247]
ds_read_b64_tr_b16 a[180:181], v12 offset:40960
v_mfma_f32_16x16x32_bf16 v[244:247], a[188:191], a[148:151], v[244:247]
ds_read_b64_tr_b16 a[182:183], v12 offset:41984
v_mfma_f32_16x16x32_bf16 v[240:243], a[188:191], a[144:147], v[240:243]
s_waitcnt lgkmcnt(10)
v_mfma_f32_16x16x32_bf16 v[240:243], a[184:187], a[128:131], v[240:243]
s_lshl_b32 s88, s2, 1
s_and_b32 s78, s48, 1
s_add_u32 s88, s88, s78
s_sub_u32 s88, s88, 0x118
s_and_b32 s88, s88, 0x1ff
s_cmp_ge_u32 s88, 40
s_cbranch_scc1 L_tch5
s_add_u32 s88, s88, 0x1d8
s_lshl_b32 s88, s88, 13
buffer_load_dword v29, v26, s[12:15], s88 offen
L_tch5:
v_mfma_f32_16x16x32_bf16 a[0:3], a[160:163], a[128:131], a[0:3]
s_add_u32 m0, s72, 0x8e80
ds_read_b64_tr_b16 a[184:185], v13 offset:32768
v_mfma_f32_16x16x32_bf16 a[0:3], a[164:167], a[144:147], a[0:3]
buffer_load_dwordx4 v2, s[8:11], s57 offen offset:384 lds
ds_read_b64_tr_b16 a[186:187], v13 offset:33792
v_mfma_f32_16x16x32_bf16 a[4:7], a[164:167], a[148:151], a[4:7]
ds_read_b64_tr_b16 a[188:189], v13 offset:40960
v_mfma_f32_16x16x32_bf16 a[4:7], a[160:163], a[132:135], a[4:7]
ds_read_b64_tr_b16 a[190:191], v13 offset:41984
v_mfma_f32_16x16x32_bf16 a[8:11], a[160:163], a[136:139], a[8:11]
v_mfma_f32_16x16x32_bf16 a[8:11], a[164:167], a[152:155], a[8:11]
s_add_u32 m0, s72, 0x9280
s_waitcnt vmcnt(12)
ds_read_b128 a[100:103], v24 offset:2048
v_mfma_f32_16x16x32_bf16 a[12:15], a[164:167], a[156:159], a[12:15]
buffer_load_dwordx4 v3, s[8:11], s57 offen offset:384 lds
ds_read_b128 a[116:119], v25 offset:2048
v_mfma_f32_16x16x32_bf16 a[12:15], a[160:163], a[140:143], a[12:15]
s_waitcnt lgkmcnt(12)
v_mfma_f32_16x16x32_bf16 a[28:31], a[168:171], a[140:143], a[28:31]
v_mfma_f32_16x16x32_bf16 a[28:31], a[172:175], a[156:159], a[28:31]
v_mfma_f32_16x16x32_bf16 a[24:27], a[172:175], a[152:155], a[24:27]
v_mfma_f32_16x16x32_bf16 a[24:27], a[168:171], a[136:139], a[24:27]
s_add_u32 m0, s72, 0x9680
v_mfma_f32_16x16x32_bf16 a[20:23], a[168:171], a[132:135], a[20:23]
buffer_load_dwordx4 v2, s[8:11], s58 offen offset:384 lds
v_mfma_f32_16x16x32_bf16 a[20:23], a[172:175], a[148:151], a[20:23]
v_mfma_f32_16x16x32_bf16 a[16:19], a[172:175], a[144:147], a[16:19]
v_mfma_f32_16x16x32_bf16 a[16:19], a[168:171], a[128:131], a[16:19]
s_waitcnt lgkmcnt(2)
v_mfma_f32_16x16x32_bf16 a[32:35], a[176:179], a[128:131], a[32:35]
s_barrier
v_mfma_f32_16x16x32_bf16 a[32:35], a[180:183], a[144:147], a[32:35]
s_add_u32 m0, s72, 0x9a80
ds_read_b64_tr_b16 a[160:161], v14
v_mfma_f32_16x16x32_bf16 a[36:39], a[180:183], a[148:151], a[36:39]
buffer_load_dwordx4 v3, s[8:11], s58 offen offset:384 lds
ds_read_b64_tr_b16 a[162:163], v14 offset:1024
v_mfma_f32_16x16x32_bf16 a[36:39], a[176:179], a[132:135], a[36:39]
ds_read_b64_tr_b16 a[164:165], v14 offset:8192
v_mfma_f32_16x16x32_bf16 a[40:43], a[176:179], a[136:139], a[40:43]
ds_read_b64_tr_b16 a[166:167], v14 offset:9216
v_mfma_f32_16x16x32_bf16 a[40:43], a[180:183], a[152:155], a[40:43]
s_add_u32 m0, s71, 0x10000
s_waitcnt vmcnt(12)
ds_read_b128 a[104:107], v24 offset:4096
v_mfma_f32_16x16x32_bf16 a[44:47], a[180:183], a[156:159], a[44:47]
s_add_u32 s75, s69, 0x6c000
ds_read_b128 a[120:123], v25 offset:4096
v_mfma_f32_16x16x32_bf16 a[44:47], a[176:179], a[140:143], a[44:47]
buffer_load_dwordx4 v5, s[20:23], s75 offen lds
ds_read_b64_tr_b16 a[168:169], v15
v_mfma_f32_16x16x32_bf16 a[60:63], a[184:187], a[140:143], a[60:63]
ds_read_b64_tr_b16 a[170:171], v15 offset:1024
v_mfma_f32_16x16x32_bf16 a[60:63], a[188:191], a[156:159], a[60:63]
ds_read_b64_tr_b16 a[172:173], v15 offset:8192
v_mfma_f32_16x16x32_bf16 a[56:59], a[188:191], a[152:155], a[56:59]
s_add_u32 m0, s71, 0x10400
ds_read_b64_tr_b16 a[174:175], v15 offset:9216
v_mfma_f32_16x16x32_bf16 a[56:59], a[184:187], a[136:139], a[56:59]
s_add_u32 s75, s69, 0x6f600
ds_read_b64_tr_b16 a[176:177], v16
v_mfma_f32_16x16x32_bf16 a[52:55], a[184:187], a[132:135], a[52:55]
v_and_b32 v28, 12, v0
v_cmp_le_u32_e64 s[80:81], 8, v28
v_cmp_eq_u32_e64 s[82:83], 4, v28
s_nop 0
v_cndmask_b32_e64 v27, 0, v27, s[80:81]
v_cndmask_b32_e64 v27, v27, 1.0, s[82:83]
v_accvgpr_write_b32 a240, v27
v_accvgpr_write_b32 a241, v27
v_accvgpr_write_b32 a242, v27
v_accvgpr_write_b32 a243, v27
v_accvgpr_write_b32 a244, v27
v_accvgpr_write_b32 a245, v27
v_accvgpr_write_b32 a246, v27
v_accvgpr_write_b32 a247, v27
v_accvgpr_write_b32 a248, v27
v_accvgpr_write_b32 a249, v27
v_accvgpr_write_b32 a250, v27
v_accvgpr_write_b32 a251, v27
v_accvgpr_write_b32 a252, v27
v_accvgpr_write_b32 a253, v27
v_accvgpr_write_b32 a254, v27
v_accvgpr_write_b32 a255, v27
v_mfma_f32_16x16x32_bf16 a[52:55], a[188:191], a[148:151], a[52:55]
buffer_load_dwordx4 v5, s[20:23], s75 offen lds
ds_read_b64_tr_b16 a[178:179], v16 offset:1024
v_mfma_f32_16x16x32_bf16 a[48:51], a[188:191], a[144:147], a[48:51]
s_waitcnt lgkmcnt(8)
ds_read_b64_tr_b16 a[180:181], v16 offset:8192
v_mfma_f32_16x16x32_bf16 a[48:51], a[184:187], a[128:131], a[48:51]
s_sub_u32 s88, s92, 0x280
s_cmp_ge_u32 s88, 0x60
s_cbranch_scc1 L_tch13
s_add_u32 s88, s88, 0
s_lshl_b32 s88, s88, 13
buffer_load_dword v29, v26, s[24:27], s88 offen
L_tch13:
v_mfma_f32_16x16x32_bf16 a[192:195], a[64:67], a[160:163], a[192:195]
s_add_u32 m0, s71, 0x12000
s_waitcnt vmcnt(12)
ds_read_b128 a[108:111], v24 offset:6144
v_mfma_f32_16x16x32_bf16 a[192:195], a[80:83], a[164:167], a[192:195]
s_add_u32 s75, s69, 0x87000
ds_read_b128 a[124:127], v25 offset:6144
v_mfma_f32_16x16x32_bf16 a[196:199], a[84:87], a[164:167], a[196:199]
buffer_load_dwordx4 v5, s[20:23], s75 offen lds
ds_read_b64_tr_b16 a[182:183], v16 offset:9216
v_mfma_f32_16x16x32_bf16 a[196:199], a[68:71], a[160:163], a[196:199]
ds_read_b64_tr_b16 a[184:185], v17
v_mfma_f32_16x16x32_bf16 a[200:203], a[72:75], a[160:163], a[200:203]
ds_read_b64_tr_b16 a[186:187], v17 offset:1024
v_mfma_f32_16x16x32_bf16 a[200:203], a[88:91], a[164:167], a[200:203]
s_add_u32 m0, s71, 0x12400
ds_read_b64_tr_b16 a[188:189], v17 offset:8192
v_mfma_f32_16x16x32_bf16 a[204:207], a[92:95], a[164:167], a[204:207]
s_add_u32 s75, s69, 0x8a600
ds_read_b64_tr_b16 a[190:191], v17 offset:9216
v_mfma_f32_16x16x32_bf16 a[204:207], a[76:79], a[160:163], a[204:207]
s_waitcnt lgkmcnt(10)
buffer_load_dwordx4 v5, s[20:23], s75 offen lds
v_mfma_f32_16x16x32_bf16 a[220:223], a[76:79], a[168:171], a[220:223]
ds_read_b64_tr_b16 a[160:161], v14 offset:16384
v_mfma_f32_16x16x32_bf16 a[220:223], a[92:95], a[172:175], a[220:223]
ds_read_b64_tr_b16 a[162:163], v14 offset:17408
v_mfma_f32_16x16x32_bf16 a[216:219], a[88:91], a[172:175], a[216:219]
ds_read_b64_tr_b16 a[164:165], v14 offset:24576
v_mfma_f32_16x16x32_bf16 a[216:219], a[72:75], a[168:171], a[216:219]
s_add_u32 m0, s71, 0x14000
ds_read_b64_tr_b16 a[166:167], v14 offset:25600
v_mfma_f32_16x16x32_bf16 a[212:215], a[68:71], a[168:171], a[212:215]
s_add_u32 s75, s69, 0xa2000
v_mfma_f32_16x16x32_bf16 a[212:215], a[84:87], a[172:175], a[212:215]
buffer_load_dwordx4 v5, s[20:23], s75 offen lds
v_mfma_f32_16x16x32_bf16 a[208:211], a[80:83], a[172:175], a[208:211]
v_mfma_f32_16x16x32_bf16 a[208:211], a[64:67], a[168:171], a[208:211]
s_waitcnt lgkmcnt(8)
v_mfma_f32_16x16x32_bf16 a[224:227], a[64:67], a[176:179], 0
s_add_u32 m0, s71, 0x14400
ds_read_b64_tr_b16 a[168:169], v15 offset:16384
v_mov_b32 v19, 0
v_mfma_f32_16x16x32_bf16 a[224:227], a[80:83], a[180:183], a[224:227]
s_add_u32 s75, s69, 0xa5600
ds_read_b64_tr_b16 a[170:171], v15 offset:17408
v_mfma_f32_16x16x32_bf16 a[228:231], a[84:87], a[180:183], 0
buffer_load_dwordx4 v5, s[20:23], s75 offen lds
ds_read_b64_tr_b16 a[172:173], v15 offset:24576
v_mfma_f32_16x16x32_bf16 a[228:231], a[68:71], a[176:179], a[228:231]
ds_read_b64_tr_b16 a[174:175], v15 offset:25600
buffer_load_dword v18, v19, s[44:47], 0 offen sc1
v_mfma_f32_16x16x32_bf16 a[232:235], a[72:75], a[176:179], 0
v_mfma_f32_16x16x32_bf16 a[232:235], a[88:91], a[180:183], a[232:235]
s_waitcnt lgkmcnt(8)
v_mfma_f32_16x16x32_bf16 a[236:239], a[92:95], a[180:183], 0
s_add_u32 m0, s71, 0x16000
s_waitcnt vmcnt(13)
ds_read_b128 a[128:131], v24 offset:32768
v_mfma_f32_16x16x32_bf16 a[236:239], a[76:79], a[176:179], a[236:239]
s_add_u32 s75, s69, 0xbd000
ds_read_b128 a[144:147], v25 offset:32768
v_mfma_f32_16x16x32_bf16 a[252:255], a[76:79], a[184:187], a[252:255]
buffer_load_dwordx4 v5, s[20:23], s75 offen lds
ds_read_b64_tr_b16 a[176:177], v16 offset:16384
v_mfma_f32_16x16x32_bf16 a[252:255], a[92:95], a[188:191], a[252:255]
ds_read_b64_tr_b16 a[178:179], v16 offset:17408
v_mfma_f32_16x16x32_bf16 a[248:251], a[88:91], a[188:191], a[248:251]
ds_read_b64_tr_b16 a[180:181], v16 offset:24576
v_mfma_f32_16x16x32_bf16 a[248:251], a[72:75], a[184:187], a[248:251]
s_add_u32 m0, s71, 0x16400
ds_read_b64_tr_b16 a[182:183], v16 offset:25600
v_mfma_f32_16x16x32_bf16 a[244:247], a[68:71], a[184:187], a[244:247]
s_add_u32 s75, s69, 0xc0600
v_mfma_f32_16x16x32_bf16 a[244:247], a[84:87], a[188:191], a[244:247]
buffer_load_dwordx4 v5, s[20:23], s75 offen lds
v_mfma_f32_16x16x32_bf16 a[240:243], a[80:83], a[188:191], a[240:243]
v_mfma_f32_16x16x32_bf16 a[240:243], a[64:67], a[184:187], a[240:243]
s_waitcnt lgkmcnt(10)
v_mfma_f32_16x16x32_bf16 a[192:195], a[96:99], a[160:163], a[192:195]
ds_read_b64_tr_b16 a[184:185], v17 offset:16384
v_mfma_f32_16x16x32_bf16 a[192:195], a[112:115], a[164:167], a[192:195]
s_waitcnt vmcnt(13)
ds_read_b128 a[132:135], v24 offset:34816
v_mfma_f32_16x16x32_bf16 a[196:199], a[116:119], a[164:167], a[196:199]
s_add_u32 m0, s72, 0xffffff00
ds_read_b128 a[148:151], v25 offset:34816
v_mfma_f32_16x16x32_bf16 a[196:199], a[100:103], a[160:163], a[196:199]
buffer_load_dwordx4 v22, s[16:19], s59 offen offset:256 lds
ds_read_b64_tr_b16 a[186:187], v17 offset:17408
v_mfma_f32_16x16x32_bf16 a[200:203], a[104:107], a[160:163], a[200:203]
ds_read_b64_tr_b16 a[188:189], v17 offset:24576
v_mfma_f32_16x16x32_bf16 a[200:203], a[120:123], a[164:167], a[200:203]
ds_read_b64_tr_b16 a[190:191], v17 offset:25600
v_mfma_f32_16x16x32_bf16 a[204:207], a[124:127], a[164:167], a[204:207]
s_waitcnt lgkmcnt(12)
v_mfma_f32_16x16x32_bf16 a[204:207], a[108:111], a[160:163], a[204:207]
s_add_u32 m0, s72, 0x300
v_mfma_f32_16x16x32_bf16 a[220:223], a[108:111], a[168:171], a[220:223]
buffer_load_dwordx4 v23, s[16:19], s59 offen offset:256 lds
v_mfma_f32_16x16x32_bf16 a[220:223], a[124:127], a[172:175], a[220:223]
v_mfma_f32_16x16x32_bf16 a[216:219], a[120:123], a[172:175], a[216:219]
v_mfma_f32_16x16x32_bf16 a[216:219], a[104:107], a[168:171], a[216:219]
v_mfma_f32_16x16x32_bf16 a[212:215], a[100:103], a[168:171], a[212:215]
s_waitcnt vmcnt(13)
ds_read_b128 a[136:139], v24 offset:36864
v_mfma_f32_16x16x32_bf16 a[212:215], a[116:119], a[172:175], a[212:215]
s_add_u32 m0, s72, 0x700
ds_read_b128 a[152:155], v25 offset:36864
v_mfma_f32_16x16x32_bf16 a[208:211], a[112:115], a[172:175], a[208:211]
buffer_load_dwordx4 v22, s[16:19], s60 offen offset:256 lds
v_mfma_f32_16x16x32_bf16 a[208:211], a[96:99], a[168:171], a[208:211]
s_waitcnt lgkmcnt(2)
v_mfma_f32_16x16x32_bf16 a[224:227], a[96:99], a[176:179], a[224:227]
s_barrier
v_mfma_f32_16x16x32_bf16 a[224:227], a[112:115], a[180:183], a[224:227]
ds_read_b64_tr_b16 a[160:161], v6 offset:16384
v_mfma_f32_16x16x32_bf16 a[228:231], a[116:119], a[180:183], a[228:231]
s_add_u32 m0, s72, 0xb00
ds_read_b64_tr_b16 a[162:163], v6 offset:17408
v_mfma_f32_16x16x32_bf16 a[228:231], a[100:103], a[176:179], a[228:231]
buffer_load_dwordx4 v23, s[16:19], s60 offen offset:256 lds
ds_read_b64_tr_b16 a[164:165], v6 offset:24576
v_mfma_f32_16x16x32_bf16 a[232:235], a[104:107], a[176:179], a[232:235]
s_waitcnt vmcnt(13)
ds_read_b128 a[140:143], v24 offset:38912
v_mfma_f32_16x16x32_bf16 a[232:235], a[120:123], a[180:183], a[232:235]
ds_read_b128 a[156:159], v25 offset:38912
v_mfma_f32_16x16x32_bf16 a[236:239], a[124:127], a[180:183], a[236:239]
ds_read_b64_tr_b16 a[166:167], v6 offset:25600
v_mfma_f32_16x16x32_bf16 a[236:239], a[108:111], a[176:179], a[236:239]
ds_read_b64_tr_b16 a[168:169], v7 offset:16384
v_mfma_f32_16x16x32_bf16 a[252:255], a[108:111], a[184:187], a[252:255]
s_add_u32 m0, s72, 0xf00
ds_read_b64_tr_b16 a[170:171], v7 offset:17408
v_mfma_f32_16x16x32_bf16 a[252:255], a[124:127], a[188:191], a[252:255]
buffer_load_dwordx4 v22, s[16:19], s61 offen offset:256 lds
ds_read_b64_tr_b16 a[172:173], v7 offset:24576
v_mfma_f32_16x16x32_bf16 a[248:251], a[120:123], a[188:191], a[248:251]
ds_read_b64_tr_b16 a[174:175], v7 offset:25600
v_mfma_f32_16x16x32_bf16 a[248:251], a[104:107], a[184:187], a[248:251]
ds_read_b64_tr_b16 a[176:177], v8 offset:16384
v_mfma_f32_16x16x32_bf16 a[244:247], a[100:103], a[184:187], a[244:247]
ds_read_b64_tr_b16 a[178:179], v8 offset:17408
v_mfma_f32_16x16x32_bf16 a[244:247], a[116:119], a[188:191], a[244:247]
s_add_u32 m0, s72, 0x1300
ds_read_b64_tr_b16 a[180:181], v8 offset:24576
v_mfma_f32_16x16x32_bf16 a[240:243], a[112:115], a[188:191], a[240:243]
buffer_load_dwordx4 v23, s[16:19], s61 offen offset:256 lds
ds_read_b64_tr_b16 a[182:183], v8 offset:25600
v_mfma_f32_16x16x32_bf16 a[240:243], a[96:99], a[184:187], a[240:243]
s_waitcnt lgkmcnt(8)
v_mfma_f32_16x16x32_bf16 v[64:67], a[128:131], a[160:163], v[64:67]
ds_read_b64_tr_b16 a[184:185], v9 offset:16384
v_mfma_f32_16x16x32_bf16 v[64:67], a[144:147], a[164:167], v[64:67]
ds_read_b64_tr_b16 a[186:187], v9 offset:17408
v_mfma_f32_16x16x32_bf16 v[68:71], a[148:151], a[164:167], v[68:71]
ds_read_b64_tr_b16 a[188:189], v9 offset:24576
v_mfma_f32_16x16x32_bf16 v[68:71], a[132:135], a[160:163], v[68:71]
s_add_u32 m0, s72, 0x1700
ds_read_b64_tr_b16 a[190:191], v9 offset:25600
v_mfma_f32_16x16x32_bf16 v[72:75], a[136:139], a[160:163], v[72:75]
buffer_load_dwordx4 v22, s[16:19], s62 offen offset:256 lds
v_mfma_f32_16x16x32_bf16 v[72:75], a[152:155], a[164:167], v[72:75]
v_mfma_f32_16x16x32_bf16 v[76:79], a[156:159], a[164:167], v[76:79]
v_mfma_f32_16x16x32_bf16 v[76:79], a[140:143], a[160:163], v[76:79]
s_waitcnt lgkmcnt(8)
v_mfma_f32_16x16x32_bf16 v[92:95], a[140:143], a[168:171], v[92:95]
s_add_u32 m0, s72, 0x1b00
ds_read_b64_tr_b16 a[160:161], v10 offset:16384
v_mfma_f32_16x16x32_bf16 v[92:95], a[156:159], a[172:175], v[92:95]
buffer_load_dwordx4 v23, s[16:19], s62 offen offset:256 lds
ds_read_b64_tr_b16 a[162:163], v10 offset:17408
v_mfma_f32_16x16x32_bf16 v[88:91], a[152:155], a[172:175], v[88:91]
ds_read_b64_tr_b16 a[164:165], v10 offset:24576
v_mfma_f32_16x16x32_bf16 v[88:91], a[136:139], a[168:171], v[88:91]
ds_read_b64_tr_b16 a[166:167], v10 offset:25600
v_mfma_f32_16x16x32_bf16 v[84:87], a[132:135], a[168:171], v[84:87]
s_sub_u32 s88, s92, 0x2e0
s_cmp_ge_u32 s88, 0x60
s_cbranch_scc1 L_tch14
s_add_u32 s88, s88, 0x60
s_lshl_b32 s88, s88, 13
buffer_load_dword v29, v26, s[24:27], s88 offen
L_tch14:
v_mfma_f32_16x16x32_bf16 v[84:87], a[148:151], a[172:175], v[84:87]
s_add_u32 m0, s71, 0
v_mfma_f32_16x16x32_bf16 v[80:83], a[144:147], a[172:175], v[80:83]
s_add_u32 s75, s69, 0xd8000
v_mfma_f32_16x16x32_bf16 v[80:83], a[128:131], a[168:171], v[80:83]
s_waitcnt lgkmcnt(8)
buffer_load_dwordx4 v5, s[20:23], s75 offen lds
v_mfma_f32_16x16x32_bf16 v[96:99], a[128:131], a[176:179], v[96:99]
ds_read_b64_tr_b16 a[168:169], v11 offset:16384
v_mfma_f32_16x16x32_bf16 v[96:99], a[144:147], a[180:183], v[96:99]
ds_read_b64_tr_b16 a[170:171], v11 offset:17408
v_mfma_f32_16x16x32_bf16 v[100:103], a[148:151], a[180:183], v[100:103]
s_add_u32 m0, s71, 0x400
ds_read_b64_tr_b16 a[172:173], v11 offset:24576
v_mfma_f32_16x16x32_bf16 v[100:103], a[132:135], a[176:179], v[100:103]
s_add_u32 s75, s69, 0xdb600
ds_read_b64_tr_b16 a[174:175], v11 offset:25600
v_mfma_f32_16x16x32_bf16 v[104:107], a[136:139], a[176:179], v[104:107]
buffer_load_dwordx4 v5, s[20:23], s75 offen lds
v_mfma_f32_16x16x32_bf16 v[104:107], a[152:155], a[180:183], v[104:107]
v_mfma_f32_16x16x32_bf16 v[108:111], a[156:159], a[180:183], v[108:111]
v_mfma_f32_16x16x32_bf16 v[108:111], a[140:143], a[176:179], v[108:111]
s_waitcnt lgkmcnt(8)
v_mfma_f32_16x16x32_bf16 v[124:127], a[140:143], a[184:187], v[124:127]
s_add_u32 m0, s71, 0x2000
ds_read_b64_tr_b16 a[176:177], v12 offset:16384
v_mfma_f32_16x16x32_bf16 v[124:127], a[156:159], a[188:191], v[124:127]
s_add_u32 s75, s69, 0xf3000
ds_read_b64_tr_b16 a[178:179], v12 offset:17408
v_mfma_f32_16x16x32_bf16 v[120:123], a[152:155], a[188:191], v[120:123]
buffer_load_dwordx4 v5, s[20:23], s75 offen lds
ds_read_b64_tr_b16 a[180:181], v12 offset:24576
v_mfma_f32_16x16x32_bf16 v[120:123], a[136:139], a[184:187], v[120:123]
ds_read_b64_tr_b16 a[182:183], v12 offset:25600
v_mfma_f32_16x16x32_bf16 v[116:119], a[132:135], a[184:187], v[116:119]
v_mfma_f32_16x16x32_bf16 v[116:119], a[148:151], a[188:191], v[116:119]
s_add_u32 m0, s71, 0x2400
v_mfma_f32_16x16x32_bf16 v[112:115], a[144:147], a[188:191], v[112:115]
s_add_u32 s75, s69, 0xf6600
v_mfma_f32_16x16x32_bf16 v[112:115], a[128:131], a[184:187], v[112:115]
s_waitcnt lgkmcnt(8)
buffer_load_dwordx4 v5, s[20:23], s75 offen lds
v_mfma_f32_16x16x32_bf16 v[128:131], a[128:131], a[160:163], v[128:131]
ds_read_b64_tr_b16 a[184:185], v13 offset:16384
v_mfma_f32_16x16x32_bf16 v[128:131], a[144:147], a[164:167], v[128:131]
ds_read_b64_tr_b16 a[186:187], v13 offset:17408
v_mfma_f32_16x16x32_bf16 v[132:135], a[148:151], a[164:167], v[132:135]
ds_read_b64_tr_b16 a[188:189], v13 offset:24576
v_mfma_f32_16x16x32_bf16 v[132:135], a[132:135], a[160:163], v[132:135]
ds_read_b64_tr_b16 a[190:191], v13 offset:25600
v_mfma_f32_16x16x32_bf16 v[136:139], a[136:139], a[160:163], v[136:139]
s_add_u32 m0, s72, 0x7e80
v_mfma_f32_16x16x32_bf16 v[136:139], a[152:155], a[164:167], v[136:139]
buffer_load_dwordx4 v22, s[16:19], s59 offen offset:384 lds
v_mfma_f32_16x16x32_bf16 v[140:143], a[156:159], a[164:167], v[140:143]
v_mfma_f32_16x16x32_bf16 v[140:143], a[140:143], a[160:163], v[140:143]
s_waitcnt lgkmcnt(8)
v_mfma_f32_16x16x32_bf16 v[156:159], a[140:143], a[168:171], v[156:159]
s_add_u32 m0, s71, 0x4000
ds_read_b64_tr_b16 a[160:161], v6
v_mfma_f32_16x16x32_bf16 v[156:159], a[156:159], a[172:175], v[156:159]
s_add_u32 s75, s69, 0x10e000
ds_read_b64_tr_b16 a[162:163], v6 offset:1024
v_mfma_f32_16x16x32_bf16 v[152:155], a[152:155], a[172:175], v[152:155]
buffer_load_dwordx4 v5, s[20:23], s75 offen lds
ds_read_b64_tr_b16 a[164:165], v6 offset:8192
v_mfma_f32_16x16x32_bf16 v[152:155], a[136:139], a[168:171], v[152:155]
ds_read_b64_tr_b16 a[166:167], v6 offset:9216
v_mfma_f32_16x16x32_bf16 v[148:151], a[132:135], a[168:171], v[148:151]
v_mfma_f32_16x16x32_bf16 v[148:151], a[148:151], a[172:175], v[148:151]
v_mfma_f32_16x16x32_bf16 v[144:147], a[144:147], a[172:175], v[144:147]
s_waitcnt vmcnt(12) lgkmcnt(8)
ds_read_b128 a[64:67], v24
v_mfma_f32_16x16x32_bf16 v[144:147], a[128:131], a[168:171], v[144:147]
s_add_u32 m0, s72, 0x8280
ds_read_b128 a[80:83], v25
v_mfma_f32_16x16x32_bf16 v[160:163], a[128:131], a[176:179], v[160:163]
buffer_load_dwordx4 v23, s[16:19], s59 offen offset:384 lds
ds_read_b64_tr_b16 a[168:169], v7
v_mfma_f32_16x16x32_bf16 v[160:163], a[144:147], a[180:183], v[160:163]
ds_read_b64_tr_b16 a[170:171], v7 offset:1024
v_mfma_f32_16x16x32_bf16 v[164:167], a[148:151], a[180:183], v[164:167]
ds_read_b64_tr_b16 a[172:173], v7 offset:8192
v_mfma_f32_16x16x32_bf16 v[164:167], a[132:135], a[176:179], v[164:167]
ds_read_b64_tr_b16 a[174:175], v7 offset:9216
v_mfma_f32_16x16x32_bf16 v[168:171], a[136:139], a[176:179], v[168:171]
s_add_u32 m0, s72, 0x8680
v_mfma_f32_16x16x32_bf16 v[168:171], a[152:155], a[180:183], v[168:171]
buffer_load_dwordx4 v22, s[16:19], s60 offen offset:384 lds
v_mfma_f32_16x16x32_bf16 v[172:175], a[156:159], a[180:183], v[172:175]
v_mfma_f32_16x16x32_bf16 v[172:175], a[140:143], a[176:179], v[172:175]
s_waitcnt lgkmcnt(10)
v_mfma_f32_16x16x32_bf16 v[188:191], a[140:143], a[184:187], v[188:191]
ds_read_b64_tr_b16 a[176:177], v8
v_mfma_f32_16x16x32_bf16 v[188:191], a[156:159], a[188:191], v[188:191]
s_waitcnt vmcnt(12)
ds_read_b128 a[68:71], v24 offset:2048
v_mfma_f32_16x16x32_bf16 v[184:187], a[152:155], a[188:191], v[184:187]
s_add_u32 m0, s72, 0x8a80
ds_read_b128 a[84:87], v25 offset:2048
v_mfma_f32_16x16x32_bf16 v[184:187], a[136:139], a[184:187], v[184:187]
buffer_load_dwordx4 v23, s[16:19], s60 offen offset:384 lds
ds_read_b64_tr_b16 a[178:179], v8 offset:1024
v_mfma_f32_16x16x32_bf16 v[180:183], a[132:135], a[184:187], v[180:183]
ds_read_b64_tr_b16 a[180:181], v8 offset:8192
v_mfma_f32_16x16x32_bf16 v[180:183], a[148:151], a[188:191], v[180:183]
ds_read_b64_tr_b16 a[182:183], v8 offset:9216
v_mfma_f32_16x16x32_bf16 v[176:179], a[144:147], a[188:191], v[176:179]
s_waitcnt lgkmcnt(12)
v_mfma_f32_16x16x32_bf16 v[176:179], a[128:131], a[184:187], v[176:179]
s_add_u32 m0, s72, 0x8e80
v_mfma_f32_16x16x32_bf16 v[192:195], a[160:163], a[128:131], v[192:195]
buffer_load_dwordx4 v22, s[16:19], s61 offen offset:384 lds
ds_read_b64_tr_b16 a[184:185], v9
v_mfma_f32_16x16x32_bf16 v[192:195], a[164:167], a[144:147], v[192:195]
ds_read_b64_tr_b16 a[186:187], v9 offset:1024
v_mfma_f32_16x16x32_bf16 v[196:199], a[164:167], a[148:151], v[196:199]
ds_read_b64_tr_b16 a[188:189], v9 offset:8192
v_mfma_f32_16x16x32_bf16 v[196:199], a[160:163], a[132:135], v[196:199]
ds_read_b64_tr_b16 a[190:191], v9 offset:9216
v_mfma_f32_16x16x32_bf16 v[200:203], a[160:163], a[136:139], v[200:203]
s_add_u32 m0, s71, 0x4400
s_waitcnt vmcnt(12)
ds_read_b128 a[72:75], v24 offset:4096
v_mfma_f32_16x16x32_bf16 v[200:203], a[164:167], a[152:155], v[200:203]
s_add_u32 s75, s69, 0x111600
ds_read_b128 a[88:91], v25 offset:4096
v_mfma_f32_16x16x32_bf16 v[204:207], a[164:167], a[156:159], v[204:207]
buffer_load_dwordx4 v5, s[20:23], s75 offen lds
v_mfma_f32_16x16x32_bf16 v[204:207], a[160:163], a[140:143], v[204:207]
s_waitcnt lgkmcnt(12)
v_mfma_f32_16x16x32_bf16 v[220:223], a[168:171], a[140:143], v[220:223]
ds_read_b64_tr_b16 a[160:161], v10
v_mfma_f32_16x16x32_bf16 v[220:223], a[172:175], a[156:159], v[220:223]
ds_read_b64_tr_b16 a[162:163], v10 offset:1024
v_mfma_f32_16x16x32_bf16 v[216:219], a[172:175], a[152:155], v[216:219]
s_add_u32 m0, s72, 0x9280
ds_read_b64_tr_b16 a[164:165], v10 offset:8192
v_mfma_f32_16x16x32_bf16 v[216:219], a[168:171], a[136:139], v[216:219]
buffer_load_dwordx4 v23, s[16:19], s61 offen offset:384 lds
ds_read_b64_tr_b16 a[166:167], v10 offset:9216
v_mfma_f32_16x16x32_bf16 v[212:215], a[168:171], a[132:135], v[212:215]
v_mfma_f32_16x16x32_bf16 v[212:215], a[172:175], a[148:151], v[212:215]
v_mfma_f32_16x16x32_bf16 v[208:211], a[172:175], a[144:147], v[208:211]
v_mfma_f32_16x16x32_bf16 v[208:211], a[168:171], a[128:131], v[208:211]
s_waitcnt vmcnt(12) lgkmcnt(10)
ds_read_b128 a[76:79], v24 offset:6144
v_mfma_f32_16x16x32_bf16 v[224:227], a[176:179], a[128:131], v[224:227]
s_add_u32 m0, s72, 0x9680
ds_read_b128 a[92:95], v25 offset:6144
v_mfma_f32_16x16x32_bf16 v[224:227], a[180:183], a[144:147], v[224:227]
buffer_load_dwordx4 v22, s[16:19], s62 offen offset:384 lds
ds_read_b64_tr_b16 a[168:169], v11
v_mfma_f32_16x16x32_bf16 v[228:231], a[180:183], a[148:151], v[228:231]
ds_read_b64_tr_b16 a[170:171], v11 offset:1024
v_mfma_f32_16x16x32_bf16 v[228:231], a[176:179], a[132:135], v[228:231]
ds_read_b64_tr_b16 a[172:173], v11 offset:8192
v_mfma_f32_16x16x32_bf16 v[232:235], a[176:179], a[136:139], v[232:235]
ds_read_b64_tr_b16 a[174:175], v11 offset:9216
v_mfma_f32_16x16x32_bf16 v[232:235], a[180:183], a[152:155], v[232:235]
s_add_u32 m0, s72, 0x9a80
v_mfma_f32_16x16x32_bf16 v[236:239], a[180:183], a[156:159], v[236:239]
buffer_load_dwordx4 v23, s[16:19], s62 offen offset:384 lds
v_mfma_f32_16x16x32_bf16 v[236:239], a[176:179], a[140:143], v[236:239]
s_waitcnt lgkmcnt(12)
v_mfma_f32_16x16x32_bf16 v[252:255], a[184:187], a[140:143], v[252:255]
ds_read_b64_tr_b16 a[176:177], v12
v_mfma_f32_16x16x32_bf16 v[252:255], a[188:191], a[156:159], v[252:255]
ds_read_b64_tr_b16 a[178:179], v12 offset:1024
v_mfma_f32_16x16x32_bf16 v[248:251], a[188:191], a[152:155], v[248:251]
s_sub_u32 s88, s92, 0x340
s_cmp_ge_u32 s88, 0x60
s_cbranch_scc1 L_tch15
s_add_u32 s88, s88, 0xc0
s_lshl_b32 s88, s88, 13
buffer_load_dword v29, v26, s[24:27], s88 offen
L_tch15:
v_mfma_f32_16x16x32_bf16 v[248:251], a[184:187], a[136:139], v[248:251]
s_add_u32 m0, s71, 0x6000
ds_read_b64_tr_b16 a[180:181], v12 offset:8192
v_mfma_f32_16x16x32_bf16 v[244:247], a[184:187], a[132:135], v[244:247]
s_add_u32 s75, s69, 0x129000
ds_read_b64_tr_b16 a[182:183], v12 offset:9216
v_mfma_f32_16x16x32_bf16 v[244:247], a[188:191], a[148:151], v[244:247]
buffer_load_dwordx4 v5, s[20:23], s75 offen lds
v_mfma_f32_16x16x32_bf16 v[240:243], a[188:191], a[144:147], v[240:243]
s_waitcnt lgkmcnt(10)
v_mfma_f32_16x16x32_bf16 v[240:243], a[184:187], a[128:131], v[240:243]
s_add_u32 m0, s71, 0x6400
v_mfma_f32_16x16x32_bf16 a[0:3], a[160:163], a[128:131], a[0:3]
s_add_u32 s75, s69, 0x12c600
ds_read_b64_tr_b16 a[184:185], v13
v_mfma_f32_16x16x32_bf16 a[0:3], a[164:167], a[144:147], a[0:3]
buffer_load_dwordx4 v5, s[20:23], s75 offen lds
ds_read_b64_tr_b16 a[186:187], v13 offset:1024
v_mfma_f32_16x16x32_bf16 a[4:7], a[164:167], a[148:151], a[4:7]
ds_read_b64_tr_b16 a[188:189], v13 offset:8192
v_mfma_f32_16x16x32_bf16 a[4:7], a[160:163], a[132:135], a[4:7]
ds_read_b64_tr_b16 a[190:191], v13 offset:9216
v_mfma_f32_16x16x32_bf16 a[8:11], a[160:163], a[136:139], a[8:11]
v_mfma_f32_16x16x32_bf16 a[8:11], a[164:167], a[152:155], a[8:11]
v_mfma_f32_16x16x32_bf16 a[12:15], a[164:167], a[156:159], a[12:15]
s_add_u32 m0, s72, 0xfffffe00
v_mfma_f32_16x16x32_bf16 a[12:15], a[160:163], a[140:143], a[12:15]
s_waitcnt lgkmcnt(8)
buffer_load_dwordx4 v22, s[16:19], s59 offen offset:512 lds
v_mfma_f32_16x16x32_bf16 a[28:31], a[168:171], a[140:143], a[28:31]
v_mfma_f32_16x16x32_bf16 a[28:31], a[172:175], a[156:159], a[28:31]
v_mfma_f32_16x16x32_bf16 a[24:27], a[172:175], a[152:155], a[24:27]
v_mfma_f32_16x16x32_bf16 a[24:27], a[168:171], a[136:139], a[24:27]
s_add_u32 m0, s72, 0x200
v_mfma_f32_16x16x32_bf16 a[20:23], a[168:171], a[132:135], a[20:23]
buffer_load_dwordx4 v23, s[16:19], s59 offen offset:512 lds
v_mfma_f32_16x16x32_bf16 a[20:23], a[172:175], a[148:151], a[20:23]
v_mfma_f32_16x16x32_bf16 a[16:19], a[172:175], a[144:147], a[16:19]
v_mfma_f32_16x16x32_bf16 a[16:19], a[168:171], a[128:131], a[16:19]
s_waitcnt lgkmcnt(0)
v_mfma_f32_16x16x32_bf16 a[32:35], a[176:179], a[128:131], a[32:35]
s_barrier
v_mfma_f32_16x16x32_bf16 a[32:35], a[180:183], a[144:147], a[32:35]
s_add_u32 m0, s72, 0x600
v_add_u32 v14, 0x8000, v14
ds_read_b64_tr_b16 a[160:161], v14 offset:32768
v_mfma_f32_16x16x32_bf16 a[36:39], a[180:183], a[148:151], a[36:39]
buffer_load_dwordx4 v22, s[16:19], s60 offen offset:512 lds
ds_read_b64_tr_b16 a[162:163], v14 offset:33792
v_mfma_f32_16x16x32_bf16 a[36:39], a[176:179], a[132:135], a[36:39]
ds_read_b64_tr_b16 a[164:165], v14 offset:40960
v_mfma_f32_16x16x32_bf16 a[40:43], a[176:179], a[136:139], a[40:43]
ds_read_b64_tr_b16 a[166:167], v14 offset:41984
v_add_u32 v15, 0x8000, v15
v_mfma_f32_16x16x32_bf16 a[40:43], a[180:183], a[152:155], a[40:43]
ds_read_b64_tr_b16 a[168:169], v15 offset:32768
v_mfma_f32_16x16x32_bf16 a[44:47], a[180:183], a[156:159], a[44:47]
s_add_u32 m0, s72, 0xa00
s_waitcnt vmcnt(12)
ds_read_b128 a[96:99], v24 offset:32768
v_mfma_f32_16x16x32_bf16 a[44:47], a[176:179], a[140:143], a[44:47]
buffer_load_dwordx4 v23, s[16:19], s60 offen offset:512 lds
ds_read_b128 a[112:115], v25 offset:32768
v_mfma_f32_16x16x32_bf16 a[60:63], a[184:187], a[140:143], a[60:63]
ds_read_b64_tr_b16 a[170:171], v15 offset:33792
v_mfma_f32_16x16x32_bf16 a[60:63], a[188:191], a[156:159], a[60:63]
ds_read_b64_tr_b16 a[172:173], v15 offset:40960
v_mfma_f32_16x16x32_bf16 a[56:59], a[188:191], a[152:155], a[56:59]
ds_read_b64_tr_b16 a[174:175], v15 offset:41984
v_add_u32 v16, 0x8000, v16
v_mfma_f32_16x16x32_bf16 a[56:59], a[184:187], a[136:139], a[56:59]
ds_read_b64_tr_b16 a[176:177], v16 offset:32768
v_mfma_f32_16x16x32_bf16 a[52:55], a[184:187], a[132:135], a[52:55]
s_add_u32 m0, s72, 0xe00
ds_read_b64_tr_b16 a[178:179], v16 offset:33792
v_mfma_f32_16x16x32_bf16 a[52:55], a[188:191], a[148:151], a[52:55]
buffer_load_dwordx4 v22, s[16:19], s61 offen offset:512 lds
ds_read_b64_tr_b16 a[180:181], v16 offset:40960
v_mfma_f32_16x16x32_bf16 a[48:51], a[188:191], a[144:147], a[48:51]
ds_read_b64_tr_b16 a[182:183], v16 offset:41984
v_add_u32 v17, 0x8000, v17
v_mfma_f32_16x16x32_bf16 a[48:51], a[184:187], a[128:131], a[48:51]
s_waitcnt lgkmcnt(10)
v_mfma_f32_16x16x32_bf16 a[192:195], a[64:67], a[160:163], a[192:195]
ds_read_b64_tr_b16 a[184:185], v17 offset:32768
v_mfma_f32_16x16x32_bf16 a[192:195], a[80:83], a[164:167], a[192:195]
s_add_u32 m0, s72, 0x1200
s_waitcnt vmcnt(12)
ds_read_b128 a[100:103], v24 offset:34816
v_mfma_f32_16x16x32_bf16 a[196:199], a[84:87], a[164:167], a[196:199]
buffer_load_dwordx4 v23, s[16:19], s61 offen offset:512 lds
ds_read_b128 a[116:119], v25 offset:34816
v_mfma_f32_16x16x32_bf16 a[196:199], a[68:71], a[160:163], a[196:199]
ds_read_b64_tr_b16 a[186:187], v17 offset:33792
v_mfma_f32_16x16x32_bf16 a[200:203], a[72:75], a[160:163], a[200:203]
ds_read_b64_tr_b16 a[188:189], v17 offset:40960
v_mfma_f32_16x16x32_bf16 a[200:203], a[88:91], a[164:167], a[200:203]
ds_read_b64_tr_b16 a[190:191], v17 offset:41984
v_mfma_f32_16x16x32_bf16 a[204:207], a[92:95], a[164:167], a[204:207]
s_waitcnt lgkmcnt(10)
v_mfma_f32_16x16x32_bf16 a[204:207], a[76:79], a[160:163], a[204:207]
s_add_u32 m0, s72, 0x1600
v_mfma_f32_16x16x32_bf16 a[220:223], a[76:79], a[168:171], a[220:223]
buffer_load_dwordx4 v22, s[16:19], s62 offen offset:512 lds
ds_read_b64_tr_b16 a[160:161], v14 offset:49152
v_mfma_f32_16x16x32_bf16 a[220:223], a[92:95], a[172:175], a[220:223]
s_add_u32 m0, s72, 0x1a00
ds_read_b64_tr_b16 a[162:163], v14 offset:50176
v_mfma_f32_16x16x32_bf16 a[216:219], a[88:91], a[172:175], a[216:219]
buffer_load_dwordx4 v23, s[16:19], s62 offen offset:512 lds
ds_read_b64_tr_b16 a[164:165], v14 offset:57344
v_mfma_f32_16x16x32_bf16 a[216:219], a[72:75], a[168:171], a[216:219]
ds_read_b64_tr_b16 a[166:167], v14 offset:58368
v_mfma_f32_16x16x32_bf16 a[212:215], a[68:71], a[168:171], a[212:215]
v_mfma_f32_16x16x32_bf16 a[212:215], a[84:87], a[172:175], a[212:215]
s_add_u32 m0, s68, 0x8000
v_mfma_f32_16x16x32_bf16 a[208:211], a[80:83], a[172:175], a[208:211]
s_add_u32 s75, s67, 0x200000
v_mfma_f32_16x16x32_bf16 a[208:211], a[64:67], a[168:171], a[208:211]
s_waitcnt lgkmcnt(10)
buffer_load_dwordx4 v4, s[12:15], s75 offen lds
v_mfma_f32_16x16x32_bf16 a[224:227], a[64:67], a[176:179], a[224:227]
ds_read_b64_tr_b16 a[168:169], v15 offset:49152
v_mfma_f32_16x16x32_bf16 a[224:227], a[80:83], a[180:183], a[224:227]
s_waitcnt vmcnt(11)
ds_read_b128 a[104:107], v24 offset:36864
v_mfma_f32_16x16x32_bf16 a[228:231], a[84:87], a[180:183], a[228:231]
ds_read_b128 a[120:123], v25 offset:36864
v_mfma_f32_16x16x32_bf16 a[228:231], a[68:71], a[176:179], a[228:231]
s_add_u32 m0, s68, 0x8400
ds_read_b64_tr_b16 a[170:171], v15 offset:50176
v_mfma_f32_16x16x32_bf16 a[232:235], a[72:75], a[176:179], a[232:235]
s_add_u32 s75, s67, 0x208000
ds_read_b128 a[108:111], v24 offset:38912
v_mfma_f32_16x16x32_bf16 a[232:235], a[88:91], a[180:183], a[232:235]
buffer_load_dwordx4 v4, s[12:15], s75 offen lds
ds_read_b128 a[124:127], v25 offset:38912
v_mfma_f32_16x16x32_bf16 a[236:239], a[92:95], a[180:183], a[236:239]
ds_read_b64_tr_b16 a[172:173], v15 offset:57344
v_mfma_f32_16x16x32_bf16 a[236:239], a[76:79], a[176:179], a[236:239]
s_waitcnt lgkmcnt(11)
ds_read_b64_tr_b16 a[174:175], v15 offset:58368
v_mfma_f32_16x16x32_bf16 a[252:255], a[76:79], a[184:187], a[252:255]
s_add_u32 m0, s68, 0x9000
ds_read_b64_tr_b16 a[176:177], v16 offset:49152
v_mfma_f32_16x16x32_bf16 a[252:255], a[92:95], a[188:191], a[252:255]
s_add_u32 s75, s67, 0x220000
ds_read_b64_tr_b16 a[178:179], v16 offset:50176
v_mfma_f32_16x16x32_bf16 a[248:251], a[88:91], a[188:191], a[248:251]
buffer_load_dwordx4 v4, s[12:15], s75 offen lds
ds_read_b64_tr_b16 a[180:181], v16 offset:57344
v_mfma_f32_16x16x32_bf16 a[248:251], a[72:75], a[184:187], a[248:251]
ds_read_b64_tr_b16 a[182:183], v16 offset:58368
v_mfma_f32_16x16x32_bf16 a[244:247], a[68:71], a[184:187], a[244:247]
s_lshl_b32 s88, s48, 13
s_add_u32 s88, s88, L_cp600-L_pc
v_lshlrev_b32 v30, 7, v0
v_add_u32 v30, s88, v30
v_min_u32 v30, L_codeend-L_pc-4, v30
global_load_dword v29, v30, s[98:99]
v_mfma_f32_16x16x32_bf16 a[244:247], a[84:87], a[188:191], a[244:247]
s_waitcnt lgkmcnt(6)
v_mfma_f32_16x16x32_bf16 a[240:243], a[80:83], a[188:191], a[240:243]
s_add_u32 m0, s68, 0x9400
v_mfma_f32_16x16x32_bf16 a[240:243], a[64:67], a[184:187], a[240:243]
s_add_u32 s75, s67, 0x228000
v_mfma_f32_16x16x32_bf16 a[192:195], a[96:99], a[160:163], a[192:195]
buffer_load_dwordx4 v4, s[12:15], s75 offen lds
ds_read_b64_tr_b16 a[184:185], v17 offset:49152
v_mfma_f32_16x16x32_bf16 a[192:195], a[112:115], a[164:167], a[192:195]
s_add_u32 m0, s72, 0x7d80
ds_read_b64_tr_b16 a[186:187], v17 offset:50176
v_mfma_f32_16x16x32_bf16 a[196:199], a[116:119], a[164:167], a[196:199]
buffer_load_dwordx4 v22, s[16:19], s59 offen offset:640 lds
s_add_u32 m0, s68, 0xa000
ds_read_b64_tr_b16 a[188:189], v17 offset:57344
v_mfma_f32_16x16x32_bf16 a[196:199], a[100:103], a[160:163], a[196:199]
s_add_u32 s75, s67, 0x240000
ds_read_b64_tr_b16 a[190:191], v17 offset:58368
v_mfma_f32_16x16x32_bf16 a[200:203], a[104:107], a[160:163], a[200:203]
buffer_load_dwordx4 v4, s[12:15], s75 offen lds
v_mfma_f32_16x16x32_bf16 a[200:203], a[120:123], a[164:167], a[200:203]
v_mfma_f32_16x16x32_bf16 a[204:207], a[124:127], a[164:167], a[204:207]
s_waitcnt lgkmcnt(8)
v_mfma_f32_16x16x32_bf16 a[204:207], a[108:111], a[160:163], a[204:207]
s_sub_u32 s88, s92, 0
s_cmp_ge_u32 s88, 0x73
s_cbranch_scc1 L_tch16
s_add_u32 s88, s88, 0
s_lshl_b32 s88, s88, 13
buffer_load_dword v29, v26, s[28:31], s88 offen
L_tch16:
v_mfma_f32_16x16x32_bf16 a[220:223], a[108:111], a[168:171], a[220:223]
s_add_u32 m0, s72, 0x8180
v_mfma_f32_16x16x32_bf16 a[220:223], a[124:127], a[172:175], a[220:223]
buffer_load_dwordx4 v23, s[16:19], s59 offen offset:640 lds
v_mfma_f32_16x16x32_bf16 a[216:219], a[120:123], a[172:175], a[216:219]
s_add_u32 m0, s72, 0x8580
v_mfma_f32_16x16x32_bf16 a[216:219], a[104:107], a[168:171], a[216:219]
buffer_load_dwordx4 v22, s[16:19], s60 offen offset:640 lds
v_mfma_f32_16x16x32_bf16 a[212:215], a[100:103], a[168:171], a[212:215]
s_add_u32 m0, s72, 0x8980
v_mfma_f32_16x16x32_bf16 a[212:215], a[116:119], a[172:175], a[212:215]
buffer_load_dwordx4 v23, s[16:19], s60 offen offset:640 lds
v_mfma_f32_16x16x32_bf16 a[208:211], a[112:115], a[172:175], a[208:211]
s_add_u32 m0, s72, 0x8d80
s_waitcnt vmcnt(14)
ds_read_b128 a[128:131], v24
v_mfma_f32_16x16x32_bf16 a[208:211], a[96:99], a[168:171], a[208:211]
s_waitcnt lgkmcnt(1)
buffer_load_dwordx4 v22, s[16:19], s61 offen offset:640 lds
s_add_u32 m0, s68, 0xa400
ds_read_b128 a[144:147], v25
v_mfma_f32_16x16x32_bf16 a[224:227], a[96:99], a[176:179], a[224:227]
s_barrier
v_mfma_f32_16x16x32_bf16 a[224:227], a[112:115], a[180:183], a[224:227]
s_add_u32 s75, s67, 0x248000
ds_read_b128 a[132:135], v24 offset:2048
v_add_u32 v14, 0xffff8000, v14
v_mfma_f32_16x16x32_bf16 a[228:231], a[116:119], a[180:183], a[228:231]
buffer_load_dwordx4 v4, s[12:15], s75 offen lds
s_add_u32 m0, s72, 0x9180
ds_read_b128 a[148:151], v25 offset:2048
v_mfma_f32_16x16x32_bf16 a[228:231], a[100:103], a[176:179], a[228:231]
buffer_load_dwordx4 v23, s[16:19], s61 offen offset:640 lds
s_waitcnt vmcnt(14)
ds_read_b128 a[136:139], v24 offset:4096
v_mfma_f32_16x16x32_bf16 a[232:235], a[104:107], a[176:179], a[232:235]
s_add_u32 m0, s72, 0x9580
ds_read_b128 a[152:155], v25 offset:4096
v_mfma_f32_16x16x32_bf16 a[232:235], a[120:123], a[180:183], a[232:235]
buffer_load_dwordx4 v22, s[16:19], s62 offen offset:640 lds
s_waitcnt vmcnt(14)
ds_read_b128 a[140:143], v24 offset:6144
v_mfma_f32_16x16x32_bf16 a[236:239], a[124:127], a[180:183], a[236:239]
s_add_u32 m0, s72, 0x9980
ds_read_b128 a[156:159], v25 offset:6144
v_mfma_f32_16x16x32_bf16 a[236:239], a[108:111], a[176:179], a[236:239]
buffer_load_dwordx4 v23, s[16:19], s62 offen offset:640 lds
s_add_u32 m0, s68, 0xb000
ds_read_b64_tr_b16 a[160:161], v14
v_mfma_f32_16x16x32_bf16 a[252:255], a[108:111], a[184:187], a[252:255]
s_add_u32 s75, s67, 0x260000
ds_read_b64_tr_b16 a[162:163], v14 offset:1024
v_mfma_f32_16x16x32_bf16 a[252:255], a[124:127], a[188:191], a[252:255]
ds_read_b64_tr_b16 a[164:165], v14 offset:8192
buffer_load_dwordx4 v4, s[12:15], s75 offen lds
s_add_u32 m0, s68, 0xb400
v_mfma_f32_16x16x32_bf16 a[248:251], a[120:123], a[188:191], a[248:251]
s_add_u32 s75, s67, 0x268000
ds_read_b64_tr_b16 a[166:167], v14 offset:9216
v_add_u32 v15, 0xffff8000, v15
v_mfma_f32_16x16x32_bf16 a[248:251], a[104:107], a[184:187], a[248:251]
buffer_load_dwordx4 v4, s[12:15], s75 offen lds
ds_read_b64_tr_b16 a[168:169], v15
v_mfma_f32_16x16x32_bf16 a[244:247], a[100:103], a[184:187], a[244:247]
s_add_u32 m0, s72, 0xfffffe00
ds_read_b64_tr_b16 a[170:171], v15 offset:1024
v_mfma_f32_16x16x32_bf16 a[244:247], a[116:119], a[188:191], a[244:247]
s_waitcnt lgkmcnt(10)
buffer_load_dwordx4 v2, s[8:11], s55 offen offset:512 lds
ds_read_b64_tr_b16 a[172:173], v15 offset:8192
v_mfma_f32_16x16x32_bf16 a[240:243], a[112:115], a[188:191], a[240:243]
ds_read_b64_tr_b16 a[174:175], v15 offset:9216
v_add_u32 v16, 0xffff8000, v16
v_mfma_f32_16x16x32_bf16 a[240:243], a[96:99], a[184:187], a[240:243]
s_waitcnt lgkmcnt(6)
ds_read_b64_tr_b16 a[176:177], v16
v_mfma_f32_16x16x32_bf16 a[192:195], a[128:131], a[160:163], a[192:195]
s_waitcnt lgkmcnt(5)
ds_read_b64_tr_b16 a[178:179], v16 offset:1024
v_mfma_f32_16x16x32_bf16 a[192:195], a[144:147], a[164:167], a[192:195]
ds_read_b64_tr_b16 a[180:181], v16 offset:8192
v_mfma_f32_16x16x32_bf16 a[196:199], a[148:151], a[164:167], a[196:199]
s_add_u32 m0, s72, 0x200
ds_read_b64_tr_b16 a[182:183], v16 offset:9216
v_add_u32 v17, 0xffff8000, v17
v_mfma_f32_16x16x32_bf16 a[196:199], a[132:135], a[160:163], a[196:199]
buffer_load_dwordx4 v3, s[8:11], s55 offen offset:512 lds
ds_read_b64_tr_b16 a[184:185], v17
v_mfma_f32_16x16x32_bf16 a[200:203], a[136:139], a[160:163], a[200:203]
ds_read_b64_tr_b16 a[186:187], v17 offset:1024
v_mfma_f32_16x16x32_bf16 a[200:203], a[152:155], a[164:167], a[200:203]
ds_read_b64_tr_b16 a[188:189], v17 offset:8192
v_mfma_f32_16x16x32_bf16 a[204:207], a[156:159], a[164:167], a[204:207]
s_waitcnt lgkmcnt(7)
ds_read_b64_tr_b16 a[190:191], v17 offset:9216
v_mfma_f32_16x16x32_bf16 a[204:207], a[140:143], a[160:163], a[204:207]
s_add_u32 m0, s72, 0x600
v_mfma_f32_16x16x32_bf16 a[220:223], a[140:143], a[168:171], a[220:223]
buffer_load_dwordx4 v2, s[8:11], s56 offen offset:512 lds
ds_read_b64_tr_b16 a[160:161], v14 offset:16384
v_mfma_f32_16x16x32_bf16 a[220:223], a[156:159], a[172:175], a[220:223]
s_add_u32 m0, s72, 0xa00
ds_read_b64_tr_b16 a[162:163], v14 offset:17408
v_mfma_f32_16x16x32_bf16 a[216:219], a[152:155], a[172:175], a[216:219]
buffer_load_dwordx4 v3, s[8:11], s56 offen offset:512 lds
ds_read_b64_tr_b16 a[164:165], v14 offset:24576
v_mfma_f32_16x16x32_bf16 a[216:219], a[136:139], a[168:171], a[216:219]
s_add_u32 m0, s72, 0xe00
ds_read_b64_tr_b16 a[166:167], v14 offset:25600
v_mfma_f32_16x16x32_bf16 a[212:215], a[132:135], a[168:171], a[212:215]
buffer_load_dwordx4 v2, s[8:11], s57 offen offset:512 lds
v_mfma_f32_16x16x32_bf16 a[212:215], a[148:151], a[172:175], a[212:215]
s_add_u32 m0, s72, 0x1200
v_mfma_f32_16x16x32_bf16 a[208:211], a[144:147], a[172:175], a[208:211]
s_waitcnt lgkmcnt(8)
buffer_load_dwordx4 v3, s[8:11], s57 offen offset:512 lds
s_waitcnt vmcnt(15)
ds_read_b128 a[64:67], v24 offset:32768
v_mfma_f32_16x16x32_bf16 a[208:211], a[128:131], a[168:171], a[208:211]
s_add_u32 m0, s72, 0x1600
ds_read_b128 a[80:83], v25 offset:32768
v_mfma_f32_16x16x32_bf16 a[224:227], a[128:131], a[176:179], a[224:227]
buffer_load_dwordx4 v2, s[8:11], s58 offen offset:512 lds
s_waitcnt vmcnt(14)
ds_read_b128 a[68:71], v24 offset:34816
v_mfma_f32_16x16x32_bf16 a[224:227], a[144:147], a[180:183], a[224:227]
s_add_u32 m0, s72, 0x1a00
ds_read_b128 a[84:87], v25 offset:34816
v_mfma_f32_16x16x32_bf16 a[228:231], a[148:151], a[180:183], a[228:231]
buffer_load_dwordx4 v3, s[8:11], s58 offen offset:512 lds
s_add_u32 m0, s71, 0x10000
s_waitcnt vmcnt(12)
ds_read_b128 a[72:75], v24 offset:36864
v_mfma_f32_16x16x32_bf16 a[228:231], a[132:135], a[176:179], a[228:231]
s_add_u32 s75, s69, 0x144000
ds_read_b128 a[88:91], v25 offset:36864
v_mfma_f32_16x16x32_bf16 a[232:235], a[136:139], a[176:179], a[232:235]
buffer_load_dwordx4 v5, s[20:23], s75 offen lds
s_waitcnt vmcnt(11)
ds_read_b128 a[76:79], v24 offset:38912
v_mfma_f32_16x16x32_bf16 a[232:235], a[152:155], a[180:183], a[232:235]
ds_read_b128 a[92:95], v25 offset:38912
v_mfma_f32_16x16x32_bf16 a[236:239], a[156:159], a[180:183], a[236:239]
ds_read_b64_tr_b16 a[168:169], v15 offset:16384
v_mfma_f32_16x16x32_bf16 a[236:239], a[140:143], a[176:179], a[236:239]
s_waitcnt lgkmcnt(13)
ds_read_b64_tr_b16 a[170:171], v15 offset:17408
v_mfma_f32_16x16x32_bf16 a[252:255], a[140:143], a[184:187], a[252:255]
s_add_u32 m0, s71, 0x10400
ds_read_b64_tr_b16 a[172:173], v15 offset:24576
v_mfma_f32_16x16x32_bf16 a[252:255], a[156:159], a[188:191], a[252:255]
s_add_u32 s75, s69, 0x147600
ds_read_b64_tr_b16 a[174:175], v15 offset:25600
v_mfma_f32_16x16x32_bf16 a[248:251], a[152:155], a[188:191], a[248:251]
buffer_load_dwordx4 v5, s[20:23], s75 offen lds
ds_read_b64_tr_b16 a[176:177], v16 offset:16384
v_mfma_f32_16x16x32_bf16 a[248:251], a[136:139], a[184:187], a[248:251]
ds_read_b64_tr_b16 a[178:179], v16 offset:17408
v_mfma_f32_16x16x32_bf16 a[244:247], a[132:135], a[184:187], a[244:247]
ds_read_b64_tr_b16 a[180:181], v16 offset:24576
v_mfma_f32_16x16x32_bf16 a[244:247], a[148:151], a[188:191], a[244:247]
s_add_u32 m0, s71, 0x12000
ds_read_b64_tr_b16 a[182:183], v16 offset:25600
v_mfma_f32_16x16x32_bf16 a[240:243], a[144:147], a[188:191], a[240:243]
s_add_u32 s75, s69, 0x15f000
v_mfma_f32_16x16x32_bf16 a[240:243], a[128:131], a[184:187], a[240:243]
s_waitcnt lgkmcnt(8)
buffer_load_dwordx4 v5, s[20:23], s75 offen lds
v_mfma_f32_16x16x32_bf16 a[192:195], a[64:67], a[160:163], a[192:195]
ds_read_b64_tr_b16 a[184:185], v17 offset:16384
v_mfma_f32_16x16x32_bf16 a[192:195], a[80:83], a[164:167], a[192:195]
ds_read_b64_tr_b16 a[186:187], v17 offset:17408
v_mfma_f32_16x16x32_bf16 a[196:199], a[84:87], a[164:167], a[196:199]
ds_read_b64_tr_b16 a[188:189], v17 offset:24576
v_mfma_f32_16x16x32_bf16 a[196:199], a[68:71], a[160:163], a[196:199]
s_add_u32 m0, s71, 0x12400
ds_read_b64_tr_b16 a[190:191], v17 offset:25600
v_mfma_f32_16x16x32_bf16 a[200:203], a[72:75], a[160:163], a[200:203]
s_add_u32 s75, s69, 0x162600
v_mfma_f32_16x16x32_bf16 a[200:203], a[88:91], a[164:167], a[200:203]
buffer_load_dwordx4 v5, s[20:23], s75 offen lds
v_mfma_f32_16x16x32_bf16 a[204:207], a[92:95], a[164:167], a[204:207]
v_mfma_f32_16x16x32_bf16 a[204:207], a[76:79], a[160:163], a[204:207]
s_waitcnt lgkmcnt(8)
v_mfma_f32_16x16x32_bf16 a[220:223], a[76:79], a[168:171], a[220:223]
s_add_u32 m0, s71, 0x14000
v_mfma_f32_16x16x32_bf16 a[220:223], a[92:95], a[172:175], a[220:223]
s_add_u32 s75, s69, 0x17a000
v_mfma_f32_16x16x32_bf16 a[216:219], a[88:91], a[172:175], a[216:219]
buffer_load_dwordx4 v5, s[20:23], s75 offen lds
v_mfma_f32_16x16x32_bf16 a[216:219], a[72:75], a[168:171], a[216:219]
v_mfma_f32_16x16x32_bf16 a[212:215], a[68:71], a[168:171], a[212:215]
v_mfma_f32_16x16x32_bf16 a[212:215], a[84:87], a[172:175], a[212:215]
s_waitcnt lgkmcnt(0)
v_mfma_f32_16x16x32_bf16 a[208:211], a[80:83], a[172:175], a[208:211]
s_add_u32 m0, s71, 0x14400
s_waitcnt vmcnt(11)
ds_read_b128 a[96:99], v24
v_mfma_f32_16x16x32_bf16 a[208:211], a[64:67], a[168:171], a[208:211]
s_add_u32 s75, s69, 0x17d600
ds_read_b128 a[112:115], v25
v_mfma_f32_16x16x32_bf16 a[224:227], a[64:67], a[176:179], a[224:227]
s_barrier
v_mfma_f32_16x16x32_bf16 a[224:227], a[80:83], a[180:183], a[224:227]
buffer_load_dwordx4 v5, s[20:23], s75 offen lds
s_waitcnt vmcnt(10)
ds_read_b128 a[100:103], v24 offset:2048
v_mfma_f32_16x16x32_bf16 a[228:231], a[84:87], a[180:183], a[228:231]
ds_read_b128 a[116:119], v25 offset:2048
v_mfma_f32_16x16x32_bf16 a[228:231], a[68:71], a[176:179], a[228:231]
s_add_u32 m0, s71, 0x16000
s_waitcnt vmcnt(8)
ds_read_b128 a[104:107], v24 offset:4096
v_mfma_f32_16x16x32_bf16 a[232:235], a[72:75], a[176:179], a[232:235]
s_add_u32 s75, s69, 0x195000
ds_read_b128 a[120:123], v25 offset:4096
v_mfma_f32_16x16x32_bf16 a[232:235], a[88:91], a[180:183], a[232:235]
s_sub_u32 s88, s92, 0x73
s_cmp_ge_u32 s88, 0x73
s_cbranch_scc1 L_tch17
s_add_u32 s88, s88, 0x73
s_lshl_b32 s88, s88, 13
buffer_load_dword v29, v26, s[28:31], s88 offen
L_tch17:
v_mfma_f32_16x16x32_bf16 a[236:239], a[92:95], a[180:183], a[236:239]
buffer_load_dwordx4 v5, s[20:23], s75 offen lds
s_waitcnt vmcnt(7)
ds_read_b128 a[108:111], v24 offset:6144
v_mfma_f32_16x16x32_bf16 a[236:239], a[76:79], a[176:179], a[236:239]
ds_read_b128 a[124:127], v25 offset:6144
v_mfma_f32_16x16x32_bf16 a[252:255], a[76:79], a[184:187], a[252:255]
ds_read_b64_tr_b16 a[160:161], v6 offset:16384
v_mfma_f32_16x16x32_bf16 a[252:255], a[92:95], a[188:191], a[252:255]
s_add_u32 m0, s71, 0x16400
ds_read_b64_tr_b16 a[162:163], v6 offset:17408
v_mfma_f32_16x16x32_bf16 a[248:251], a[88:91], a[188:191], a[248:251]
s_add_u32 s75, s69, 0x198600
ds_read_b64_tr_b16 a[164:165], v6 offset:24576
ds_read_b64_tr_b16 a[166:167], v6 offset:25600
v_mfma_f32_16x16x32_bf16 a[248:251], a[72:75], a[184:187], a[248:251]
buffer_load_dwordx4 v5, s[20:23], s75 offen lds
ds_read_b64_tr_b16 a[168:169], v7 offset:16384
v_mfma_f32_16x16x32_bf16 a[244:247], a[68:71], a[184:187], a[244:247]
ds_read_b64_tr_b16 a[170:171], v7 offset:17408
v_mfma_f32_16x16x32_bf16 a[244:247], a[84:87], a[188:191], a[244:247]
ds_read_b64_tr_b16 a[172:173], v7 offset:24576
v_mfma_f32_16x16x32_bf16 a[240:243], a[80:83], a[188:191], a[240:243]
ds_read_b64_tr_b16 a[174:175], v7 offset:25600
v_mfma_f32_16x16x32_bf16 a[240:243], a[64:67], a[184:187], a[240:243]
s_waitcnt lgkmcnt(6)
s_add_u32 m0, s72, 0x7d00
ds_read_b64_tr_b16 a[176:177], v8 offset:16384
v_mfma_f32_16x16x32_bf16 v[64:67], a[96:99], a[160:163], v[64:67]
s_waitcnt lgkmcnt(5)
buffer_load_dwordx4 v22, s[16:19], s59 offen offset:768 lds
ds_read_b64_tr_b16 a[178:179], v8 offset:17408
v_mfma_f32_16x16x32_bf16 v[64:67], a[112:115], a[164:167], v[64:67]
ds_read_b64_tr_b16 a[180:181], v8 offset:24576
v_mfma_f32_16x16x32_bf16 v[68:71], a[116:119], a[164:167], v[68:71]
ds_read_b64_tr_b16 a[182:183], v8 offset:25600
v_mfma_f32_16x16x32_bf16 v[68:71], a[100:103], a[160:163], v[68:71]
ds_read_b64_tr_b16 a[184:185], v9 offset:16384
v_mfma_f32_16x16x32_bf16 v[72:75], a[104:107], a[160:163], v[72:75]
ds_read_b64_tr_b16 a[186:187], v9 offset:17408
v_mfma_f32_16x16x32_bf16 v[72:75], a[120:123], a[164:167], v[72:75]
s_add_u32 m0, s72, 0x8100
ds_read_b64_tr_b16 a[188:189], v9 offset:24576
v_mfma_f32_16x16x32_bf16 v[76:79], a[124:127], a[164:167], v[76:79]
buffer_load_dwordx4 v23, s[16:19], s59 offen offset:768 lds
ds_read_b64_tr_b16 a[190:191], v9 offset:25600
v_mfma_f32_16x16x32_bf16 v[76:79], a[108:111], a[160:163], v[76:79]
s_waitcnt lgkmcnt(8)
v_mfma_f32_16x16x32_bf16 v[92:95], a[108:111], a[168:171], v[92:95]
ds_read_b64_tr_b16 a[160:161], v10 offset:16384
v_mfma_f32_16x16x32_bf16 v[92:95], a[124:127], a[172:175], v[92:95]
ds_read_b64_tr_b16 a[162:163], v10 offset:17408
v_mfma_f32_16x16x32_bf16 v[88:91], a[120:123], a[172:175], v[88:91]
s_add_u32 m0, s72, 0x8500
ds_read_b64_tr_b16 a[164:165], v10 offset:24576
v_mfma_f32_16x16x32_bf16 v[88:91], a[104:107], a[168:171], v[88:91]
buffer_load_dwordx4 v22, s[16:19], s60 offen offset:768 lds
ds_read_b64_tr_b16 a[166:167], v10 offset:25600
v_mfma_f32_16x16x32_bf16 v[84:87], a[100:103], a[168:171], v[84:87]
v_mfma_f32_16x16x32_bf16 v[84:87], a[116:119], a[172:175], v[84:87]
v_mfma_f32_16x16x32_bf16 v[80:83], a[112:115], a[172:175], v[80:83]
v_mfma_f32_16x16x32_bf16 v[80:83], a[96:99], a[168:171], v[80:83]
s_waitcnt lgkmcnt(8)
v_mfma_f32_16x16x32_bf16 v[96:99], a[96:99], a[176:179], v[96:99]
s_add_u32 m0, s72, 0x8900
ds_read_b64_tr_b16 a[168:169], v11 offset:16384
v_mfma_f32_16x16x32_bf16 v[96:99], a[112:115], a[180:183], v[96:99]
buffer_load_dwordx4 v23, s[16:19], s60 offen offset:768 lds
ds_read_b64_tr_b16 a[170:171], v11 offset:17408
v_mfma_f32_16x16x32_bf16 v[100:103], a[116:119], a[180:183], v[100:103]
ds_read_b64_tr_b16 a[172:173], v11 offset:24576
v_mfma_f32_16x16x32_bf16 v[100:103], a[100:103], a[176:179], v[100:103]
ds_read_b64_tr_b16 a[174:175], v11 offset:25600
v_mfma_f32_16x16x32_bf16 v[104:107], a[104:107], a[176:179], v[104:107]
v_mfma_f32_16x16x32_bf16 v[104:107], a[120:123], a[180:183], v[104:107]
s_add_u32 m0, s72, 0x8d00
v_mfma_f32_16x16x32_bf16 v[108:111], a[124:127], a[180:183], v[108:111]
buffer_load_dwordx4 v22, s[16:19], s61 offen offset:768 lds
v_mfma_f32_16x16x32_bf16 v[108:111], a[108:111], a[176:179], v[108:111]
s_waitcnt lgkmcnt(8)
v_mfma_f32_16x16x32_bf16 v[124:127], a[108:111], a[184:187], v[124:127]
ds_read_b64_tr_b16 a[176:177], v12 offset:16384
v_mfma_f32_16x16x32_bf16 v[124:127], a[124:127], a[188:191], v[124:127]
ds_read_b64_tr_b16 a[178:179], v12 offset:17408
v_mfma_f32_16x16x32_bf16 v[120:123], a[120:123], a[188:191], v[120:123]
ds_read_b64_tr_b16 a[180:181], v12 offset:24576
v_mfma_f32_16x16x32_bf16 v[120:123], a[104:107], a[184:187], v[120:123]
s_add_u32 m0, s72, 0x9100
ds_read_b64_tr_b16 a[182:183], v12 offset:25600
v_mfma_f32_16x16x32_bf16 v[116:119], a[100:103], a[184:187], v[116:119]
buffer_load_dwordx4 v23, s[16:19], s61 offen offset:768 lds
v_mfma_f32_16x16x32_bf16 v[116:119], a[116:119], a[188:191], v[116:119]
v_mfma_f32_16x16x32_bf16 v[112:115], a[112:115], a[188:191], v[112:115]
v_mfma_f32_16x16x32_bf16 v[112:115], a[96:99], a[184:187], v[112:115]
s_waitcnt lgkmcnt(8)
v_mfma_f32_16x16x32_bf16 v[128:131], a[96:99], a[160:163], v[128:131]
s_add_u32 m0, s72, 0x9500
ds_read_b64_tr_b16 a[184:185], v13 offset:16384
v_mfma_f32_16x16x32_bf16 v[128:131], a[112:115], a[164:167], v[128:131]
buffer_load_dwordx4 v22, s[16:19], s62 offen offset:768 lds
ds_read_b64_tr_b16 a[186:187], v13 offset:17408
v_mfma_f32_16x16x32_bf16 v[132:135], a[116:119], a[164:167], v[132:135]
ds_read_b64_tr_b16 a[188:189], v13 offset:24576
v_mfma_f32_16x16x32_bf16 v[132:135], a[100:103], a[160:163], v[132:135]
ds_read_b64_tr_b16 a[190:191], v13 offset:25600
v_mfma_f32_16x16x32_bf16 v[136:139], a[104:107], a[160:163], v[136:139]
v_mfma_f32_16x16x32_bf16 v[136:139], a[120:123], a[164:167], v[136:139]
v_mfma_f32_16x16x32_bf16 v[140:143], a[124:127], a[164:167], v[140:143]
s_add_u32 m0, s72, 0x9900
v_mfma_f32_16x16x32_bf16 v[140:143], a[108:111], a[160:163], v[140:143]
s_waitcnt lgkmcnt(8)
buffer_load_dwordx4 v23, s[16:19], s62 offen offset:768 lds
v_mfma_f32_16x16x32_bf16 v[156:159], a[108:111], a[168:171], v[156:159]
ds_read_b64_tr_b16 a[160:161], v6
v_mfma_f32_16x16x32_bf16 v[156:159], a[124:127], a[172:175], v[156:159]
ds_read_b64_tr_b16 a[162:163], v6 offset:1024
v_mfma_f32_16x16x32_bf16 v[152:155], a[120:123], a[172:175], v[152:155]
s_add_u32 m0, s71, 0
ds_read_b64_tr_b16 a[164:165], v6 offset:8192
v_mfma_f32_16x16x32_bf16 v[152:155], a[104:107], a[168:171], v[152:155]
s_add_u32 s75, s69, 0x1b0000
ds_read_b64_tr_b16 a[166:167], v6 offset:9216
v_mfma_f32_16x16x32_bf16 v[148:151], a[100:103], a[168:171], v[148:151]
buffer_load_dwordx4 v5, s[20:23], s75 offen lds
v_mfma_f32_16x16x32_bf16 v[148:151], a[116:119], a[172:175], v[148:151]
v_mfma_f32_16x16x32_bf16 v[144:147], a[112:115], a[172:175], v[144:147]
v_mfma_f32_16x16x32_bf16 v[144:147], a[96:99], a[168:171], v[144:147]
s_waitcnt lgkmcnt(8)
v_mfma_f32_16x16x32_bf16 v[160:163], a[96:99], a[176:179], v[160:163]
ds_read_b64_tr_b16 a[168:169], v7
v_mfma_f32_16x16x32_bf16 v[160:163], a[112:115], a[180:183], v[160:163]
s_add_u32 m0, s72, 0xfffffc80
ds_read_b64_tr_b16 a[170:171], v7 offset:1024
v_mfma_f32_16x16x32_bf16 v[164:167], a[116:119], a[180:183], v[164:167]
buffer_load_dwordx4 v22, s[16:19], s59 offen offset:896 lds
ds_read_b64_tr_b16 a[172:173], v7 offset:8192
v_mfma_f32_16x16x32_bf16 v[164:167], a[100:103], a[176:179], v[164:167]
ds_read_b64_tr_b16 a[174:175], v7 offset:9216
v_mfma_f32_16x16x32_bf16 v[168:171], a[104:107], a[176:179], v[168:171]
v_mfma_f32_16x16x32_bf16 v[168:171], a[120:123], a[180:183], v[168:171]
s_add_u32 m0, s71, 0x400
v_mfma_f32_16x16x32_bf16 v[172:175], a[124:127], a[180:183], v[172:175]
s_add_u32 s75, s69, 0x1b3600
v_mfma_f32_16x16x32_bf16 v[172:175], a[108:111], a[176:179], v[172:175]
s_waitcnt lgkmcnt(8)
buffer_load_dwordx4 v5, s[20:23], s75 offen lds
v_mfma_f32_16x16x32_bf16 v[188:191], a[108:111], a[184:187], v[188:191]
ds_read_b64_tr_b16 a[176:177], v8
v_mfma_f32_16x16x32_bf16 v[188:191], a[124:127], a[188:191], v[188:191]
ds_read_b64_tr_b16 a[178:179], v8 offset:1024
v_mfma_f32_16x16x32_bf16 v[184:187], a[120:123], a[188:191], v[184:187]
ds_read_b64_tr_b16 a[180:181], v8 offset:8192
v_mfma_f32_16x16x32_bf16 v[184:187], a[104:107], a[184:187], v[184:187]
ds_read_b64_tr_b16 a[182:183], v8 offset:9216
v_mfma_f32_16x16x32_bf16 v[180:183], a[100:103], a[184:187], v[180:183]
s_add_u32 m0, s72, 0x80
v_mfma_f32_16x16x32_bf16 v[180:183], a[116:119], a[188:191], v[180:183]
buffer_load_dwordx4 v23, s[16:19], s59 offen offset:896 lds
v_mfma_f32_16x16x32_bf16 v[176:179], a[112:115], a[188:191], v[176:179]
v_mfma_f32_16x16x32_bf16 v[176:179], a[96:99], a[184:187], v[176:179]
s_waitcnt lgkmcnt(8)
v_mfma_f32_16x16x32_bf16 v[192:195], a[160:163], a[96:99], v[192:195]
ds_read_b64_tr_b16 a[184:185], v9
v_mfma_f32_16x16x32_bf16 v[192:195], a[164:167], a[112:115], v[192:195]
s_add_u32 m0, s72, 0x480
ds_read_b64_tr_b16 a[186:187], v9 offset:1024
v_mfma_f32_16x16x32_bf16 v[196:199], a[164:167], a[116:119], v[196:199]
s_sub_u32 s88, s92, 0xe6
s_cmp_ge_u32 s88, 0x73
s_cbranch_scc1 L_tch18
s_add_u32 s88, s88, 0xe6
s_lshl_b32 s88, s88, 13
buffer_load_dword v29, v26, s[28:31], s88 offen
L_tch18:
v_mfma_f32_16x16x32_bf16 v[196:199], a[160:163], a[100:103], v[196:199]
buffer_load_dwordx4 v22, s[16:19], s60 offen offset:896 lds
ds_read_b64_tr_b16 a[188:189], v9 offset:8192
v_mfma_f32_16x16x32_bf16 v[200:203], a[160:163], a[104:107], v[200:203]
ds_read_b64_tr_b16 a[190:191], v9 offset:9216
v_mfma_f32_16x16x32_bf16 v[200:203], a[164:167], a[120:123], v[200:203]
s_waitcnt lgkmcnt(8)
v_mfma_f32_16x16x32_bf16 v[204:207], a[164:167], a[124:127], v[204:207]
s_add_u32 m0, s71, 0x2000
v_mfma_f32_16x16x32_bf16 v[204:207], a[160:163], a[108:111], v[204:207]
s_add_u32 s75, s69, 0x1cb000
v_mfma_f32_16x16x32_bf16 v[220:223], a[168:171], a[108:111], v[220:223]
buffer_load_dwordx4 v5, s[20:23], s75 offen lds
ds_read_b64_tr_b16 a[160:161], v10
v_mfma_f32_16x16x32_bf16 v[220:223], a[172:175], a[124:127], v[220:223]
ds_read_b64_tr_b16 a[162:163], v10 offset:1024
v_mfma_f32_16x16x32_bf16 v[216:219], a[172:175], a[120:123], v[216:219]
ds_read_b64_tr_b16 a[164:165], v10 offset:8192
v_mfma_f32_16x16x32_bf16 v[216:219], a[168:171], a[104:107], v[216:219]
ds_read_b64_tr_b16 a[166:167], v10 offset:9216
v_mfma_f32_16x16x32_bf16 v[212:215], a[168:171], a[100:103], v[212:215]
s_add_u32 m0, s72, 0x880
s_waitcnt vmcnt(12)
ds_read_b128 a[128:131], v24 offset:32768
v_mfma_f32_16x16x32_bf16 v[212:215], a[172:175], a[116:119], v[212:215]
buffer_load_dwordx4 v23, s[16:19], s60 offen offset:896 lds
ds_read_b128 a[144:147], v25 offset:32768
v_mfma_f32_16x16x32_bf16 v[208:211], a[172:175], a[112:115], v[208:211]
v_mfma_f32_16x16x32_bf16 v[208:211], a[168:171], a[96:99], v[208:211]
s_waitcnt lgkmcnt(10)
v_mfma_f32_16x16x32_bf16 v[224:227], a[176:179], a[96:99], v[224:227]
ds_read_b64_tr_b16 a[168:169], v11
v_mfma_f32_16x16x32_bf16 v[224:227], a[180:183], a[112:115], v[224:227]
ds_read_b64_tr_b16 a[170:171], v11 offset:1024
v_mfma_f32_16x16x32_bf16 v[228:231], a[180:183], a[116:119], v[228:231]
s_add_u32 m0, s72, 0xc80
ds_read_b64_tr_b16 a[172:173], v11 offset:8192
v_mfma_f32_16x16x32_bf16 v[228:231], a[176:179], a[100:103], v[228:231]
buffer_load_dwordx4 v22, s[16:19], s61 offen offset:896 lds
ds_read_b64_tr_b16 a[174:175], v11 offset:9216
v_mfma_f32_16x16x32_bf16 v[232:235], a[176:179], a[104:107], v[232:235]
v_mfma_f32_16x16x32_bf16 v[232:235], a[180:183], a[120:123], v[232:235]
v_mfma_f32_16x16x32_bf16 v[236:239], a[180:183], a[124:127], v[236:239]
s_waitcnt lgkmcnt(10)
v_mfma_f32_16x16x32_bf16 v[236:239], a[176:179], a[108:111], v[236:239]
s_add_u32 m0, s72, 0x1080
s_waitcnt vmcnt(12)
ds_read_b128 a[132:135], v24 offset:34816
v_mfma_f32_16x16x32_bf16 v[252:255], a[184:187], a[108:111], v[252:255]
buffer_load_dwordx4 v23, s[16:19], s61 offen offset:896 lds
ds_read_b128 a[148:151], v25 offset:34816
v_mfma_f32_16x16x32_bf16 v[252:255], a[188:191], a[124:127], v[252:255]
ds_read_b64_tr_b16 a[176:177], v12
v_mfma_f32_16x16x32_bf16 v[248:251], a[188:191], a[120:123], v[248:251]
ds_read_b64_tr_b16 a[178:179], v12 offset:1024
v_mfma_f32_16x16x32_bf16 v[248:251], a[184:187], a[104:107], v[248:251]
ds_read_b64_tr_b16 a[180:181], v12 offset:8192
v_mfma_f32_16x16x32_bf16 v[244:247], a[184:187], a[100:103], v[244:247]
ds_read_b64_tr_b16 a[182:183], v12 offset:9216
v_mfma_f32_16x16x32_bf16 v[244:247], a[188:191], a[116:119], v[244:247]
s_add_u32 m0, s72, 0x1480
v_mfma_f32_16x16x32_bf16 v[240:243], a[188:191], a[112:115], v[240:243]
buffer_load_dwordx4 v22, s[16:19], s62 offen offset:896 lds
v_mfma_f32_16x16x32_bf16 v[240:243], a[184:187], a[96:99], v[240:243]
s_waitcnt lgkmcnt(12)
v_mfma_f32_16x16x32_bf16 a[0:3], a[160:163], a[96:99], a[0:3]
ds_read_b64_tr_b16 a[184:185], v13
v_mfma_f32_16x16x32_bf16 a[0:3], a[164:167], a[112:115], a[0:3]
s_add_u32 m0, s71, 0x2400
ds_read_b64_tr_b16 a[186:187], v13 offset:1024
v_mfma_f32_16x16x32_bf16 a[4:7], a[164:167], a[116:119], a[4:7]
s_add_u32 s75, s69, 0x1ce600
s_waitcnt vmcnt(12)
ds_read_b128 a[136:139], v24 offset:36864
v_mfma_f32_16x16x32_bf16 a[4:7], a[160:163], a[100:103], a[4:7]
buffer_load_dwordx4 v5, s[20:23], s75 offen lds
ds_read_b128 a[152:155], v25 offset:36864
v_mfma_f32_16x16x32_bf16 a[8:11], a[160:163], a[104:107], a[8:11]
ds_read_b64_tr_b16 a[188:189], v13 offset:8192
v_mfma_f32_16x16x32_bf16 a[8:11], a[164:167], a[120:123], a[8:11]
ds_read_b64_tr_b16 a[190:191], v13 offset:9216
v_mfma_f32_16x16x32_bf16 a[12:15], a[164:167], a[124:127], a[12:15]
v_mfma_f32_16x16x32_bf16 a[12:15], a[160:163], a[108:111], a[12:15]
s_waitcnt lgkmcnt(12)
v_mfma_f32_16x16x32_bf16 a[28:31], a[168:171], a[108:111], a[28:31]
s_add_u32 m0, s72, 0x1880
v_mfma_f32_16x16x32_bf16 a[28:31], a[172:175], a[124:127], a[28:31]
buffer_load_dwordx4 v23, s[16:19], s62 offen offset:896 lds
v_mfma_f32_16x16x32_bf16 a[24:27], a[172:175], a[120:123], a[24:27]
v_mfma_f32_16x16x32_bf16 a[24:27], a[168:171], a[104:107], a[24:27]
v_mfma_f32_16x16x32_bf16 a[20:23], a[168:171], a[100:103], a[20:23]
v_mfma_f32_16x16x32_bf16 a[20:23], a[172:175], a[116:119], a[20:23]
s_add_u32 m0, s72, 0x7c00
s_waitcnt vmcnt(12)
ds_read_b128 a[140:143], v24 offset:38912
v_mfma_f32_16x16x32_bf16 a[16:19], a[172:175], a[112:115], a[16:19]
buffer_load_dwordx4 v22, s[16:19], s59 offen offset:1024 lds
ds_read_b128 a[156:159], v25 offset:38912
v_mfma_f32_16x16x32_bf16 a[16:19], a[168:171], a[96:99], a[16:19]
s_waitcnt lgkmcnt(2)
v_mfma_f32_16x16x32_bf16 a[32:35], a[176:179], a[96:99], a[32:35]
s_barrier
v_mfma_f32_16x16x32_bf16 a[32:35], a[180:183], a[112:115], a[32:35]
v_add_u32 v14, 0x8000, v14
ds_read_b64_tr_b16 a[160:161], v14 offset:32768
v_mfma_f32_16x16x32_bf16 a[36:39], a[180:183], a[116:119], a[36:39]
s_add_u32 m0, s68, 0x8000
ds_read_b64_tr_b16 a[162:163], v14 offset:33792
v_mfma_f32_16x16x32_bf16 a[36:39], a[176:179], a[100:103], a[36:39]
s_add_u32 s75, s67, 0x280000
ds_read_b64_tr_b16 a[164:165], v14 offset:40960
v_mfma_f32_16x16x32_bf16 a[40:43], a[176:179], a[104:107], a[40:43]
buffer_load_dwordx4 v4, s[12:15], s75 offen lds
s_add_u32 m0, s68, 0x8400
ds_read_b64_tr_b16 a[166:167], v14 offset:41984
v_mfma_f32_16x16x32_bf16 a[40:43], a[180:183], a[120:123], a[40:43]
s_add_u32 s75, s67, 0x288000
v_add_u32 v15, 0x8000, v15
ds_read_b64_tr_b16 a[168:169], v15 offset:32768
v_mfma_f32_16x16x32_bf16 a[44:47], a[180:183], a[124:127], a[44:47]
buffer_load_dwordx4 v4, s[12:15], s75 offen lds
s_add_u32 m0, s68, 0x9000
ds_read_b64_tr_b16 a[170:171], v15 offset:33792
v_mfma_f32_16x16x32_bf16 a[44:47], a[176:179], a[108:111], a[44:47]
s_add_u32 s75, s67, 0x2a0000
ds_read_b64_tr_b16 a[172:173], v15 offset:40960
v_mfma_f32_16x16x32_bf16 a[60:63], a[184:187], a[108:111], a[60:63]
buffer_load_dwordx4 v4, s[12:15], s75 offen lds
ds_read_b64_tr_b16 a[174:175], v15 offset:41984
v_mfma_f32_16x16x32_bf16 a[60:63], a[188:191], a[124:127], a[60:63]
v_add_u32 v16, 0x8000, v16
ds_read_b64_tr_b16 a[176:177], v16 offset:32768
v_mfma_f32_16x16x32_bf16 a[56:59], a[188:191], a[120:123], a[56:59]
ds_read_b64_tr_b16 a[178:179], v16 offset:33792
v_mfma_f32_16x16x32_bf16 a[56:59], a[184:187], a[104:107], a[56:59]
s_add_u32 m0, s68, 0x9400
ds_read_b64_tr_b16 a[180:181], v16 offset:40960
v_mfma_f32_16x16x32_bf16 a[52:55], a[184:187], a[100:103], a[52:55]
s_add_u32 s75, s67, 0x2a8000
ds_read_b64_tr_b16 a[182:183], v16 offset:41984
v_add_u32 v17, 0x8000, v17
v_mfma_f32_16x16x32_bf16 a[52:55], a[188:191], a[116:119], a[52:55]
buffer_load_dwordx4 v4, s[12:15], s75 offen lds
v_mfma_f32_16x16x32_bf16 a[48:51], a[188:191], a[112:115], a[48:51]
v_mfma_f32_16x16x32_bf16 a[48:51], a[184:187], a[96:99], a[48:51]
s_waitcnt lgkmcnt(8)
v_mfma_f32_16x16x32_bf16 a[192:195], a[128:131], a[160:163], a[192:195]
ds_read_b64_tr_b16 a[184:185], v17 offset:32768
v_mfma_f32_16x16x32_bf16 a[192:195], a[144:147], a[164:167], a[192:195]
s_add_u32 m0, s68, 0xa000
ds_read_b64_tr_b16 a[186:187], v17 offset:33792
v_mfma_f32_16x16x32_bf16 a[196:199], a[148:151], a[164:167], a[196:199]
s_add_u32 s75, s67, 0x2c0000
ds_read_b64_tr_b16 a[188:189], v17 offset:40960
v_mfma_f32_16x16x32_bf16 a[196:199], a[132:135], a[160:163], a[196:199]
buffer_load_dwordx4 v4, s[12:15], s75 offen lds
s_waitcnt vmcnt(14)
ds_read_b128 a[64:67], v24
v_mfma_f32_16x16x32_bf16 a[200:203], a[136:139], a[160:163], a[200:203]
ds_read_b128 a[80:83], v25
v_mfma_f32_16x16x32_bf16 a[200:203], a[152:155], a[164:167], a[200:203]
ds_read_b64_tr_b16 a[190:191], v17 offset:41984
v_mfma_f32_16x16x32_bf16 a[204:207], a[156:159], a[164:167], a[204:207]
s_waitcnt lgkmcnt(10)
v_mfma_f32_16x16x32_bf16 a[204:207], a[140:143], a[160:163], a[204:207]
s_add_u32 m0, s72, 0x8000
v_mfma_f32_16x16x32_bf16 a[220:223], a[140:143], a[168:171], a[220:223]
buffer_load_dwordx4 v23, s[16:19], s59 offen offset:1024 lds
ds_read_b64_tr_b16 a[160:161], v14 offset:49152
v_mfma_f32_16x16x32_bf16 a[220:223], a[156:159], a[172:175], a[220:223]
s_add_u32 m0, s72, 0x8400
ds_read_b64_tr_b16 a[162:163], v14 offset:50176
v_mfma_f32_16x16x32_bf16 a[216:219], a[152:155], a[172:175], a[216:219]
buffer_load_dwordx4 v22, s[16:19], s60 offen offset:1024 lds
ds_read_b64_tr_b16 a[164:165], v14 offset:57344
v_mfma_f32_16x16x32_bf16 a[216:219], a[136:139], a[168:171], a[216:219]
s_add_u32 m0, s72, 0x8800
ds_read_b64_tr_b16 a[166:167], v14 offset:58368
v_mfma_f32_16x16x32_bf16 a[212:215], a[132:135], a[168:171], a[212:215]
buffer_load_dwordx4 v23, s[16:19], s60 offen offset:1024 lds
v_mfma_f32_16x16x32_bf16 a[212:215], a[148:151], a[172:175], a[212:215]
s_add_u32 m0, s72, 0x8c00
v_mfma_f32_16x16x32_bf16 a[208:211], a[144:147], a[172:175], a[208:211]
s_waitcnt lgkmcnt(10)
buffer_load_dwordx4 v22, s[16:19], s61 offen offset:1024 lds
s_add_u32 m0, s68, 0xa400
v_mfma_f32_16x16x32_bf16 a[208:211], a[128:131], a[168:171], a[208:211]
s_add_u32 s75, s67, 0x2c8000
v_mfma_f32_16x16x32_bf16 a[224:227], a[128:131], a[176:179], a[224:227]
s_sub_u32 s88, s92, 0x159
s_cmp_ge_u32 s88, 0x73
s_cbranch_scc1 L_tch19
s_add_u32 s88, s88, 0x159
s_lshl_b32 s88, s88, 13
buffer_load_dword v29, v26, s[28:31], s88 offen
L_tch19:
v_mfma_f32_16x16x32_bf16 a[224:227], a[144:147], a[180:183], a[224:227]
buffer_load_dwordx4 v4, s[12:15], s75 offen lds
s_add_u32 m0, s72, 0x9000
s_waitcnt vmcnt(13)
ds_read_b128 a[68:71], v24 offset:2048
v_mfma_f32_16x16x32_bf16 a[228:231], a[148:151], a[180:183], a[228:231]
ds_read_b128 a[84:87], v25 offset:2048
buffer_load_dwordx4 v23, s[16:19], s61 offen offset:1024 lds
L_cp600:
v_mfma_f32_16x16x32_bf16 a[228:231], a[132:135], a[176:179], a[228:231]
s_add_u32 m0, s72, 0x9400
ds_read_b128 a[72:75], v24 offset:4096
v_mfma_f32_16x16x32_bf16 a[232:235], a[136:139], a[176:179], a[232:235]
ds_read_b128 a[88:91], v25 offset:4096
buffer_load_dwordx4 v22, s[16:19], s62 offen offset:1024 lds
v_mfma_f32_16x16x32_bf16 a[232:235], a[152:155], a[180:183], a[232:235]
s_add_u32 m0, s72, 0x9800
s_waitcnt vmcnt(13)
ds_read_b128 a[76:79], v24 offset:6144
v_mfma_f32_16x16x32_bf16 a[236:239], a[156:159], a[180:183], a[236:239]
s_waitcnt lgkmcnt(9)
ds_read_b128 a[92:95], v25 offset:6144
buffer_load_dwordx4 v23, s[16:19], s62 offen offset:1024 lds
s_add_u32 m0, s68, 0xb000
v_mfma_f32_16x16x32_bf16 a[236:239], a[140:143], a[176:179], a[236:239]
s_add_u32 s75, s67, 0x2e0000
ds_read_b64_tr_b16 a[168:169], v15 offset:49152
v_mfma_f32_16x16x32_bf16 a[252:255], a[140:143], a[184:187], a[252:255]
buffer_load_dwordx4 v4, s[12:15], s75 offen lds
s_add_u32 m0, s68, 0xb400
ds_read_b64_tr_b16 a[170:171], v15 offset:50176
v_mfma_f32_16x16x32_bf16 a[252:255], a[156:159], a[188:191], a[252:255]
s_add_u32 s75, s67, 0x2e8000
ds_read_b64_tr_b16 a[172:173], v15 offset:57344
v_mfma_f32_16x16x32_bf16 a[248:251], a[152:155], a[188:191], a[248:251]
buffer_load_dwordx4 v4, s[12:15], s75 offen lds
ds_read_b64_tr_b16 a[174:175], v15 offset:58368
v_mfma_f32_16x16x32_bf16 a[248:251], a[136:139], a[184:187], a[248:251]
s_add_u32 m0, s72, 0xfffffd80
ds_read_b64_tr_b16 a[176:177], v16 offset:49152
v_mfma_f32_16x16x32_bf16 a[244:247], a[132:135], a[184:187], a[244:247]
buffer_load_dwordx4 v2, s[8:11], s55 offen offset:640 lds
ds_read_b64_tr_b16 a[178:179], v16 offset:50176
v_mfma_f32_16x16x32_bf16 a[244:247], a[148:151], a[188:191], a[244:247]
ds_read_b64_tr_b16 a[180:181], v16 offset:57344
v_mfma_f32_16x16x32_bf16 a[240:243], a[144:147], a[188:191], a[240:243]
ds_read_b64_tr_b16 a[182:183], v16 offset:58368
v_mfma_f32_16x16x32_bf16 a[240:243], a[128:131], a[184:187], a[240:243]
s_waitcnt lgkmcnt(8)
v_mfma_f32_16x16x32_bf16 a[192:195], a[64:67], a[160:163], a[192:195]
ds_read_b64_tr_b16 a[184:185], v17 offset:49152
v_mfma_f32_16x16x32_bf16 a[192:195], a[80:83], a[164:167], a[192:195]
s_add_u32 m0, s72, 0x180
ds_read_b64_tr_b16 a[186:187], v17 offset:50176
v_mfma_f32_16x16x32_bf16 a[196:199], a[84:87], a[164:167], a[196:199]
buffer_load_dwordx4 v3, s[8:11], s55 offen offset:640 lds
ds_read_b64_tr_b16 a[188:189], v17 offset:57344
v_mfma_f32_16x16x32_bf16 a[196:199], a[68:71], a[160:163], a[196:199]
ds_read_b64_tr_b16 a[190:191], v17 offset:58368
v_mfma_f32_16x16x32_bf16 a[200:203], a[72:75], a[160:163], a[200:203]
v_mfma_f32_16x16x32_bf16 a[200:203], a[88:91], a[164:167], a[200:203]
v_mfma_f32_16x16x32_bf16 a[204:207], a[92:95], a[164:167], a[204:207]
s_add_u32 m0, s72, 0x580
v_mfma_f32_16x16x32_bf16 a[204:207], a[76:79], a[160:163], a[204:207]
s_waitcnt lgkmcnt(8)
buffer_load_dwordx4 v2, s[8:11], s56 offen offset:640 lds
v_mfma_f32_16x16x32_bf16 a[220:223], a[76:79], a[168:171], a[220:223]
s_add_u32 m0, s72, 0x980
v_mfma_f32_16x16x32_bf16 a[220:223], a[92:95], a[172:175], a[220:223]
buffer_load_dwordx4 v3, s[8:11], s56 offen offset:640 lds
v_mfma_f32_16x16x32_bf16 a[216:219], a[88:91], a[172:175], a[216:219]
s_add_u32 m0, s72, 0xd80
v_mfma_f32_16x16x32_bf16 a[216:219], a[72:75], a[168:171], a[216:219]
buffer_load_dwordx4 v2, s[8:11], s57 offen offset:640 lds
v_mfma_f32_16x16x32_bf16 a[212:215], a[68:71], a[168:171], a[212:215]
s_add_u32 m0, s72, 0x1180
v_mfma_f32_16x16x32_bf16 a[212:215], a[84:87], a[172:175], a[212:215]
buffer_load_dwordx4 v3, s[8:11], s57 offen offset:640 lds
v_mfma_f32_16x16x32_bf16 a[208:211], a[80:83], a[172:175], a[208:211]
s_add_u32 m0, s72, 0x1580
s_waitcnt vmcnt(15)
ds_read_b128 a[96:99], v24 offset:32768
v_mfma_f32_16x16x32_bf16 a[208:211], a[64:67], a[168:171], a[208:211]
s_waitcnt lgkmcnt(1)
buffer_load_dwordx4 v2, s[8:11], s58 offen offset:640 lds
ds_read_b128 a[112:115], v25 offset:32768
v_mfma_f32_16x16x32_bf16 a[224:227], a[64:67], a[176:179], a[224:227]
s_barrier
v_mfma_f32_16x16x32_bf16 a[224:227], a[80:83], a[180:183], a[224:227]
s_add_u32 m0, s72, 0x1980
s_waitcnt vmcnt(14)
ds_read_b128 a[100:103], v24 offset:34816
v_add_u32 v14, 0xffff8000, v14
v_mfma_f32_16x16x32_bf16 a[228:231], a[84:87], a[180:183], a[228:231]
buffer_load_dwordx4 v3, s[8:11], s58 offen offset:640 lds
s_add_u32 m0, s68, 0x10000
ds_read_b128 a[116:119], v25 offset:34816
v_mfma_f32_16x16x32_bf16 a[228:231], a[68:71], a[176:179], a[228:231]
s_add_u32 s75, s67, 0x300000
s_waitcnt vmcnt(12)
ds_read_b128 a[104:107], v24 offset:36864
v_mfma_f32_16x16x32_bf16 a[232:235], a[72:75], a[176:179], a[232:235]
buffer_load_dwordx4 v4, s[12:15], s75 offen lds
ds_read_b128 a[120:123], v25 offset:36864
v_mfma_f32_16x16x32_bf16 a[232:235], a[88:91], a[180:183], a[232:235]
s_waitcnt vmcnt(11)
ds_read_b128 a[108:111], v24 offset:38912
v_mfma_f32_16x16x32_bf16 a[236:239], a[92:95], a[180:183], a[236:239]
ds_read_b128 a[124:127], v25 offset:38912
v_mfma_f32_16x16x32_bf16 a[236:239], a[76:79], a[176:179], a[236:239]
s_add_u32 m0, s68, 0x10400
ds_read_b64_tr_b16 a[160:161], v14
v_mfma_f32_16x16x32_bf16 a[252:255], a[76:79], a[184:187], a[252:255]
s_add_u32 s75, s67, 0x308000
ds_read_b64_tr_b16 a[162:163], v14 offset:1024
v_mfma_f32_16x16x32_bf16 a[252:255], a[92:95], a[188:191], a[252:255]
ds_read_b64_tr_b16 a[164:165], v14 offset:8192
buffer_load_dwordx4 v4, s[12:15], s75 offen lds
v_mfma_f32_16x16x32_bf16 a[248:251], a[88:91], a[188:191], a[248:251]
ds_read_b64_tr_b16 a[166:167], v14 offset:9216
v_add_u32 v15, 0xffff8000, v15
v_mfma_f32_16x16x32_bf16 a[248:251], a[72:75], a[184:187], a[248:251]
ds_read_b64_tr_b16 a[168:169], v15
v_mfma_f32_16x16x32_bf16 a[244:247], a[68:71], a[184:187], a[244:247]
s_add_u32 m0, s68, 0x11000
ds_read_b64_tr_b16 a[170:171], v15 offset:1024
v_mfma_f32_16x16x32_bf16 a[244:247], a[84:87], a[188:191], a[244:247]
s_add_u32 s75, s67, 0x320000
ds_read_b64_tr_b16 a[172:173], v15 offset:8192
v_mfma_f32_16x16x32_bf16 a[240:243], a[80:83], a[188:191], a[240:243]
buffer_load_dwordx4 v4, s[12:15], s75 offen lds
ds_read_b64_tr_b16 a[174:175], v15 offset:9216
v_mfma_f32_16x16x32_bf16 a[240:243], a[64:67], a[184:187], a[240:243]
s_waitcnt lgkmcnt(6)
v_add_u32 v16, 0xffff8000, v16
ds_read_b64_tr_b16 a[176:177], v16
v_mfma_f32_16x16x32_bf16 a[192:195], a[96:99], a[160:163], a[192:195]
s_waitcnt lgkmcnt(5)
ds_read_b64_tr_b16 a[178:179], v16 offset:1024
v_mfma_f32_16x16x32_bf16 a[192:195], a[112:115], a[164:167], a[192:195]
ds_read_b64_tr_b16 a[180:181], v16 offset:8192
v_mfma_f32_16x16x32_bf16 a[196:199], a[116:119], a[164:167], a[196:199]
s_add_u32 m0, s68, 0x11400
ds_read_b64_tr_b16 a[182:183], v16 offset:9216
v_add_u32 v17, 0xffff8000, v17
v_mfma_f32_16x16x32_bf16 a[196:199], a[100:103], a[160:163], a[196:199]
s_add_u32 s75, s67, 0x328000
ds_read_b64_tr_b16 a[184:185], v17
v_mfma_f32_16x16x32_bf16 a[200:203], a[104:107], a[160:163], a[200:203]
buffer_load_dwordx4 v4, s[12:15], s75 offen lds
ds_read_b64_tr_b16 a[186:187], v17 offset:1024
v_mfma_f32_16x16x32_bf16 a[200:203], a[120:123], a[164:167], a[200:203]
ds_read_b64_tr_b16 a[188:189], v17 offset:8192
v_mfma_f32_16x16x32_bf16 a[204:207], a[124:127], a[164:167], a[204:207]
s_waitcnt lgkmcnt(7)
ds_read_b64_tr_b16 a[190:191], v17 offset:9216
v_mfma_f32_16x16x32_bf16 a[204:207], a[108:111], a[160:163], a[204:207]
s_add_u32 m0, s68, 0x12000
v_mfma_f32_16x16x32_bf16 a[220:223], a[108:111], a[168:171], a[220:223]
s_add_u32 s75, s67, 0x340000
v_mfma_f32_16x16x32_bf16 a[220:223], a[124:127], a[172:175], a[220:223]
buffer_load_dwordx4 v4, s[12:15], s75 offen lds
v_mfma_f32_16x16x32_bf16 a[216:219], a[120:123], a[172:175], a[216:219]
v_mfma_f32_16x16x32_bf16 a[216:219], a[104:107], a[168:171], a[216:219]
v_mfma_f32_16x16x32_bf16 a[212:215], a[100:103], a[168:171], a[212:215]
v_mfma_f32_16x16x32_bf16 a[212:215], a[116:119], a[172:175], a[212:215]
s_add_u32 m0, s68, 0x12400
v_mfma_f32_16x16x32_bf16 a[208:211], a[112:115], a[172:175], a[208:211]
s_waitcnt lgkmcnt(0)
v_cmp_eq_u32 vcc, 0, v18
s_nop 1
s_cbranch_vccnz L_spin_nonce
L_back_nonce:
v_mfma_f32_16x16x32_bf16 a[208:211], a[96:99], a[168:171], a[208:211]
s_add_u32 s75, s67, 0x348000
s_waitcnt vmcnt(11)
ds_read_b128 a[128:131], v24
v_mfma_f32_16x16x32_bf16 a[224:227], a[96:99], a[176:179], a[224:227]
buffer_load_dwordx4 v4, s[12:15], s75 offen lds
s_barrier
v_mfma_f32_16x16x32_bf16 a[224:227], a[112:115], a[180:183], a[224:227]
ds_read_b128 a[144:147], v25
v_mfma_f32_16x16x32_bf16 a[228:231], a[116:119], a[180:183], a[228:231]
s_add_u32 m0, s68, 0x13000
s_waitcnt vmcnt(10)
ds_read_b128 a[132:135], v24 offset:2048
v_mfma_f32_16x16x32_bf16 a[228:231], a[100:103], a[176:179], a[228:231]
s_add_u32 s75, s67, 0x360000
ds_read_b128 a[148:151], v25 offset:2048
v_mfma_f32_16x16x32_bf16 a[232:235], a[104:107], a[176:179], a[232:235]
s_waitcnt vmcnt(8)
ds_read_b128 a[136:139], v24 offset:4096
buffer_load_dwordx4 v4, s[12:15], s75 offen lds
v_mfma_f32_16x16x32_bf16 a[232:235], a[120:123], a[180:183], a[232:235]
ds_read_b128 a[152:155], v25 offset:4096
v_mfma_f32_16x16x32_bf16 a[236:239], a[124:127], a[180:183], a[236:239]
s_waitcnt vmcnt(7)
ds_read_b128 a[140:143], v24 offset:6144
v_mfma_f32_16x16x32_bf16 a[236:239], a[108:111], a[176:179], a[236:239]
ds_read_b128 a[156:159], v25 offset:6144
v_mfma_f32_16x16x32_bf16 a[252:255], a[108:111], a[184:187], a[252:255]
s_add_u32 m0, s68, 0x13400
ds_read_b64_tr_b16 a[160:161], v6 offset:16384
v_mfma_f32_16x16x32_bf16 a[252:255], a[124:127], a[188:191], a[252:255]
s_add_u32 s75, s67, 0x368000
ds_read_b64_tr_b16 a[162:163], v6 offset:17408
v_mfma_f32_16x16x32_bf16 a[248:251], a[120:123], a[188:191], a[248:251]
ds_read_b64_tr_b16 a[164:165], v6 offset:24576
ds_read_b64_tr_b16 a[166:167], v6 offset:25600
v_mfma_f32_16x16x32_bf16 a[248:251], a[104:107], a[184:187], a[248:251]
buffer_load_dwordx4 v4, s[12:15], s75 offen lds
ds_read_b64_tr_b16 a[168:169], v7 offset:16384
v_mfma_f32_16x16x32_bf16 a[244:247], a[100:103], a[184:187], a[244:247]
ds_read_b64_tr_b16 a[170:171], v7 offset:17408
v_mfma_f32_16x16x32_bf16 a[244:247], a[116:119], a[188:191], a[244:247]
s_sub_u32 s88, s92, 0x1cc
s_cmp_ge_u32 s88, 0x74
s_cbranch_scc1 L_tch20
s_add_u32 s88, s88, 0x1cc
s_lshl_b32 s88, s88, 13
buffer_load_dword v29, v26, s[28:31], s88 offen
L_tch20:
v_mfma_f32_16x16x32_bf16 a[240:243], a[112:115], a[188:191], a[240:243]
s_add_u32 m0, s72, 0x7d00
ds_read_b64_tr_b16 a[172:173], v7 offset:24576
v_mfma_f32_16x16x32_bf16 a[240:243], a[96:99], a[184:187], a[240:243]
s_waitcnt lgkmcnt(5)
buffer_load_dwordx4 v2, s[8:11], s55 offen offset:768 lds
ds_read_b64_tr_b16 a[174:175], v7 offset:25600
v_mfma_f32_16x16x32_bf16 v[64:67], a[128:131], a[160:163], v[64:67]
s_waitcnt lgkmcnt(4)
ds_read_b64_tr_b16 a[176:177], v8 offset:16384
v_mfma_f32_16x16x32_bf16 v[64:67], a[144:147], a[164:167], v[64:67]
ds_read_b64_tr_b16 a[178:179], v8 offset:17408
v_mfma_f32_16x16x32_bf16 v[68:71], a[148:151], a[164:167], v[68:71]
ds_read_b64_tr_b16 a[180:181], v8 offset:24576
v_mfma_f32_16x16x32_bf16 v[68:71], a[132:135], a[160:163], v[68:71]
ds_read_b64_tr_b16 a[182:183], v8 offset:25600
v_mfma_f32_16x16x32_bf16 v[72:75], a[136:139], a[160:163], v[72:75]
s_add_u32 m0, s72, 0x8100
ds_read_b64_tr_b16 a[184:185], v9 offset:16384
v_and_b32 v62, 12, v0
v_mfma_f32_16x16x32_bf16 v[72:75], a[152:155], a[164:167], v[72:75]
s_mul_i32 s87, s48, 0x5a0
buffer_load_dwordx4 v3, s[8:11], s55 offen offset:768 lds
ds_read_b64_tr_b16 a[186:187], v9 offset:17408
v_mfma_f32_16x16x32_bf16 v[76:79], a[156:159], a[164:167], v[76:79]
ds_read_b64_tr_b16 a[188:189], v9 offset:24576
v_cmp_le_u32_e64 s[80:81], 8, v62
s_add_u32 s87, s87, 0x6000
v_mfma_f32_16x16x32_bf16 v[76:79], a[140:143], a[160:163], v[76:79]
s_waitcnt lgkmcnt(7)
ds_read_b64_tr_b16 a[190:191], v9 offset:25600
v_mov_b32 v28, 0xb5c1a2a0
v_mfma_f32_16x16x32_bf16 v[92:95], a[140:143], a[168:171], v[92:95]
ds_read_b64_tr_b16 a[160:161], v10 offset:16384
v_and_b32 v62, 15, v0
v_mfma_f32_16x16x32_bf16 v[92:95], a[156:159], a[172:175], v[92:95]
s_add_u32 m0, s72, 0x8500
ds_read_b64_tr_b16 a[162:163], v10 offset:17408
v_lshrrev_b32 v63, 4, v0
v_mfma_f32_16x16x32_bf16 v[88:91], a[152:155], a[172:175], v[88:91]
buffer_load_dwordx4 v2, s[8:11], s56 offen offset:768 lds
ds_read_b64_tr_b16 a[164:165], v10 offset:24576
v_mfma_f32_16x16x32_bf16 v[88:91], a[136:139], a[168:171], v[88:91]
ds_read_b64_tr_b16 a[166:167], v10 offset:25600
v_subrev_u32 v58, 4, v62
v_mfma_f32_16x16x32_bf16 v[84:87], a[132:135], a[168:171], v[84:87]
v_min_u32 v58, 19, v58
v_add_u32 v59, 4, v62
v_mfma_f32_16x16x32_bf16 v[84:87], a[148:151], a[172:175], v[84:87]
v_mov_b32 v60, 19
v_cndmask_b32_e64 v59, v60, v59, s[80:81]
v_mfma_f32_16x16x32_bf16 v[80:83], a[144:147], a[172:175], v[80:83]
s_waitcnt lgkmcnt(8)
v_lshlrev_b32 v60, 3, v63
v_add_u32 v60, s87, v60
v_mfma_f32_16x16x32_bf16 v[80:83], a[128:131], a[168:171], v[80:83]
s_add_u32 m0, s72, 0x8900
v_mul_u32_u24 v58, 0x48, v58
v_mul_u32_u24 v59, 0x48, v59
v_mfma_f32_16x16x32_bf16 v[96:99], a[128:131], a[176:179], v[96:99]
buffer_load_dwordx4 v3, s[8:11], s56 offen offset:768 lds
ds_read_b64_tr_b16 a[168:169], v11 offset:16384
v_mfma_f32_16x16x32_bf16 v[96:99], a[144:147], a[180:183], v[96:99]
ds_read_b64_tr_b16 a[170:171], v11 offset:17408
v_add_u32 v58, v58, v60
v_mfma_f32_16x16x32_bf16 v[100:103], a[148:151], a[180:183], v[100:103]
ds_read_b64_tr_b16 a[172:173], v11 offset:24576
v_add_u32 v59, v59, v60
v_mfma_f32_16x16x32_bf16 v[100:103], a[132:135], a[176:179], v[100:103]
ds_read_b64_tr_b16 a[174:175], v11 offset:25600
v_lshrrev_b32 v61, 2, v62
v_mfma_f32_16x16x32_bf16 v[104:107], a[136:139], a[176:179], v[104:107]
s_add_u32 m0, s72, 0x8d00
v_lshl_add_u32 v60, v63, 2, v61
v_add_u32 v61, 16, v61
v_mfma_f32_16x16x32_bf16 v[104:107], a[152:155], a[180:183], v[104:107]
buffer_load_dwordx4 v2, s[8:11], s57 offen offset:768 lds
v_and_b32 v62, 3, v0
v_mfma_f32_16x16x32_bf16 v[108:111], a[156:159], a[180:183], v[108:111]
v_lshlrev_b32 v62, 3, v62
v_add_u32 v62, s87, v62
v_mfma_f32_16x16x32_bf16 v[108:111], a[140:143], a[176:179], v[108:111]
s_waitcnt lgkmcnt(8)
v_mul_u32_u24 v60, 0x48, v60
v_mul_u32_u24 v61, 0x48, v61
v_mfma_f32_16x16x32_bf16 v[124:127], a[140:143], a[184:187], v[124:127]
ds_read_b64_tr_b16 a[176:177], v12 offset:16384
v_add_u32 v60, v60, v62
v_mfma_f32_16x16x32_bf16 v[124:127], a[156:159], a[188:191], v[124:127]
ds_read_b64_tr_b16 a[178:179], v12 offset:17408
v_add_u32 v61, v61, v62
v_mfma_f32_16x16x32_bf16 v[120:123], a[152:155], a[188:191], v[120:123]
s_add_u32 m0, s72, 0x9100
ds_read_b64_tr_b16 a[180:181], v12 offset:24576
v_accvgpr_read_b32 v32, a208
v_mfma_f32_16x16x32_bf16 v[120:123], a[136:139], a[184:187], v[120:123]
buffer_load_dwordx4 v3, s[8:11], s57 offen offset:768 lds
ds_read_b64_tr_b16 a[182:183], v12 offset:25600
v_mfma_f32_16x16x32_bf16 v[116:119], a[132:135], a[184:187], v[116:119]
v_accvgpr_read_b32 v33, a209
v_accvgpr_read_b32 v34, a210
v_mfma_f32_16x16x32_bf16 v[116:119], a[148:151], a[188:191], v[116:119]
v_accvgpr_read_b32 v35, a211
v_fma_f32 v36, v32, s85, v28
v_mfma_f32_16x16x32_bf16 v[112:115], a[144:147], a[188:191], v[112:115]
s_waitcnt lgkmcnt(8)
v_fma_f32 v37, v33, s85, v28
v_fma_f32 v38, v34, s85, v28
v_mfma_f32_16x16x32_bf16 v[112:115], a[128:131], a[184:187], v[112:115]
s_add_u32 m0, s72, 0x9500
v_fma_f32 v39, v35, s85, v28
v_max_f32 v40, s86, v32
v_mfma_f32_16x16x32_bf16 v[128:131], a[128:131], a[160:163], v[128:131]
buffer_load_dwordx4 v2, s[8:11], s58 offen offset:768 lds
ds_read_b64_tr_b16 a[184:185], v13 offset:16384
v_mfma_f32_16x16x32_bf16 v[128:131], a[144:147], a[164:167], v[128:131]
ds_read_b64_tr_b16 a[186:187], v13 offset:17408
v_max_f32 v41, s86, v33
v_mfma_f32_16x16x32_bf16 v[132:135], a[148:151], a[164:167], v[132:135]
ds_read_b64_tr_b16 a[188:189], v13 offset:24576
v_max_f32 v42, s86, v34
v_mfma_f32_16x16x32_bf16 v[132:135], a[132:135], a[160:163], v[132:135]
ds_read_b64_tr_b16 a[190:191], v13 offset:25600
v_max_f32 v43, s86, v35
v_mfma_f32_16x16x32_bf16 v[136:139], a[136:139], a[160:163], v[136:139]
v_exp_f32_e64 v36, v36 clamp
v_mfma_f32_16x16x32_bf16 v[136:139], a[152:155], a[164:167], v[136:139]
s_add_u32 m0, s72, 0x9900
v_exp_f32_e64 v37, v37 clamp
v_mfma_f32_16x16x32_bf16 v[140:143], a[156:159], a[164:167], v[140:143]
buffer_load_dwordx4 v3, s[8:11], s58 offen offset:768 lds
v_add_f32 v32, v40, v36
v_mfma_f32_16x16x32_bf16 v[140:143], a[140:143], a[160:163], v[140:143]
s_waitcnt lgkmcnt(8)
v_exp_f32_e64 v38, v38 clamp
v_mfma_f32_16x16x32_bf16 v[156:159], a[140:143], a[168:171], v[156:159]
ds_read_b64_tr_b16 a[160:161], v6
v_add_f32 v33, v41, v37
v_mfma_f32_16x16x32_bf16 v[156:159], a[156:159], a[172:175], v[156:159]
ds_read_b64_tr_b16 a[162:163], v6 offset:1024
v_add_f32 v34, v42, v38
v_mfma_f32_16x16x32_bf16 v[152:155], a[152:155], a[172:175], v[152:155]
s_add_u32 m0, s72, 0xfffffc80
ds_read_b64_tr_b16 a[164:165], v6 offset:8192
v_cvt_pk_bf16_f32 v40, v32, v33
v_mfma_f32_16x16x32_bf16 v[152:155], a[136:139], a[168:171], v[152:155]
buffer_load_dwordx4 v2, s[8:11], s55 offen offset:896 lds
ds_read_b64_tr_b16 a[166:167], v6 offset:9216
v_mfma_f32_16x16x32_bf16 v[148:151], a[132:135], a[168:171], v[148:151]
v_exp_f32_e64 v39, v39 clamp
v_mfma_f32_16x16x32_bf16 v[148:151], a[148:151], a[172:175], v[148:151]
v_add_f32 v35, v43, v39
v_cvt_pk_bf16_f32 v41, v34, v35
v_mfma_f32_16x16x32_bf16 v[144:147], a[144:147], a[172:175], v[144:147]
ds_write_b64 v58, v[40:41]
v_accvgpr_write_b32 a208, v40
v_mfma_f32_16x16x32_bf16 v[144:147], a[128:131], a[168:171], v[144:147]
s_waitcnt lgkmcnt(9)
v_accvgpr_write_b32 a209, v41
v_accvgpr_read_b32 v44, a212
v_mfma_f32_16x16x32_bf16 v[160:163], a[128:131], a[176:179], v[160:163]
s_add_u32 m0, s72, 0x80
ds_read_b64_tr_b16 a[168:169], v7
v_accvgpr_read_b32 v45, a213
v_mfma_f32_16x16x32_bf16 v[160:163], a[144:147], a[180:183], v[160:163]
buffer_load_dwordx4 v3, s[8:11], s55 offen offset:896 lds
ds_read_b64_tr_b16 a[170:171], v7 offset:1024
v_mfma_f32_16x16x32_bf16 v[164:167], a[148:151], a[180:183], v[164:167]
ds_read_b64_tr_b16 a[172:173], v7 offset:8192
v_accvgpr_read_b32 v46, a214
v_mfma_f32_16x16x32_bf16 v[164:167], a[132:135], a[176:179], v[164:167]
ds_read_b64_tr_b16 a[174:175], v7 offset:9216
v_accvgpr_read_b32 v47, a215
v_mfma_f32_16x16x32_bf16 v[168:171], a[136:139], a[176:179], v[168:171]
v_fma_f32 v48, v44, s85, v28
v_fma_f32 v49, v45, s85, v28
v_mfma_f32_16x16x32_bf16 v[168:171], a[152:155], a[180:183], v[168:171]
s_add_u32 m0, s72, 0x480
v_fma_f32 v50, v46, s85, v28
v_fma_f32 v51, v47, s85, v28
v_mfma_f32_16x16x32_bf16 v[172:175], a[156:159], a[180:183], v[172:175]
buffer_load_dwordx4 v2, s[8:11], s56 offen offset:896 lds
v_max_f32 v52, s86, v44
v_mfma_f32_16x16x32_bf16 v[172:175], a[140:143], a[176:179], v[172:175]
s_waitcnt lgkmcnt(9)
v_exp_f32_e64 v48, v48 clamp
v_mfma_f32_16x16x32_bf16 v[188:191], a[140:143], a[184:187], v[188:191]
ds_read_b64_tr_b16 a[176:177], v8
v_max_f32 v53, s86, v45
v_mfma_f32_16x16x32_bf16 v[188:191], a[156:159], a[188:191], v[188:191]
ds_read_b64_tr_b16 a[178:179], v8 offset:1024
v_max_f32 v54, s86, v46
v_mfma_f32_16x16x32_bf16 v[184:187], a[152:155], a[188:191], v[184:187]
ds_read_b64_tr_b16 a[180:181], v8 offset:8192
v_max_f32 v55, s86, v47
v_mfma_f32_16x16x32_bf16 v[184:187], a[136:139], a[184:187], v[184:187]
s_add_u32 m0, s72, 0x880
ds_read_b64_tr_b16 a[182:183], v8 offset:9216
v_add_f32 v44, v52, v48
v_mfma_f32_16x16x32_bf16 v[180:183], a[132:135], a[184:187], v[180:183]
buffer_load_dwordx4 v3, s[8:11], s56 offen offset:896 lds
v_accvgpr_read_b32 v32, a240
v_mfma_f32_16x16x32_bf16 v[180:183], a[148:151], a[188:191], v[180:183]
v_exp_f32_e64 v49, v49 clamp
v_mfma_f32_16x16x32_bf16 v[176:179], a[144:147], a[188:191], v[176:179]
v_exp_f32_e64 v50, v50 clamp
v_mfma_f32_16x16x32_bf16 v[176:179], a[128:131], a[184:187], v[176:179]
s_waitcnt lgkmcnt(9)
v_exp_f32_e64 v51, v51 clamp
v_mfma_f32_16x16x32_bf16 v[192:195], a[160:163], a[128:131], v[192:195]
s_add_u32 m0, s72, 0xc80
ds_read_b64_tr_b16 a[184:185], v9
v_add_f32 v45, v53, v49
v_mfma_f32_16x16x32_bf16 v[192:195], a[164:167], a[144:147], v[192:195]
buffer_load_dwordx4 v2, s[8:11], s57 offen offset:896 lds
ds_read_b64_tr_b16 a[186:187], v9 offset:1024
v_mfma_f32_16x16x32_bf16 v[196:199], a[164:167], a[148:151], v[196:199]
ds_read_b64_tr_b16 a[188:189], v9 offset:8192
v_add_f32 v46, v54, v50
v_mfma_f32_16x16x32_bf16 v[196:199], a[160:163], a[132:135], v[196:199]
ds_read_b64_tr_b16 a[190:191], v9 offset:9216
v_add_f32 v47, v55, v51
v_mfma_f32_16x16x32_bf16 v[200:203], a[160:163], a[136:139], v[200:203]
v_cvt_pk_bf16_f32 v52, v44, v45
v_cvt_pk_bf16_f32 v53, v46, v47
v_mfma_f32_16x16x32_bf16 v[200:203], a[164:167], a[152:155], v[200:203]
ds_write_b64 v58, v[52:53] offset:32
v_accvgpr_write_b32 a210, v52
v_mfma_f32_16x16x32_bf16 v[204:207], a[164:167], a[156:159], v[204:207]
s_add_u32 m0, s72, 0x1080
v_accvgpr_write_b32 a211, v53
v_accvgpr_read_b32 v33, a241
v_mfma_f32_16x16x32_bf16 v[204:207], a[160:163], a[140:143], v[204:207]
s_waitcnt lgkmcnt(9)
buffer_load_dwordx4 v3, s[8:11], s57 offen offset:896 lds
v_accvgpr_read_b32 v34, a242
v_mfma_f32_16x16x32_bf16 v[220:223], a[168:171], a[140:143], v[220:223]
ds_read_b64_tr_b16 a[160:161], v10
v_accvgpr_read_b32 v35, a243
v_mfma_f32_16x16x32_bf16 v[220:223], a[172:175], a[156:159], v[220:223]
ds_read_b64_tr_b16 a[162:163], v10 offset:1024
v_fma_f32 v36, v32, s85, v28
v_mfma_f32_16x16x32_bf16 v[216:219], a[172:175], a[152:155], v[216:219]
ds_read_b64_tr_b16 a[164:165], v10 offset:8192
v_fma_f32 v37, v33, s85, v28
v_mfma_f32_16x16x32_bf16 v[216:219], a[168:171], a[136:139], v[216:219]
s_add_u32 m0, s72, 0x1480
s_waitcnt vmcnt(12)
ds_read_b128 a[64:67], v24 offset:32768
v_fma_f32 v38, v34, s85, v28
v_mfma_f32_16x16x32_bf16 v[212:215], a[168:171], a[132:135], v[212:215]
buffer_load_dwordx4 v2, s[8:11], s58 offen offset:896 lds
ds_read_b128 a[80:83], v25 offset:32768
v_mfma_f32_16x16x32_bf16 v[212:215], a[172:175], a[148:151], v[212:215]
ds_read_b64_tr_b16 a[166:167], v10 offset:9216
v_fma_f32 v39, v35, s85, v28
v_mfma_f32_16x16x32_bf16 v[208:211], a[172:175], a[144:147], v[208:211]
v_exp_f32_e64 v36, v36 clamp
v_mfma_f32_16x16x32_bf16 v[208:211], a[168:171], a[128:131], v[208:211]
s_waitcnt lgkmcnt(11)
v_exp_f32_e64 v37, v37 clamp
v_mfma_f32_16x16x32_bf16 v[224:227], a[176:179], a[128:131], v[224:227]
ds_read_b64_tr_b16 a[168:169], v11
v_max_f32 v40, s86, v32
v_mfma_f32_16x16x32_bf16 v[224:227], a[180:183], a[144:147], v[224:227]
s_add_u32 m0, s72, 0x1880
ds_read_b64_tr_b16 a[170:171], v11 offset:1024
v_max_f32 v41, s86, v33
v_mfma_f32_16x16x32_bf16 v[228:231], a[180:183], a[148:151], v[228:231]
buffer_load_dwordx4 v3, s[8:11], s58 offen offset:896 lds
ds_read_b64_tr_b16 a[172:173], v11 offset:8192
v_mfma_f32_16x16x32_bf16 v[228:231], a[176:179], a[132:135], v[228:231]
ds_read_b64_tr_b16 a[174:175], v11 offset:9216
v_max_f32 v42, s86, v34
v_mfma_f32_16x16x32_bf16 v[232:235], a[176:179], a[136:139], v[232:235]
v_exp_f32_e64 v38, v38 clamp
v_mfma_f32_16x16x32_bf16 v[232:235], a[180:183], a[152:155], v[232:235]
v_exp_f32_e64 v39, v39 clamp
v_mfma_f32_16x16x32_bf16 v[236:239], a[180:183], a[156:159], v[236:239]
s_add_u32 m0, s72, 0x8000
s_waitcnt vmcnt(12)
ds_read_b128 a[68:71], v24 offset:34816
v_max_f32 v43, s86, v35
v_mfma_f32_16x16x32_bf16 v[236:239], a[176:179], a[140:143], v[236:239]
s_waitcnt lgkmcnt(6)
buffer_load_dwordx4 v22, s[24:27], s63 offen lds
ds_read_b128 a[84:87], v25 offset:34816
v_mfma_f32_16x16x32_bf16 v[252:255], a[184:187], a[140:143], v[252:255]
ds_read_b64_tr_b16 a[176:177], v12
v_add_f32 v36, v40, v36
v_mfma_f32_16x16x32_bf16 v[252:255], a[188:191], a[156:159], v[252:255]
ds_read_b64_tr_b16 a[178:179], v12 offset:1024
v_add_f32 v37, v41, v37
v_mfma_f32_16x16x32_bf16 v[248:251], a[188:191], a[152:155], v[248:251]
ds_read_b64_tr_b16 a[180:181], v12 offset:8192
v_add_f32 v38, v42, v38
v_mfma_f32_16x16x32_bf16 v[248:251], a[184:187], a[136:139], v[248:251]
ds_read_b64_tr_b16 a[182:183], v12 offset:9216
v_add_f32 v39, v43, v39
v_mfma_f32_16x16x32_bf16 v[244:247], a[184:187], a[132:135], v[244:247]
s_add_u32 m0, s72, 0x8400
v_cndmask_b32_e64 v32, v32, v36, s[80:81]
v_cndmask_b32_e64 v33, v33, v37, s[80:81]
v_mfma_f32_16x16x32_bf16 v[244:247], a[188:191], a[148:151], v[244:247]
buffer_load_dwordx4 v23, s[24:27], s63 offen lds
v_cndmask_b32_e64 v34, v34, v38, s[80:81]
v_mfma_f32_16x16x32_bf16 v[240:243], a[188:191], a[144:147], v[240:243]
v_cndmask_b32_e64 v35, v35, v39, s[80:81]
v_cvt_pk_bf16_f32 v40, v32, v33
v_mfma_f32_16x16x32_bf16 v[240:243], a[184:187], a[128:131], v[240:243]
v_cvt_pk_bf16_f32 v41, v34, v35
ds_write_b64 v59, v[40:41]
v_mfma_f32_16x16x32_bf16 a[0:3], a[160:163], a[128:131], a[0:3]
s_waitcnt lgkmcnt(5)
ds_read_b64_tr_b16 a[184:185], v13
v_accvgpr_write_b32 a240, v40
v_mfma_f32_16x16x32_bf16 a[0:3], a[164:167], a[144:147], a[0:3]
s_add_u32 m0, s72, 0x8800
s_waitcnt vmcnt(12)
ds_read_b128 a[72:75], v24 offset:36864
v_accvgpr_write_b32 a241, v41
v_mfma_f32_16x16x32_bf16 a[4:7], a[164:167], a[148:151], a[4:7]
buffer_load_dwordx4 v22, s[24:27], s64 offen lds
ds_read_b128 a[88:91], v25 offset:36864
v_mfma_f32_16x16x32_bf16 a[4:7], a[160:163], a[132:135], a[4:7]
ds_read_b64_tr_b16 a[186:187], v13 offset:1024
v_accvgpr_read_b32 v44, a244
v_mfma_f32_16x16x32_bf16 a[8:11], a[160:163], a[136:139], a[8:11]
ds_read_b64_tr_b16 a[188:189], v13 offset:8192
v_accvgpr_read_b32 v45, a245
v_mfma_f32_16x16x32_bf16 a[8:11], a[164:167], a[152:155], a[8:11]
ds_read_b64_tr_b16 a[190:191], v13 offset:9216
v_accvgpr_read_b32 v46, a246
v_mfma_f32_16x16x32_bf16 a[12:15], a[164:167], a[156:159], a[12:15]
v_accvgpr_read_b32 v47, a247
v_fma_f32 v48, v44, s85, v28
v_mfma_f32_16x16x32_bf16 a[12:15], a[160:163], a[140:143], a[12:15]
s_add_u32 m0, s72, 0x8c00
v_fma_f32 v49, v45, s85, v28
v_fma_f32 v50, v46, s85, v28
v_mfma_f32_16x16x32_bf16 a[28:31], a[168:171], a[140:143], a[28:31]
buffer_load_dwordx4 v23, s[24:27], s64 offen lds
v_fma_f32 v51, v47, s85, v28
v_mfma_f32_16x16x32_bf16 a[28:31], a[172:175], a[156:159], a[28:31]
v_exp_f32_e64 v48, v48 clamp
v_mfma_f32_16x16x32_bf16 a[24:27], a[172:175], a[152:155], a[24:27]
v_exp_f32_e64 v49, v49 clamp
v_mfma_f32_16x16x32_bf16 a[24:27], a[168:171], a[136:139], a[24:27]
v_exp_f32_e64 v50, v50 clamp
v_mfma_f32_16x16x32_bf16 a[20:23], a[168:171], a[132:135], a[20:23]
s_add_u32 m0, s72, 0x9000
s_waitcnt vmcnt(12)
ds_read_b128 a[76:79], v24 offset:38912
v_max_f32 v52, s86, v44
v_mfma_f32_16x16x32_bf16 a[20:23], a[172:175], a[148:151], a[20:23]
s_waitcnt lgkmcnt(4)
buffer_load_dwordx4 v22, s[24:27], s65 offen lds
ds_read_b128 a[92:95], v25 offset:38912
v_mfma_f32_16x16x32_bf16 a[16:19], a[172:175], a[144:147], a[16:19]
v_exp_f32_e64 v51, v51 clamp
v_mfma_f32_16x16x32_bf16 a[16:19], a[168:171], a[128:131], a[16:19]
v_max_f32 v53, s86, v45
v_max_f32 v54, s86, v46
v_mfma_f32_16x16x32_bf16 a[32:35], a[176:179], a[128:131], a[32:35]
s_waitcnt lgkmcnt(2)
s_barrier
v_mfma_f32_16x16x32_bf16 a[32:35], a[180:183], a[144:147], a[32:35]
s_add_u32 m0, s68, 0x8000
ds_read_b64_tr_b16 a[160:161], v6 offset:49152
v_max_f32 v55, s86, v47
v_mfma_f32_16x16x32_bf16 a[36:39], a[180:183], a[148:151], a[36:39]
s_add_u32 s75, s67, 0x380000
ds_read_b64_tr_b16 a[162:163], v6 offset:50176
v_add_f32 v48, v52, v48
v_mfma_f32_16x16x32_bf16 a[36:39], a[176:179], a[132:135], a[36:39]
buffer_load_dwordx4 v4, s[12:15], s75 offen lds
ds_read_b64_tr_b16 a[164:165], v6 offset:57344
v_mfma_f32_16x16x32_bf16 a[40:43], a[176:179], a[136:139], a[40:43]
ds_read_b64_tr_b16 a[166:167], v6 offset:58368
v_add_f32 v49, v53, v49
v_mfma_f32_16x16x32_bf16 a[40:43], a[180:183], a[152:155], a[40:43]
ds_read_b64_tr_b16 a[168:169], v7 offset:49152
v_add_f32 v50, v54, v50
v_mfma_f32_16x16x32_bf16 a[44:47], a[180:183], a[156:159], a[44:47]
s_add_u32 m0, s68, 0x8400
ds_read_b64_tr_b16 a[170:171], v7 offset:50176
v_add_f32 v51, v55, v51
v_mfma_f32_16x16x32_bf16 a[44:47], a[176:179], a[140:143], a[44:47]
s_add_u32 s75, s67, 0x388000
s_waitcnt vmcnt(12)
ds_read_b128 a[96:99], v24
v_cndmask_b32_e64 v44, v44, v48, s[80:81]
v_mfma_f32_16x16x32_bf16 a[60:63], a[184:187], a[140:143], a[60:63]
buffer_load_dwordx4 v4, s[12:15], s75 offen lds
ds_read_b128 a[112:115], v25
v_mfma_f32_16x16x32_bf16 a[60:63], a[188:191], a[156:159], a[60:63]
ds_read_b64_tr_b16 a[172:173], v7 offset:57344
v_cndmask_b32_e64 v45, v45, v49, s[80:81]
v_mfma_f32_16x16x32_bf16 a[56:59], a[188:191], a[152:155], a[56:59]
ds_read_b64_tr_b16 a[174:175], v7 offset:58368
v_cndmask_b32_e64 v46, v46, v50, s[80:81]
v_mfma_f32_16x16x32_bf16 a[56:59], a[184:187], a[136:139], a[56:59]
ds_read_b64_tr_b16 a[176:177], v8 offset:49152
v_cndmask_b32_e64 v47, v47, v51, s[80:81]
v_mfma_f32_16x16x32_bf16 a[52:55], a[184:187], a[132:135], a[52:55]
s_add_u32 m0, s68, 0x9000
ds_read_b64_tr_b16 a[178:179], v8 offset:50176
v_cvt_pk_bf16_f32 v52, v44, v45
v_mfma_f32_16x16x32_bf16 a[52:55], a[188:191], a[148:151], a[52:55]
s_add_u32 s75, s67, 0x3a0000
ds_read_b64_tr_b16 a[180:181], v8 offset:57344
v_cvt_pk_bf16_f32 v53, v46, v47
v_mfma_f32_16x16x32_bf16 a[48:51], a[188:191], a[144:147], a[48:51]
buffer_load_dwordx4 v4, s[12:15], s75 offen lds
ds_read_b64_tr_b16 a[182:183], v8 offset:58368
v_mfma_f32_16x16x32_bf16 a[48:51], a[184:187], a[128:131], a[48:51]
s_waitcnt lgkmcnt(10)
ds_write_b64 v59, v[52:53] offset:32
v_accvgpr_write_b32 a242, v52
v_mfma_f32_16x16x32_bf16 v[64:67], a[64:67], a[160:163], v[64:67]
ds_read_b64_tr_b16 a[184:185], v9 offset:49152
v_accvgpr_write_b32 a243, v53
v_mfma_f32_16x16x32_bf16 v[64:67], a[80:83], a[164:167], v[64:67]
s_add_u32 m0, s68, 0x9400
ds_read_b64_tr_b16 a[186:187], v9 offset:50176
ds_read_b64_tr_b16 a[212:213], v60
v_mfma_f32_16x16x32_bf16 v[68:71], a[84:87], a[164:167], v[68:71]
s_add_u32 s75, s67, 0x3a8000
s_waitcnt vmcnt(12)
ds_read_b128 a[100:103], v24 offset:2048
ds_read_b64_tr_b16 a[214:215], v61
v_mfma_f32_16x16x32_bf16 v[68:71], a[68:71], a[160:163], v[68:71]
buffer_load_dwordx4 v4, s[12:15], s75 offen lds
ds_read_b128 a[116:119], v25 offset:2048
v_mfma_f32_16x16x32_bf16 v[72:75], a[72:75], a[160:163], v[72:75]
ds_read_b64_tr_b16 a[188:189], v9 offset:57344
ds_read_b64_tr_b16 a[244:245], v60 offset:32
v_mfma_f32_16x16x32_bf16 v[72:75], a[88:91], a[164:167], v[72:75]
ds_read_b64_tr_b16 a[190:191], v9 offset:58368
ds_read_b64_tr_b16 a[246:247], v61 offset:32
v_mfma_f32_16x16x32_bf16 v[76:79], a[92:95], a[164:167], v[76:79]
s_waitcnt lgkmcnt(15)
v_accvgpr_read_b32 v32, a216
v_accvgpr_read_b32 v33, a217
v_mfma_f32_16x16x32_bf16 v[76:79], a[76:79], a[160:163], v[76:79]
s_add_u32 m0, s68, 0xa000
v_accvgpr_read_b32 v34, a218
v_accvgpr_read_b32 v35, a219
v_mfma_f32_16x16x32_bf16 v[92:95], a[76:79], a[168:171], v[92:95]
s_add_u32 s75, s67, 0x3c0000
ds_read_b64_tr_b16 a[160:161], v10 offset:49152
v_fma_f32 v36, v32, s85, v28
v_mfma_f32_16x16x32_bf16 v[92:95], a[92:95], a[172:175], v[92:95]
buffer_load_dwordx4 v4, s[12:15], s75 offen lds
ds_read_b64_tr_b16 a[162:163], v10 offset:50176
v_mfma_f32_16x16x32_bf16 v[88:91], a[88:91], a[172:175], v[88:91]
ds_read_b64_tr_b16 a[164:165], v10 offset:57344
v_fma_f32 v37, v33, s85, v28
v_mfma_f32_16x16x32_bf16 v[88:91], a[72:75], a[168:171], v[88:91]
ds_read_b64_tr_b16 a[166:167], v10 offset:58368
v_fma_f32 v38, v34, s85, v28
v_mfma_f32_16x16x32_bf16 v[84:87], a[68:71], a[168:171], v[84:87]
s_add_u32 m0, s68, 0xa400
v_fma_f32 v39, v35, s85, v28
v_max_f32 v40, s86, v32
v_mfma_f32_16x16x32_bf16 v[84:87], a[84:87], a[172:175], v[84:87]
s_add_u32 s75, s67, 0x3c8000
s_waitcnt vmcnt(12)
ds_read_b128 a[104:107], v24 offset:4096
v_max_f32 v41, s86, v33
v_mfma_f32_16x16x32_bf16 v[80:83], a[80:83], a[172:175], v[80:83]
buffer_load_dwordx4 v4, s[12:15], s75 offen lds
ds_read_b128 a[120:123], v25 offset:4096
v_mfma_f32_16x16x32_bf16 v[80:83], a[64:67], a[168:171], v[80:83]
s_waitcnt lgkmcnt(15)
v_exp_f32_e64 v36, v36 clamp
v_mfma_f32_16x16x32_bf16 v[96:99], a[64:67], a[176:179], v[96:99]
ds_read_b64_tr_b16 a[168:169], v11 offset:49152
v_max_f32 v42, s86, v34
v_mfma_f32_16x16x32_bf16 v[96:99], a[80:83], a[180:183], v[96:99]
ds_read_b64_tr_b16 a[170:171], v11 offset:50176
v_max_f32 v43, s86, v35
v_mfma_f32_16x16x32_bf16 v[100:103], a[84:87], a[180:183], v[100:103]
s_add_u32 m0, s68, 0xb000
ds_read_b64_tr_b16 a[172:173], v11 offset:57344
v_add_f32 v32, v40, v36
v_mfma_f32_16x16x32_bf16 v[100:103], a[68:71], a[176:179], v[100:103]
s_add_u32 s75, s67, 0x3e0000
ds_read_b64_tr_b16 a[174:175], v11 offset:58368
v_accvgpr_read_b32 v44, a220
v_mfma_f32_16x16x32_bf16 v[104:107], a[72:75], a[176:179], v[104:107]
buffer_load_dwordx4 v4, s[12:15], s75 offen lds
v_accvgpr_read_b32 v45, a221
v_mfma_f32_16x16x32_bf16 v[104:107], a[88:91], a[180:183], v[104:107]
v_exp_f32_e64 v37, v37 clamp
v_mfma_f32_16x16x32_bf16 v[108:111], a[92:95], a[180:183], v[108:111]
s_waitcnt lgkmcnt(11)
v_exp_f32_e64 v38, v38 clamp
v_mfma_f32_16x16x32_bf16 v[108:111], a[76:79], a[176:179], v[108:111]
s_add_u32 m0, s68, 0xb400
v_exp_f32_e64 v39, v39 clamp
v_mfma_f32_16x16x32_bf16 v[124:127], a[76:79], a[184:187], v[124:127]
s_add_u32 s75, s67, 0x3e8000
s_waitcnt vmcnt(12)
ds_read_b128 a[108:111], v24 offset:6144
v_add_f32 v33, v41, v37
v_mfma_f32_16x16x32_bf16 v[124:127], a[92:95], a[188:191], v[124:127]
buffer_load_dwordx4 v4, s[12:15], s75 offen lds
ds_read_b128 a[124:127], v25 offset:6144
v_mfma_f32_16x16x32_bf16 v[120:123], a[88:91], a[188:191], v[120:123]
ds_read_b64_tr_b16 a[176:177], v12 offset:49152
v_add_f32 v34, v42, v38
v_mfma_f32_16x16x32_bf16 v[120:123], a[72:75], a[184:187], v[120:123]
ds_read_b64_tr_b16 a[178:179], v12 offset:50176
v_add_f32 v35, v43, v39
v_mfma_f32_16x16x32_bf16 v[116:119], a[68:71], a[184:187], v[116:119]
ds_read_b64_tr_b16 a[180:181], v12 offset:57344
v_cvt_pk_bf16_f32 v40, v32, v33
v_mfma_f32_16x16x32_bf16 v[116:119], a[84:87], a[188:191], v[116:119]
s_add_u32 m0, s71, 0
ds_read_b64_tr_b16 a[182:183], v12 offset:58368
v_cvt_pk_bf16_f32 v41, v34, v35
v_mfma_f32_16x16x32_bf16 v[112:115], a[80:83], a[188:191], v[112:115]
s_add_u32 s75, s70, 0
ds_write_b64 v58, v[40:41]
v_accvgpr_write_b32 a216, v40
v_mfma_f32_16x16x32_bf16 v[112:115], a[64:67], a[184:187], v[112:115]
s_waitcnt lgkmcnt(13)
buffer_load_dwordx4 v4, s[28:31], s75 offen lds
v_accvgpr_write_b32 a217, v41
v_mfma_f32_16x16x32_bf16 v[128:131], a[64:67], a[160:163], v[128:131]
ds_read_b64_tr_b16 a[184:185], v13 offset:49152
v_accvgpr_read_b32 v46, a222
v_mfma_f32_16x16x32_bf16 v[128:131], a[80:83], a[164:167], v[128:131]
ds_read_b64_tr_b16 a[186:187], v13 offset:50176
v_accvgpr_read_b32 v47, a223
v_mfma_f32_16x16x32_bf16 v[132:135], a[84:87], a[164:167], v[132:135]
s_add_u32 m0, s71, 0x400
ds_read_b64_tr_b16 a[188:189], v13 offset:57344
v_fma_f32 v48, v44, s85, v28
v_mfma_f32_16x16x32_bf16 v[132:135], a[68:71], a[160:163], v[132:135]
s_add_u32 s75, s70, 0x8000
s_waitcnt vmcnt(12)
ds_read_b128 a[128:131], v24 offset:32768
v_fma_f32 v49, v45, s85, v28
v_mfma_f32_16x16x32_bf16 v[136:139], a[72:75], a[160:163], v[136:139]
buffer_load_dwordx4 v4, s[28:31], s75 offen lds
ds_read_b128 a[144:147], v25 offset:32768
v_mfma_f32_16x16x32_bf16 v[136:139], a[88:91], a[164:167], v[136:139]
ds_read_b64_tr_b16 a[190:191], v13 offset:58368
v_fma_f32 v50, v46, s85, v28
v_mfma_f32_16x16x32_bf16 v[140:143], a[92:95], a[164:167], v[140:143]
v_fma_f32 v51, v47, s85, v28
v_max_f32 v52, s86, v44
v_mfma_f32_16x16x32_bf16 v[140:143], a[76:79], a[160:163], v[140:143]
s_waitcnt lgkmcnt(13)
v_exp_f32_e64 v48, v48 clamp
v_mfma_f32_16x16x32_bf16 v[156:159], a[76:79], a[168:171], v[156:159]
s_add_u32 m0, s71, 0x2000
ds_read_b64_tr_b16 a[160:161], v6 offset:32768
v_max_f32 v53, s86, v45
v_mfma_f32_16x16x32_bf16 v[156:159], a[92:95], a[172:175], v[156:159]
s_add_u32 s75, s70, 0x40000
ds_read_b64_tr_b16 a[162:163], v6 offset:33792
v_max_f32 v54, s86, v46
v_mfma_f32_16x16x32_bf16 v[152:155], a[88:91], a[172:175], v[152:155]
buffer_load_dwordx4 v4, s[28:31], s75 offen lds
ds_read_b64_tr_b16 a[164:165], v6 offset:40960
v_mfma_f32_16x16x32_bf16 v[152:155], a[72:75], a[168:171], v[152:155]
ds_read_b64_tr_b16 a[166:167], v6 offset:41984
v_max_f32 v55, s86, v47
v_mfma_f32_16x16x32_bf16 v[148:151], a[68:71], a[168:171], v[148:151]
v_exp_f32_e64 v49, v49 clamp
v_mfma_f32_16x16x32_bf16 v[148:151], a[84:87], a[172:175], v[148:151]
s_add_u32 m0, s71, 0x2400
v_exp_f32_e64 v50, v50 clamp
v_mfma_f32_16x16x32_bf16 v[144:147], a[80:83], a[172:175], v[144:147]
s_add_u32 s75, s70, 0x48000
s_waitcnt vmcnt(12)
ds_read_b128 a[132:135], v24 offset:34816
v_add_f32 v44, v52, v48
v_mfma_f32_16x16x32_bf16 v[144:147], a[64:67], a[168:171], v[144:147]
s_waitcnt lgkmcnt(12)
buffer_load_dwordx4 v4, s[28:31], s75 offen lds
ds_read_b128 a[148:151], v25 offset:34816
v_mfma_f32_16x16x32_bf16 v[160:163], a[64:67], a[176:179], v[160:163]
ds_read_b64_tr_b16 a[168:169], v7 offset:32768
v_add_f32 v45, v53, v49
v_mfma_f32_16x16x32_bf16 v[160:163], a[80:83], a[180:183], v[160:163]
ds_read_b64_tr_b16 a[170:171], v7 offset:33792
v_add_f32 v46, v54, v50
v_mfma_f32_16x16x32_bf16 v[164:167], a[84:87], a[180:183], v[164:167]
ds_read_b64_tr_b16 a[172:173], v7 offset:40960
v_cvt_pk_bf16_f32 v52, v44, v45
v_mfma_f32_16x16x32_bf16 v[164:167], a[68:71], a[176:179], v[164:167]
s_add_u32 m0, s71, 0x4000
ds_read_b64_tr_b16 a[174:175], v7 offset:41984
v_accvgpr_write_b32 a218, v52
v_mfma_f32_16x16x32_bf16 v[168:171], a[72:75], a[176:179], v[168:171]
s_add_u32 s75, s70, 0x80000
v_exp_f32_e64 v51, v51 clamp
v_mfma_f32_16x16x32_bf16 v[168:171], a[88:91], a[180:183], v[168:171]
buffer_load_dwordx4 v4, s[28:31], s75 offen lds
v_add_f32 v47, v55, v51
v_mfma_f32_16x16x32_bf16 v[172:175], a[92:95], a[180:183], v[172:175]
v_cvt_pk_bf16_f32 v53, v46, v47
ds_write_b64 v58, v[52:53] offset:32
v_mfma_f32_16x16x32_bf16 v[172:175], a[76:79], a[176:179], v[172:175]
s_waitcnt lgkmcnt(11)
v_accvgpr_write_b32 a219, v53
v_accvgpr_read_b32 v32, a248
v_mfma_f32_16x16x32_bf16 v[188:191], a[76:79], a[184:187], v[188:191]
s_add_u32 m0, s71, 0x4400
ds_read_b64_tr_b16 a[176:177], v8 offset:32768
v_accvgpr_read_b32 v33, a249
v_mfma_f32_16x16x32_bf16 v[188:191], a[92:95], a[188:191], v[188:191]
s_add_u32 s75, s70, 0x88000
ds_read_b64_tr_b16 a[178:179], v8 offset:33792
v_accvgpr_read_b32 v34, a250
v_mfma_f32_16x16x32_bf16 v[184:187], a[88:91], a[188:191], v[184:187]
buffer_load_dwordx4 v4, s[28:31], s75 offen lds
ds_read_b64_tr_b16 a[180:181], v8 offset:40960
v_mfma_f32_16x16x32_bf16 v[184:187], a[72:75], a[184:187], v[184:187]
ds_read_b64_tr_b16 a[182:183], v8 offset:41984
v_accvgpr_read_b32 v35, a251
v_mfma_f32_16x16x32_bf16 v[180:183], a[68:71], a[184:187], v[180:183]
v_fma_f32 v36, v32, s85, v28
v_fma_f32 v37, v33, s85, v28
v_mfma_f32_16x16x32_bf16 v[180:183], a[84:87], a[188:191], v[180:183]
v_fma_f32 v38, v34, s85, v28
v_fma_f32 v39, v35, s85, v28
v_mfma_f32_16x16x32_bf16 v[176:179], a[80:83], a[188:191], v[176:179]
s_waitcnt lgkmcnt(11)
v_exp_f32_e64 v36, v36 clamp
v_mfma_f32_16x16x32_bf16 v[176:179], a[64:67], a[184:187], v[176:179]
s_add_u32 m0, s72, 0x9400
v_exp_f32_e64 v37, v37 clamp
v_mfma_f32_16x16x32_bf16 v[192:195], a[160:163], a[64:67], v[192:195]
buffer_load_dwordx4 v23, s[24:27], s65 offen lds
ds_read_b64_tr_b16 a[184:185], v9 offset:32768
v_mfma_f32_16x16x32_bf16 v[192:195], a[164:167], a[80:83], v[192:195]
ds_read_b64_tr_b16 a[186:187], v9 offset:33792
v_max_f32 v40, s86, v32
v_mfma_f32_16x16x32_bf16 v[196:199], a[164:167], a[84:87], v[196:199]
ds_read_b64_tr_b16 a[188:189], v9 offset:40960
v_max_f32 v41, s86, v33
v_mfma_f32_16x16x32_bf16 v[196:199], a[160:163], a[68:71], v[196:199]
ds_read_b64_tr_b16 a[190:191], v9 offset:41984
v_max_f32 v42, s86, v34
v_mfma_f32_16x16x32_bf16 v[200:203], a[160:163], a[72:75], v[200:203]
s_add_u32 m0, s72, 0x9800
v_exp_f32_e64 v38, v38 clamp
v_mfma_f32_16x16x32_bf16 v[200:203], a[164:167], a[88:91], v[200:203]
buffer_load_dwordx4 v22, s[24:27], s66 offen lds
v_max_f32 v43, s86, v35
v_mfma_f32_16x16x32_bf16 v[204:207], a[164:167], a[92:95], v[204:207]
v_exp_f32_e64 v39, v39 clamp
v_mfma_f32_16x16x32_bf16 v[204:207], a[160:163], a[76:79], v[204:207]
s_waitcnt lgkmcnt(9)
v_add_f32 v36, v40, v36
v_add_f32 v37, v41, v37
v_mfma_f32_16x16x32_bf16 v[220:223], a[168:171], a[76:79], v[220:223]
ds_read_b64_tr_b16 a[160:161], v10 offset:32768
v_add_f32 v38, v42, v38
v_mfma_f32_16x16x32_bf16 v[220:223], a[172:175], a[92:95], v[220:223]
ds_read_b64_tr_b16 a[162:163], v10 offset:33792
v_add_f32 v39, v43, v39
v_mfma_f32_16x16x32_bf16 v[216:219], a[172:175], a[88:91], v[216:219]
s_add_u32 m0, s72, 0x9c00
ds_read_b64_tr_b16 a[164:165], v10 offset:40960
v_cndmask_b32_e64 v32, v32, v36, s[80:81]
v_mfma_f32_16x16x32_bf16 v[216:219], a[168:171], a[72:75], v[216:219]
buffer_load_dwordx4 v23, s[24:27], s66 offen lds
ds_read_b64_tr_b16 a[166:167], v10 offset:41984
v_mfma_f32_16x16x32_bf16 v[212:215], a[168:171], a[68:71], v[212:215]
v_cndmask_b32_e64 v33, v33, v37, s[80:81]
v_cndmask_b32_e64 v34, v34, v38, s[80:81]
v_mfma_f32_16x16x32_bf16 v[212:215], a[172:175], a[84:87], v[212:215]
v_cndmask_b32_e64 v35, v35, v39, s[80:81]
v_cvt_pk_bf16_f32 v40, v32, v33
v_mfma_f32_16x16x32_bf16 v[208:211], a[172:175], a[80:83], v[208:211]
s_waitcnt lgkmcnt(8)
v_cvt_pk_bf16_f32 v41, v34, v35
ds_write_b64 v59, v[40:41]
v_mfma_f32_16x16x32_bf16 v[208:211], a[168:171], a[64:67], v[208:211]
s_add_u32 m0, s72, 0xffffff80
v_accvgpr_write_b32 a248, v40
v_accvgpr_write_b32 a249, v41
v_mfma_f32_16x16x32_bf16 v[224:227], a[176:179], a[64:67], v[224:227]
buffer_load_dwordx4 v22, s[24:27], s63 offen offset:128 lds
ds_read_b64_tr_b16 a[168:169], v11 offset:32768
v_mfma_f32_16x16x32_bf16 v[224:227], a[180:183], a[80:83], v[224:227]
ds_read_b64_tr_b16 a[170:171], v11 offset:33792
v_accvgpr_read_b32 v44, a252
v_mfma_f32_16x16x32_bf16 v[228:231], a[180:183], a[84:87], v[228:231]
ds_read_b64_tr_b16 a[172:173], v11 offset:40960
v_accvgpr_read_b32 v45, a253
v_mfma_f32_16x16x32_bf16 v[228:231], a[176:179], a[68:71], v[228:231]
ds_read_b64_tr_b16 a[174:175], v11 offset:41984
v_accvgpr_read_b32 v46, a254
v_mfma_f32_16x16x32_bf16 v[232:235], a[176:179], a[72:75], v[232:235]
v_accvgpr_read_b32 v47, a255
v_fma_f32 v48, v44, s85, v28
v_mfma_f32_16x16x32_bf16 v[232:235], a[180:183], a[88:91], v[232:235]
s_add_u32 m0, s72, 0x380
v_fma_f32 v49, v45, s85, v28
v_fma_f32 v50, v46, s85, v28
v_mfma_f32_16x16x32_bf16 v[236:239], a[180:183], a[92:95], v[236:239]
buffer_load_dwordx4 v23, s[24:27], s63 offen offset:128 lds
v_fma_f32 v51, v47, s85, v28
v_mfma_f32_16x16x32_bf16 v[236:239], a[176:179], a[76:79], v[236:239]
s_waitcnt lgkmcnt(9)
v_exp_f32_e64 v48, v48 clamp
v_mfma_f32_16x16x32_bf16 v[252:255], a[184:187], a[76:79], v[252:255]
ds_read_b64_tr_b16 a[176:177], v12 offset:32768
v_max_f32 v52, s86, v44
v_mfma_f32_16x16x32_bf16 v[252:255], a[188:191], a[92:95], v[252:255]
ds_read_b64_tr_b16 a[178:179], v12 offset:33792
v_max_f32 v53, s86, v45
v_mfma_f32_16x16x32_bf16 v[248:251], a[188:191], a[88:91], v[248:251]
s_add_u32 m0, s72, 0x780
ds_read_b64_tr_b16 a[180:181], v12 offset:40960
v_max_f32 v54, s86, v46
v_mfma_f32_16x16x32_bf16 v[248:251], a[184:187], a[72:75], v[248:251]
buffer_load_dwordx4 v22, s[24:27], s64 offen offset:128 lds
ds_read_b64_tr_b16 a[182:183], v12 offset:41984
v_mfma_f32_16x16x32_bf16 v[244:247], a[184:187], a[68:71], v[244:247]
v_exp_f32_e64 v49, v49 clamp
v_mfma_f32_16x16x32_bf16 v[244:247], a[188:191], a[84:87], v[244:247]
v_exp_f32_e64 v50, v50 clamp
v_mfma_f32_16x16x32_bf16 v[240:243], a[188:191], a[80:83], v[240:243]
v_exp_f32_e64 v51, v51 clamp
v_mfma_f32_16x16x32_bf16 v[240:243], a[184:187], a[64:67], v[240:243]
s_waitcnt lgkmcnt(9)
v_max_f32 v55, s86, v47
v_add_f32 v48, v52, v48
v_mfma_f32_16x16x32_bf16 a[0:3], a[160:163], a[64:67], a[0:3]
s_add_u32 m0, s72, 0xb80
ds_read_b64_tr_b16 a[184:185], v13 offset:32768
v_add_f32 v49, v53, v49
v_mfma_f32_16x16x32_bf16 a[0:3], a[164:167], a[80:83], a[0:3]
buffer_load_dwordx4 v23, s[24:27], s64 offen offset:128 lds
ds_read_b64_tr_b16 a[186:187], v13 offset:33792
v_mfma_f32_16x16x32_bf16 a[4:7], a[164:167], a[84:87], a[4:7]
ds_read_b64_tr_b16 a[188:189], v13 offset:40960
v_add_f32 v50, v54, v50
v_mfma_f32_16x16x32_bf16 a[4:7], a[160:163], a[68:71], a[4:7]
ds_read_b64_tr_b16 a[190:191], v13 offset:41984
v_add_f32 v51, v55, v51
v_mfma_f32_16x16x32_bf16 a[8:11], a[160:163], a[72:75], a[8:11]
v_cndmask_b32_e64 v44, v44, v48, s[80:81]
v_cndmask_b32_e64 v45, v45, v49, s[80:81]
v_mfma_f32_16x16x32_bf16 a[8:11], a[164:167], a[88:91], a[8:11]
s_add_u32 m0, s72, 0xf80
v_cndmask_b32_e64 v46, v46, v50, s[80:81]
v_cndmask_b32_e64 v47, v47, v51, s[80:81]
v_mfma_f32_16x16x32_bf16 a[12:15], a[164:167], a[92:95], a[12:15]
buffer_load_dwordx4 v22, s[24:27], s65 offen offset:128 lds
v_cvt_pk_bf16_f32 v52, v44, v45
v_mfma_f32_16x16x32_bf16 a[12:15], a[160:163], a[76:79], a[12:15]
s_waitcnt lgkmcnt(8)
v_cvt_pk_bf16_f32 v53, v46, v47
ds_write_b64 v59, v[52:53] offset:32
v_mfma_f32_16x16x32_bf16 a[28:31], a[168:171], a[76:79], a[28:31]
v_accvgpr_write_b32 a250, v52
v_accvgpr_write_b32 a251, v53
v_mfma_f32_16x16x32_bf16 a[28:31], a[172:175], a[92:95], a[28:31]
ds_read_b64_tr_b16 a[220:221], v60
ds_read_b64_tr_b16 a[222:223], v61
v_mfma_f32_16x16x32_bf16 a[24:27], a[172:175], a[88:91], a[24:27]
ds_read_b64_tr_b16 a[252:253], v60 offset:32
ds_read_b64_tr_b16 a[254:255], v61 offset:32
v_mfma_f32_16x16x32_bf16 a[24:27], a[168:171], a[72:75], a[24:27]
s_add_u32 m0, s72, 0x1380
v_accvgpr_read_b32 v32, a192
v_accvgpr_read_b32 v33, a193
v_mfma_f32_16x16x32_bf16 a[20:23], a[168:171], a[68:71], a[20:23]
buffer_load_dwordx4 v23, s[24:27], s65 offen offset:128 lds
v_accvgpr_read_b32 v34, a194
v_mfma_f32_16x16x32_bf16 a[20:23], a[172:175], a[84:87], a[20:23]
v_accvgpr_read_b32 v35, a195
v_fma_f32 v36, v32, s85, v28
v_mfma_f32_16x16x32_bf16 a[16:19], a[172:175], a[80:83], a[16:19]
v_fma_f32 v37, v33, s85, v28
v_fma_f32 v38, v34, s85, v28
v_mfma_f32_16x16x32_bf16 a[16:19], a[168:171], a[64:67], a[16:19]
s_waitcnt lgkmcnt(5)
v_fma_f32 v39, v35, s85, v28
v_max_f32 v40, s86, v32
v_mfma_f32_16x16x32_bf16 a[32:35], a[176:179], a[64:67], a[32:35]
s_waitcnt vmcnt(15)
s_barrier
v_mfma_f32_16x16x32_bf16 a[32:35], a[180:183], a[80:83], a[32:35]
s_add_u32 m0, s72, 0x1780
ds_read_b64_tr_b16 a[160:161], v6 offset:16384
v_max_f32 v41, s86, v33
v_mfma_f32_16x16x32_bf16 a[36:39], a[180:183], a[84:87], a[36:39]
buffer_load_dwordx4 v22, s[24:27], s66 offen offset:128 lds
ds_read_b64_tr_b16 a[162:163], v6 offset:17408
v_mfma_f32_16x16x32_bf16 a[36:39], a[176:179], a[68:71], a[36:39]
ds_read_b64_tr_b16 a[164:165], v6 offset:24576
v_max_f32 v42, s86, v34
v_mfma_f32_16x16x32_bf16 a[40:43], a[176:179], a[72:75], a[40:43]
ds_read_b64_tr_b16 a[166:167], v6 offset:25600
v_max_f32 v43, s86, v35
v_mfma_f32_16x16x32_bf16 a[40:43], a[180:183], a[88:91], a[40:43]
ds_read_b64_tr_b16 a[168:169], v7 offset:16384
v_accvgpr_read_b32 v44, a196
v_mfma_f32_16x16x32_bf16 a[44:47], a[180:183], a[92:95], a[44:47]
s_add_u32 m0, s72, 0x1b80
ds_read_b64_tr_b16 a[170:171], v7 offset:17408
v_accvgpr_read_b32 v45, a197
v_mfma_f32_16x16x32_bf16 a[44:47], a[176:179], a[76:79], a[44:47]
buffer_load_dwordx4 v23, s[24:27], s66 offen offset:128 lds
ds_read_b64_tr_b16 a[172:173], v7 offset:24576
v_mfma_f32_16x16x32_bf16 a[60:63], a[184:187], a[76:79], a[60:63]
ds_read_b64_tr_b16 a[174:175], v7 offset:25600
v_accvgpr_read_b32 v46, a198
v_mfma_f32_16x16x32_bf16 a[60:63], a[188:191], a[92:95], a[60:63]
ds_read_b64_tr_b16 a[176:177], v8 offset:16384
v_accvgpr_read_b32 v47, a199
v_mfma_f32_16x16x32_bf16 a[56:59], a[188:191], a[88:91], a[56:59]
s_add_u32 m0, s71, 0x10000
ds_read_b64_tr_b16 a[178:179], v8 offset:17408
v_fma_f32 v48, v44, s85, v28
v_mfma_f32_16x16x32_bf16 a[56:59], a[184:187], a[72:75], a[56:59]
s_add_u32 s75, s70, 0xc0000
ds_read_b64_tr_b16 a[180:181], v8 offset:24576
v_fma_f32 v49, v45, s85, v28
v_mfma_f32_16x16x32_bf16 a[52:55], a[184:187], a[68:71], a[52:55]
buffer_load_dwordx4 v4, s[28:31], s75 offen lds
ds_read_b64_tr_b16 a[182:183], v8 offset:25600
v_mfma_f32_16x16x32_bf16 a[52:55], a[188:191], a[84:87], a[52:55]
v_exp_f32_e64 v36, v36 clamp
v_mfma_f32_16x16x32_bf16 a[48:51], a[188:191], a[80:83], a[48:51]
v_exp_f32_e64 v37, v37 clamp
v_mfma_f32_16x16x32_bf16 a[48:51], a[184:187], a[64:67], a[48:51]
s_waitcnt lgkmcnt(8)
v_exp_f32_e64 v38, v38 clamp
v_mfma_f32_16x16x32_bf16 v[64:67], a[96:99], a[160:163], v[64:67]
s_add_u32 m0, s71, 0x10400
ds_read_b64_tr_b16 a[184:185], v9 offset:16384
v_add_f32 v32, v40, v36
v_mfma_f32_16x16x32_bf16 v[64:67], a[112:115], a[164:167], v[64:67]
s_add_u32 s75, s70, 0xc8000
ds_read_b64_tr_b16 a[186:187], v9 offset:17408
v_add_f32 v33, v41, v37
v_mfma_f32_16x16x32_bf16 v[68:71], a[116:119], a[164:167], v[68:71]
buffer_load_dwordx4 v4, s[28:31], s75 offen lds
ds_read_b64_tr_b16 a[188:189], v9 offset:24576
v_mfma_f32_16x16x32_bf16 v[68:71], a[100:103], a[160:163], v[68:71]
ds_read_b64_tr_b16 a[190:191], v9 offset:25600
v_add_f32 v34, v42, v38
v_mfma_f32_16x16x32_bf16 v[72:75], a[104:107], a[160:163], v[72:75]
v_exp_f32_e64 v39, v39 clamp
v_mfma_f32_16x16x32_bf16 v[72:75], a[120:123], a[164:167], v[72:75]
v_add_f32 v35, v43, v39
v_cvt_pk_bf16_f32 v40, v32, v33
v_mfma_f32_16x16x32_bf16 v[76:79], a[124:127], a[164:167], v[76:79]
s_add_u32 m0, s72, 0x7f00
s_waitcnt vmcnt(12)
ds_read_b128 a[136:139], v24 offset:36864
v_cvt_pk_bf16_f32 v41, v34, v35
v_mfma_f32_16x16x32_bf16 v[76:79], a[108:111], a[160:163], v[76:79]
s_waitcnt lgkmcnt(9)
buffer_load_dwordx4 v22, s[24:27], s63 offen offset:256 lds
ds_read_b128 a[152:155], v25 offset:36864
v_mfma_f32_16x16x32_bf16 v[92:95], a[108:111], a[168:171], v[92:95]
ds_read_b64_tr_b16 a[160:161], v10 offset:16384
v_accvgpr_write_b32 a192, v40
v_mfma_f32_16x16x32_bf16 v[92:95], a[124:127], a[172:175], v[92:95]
ds_read_b64_tr_b16 a[162:163], v10 offset:17408
v_accvgpr_write_b32 a193, v41
v_mfma_f32_16x16x32_bf16 v[88:91], a[120:123], a[172:175], v[88:91]
ds_read_b64_tr_b16 a[164:165], v10 offset:24576
v_fma_f32 v50, v46, s85, v28
v_mfma_f32_16x16x32_bf16 v[88:91], a[104:107], a[168:171], v[88:91]
s_add_u32 m0, s71, 0x12000
ds_read_b64_tr_b16 a[166:167], v10 offset:25600
v_fma_f32 v51, v47, s85, v28
v_mfma_f32_16x16x32_bf16 v[84:87], a[100:103], a[168:171], v[84:87]
s_add_u32 s75, s70, 0x100000
v_cvt_pk_bf16_f32 v64, v64, v65
v_cvt_pk_bf16_f32 v65, v66, v67
v_mfma_f32_16x16x32_bf16 v[84:87], a[116:119], a[172:175], v[84:87]
buffer_load_dwordx4 v4, s[28:31], s75 offen lds
v_cvt_pk_bf16_f32 v66, v68, v69
v_mfma_f32_16x16x32_bf16 v[80:83], a[112:115], a[172:175], v[80:83]
v_cvt_pk_bf16_f32 v67, v70, v71
v_cvt_pk_bf16_f32 v72, v72, v73
v_mfma_f32_16x16x32_bf16 v[80:83], a[96:99], a[168:171], v[80:83]
s_waitcnt lgkmcnt(10)
v_cvt_pk_bf16_f32 v73, v74, v75
v_cvt_pk_bf16_f32 v74, v76, v77
v_mfma_f32_16x16x32_bf16 v[96:99], a[96:99], a[176:179], v[96:99]
ds_read_b64_tr_b16 a[168:169], v11 offset:16384
v_cvt_pk_bf16_f32 v75, v78, v79
v_mfma_f32_16x16x32_bf16 v[96:99], a[112:115], a[180:183], v[96:99]
s_add_u32 s76, s0, 0x1000000
s_waitcnt vmcnt(12)
ds_read_b128 a[140:143], v24 offset:38912
v_max_f32 v52, s86, v44
v_mfma_f32_16x16x32_bf16 v[100:103], a[116:119], a[180:183], v[100:103]
buffer_store_dwordx4 v[64:67], v1, s[4:7], s76 offen sc1
ds_read_b128 a[156:159], v25 offset:38912
v_mfma_f32_16x16x32_bf16 v[100:103], a[100:103], a[176:179], v[100:103]
s_add_u32 m0, s72, 0x8300
ds_read_b64_tr_b16 a[170:171], v11 offset:17408
v_max_f32 v53, s86, v45
v_mfma_f32_16x16x32_bf16 v[104:107], a[104:107], a[176:179], v[104:107]
buffer_load_dwordx4 v23, s[24:27], s63 offen offset:256 lds
ds_read_b64_tr_b16 a[172:173], v11 offset:24576
v_mfma_f32_16x16x32_bf16 v[104:107], a[120:123], a[180:183], v[104:107]
ds_read_b64_tr_b16 a[174:175], v11 offset:25600
v_cvt_pk_bf16_f32 v80, v80, v81
v_mfma_f32_16x16x32_bf16 v[108:111], a[124:127], a[180:183], v[108:111]
v_cvt_pk_bf16_f32 v81, v82, v83
v_cvt_pk_bf16_f32 v82, v84, v85
v_mfma_f32_16x16x32_bf16 v[108:111], a[108:111], a[176:179], v[108:111]
s_waitcnt lgkmcnt(12)
v_cvt_pk_bf16_f32 v83, v86, v87
v_cvt_pk_bf16_f32 v88, v88, v89
v_mfma_f32_16x16x32_bf16 v[124:127], a[108:111], a[184:187], v[124:127]
ds_read_b64_tr_b16 a[176:177], v12 offset:16384
v_cvt_pk_bf16_f32 v89, v90, v91
v_mfma_f32_16x16x32_bf16 v[124:127], a[124:127], a[188:191], v[124:127]
s_add_u32 m0, s72, 0x8700
ds_read_b64_tr_b16 a[178:179], v12 offset:17408
v_cvt_pk_bf16_f32 v90, v92, v93
v_mfma_f32_16x16x32_bf16 v[120:123], a[120:123], a[188:191], v[120:123]
buffer_load_dwordx4 v22, s[24:27], s64 offen offset:256 lds
ds_read_b64_tr_b16 a[180:181], v12 offset:24576
v_mfma_f32_16x16x32_bf16 v[120:123], a[104:107], a[184:187], v[120:123]
ds_read_b64_tr_b16 a[182:183], v12 offset:25600
v_cvt_pk_bf16_f32 v91, v94, v95
v_mfma_f32_16x16x32_bf16 v[116:119], a[100:103], a[184:187], v[116:119]
s_waitcnt vmcnt(13)
ds_read_b128 a[64:67], v24
v_cvt_pk_bf16_f32 v96, v96, v97
v_mfma_f32_16x16x32_bf16 v[116:119], a[116:119], a[188:191], v[116:119]
s_waitcnt lgkmcnt(11)
ds_read_b128 a[80:83], v25
v_cvt_pk_bf16_f32 v97, v98, v99
v_mfma_f32_16x16x32_bf16 v[112:115], a[112:115], a[188:191], v[112:115]
s_add_u32 s76, s0, 0x1002000
v_cvt_pk_bf16_f32 v98, v100, v101
v_cvt_pk_bf16_f32 v99, v102, v103
v_mfma_f32_16x16x32_bf16 v[112:115], a[96:99], a[184:187], v[112:115]
s_add_u32 m0, s71, 0x12400
buffer_store_dwordx4 v[72:75], v1, s[4:7], s76 offen sc1
v_cvt_pk_bf16_f32 v104, v104, v105
v_mfma_f32_16x16x32_bf16 v[128:131], a[96:99], a[160:163], v[128:131]
s_add_u32 s75, s70, 0x108000
ds_read_b64_tr_b16 a[184:185], v13 offset:16384
v_cvt_pk_bf16_f32 v105, v106, v107
v_mfma_f32_16x16x32_bf16 v[128:131], a[112:115], a[164:167], v[128:131]
buffer_load_dwordx4 v4, s[28:31], s75 offen lds
ds_read_b64_tr_b16 a[186:187], v13 offset:17408
v_mfma_f32_16x16x32_bf16 v[132:135], a[116:119], a[164:167], v[132:135]
ds_read_b64_tr_b16 a[188:189], v13 offset:24576
v_cvt_pk_bf16_f32 v106, v108, v109
v_mfma_f32_16x16x32_bf16 v[132:135], a[100:103], a[160:163], v[132:135]
ds_read_b64_tr_b16 a[190:191], v13 offset:25600
v_cvt_pk_bf16_f32 v107, v110, v111
v_mfma_f32_16x16x32_bf16 v[136:139], a[104:107], a[160:163], v[136:139]
v_cvt_pk_bf16_f32 v112, v112, v113
v_cvt_pk_bf16_f32 v113, v114, v115
v_mfma_f32_16x16x32_bf16 v[136:139], a[120:123], a[164:167], v[136:139]
v_cvt_pk_bf16_f32 v114, v116, v117
v_cvt_pk_bf16_f32 v115, v118, v119
v_mfma_f32_16x16x32_bf16 v[140:143], a[124:127], a[164:167], v[140:143]
s_add_u32 m0, s72, 0x8b00
v_cvt_pk_bf16_f32 v120, v120, v121
v_cvt_pk_bf16_f32 v121, v122, v123
v_mfma_f32_16x16x32_bf16 v[140:143], a[108:111], a[160:163], v[140:143]
s_waitcnt lgkmcnt(10)
buffer_load_dwordx4 v23, s[24:27], s64 offen offset:256 lds
s_waitcnt vmcnt(14)
ds_read_b128 a[68:71], v24 offset:2048
v_mfma_f32_16x16x32_bf16 v[156:159], a[108:111], a[168:171], v[156:159]
ds_read_b128 a[84:87], v25 offset:2048
v_cvt_pk_bf16_f32 v122, v124, v125
v_mfma_f32_16x16x32_bf16 v[156:159], a[124:127], a[172:175], v[156:159]
ds_read_b64_tr_b16 a[160:161], v6
v_cvt_pk_bf16_f32 v123, v126, v127
v_mfma_f32_16x16x32_bf16 v[152:155], a[120:123], a[172:175], v[152:155]
ds_read_b64_tr_b16 a[162:163], v6 offset:1024
v_max_f32 v54, s86, v46
v_mfma_f32_16x16x32_bf16 v[152:155], a[104:107], a[168:171], v[152:155]
s_add_u32 s76, s0, 0x1000000
ds_read_b64_tr_b16 a[164:165], v6 offset:8192
v_max_f32 v55, s86, v47
v_mfma_f32_16x16x32_bf16 v[148:151], a[100:103], a[168:171], v[148:151]
buffer_store_dwordx4 v[80:83], v1, s[4:7], s76 offen offset:1024 sc1
ds_read_b64_tr_b16 a[166:167], v6 offset:9216
v_mfma_f32_16x16x32_bf16 v[148:151], a[116:119], a[172:175], v[148:151]
s_add_u32 m0, s72, 0x8f00
v_cvt_pk_bf16_f32 v128, v128, v129
v_cvt_pk_bf16_f32 v129, v130, v131
v_mfma_f32_16x16x32_bf16 v[144:147], a[112:115], a[172:175], v[144:147]
buffer_load_dwordx4 v22, s[24:27], s65 offen offset:256 lds
v_cvt_pk_bf16_f32 v130, v132, v133
v_mfma_f32_16x16x32_bf16 v[144:147], a[96:99], a[168:171], v[144:147]
s_waitcnt lgkmcnt(12)
v_cvt_pk_bf16_f32 v131, v134, v135
v_cvt_pk_bf16_f32 v136, v136, v137
v_mfma_f32_16x16x32_bf16 v[160:163], a[96:99], a[176:179], v[160:163]
ds_read_b64_tr_b16 a[168:169], v7
v_cvt_pk_bf16_f32 v137, v138, v139
v_mfma_f32_16x16x32_bf16 v[160:163], a[112:115], a[180:183], v[160:163]
ds_read_b64_tr_b16 a[170:171], v7 offset:1024
v_cvt_pk_bf16_f32 v138, v140, v141
v_mfma_f32_16x16x32_bf16 v[164:167], a[116:119], a[180:183], v[164:167]
s_waitcnt vmcnt(14)
ds_read_b128 a[72:75], v24 offset:4096
v_cvt_pk_bf16_f32 v139, v142, v143
v_mfma_f32_16x16x32_bf16 v[164:167], a[100:103], a[176:179], v[164:167]
s_add_u32 m0, s72, 0x9300
ds_read_b128 a[88:91], v25 offset:4096
v_accvgpr_read_b32 v32, a200
v_mfma_f32_16x16x32_bf16 v[168:171], a[104:107], a[176:179], v[168:171]
buffer_load_dwordx4 v23, s[24:27], s65 offen offset:256 lds
ds_read_b64_tr_b16 a[172:173], v7 offset:8192
v_mfma_f32_16x16x32_bf16 v[168:171], a[120:123], a[180:183], v[168:171]
ds_read_b64_tr_b16 a[174:175], v7 offset:9216
v_cvt_pk_bf16_f32 v144, v144, v145
v_mfma_f32_16x16x32_bf16 v[172:175], a[124:127], a[180:183], v[172:175]
v_cvt_pk_bf16_f32 v145, v146, v147
v_cvt_pk_bf16_f32 v146, v148, v149
v_mfma_f32_16x16x32_bf16 v[172:175], a[108:111], a[176:179], v[172:175]
s_waitcnt lgkmcnt(12)
v_cvt_pk_bf16_f32 v147, v150, v151
v_cvt_pk_bf16_f32 v152, v152, v153
v_mfma_f32_16x16x32_bf16 v[188:191], a[108:111], a[184:187], v[188:191]
s_add_u32 s76, s0, 0x1002000
ds_read_b64_tr_b16 a[176:177], v8
v_cvt_pk_bf16_f32 v153, v154, v155
v_mfma_f32_16x16x32_bf16 v[188:191], a[124:127], a[188:191], v[188:191]
buffer_store_dwordx4 v[88:91], v1, s[4:7], s76 offen offset:1024 sc1
ds_read_b64_tr_b16 a[178:179], v8 offset:1024
v_mfma_f32_16x16x32_bf16 v[184:187], a[120:123], a[188:191], v[184:187]
s_add_u32 m0, s72, 0x9700
ds_read_b64_tr_b16 a[180:181], v8 offset:8192
v_cvt_pk_bf16_f32 v154, v156, v157
v_mfma_f32_16x16x32_bf16 v[184:187], a[104:107], a[184:187], v[184:187]
buffer_load_dwordx4 v22, s[24:27], s66 offen offset:256 lds
ds_read_b64_tr_b16 a[182:183], v8 offset:9216
v_mfma_f32_16x16x32_bf16 v[180:183], a[100:103], a[184:187], v[180:183]
v_cvt_pk_bf16_f32 v155, v158, v159
v_cvt_pk_bf16_f32 v160, v160, v161
v_mfma_f32_16x16x32_bf16 v[180:183], a[116:119], a[188:191], v[180:183]
s_waitcnt vmcnt(15)
ds_read_b128 a[76:79], v24 offset:6144
v_cvt_pk_bf16_f32 v161, v162, v163
v_mfma_f32_16x16x32_bf16 v[176:179], a[112:115], a[188:191], v[176:179]
ds_read_b128 a[92:95], v25 offset:6144
v_cvt_pk_bf16_f32 v162, v164, v165
v_mfma_f32_16x16x32_bf16 v[176:179], a[96:99], a[184:187], v[176:179]
s_waitcnt lgkmcnt(12)
v_cvt_pk_bf16_f32 v163, v166, v167
v_cvt_pk_bf16_f32 v168, v168, v169
v_mfma_f32_16x16x32_bf16 v[192:195], a[160:163], a[96:99], v[192:195]
s_add_u32 s76, s0, 0x1000000
ds_read_b64_tr_b16 a[184:185], v9
v_cvt_pk_bf16_f32 v169, v170, v171
v_mfma_f32_16x16x32_bf16 v[192:195], a[164:167], a[112:115], v[192:195]
buffer_store_dwordx4 v[96:99], v1, s[4:7], s76 offen offset:2048 sc1
ds_read_b64_tr_b16 a[186:187], v9 offset:1024
v_mfma_f32_16x16x32_bf16 v[196:199], a[164:167], a[116:119], v[196:199]
s_add_u32 m0, s72, 0x9b00
ds_read_b64_tr_b16 a[188:189], v9 offset:8192
v_cvt_pk_bf16_f32 v170, v172, v173
v_mfma_f32_16x16x32_bf16 v[196:199], a[160:163], a[100:103], v[196:199]
buffer_load_dwordx4 v23, s[24:27], s66 offen offset:256 lds
ds_read_b64_tr_b16 a[190:191], v9 offset:9216
v_mfma_f32_16x16x32_bf16 v[200:203], a[160:163], a[104:107], v[200:203]
v_cvt_pk_bf16_f32 v171, v174, v175
v_cvt_pk_bf16_f32 v176, v176, v177
v_mfma_f32_16x16x32_bf16 v[200:203], a[164:167], a[120:123], v[200:203]
s_add_u32 m0, s72, 0xfffffe80
v_cvt_pk_bf16_f32 v177, v178, v179
v_cvt_pk_bf16_f32 v178, v180, v181
v_mfma_f32_16x16x32_bf16 v[204:207], a[164:167], a[124:127], v[204:207]
buffer_load_dwordx4 v22, s[24:27], s63 offen offset:384 lds
v_cvt_pk_bf16_f32 v179, v182, v183
v_mfma_f32_16x16x32_bf16 v[204:207], a[160:163], a[108:111], v[204:207]
s_waitcnt lgkmcnt(10)
v_cvt_pk_bf16_f32 v184, v184, v185
v_cvt_pk_bf16_f32 v185, v186, v187
v_mfma_f32_16x16x32_bf16 v[220:223], a[168:171], a[108:111], v[220:223]
s_add_u32 m0, s72, 0x280
ds_read_b64_tr_b16 a[160:161], v10
v_cvt_pk_bf16_f32 v186, v188, v189
v_mfma_f32_16x16x32_bf16 v[220:223], a[172:175], a[124:127], v[220:223]
buffer_load_dwordx4 v23, s[24:27], s63 offen offset:384 lds
ds_read_b64_tr_b16 a[162:163], v10 offset:1024
v_mfma_f32_16x16x32_bf16 v[216:219], a[172:175], a[120:123], v[216:219]
ds_read_b64_tr_b16 a[164:165], v10 offset:8192
v_cvt_pk_bf16_f32 v187, v190, v191
v_mfma_f32_16x16x32_bf16 v[216:219], a[168:171], a[104:107], v[216:219]
ds_read_b64_tr_b16 a[166:167], v10 offset:9216
v_accvgpr_read_b32 v33, a201
v_mfma_f32_16x16x32_bf16 v[212:215], a[168:171], a[100:103], v[212:215]
s_add_u32 m0, s72, 0x680
v_exp_f32_e64 v48, v48 clamp
v_mfma_f32_16x16x32_bf16 v[212:215], a[172:175], a[116:119], v[212:215]
buffer_load_dwordx4 v22, s[24:27], s64 offen offset:384 lds
v_add_f32 v44, v52, v48
v_mfma_f32_16x16x32_bf16 v[208:211], a[172:175], a[112:115], v[208:211]
s_waitcnt lgkmcnt(10)
v_exp_f32_e64 v49, v49 clamp
v_mfma_f32_16x16x32_bf16 v[208:211], a[168:171], a[96:99], v[208:211]
s_add_u32 s76, s0, 0x1002000
v_exp_f32_e64 v50, v50 clamp
v_mfma_f32_16x16x32_bf16 v[224:227], a[176:179], a[96:99], v[224:227]
buffer_store_dwordx4 v[104:107], v1, s[4:7], s76 offen offset:2048 sc1
v_add_f32 v45, v53, v49
v_mfma_f32_16x16x32_bf16 v[224:227], a[180:183], a[112:115], v[224:227]
s_add_u32 m0, s72, 0xa80
v_exp_f32_e64 v51, v51 clamp
v_mfma_f32_16x16x32_bf16 v[228:231], a[180:183], a[116:119], v[228:231]
buffer_load_dwordx4 v23, s[24:27], s64 offen offset:384 lds
v_add_f32 v46, v54, v50
v_mfma_f32_16x16x32_bf16 v[228:231], a[176:179], a[100:103], v[228:231]
v_add_f32 v47, v55, v51
v_cvt_pk_bf16_f32 v52, v44, v45
v_mfma_f32_16x16x32_bf16 v[232:235], a[176:179], a[104:107], v[232:235]
v_mul_f32 v192, s84, v192
v_mul_f32 v193, s84, v193
v_mfma_f32_16x16x32_bf16 v[232:235], a[180:183], a[120:123], v[232:235]
s_add_u32 m0, s72, 0xe80
v_mul_f32 v194, s84, v194
v_mul_f32 v195, s84, v195
v_mfma_f32_16x16x32_bf16 v[236:239], a[180:183], a[124:127], v[236:239]
buffer_load_dwordx4 v22, s[24:27], s65 offen offset:384 lds
v_mul_f32 v208, s84, v208
v_mfma_f32_16x16x32_bf16 v[236:239], a[176:179], a[108:111], v[236:239]
s_waitcnt lgkmcnt(4)
v_mul_f32 v209, s84, v209
v_mul_f32 v210, s84, v210
v_mfma_f32_16x16x32_bf16 v[252:255], a[184:187], a[108:111], v[252:255]
s_add_u32 m0, s72, 0x1280
v_mul_f32 v211, s84, v211
v_cvt_pk_bf16_f32 v192, v192, v193
v_mfma_f32_16x16x32_bf16 v[252:255], a[188:191], a[124:127], v[252:255]
buffer_load_dwordx4 v23, s[24:27], s65 offen offset:384 lds
v_cvt_pk_bf16_f32 v193, v194, v195
v_mfma_f32_16x16x32_bf16 v[248:251], a[188:191], a[120:123], v[248:251]
v_cvt_pk_bf16_f32 v194, v208, v209
v_cvt_pk_bf16_f32 v195, v210, v211
v_mfma_f32_16x16x32_bf16 v[248:251], a[184:187], a[104:107], v[248:251]
s_add_u32 s76, s0, 0
ds_read_b64_tr_b16 a[168:169], v11
v_cvt_pk_bf16_f32 v53, v46, v47
v_mfma_f32_16x16x32_bf16 v[244:247], a[184:187], a[100:103], v[244:247]
buffer_store_dwordx4 v[192:195], v1, s[4:7], s76 offen sc1
ds_read_b64_tr_b16 a[170:171], v11 offset:1024
v_mfma_f32_16x16x32_bf16 v[244:247], a[188:191], a[116:119], v[244:247]
s_add_u32 s76, s73, 0
v_accvgpr_write_b32 a194, v52
v_accvgpr_write_b32 a195, v53
v_mfma_f32_16x16x32_bf16 v[240:243], a[188:191], a[112:115], v[240:243]
s_waitcnt lgkmcnt(2)
buffer_store_dwordx4 v[192:195], v1, s[4:7], s76 offen sc1
ds_read_b64_tr_b16 a[172:173], v11 offset:8192
v_mfma_f32_16x16x32_bf16 v[240:243], a[184:187], a[96:99], v[240:243]
s_add_u32 m0, s72, 0x1680
ds_read_b64_tr_b16 a[174:175], v11 offset:9216
v_accvgpr_read_b32 v34, a202
v_mfma_f32_16x16x32_bf16 a[0:3], a[160:163], a[96:99], a[0:3]
buffer_load_dwordx4 v22, s[24:27], s66 offen offset:384 lds
v_accvgpr_read_b32 v35, a203
v_mfma_f32_16x16x32_bf16 a[0:3], a[164:167], a[112:115], a[0:3]
v_fma_f32 v36, v32, s85, v28
v_fma_f32 v37, v33, s85, v28
v_mfma_f32_16x16x32_bf16 a[4:7], a[164:167], a[116:119], a[4:7]
v_fma_f32 v38, v34, s85, v28
v_fma_f32 v39, v35, s85, v28
v_mfma_f32_16x16x32_bf16 a[4:7], a[160:163], a[100:103], a[4:7]
s_add_u32 m0, s72, 0x1a80
v_exp_f32_e64 v36, v36 clamp
v_mfma_f32_16x16x32_bf16 a[8:11], a[160:163], a[104:107], a[8:11]
buffer_load_dwordx4 v23, s[24:27], s66 offen offset:384 lds
v_max_f32 v40, s86, v32
v_mfma_f32_16x16x32_bf16 a[8:11], a[164:167], a[120:123], a[8:11]
v_exp_f32_e64 v37, v37 clamp
v_mfma_f32_16x16x32_bf16 a[12:15], a[164:167], a[124:127], a[12:15]
s_waitcnt lgkmcnt(1)
v_exp_f32_e64 v38, v38 clamp
v_exp_f32_e64 v39, v39 clamp
v_mfma_f32_16x16x32_bf16 a[12:15], a[160:163], a[108:111], a[12:15]
s_add_u32 s76, s0, 0x1000000
v_max_f32 v41, s86, v33
v_max_f32 v42, s86, v34
v_mfma_f32_16x16x32_bf16 a[28:31], a[168:171], a[108:111], a[28:31]
s_waitcnt lgkmcnt(0)
buffer_store_dwordx4 v[112:115], v1, s[4:7], s76 offen offset:3072 sc1
v_max_f32 v43, s86, v35
v_add_f32 v32, v40, v36
v_add_f32 v33, v41, v37
v_mfma_f32_16x16x32_bf16 a[28:31], a[172:175], a[124:127], a[28:31]
ds_read_b64_tr_b16 a[176:177], v12
ds_read_b64_tr_b16 a[178:179], v12 offset:1024
v_add_f32 v34, v42, v38
v_add_f32 v35, v43, v39
v_cvt_pk_bf16_f32 v40, v32, v33
v_mfma_f32_16x16x32_bf16 a[24:27], a[172:175], a[120:123], a[24:27]
ds_read_b64_tr_b16 a[180:181], v12 offset:8192
ds_read_b64_tr_b16 a[182:183], v12 offset:9216
v_cvt_pk_bf16_f32 v41, v34, v35
v_accvgpr_write_b32 a200, v40
v_accvgpr_write_b32 a201, v41
v_mfma_f32_16x16x32_bf16 a[24:27], a[168:171], a[104:107], a[24:27]
v_accvgpr_read_b32 v44, a204
v_accvgpr_read_b32 v45, a205
v_accvgpr_read_b32 v46, a206
v_mfma_f32_16x16x32_bf16 a[20:23], a[168:171], a[100:103], a[20:23]
v_accvgpr_read_b32 v47, a207
v_fma_f32 v48, v44, s85, v28
v_fma_f32 v49, v45, s85, v28
v_mfma_f32_16x16x32_bf16 a[20:23], a[172:175], a[116:119], a[20:23]
v_fma_f32 v50, v46, s85, v28
v_fma_f32 v51, v47, s85, v28
v_exp_f32_e64 v48, v48 clamp
v_mfma_f32_16x16x32_bf16 a[16:19], a[172:175], a[112:115], a[16:19]
v_exp_f32_e64 v49, v49 clamp
v_exp_f32_e64 v50, v50 clamp
v_exp_f32_e64 v51, v51 clamp
v_mfma_f32_16x16x32_bf16 a[16:19], a[168:171], a[96:99], a[16:19]
s_waitcnt lgkmcnt(2)
v_max_f32 v52, s86, v44
v_max_f32 v53, s86, v45
v_max_f32 v54, s86, v46
v_mfma_f32_16x16x32_bf16 a[32:35], a[176:179], a[96:99], a[32:35]
s_waitcnt lgkmcnt(0)
v_max_f32 v55, s86, v47
v_add_f32 v44, v52, v48
v_add_f32 v45, v53, v49
v_mfma_f32_16x16x32_bf16 a[32:35], a[180:183], a[112:115], a[32:35]
ds_read_b64_tr_b16 a[184:185], v13
ds_read_b64_tr_b16 a[186:187], v13 offset:1024
ds_read_b64_tr_b16 a[188:189], v13 offset:8192
ds_read_b64_tr_b16 a[190:191], v13 offset:9216
v_add_f32 v46, v54, v50
v_add_f32 v47, v55, v51
v_cvt_pk_bf16_f32 v52, v44, v45
v_mul_f32 v196, s84, v196
v_mul_f32 v197, s84, v197
v_mul_f32 v198, s84, v198
v_mul_f32 v199, s84, v199
v_mul_f32 v212, s84, v212
v_mul_f32 v213, s84, v213
v_mul_f32 v214, s84, v214
v_mul_f32 v215, s84, v215
v_cvt_pk_bf16_f32 v196, v196, v197
v_cvt_pk_bf16_f32 v197, v198, v199
v_cvt_pk_bf16_f32 v198, v212, v213
v_cvt_pk_bf16_f32 v199, v214, v215
v_mfma_f32_16x16x32_bf16 a[36:39], a[180:183], a[116:119], a[36:39]
s_add_u32 s76, s0, 0x1000
v_cvt_pk_bf16_f32 v53, v46, v47
v_accvgpr_write_b32 a202, v52
v_accvgpr_write_b32 a203, v53
v_mfma_f32_16x16x32_bf16 a[36:39], a[176:179], a[100:103], a[36:39]
buffer_store_dwordx4 v[196:199], v1, s[4:7], s76 offen sc1
v_accvgpr_read_b32 v32, a224
v_accvgpr_read_b32 v33, a225
v_accvgpr_read_b32 v34, a226
v_mfma_f32_16x16x32_bf16 a[40:43], a[176:179], a[104:107], a[40:43]
v_accvgpr_read_b32 v35, a227
v_cvt_pk_bf16_f32 v40, v32, v33
v_cvt_pk_bf16_f32 v41, v34, v35
v_mfma_f32_16x16x32_bf16 a[40:43], a[180:183], a[120:123], a[40:43]
v_accvgpr_write_b32 a224, v40
v_accvgpr_write_b32 a225, v41
v_accvgpr_read_b32 v44, a228
v_mfma_f32_16x16x32_bf16 a[44:47], a[180:183], a[124:127], a[44:47]
v_accvgpr_read_b32 v45, a229
v_accvgpr_read_b32 v46, a230
v_accvgpr_read_b32 v47, a231
v_mfma_f32_16x16x32_bf16 a[44:47], a[176:179], a[108:111], a[44:47]
s_waitcnt lgkmcnt(0)
v_cvt_pk_bf16_f32 v52, v44, v45
v_cvt_pk_bf16_f32 v53, v46, v47
v_accvgpr_write_b32 a226, v52
v_mfma_f32_16x16x32_bf16 a[60:63], a[184:187], a[108:111], a[60:63]
v_accvgpr_write_b32 a227, v53
v_accvgpr_read_b32 v32, a232
v_accvgpr_read_b32 v33, a233
s_barrier
v_mfma_f32_16x16x32_bf16 a[60:63], a[188:191], a[124:127], a[60:63]
v_accvgpr_read_b32 v34, a234
v_accvgpr_read_b32 v35, a235
v_cvt_pk_bf16_f32 v40, v32, v33
v_mfma_f32_16x16x32_bf16 a[56:59], a[188:191], a[120:123], a[56:59]
s_add_u32 m0, s71, 0x8000
v_cvt_pk_bf16_f32 v41, v34, v35
v_accvgpr_write_b32 a232, v40
v_accvgpr_write_b32 a233, v41
v_mfma_f32_16x16x32_bf16 a[56:59], a[184:187], a[104:107], a[56:59]
s_add_u32 s75, s70, 0x140000
v_accvgpr_read_b32 v44, a236
v_accvgpr_read_b32 v45, a237
v_accvgpr_read_b32 v46, a238
v_mfma_f32_16x16x32_bf16 a[52:55], a[184:187], a[100:103], a[52:55]
buffer_load_dwordx4 v4, s[28:31], s75 offen lds
v_accvgpr_read_b32 v47, a239
v_cvt_pk_bf16_f32 v52, v44, v45
v_cvt_pk_bf16_f32 v53, v46, v47
v_mfma_f32_16x16x32_bf16 a[52:55], a[188:191], a[116:119], a[52:55]
s_add_u32 m0, s71, 0x8400
v_accvgpr_write_b32 a234, v52
v_accvgpr_write_b32 a235, v53
v_mfma_f32_16x16x32_bf16 a[48:51], a[188:191], a[112:115], a[48:51]
s_add_u32 s75, s70, 0x148000
v_add_u32 v6, 0xffff8000, v6
ds_read_b64_tr_b16 a[160:161], v6
v_mfma_f32_16x16x32_bf16 a[48:51], a[184:187], a[96:99], a[48:51]
buffer_load_dwordx4 v4, s[28:31], s75 offen lds
ds_read_b64_tr_b16 a[162:163], v6 offset:1024
v_mfma_f32_16x16x32_bf16 a[196:199], a[192:195], a[224:227], 0
s_add_u32 s76, s0, 0x1002000
v_add_u32 v7, 0xffff8000, v7
ds_read_b64_tr_b16 a[164:165], v7
v_mfma_f32_16x16x32_bf16 a[204:207], a[192:195], a[240:243], 0
s_add_u32 m0, s71, 0xa000
buffer_store_dwordx4 v[120:123], v1, s[4:7], s76 offen offset:3072 sc1
ds_read_b64_tr_b16 a[166:167], v7 offset:1024
v_mfma_f32_16x16x32_bf16 a[228:231], a[208:211], a[224:227], 0
s_add_u32 s75, s70, 0x180000
v_add_u32 v8, 0xffff8000, v8
ds_read_b64_tr_b16 a[168:169], v8
v_mfma_f32_16x16x32_bf16 a[236:239], a[208:211], a[240:243], 0
buffer_load_dwordx4 v4, s[28:31], s75 offen lds
ds_read_b64_tr_b16 a[170:171], v8 offset:1024
v_mfma_f32_16x16x32_bf16 a[196:199], a[200:203], a[232:235], a[196:199]
v_add_u32 v9, 0xffff8000, v9
ds_read_b64_tr_b16 a[172:173], v9
v_mfma_f32_16x16x32_bf16 a[204:207], a[200:203], a[248:251], a[204:207]
s_add_u32 m0, s71, 0xa400
ds_read_b64_tr_b16 a[174:175], v9 offset:1024
v_add_u32 v10, 0xffff8000, v10
v_mfma_f32_16x16x32_bf16 a[228:231], a[216:219], a[232:235], a[228:231]
s_add_u32 s75, s70, 0x188000
ds_read_b64_tr_b16 a[176:177], v10
v_mul_f32 v200, s84, v200
v_mfma_f32_16x16x32_bf16 a[236:239], a[216:219], a[248:251], a[236:239]
s_waitcnt lgkmcnt(7)
ds_read_b64_tr_b16 a[178:179], v10 offset:1024
v_add_u32 v11, 0xffff8000, v11
v_mfma_f32_16x16x32_bf16 v[68:71], a[160:163], a[140:143], 0
s_waitcnt lgkmcnt(6)
ds_read_b64_tr_b16 a[180:181], v11
ds_read_b64_tr_b16 a[182:183], v11 offset:1024
buffer_load_dwordx4 v4, s[28:31], s75 offen lds
v_add_u32 v12, 0xffff8000, v12
v_mfma_f32_16x16x32_bf16 v[76:79], a[164:167], a[140:143], 0
s_waitcnt lgkmcnt(6)
ds_read_b64_tr_b16 a[184:185], v12
ds_read_b64_tr_b16 a[186:187], v12 offset:1024
v_add_u32 v13, 0xffff8000, v13
v_mfma_f32_16x16x32_bf16 v[84:87], a[168:171], a[140:143], 0
s_waitcnt lgkmcnt(6)
s_add_u32 s76, s73, 0x1000
ds_read_b64_tr_b16 a[188:189], v13
ds_read_b64_tr_b16 a[190:191], v13 offset:1024
v_mfma_f32_16x16x32_bf16 v[92:95], a[172:175], a[140:143], 0
s_waitcnt lgkmcnt(6)
buffer_store_dwordx4 v[196:199], v1, s[4:7], s76 offen sc1
v_mul_f32 v201, s84, v201
v_mul_f32 v202, s84, v202
v_mul_f32 v203, s84, v203
v_mul_f32 v216, s84, v216
v_mul_f32 v217, s84, v217
v_mul_f32 v218, s84, v218
v_mul_f32 v219, s84, v219
v_cvt_pk_bf16_f32 v200, v200, v201
v_cvt_pk_bf16_f32 v201, v202, v203
v_cvt_pk_bf16_f32 v202, v216, v217
v_cvt_pk_bf16_f32 v203, v218, v219
v_mfma_f32_16x16x32_bf16 v[100:103], a[176:179], a[140:143], 0
s_waitcnt lgkmcnt(4)
s_add_u32 s76, s0, 0x2000
s_waitcnt vmcnt(30)
ds_read_b128 a[96:99], v24 offset:32768
v_mul_f32 v204, s84, v204
v_mfma_f32_16x16x32_bf16 v[108:111], a[180:183], a[140:143], 0
s_waitcnt lgkmcnt(3)
buffer_store_dwordx4 v[200:203], v1, s[4:7], s76 offen sc1
ds_read_b128 a[112:115], v25 offset:32768
v_mfma_f32_16x16x32_bf16 v[116:119], a[184:187], a[140:143], 0
s_waitcnt lgkmcnt(2)
v_mul_f32 v205, s84, v205
v_mul_f32 v206, s84, v206
v_mfma_f32_16x16x32_bf16 v[124:127], a[188:191], a[140:143], 0
v_mul_f32 v207, s84, v207
v_mul_f32 v220, s84, v220
v_mfma_f32_16x16x32_bf16 v[132:135], a[160:163], a[136:139], 0
v_mul_f32 v221, s84, v221
v_mul_f32 v222, s84, v222
v_mfma_f32_16x16x32_bf16 v[140:143], a[164:167], a[136:139], 0
v_mul_f32 v223, s84, v223
v_cvt_pk_bf16_f32 v204, v204, v205
v_mfma_f32_16x16x32_bf16 v[148:151], a[168:171], a[136:139], 0
v_cvt_pk_bf16_f32 v205, v206, v207
v_cvt_pk_bf16_f32 v206, v220, v221
v_mfma_f32_16x16x32_bf16 v[156:159], a[172:175], a[136:139], 0
v_cvt_pk_bf16_f32 v207, v222, v223
v_mul_f32 v224, s84, v224
v_mfma_f32_16x16x32_bf16 v[164:167], a[176:179], a[136:139], 0
v_mul_f32 v225, s84, v225
v_mul_f32 v226, s84, v226
v_mfma_f32_16x16x32_bf16 v[172:175], a[180:183], a[136:139], 0
v_mul_f32 v227, s84, v227
v_mul_f32 v240, s84, v240
v_mfma_f32_16x16x32_bf16 v[180:183], a[184:187], a[136:139], 0
s_add_u32 s76, s0, 0x1001000
v_mul_f32 v241, s84, v241
v_mul_f32 v242, s84, v242
v_mfma_f32_16x16x32_bf16 v[188:191], a[188:191], a[136:139], 0
buffer_store_dwordx4 v[128:131], v1, s[4:7], s76 offen sc1
v_mul_f32 v243, s84, v243
v_mfma_f32_16x16x32_bf16 v[208:211], a[160:163], a[132:135], 0
s_add_u32 m0, s72, 0x7e00
v_cvt_pk_bf16_f32 v224, v224, v225
v_cvt_pk_bf16_f32 v225, v226, v227
v_mfma_f32_16x16x32_bf16 v[212:215], a[164:167], a[132:135], 0
s_waitcnt lgkmcnt(0)
buffer_load_dwordx4 v22, s[24:27], s63 offen offset:512 lds
v_cvt_pk_bf16_f32 v226, v240, v241
v_mfma_f32_16x16x32_bf16 v[216:219], a[168:171], a[132:135], 0
v_cvt_pk_bf16_f32 v227, v242, v243
v_mul_f32 v228, s84, v228
v_mfma_f32_16x16x32_bf16 v[220:223], a[172:175], a[132:135], 0
s_add_u32 m0, s72, 0x8200
v_mul_f32 v229, s84, v229
v_mul_f32 v230, s84, v230
v_mfma_f32_16x16x32_bf16 v[240:243], a[176:179], a[132:135], 0
v_mul_f32 v231, s84, v231
v_mul_f32 v244, s84, v244
v_mul_f32 v245, s84, v245
v_mul_f32 v246, s84, v246
v_mul_f32 v247, s84, v247
v_cvt_pk_bf16_f32 v228, v228, v229
v_cvt_pk_bf16_f32 v229, v230, v231
v_cvt_pk_bf16_f32 v230, v244, v245
v_cvt_pk_bf16_f32 v231, v246, v247
v_mfma_f32_16x16x32_bf16 v[244:247], a[180:183], a[132:135], 0
buffer_load_dwordx4 v23, s[24:27], s63 offen offset:512 lds
v_mul_f32 v232, s84, v232
v_mul_f32 v233, s84, v233
v_mul_f32 v234, s84, v234
v_mul_f32 v235, s84, v235
v_mul_f32 v248, s84, v248
v_mul_f32 v249, s84, v249
v_mul_f32 v250, s84, v250
v_mul_f32 v251, s84, v251
v_cvt_pk_bf16_f32 v232, v232, v233
v_cvt_pk_bf16_f32 v233, v234, v235
v_cvt_pk_bf16_f32 v234, v248, v249
v_cvt_pk_bf16_f32 v235, v250, v251
v_mfma_f32_16x16x32_bf16 v[248:251], a[184:187], a[132:135], 0
v_mul_f32 v236, s84, v236
v_mul_f32 v237, s84, v237
v_mul_f32 v238, s84, v238
v_mul_f32 v239, s84, v239
v_mul_f32 v252, s84, v252
v_mul_f32 v253, s84, v253
v_mul_f32 v254, s84, v254
v_mul_f32 v255, s84, v255
v_cvt_pk_bf16_f32 v236, v236, v237
v_cvt_pk_bf16_f32 v237, v238, v239
v_cvt_pk_bf16_f32 v238, v252, v253
v_cvt_pk_bf16_f32 v239, v254, v255
v_mfma_f32_16x16x32_bf16 v[252:255], a[188:191], a[132:135], 0
s_waitcnt vmcnt(30)
ds_read_b128 a[100:103], v24 offset:34816
v_accvgpr_write_b32 a192, v64
v_mfma_f32_16x16x32_bf16 v[32:35], a[160:163], a[128:131], 0
ds_read_b64_tr_b16 a[160:161], v6 offset:8192
v_accvgpr_write_b32 a193, v65
v_mfma_f32_16x16x32_bf16 v[36:39], a[164:167], a[128:131], 0
ds_read_b64_tr_b16 a[162:163], v6 offset:9216
v_accvgpr_write_b32 a194, v66
v_mfma_f32_16x16x32_bf16 v[40:43], a[168:171], a[128:131], 0
ds_read_b128 a[116:119], v25 offset:34816
ds_read_b64_tr_b16 a[164:165], v6 offset:16384
ds_read_b64_tr_b16 a[166:167], v6 offset:17408
v_mfma_f32_16x16x32_bf16 v[44:47], a[172:175], a[128:131], 0
s_add_u32 s76, s0, 0x3000
ds_read_b64_tr_b16 a[168:169], v7 offset:8192
v_accvgpr_write_b32 a195, v67
v_mfma_f32_16x16x32_bf16 v[48:51], a[176:179], a[128:131], 0
buffer_store_dwordx4 v[204:207], v1, s[4:7], s76 offen sc1
ds_read_b64_tr_b16 a[170:171], v7 offset:9216
v_mfma_f32_16x16x32_bf16 v[52:55], a[180:183], a[128:131], 0
ds_read_b64_tr_b16 a[172:173], v7 offset:16384
v_accvgpr_write_b32 a200, v72
v_mfma_f32_16x16x32_bf16 v[56:59], a[184:187], a[128:131], 0
ds_read_b64_tr_b16 a[174:175], v7 offset:17408
v_accvgpr_write_b32 a201, v73
v_mfma_f32_16x16x32_bf16 v[60:63], a[188:191], a[128:131], 0
s_waitcnt lgkmcnt(7)
ds_read_b64_tr_b16 a[176:177], v8 offset:8192
v_accvgpr_write_b32 a202, v74
v_mfma_f32_16x16x32_bf16 v[32:35], a[160:163], a[144:147], v[32:35]
s_waitcnt lgkmcnt(5)
ds_read_b64_tr_b16 a[178:179], v8 offset:9216
v_accvgpr_write_b32 a203, v75
v_mfma_f32_16x16x32_bf16 v[32:35], a[164:167], a[64:67], v[32:35]
s_add_u32 m0, s72, 0x8600
ds_read_b64_tr_b16 a[180:181], v8 offset:16384
v_accvgpr_write_b32 a208, v80
v_mfma_f32_16x16x32_bf16 v[208:211], a[164:167], a[68:71], v[208:211]
buffer_load_dwordx4 v22, s[24:27], s64 offen offset:512 lds
ds_read_b64_tr_b16 a[182:183], v8 offset:17408
v_mfma_f32_16x16x32_bf16 v[208:211], a[160:163], a[148:151], v[208:211]
ds_read_b64_tr_b16 a[184:185], v9 offset:8192
v_accvgpr_write_b32 a209, v81
v_mfma_f32_16x16x32_bf16 v[132:135], a[160:163], a[152:155], v[132:135]
s_add_u32 m0, s72, 0x8a00
s_waitcnt vmcnt(29)
ds_read_b128 a[104:107], v24 offset:36864
v_accvgpr_write_b32 a210, v82
v_mfma_f32_16x16x32_bf16 v[132:135], a[164:167], a[72:75], v[132:135]
buffer_load_dwordx4 v23, s[24:27], s64 offen offset:512 lds
ds_read_b128 a[120:123], v25 offset:36864
v_mfma_f32_16x16x32_bf16 v[68:71], a[164:167], a[76:79], v[68:71]
s_waitcnt lgkmcnt(7)
ds_read_b64_tr_b16 a[186:187], v9 offset:9216
v_accvgpr_write_b32 a211, v83
v_mfma_f32_16x16x32_bf16 v[68:71], a[160:163], a[156:159], v[68:71]
s_add_u32 s76, s0, 0x1003000
ds_read_b64_tr_b16 a[188:189], v9 offset:16384
v_accvgpr_write_b32 a216, v88
v_mfma_f32_16x16x32_bf16 v[76:79], a[168:171], a[156:159], v[76:79]
buffer_store_dwordx4 v[136:139], v1, s[4:7], s76 offen sc1
ds_read_b64_tr_b16 a[190:191], v9 offset:17408
v_mfma_f32_16x16x32_bf16 v[76:79], a[172:175], a[76:79], v[76:79]
ds_read_b64_tr_b16 a[160:161], v10 offset:8192
v_accvgpr_write_b32 a217, v89
v_mfma_f32_16x16x32_bf16 v[140:143], a[172:175], a[72:75], v[140:143]
ds_read_b64_tr_b16 a[162:163], v10 offset:9216
v_accvgpr_write_b32 a218, v90
v_mfma_f32_16x16x32_bf16 v[140:143], a[168:171], a[152:155], v[140:143]
ds_read_b64_tr_b16 a[164:165], v10 offset:16384
v_accvgpr_write_b32 a219, v91
v_mfma_f32_16x16x32_bf16 v[212:215], a[168:171], a[148:151], v[212:215]
ds_read_b64_tr_b16 a[166:167], v10 offset:17408
v_accvgpr_write_b32 a224, v96
v_mfma_f32_16x16x32_bf16 v[212:215], a[172:175], a[68:71], v[212:215]
v_accvgpr_write_b32 a225, v97
v_accvgpr_write_b32 a226, v98
v_mfma_f32_16x16x32_bf16 v[36:39], a[172:175], a[64:67], v[36:39]
s_add_u32 m0, s72, 0x8e00
v_accvgpr_write_b32 a227, v99
v_accvgpr_write_b32 a232, v104
v_mfma_f32_16x16x32_bf16 v[36:39], a[168:171], a[144:147], v[36:39]
s_waitcnt lgkmcnt(7)
buffer_load_dwordx4 v22, s[24:27], s65 offen offset:512 lds
v_accvgpr_write_b32 a233, v105
v_mfma_f32_16x16x32_bf16 v[40:43], a[176:179], a[144:147], v[40:43]
ds_read_b64_tr_b16 a[168:169], v11 offset:8192
v_accvgpr_write_b32 a234, v106
v_mfma_f32_16x16x32_bf16 v[40:43], a[180:183], a[64:67], v[40:43]
s_add_u32 m0, s72, 0x9200
ds_read_b64_tr_b16 a[170:171], v11 offset:9216
v_accvgpr_write_b32 a235, v107
v_mfma_f32_16x16x32_bf16 v[216:219], a[180:183], a[68:71], v[216:219]
buffer_load_dwordx4 v23, s[24:27], s65 offen offset:512 lds
ds_read_b64_tr_b16 a[172:173], v11 offset:16384
v_mfma_f32_16x16x32_bf16 v[216:219], a[176:179], a[148:151], v[216:219]
s_waitcnt vmcnt(29)
ds_read_b128 a[108:111], v24 offset:38912
v_accvgpr_write_b32 a240, v112
v_mfma_f32_16x16x32_bf16 v[148:151], a[176:179], a[152:155], v[148:151]
s_add_u32 s76, s0, 0
ds_read_b128 a[124:127], v25 offset:38912
v_accvgpr_write_b32 a241, v113
v_mfma_f32_16x16x32_bf16 v[148:151], a[180:183], a[72:75], v[148:151]
buffer_store_dwordx4 v[224:227], v1, s[4:7], s76 offen offset:1024 sc1
ds_read_b64_tr_b16 a[174:175], v11 offset:17408
v_mfma_f32_16x16x32_bf16 v[84:87], a[180:183], a[76:79], v[84:87]
v_accvgpr_write_b32 a242, v114
v_accvgpr_write_b32 a243, v115
v_mfma_f32_16x16x32_bf16 v[84:87], a[176:179], a[156:159], v[84:87]
s_waitcnt lgkmcnt(10)
v_accvgpr_write_b32 a248, v120
v_accvgpr_write_b32 a249, v121
v_mfma_f32_16x16x32_bf16 v[92:95], a[184:187], a[156:159], v[92:95]
v_accvgpr_write_b32 a250, v122
v_accvgpr_write_b32 a251, v123
v_mfma_f32_16x16x32_bf16 v[92:95], a[188:191], a[76:79], v[92:95]
v_accvgpr_mov_b32 a230, a236
v_accvgpr_mov_b32 a231, a237
s_lshl_b32 s87, s48, 10
v_mfma_f32_16x16x32_bf16 v[156:159], a[188:191], a[72:75], v[156:159]
s_add_u32 s87, s87, 0xe000
v_add_u32 v27, s87, v1
ds_write_b128 v27, a[196:199]
v_mfma_f32_16x16x32_bf16 v[156:159], a[184:187], a[152:155], v[156:159]
s_add_u32 s76, s73, 0x2000
ds_write_b128 v27, a[204:207] offset:32768
ds_write_b128 v27, a[228:231] offset:36864
v_mfma_f32_16x16x32_bf16 v[220:223], a[184:187], a[148:151], v[220:223]
buffer_store_dwordx4 v[200:203], v1, s[4:7], s76 offen sc1
ds_read_b64_tr_b16 a[176:177], v12 offset:8192
v_mfma_f32_16x16x32_bf16 v[220:223], a[188:191], a[68:71], v[220:223]
s_add_u32 m0, s72, 0x9600
ds_read_b64_tr_b16 a[178:179], v12 offset:9216
v_mfma_f32_16x16x32_bf16 v[44:47], a[188:191], a[64:67], v[44:47]
s_waitcnt lgkmcnt(6)
buffer_load_dwordx4 v22, s[24:27], s66 offen offset:512 lds
ds_read_b64_tr_b16 a[180:181], v12 offset:16384
v_mfma_f32_16x16x32_bf16 v[44:47], a[184:187], a[144:147], v[44:47]
ds_read_b64_tr_b16 a[182:183], v12 offset:17408
v_mfma_f32_16x16x32_bf16 v[48:51], a[160:163], a[144:147], v[48:51]
s_add_u32 s76, s0, 0x1001000
ds_read_b64_tr_b16 a[184:185], v13 offset:8192
v_mfma_f32_16x16x32_bf16 v[48:51], a[164:167], a[64:67], v[48:51]
buffer_store_dwordx4 v[144:147], v1, s[4:7], s76 offen offset:1024 sc1
ds_read_b64_tr_b16 a[186:187], v13 offset:9216
v_mfma_f32_16x16x32_bf16 v[240:243], a[164:167], a[68:71], v[240:243]
s_add_u32 m0, s72, 0x9a00
ds_read_b64_tr_b16 a[188:189], v13 offset:16384
v_mfma_f32_16x16x32_bf16 v[240:243], a[160:163], a[148:151], v[240:243]
buffer_load_dwordx4 v23, s[24:27], s66 offen offset:512 lds
ds_read_b64_tr_b16 a[190:191], v13 offset:17408
v_mfma_f32_16x16x32_bf16 v[164:167], a[160:163], a[152:155], v[164:167]
v_mfma_f32_16x16x32_bf16 v[164:167], a[164:167], a[72:75], v[164:167]
v_mfma_f32_16x16x32_bf16 v[100:103], a[164:167], a[76:79], v[100:103]
s_min_u32 s87, s48, 2
s_lshl_b32 s87, s87, 12
s_add_u32 s87, s87, 0x15000
s_cmp_eq_u32 s48, 0
s_cselect_b32 s87, 0xe000, s87
v_add_u32 v27, s87, v1
v_mfma_f32_16x16x32_bf16 v[100:103], a[160:163], a[156:159], v[100:103]
v_mfma_f32_16x16x32_bf16 v[108:111], a[168:171], a[156:159], v[108:111]
s_waitcnt lgkmcnt(11)
v_mfma_f32_16x16x32_bf16 v[108:111], a[172:175], a[76:79], v[108:111]
v_mfma_f32_16x16x32_bf16 v[172:175], a[172:175], a[72:75], v[172:175]
v_mfma_f32_16x16x32_bf16 v[172:175], a[168:171], a[152:155], v[172:175]
s_add_u32 s76, s0, 0x1000
v_mfma_f32_16x16x32_bf16 v[244:247], a[168:171], a[148:151], v[244:247]
buffer_store_dwordx4 v[228:231], v1, s[4:7], s76 offen offset:1024 sc1
v_mfma_f32_16x16x32_bf16 v[244:247], a[172:175], a[68:71], v[244:247]
v_mfma_f32_16x16x32_bf16 v[52:55], a[172:175], a[64:67], v[52:55]
v_mfma_f32_16x16x32_bf16 v[52:55], a[168:171], a[144:147], v[52:55]
s_waitcnt lgkmcnt(0)
v_mfma_f32_16x16x32_bf16 v[56:59], a[176:179], a[144:147], v[56:59]
s_barrier
v_mfma_f32_16x16x32_bf16 v[56:59], a[180:183], a[64:67], v[56:59]
s_add_u32 m0, s71, 0
v_add_u32 v6, 0x8000, v6
ds_read_b64_tr_b16 a[160:161], v6 offset:32768
v_mfma_f32_16x16x32_bf16 v[248:251], a[180:183], a[68:71], v[248:251]
s_add_u32 s75, s70, 0x1c0000
ds_read_b64_tr_b16 a[162:163], v6 offset:33792
v_accvgpr_write_b32 a196, v128
v_mfma_f32_16x16x32_bf16 v[248:251], a[176:179], a[148:151], v[248:251]
buffer_load_dwordx4 v4, s[28:31], s75 offen lds
ds_read_b64_tr_b16 a[164:165], v6 offset:40960
v_mfma_f32_16x16x32_bf16 v[180:183], a[176:179], a[152:155], v[180:183]
s_add_u32 m0, s71, 0x400
ds_read_b64_tr_b16 a[166:167], v6 offset:41984
v_add_u32 v7, 0x8000, v7
v_mfma_f32_16x16x32_bf16 v[180:183], a[180:183], a[72:75], v[180:183]
s_add_u32 s75, s70, 0x1c8000
ds_read_b64_tr_b16 a[168:169], v7 offset:32768
v_accvgpr_write_b32 a197, v129
v_mfma_f32_16x16x32_bf16 v[116:119], a[180:183], a[76:79], v[116:119]
buffer_load_dwordx4 v4, s[28:31], s75 offen lds
ds_read_b64_tr_b16 a[170:171], v7 offset:33792
v_mfma_f32_16x16x32_bf16 v[116:119], a[176:179], a[156:159], v[116:119]
ds_read_b64_tr_b16 a[172:173], v7 offset:40960
v_accvgpr_write_b32 a198, v130
v_mfma_f32_16x16x32_bf16 v[124:127], a[184:187], a[156:159], v[124:127]
s_add_u32 s76, s0, 0x1003000
ds_read_b64_tr_b16 a[174:175], v7 offset:41984
v_add_u32 v8, 0x8000, v8
v_mfma_f32_16x16x32_bf16 v[124:127], a[188:191], a[76:79], v[124:127]
s_add_u32 m0, s71, 0x2000
buffer_store_dwordx4 v[152:155], v1, s[4:7], s76 offen offset:1024 sc1
ds_read_b64_tr_b16 a[176:177], v8 offset:32768
v_mfma_f32_16x16x32_bf16 v[188:191], a[188:191], a[72:75], v[188:191]
s_add_u32 s75, s70, 0x200000
ds_read_b64_tr_b16 a[178:179], v8 offset:33792
v_accvgpr_write_b32 a199, v131
v_mfma_f32_16x16x32_bf16 v[188:191], a[184:187], a[152:155], v[188:191]
buffer_load_dwordx4 v4, s[28:31], s75 offen lds
ds_read_b64_tr_b16 a[180:181], v8 offset:40960
v_mfma_f32_16x16x32_bf16 v[252:255], a[184:187], a[148:151], v[252:255]
ds_read_b64_tr_b16 a[182:183], v8 offset:41984
v_accvgpr_write_b32 a228, v136
v_mfma_f32_16x16x32_bf16 v[252:255], a[188:191], a[68:71], v[252:255]
s_add_u32 m0, s71, 0x2400
v_accvgpr_write_b32 a229, v137
v_accvgpr_write_b32 a230, v138
v_mfma_f32_16x16x32_bf16 v[60:63], a[188:191], a[64:67], v[60:63]
s_add_u32 s75, s70, 0x208000
v_accvgpr_write_b32 a231, v139
v_accvgpr_write_b32 a204, v144
v_mfma_f32_16x16x32_bf16 v[60:63], a[184:187], a[144:147], v[60:63]
s_waitcnt lgkmcnt(8)
buffer_load_dwordx4 v4, s[28:31], s75 offen lds
v_accvgpr_write_b32 a205, v145
v_mfma_f32_16x16x32_bf16 v[32:35], a[160:163], a[80:83], v[32:35]
s_add_u32 m0, s71, 0x4000
s_waitcnt vmcnt(29)
ds_read_b128 a[128:131], v24
v_accvgpr_write_b32 a206, v146
v_mfma_f32_16x16x32_bf16 v[32:35], a[164:167], a[96:99], v[32:35]
s_add_u32 s75, s70, 0x240000
ds_read_b128 a[144:147], v25
v_accvgpr_write_b32 a207, v147
v_mfma_f32_16x16x32_bf16 v[208:211], a[164:167], a[100:103], v[208:211]
ds_read_b128 a[132:135], v24 offset:2048
buffer_load_dwordx4 v4, s[28:31], s75 offen lds
v_mfma_f32_16x16x32_bf16 v[208:211], a[160:163], a[84:87], v[208:211]
ds_read_b128 a[148:151], v25 offset:2048
ds_read_b128 a[136:139], v24 offset:4096
ds_read_b128 a[152:155], v25 offset:4096
ds_read_b128 a[140:143], v24 offset:6144
ds_read_b128 a[156:159], v25 offset:6144
v_mfma_f32_16x16x32_bf16 v[132:135], a[160:163], a[88:91], v[132:135]
v_accvgpr_write_b32 a236, v152
v_accvgpr_write_b32 a237, v153
v_mfma_f32_16x16x32_bf16 v[132:135], a[164:167], a[104:107], v[132:135]
s_add_u32 s76, s0, 0x2000
v_accvgpr_write_b32 a238, v154
v_accvgpr_write_b32 a239, v155
v_mfma_f32_16x16x32_bf16 v[68:71], a[164:167], a[108:111], v[68:71]
s_add_u32 m0, s71, 0x4400
buffer_store_dwordx4 v[232:235], v1, s[4:7], s76 offen offset:1024 sc1
ds_read_b128 v[96:99], v27
v_mfma_f32_16x16x32_bf16 v[68:71], a[160:163], a[92:95], v[68:71]
s_waitcnt lgkmcnt(13)
s_add_u32 s75, s70, 0x248000
ds_read_b128 v[104:107], v27 offset:1024
ds_read_b128 v[112:115], v27 offset:2048
v_mfma_f32_16x16x32_bf16 v[76:79], a[168:171], a[92:95], v[76:79]
buffer_load_dwordx4 v4, s[28:31], s75 offen lds
ds_read_b128 v[120:123], v27 offset:3072
v_mfma_f32_16x16x32_bf16 v[76:79], a[172:175], a[108:111], v[76:79]
s_add_u32 m0, s71, 0x6000
s_waitcnt lgkmcnt(2)
v_add_f32 v96, v96, v104
v_add_f32 v97, v97, v105
v_mfma_f32_16x16x32_bf16 v[140:143], a[172:175], a[104:107], v[140:143]
s_add_u32 s75, s70, 0x280000
v_add_f32 v98, v98, v106
v_add_f32 v99, v99, v107
v_mfma_f32_16x16x32_bf16 v[140:143], a[168:171], a[88:91], v[140:143]
buffer_load_dwordx4 v4, s[28:31], s75 offen lds
s_waitcnt lgkmcnt(1)
v_add_f32 v96, v96, v112
v_mfma_f32_16x16x32_bf16 v[212:215], a[168:171], a[84:87], v[212:215]
s_add_u32 m0, s71, 0x6400
v_add_f32 v97, v97, v113
v_add_f32 v98, v98, v114
v_mfma_f32_16x16x32_bf16 v[212:215], a[172:175], a[100:103], v[212:215]
s_add_u32 s75, s70, 0x288000
v_add_f32 v99, v99, v115
s_waitcnt lgkmcnt(0)
v_add_f32 v96, v96, v120
v_mfma_f32_16x16x32_bf16 v[36:39], a[172:175], a[96:99], v[36:39]
v_add_f32 v97, v97, v121
v_add_f32 v98, v98, v122
v_mfma_f32_16x16x32_bf16 v[36:39], a[168:171], a[80:83], v[36:39]
buffer_load_dwordx4 v4, s[28:31], s75 offen lds
v_add_f32 v99, v99, v123
s_lshl_b32 s87, s53, 3
s_add_u32 s87, s87, s54
s_lshl_b32 s87, s87, 2
s_min_u32 s78, s48, 2
s_add_u32 s87, s87, s78
s_lshl_b32 s87, s87, 10
s_add_u32 s87, s87, 0x4c00000
buffer_store_dwordx4 v[96:99], v1, s[4:7], s87 offen sc1
v_mfma_f32_16x16x32_bf16 v[40:43], a[176:179], a[80:83], v[40:43]
v_add_u32 v9, 0x8000, v9
ds_read_b64_tr_b16 a[184:185], v9 offset:32768
v_mfma_f32_16x16x32_bf16 v[40:43], a[180:183], a[96:99], v[40:43]
s_add_u32 s76, s0, 0x1001000
ds_read_b64_tr_b16 a[186:187], v9 offset:33792
v_mfma_f32_16x16x32_bf16 v[216:219], a[180:183], a[100:103], v[216:219]
ds_read_b64_tr_b16 a[188:189], v9 offset:40960
ds_read_b64_tr_b16 a[190:191], v9 offset:41984
v_mfma_f32_16x16x32_bf16 v[216:219], a[176:179], a[84:87], v[216:219]
s_add_u32 m0, s72, 0xfffffd80
buffer_store_dwordx4 v[160:163], v1, s[4:7], s76 offen offset:2048 sc1
v_add_u32 v10, 0x8000, v10
v_mfma_f32_16x16x32_bf16 v[148:151], a[176:179], a[88:91], v[148:151]
buffer_load_dwordx4 v22, s[24:27], s63 offen offset:640 lds
ds_read_b64_tr_b16 a[160:161], v10 offset:32768
v_mfma_f32_16x16x32_bf16 v[148:151], a[180:183], a[104:107], v[148:151]
ds_read_b64_tr_b16 a[162:163], v10 offset:33792
v_accvgpr_read_b32 v64, a0
v_mfma_f32_16x16x32_bf16 v[84:87], a[180:183], a[108:111], v[84:87]
s_add_u32 m0, s72, 0x180
ds_read_b64_tr_b16 a[164:165], v10 offset:40960
v_accvgpr_read_b32 v65, a1
v_mfma_f32_16x16x32_bf16 v[84:87], a[176:179], a[92:95], v[84:87]
s_waitcnt lgkmcnt(5)
buffer_load_dwordx4 v23, s[24:27], s63 offen offset:640 lds
ds_read_b64_tr_b16 a[166:167], v10 offset:41984
v_mfma_f32_16x16x32_bf16 v[92:95], a[184:187], a[92:95], v[92:95]
s_waitcnt lgkmcnt(4)
v_add_u32 v11, 0x8000, v11
ds_read_b64_tr_b16 a[168:169], v11 offset:32768
v_mfma_f32_16x16x32_bf16 v[92:95], a[188:191], a[108:111], v[92:95]
ds_read_b64_tr_b16 a[170:171], v11 offset:33792
v_accvgpr_read_b32 v66, a2
v_mfma_f32_16x16x32_bf16 v[156:159], a[188:191], a[104:107], v[156:159]
s_add_u32 s76, s73, 0x3000
ds_read_b64_tr_b16 a[172:173], v11 offset:40960
v_accvgpr_read_b32 v67, a3
v_mfma_f32_16x16x32_bf16 v[156:159], a[184:187], a[88:91], v[156:159]
buffer_store_dwordx4 v[204:207], v1, s[4:7], s76 offen sc1
ds_read_b64_tr_b16 a[174:175], v11 offset:41984
v_mfma_f32_16x16x32_bf16 v[220:223], a[184:187], a[84:87], v[220:223]
s_add_u32 s76, s0, 0x3000
v_add_u32 v12, 0x8000, v12
ds_read_b64_tr_b16 a[176:177], v12 offset:32768
v_mfma_f32_16x16x32_bf16 v[220:223], a[188:191], a[100:103], v[220:223]
buffer_store_dwordx4 v[236:239], v1, s[4:7], s76 offen offset:1024 sc1
ds_read_b64_tr_b16 a[178:179], v12 offset:33792
v_mfma_f32_16x16x32_bf16 v[44:47], a[188:191], a[96:99], v[44:47]
s_add_u32 m0, s72, 0x580
ds_read_b64_tr_b16 a[180:181], v12 offset:40960
v_accvgpr_read_b32 v112, a16
v_mfma_f32_16x16x32_bf16 v[44:47], a[184:187], a[80:83], v[44:47]
s_waitcnt lgkmcnt(7)
buffer_load_dwordx4 v22, s[24:27], s64 offen offset:640 lds
ds_read_b64_tr_b16 a[182:183], v12 offset:41984
v_mfma_f32_16x16x32_bf16 v[48:51], a[160:163], a[80:83], v[48:51]
v_add_u32 v13, 0x8000, v13
ds_read_b64_tr_b16 a[184:185], v13 offset:32768
v_mfma_f32_16x16x32_bf16 v[48:51], a[164:167], a[96:99], v[48:51]
s_add_u32 m0, s72, 0x980
ds_read_b64_tr_b16 a[186:187], v13 offset:33792
v_accvgpr_read_b32 v113, a17
v_mfma_f32_16x16x32_bf16 v[240:243], a[164:167], a[100:103], v[240:243]
buffer_load_dwordx4 v23, s[24:27], s64 offen offset:640 lds
ds_read_b64_tr_b16 a[188:189], v13 offset:40960
v_mfma_f32_16x16x32_bf16 v[240:243], a[160:163], a[84:87], v[240:243]
ds_read_b64_tr_b16 a[190:191], v13 offset:41984
v_accvgpr_read_b32 v114, a18
v_mfma_f32_16x16x32_bf16 v[164:167], a[160:163], a[88:91], v[164:167]
s_add_u32 m0, s72, 0xd80
v_accvgpr_read_b32 v115, a19
v_mul_f32 v64, s84, v64
v_mfma_f32_16x16x32_bf16 v[164:167], a[164:167], a[104:107], v[164:167]
buffer_load_dwordx4 v22, s[24:27], s65 offen offset:640 lds
v_mul_f32 v65, s84, v65
v_mfma_f32_16x16x32_bf16 v[100:103], a[164:167], a[108:111], v[100:103]
v_mul_f32 v66, s84, v66
v_mul_f32 v67, s84, v67
v_mfma_f32_16x16x32_bf16 v[100:103], a[160:163], a[92:95], v[100:103]
s_waitcnt lgkmcnt(8)
v_mul_f32 v112, s84, v112
v_mul_f32 v113, s84, v113
v_mfma_f32_16x16x32_bf16 v[108:111], a[168:171], a[92:95], v[108:111]
s_add_u32 s76, s0, 0x1003000
v_mul_f32 v114, s84, v114
v_mul_f32 v115, s84, v115
v_mfma_f32_16x16x32_bf16 v[108:111], a[172:175], a[108:111], v[108:111]
buffer_store_dwordx4 v[168:171], v1, s[4:7], s76 offen offset:2048 sc1
v_cvt_pk_bf16_f32 v64, v64, v65
v_mfma_f32_16x16x32_bf16 v[172:175], a[172:175], a[104:107], v[172:175]
s_add_u32 m0, s72, 0x1180
v_cvt_pk_bf16_f32 v65, v66, v67
v_cvt_pk_bf16_f32 v66, v112, v113
v_mfma_f32_16x16x32_bf16 v[172:175], a[168:171], a[88:91], v[172:175]
buffer_load_dwordx4 v23, s[24:27], s65 offen offset:640 lds
v_cvt_pk_bf16_f32 v67, v114, v115
v_mfma_f32_16x16x32_bf16 v[244:247], a[168:171], a[84:87], v[244:247]
v_accvgpr_read_b32 v72, a4
v_accvgpr_read_b32 v73, a5
v_mfma_f32_16x16x32_bf16 v[244:247], a[172:175], a[100:103], v[244:247]
s_add_u32 m0, s72, 0x1580
v_accvgpr_read_b32 v74, a6
v_accvgpr_read_b32 v75, a7
v_mfma_f32_16x16x32_bf16 v[52:55], a[172:175], a[96:99], v[52:55]
buffer_load_dwordx4 v22, s[24:27], s66 offen offset:640 lds
v_accvgpr_read_b32 v120, a20
v_mfma_f32_16x16x32_bf16 v[52:55], a[168:171], a[80:83], v[52:55]
s_waitcnt lgkmcnt(0)
v_accvgpr_read_b32 v121, a21
v_accvgpr_read_b32 v122, a22
v_mfma_f32_16x16x32_bf16 v[56:59], a[176:179], a[80:83], v[56:59]
s_waitcnt vmcnt(39)
s_barrier
v_mfma_f32_16x16x32_bf16 v[56:59], a[180:183], a[96:99], v[56:59]
s_add_u32 m0, s72, 0x1980
ds_read_b64_tr_b16 a[160:161], v6
v_accvgpr_read_b32 v123, a23
v_mfma_f32_16x16x32_bf16 v[248:251], a[180:183], a[100:103], v[248:251]
buffer_load_dwordx4 v23, s[24:27], s66 offen offset:640 lds
ds_read_b64_tr_b16 a[162:163], v6 offset:1024
v_mfma_f32_16x16x32_bf16 v[248:251], a[176:179], a[84:87], v[248:251]
ds_read_b64_tr_b16 a[164:165], v6 offset:8192
v_mul_f32 v72, s84, v72
v_mfma_f32_16x16x32_bf16 v[180:183], a[176:179], a[88:91], v[180:183]
s_add_u32 s76, s0, 0
ds_read_b64_tr_b16 a[166:167], v6 offset:9216
v_mul_f32 v73, s84, v73
v_mfma_f32_16x16x32_bf16 v[180:183], a[180:183], a[104:107], v[180:183]
s_add_u32 m0, s71, 0x10000
buffer_store_dwordx4 v[64:67], v1, s[4:7], s76 offen offset:2048 sc1
ds_read_b64_tr_b16 a[168:169], v7
v_mfma_f32_16x16x32_bf16 v[116:119], a[180:183], a[108:111], v[116:119]
s_add_u32 s75, s70, 0x2c0000
ds_read_b64_tr_b16 a[170:171], v7 offset:1024
v_mul_f32 v74, s84, v74
v_mfma_f32_16x16x32_bf16 v[116:119], a[176:179], a[92:95], v[116:119]
buffer_load_dwordx4 v4, s[28:31], s75 offen lds
ds_read_b64_tr_b16 a[172:173], v7 offset:8192
v_mfma_f32_16x16x32_bf16 v[124:127], a[184:187], a[92:95], v[124:127]
s_add_u32 m0, s71, 0x10400
ds_read_b64_tr_b16 a[174:175], v7 offset:9216
v_mul_f32 v75, s84, v75
v_mfma_f32_16x16x32_bf16 v[124:127], a[188:191], a[108:111], v[124:127]
s_add_u32 s75, s70, 0x2c8000
ds_read_b64_tr_b16 a[176:177], v8
v_mul_f32 v120, s84, v120
v_mfma_f32_16x16x32_bf16 v[188:191], a[188:191], a[104:107], v[188:191]
buffer_load_dwordx4 v4, s[28:31], s75 offen lds
ds_read_b64_tr_b16 a[178:179], v8 offset:1024
v_mfma_f32_16x16x32_bf16 v[188:191], a[184:187], a[88:91], v[188:191]
ds_read_b64_tr_b16 a[180:181], v8 offset:8192
v_mul_f32 v121, s84, v121
v_mfma_f32_16x16x32_bf16 v[252:255], a[184:187], a[84:87], v[252:255]
s_add_u32 m0, s71, 0x12000
ds_read_b64_tr_b16 a[182:183], v8 offset:9216
v_mul_f32 v122, s84, v122
v_mfma_f32_16x16x32_bf16 v[252:255], a[188:191], a[100:103], v[252:255]
s_add_u32 s75, s70, 0x300000
v_mul_f32 v123, s84, v123
v_cvt_pk_bf16_f32 v72, v72, v73
v_mfma_f32_16x16x32_bf16 v[60:63], a[188:191], a[96:99], v[60:63]
s_waitcnt lgkmcnt(8)
buffer_load_dwordx4 v4, s[28:31], s75 offen lds
v_cvt_pk_bf16_f32 v73, v74, v75
v_mfma_f32_16x16x32_bf16 v[60:63], a[184:187], a[80:83], v[60:63]
s_add_u32 m0, s71, 0x12400
v_cvt_pk_bf16_f32 v74, v120, v121
v_cvt_pk_bf16_f32 v75, v122, v123
v_mfma_f32_16x16x32_bf16 v[32:35], a[160:163], a[112:115], v[32:35]
s_add_u32 s75, s70, 0x308000
s_waitcnt vmcnt(36)
ds_read_b128 a[64:67], v24 offset:32768
v_accvgpr_read_b32 v80, a8
v_mfma_f32_16x16x32_bf16 v[32:35], a[164:167], a[128:131], v[32:35]
buffer_load_dwordx4 v4, s[28:31], s75 offen lds
ds_read_b128 a[80:83], v25 offset:32768
v_mfma_f32_16x16x32_bf16 v[208:211], a[164:167], a[132:135], v[208:211]
ds_read_b128 a[68:71], v24 offset:34816
v_accvgpr_read_b32 v81, a9
v_mfma_f32_16x16x32_bf16 v[208:211], a[160:163], a[116:119], v[208:211]
ds_read_b128 a[84:87], v25 offset:34816
v_accvgpr_read_b32 v82, a10
v_mfma_f32_16x16x32_bf16 v[132:135], a[160:163], a[120:123], v[132:135]
s_add_u32 s76, s0, 0x1001000
ds_read_b64_tr_b16 a[184:185], v9
v_accvgpr_read_b32 v83, a11
v_mfma_f32_16x16x32_bf16 v[132:135], a[164:167], a[136:139], v[132:135]
s_add_u32 m0, s71, 0x14000
buffer_store_dwordx4 v[176:179], v1, s[4:7], s76 offen offset:3072 sc1
ds_read_b64_tr_b16 a[186:187], v9 offset:1024
v_mfma_f32_16x16x32_bf16 v[68:71], a[164:167], a[140:143], v[68:71]
s_add_u32 s75, s70, 0x340000
ds_read_b64_tr_b16 a[188:189], v9 offset:8192
v_accvgpr_read_b32 v112, a24
v_mfma_f32_16x16x32_bf16 v[68:71], a[160:163], a[124:127], v[68:71]
s_waitcnt lgkmcnt(11)
buffer_load_dwordx4 v4, s[28:31], s75 offen lds
ds_read_b64_tr_b16 a[190:191], v9 offset:9216
v_mfma_f32_16x16x32_bf16 v[76:79], a[168:171], a[124:127], v[76:79]
s_add_u32 m0, s71, 0x14400
ds_read_b64_tr_b16 a[160:161], v10
v_accvgpr_read_b32 v113, a25
v_mfma_f32_16x16x32_bf16 v[76:79], a[172:175], a[140:143], v[76:79]
s_add_u32 s75, s70, 0x348000
ds_read_b64_tr_b16 a[162:163], v10 offset:1024
v_accvgpr_read_b32 v114, a26
v_mfma_f32_16x16x32_bf16 v[140:143], a[172:175], a[136:139], v[140:143]
buffer_load_dwordx4 v4, s[28:31], s75 offen lds
s_waitcnt vmcnt(37)
ds_read_b128 a[72:75], v24 offset:36864
v_mfma_f32_16x16x32_bf16 v[140:143], a[168:171], a[120:123], v[140:143]
ds_read_b128 a[88:91], v25 offset:36864
v_accvgpr_read_b32 v115, a27
v_mfma_f32_16x16x32_bf16 v[212:215], a[168:171], a[116:119], v[212:215]
s_add_u32 m0, s72, 0x7d00
ds_read_b64_tr_b16 a[164:165], v10 offset:8192
v_mul_f32 v80, s84, v80
v_mfma_f32_16x16x32_bf16 v[212:215], a[172:175], a[132:135], v[212:215]
s_waitcnt lgkmcnt(11)
buffer_load_dwordx4 v22, s[24:27], s63 offen offset:768 lds
ds_read_b64_tr_b16 a[166:167], v10 offset:9216
v_mfma_f32_16x16x32_bf16 v[36:39], a[172:175], a[128:131], v[36:39]
v_mul_f32 v81, s84, v81
v_mul_f32 v82, s84, v82
v_mfma_f32_16x16x32_bf16 v[36:39], a[168:171], a[112:115], v[36:39]
v_mul_f32 v83, s84, v83
v_mul_f32 v112, s84, v112
v_mfma_f32_16x16x32_bf16 v[40:43], a[176:179], a[112:115], v[40:43]
s_add_u32 s76, s0, 0x1000
ds_read_b64_tr_b16 a[168:169], v11
v_mul_f32 v113, s84, v113
v_mfma_f32_16x16x32_bf16 v[40:43], a[180:183], a[128:131], v[40:43]
s_add_u32 m0, s71, 0x16000
buffer_store_dwordx4 v[72:75], v1, s[4:7], s76 offen offset:2048 sc1
ds_read_b64_tr_b16 a[170:171], v11 offset:1024
v_mfma_f32_16x16x32_bf16 v[216:219], a[180:183], a[132:135], v[216:219]
s_add_u32 s75, s70, 0x380000
ds_read_b64_tr_b16 a[172:173], v11 offset:8192
v_mul_f32 v114, s84, v114
v_mfma_f32_16x16x32_bf16 v[216:219], a[176:179], a[116:119], v[216:219]
buffer_load_dwordx4 v4, s[28:31], s75 offen lds
ds_read_b64_tr_b16 a[174:175], v11 offset:9216
v_mfma_f32_16x16x32_bf16 v[148:151], a[176:179], a[120:123], v[148:151]
v_mul_f32 v115, s84, v115
v_cvt_pk_bf16_f32 v80, v80, v81
v_mfma_f32_16x16x32_bf16 v[148:151], a[180:183], a[136:139], v[148:151]
s_add_u32 s76, s73, 0x1001000
v_cvt_pk_bf16_f32 v81, v82, v83
v_cvt_pk_bf16_f32 v82, v112, v113
v_mfma_f32_16x16x32_bf16 v[84:87], a[180:183], a[140:143], v[84:87]
s_waitcnt lgkmcnt(10)
buffer_store_dwordx4 v[160:163], v1, s[4:7], s76 offen offset:2048 sc1
v_cvt_pk_bf16_f32 v83, v114, v115
v_mfma_f32_16x16x32_bf16 v[84:87], a[176:179], a[124:127], v[84:87]
s_add_u32 m0, s72, 0x8100
v_accvgpr_read_b32 v88, a12
v_accvgpr_read_b32 v89, a13
v_mfma_f32_16x16x32_bf16 v[92:95], a[184:187], a[124:127], v[92:95]
s_lshl_b32 s88, s48, 13
s_add_u32 s88, s88, L_cp1500-L_pc
v_lshlrev_b32 v30, 7, v0
v_add_u32 v30, s88, v30
v_min_u32 v30, L_codeend-L_pc-4, v30
global_load_dword v29, v30, s[98:99]
v_mfma_f32_16x16x32_bf16 v[92:95], a[188:191], a[140:143], v[92:95]
buffer_load_dwordx4 v23, s[24:27], s63 offen offset:768 lds
ds_read_b64_tr_b16 a[176:177], v12
v_mfma_f32_16x16x32_bf16 v[156:159], a[188:191], a[136:139], v[156:159]
ds_read_b64_tr_b16 a[178:179], v12 offset:1024
v_accvgpr_read_b32 v90, a14
v_mfma_f32_16x16x32_bf16 v[156:159], a[184:187], a[120:123], v[156:159]
s_add_u32 s76, s0, 0x1003000
s_waitcnt vmcnt(38)
ds_read_b128 a[76:79], v24 offset:38912
v_accvgpr_read_b32 v91, a15
v_mfma_f32_16x16x32_bf16 v[220:223], a[184:187], a[116:119], v[220:223]
buffer_store_dwordx4 v[184:187], v1, s[4:7], s76 offen offset:3072 sc1
ds_read_b128 a[92:95], v25 offset:38912
v_mfma_f32_16x16x32_bf16 v[220:223], a[188:191], a[132:135], v[220:223]
s_add_u32 m0, s72, 0x8500
ds_read_b64_tr_b16 a[180:181], v12 offset:8192
v_accvgpr_read_b32 v120, a28
v_mfma_f32_16x16x32_bf16 v[44:47], a[188:191], a[128:131], v[44:47]
s_waitcnt lgkmcnt(9)
buffer_load_dwordx4 v22, s[24:27], s64 offen offset:768 lds
ds_read_b64_tr_b16 a[182:183], v12 offset:9216
v_mfma_f32_16x16x32_bf16 v[44:47], a[184:187], a[112:115], v[44:47]
s_add_u32 m0, s71, 0x16400
v_accvgpr_read_b32 v121, a29
v_accvgpr_read_b32 v122, a30
v_mfma_f32_16x16x32_bf16 v[48:51], a[160:163], a[112:115], v[48:51]
s_add_u32 s75, s70, 0x388000
ds_read_b64_tr_b16 a[184:185], v13
v_accvgpr_read_b32 v123, a31
v_mfma_f32_16x16x32_bf16 v[48:51], a[164:167], a[128:131], v[48:51]
buffer_load_dwordx4 v4, s[28:31], s75 offen lds
ds_read_b64_tr_b16 a[186:187], v13 offset:1024
v_mfma_f32_16x16x32_bf16 v[240:243], a[164:167], a[132:135], v[240:243]
ds_read_b64_tr_b16 a[188:189], v13 offset:8192
v_mul_f32 v88, s84, v88
v_mfma_f32_16x16x32_bf16 v[240:243], a[160:163], a[116:119], v[240:243]
s_add_u32 m0, s72, 0x8900
ds_read_b64_tr_b16 a[190:191], v13 offset:9216
v_mul_f32 v89, s84, v89
v_mfma_f32_16x16x32_bf16 v[164:167], a[160:163], a[120:123], v[164:167]
buffer_load_dwordx4 v23, s[24:27], s64 offen offset:768 lds
v_mul_f32 v90, s84, v90
v_mfma_f32_16x16x32_bf16 v[164:167], a[164:167], a[136:139], v[164:167]
v_mul_f32 v91, s84, v91
v_mul_f32 v120, s84, v120
v_mfma_f32_16x16x32_bf16 v[100:103], a[164:167], a[140:143], v[100:103]
s_waitcnt lgkmcnt(10)
v_mul_f32 v121, s84, v121
v_mul_f32 v122, s84, v122
v_mfma_f32_16x16x32_bf16 v[100:103], a[160:163], a[124:127], v[100:103]
s_add_u32 s76, s0, 0x2000
v_mul_f32 v123, s84, v123
v_cvt_pk_bf16_f32 v88, v88, v89
v_mfma_f32_16x16x32_bf16 v[108:111], a[168:171], a[124:127], v[108:111]
buffer_store_dwordx4 v[80:83], v1, s[4:7], s76 offen offset:2048 sc1
v_cvt_pk_bf16_f32 v89, v90, v91
v_mfma_f32_16x16x32_bf16 v[108:111], a[172:175], a[140:143], v[108:111]
s_add_u32 m0, s72, 0x8d00
v_cvt_pk_bf16_f32 v90, v120, v121
v_cvt_pk_bf16_f32 v91, v122, v123
v_mfma_f32_16x16x32_bf16 v[172:175], a[172:175], a[136:139], v[172:175]
buffer_load_dwordx4 v22, s[24:27], s65 offen offset:768 lds
v_accvgpr_read_b32 v128, a32
v_mfma_f32_16x16x32_bf16 v[172:175], a[168:171], a[120:123], v[172:175]
v_accvgpr_read_b32 v129, a33
v_accvgpr_read_b32 v130, a34
v_mfma_f32_16x16x32_bf16 v[244:247], a[168:171], a[116:119], v[244:247]
s_add_u32 m0, s72, 0x9100
v_accvgpr_read_b32 v131, a35
v_accvgpr_read_b32 v112, a48
v_mfma_f32_16x16x32_bf16 v[244:247], a[172:175], a[132:135], v[244:247]
buffer_load_dwordx4 v23, s[24:27], s65 offen offset:768 lds
v_accvgpr_read_b32 v113, a49
v_mfma_f32_16x16x32_bf16 v[52:55], a[172:175], a[128:131], v[52:55]
v_accvgpr_read_b32 v114, a50
v_accvgpr_read_b32 v115, a51
v_mfma_f32_16x16x32_bf16 v[52:55], a[168:171], a[112:115], v[52:55]
s_waitcnt lgkmcnt(0)
v_mul_f32 v128, s84, v128
v_mul_f32 v129, s84, v129
v_mfma_f32_16x16x32_bf16 v[56:59], a[176:179], a[112:115], v[56:59]
s_waitcnt vmcnt(34)
s_barrier
v_mfma_f32_16x16x32_bf16 v[56:59], a[180:183], a[128:131], v[56:59]
s_add_u32 m0, s72, 0x9500
v_add_u32 v6, 0xffff8000, v6
ds_read_b64_tr_b16 a[160:161], v6
v_mfma_f32_16x16x32_bf16 v[248:251], a[180:183], a[132:135], v[248:251]
buffer_load_dwordx4 v22, s[24:27], s66 offen offset:768 lds
ds_read_b64_tr_b16 a[162:163], v6 offset:1024
v_mfma_f32_16x16x32_bf16 v[248:251], a[176:179], a[116:119], v[248:251]
s_add_u32 s76, s0, 0x3000
ds_read_b64_tr_b16 a[164:165], v6 offset:8192
v_mul_f32 v130, s84, v130
v_mfma_f32_16x16x32_bf16 v[180:183], a[176:179], a[120:123], v[180:183]
buffer_store_dwordx4 v[88:91], v1, s[4:7], s76 offen offset:2048 sc1
ds_read_b64_tr_b16 a[166:167], v6 offset:9216
v_mfma_f32_16x16x32_bf16 v[180:183], a[180:183], a[136:139], v[180:183]
s_add_u32 m0, s72, 0x9900
v_mul_f32 v131, s84, v131
v_mul_f32 v112, s84, v112
v_mfma_f32_16x16x32_bf16 v[116:119], a[180:183], a[140:143], v[116:119]
buffer_load_dwordx4 v23, s[24:27], s66 offen offset:768 lds
v_mul_f32 v113, s84, v113
v_mfma_f32_16x16x32_bf16 v[116:119], a[176:179], a[124:127], v[116:119]
s_add_u32 m0, s71, 0x8000
v_mul_f32 v114, s84, v114
v_mul_f32 v115, s84, v115
v_mfma_f32_16x16x32_bf16 v[124:127], a[184:187], a[124:127], v[124:127]
s_add_u32 s75, s70, 0x3c0000
v_cvt_pk_bf16_f32 v128, v128, v129
v_cvt_pk_bf16_f32 v129, v130, v131
v_mfma_f32_16x16x32_bf16 v[124:127], a[188:191], a[140:143], v[124:127]
buffer_load_dwordx4 v4, s[28:31], s75 offen lds
v_cvt_pk_bf16_f32 v130, v112, v113
v_mfma_f32_16x16x32_bf16 v[188:191], a[188:191], a[136:139], v[188:191]
v_cvt_pk_bf16_f32 v131, v114, v115
v_add_u32 v7, 0xffff8000, v7
v_mfma_f32_16x16x32_bf16 v[188:191], a[184:187], a[120:123], v[188:191]
s_add_u32 m0, s71, 0x8400
ds_read_b64_tr_b16 a[168:169], v7
v_accvgpr_read_b32 v136, a36
v_mfma_f32_16x16x32_bf16 v[252:255], a[184:187], a[116:119], v[252:255]
s_add_u32 s75, s70, 0x3c8000
ds_read_b64_tr_b16 a[170:171], v7 offset:1024
v_accvgpr_read_b32 v137, a37
v_mfma_f32_16x16x32_bf16 v[252:255], a[188:191], a[132:135], v[252:255]
buffer_load_dwordx4 v4, s[28:31], s75 offen lds
ds_read_b64_tr_b16 a[172:173], v7 offset:8192
v_mfma_f32_16x16x32_bf16 v[60:63], a[188:191], a[128:131], v[60:63]
s_waitcnt lgkmcnt(3)
ds_read_b64_tr_b16 a[174:175], v7 offset:9216
v_add_u32 v8, 0xffff8000, v8
v_mfma_f32_16x16x32_bf16 v[60:63], a[184:187], a[112:115], v[60:63]
s_add_u32 s76, s0, 0
ds_read_b64_tr_b16 a[176:177], v8
v_accvgpr_read_b32 v138, a38
v_mfma_f32_16x16x32_bf16 v[32:35], a[160:163], a[144:147], v[32:35]
s_add_u32 m0, s71, 0xa000
buffer_store_dwordx4 v[128:131], v1, s[4:7], s76 offen offset:3072 sc1
ds_read_b64_tr_b16 a[178:179], v8 offset:1024
v_mfma_f32_16x16x32_bf16 v[32:35], a[164:167], a[64:67], v[32:35]
s_add_u32 s75, s70, 0x400000
ds_read_b64_tr_b16 a[180:181], v8 offset:8192
v_accvgpr_read_b32 v139, a39
v_mfma_f32_16x16x32_bf16 v[208:211], a[164:167], a[68:71], v[208:211]
buffer_load_dwordx4 v4, s[28:31], s75 offen lds
ds_read_b64_tr_b16 a[182:183], v8 offset:9216
v_mfma_f32_16x16x32_bf16 v[208:211], a[160:163], a[148:151], v[208:211]
v_accvgpr_read_b32 v120, a52
v_accvgpr_read_b32 v121, a53
v_mfma_f32_16x16x32_bf16 v[132:135], a[160:163], a[152:155], v[132:135]
s_add_u32 m0, s71, 0xa400
v_accvgpr_read_b32 v122, a54
v_accvgpr_read_b32 v123, a55
v_mfma_f32_16x16x32_bf16 v[132:135], a[164:167], a[72:75], v[132:135]
s_add_u32 s75, s70, 0x408000
v_mul_f32 v136, s84, v136
v_mul_f32 v137, s84, v137
v_mfma_f32_16x16x32_bf16 v[68:71], a[164:167], a[76:79], v[68:71]
s_waitcnt lgkmcnt(4)
buffer_load_dwordx4 v4, s[28:31], s75 offen lds
v_mul_f32 v138, s84, v138
v_mfma_f32_16x16x32_bf16 v[68:71], a[160:163], a[156:159], v[68:71]
s_add_u32 m0, s71, 0xc000
v_mul_f32 v139, s84, v139
v_mul_f32 v120, s84, v120
v_mfma_f32_16x16x32_bf16 v[76:79], a[168:171], a[156:159], v[76:79]
s_add_u32 s75, s70, 0x440000
v_mul_f32 v121, s84, v121
v_mul_f32 v122, s84, v122
v_mfma_f32_16x16x32_bf16 v[76:79], a[172:175], a[76:79], v[76:79]
buffer_load_dwordx4 v4, s[28:31], s75 offen lds
v_mul_f32 v123, s84, v123
v_mfma_f32_16x16x32_bf16 v[140:143], a[172:175], a[72:75], v[140:143]
v_cvt_pk_bf16_f32 v136, v136, v137
v_cvt_pk_bf16_f32 v137, v138, v139
v_mfma_f32_16x16x32_bf16 v[140:143], a[168:171], a[152:155], v[140:143]
s_add_u32 s76, s0, 0x1000
v_cvt_pk_bf16_f32 v138, v120, v121
v_cvt_pk_bf16_f32 v139, v122, v123
v_mfma_f32_16x16x32_bf16 v[212:215], a[168:171], a[148:151], v[212:215]
s_add_u32 m0, s71, 0xc400
buffer_store_dwordx4 v[136:139], v1, s[4:7], s76 offen offset:3072 sc1
v_add_u32 v9, 0xffff8000, v9
v_mfma_f32_16x16x32_bf16 v[212:215], a[172:175], a[68:71], v[212:215]
s_add_u32 s75, s70, 0x448000
ds_read_b64_tr_b16 a[184:185], v9
v_accvgpr_read_b32 v144, a40
v_mfma_f32_16x16x32_bf16 v[36:39], a[172:175], a[64:67], v[36:39]
buffer_load_dwordx4 v4, s[28:31], s75 offen lds
ds_read_b64_tr_b16 a[186:187], v9 offset:1024
v_mfma_f32_16x16x32_bf16 v[36:39], a[168:171], a[144:147], v[36:39]
s_waitcnt lgkmcnt(2)
ds_read_b64_tr_b16 a[188:189], v9 offset:8192
v_accvgpr_read_b32 v145, a41
v_mfma_f32_16x16x32_bf16 v[40:43], a[176:179], a[144:147], v[40:43]
s_lshl_b32 s87, s53, 3
s_add_u32 s87, s87, s54
s_lshl_b32 s87, s87, 2
s_add_u32 s87, s87, s48
s_lshl_b32 s87, s87, 2
s_add_u32 s78, s87, 0x5001000
v_mfma_f32_16x16x32_bf16 v[40:43], a[180:183], a[64:67], v[40:43]
s_add_u32 s76, s73, 0
ds_read_b64_tr_b16 a[190:191], v9 offset:9216
s_waitcnt vmcnt(41)
buffer_store_dword v18, v20, s[4:7], s78 offen sc1
v_mfma_f32_16x16x32_bf16 v[216:219], a[180:183], a[68:71], v[216:219]
ds_read_b128 a[96:99], v24
ds_read_b128 a[112:115], v25
v_mfma_f32_16x16x32_bf16 v[216:219], a[176:179], a[148:151], v[216:219]
buffer_store_dwordx4 v[224:227], v1, s[4:7], s76 offen offset:1024 sc1
v_accvgpr_read_b32 v146, a42
v_mfma_f32_16x16x32_bf16 v[148:151], a[176:179], a[152:155], v[148:151]
s_cmp_lg_u32 s50, 0
s_cbranch_scc1 L_nopz
s_lshl_b32 s88, s48, 13
s_add_u32 s88, s88, L_zero-L_pc
v_lshlrev_b32 v30, 7, v0
v_add_u32 v30, s88, v30
v_min_u32 v30, L_codeend-L_pc-4, v30
global_load_dword v29, v30, s[98:99]
L_nopz:
v_mfma_f32_16x16x32_bf16 v[148:151], a[180:183], a[72:75], v[148:151]
v_accvgpr_read_b32 v147, a43
v_accvgpr_read_b32 v112, a56
v_mfma_f32_16x16x32_bf16 v[84:87], a[180:183], a[76:79], v[84:87]
s_waitcnt lgkmcnt(3)
v_accvgpr_read_b32 v113, a57
v_accvgpr_read_b32 v114, a58
v_accvgpr_read_b32 v115, a59
v_mul_f32 v144, s84, v144
v_mul_f32 v145, s84, v145
v_mul_f32 v146, s84, v146
v_mul_f32 v147, s84, v147
v_mul_f32 v112, s84, v112
v_mul_f32 v113, s84, v113
v_mul_f32 v114, s84, v114
v_mul_f32 v115, s84, v115
v_cvt_pk_bf16_f32 v144, v144, v145
v_cvt_pk_bf16_f32 v145, v146, v147
v_cvt_pk_bf16_f32 v146, v112, v113
v_cvt_pk_bf16_f32 v147, v114, v115
v_mfma_f32_16x16x32_bf16 v[84:87], a[176:179], a[156:159], v[84:87]
s_add_u32 s76, s0, 0x2000
v_add_u32 v10, 0xffff8000, v10
ds_read_b64_tr_b16 a[160:161], v10
v_mfma_f32_16x16x32_bf16 v[92:95], a[184:187], a[156:159], v[92:95]
s_waitcnt lgkmcnt(1)
buffer_store_dwordx4 v[144:147], v1, s[4:7], s76 offen offset:3072 sc1
ds_read_b64_tr_b16 a[162:163], v10 offset:1024
v_mfma_f32_16x16x32_bf16 v[92:95], a[188:191], a[76:79], v[92:95]
s_add_u32 m0, s72, 0xfffffc80
ds_read_b64_tr_b16 a[164:165], v10 offset:8192
v_accvgpr_read_b32 v152, a44
v_mfma_f32_16x16x32_bf16 v[156:159], a[188:191], a[72:75], v[156:159]
ds_read_b64_tr_b16 a[166:167], v10 offset:9216
buffer_load_dwordx4 v22, s[24:27], s63 offen offset:896 lds
v_mfma_f32_16x16x32_bf16 v[156:159], a[184:187], a[152:155], v[156:159]
s_waitcnt vmcnt(41)
ds_read_b128 a[100:103], v24 offset:2048
v_add_u32 v11, 0xffff8000, v11
v_mfma_f32_16x16x32_bf16 v[220:223], a[184:187], a[148:151], v[220:223]
s_add_u32 m0, s72, 0x80
ds_read_b128 a[116:119], v25 offset:2048
v_accvgpr_read_b32 v153, a45
v_mfma_f32_16x16x32_bf16 v[220:223], a[188:191], a[68:71], v[220:223]
buffer_load_dwordx4 v23, s[24:27], s63 offen offset:896 lds
ds_read_b64_tr_b16 a[168:169], v11
v_mfma_f32_16x16x32_bf16 v[44:47], a[188:191], a[64:67], v[44:47]
ds_read_b64_tr_b16 a[170:171], v11 offset:1024
v_accvgpr_read_b32 v154, a46
v_mfma_f32_16x16x32_bf16 v[44:47], a[184:187], a[144:147], v[44:47]
s_waitcnt lgkmcnt(6)
ds_read_b64_tr_b16 a[172:173], v11 offset:8192
v_accvgpr_read_b32 v155, a47
v_mfma_f32_16x16x32_bf16 v[48:51], a[160:163], a[144:147], v[48:51]
s_waitcnt lgkmcnt(5)
ds_read_b64_tr_b16 a[174:175], v11 offset:9216
v_accvgpr_read_b32 v120, a60
v_mfma_f32_16x16x32_bf16 v[48:51], a[164:167], a[64:67], v[48:51]
v_accvgpr_read_b32 v121, a61
v_accvgpr_read_b32 v122, a62
v_mfma_f32_16x16x32_bf16 v[240:243], a[164:167], a[68:71], v[240:243]
v_accvgpr_read_b32 v123, a63
v_mul_f32 v152, s84, v152
v_mfma_f32_16x16x32_bf16 v[240:243], a[160:163], a[148:151], v[240:243]
v_mul_f32 v153, s84, v153
v_mul_f32 v154, s84, v154
v_mfma_f32_16x16x32_bf16 v[164:167], a[160:163], a[152:155], v[164:167]
v_mul_f32 v155, s84, v155
v_mul_f32 v120, s84, v120
v_mul_f32 v121, s84, v121
v_mul_f32 v122, s84, v122
v_mul_f32 v123, s84, v123
v_cvt_pk_bf16_f32 v152, v152, v153
v_cvt_pk_bf16_f32 v153, v154, v155
v_cvt_pk_bf16_f32 v154, v120, v121
v_cvt_pk_bf16_f32 v155, v122, v123
v_mfma_f32_16x16x32_bf16 v[164:167], a[164:167], a[72:75], v[164:167]
s_add_u32 s76, s0, 0x3000
s_waitcnt vmcnt(39)
ds_read_b128 a[104:107], v24 offset:4096
v_add_u32 v12, 0xffff8000, v12
v_mfma_f32_16x16x32_bf16 v[100:103], a[164:167], a[76:79], v[100:103]
s_add_u32 m0, s72, 0x480
ds_read_b128 a[120:123], v25 offset:4096
buffer_store_dwordx4 v[152:155], v1, s[4:7], s76 offen offset:3072 sc1
v_mfma_f32_16x16x32_bf16 v[100:103], a[160:163], a[156:159], v[100:103]
s_waitcnt lgkmcnt(2)
buffer_load_dwordx4 v22, s[24:27], s64 offen offset:896 lds
ds_read_b64_tr_b16 a[176:177], v12
v_mfma_f32_16x16x32_bf16 v[108:111], a[168:171], a[156:159], v[108:111]
ds_read_b64_tr_b16 a[178:179], v12 offset:1024
v_mfma_f32_16x16x32_bf16 v[108:111], a[172:175], a[76:79], v[108:111]
s_add_u32 m0, s72, 0x880
ds_read_b64_tr_b16 a[180:181], v12 offset:8192
v_mfma_f32_16x16x32_bf16 v[172:175], a[172:175], a[72:75], v[172:175]
ds_read_b64_tr_b16 a[182:183], v12 offset:9216
buffer_load_dwordx4 v23, s[24:27], s64 offen offset:896 lds
v_mfma_f32_16x16x32_bf16 v[172:175], a[168:171], a[152:155], v[172:175]
s_waitcnt vmcnt(40)
ds_read_b128 a[108:111], v24 offset:6144
v_add_u32 v13, 0xffff8000, v13
v_mfma_f32_16x16x32_bf16 v[244:247], a[168:171], a[148:151], v[244:247]
ds_read_b128 a[124:127], v25 offset:6144
v_mfma_f32_16x16x32_bf16 v[244:247], a[172:175], a[68:71], v[244:247]
s_add_u32 m0, s72, 0xc80
ds_read_b64_tr_b16 a[184:185], v13
v_mfma_f32_16x16x32_bf16 v[52:55], a[172:175], a[64:67], v[52:55]
s_waitcnt lgkmcnt(7)
buffer_load_dwordx4 v22, s[24:27], s65 offen offset:896 lds
ds_read_b64_tr_b16 a[186:187], v13 offset:1024
v_mfma_f32_16x16x32_bf16 v[52:55], a[168:171], a[144:147], v[52:55]
s_waitcnt lgkmcnt(6)
ds_read_b64_tr_b16 a[188:189], v13 offset:8192
v_mfma_f32_16x16x32_bf16 v[56:59], a[176:179], a[144:147], v[56:59]
s_waitcnt lgkmcnt(5)
s_add_u32 m0, s72, 0x1080
ds_read_b64_tr_b16 a[190:191], v13 offset:9216
v_mfma_f32_16x16x32_bf16 v[56:59], a[180:183], a[64:67], v[56:59]
buffer_load_dwordx4 v23, s[24:27], s65 offen offset:896 lds
ds_read_b64_tr_b16 a[160:161], v6 offset:16384
v_mfma_f32_16x16x32_bf16 v[248:251], a[180:183], a[68:71], v[248:251]
ds_read_b64_tr_b16 a[162:163], v6 offset:17408
v_mfma_f32_16x16x32_bf16 v[248:251], a[176:179], a[148:151], v[248:251]
s_add_u32 s76, s73, 0x1003000
ds_read_b64_tr_b16 a[164:165], v6 offset:24576
v_mfma_f32_16x16x32_bf16 v[180:183], a[176:179], a[152:155], v[180:183]
buffer_store_dwordx4 v[168:171], v1, s[4:7], s76 offen offset:2048 sc1
ds_read_b64_tr_b16 a[166:167], v6 offset:25600
v_mfma_f32_16x16x32_bf16 v[180:183], a[180:183], a[72:75], v[180:183]
s_add_u32 m0, s72, 0x1480
ds_read_b64_tr_b16 a[168:169], v7 offset:16384
v_mfma_f32_16x16x32_bf16 v[116:119], a[180:183], a[76:79], v[116:119]
s_waitcnt lgkmcnt(7)
buffer_load_dwordx4 v22, s[24:27], s66 offen offset:896 lds
ds_read_b64_tr_b16 a[170:171], v7 offset:17408
v_mfma_f32_16x16x32_bf16 v[116:119], a[176:179], a[156:159], v[116:119]
ds_read_b64_tr_b16 a[172:173], v7 offset:24576
v_mfma_f32_16x16x32_bf16 v[124:127], a[184:187], a[156:159], v[124:127]
s_waitcnt lgkmcnt(7)
ds_read_b64_tr_b16 a[174:175], v7 offset:25600
v_mfma_f32_16x16x32_bf16 v[124:127], a[188:191], a[76:79], v[124:127]
s_add_u32 m0, s72, 0x1880
ds_read_b64_tr_b16 a[176:177], v8 offset:16384
v_mfma_f32_16x16x32_bf16 v[188:191], a[188:191], a[72:75], v[188:191]
buffer_load_dwordx4 v23, s[24:27], s66 offen offset:896 lds
ds_read_b64_tr_b16 a[178:179], v8 offset:17408
v_mfma_f32_16x16x32_bf16 v[188:191], a[184:187], a[152:155], v[188:191]
ds_read_b64_tr_b16 a[180:181], v8 offset:24576
v_mfma_f32_16x16x32_bf16 v[252:255], a[184:187], a[148:151], v[252:255]
ds_read_b64_tr_b16 a[182:183], v8 offset:25600
v_mfma_f32_16x16x32_bf16 v[252:255], a[188:191], a[68:71], v[252:255]
v_mfma_f32_16x16x32_bf16 v[60:63], a[188:191], a[64:67], v[60:63]
v_mfma_f32_16x16x32_bf16 v[60:63], a[184:187], a[144:147], v[60:63]
s_waitcnt lgkmcnt(8)
v_mfma_f32_16x16x32_bf16 v[32:35], a[160:163], a[80:83], v[32:35]
ds_read_b64_tr_b16 a[184:185], v9 offset:16384
v_mfma_f32_16x16x32_bf16 v[32:35], a[164:167], a[96:99], v[32:35]
ds_read_b64_tr_b16 a[186:187], v9 offset:17408
v_mfma_f32_16x16x32_bf16 v[208:211], a[164:167], a[100:103], v[208:211]
ds_read_b64_tr_b16 a[188:189], v9 offset:24576
v_mfma_f32_16x16x32_bf16 v[208:211], a[160:163], a[84:87], v[208:211]
ds_read_b64_tr_b16 a[190:191], v9 offset:25600
v_mfma_f32_16x16x32_bf16 v[132:135], a[160:163], a[88:91], v[132:135]
v_mfma_f32_16x16x32_bf16 v[132:135], a[164:167], a[104:107], v[132:135]
v_mfma_f32_16x16x32_bf16 v[68:71], a[164:167], a[108:111], v[68:71]
v_mfma_f32_16x16x32_bf16 v[68:71], a[160:163], a[92:95], v[68:71]
s_waitcnt lgkmcnt(8)
v_mfma_f32_16x16x32_bf16 v[76:79], a[168:171], a[92:95], v[76:79]
s_add_u32 s76, s73, 0x1000
ds_read_b64_tr_b16 a[160:161], v10 offset:16384
v_mfma_f32_16x16x32_bf16 v[76:79], a[172:175], a[108:111], v[76:79]
buffer_store_dwordx4 v[228:231], v1, s[4:7], s76 offen offset:1024 sc1
ds_read_b64_tr_b16 a[162:163], v10 offset:17408
v_mfma_f32_16x16x32_bf16 v[140:143], a[172:175], a[104:107], v[140:143]
ds_read_b64_tr_b16 a[164:165], v10 offset:24576
v_mfma_f32_16x16x32_bf16 v[140:143], a[168:171], a[88:91], v[140:143]
ds_read_b64_tr_b16 a[166:167], v10 offset:25600
v_mfma_f32_16x16x32_bf16 v[212:215], a[168:171], a[84:87], v[212:215]
v_mfma_f32_16x16x32_bf16 v[212:215], a[172:175], a[100:103], v[212:215]
v_mfma_f32_16x16x32_bf16 v[36:39], a[172:175], a[96:99], v[36:39]
v_mfma_f32_16x16x32_bf16 v[36:39], a[168:171], a[80:83], v[36:39]
s_waitcnt lgkmcnt(8)
v_mfma_f32_16x16x32_bf16 v[40:43], a[176:179], a[80:83], v[40:43]
s_waitcnt vmcnt(32)
ds_read_b128 a[128:131], v24 offset:32768
v_mfma_f32_16x16x32_bf16 v[40:43], a[180:183], a[96:99], v[40:43]
ds_read_b128 a[144:147], v25 offset:32768
v_mfma_f32_16x16x32_bf16 v[216:219], a[180:183], a[100:103], v[216:219]
ds_read_b64_tr_b16 a[168:169], v11 offset:16384
v_mfma_f32_16x16x32_bf16 v[216:219], a[176:179], a[84:87], v[216:219]
ds_read_b64_tr_b16 a[170:171], v11 offset:17408
v_mfma_f32_16x16x32_bf16 v[148:151], a[176:179], a[88:91], v[148:151]
ds_read_b64_tr_b16 a[172:173], v11 offset:24576
v_mfma_f32_16x16x32_bf16 v[148:151], a[180:183], a[104:107], v[148:151]
ds_read_b64_tr_b16 a[174:175], v11 offset:25600
v_mfma_f32_16x16x32_bf16 v[84:87], a[180:183], a[108:111], v[84:87]
s_lshl_b32 s77, s49, 3
s_add_u32 s77, s77, s3
s_lshl_b32 s77, s77, 2
s_add_u32 s77, s77, s48
s_lshl_b32 s77, s77, 2
s_add_u32 s67, s77, 0x5009000
s_add_u32 s77, s77, 0x5000000
v_mfma_f32_16x16x32_bf16 v[84:87], a[176:179], a[92:95], v[84:87]
s_waitcnt vmcnt(8) lgkmcnt(5)
buffer_store_dword v18, v20, s[4:7], s77 offen sc1
v_mfma_f32_16x16x32_bf16 v[92:95], a[184:187], a[92:95], v[92:95]
ds_read_b64_tr_b16 a[176:177], v12 offset:16384
v_mfma_f32_16x16x32_bf16 v[92:95], a[188:191], a[108:111], v[92:95]
ds_read_b64_tr_b16 a[178:179], v12 offset:17408
v_mfma_f32_16x16x32_bf16 v[156:159], a[188:191], a[104:107], v[156:159]
s_add_u32 m0, s72, 0x7c00
ds_read_b64_tr_b16 a[180:181], v12 offset:24576
v_mfma_f32_16x16x32_bf16 v[156:159], a[184:187], a[88:91], v[156:159]
s_waitcnt lgkmcnt(7)
buffer_load_dwordx4 v22, s[24:27], s63 offen offset:1024 lds
ds_read_b64_tr_b16 a[182:183], v12 offset:25600
v_mfma_f32_16x16x32_bf16 v[220:223], a[184:187], a[84:87], v[220:223]
ds_read_b128 a[132:135], v24 offset:34816
v_mfma_f32_16x16x32_bf16 v[220:223], a[188:191], a[100:103], v[220:223]
s_add_u32 m0, s72, 0x8000
ds_read_b128 a[148:151], v25 offset:34816
v_mfma_f32_16x16x32_bf16 v[44:47], a[188:191], a[96:99], v[44:47]
buffer_load_dwordx4 v23, s[24:27], s63 offen offset:1024 lds
v_mfma_f32_16x16x32_bf16 v[44:47], a[184:187], a[80:83], v[44:47]
v_mfma_f32_16x16x32_bf16 v[48:51], a[160:163], a[80:83], v[48:51]
s_add_u32 s76, s73, 0x1001000
ds_read_b64_tr_b16 a[184:185], v13 offset:16384
v_mfma_f32_16x16x32_bf16 v[48:51], a[164:167], a[96:99], v[48:51]
buffer_store_dwordx4 v[176:179], v1, s[4:7], s76 offen offset:3072 sc1
ds_read_b64_tr_b16 a[186:187], v13 offset:17408
v_mfma_f32_16x16x32_bf16 v[240:243], a[164:167], a[100:103], v[240:243]
s_lshl_b32 s74, s53, 7
s_add_u32 s74, s74, 0x5001000
ds_read_b64_tr_b16 a[188:189], v13 offset:24576
v_mfma_f32_16x16x32_bf16 v[240:243], a[160:163], a[84:87], v[240:243]
ds_read_b64_tr_b16 a[190:191], v13 offset:25600
v_mfma_f32_16x16x32_bf16 v[164:167], a[160:163], a[88:91], v[164:167]
v_mfma_f32_16x16x32_bf16 v[164:167], a[164:167], a[104:107], v[164:167]
ds_read_b128 a[136:139], v24 offset:36864
v_mfma_f32_16x16x32_bf16 v[100:103], a[164:167], a[108:111], v[100:103]
s_add_u32 m0, s72, 0x8400
ds_read_b128 a[152:155], v25 offset:36864
v_mfma_f32_16x16x32_bf16 v[100:103], a[160:163], a[92:95], v[100:103]
s_waitcnt lgkmcnt(6)
buffer_load_dwordx4 v22, s[24:27], s64 offen offset:1024 lds
v_mfma_f32_16x16x32_bf16 v[108:111], a[168:171], a[92:95], v[108:111]
buffer_load_dword v28, v21, s[4:7], s74 offen sc1
v_mfma_f32_16x16x32_bf16 v[108:111], a[172:175], a[108:111], v[108:111]
s_add_u32 m0, s72, 0x8800
v_mfma_f32_16x16x32_bf16 v[172:175], a[172:175], a[104:107], v[172:175]
buffer_load_dwordx4 v23, s[24:27], s64 offen offset:1024 lds
v_mfma_f32_16x16x32_bf16 v[172:175], a[168:171], a[88:91], v[172:175]
v_mfma_f32_16x16x32_bf16 v[244:247], a[168:171], a[84:87], v[244:247]
v_mfma_f32_16x16x32_bf16 v[244:247], a[172:175], a[100:103], v[244:247]
v_mfma_f32_16x16x32_bf16 v[52:55], a[172:175], a[96:99], v[52:55]
ds_read_b128 a[140:143], v24 offset:38912
v_mfma_f32_16x16x32_bf16 v[52:55], a[168:171], a[80:83], v[52:55]
s_add_u32 m0, s72, 0x8c00
ds_read_b128 a[156:159], v25 offset:38912
v_mfma_f32_16x16x32_bf16 v[56:59], a[176:179], a[80:83], v[56:59]
s_waitcnt lgkmcnt(2)
s_barrier
v_mfma_f32_16x16x32_bf16 v[56:59], a[180:183], a[96:99], v[56:59]
buffer_load_dwordx4 v22, s[24:27], s65 offen offset:1024 lds
v_add_u32 v6, 0x8000, v6
v_mfma_f32_16x16x32_bf16 v[248:251], a[180:183], a[100:103], v[248:251]
s_add_u32 m0, s72, 0x9000
ds_read_b64_tr_b16 a[160:161], v6 offset:32768
v_mfma_f32_16x16x32_bf16 v[248:251], a[176:179], a[84:87], v[248:251]
buffer_load_dwordx4 v23, s[24:27], s65 offen offset:1024 lds
ds_read_b64_tr_b16 a[162:163], v6 offset:33792
v_mfma_f32_16x16x32_bf16 v[180:183], a[176:179], a[88:91], v[180:183]
ds_read_b64_tr_b16 a[164:165], v6 offset:40960
v_mfma_f32_16x16x32_bf16 v[180:183], a[180:183], a[104:107], v[180:183]
s_add_u32 s76, s73, 0x2000
ds_read_b64_tr_b16 a[166:167], v6 offset:41984
v_add_u32 v7, 0x8000, v7
v_mfma_f32_16x16x32_bf16 v[116:119], a[180:183], a[108:111], v[116:119]
buffer_store_dwordx4 v[232:235], v1, s[4:7], s76 offen offset:1024 sc1
ds_read_b64_tr_b16 a[168:169], v7 offset:32768
v_mfma_f32_16x16x32_bf16 v[116:119], a[176:179], a[92:95], v[116:119]
ds_read_b64_tr_b16 a[170:171], v7 offset:33792
v_mfma_f32_16x16x32_bf16 v[124:127], a[184:187], a[92:95], v[124:127]
s_add_u32 m0, s72, 0x9400
ds_read_b64_tr_b16 a[172:173], v7 offset:40960
v_mfma_f32_16x16x32_bf16 v[124:127], a[188:191], a[108:111], v[124:127]
s_waitcnt lgkmcnt(7)
buffer_load_dwordx4 v22, s[24:27], s66 offen offset:1024 lds
ds_read_b64_tr_b16 a[174:175], v7 offset:41984
v_mfma_f32_16x16x32_bf16 v[188:191], a[188:191], a[104:107], v[188:191]
v_add_u32 v8, 0x8000, v8
ds_read_b64_tr_b16 a[176:177], v8 offset:32768
v_mfma_f32_16x16x32_bf16 v[188:191], a[184:187], a[88:91], v[188:191]
s_add_u32 m0, s72, 0x9800
ds_read_b64_tr_b16 a[178:179], v8 offset:33792
v_mfma_f32_16x16x32_bf16 v[252:255], a[184:187], a[84:87], v[252:255]
buffer_load_dwordx4 v23, s[24:27], s66 offen offset:1024 lds
ds_read_b64_tr_b16 a[180:181], v8 offset:40960
v_mfma_f32_16x16x32_bf16 v[252:255], a[188:191], a[100:103], v[252:255]
ds_read_b64_tr_b16 a[182:183], v8 offset:41984
v_add_u32 v9, 0x8000, v9
v_mfma_f32_16x16x32_bf16 v[60:63], a[188:191], a[96:99], v[60:63]
v_mfma_f32_16x16x32_bf16 v[60:63], a[184:187], a[80:83], v[60:63]
s_waitcnt lgkmcnt(8)
v_mfma_f32_16x16x32_bf16 v[32:35], a[160:163], a[112:115], v[32:35]
ds_read_b64_tr_b16 a[184:185], v9 offset:32768
v_mfma_f32_16x16x32_bf16 v[32:35], a[164:167], a[128:131], v[32:35]
ds_read_b64_tr_b16 a[186:187], v9 offset:33792
v_mfma_f32_16x16x32_bf16 v[208:211], a[164:167], a[132:135], v[208:211]
ds_read_b64_tr_b16 a[188:189], v9 offset:40960
v_mfma_f32_16x16x32_bf16 v[208:211], a[160:163], a[116:119], v[208:211]
ds_read_b64_tr_b16 a[190:191], v9 offset:41984
v_add_u32 v10, 0x8000, v10
v_mfma_f32_16x16x32_bf16 v[132:135], a[160:163], a[120:123], v[132:135]
v_mfma_f32_16x16x32_bf16 v[132:135], a[164:167], a[136:139], v[132:135]
v_mfma_f32_16x16x32_bf16 v[68:71], a[164:167], a[140:143], v[68:71]
v_mfma_f32_16x16x32_bf16 v[68:71], a[160:163], a[124:127], v[68:71]
s_waitcnt lgkmcnt(8)
v_mfma_f32_16x16x32_bf16 v[76:79], a[168:171], a[124:127], v[76:79]
ds_read_b64_tr_b16 a[160:161], v10 offset:32768
v_mfma_f32_16x16x32_bf16 v[76:79], a[172:175], a[140:143], v[76:79]
ds_read_b64_tr_b16 a[162:163], v10 offset:33792
v_mfma_f32_16x16x32_bf16 v[140:143], a[172:175], a[136:139], v[140:143]
ds_read_b64_tr_b16 a[164:165], v10 offset:40960
v_mfma_f32_16x16x32_bf16 v[140:143], a[168:171], a[120:123], v[140:143]
s_add_u32 s76, s73, 0x1003000
ds_read_b64_tr_b16 a[166:167], v10 offset:41984
v_add_u32 v11, 0x8000, v11
v_mfma_f32_16x16x32_bf16 v[212:215], a[168:171], a[116:119], v[212:215]
buffer_store_dwordx4 v[184:187], v1, s[4:7], s76 offen offset:3072 sc1
v_mfma_f32_16x16x32_bf16 v[212:215], a[172:175], a[132:135], v[212:215]
v_mfma_f32_16x16x32_bf16 v[36:39], a[172:175], a[128:131], v[36:39]
v_mfma_f32_16x16x32_bf16 v[36:39], a[168:171], a[112:115], v[36:39]
s_waitcnt lgkmcnt(8)
v_mfma_f32_16x16x32_bf16 v[40:43], a[176:179], a[112:115], v[40:43]
ds_read_b64_tr_b16 a[168:169], v11 offset:32768
v_mfma_f32_16x16x32_bf16 v[40:43], a[180:183], a[128:131], v[40:43]
ds_read_b64_tr_b16 a[170:171], v11 offset:33792
v_mfma_f32_16x16x32_bf16 v[216:219], a[180:183], a[132:135], v[216:219]
ds_read_b64_tr_b16 a[172:173], v11 offset:40960
v_mfma_f32_16x16x32_bf16 v[216:219], a[176:179], a[116:119], v[216:219]
ds_read_b64_tr_b16 a[174:175], v11 offset:41984
v_add_u32 v12, 0x8000, v12
v_mfma_f32_16x16x32_bf16 v[148:151], a[176:179], a[120:123], v[148:151]
v_mfma_f32_16x16x32_bf16 v[148:151], a[180:183], a[136:139], v[148:151]
ds_read_b128 a[64:67], v24
v_mfma_f32_16x16x32_bf16 v[84:87], a[180:183], a[140:143], v[84:87]
ds_read_b128 a[80:83], v25
v_mfma_f32_16x16x32_bf16 v[84:87], a[176:179], a[124:127], v[84:87]
s_waitcnt lgkmcnt(10)
v_mfma_f32_16x16x32_bf16 v[92:95], a[184:187], a[124:127], v[92:95]
ds_read_b64_tr_b16 a[176:177], v12 offset:32768
v_mfma_f32_16x16x32_bf16 v[92:95], a[188:191], a[140:143], v[92:95]
ds_read_b64_tr_b16 a[178:179], v12 offset:33792
v_mfma_f32_16x16x32_bf16 v[156:159], a[188:191], a[136:139], v[156:159]
ds_read_b64_tr_b16 a[180:181], v12 offset:40960
v_mfma_f32_16x16x32_bf16 v[156:159], a[184:187], a[120:123], v[156:159]
ds_read_b64_tr_b16 a[182:183], v12 offset:41984
v_add_u32 v13, 0x8000, v13
v_mfma_f32_16x16x32_bf16 v[220:223], a[184:187], a[116:119], v[220:223]
v_mfma_f32_16x16x32_bf16 v[220:223], a[188:191], a[132:135], v[220:223]
v_mfma_f32_16x16x32_bf16 v[44:47], a[188:191], a[128:131], v[44:47]
v_mfma_f32_16x16x32_bf16 v[44:47], a[184:187], a[112:115], v[44:47]
s_waitcnt lgkmcnt(10)
v_mfma_f32_16x16x32_bf16 v[48:51], a[160:163], a[112:115], v[48:51]
s_lshl_b32 s88, s48, 13
s_add_u32 s88, s88, L_adX-L_pc
v_lshlrev_b32 v30, 7, v0
v_add_u32 v30, s88, v30
v_min_u32 v30, L_codeend-L_pc-4, v30
global_load_dword v29, v30, s[98:99]
v_mfma_f32_16x16x32_bf16 v[48:51], a[164:167], a[128:131], v[48:51]
ds_read_b64_tr_b16 a[184:185], v13 offset:32768
v_mfma_f32_16x16x32_bf16 v[240:243], a[164:167], a[132:135], v[240:243]
s_add_u32 s76, s73, 0x3000
s_waitcnt vmcnt(20)
ds_read_b128 a[68:71], v24 offset:2048
v_mfma_f32_16x16x32_bf16 v[240:243], a[160:163], a[116:119], v[240:243]
buffer_store_dwordx4 v[236:239], v1, s[4:7], s76 offen offset:1024 sc1
ds_read_b128 a[84:87], v25 offset:2048
v_mfma_f32_16x16x32_bf16 v[164:167], a[160:163], a[120:123], v[164:167]
ds_read_b64_tr_b16 a[186:187], v13 offset:33792
v_mfma_f32_16x16x32_bf16 v[164:167], a[164:167], a[136:139], v[164:167]
ds_read_b64_tr_b16 a[188:189], v13 offset:40960
v_mfma_f32_16x16x32_bf16 v[100:103], a[164:167], a[140:143], v[100:103]
ds_read_b64_tr_b16 a[190:191], v13 offset:41984
v_mfma_f32_16x16x32_bf16 v[100:103], a[160:163], a[124:127], v[100:103]
s_waitcnt lgkmcnt(12)
v_mfma_f32_16x16x32_bf16 v[108:111], a[168:171], a[124:127], v[108:111]
ds_read_b64_tr_b16 a[160:161], v6 offset:49152
v_mfma_f32_16x16x32_bf16 v[108:111], a[172:175], a[140:143], v[108:111]
s_waitcnt vmcnt(19)
ds_read_b128 a[72:75], v24 offset:4096
v_mfma_f32_16x16x32_bf16 v[172:175], a[172:175], a[136:139], v[172:175]
ds_read_b128 a[88:91], v25 offset:4096
v_mfma_f32_16x16x32_bf16 v[172:175], a[168:171], a[120:123], v[172:175]
ds_read_b64_tr_b16 a[162:163], v6 offset:50176
v_mfma_f32_16x16x32_bf16 v[244:247], a[168:171], a[116:119], v[244:247]
ds_read_b64_tr_b16 a[164:165], v6 offset:57344
v_mfma_f32_16x16x32_bf16 v[244:247], a[172:175], a[132:135], v[244:247]
ds_read_b64_tr_b16 a[166:167], v6 offset:58368
v_mfma_f32_16x16x32_bf16 v[52:55], a[172:175], a[128:131], v[52:55]
v_mfma_f32_16x16x32_bf16 v[52:55], a[168:171], a[112:115], v[52:55]
s_waitcnt lgkmcnt(12)
v_mfma_f32_16x16x32_bf16 v[56:59], a[176:179], a[112:115], v[56:59]
s_waitcnt vmcnt(9)
v_cmp_ne_u32 vcc, v28, v18
s_nop 1
s_cbranch_vccnz L_spin_fb
L_back_fb:
v_mfma_f32_16x16x32_bf16 v[56:59], a[180:183], a[128:131], v[56:59]
ds_read_b64_tr_b16 a[168:169], v7 offset:49152
v_mfma_f32_16x16x32_bf16 v[248:251], a[180:183], a[132:135], v[248:251]
s_min_u32 s74, s48, 2
s_lshl_b32 s74, s74, 3
s_add_u32 s74, s74, s54
s_lshl_b32 s74, s74, 7
v_mfma_f32_16x16x32_bf16 v[248:251], a[176:179], a[116:119], v[248:251]
ds_read_b128 a[76:79], v24 offset:6144
v_lshrrev_b32 v27, 3, v0
v_mfma_f32_16x16x32_bf16 v[180:183], a[176:179], a[120:123], v[180:183]
ds_read_b128 a[92:95], v25 offset:6144
v_lshlrev_b32 v27, 12, v27
v_mfma_f32_16x16x32_bf16 v[180:183], a[180:183], a[136:139], v[180:183]
v_and_b32 v104, 0x70, v1
v_add_u32 v27, v27, v104
v_mfma_f32_16x16x32_bf16 v[116:119], a[180:183], a[140:143], v[116:119]
s_lshl_b32 s77, s53, 15
s_add_u32 s77, s77, s74
s_add_u32 s77, s77, 0x4c00000
v_mfma_f32_16x16x32_bf16 v[116:119], a[176:179], a[124:127], v[116:119]
s_waitcnt lgkmcnt(9)
buffer_load_dwordx4 v[96:99], v27, s[4:7], s77 offen sc1
ds_read_b64_tr_b16 a[170:171], v7 offset:50176
v_mfma_f32_16x16x32_bf16 v[124:127], a[184:187], a[124:127], v[124:127]
s_add_u32 s76, s73, 0
ds_read_b64_tr_b16 a[172:173], v7 offset:57344
v_mfma_f32_16x16x32_bf16 v[124:127], a[188:191], a[140:143], v[124:127]
buffer_store_dwordx4 v[64:67], v1, s[4:7], s76 offen offset:2048 sc1
ds_read_b64_tr_b16 a[174:175], v7 offset:58368
v_mfma_f32_16x16x32_bf16 v[188:191], a[188:191], a[136:139], v[188:191]
ds_read_b64_tr_b16 a[176:177], v8 offset:49152
v_mfma_f32_16x16x32_bf16 v[188:191], a[184:187], a[120:123], v[188:191]
ds_read_b64_tr_b16 a[178:179], v8 offset:50176
v_mfma_f32_16x16x32_bf16 v[252:255], a[184:187], a[116:119], v[252:255]
ds_read_b64_tr_b16 a[180:181], v8 offset:57344
v_mfma_f32_16x16x32_bf16 v[252:255], a[188:191], a[132:135], v[252:255]
ds_read_b64_tr_b16 a[182:183], v8 offset:58368
v_mfma_f32_16x16x32_bf16 v[60:63], a[188:191], a[128:131], v[60:63]
v_mfma_f32_16x16x32_bf16 v[60:63], a[184:187], a[112:115], v[60:63]
s_waitcnt lgkmcnt(8)
v_mfma_f32_16x16x32_bf16 v[32:35], a[160:163], a[144:147], v[32:35]
ds_read_b64_tr_b16 a[184:185], v9 offset:49152
v_mfma_f32_16x16x32_bf16 v[32:35], a[164:167], a[64:67], v[32:35]
ds_read_b64_tr_b16 a[186:187], v9 offset:50176
v_mfma_f32_16x16x32_bf16 v[208:211], a[164:167], a[68:71], v[208:211]
ds_read_b64_tr_b16 a[188:189], v9 offset:57344
v_mfma_f32_16x16x32_bf16 v[208:211], a[160:163], a[148:151], v[208:211]
ds_read_b64_tr_b16 a[190:191], v9 offset:58368
v_mfma_f32_16x16x32_bf16 v[132:135], a[160:163], a[152:155], v[132:135]
v_mfma_f32_16x16x32_bf16 v[132:135], a[164:167], a[72:75], v[132:135]
v_mfma_f32_16x16x32_bf16 v[68:71], a[164:167], a[76:79], v[68:71]
v_mfma_f32_16x16x32_bf16 v[68:71], a[160:163], a[156:159], v[68:71]
s_waitcnt lgkmcnt(8)
v_mfma_f32_16x16x32_bf16 v[76:79], a[168:171], a[156:159], v[76:79]
ds_read_b64_tr_b16 a[160:161], v10 offset:49152
v_mfma_f32_16x16x32_bf16 v[76:79], a[172:175], a[76:79], v[76:79]
ds_read_b64_tr_b16 a[162:163], v10 offset:50176
v_mfma_f32_16x16x32_bf16 v[140:143], a[172:175], a[72:75], v[140:143]
ds_read_b64_tr_b16 a[164:165], v10 offset:57344
v_mfma_f32_16x16x32_bf16 v[140:143], a[168:171], a[152:155], v[140:143]
ds_read_b64_tr_b16 a[166:167], v10 offset:58368
v_mfma_f32_16x16x32_bf16 v[212:215], a[168:171], a[148:151], v[212:215]
v_mfma_f32_16x16x32_bf16 v[212:215], a[172:175], a[68:71], v[212:215]
s_waitcnt lgkmcnt(8)
v_mfma_f32_16x16x32_bf16 v[36:39], a[172:175], a[64:67], v[36:39]
s_add_u32 s76, s73, 0x1000
L_cp1500:
v_mfma_f32_16x16x32_bf16 v[36:39], a[168:171], a[144:147], v[36:39]
s_lshl_b32 s78, s49, 7
s_add_u32 s78, s78, 0x5000000
v_and_b32 v3, 28, v21
v_mfma_f32_16x16x32_bf16 v[40:43], a[176:179], a[144:147], v[40:43]
buffer_store_dwordx4 v[72:75], v1, s[4:7], s76 offen offset:2048 sc1
ds_read_b64_tr_b16 a[168:169], v11 offset:49152
v_mfma_f32_16x16x32_bf16 v[40:43], a[180:183], a[64:67], v[40:43]
buffer_load_dword v19, v3, s[4:7], s78 offen sc1
ds_read_b64_tr_b16 a[170:171], v11 offset:50176
v_mfma_f32_16x16x32_bf16 v[216:219], a[180:183], a[68:71], v[216:219]
ds_read_b64_tr_b16 a[172:173], v11 offset:57344
v_mfma_f32_16x16x32_bf16 v[216:219], a[176:179], a[148:151], v[216:219]
ds_read_b64_tr_b16 a[174:175], v11 offset:58368
v_mfma_f32_16x16x32_bf16 v[148:151], a[176:179], a[152:155], v[148:151]
v_mfma_f32_16x16x32_bf16 v[148:151], a[180:183], a[72:75], v[148:151]
v_mfma_f32_16x16x32_bf16 v[84:87], a[180:183], a[76:79], v[84:87]
ds_read_b128 a[96:99], v24 offset:32768
v_mfma_f32_16x16x32_bf16 v[84:87], a[176:179], a[156:159], v[84:87]
s_waitcnt lgkmcnt(9)
ds_read_b128 a[112:115], v25 offset:32768
v_mfma_f32_16x16x32_bf16 v[92:95], a[184:187], a[156:159], v[92:95]
ds_read_b64_tr_b16 a[176:177], v12 offset:49152
v_mfma_f32_16x16x32_bf16 v[92:95], a[188:191], a[76:79], v[92:95]
ds_read_b64_tr_b16 a[178:179], v12 offset:50176
v_mfma_f32_16x16x32_bf16 v[156:159], a[188:191], a[72:75], v[156:159]
ds_read_b64_tr_b16 a[180:181], v12 offset:57344
v_mfma_f32_16x16x32_bf16 v[156:159], a[184:187], a[152:155], v[156:159]
ds_read_b64_tr_b16 a[182:183], v12 offset:58368
v_mfma_f32_16x16x32_bf16 v[220:223], a[184:187], a[148:151], v[220:223]
v_mfma_f32_16x16x32_bf16 v[220:223], a[188:191], a[68:71], v[220:223]
v_mfma_f32_16x16x32_bf16 v[44:47], a[188:191], a[64:67], v[44:47]
v_mfma_f32_16x16x32_bf16 v[44:47], a[184:187], a[144:147], v[44:47]
s_waitcnt lgkmcnt(10)
v_mfma_f32_16x16x32_bf16 v[48:51], a[160:163], a[144:147], v[48:51]
ds_read_b64_tr_b16 a[184:185], v13 offset:49152
v_mfma_f32_16x16x32_bf16 v[48:51], a[164:167], a[64:67], v[48:51]
ds_read_b64_tr_b16 a[186:187], v13 offset:50176
v_mfma_f32_16x16x32_bf16 v[240:243], a[164:167], a[68:71], v[240:243]
s_waitcnt vmcnt(12)
ds_read_b128 a[100:103], v24 offset:34816
v_mfma_f32_16x16x32_bf16 v[240:243], a[160:163], a[148:151], v[240:243]
ds_read_b128 a[116:119], v25 offset:34816
v_mfma_f32_16x16x32_bf16 v[164:167], a[160:163], a[152:155], v[164:167]
ds_read_b64_tr_b16 a[188:189], v13 offset:57344
v_mfma_f32_16x16x32_bf16 v[164:167], a[164:167], a[72:75], v[164:167]
s_add_u32 s76, s73, 0x2000
ds_read_b64_tr_b16 a[190:191], v13 offset:58368
v_mfma_f32_16x16x32_bf16 v[100:103], a[164:167], a[76:79], v[100:103]
buffer_store_dwordx4 v[80:83], v1, s[4:7], s76 offen offset:2048 sc1
v_mfma_f32_16x16x32_bf16 v[100:103], a[160:163], a[156:159], v[100:103]
s_waitcnt lgkmcnt(12)
v_mfma_f32_16x16x32_bf16 v[108:111], a[168:171], a[156:159], v[108:111]
v_mfma_f32_16x16x32_bf16 v[108:111], a[172:175], a[76:79], v[108:111]
v_mfma_f32_16x16x32_bf16 v[172:175], a[172:175], a[72:75], v[172:175]
v_mfma_f32_16x16x32_bf16 v[172:175], a[168:171], a[152:155], v[172:175]
s_waitcnt vmcnt(11)
ds_read_b128 a[104:107], v24 offset:36864
v_mfma_f32_16x16x32_bf16 v[244:247], a[168:171], a[148:151], v[244:247]
ds_read_b128 a[120:123], v25 offset:36864
v_mfma_f32_16x16x32_bf16 v[244:247], a[172:175], a[68:71], v[244:247]
v_mfma_f32_16x16x32_bf16 v[52:55], a[172:175], a[64:67], v[52:55]
v_mfma_f32_16x16x32_bf16 v[52:55], a[168:171], a[144:147], v[52:55]
s_waitcnt lgkmcnt(2)
v_mfma_f32_16x16x32_bf16 v[56:59], a[176:179], a[144:147], v[56:59]
s_barrier
v_mfma_f32_16x16x32_bf16 v[56:59], a[180:183], a[64:67], v[56:59]
ds_read_b64_tr_b16 a[160:161], v6
v_mfma_f32_16x16x32_bf16 v[248:251], a[180:183], a[68:71], v[248:251]
ds_read_b64_tr_b16 a[162:163], v6 offset:1024
v_mfma_f32_16x16x32_bf16 v[248:251], a[176:179], a[148:151], v[248:251]
ds_read_b64_tr_b16 a[164:165], v6 offset:8192
v_mfma_f32_16x16x32_bf16 v[180:183], a[176:179], a[152:155], v[180:183]
s_waitcnt vmcnt(8)
ds_read_b128 a[108:111], v24 offset:38912
v_mfma_f32_16x16x32_bf16 v[180:183], a[180:183], a[72:75], v[180:183]
ds_read_b128 a[124:127], v25 offset:38912
v_mfma_f32_16x16x32_bf16 v[116:119], a[180:183], a[76:79], v[116:119]
ds_read_b64_tr_b16 a[166:167], v6 offset:9216
v_mfma_f32_16x16x32_bf16 v[116:119], a[176:179], a[156:159], v[116:119]
ds_read_b64_tr_b16 a[168:169], v7
v_mfma_f32_16x16x32_bf16 v[124:127], a[184:187], a[156:159], v[124:127]
ds_read_b64_tr_b16 a[170:171], v7 offset:1024
v_mfma_f32_16x16x32_bf16 v[124:127], a[188:191], a[76:79], v[124:127]
s_lshl_b32 s59, s48, 12
s_add_u32 s59, s59, 0x8000
ds_read_b64_tr_b16 a[172:173], v7 offset:8192
v_mfma_f32_16x16x32_bf16 v[188:191], a[188:191], a[72:75], v[188:191]
ds_read_b64_tr_b16 a[174:175], v7 offset:9216
v_mfma_f32_16x16x32_bf16 v[188:191], a[184:187], a[152:155], v[188:191]
s_add_u32 s76, s73, 0x3000
ds_read_b64_tr_b16 a[176:177], v8
v_mfma_f32_16x16x32_bf16 v[252:255], a[184:187], a[148:151], v[252:255]
buffer_store_dwordx4 v[88:91], v1, s[4:7], s76 offen offset:2048 sc1
ds_read_b64_tr_b16 a[178:179], v8 offset:1024
v_mfma_f32_16x16x32_bf16 v[252:255], a[188:191], a[68:71], v[252:255]
ds_read_b64_tr_b16 a[180:181], v8 offset:8192
v_mfma_f32_16x16x32_bf16 v[60:63], a[188:191], a[64:67], v[60:63]
ds_read_b64_tr_b16 a[182:183], v8 offset:9216
v_mfma_f32_16x16x32_bf16 v[60:63], a[184:187], a[144:147], v[60:63]
s_waitcnt lgkmcnt(8)
v_mfma_f32_16x16x32_bf16 v[32:35], a[160:163], a[80:83], v[32:35]
v_cmp_gt_u32_e64 s[82:83], 8, v0
v_mov_b32 v104, 0x40000000
s_nop 0
v_cndmask_b32_e64 v27, v104, v1, s[82:83]
v_mfma_f32_16x16x32_bf16 v[32:35], a[164:167], a[96:99], v[32:35]
s_waitcnt vmcnt(5)
v_add_f32_dpp v96, v96, v96 row_ror:8 row_mask:0xf bank_mask:0xf
v_add_f32_dpp v97, v97, v97 row_ror:8 row_mask:0xf bank_mask:0xf
v_mfma_f32_16x16x32_bf16 v[208:211], a[164:167], a[100:103], v[208:211]
v_add_f32_dpp v98, v98, v98 row_ror:8 row_mask:0xf bank_mask:0xf
v_add_f32_dpp v99, v99, v99 row_ror:8 row_mask:0xf bank_mask:0xf
v_mfma_f32_16x16x32_bf16 v[208:211], a[160:163], a[84:87], v[208:211]
v_mov_b32 v104, v96
v_mov_b32 v105, v97
v_mfma_f32_16x16x32_bf16 v[132:135], a[160:163], a[88:91], v[132:135]
v_mov_b32 v106, v98
v_mov_b32 v107, v99
v_mfma_f32_16x16x32_bf16 v[132:135], a[164:167], a[104:107], v[132:135]
s_nop 0
v_permlane16_swap_b32 v96, v104
v_mfma_f32_16x16x32_bf16 v[68:71], a[164:167], a[108:111], v[68:71]
v_permlane16_swap_b32 v97, v105
v_permlane16_swap_b32 v98, v106
v_mfma_f32_16x16x32_bf16 v[68:71], a[160:163], a[92:95], v[68:71]
s_waitcnt lgkmcnt(4)
v_permlane16_swap_b32 v99, v107
v_add_f32 v96, v96, v104
v_mfma_f32_16x16x32_bf16 v[76:79], a[168:171], a[92:95], v[76:79]
v_add_f32 v97, v97, v105
v_add_f32 v98, v98, v106
v_mfma_f32_16x16x32_bf16 v[76:79], a[172:175], a[108:111], v[76:79]
v_add_f32 v99, v99, v107
v_mov_b32 v104, v96
v_mfma_f32_16x16x32_bf16 v[140:143], a[172:175], a[104:107], v[140:143]
ds_read_b64_tr_b16 a[184:185], v9
v_mov_b32 v105, v97
v_mfma_f32_16x16x32_bf16 v[140:143], a[168:171], a[88:91], v[140:143]
ds_read_b64_tr_b16 a[186:187], v9 offset:1024
v_mov_b32 v106, v98
v_mfma_f32_16x16x32_bf16 v[212:215], a[168:171], a[84:87], v[212:215]
ds_read_b64_tr_b16 a[188:189], v9 offset:8192
v_mov_b32 v107, v99
v_mfma_f32_16x16x32_bf16 v[212:215], a[172:175], a[100:103], v[212:215]
ds_read_b64_tr_b16 a[190:191], v9 offset:9216
v_mfma_f32_16x16x32_bf16 v[36:39], a[172:175], a[96:99], v[36:39]
s_nop 0
v_permlane32_swap_b32 v96, v104
v_mfma_f32_16x16x32_bf16 v[36:39], a[168:171], a[80:83], v[36:39]
s_waitcnt lgkmcnt(4)
v_permlane32_swap_b32 v97, v105
v_permlane32_swap_b32 v98, v106
v_mfma_f32_16x16x32_bf16 v[40:43], a[176:179], a[80:83], v[40:43]
v_permlane32_swap_b32 v99, v107
v_add_f32 v96, v96, v104
v_mfma_f32_16x16x32_bf16 v[40:43], a[180:183], a[96:99], v[40:43]
s_add_u32 s76, s73, 0
ds_read_b64_tr_b16 a[160:161], v10
v_add_f32 v97, v97, v105
v_mfma_f32_16x16x32_bf16 v[216:219], a[180:183], a[100:103], v[216:219]
buffer_store_dwordx4 v[128:131], v1, s[4:7], s76 offen offset:3072 sc1
ds_read_b64_tr_b16 a[162:163], v10 offset:1024
v_mfma_f32_16x16x32_bf16 v[216:219], a[176:179], a[84:87], v[216:219]
ds_read_b64_tr_b16 a[164:165], v10 offset:8192
v_add_f32 v98, v98, v106
v_mfma_f32_16x16x32_bf16 v[148:151], a[176:179], a[88:91], v[148:151]
ds_read_b64_tr_b16 a[166:167], v10 offset:9216
v_add_f32 v99, v99, v107
v_mfma_f32_16x16x32_bf16 v[148:151], a[180:183], a[104:107], v[148:151]
s_lshl_b32 s77, s53, 12
s_add_u32 s77, s77, s74
s_add_u32 s77, s77, 0x4e00000
v_mfma_f32_16x16x32_bf16 v[84:87], a[180:183], a[108:111], v[84:87]
buffer_store_dwordx4 v[96:99], v27, s[4:7], s77 offen sc1
s_add_u32 s0, s87, 0x500a000
v_mfma_f32_16x16x32_bf16 v[84:87], a[176:179], a[92:95], v[84:87]
s_waitcnt vmcnt(4) lgkmcnt(4)
v_cmp_ne_u32 vcc, v19, v18
s_nop 1
s_cbranch_vccnz L_spin_kv
L_back_kv:
v_mfma_f32_16x16x32_bf16 v[92:95], a[184:187], a[92:95], v[92:95]
ds_read_b64_tr_b16 a[168:169], v11
v_mfma_f32_16x16x32_bf16 v[92:95], a[188:191], a[108:111], v[92:95]
s_add_u32 m0, s59, 0xffff8000
ds_read_b64_tr_b16 a[170:171], v11 offset:1024
v_mfma_f32_16x16x32_bf16 v[156:159], a[188:191], a[104:107], v[156:159]
buffer_load_dwordx4 v1, s[4:7], s89 offen sc1 lds
ds_read_b64_tr_b16 a[172:173], v11 offset:8192
v_mfma_f32_16x16x32_bf16 v[156:159], a[184:187], a[88:91], v[156:159]
ds_read_b64_tr_b16 a[174:175], v11 offset:9216
v_mfma_f32_16x16x32_bf16 v[220:223], a[184:187], a[84:87], v[220:223]
s_add_u32 m0, s59, 0xffff8000
ds_read_b64_tr_b16 a[176:177], v12
v_mfma_f32_16x16x32_bf16 v[220:223], a[188:191], a[100:103], v[220:223]
buffer_load_dwordx4 v1, s[4:7], s89 offen offset:1024 sc1 lds
ds_read_b64_tr_b16 a[178:179], v12 offset:1024
v_mfma_f32_16x16x32_bf16 v[44:47], a[188:191], a[96:99], v[44:47]
s_waitcnt lgkmcnt(6)
ds_read_b64_tr_b16 a[180:181], v12 offset:8192
v_mfma_f32_16x16x32_bf16 v[44:47], a[184:187], a[80:83], v[44:47]
s_add_u32 m0, s59, 0xffff8000
ds_read_b64_tr_b16 a[182:183], v12 offset:9216
v_mfma_f32_16x16x32_bf16 v[48:51], a[160:163], a[80:83], v[48:51]
buffer_load_dwordx4 v1, s[4:7], s89 offen offset:2048 sc1 lds
ds_read_b64_tr_b16 a[184:185], v13
v_mfma_f32_16x16x32_bf16 v[48:51], a[164:167], a[96:99], v[48:51]
ds_read_b64_tr_b16 a[186:187], v13 offset:1024
v_mfma_f32_16x16x32_bf16 v[240:243], a[164:167], a[100:103], v[240:243]
s_add_u32 m0, s59, 0xffff8000
ds_read_b64_tr_b16 a[188:189], v13 offset:8192
v_mfma_f32_16x16x32_bf16 v[240:243], a[160:163], a[84:87], v[240:243]
buffer_load_dwordx4 v1, s[4:7], s89 offen offset:3072 sc1 lds
ds_read_b64_tr_b16 a[190:191], v13 offset:9216
v_mfma_f32_16x16x32_bf16 v[164:167], a[160:163], a[88:91], v[164:167]
s_add_u32 s89, s89, 0x4000
v_mfma_f32_16x16x32_bf16 v[164:167], a[164:167], a[104:107], v[164:167]
v_mfma_f32_16x16x32_bf16 v[100:103], a[164:167], a[108:111], v[100:103]
s_add_u32 m0, s59, 0x10000
v_mfma_f32_16x16x32_bf16 v[100:103], a[160:163], a[92:95], v[100:103]
s_waitcnt lgkmcnt(8)
buffer_load_dwordx4 v1, s[4:7], s89 offen sc1 lds
ds_read_b64_tr_b16 a[160:161], v6 offset:16384
v_mfma_f32_16x16x32_bf16 v[108:111], a[168:171], a[92:95], v[108:111]
ds_read_b64_tr_b16 a[162:163], v6 offset:17408
v_mfma_f32_16x16x32_bf16 v[108:111], a[172:175], a[108:111], v[108:111]
ds_read_b64_tr_b16 a[164:165], v7 offset:16384
v_mfma_f32_16x16x32_bf16 v[172:175], a[172:175], a[104:107], v[172:175]
s_add_u32 s76, s73, 0x1000
ds_read_b64_tr_b16 a[166:167], v7 offset:17408
v_mfma_f32_16x16x32_bf16 v[172:175], a[168:171], a[88:91], v[172:175]
buffer_store_dwordx4 v[136:139], v1, s[4:7], s76 offen offset:3072 sc1
v_mfma_f32_16x16x32_bf16 v[244:247], a[168:171], a[84:87], v[244:247]
s_add_u32 m0, s59, 0x10000
v_mfma_f32_16x16x32_bf16 v[244:247], a[172:175], a[100:103], v[244:247]
buffer_load_dwordx4 v1, s[4:7], s89 offen offset:1024 sc1 lds
v_mfma_f32_16x16x32_bf16 v[52:55], a[172:175], a[96:99], v[52:55]
s_waitcnt lgkmcnt(8)
v_mfma_f32_16x16x32_bf16 v[52:55], a[168:171], a[80:83], v[52:55]
s_add_u32 m0, s59, 0x10000
ds_read_b64_tr_b16 a[168:169], v8 offset:16384
v_mfma_f32_16x16x32_bf16 v[56:59], a[176:179], a[80:83], v[56:59]
buffer_load_dwordx4 v1, s[4:7], s89 offen offset:2048 sc1 lds
ds_read_b64_tr_b16 a[170:171], v8 offset:17408
v_mfma_f32_16x16x32_bf16 v[56:59], a[180:183], a[96:99], v[56:59]
s_add_u32 m0, s59, 0x10000
ds_read_b64_tr_b16 a[172:173], v9 offset:16384
v_mfma_f32_16x16x32_bf16 v[248:251], a[180:183], a[100:103], v[248:251]
buffer_load_dwordx4 v1, s[4:7], s89 offen offset:3072 sc1 lds
ds_read_b64_tr_b16 a[174:175], v9 offset:17408
v_mfma_f32_16x16x32_bf16 v[248:251], a[176:179], a[84:87], v[248:251]
s_add_u32 s89, s89, 0x4000
v_mfma_f32_16x16x32_bf16 v[180:183], a[176:179], a[88:91], v[180:183]
v_mfma_f32_16x16x32_bf16 v[180:183], a[180:183], a[104:107], v[180:183]
v_mfma_f32_16x16x32_bf16 v[116:119], a[180:183], a[108:111], v[116:119]
s_add_u32 m0, s59, 0x14000
v_mfma_f32_16x16x32_bf16 v[116:119], a[176:179], a[92:95], v[116:119]
s_waitcnt lgkmcnt(8)
buffer_load_dwordx4 v1, s[4:7], s90 offen sc1 lds
ds_read_b64_tr_b16 a[176:177], v10 offset:16384
v_mfma_f32_16x16x32_bf16 v[124:127], a[184:187], a[92:95], v[124:127]
ds_read_b64_tr_b16 a[178:179], v10 offset:17408
v_mfma_f32_16x16x32_bf16 v[124:127], a[188:191], a[108:111], v[124:127]
s_add_u32 m0, s59, 0x14000
ds_read_b64_tr_b16 a[180:181], v11 offset:16384
v_mfma_f32_16x16x32_bf16 v[188:191], a[188:191], a[104:107], v[188:191]
buffer_load_dwordx4 v1, s[4:7], s90 offen offset:1024 sc1 lds
ds_read_b64_tr_b16 a[182:183], v11 offset:17408
v_mfma_f32_16x16x32_bf16 v[188:191], a[184:187], a[88:91], v[188:191]
v_mfma_f32_16x16x32_bf16 v[252:255], a[184:187], a[84:87], v[252:255]
v_mfma_f32_16x16x32_bf16 v[252:255], a[188:191], a[100:103], v[252:255]
s_add_u32 m0, s59, 0x14000
v_mfma_f32_16x16x32_bf16 v[60:63], a[188:191], a[96:99], v[60:63]
buffer_load_dwordx4 v1, s[4:7], s90 offen offset:2048 sc1 lds
v_mfma_f32_16x16x32_bf16 v[60:63], a[184:187], a[80:83], v[60:63]
s_waitcnt lgkmcnt(3)
ds_read_b64_tr_b16 a[184:185], v12 offset:16384
v_mfma_f32_16x16x32_bf16 v[32:35], a[160:163], a[112:115], v[32:35]
s_add_u32 s76, s73, 0x2000
ds_read_b64_tr_b16 a[186:187], v12 offset:17408
v_add_u32 v2, 0x8000, v1
v_mfma_f32_16x16x32_bf16 v[36:39], a[164:167], a[112:115], v[36:39]
s_add_u32 m0, s59, 0x14000
ds_read_b64_tr_b16 a[188:189], v13 offset:16384
buffer_store_dwordx4 v[144:147], v1, s[4:7], s76 offen offset:3072 sc1
v_mfma_f32_16x16x32_bf16 v[40:43], a[168:171], a[112:115], v[40:43]
s_waitcnt lgkmcnt(3)
ds_read_b64_tr_b16 a[190:191], v13 offset:17408
buffer_load_dwordx4 v1, s[4:7], s90 offen offset:3072 sc1 lds
v_mfma_f32_16x16x32_bf16 v[44:47], a[172:175], a[112:115], v[44:47]
s_add_u32 s90, s90, 0x4000
v_mfma_f32_16x16x32_bf16 v[48:51], a[176:179], a[112:115], v[48:51]
v_mfma_f32_16x16x32_bf16 v[52:55], a[180:183], a[112:115], v[52:55]
s_waitcnt lgkmcnt(2)
v_mfma_f32_16x16x32_bf16 v[56:59], a[184:187], a[112:115], v[56:59]
s_waitcnt lgkmcnt(0)
v_mfma_f32_16x16x32_bf16 v[60:63], a[188:191], a[112:115], v[60:63]
v_mfma_f32_16x16x32_bf16 v[208:211], a[160:163], a[116:119], v[208:211]
v_mfma_f32_16x16x32_bf16 v[212:215], a[164:167], a[116:119], v[212:215]
v_mfma_f32_16x16x32_bf16 v[216:219], a[168:171], a[116:119], v[216:219]
v_mfma_f32_16x16x32_bf16 v[220:223], a[172:175], a[116:119], v[220:223]
v_mfma_f32_16x16x32_bf16 v[240:243], a[176:179], a[116:119], v[240:243]
v_cvt_pk_bf16_f32 v32, v32, v33
v_cvt_pk_bf16_f32 v33, v34, v35
v_mfma_f32_16x16x32_bf16 v[244:247], a[180:183], a[116:119], v[244:247]
v_cvt_pk_bf16_f32 v34, v36, v37
v_cvt_pk_bf16_f32 v35, v38, v39
v_mfma_f32_16x16x32_bf16 v[248:251], a[184:187], a[116:119], v[248:251]
v_accvgpr_write_b32 a0, v32
v_accvgpr_write_b32 a1, v33
v_mfma_f32_16x16x32_bf16 v[252:255], a[188:191], a[116:119], v[252:255]
v_accvgpr_write_b32 a2, v34
v_accvgpr_write_b32 a3, v35
v_mfma_f32_16x16x32_bf16 v[132:135], a[160:163], a[120:123], v[132:135]
v_cvt_pk_bf16_f32 v40, v40, v41
v_cvt_pk_bf16_f32 v41, v42, v43
v_mfma_f32_16x16x32_bf16 v[140:143], a[164:167], a[120:123], v[140:143]
v_cvt_pk_bf16_f32 v42, v44, v45
v_cvt_pk_bf16_f32 v43, v46, v47
v_mfma_f32_16x16x32_bf16 v[148:151], a[168:171], a[120:123], v[148:151]
v_accvgpr_write_b32 a4, v40
v_accvgpr_write_b32 a5, v41
v_mfma_f32_16x16x32_bf16 v[156:159], a[172:175], a[120:123], v[156:159]
v_accvgpr_write_b32 a6, v42
v_accvgpr_write_b32 a7, v43
v_mfma_f32_16x16x32_bf16 v[164:167], a[176:179], a[120:123], v[164:167]
s_waitcnt vmcnt(10)
s_barrier
v_mfma_f32_16x16x32_bf16 v[172:175], a[180:183], a[120:123], v[172:175]
s_add_u32 s76, s73, 0x3000
ds_read_b128 a[64:67], v1
ds_read_b128 a[68:71], v1 offset:1024
v_mfma_f32_16x16x32_bf16 v[180:183], a[184:187], a[120:123], v[180:183]
s_add_u32 m0, s59, 0x18000
buffer_store_dwordx4 v[152:155], v1, s[4:7], s76 offen offset:3072 sc1
ds_read_b128 a[72:75], v1 offset:2048
v_mfma_f32_16x16x32_bf16 v[188:191], a[188:191], a[120:123], v[188:191]
buffer_load_dwordx4 v1, s[4:7], s89 offen sc1 lds
ds_read_b128 a[76:79], v1 offset:3072
v_mfma_f32_16x16x32_bf16 v[68:71], a[160:163], a[124:127], v[68:71]
ds_read_b128 a[80:83], v1 offset:4096
ds_read_b128 a[84:87], v1 offset:5120
v_mfma_f32_16x16x32_bf16 v[76:79], a[164:167], a[124:127], v[76:79]
v_cvt_pk_bf16_f32 v48, v48, v49
v_cvt_pk_bf16_f32 v49, v50, v51
v_mfma_f32_16x16x32_bf16 v[84:87], a[168:171], a[124:127], v[84:87]
v_cvt_pk_bf16_f32 v50, v52, v53
v_cvt_pk_bf16_f32 v51, v54, v55
v_mfma_f32_16x16x32_bf16 v[92:95], a[172:175], a[124:127], v[92:95]
v_accvgpr_write_b32 a8, v48
v_accvgpr_write_b32 a9, v49
v_mfma_f32_16x16x32_bf16 v[100:103], a[176:179], a[124:127], v[100:103]
v_accvgpr_write_b32 a10, v50
v_accvgpr_write_b32 a11, v51
v_mfma_f32_16x16x32_bf16 v[108:111], a[180:183], a[124:127], v[108:111]
ds_read_b128 a[88:91], v1 offset:6144
buffer_load_dwordx4 v1, s[4:7], s89 offen offset:1024 sc1 lds
v_mfma_f32_16x16x32_bf16 v[116:119], a[184:187], a[124:127], v[116:119]
v_cvt_pk_bf16_f32 v56, v56, v57
v_cvt_pk_bf16_f32 v57, v58, v59
v_mfma_f32_16x16x32_bf16 v[124:127], a[188:191], a[124:127], v[124:127]
s_waitcnt lgkmcnt(5)
v_cvt_pk_bf16_f32 v58, v60, v61
v_cvt_pk_bf16_f32 v59, v62, v63
v_mfma_f32_16x16x32_bf16 v[32:35], a[64:67], a[0:3], 0
ds_read_b128 a[92:95], v1 offset:7168
v_accvgpr_write_b32 a12, v56
v_accvgpr_write_b32 a13, v57
v_accvgpr_write_b32 a14, v58
v_accvgpr_write_b32 a15, v59
v_mfma_f32_16x16x32_bf16 v[32:35], a[68:71], a[4:7], v[32:35]
s_waitcnt lgkmcnt(3)
buffer_load_dwordx4 v1, s[4:7], s89 offen offset:2048 sc1 lds
v_cvt_pk_bf16_f32 v208, v208, v209
v_mfma_f32_16x16x32_bf16 v[32:35], a[72:75], a[8:11], v[32:35]
v_cvt_pk_bf16_f32 v209, v210, v211
v_cvt_pk_bf16_f32 v210, v212, v213
v_mfma_f32_16x16x32_bf16 v[32:35], a[76:79], a[12:15], v[32:35]
v_cvt_pk_bf16_f32 v211, v214, v215
v_accvgpr_write_b32 a16, v208
v_mfma_f32_16x16x32_bf16 v[36:39], a[80:83], a[0:3], 0
s_waitcnt lgkmcnt(2)
v_accvgpr_write_b32 a17, v209
v_accvgpr_write_b32 a18, v210
v_mfma_f32_16x16x32_bf16 v[36:39], a[84:87], a[4:7], v[36:39]
s_waitcnt lgkmcnt(1)
v_accvgpr_write_b32 a19, v211
v_cvt_pk_bf16_f32 v216, v216, v217
v_mfma_f32_16x16x32_bf16 v[36:39], a[88:91], a[8:11], v[36:39]
s_waitcnt lgkmcnt(0)
v_cvt_pk_bf16_f32 v217, v218, v219
v_cvt_pk_bf16_f32 v218, v220, v221
v_cvt_pk_bf16_f32 v219, v222, v223
v_accvgpr_write_b32 a20, v216
v_accvgpr_write_b32 a21, v217
v_accvgpr_write_b32 a22, v218
v_accvgpr_write_b32 a23, v219
v_mfma_f32_16x16x32_bf16 v[36:39], a[92:95], a[12:15], v[36:39]
v_cvt_pk_bf16_f32 v240, v240, v241
v_cvt_pk_bf16_f32 v241, v242, v243
v_cvt_pk_bf16_f32 v242, v244, v245
v_cvt_pk_bf16_f32 v243, v246, v247
v_accvgpr_write_b32 a24, v240
v_accvgpr_write_b32 a25, v241
v_accvgpr_write_b32 a26, v242
v_accvgpr_write_b32 a27, v243
v_mfma_f32_16x16x32_bf16 v[40:43], a[64:67], a[16:19], 0
v_cvt_pk_bf16_f32 v248, v248, v249
v_cvt_pk_bf16_f32 v249, v250, v251
v_cvt_pk_bf16_f32 v250, v252, v253
v_cvt_pk_bf16_f32 v251, v254, v255
v_accvgpr_write_b32 a28, v248
v_accvgpr_write_b32 a29, v249
v_accvgpr_write_b32 a30, v250
v_accvgpr_write_b32 a31, v251
v_mfma_f32_16x16x32_bf16 v[40:43], a[68:71], a[20:23], v[40:43]
buffer_load_dwordx4 v1, s[4:7], s89 offen offset:3072 sc1 lds
s_add_u32 s89, s89, 0x4000
v_cvt_pk_bf16_f32 v132, v132, v133
v_mfma_f32_16x16x32_bf16 v[40:43], a[72:75], a[24:27], v[40:43]
v_cvt_pk_bf16_f32 v133, v134, v135
v_cvt_pk_bf16_f32 v134, v140, v141
v_mfma_f32_16x16x32_bf16 v[40:43], a[76:79], a[28:31], v[40:43]
s_add_u32 m0, s59, 0x1c000
v_cvt_pk_bf16_f32 v135, v142, v143
v_accvgpr_write_b32 a32, v132
v_mfma_f32_16x16x32_bf16 v[44:47], a[80:83], a[16:19], 0
v_accvgpr_write_b32 a33, v133
v_accvgpr_write_b32 a34, v134
v_mfma_f32_16x16x32_bf16 v[44:47], a[84:87], a[20:23], v[44:47]
v_accvgpr_write_b32 a35, v135
v_cvt_pk_bf16_f32 v148, v148, v149
v_mfma_f32_16x16x32_bf16 v[44:47], a[88:91], a[24:27], v[44:47]
v_cvt_pk_bf16_f32 v149, v150, v151
v_cvt_pk_bf16_f32 v150, v156, v157
v_cvt_pk_bf16_f32 v151, v158, v159
v_accvgpr_write_b32 a36, v148
v_accvgpr_write_b32 a37, v149
v_accvgpr_write_b32 a38, v150
v_accvgpr_write_b32 a39, v151
v_mfma_f32_16x16x32_bf16 v[44:47], a[92:95], a[28:31], v[44:47]
buffer_load_dwordx4 v1, s[4:7], s90 offen sc1 lds
v_cvt_pk_bf16_f32 v164, v164, v165
v_cvt_pk_bf16_f32 v165, v166, v167
v_cvt_pk_bf16_f32 v166, v172, v173
v_cvt_pk_bf16_f32 v167, v174, v175
v_accvgpr_write_b32 a40, v164
v_accvgpr_write_b32 a41, v165
v_accvgpr_write_b32 a42, v166
v_accvgpr_write_b32 a43, v167
v_mfma_f32_16x16x32_bf16 v[48:51], a[64:67], a[32:35], 0
v_cvt_pk_bf16_f32 v180, v180, v181
v_cvt_pk_bf16_f32 v181, v182, v183
v_cvt_pk_bf16_f32 v182, v188, v189
v_cvt_pk_bf16_f32 v183, v190, v191
v_accvgpr_write_b32 a44, v180
v_accvgpr_write_b32 a45, v181
v_accvgpr_write_b32 a46, v182
v_accvgpr_write_b32 a47, v183
v_mfma_f32_16x16x32_bf16 v[48:51], a[68:71], a[36:39], v[48:51]
buffer_load_dwordx4 v1, s[4:7], s90 offen offset:1024 sc1 lds
v_cvt_pk_bf16_f32 v68, v68, v69
v_mfma_f32_16x16x32_bf16 v[48:51], a[72:75], a[40:43], v[48:51]
v_cvt_pk_bf16_f32 v69, v70, v71
v_cvt_pk_bf16_f32 v70, v76, v77
v_mfma_f32_16x16x32_bf16 v[48:51], a[76:79], a[44:47], v[48:51]
v_cvt_pk_bf16_f32 v71, v78, v79
v_accvgpr_write_b32 a48, v68
v_mfma_f32_16x16x32_bf16 v[52:55], a[80:83], a[32:35], 0
v_accvgpr_write_b32 a49, v69
v_accvgpr_write_b32 a50, v70
v_mfma_f32_16x16x32_bf16 v[52:55], a[84:87], a[36:39], v[52:55]
v_accvgpr_write_b32 a51, v71
v_cvt_pk_bf16_f32 v84, v84, v85
v_mfma_f32_16x16x32_bf16 v[52:55], a[88:91], a[40:43], v[52:55]
v_cvt_pk_bf16_f32 v85, v86, v87
v_cvt_pk_bf16_f32 v86, v92, v93
v_cvt_pk_bf16_f32 v87, v94, v95
v_accvgpr_write_b32 a52, v84
v_accvgpr_write_b32 a53, v85
v_accvgpr_write_b32 a54, v86
v_accvgpr_write_b32 a55, v87
v_mfma_f32_16x16x32_bf16 v[52:55], a[92:95], a[44:47], v[52:55]
v_cvt_pk_bf16_f32 v100, v100, v101
v_cvt_pk_bf16_f32 v101, v102, v103
v_cvt_pk_bf16_f32 v102, v108, v109
v_cvt_pk_bf16_f32 v103, v110, v111
v_accvgpr_write_b32 a56, v100
v_accvgpr_write_b32 a57, v101
v_accvgpr_write_b32 a58, v102
v_accvgpr_write_b32 a59, v103
v_mfma_f32_16x16x32_bf16 v[56:59], a[64:67], a[48:51], 0
v_cvt_pk_bf16_f32 v116, v116, v117
v_cvt_pk_bf16_f32 v117, v118, v119
v_cvt_pk_bf16_f32 v118, v124, v125
v_cvt_pk_bf16_f32 v119, v126, v127
v_accvgpr_write_b32 a60, v116
v_accvgpr_write_b32 a61, v117
v_accvgpr_write_b32 a62, v118
v_accvgpr_write_b32 a63, v119
v_mfma_f32_16x16x32_bf16 v[56:59], a[68:71], a[52:55], v[56:59]
buffer_load_dwordx4 v1, s[4:7], s90 offen offset:2048 sc1 lds
v_mov_b32 v29, 0xff800000
s_mov_b32 s91, 0x10000
v_mfma_f32_16x16x32_bf16 v[56:59], a[72:75], a[56:59], v[56:59]
v_add_u32 v26, 0x18000, v1
v_lshrrev_b32 v28, 4, v0
v_mfma_f32_16x16x32_bf16 v[56:59], a[76:79], a[60:63], v[56:59]
buffer_load_dwordx4 v1, s[4:7], s90 offen offset:3072 sc1 lds
v_and_b32 v27, 15, v0
v_mfma_f32_16x16x32_bf16 v[60:63], a[80:83], a[48:51], 0
v_lshlrev_b32 v28, 2, v28
v_sub_u32 v27, v27, v28
s_and_b32 s87, s48, 1
v_mfma_f32_16x16x32_bf16 v[60:63], a[84:87], a[52:55], v[60:63]
s_lshl_b32 s87, s87, 4
s_sub_u32 s88, 16, s87
v_add_u32 v28, s88, v27
v_mfma_f32_16x16x32_bf16 v[60:63], a[88:91], a[56:59], v[60:63]
s_add_u32 s90, s90, 0x4000
v_add_u32 v27, s87, v27
v_mov_b32 v112, 0x3f803f80
v_mfma_f32_16x16x32_bf16 v[60:63], a[92:95], a[60:63], v[60:63]
ds_read_b128 a[64:67], v1 offset:8192
ds_read_b128 a[68:71], v1 offset:9216
ds_read_b128 a[72:75], v1 offset:10240
ds_read_b128 a[76:79], v1 offset:11264
ds_read_b128 a[80:83], v1 offset:12288
ds_read_b128 a[84:87], v1 offset:13312
ds_read_b128 a[88:91], v1 offset:14336
ds_read_b128 a[92:95], v1 offset:15360
v_accvgpr_write_b32 a144, v112
v_accvgpr_write_b32 a145, v112
v_accvgpr_write_b32 a146, v112
v_accvgpr_write_b32 a147, v112
s_lshl_b32 s87, s50, 3
s_sub_u32 s88, 0x7f, s87
s_add_u32 s55, s87, s48
s_sub_u32 s58, s88, s48
s_add_u32 s87, s87, 7
s_sub_u32 s88, s88, 7
s_sub_u32 s56, s87, s48
s_add_u32 s57, s88, s48
s_lshl_b32 s87, s49, 12
s_add_u32 s87, s87, 0x2000000
s_lshl_b32 s55, s55, 17
s_add_u32 s55, s55, s87
s_lshl_b32 s56, s56, 17
s_add_u32 s56, s56, s87
s_lshl_b32 s57, s57, 17
s_add_u32 s57, s57, s87
s_lshl_b32 s58, s58, 17
s_add_u32 s58, s58, s87
s_lshl_b32 s87, s50, 1
s_lshl_b32 s88, s50, 2
s_sub_u32 s88, 28, s88
s_cmp_lt_u32 s48, 2
s_cselect_b32 s60, 1, -1
s_mov_b32 s72, 3
s_mov_b32 s85, 0
s_nop 7
v_max3_f32 v64, v32, v33, v34
v_max3_f32 v68, v40, v41, v42
v_max3_f32 v72, v48, v49, v50
v_max3_f32 v76, v56, v57, v58
v_max3_f32 v65, v35, v36, v37
v_max3_f32 v69, v43, v44, v45
v_max3_f32 v73, v51, v52, v53
v_max3_f32 v77, v59, v60, v61
v_max3_f32 v64, v64, v38, v39
v_max3_f32 v68, v68, v46, v47
v_max3_f32 v72, v72, v54, v55
v_max3_f32 v76, v76, v62, v63
v_max_f32 v64, v64, v65
v_max_f32 v68, v68, v69
v_max_f32 v72, v72, v73
v_max_f32 v76, v76, v77
v_mov_b32 v65, v64
v_mov_b32 v69, v68
v_mov_b32 v73, v72
v_mov_b32 v77, v76
s_nop 0
v_permlane16_swap_b32 v64, v65
v_permlane16_swap_b32 v68, v69
v_permlane16_swap_b32 v72, v73
v_permlane16_swap_b32 v76, v77
v_max_f32 v64, v64, v65
v_max_f32 v68, v68, v69
v_max_f32 v72, v72, v73
v_max_f32 v76, v76, v77
v_mov_b32 v65, v64
v_mov_b32 v69, v68
v_mov_b32 v73, v72
v_mov_b32 v77, v76
s_nop 0
v_permlane32_swap_b32 v64, v65
v_permlane32_swap_b32 v68, v69
v_permlane32_swap_b32 v72, v73
v_permlane32_swap_b32 v76, v77
v_max_f32 v64, v64, v65
v_max_f32 v68, v68, v69
v_max_f32 v72, v72, v73
v_max_f32 v76, v76, v77
v_sub_f32 v96, 0, v64
v_sub_f32 v100, 0, v68
v_sub_f32 v104, 0, v72
v_sub_f32 v108, 0, v76
v_sub_f32 v97, 0, v64
v_sub_f32 v101, 0, v68
v_sub_f32 v105, 0, v72
v_sub_f32 v109, 0, v76
v_mov_b64 v[98:99], v[96:97]
v_mov_b64 v[102:103], v[100:101]
v_mov_b64 v[106:107], v[104:105]
v_mov_b64 v[110:111], v[108:109]
v_mov_b64 v[112:113], v[96:97]
v_mov_b64 v[114:115], v[96:97]
v_mov_b64 v[116:117], v[96:97]
v_mov_b64 v[118:119], v[96:97]
s_add_u32 s76, s87, 1
s_cmp_eq_u32 s76, s60
s_cbranch_scc1 L_setca0
L_back_setca0:
v_pk_add_f32 v[32:33], v[32:33], v[112:113]
v_pk_add_f32 v[34:35], v[34:35], v[114:115]
v_pk_add_f32 v[36:37], v[36:37], v[116:117]
v_pk_add_f32 v[38:39], v[38:39], v[118:119]
v_pk_add_f32 v[40:41], v[40:41], v[100:101]
v_pk_add_f32 v[42:43], v[42:43], v[102:103]
v_pk_add_f32 v[44:45], v[44:45], v[100:101]
v_pk_add_f32 v[46:47], v[46:47], v[102:103]
v_pk_add_f32 v[48:49], v[48:49], v[104:105]
v_pk_add_f32 v[50:51], v[50:51], v[106:107]
v_pk_add_f32 v[52:53], v[52:53], v[104:105]
v_pk_add_f32 v[54:55], v[54:55], v[106:107]
v_pk_add_f32 v[56:57], v[56:57], v[108:109]
v_pk_add_f32 v[58:59], v[58:59], v[110:111]
v_pk_add_f32 v[60:61], v[60:61], v[108:109]
v_pk_add_f32 v[62:63], v[62:63], v[110:111]
v_exp_f32 v32, v32
v_exp_f32 v33, v33
v_exp_f32 v34, v34
v_exp_f32 v35, v35
v_cvt_pk_bf16_f32 v64, v32, v33
v_cvt_pk_bf16_f32 v65, v34, v35
v_exp_f32 v36, v36
v_exp_f32 v37, v37
v_exp_f32 v38, v38
v_exp_f32 v39, v39
v_cvt_pk_bf16_f32 v66, v36, v37
v_cvt_pk_bf16_f32 v67, v38, v39
v_exp_f32 v40, v40
v_exp_f32 v41, v41
v_exp_f32 v42, v42
v_exp_f32 v43, v43
v_cvt_pk_bf16_f32 v68, v40, v41
v_cvt_pk_bf16_f32 v69, v42, v43
v_exp_f32 v44, v44
v_exp_f32 v45, v45
v_exp_f32 v46, v46
v_exp_f32 v47, v47
v_cvt_pk_bf16_f32 v70, v44, v45
v_cvt_pk_bf16_f32 v71, v46, v47
v_exp_f32 v48, v48
v_exp_f32 v49, v49
v_exp_f32 v50, v50
v_exp_f32 v51, v51
v_cvt_pk_bf16_f32 v72, v48, v49
v_cvt_pk_bf16_f32 v73, v50, v51
v_exp_f32 v52, v52
v_exp_f32 v53, v53
v_exp_f32 v54, v54
v_exp_f32 v55, v55
v_cvt_pk_bf16_f32 v74, v52, v53
v_cvt_pk_bf16_f32 v75, v54, v55
v_exp_f32 v56, v56
v_exp_f32 v57, v57
v_exp_f32 v58, v58
v_exp_f32 v59, v59
v_cvt_pk_bf16_f32 v76, v56, v57
v_cvt_pk_bf16_f32 v77, v58, v59
buffer_store_dword v18, v20, s[4:7], s0 offen sc1
s_waitcnt vmcnt(10) lgkmcnt(0)
s_barrier
s_cmp_eq_u32 s87, 0
s_cbranch_scc1 L_zero
L_dual0:
v_mfma_f32_16x16x32_bf16 v[32:35], a[64:67], a[0:3], v[96:99]
s_sub_u32 s72, s72, 1
s_cbranch_scc1 L_fv1
L_back_fv1:
v_exp_f32 v60, v60
v_mfma_f32_16x16x32_bf16 v[32:35], a[68:71], a[4:7], v[32:35]
s_xor_b32 s75, s91, 0x10000
ds_read_b128 a[96:99], v26 offset:16384
v_mfma_f32_16x16x32_bf16 v[32:35], a[72:75], a[8:11], v[32:35]
s_add_u32 m0, s75, s59
v_exp_f32 v61, v61
v_mfma_f32_16x16x32_bf16 v[32:35], a[76:79], a[12:15], v[32:35]
v_cvt_pk_bf16_f32 v78, v60, v61
v_mfma_f32_16x16x32_bf16 v[36:39], a[92:95], a[12:15], v[96:99]
v_exp_f32 v62, v62
v_mfma_f32_16x16x32_bf16 v[36:39], a[88:91], a[8:11], v[36:39]
s_add_u32 s78, s1, 0
ds_read_b128 a[100:103], v26 offset:17408
buffer_load_dwordx4 v1, s[4:7], s89 offen sc1 lds
v_mfma_f32_16x16x32_bf16 v[36:39], a[84:87], a[4:7], v[36:39]
v_exp_f32 v63, v63
v_mfma_f32_16x16x32_bf16 v[36:39], a[80:83], a[0:3], v[36:39]
buffer_store_dwordx4 a[192:195], v1, s[4:7], s78 offen sc1
v_cvt_pk_bf16_f32 v79, v62, v63
v_mfma_f32_16x16x32_bf16 v[40:43], a[64:67], a[16:19], v[100:103]
v_exp_f32 v32, v32
v_mfma_f32_16x16x32_bf16 v[40:43], a[68:71], a[20:23], v[40:43]
ds_read_b128 a[104:107], v26 offset:18432
v_mfma_f32_16x16x32_bf16 v[40:43], a[72:75], a[24:27], v[40:43]
v_exp_f32 v33, v33
v_mfma_f32_16x16x32_bf16 v[40:43], a[76:79], a[28:31], v[40:43]
v_cvt_pk_bf16_f32 v80, v32, v33
v_mfma_f32_16x16x32_bf16 v[44:47], a[92:95], a[28:31], v[100:103]
v_exp_f32 v34, v34
v_mfma_f32_16x16x32_bf16 v[44:47], a[88:91], a[24:27], v[44:47]
ds_read_b128 a[108:111], v26 offset:19456
v_mfma_f32_16x16x32_bf16 v[44:47], a[84:87], a[20:23], v[44:47]
v_exp_f32 v35, v35
v_mfma_f32_16x16x32_bf16 v[44:47], a[80:83], a[16:19], v[44:47]
v_cvt_pk_bf16_f32 v81, v34, v35
v_mfma_f32_16x16x32_bf16 v[48:51], a[64:67], a[32:35], v[104:107]
v_exp_f32 v36, v36
v_mfma_f32_16x16x32_bf16 v[48:51], a[68:71], a[36:39], v[48:51]
s_add_u32 s78, s1, 0x2000
ds_read_b128 a[112:115], v26 offset:20480
v_mfma_f32_16x16x32_bf16 v[48:51], a[72:75], a[40:43], v[48:51]
v_exp_f32 v37, v37
v_mfma_f32_16x16x32_bf16 v[48:51], a[76:79], a[44:47], v[48:51]
buffer_store_dwordx4 a[200:203], v1, s[4:7], s78 offen sc1
v_cvt_pk_bf16_f32 v82, v36, v37
v_mfma_f32_16x16x32_bf16 v[52:55], a[92:95], a[44:47], v[104:107]
v_exp_f32 v38, v38
v_mfma_f32_16x16x32_bf16 v[52:55], a[88:91], a[40:43], v[52:55]
ds_read_b128 a[116:119], v26 offset:21504
buffer_load_dwordx4 v1, s[4:7], s89 offen offset:1024 sc1 lds
v_mfma_f32_16x16x32_bf16 v[52:55], a[84:87], a[36:39], v[52:55]
v_exp_f32 v39, v39
v_mfma_f32_16x16x32_bf16 v[52:55], a[80:83], a[32:35], v[52:55]
v_cvt_pk_bf16_f32 v83, v38, v39
v_mfma_f32_16x16x32_bf16 v[56:59], a[64:67], a[48:51], v[108:111]
v_exp_f32 v40, v40
v_mfma_f32_16x16x32_bf16 v[56:59], a[68:71], a[52:55], v[56:59]
ds_read_b128 a[120:123], v26 offset:22528
v_mfma_f32_16x16x32_bf16 v[56:59], a[72:75], a[56:59], v[56:59]
v_exp_f32 v41, v41
v_mfma_f32_16x16x32_bf16 v[56:59], a[76:79], a[60:63], v[56:59]
v_cvt_pk_bf16_f32 v84, v40, v41
v_mfma_f32_16x16x32_bf16 v[60:63], a[92:95], a[60:63], v[108:111]
v_exp_f32 v42, v42
v_mfma_f32_16x16x32_bf16 v[60:63], a[88:91], a[56:59], v[60:63]
s_add_u32 s78, s1, 0
ds_read_b128 a[124:127], v26 offset:23552
v_mfma_f32_16x16x32_bf16 v[60:63], a[84:87], a[52:55], v[60:63]
v_exp_f32 v43, v43
v_mfma_f32_16x16x32_bf16 v[60:63], a[80:83], a[48:51], v[60:63]
s_waitcnt lgkmcnt(7)
buffer_store_dwordx4 a[208:211], v1, s[4:7], s78 offen offset:1024 sc1
v_cvt_pk_bf16_f32 v85, v42, v43
v_mfma_f32_16x16x32_bf16 v[128:131], a[96:99], v[64:67], 0
v_exp_f32 v44, v44
v_mfma_f32_16x16x32_bf16 v[160:163], a[96:99], v[68:71], 0
ds_read_b128 a[64:67], v26
v_mfma_f32_16x16x32_bf16 v[192:195], a[96:99], v[72:75], 0
v_exp_f32 v45, v45
v_mfma_f32_16x16x32_bf16 v[224:227], a[96:99], v[76:79], 0
s_waitcnt lgkmcnt(7)
v_cvt_pk_bf16_f32 v86, v44, v45
v_mfma_f32_16x16x32_bf16 v[228:231], a[100:103], v[76:79], 0
v_exp_f32 v46, v46
v_mfma_f32_16x16x32_bf16 v[196:199], a[100:103], v[72:75], 0
ds_read_b128 a[68:71], v26 offset:1024
buffer_load_dwordx4 v1, s[4:7], s89 offen offset:2048 sc1 lds
v_mfma_f32_16x16x32_bf16 v[164:167], a[100:103], v[68:71], 0
v_exp_f32 v47, v47
v_mfma_f32_16x16x32_bf16 v[132:135], a[100:103], v[64:67], 0
s_waitcnt lgkmcnt(7)
v_cvt_pk_bf16_f32 v87, v46, v47
v_mfma_f32_16x16x32_bf16 v[136:139], a[104:107], v[64:67], 0
v_exp_f32 v48, v48
v_mfma_f32_16x16x32_bf16 v[168:171], a[104:107], v[68:71], 0
s_add_u32 s78, s1, 0x2000
ds_read_b128 a[72:75], v26 offset:2048
v_mfma_f32_16x16x32_bf16 v[200:203], a[104:107], v[72:75], 0
v_exp_f32 v49, v49
v_mfma_f32_16x16x32_bf16 v[232:235], a[104:107], v[76:79], 0
s_waitcnt lgkmcnt(7)
buffer_store_dwordx4 a[216:219], v1, s[4:7], s78 offen offset:1024 sc1
v_cvt_pk_bf16_f32 v88, v48, v49
v_mfma_f32_16x16x32_bf16 v[236:239], a[108:111], v[76:79], 0
v_exp_f32 v50, v50
v_mfma_f32_16x16x32_bf16 v[204:207], a[108:111], v[72:75], 0
ds_read_b128 a[76:79], v26 offset:3072
v_mfma_f32_16x16x32_bf16 v[172:175], a[108:111], v[68:71], 0
v_exp_f32 v51, v51
v_mfma_f32_16x16x32_bf16 v[140:143], a[108:111], v[64:67], 0
s_waitcnt lgkmcnt(7)
v_cvt_pk_bf16_f32 v89, v50, v51
v_mfma_f32_16x16x32_bf16 v[144:147], a[112:115], v[64:67], 0
v_exp_f32 v52, v52
v_mfma_f32_16x16x32_bf16 v[176:179], a[112:115], v[68:71], 0
ds_read_b128 a[92:95], v26 offset:7168
v_mfma_f32_16x16x32_bf16 v[208:211], a[112:115], v[72:75], 0
v_exp_f32 v53, v53
v_mfma_f32_16x16x32_bf16 v[240:243], a[112:115], v[76:79], 0
s_waitcnt lgkmcnt(7)
v_cvt_pk_bf16_f32 v90, v52, v53
v_mfma_f32_16x16x32_bf16 v[244:247], a[116:119], v[76:79], 0
v_exp_f32 v54, v54
v_mfma_f32_16x16x32_bf16 v[212:215], a[116:119], v[72:75], 0
s_add_u32 s78, s1, 0
ds_read_b128 a[88:91], v26 offset:6144
buffer_load_dwordx4 v1, s[4:7], s89 offen offset:3072 sc1 lds
v_mfma_f32_16x16x32_bf16 v[180:183], a[116:119], v[68:71], 0
s_add_u32 s89, s89, 0x4000
v_exp_f32 v55, v55
v_mfma_f32_16x16x32_bf16 v[148:151], a[116:119], v[64:67], 0
s_waitcnt lgkmcnt(7)
buffer_store_dwordx4 a[224:227], v1, s[4:7], s78 offen offset:2048 sc1
v_cvt_pk_bf16_f32 v91, v54, v55
v_mfma_f32_16x16x32_bf16 v[152:155], a[120:123], v[64:67], 0
v_exp_f32 v56, v56
v_mfma_f32_16x16x32_bf16 v[184:187], a[120:123], v[68:71], 0
ds_read_b128 a[84:87], v26 offset:5120
v_mfma_f32_16x16x32_bf16 v[216:219], a[120:123], v[72:75], 0
v_exp_f32 v57, v57
v_mfma_f32_16x16x32_bf16 v[248:251], a[120:123], v[76:79], 0
s_waitcnt lgkmcnt(7)
v_cvt_pk_bf16_f32 v92, v56, v57
v_mfma_f32_16x16x32_bf16 v[252:255], a[124:127], v[76:79], 0
v_exp_f32 v58, v58
v_mfma_f32_16x16x32_bf16 v[220:223], a[124:127], v[72:75], 0
ds_read_b128 a[80:83], v26 offset:4096
v_mfma_f32_16x16x32_bf16 v[188:191], a[124:127], v[68:71], 0
v_exp_f32 v59, v59
v_mfma_f32_16x16x32_bf16 v[156:159], a[124:127], v[64:67], 0
v_cvt_pk_bf16_f32 v93, v58, v59
v_mfma_f32_16x16x32_bf16 a[128:131], a[144:147], v[64:67], 0
v_cmp_gt_i32_e64 s[80:81], 0, v27
v_cmp_gt_i32_e64 s[82:83], 1, v27
v_mfma_f32_16x16x32_bf16 a[132:135], a[144:147], v[68:71], 0
s_add_u32 s78, s1, 0x2000
v_mfma_f32_16x16x32_bf16 a[136:139], a[144:147], v[72:75], 0
buffer_store_dwordx4 a[232:235], v1, s[4:7], s78 offen offset:2048 sc1
v_mfma_f32_16x16x32_bf16 a[140:143], a[144:147], v[76:79], 0
s_waitcnt lgkmcnt(4)
v_mfma_f32_16x16x32_bf16 v[32:35], a[64:67], a[0:3], v[112:115]
v_exp_f32 v60, v60
v_mfma_f32_16x16x32_bf16 v[32:35], a[68:71], a[4:7], v[32:35]
ds_read_b128 a[96:99], v26 offset:24576
v_mfma_f32_16x16x32_bf16 v[32:35], a[72:75], a[8:11], v[32:35]
s_add_u32 m0, m0, 0x4000
v_exp_f32 v61, v61
v_mfma_f32_16x16x32_bf16 v[32:35], a[76:79], a[12:15], v[32:35]
s_waitcnt lgkmcnt(1)
v_cvt_pk_bf16_f32 v94, v60, v61
v_mfma_f32_16x16x32_bf16 v[36:39], a[92:95], a[12:15], v[116:119]
v_exp_f32 v62, v62
v_mfma_f32_16x16x32_bf16 v[36:39], a[88:91], a[8:11], v[36:39]
ds_read_b128 a[100:103], v26 offset:25600
buffer_load_dwordx4 v1, s[4:7], s90 offen sc1 lds
v_mfma_f32_16x16x32_bf16 v[36:39], a[84:87], a[4:7], v[36:39]
v_exp_f32 v63, v63
v_mfma_f32_16x16x32_bf16 v[36:39], a[80:83], a[0:3], v[36:39]
v_cvt_pk_bf16_f32 v95, v62, v63
v_mfma_f32_16x16x32_bf16 v[40:43], a[64:67], a[16:19], v[100:103]
v_exp_f32 v32, v32
v_mfma_f32_16x16x32_bf16 v[40:43], a[68:71], a[20:23], v[40:43]
ds_read_b128 a[104:107], v26 offset:26624
v_mfma_f32_16x16x32_bf16 v[40:43], a[72:75], a[24:27], v[40:43]
s_add_u32 s78, s1, 0
v_exp_f32 v33, v33
v_mfma_f32_16x16x32_bf16 v[40:43], a[76:79], a[28:31], v[40:43]
buffer_store_dwordx4 a[240:243], v1, s[4:7], s78 offen offset:3072 sc1
v_cvt_pk_bf16_f32 v64, v32, v33
v_mfma_f32_16x16x32_bf16 v[44:47], a[92:95], a[28:31], v[100:103]
v_exp_f32 v34, v34
v_mfma_f32_16x16x32_bf16 v[44:47], a[88:91], a[24:27], v[44:47]
ds_read_b128 a[108:111], v26 offset:27648
v_mfma_f32_16x16x32_bf16 v[44:47], a[84:87], a[20:23], v[44:47]
v_exp_f32 v35, v35
v_mfma_f32_16x16x32_bf16 v[44:47], a[80:83], a[16:19], v[44:47]
v_cvt_pk_bf16_f32 v65, v34, v35
v_mfma_f32_16x16x32_bf16 v[48:51], a[64:67], a[32:35], v[104:107]
v_exp_f32 v36, v36
v_mfma_f32_16x16x32_bf16 v[48:51], a[68:71], a[36:39], v[48:51]
ds_read_b128 a[112:115], v26 offset:28672
v_mfma_f32_16x16x32_bf16 v[48:51], a[72:75], a[40:43], v[48:51]
v_exp_f32 v37, v37
v_mfma_f32_16x16x32_bf16 v[48:51], a[76:79], a[44:47], v[48:51]
v_cvt_pk_bf16_f32 v66, v36, v37
v_mfma_f32_16x16x32_bf16 v[52:55], a[92:95], a[44:47], v[104:107]
v_exp_f32 v38, v38
v_mfma_f32_16x16x32_bf16 v[52:55], a[88:91], a[40:43], v[52:55]
ds_read_b128 a[116:119], v26 offset:29696
buffer_load_dwordx4 v1, s[4:7], s90 offen offset:1024 sc1 lds
v_mfma_f32_16x16x32_bf16 v[52:55], a[84:87], a[36:39], v[52:55]
s_add_u32 s78, s1, 0x2000
v_exp_f32 v39, v39
v_mfma_f32_16x16x32_bf16 v[52:55], a[80:83], a[32:35], v[52:55]
buffer_store_dwordx4 a[248:251], v1, s[4:7], s78 offen offset:3072 sc1
v_cvt_pk_bf16_f32 v67, v38, v39
v_mfma_f32_16x16x32_bf16 v[56:59], a[64:67], a[48:51], v[108:111]
v_exp_f32 v40, v40
v_mfma_f32_16x16x32_bf16 v[56:59], a[68:71], a[52:55], v[56:59]
ds_read_b128 a[120:123], v26 offset:30720
v_mfma_f32_16x16x32_bf16 v[56:59], a[72:75], a[56:59], v[56:59]
v_exp_f32 v41, v41
v_mfma_f32_16x16x32_bf16 v[56:59], a[76:79], a[60:63], v[56:59]
v_cvt_pk_bf16_f32 v68, v40, v41
v_mfma_f32_16x16x32_bf16 v[60:63], a[92:95], a[60:63], v[108:111]
v_exp_f32 v42, v42
v_mfma_f32_16x16x32_bf16 v[60:63], a[88:91], a[56:59], v[60:63]
ds_read_b128 a[124:127], v26 offset:31744
v_mfma_f32_16x16x32_bf16 v[60:63], a[84:87], a[52:55], v[60:63]
v_exp_f32 v43, v43
v_mfma_f32_16x16x32_bf16 v[60:63], a[80:83], a[48:51], v[60:63]
s_waitcnt lgkmcnt(7)
v_cvt_pk_bf16_f32 v69, v42, v43
v_mfma_f32_16x16x32_bf16 v[128:131], a[96:99], v[80:83], v[128:131]
s_sub_u32 s87, s87, 1
v_exp_f32 v44, v44
v_mfma_f32_16x16x32_bf16 v[160:163], a[96:99], v[84:87], v[160:163]
ds_read_b128 a[64:67], v26 offset:8192
v_mfma_f32_16x16x32_bf16 v[192:195], a[96:99], v[88:91], v[192:195]
s_add_u32 s78, s1, 0x1000
v_exp_f32 v45, v45
v_mfma_f32_16x16x32_bf16 v[224:227], a[96:99], v[92:95], v[224:227]
s_waitcnt lgkmcnt(7)
buffer_store_dwordx4 a[196:199], v1, s[4:7], s78 offen sc1
v_cvt_pk_bf16_f32 v70, v44, v45
v_mfma_f32_16x16x32_bf16 v[228:231], a[100:103], v[92:95], v[228:231]
v_exp_f32 v46, v46
v_mfma_f32_16x16x32_bf16 v[196:199], a[100:103], v[88:91], v[196:199]
ds_read_b128 a[68:71], v26 offset:9216
buffer_load_dwordx4 v1, s[4:7], s90 offen offset:2048 sc1 lds
v_mfma_f32_16x16x32_bf16 v[164:167], a[100:103], v[84:87], v[164:167]
v_exp_f32 v47, v47
v_mfma_f32_16x16x32_bf16 v[132:135], a[100:103], v[80:83], v[132:135]
s_waitcnt lgkmcnt(7)
v_cvt_pk_bf16_f32 v71, v46, v47
v_mfma_f32_16x16x32_bf16 v[136:139], a[104:107], v[80:83], v[136:139]
v_exp_f32 v48, v48
v_mfma_f32_16x16x32_bf16 v[168:171], a[104:107], v[84:87], v[168:171]
ds_read_b128 a[72:75], v26 offset:10240
v_mfma_f32_16x16x32_bf16 v[200:203], a[104:107], v[88:91], v[200:203]
v_exp_f32 v49, v49
v_mfma_f32_16x16x32_bf16 v[232:235], a[104:107], v[92:95], v[232:235]
s_waitcnt lgkmcnt(7)
v_cvt_pk_bf16_f32 v72, v48, v49
v_mfma_f32_16x16x32_bf16 v[236:239], a[108:111], v[92:95], v[236:239]
v_exp_f32 v50, v50
v_mfma_f32_16x16x32_bf16 v[204:207], a[108:111], v[88:91], v[204:207]
ds_read_b128 a[76:79], v26 offset:11264
v_mfma_f32_16x16x32_bf16 v[172:175], a[108:111], v[84:87], v[172:175]
s_add_u32 s78, s1, 0x3000
v_exp_f32 v51, v51
v_mfma_f32_16x16x32_bf16 v[140:143], a[108:111], v[80:83], v[140:143]
s_waitcnt lgkmcnt(7)
buffer_store_dwordx4 a[228:231], v1, s[4:7], s78 offen sc1
v_cvt_pk_bf16_f32 v73, v50, v51
v_mfma_f32_16x16x32_bf16 v[144:147], a[112:115], v[80:83], v[144:147]
v_exp_f32 v52, v52
v_mfma_f32_16x16x32_bf16 v[176:179], a[112:115], v[84:87], v[176:179]
ds_read_b128 a[92:95], v26 offset:15360
v_mfma_f32_16x16x32_bf16 v[208:211], a[112:115], v[88:91], v[208:211]
v_exp_f32 v53, v53
v_mfma_f32_16x16x32_bf16 v[240:243], a[112:115], v[92:95], v[240:243]
s_waitcnt lgkmcnt(7)
v_cvt_pk_bf16_f32 v74, v52, v53
v_mfma_f32_16x16x32_bf16 v[244:247], a[116:119], v[92:95], v[244:247]
v_exp_f32 v54, v54
v_mfma_f32_16x16x32_bf16 v[212:215], a[116:119], v[88:91], v[212:215]
ds_read_b128 a[88:91], v26 offset:14336
buffer_load_dwordx4 v1, s[4:7], s90 offen offset:3072 sc1 lds
s_add_u32 s90, s90, 0x4000
v_mfma_f32_16x16x32_bf16 v[180:183], a[116:119], v[84:87], v[180:183]
v_exp_f32 v55, v55
v_mfma_f32_16x16x32_bf16 v[148:151], a[116:119], v[80:83], v[148:151]
s_waitcnt lgkmcnt(7)
v_cvt_pk_bf16_f32 v75, v54, v55
v_mfma_f32_16x16x32_bf16 v[152:155], a[120:123], v[80:83], v[152:155]
v_exp_f32 v56, v56
v_mfma_f32_16x16x32_bf16 v[184:187], a[120:123], v[84:87], v[184:187]
ds_read_b128 a[84:87], v26 offset:13312
v_mfma_f32_16x16x32_bf16 v[216:219], a[120:123], v[88:91], v[216:219]
s_add_u32 s78, s1, 0x1000
v_exp_f32 v57, v57
v_mfma_f32_16x16x32_bf16 v[248:251], a[120:123], v[92:95], v[248:251]
s_waitcnt lgkmcnt(7)
buffer_store_dwordx4 a[204:207], v1, s[4:7], s78 offen offset:1024 sc1
v_cvt_pk_bf16_f32 v76, v56, v57
v_mfma_f32_16x16x32_bf16 v[252:255], a[124:127], v[92:95], v[252:255]
v_exp_f32 v58, v58
v_mfma_f32_16x16x32_bf16 v[220:223], a[124:127], v[88:91], v[220:223]
ds_read_b128 a[80:83], v26 offset:12288
v_mfma_f32_16x16x32_bf16 v[188:191], a[124:127], v[84:87], v[188:191]
s_add_u32 s91, s91, 0x8000
v_exp_f32 v59, v59
v_mfma_f32_16x16x32_bf16 v[156:159], a[124:127], v[80:83], v[156:159]
s_and_b32 s91, s91, 0x18000
v_cvt_pk_bf16_f32 v77, v58, v59
v_mfma_f32_16x16x32_bf16 a[128:131], a[144:147], v[80:83], a[128:131]
v_mfma_f32_16x16x32_bf16 a[132:135], a[144:147], v[84:87], a[132:135]
v_mfma_f32_16x16x32_bf16 a[136:139], a[144:147], v[88:91], a[136:139]
s_waitcnt vmcnt(20)
s_barrier
v_mfma_f32_16x16x32_bf16 a[140:143], a[144:147], v[92:95], a[140:143]
s_waitcnt lgkmcnt(4)
v_add_u32 v26, s91, v2
v_mfma_f32_16x16x32_bf16 v[32:35], a[64:67], a[0:3], v[96:99]
s_sub_u32 s72, s72, 1
s_cbranch_scc1 L_fv2
L_back_fv2:
v_exp_f32 v60, v60
v_mfma_f32_16x16x32_bf16 v[32:35], a[68:71], a[4:7], v[32:35]
s_xor_b32 s75, s91, 0x10000
ds_read_b128 a[96:99], v26 offset:16384
v_mfma_f32_16x16x32_bf16 v[32:35], a[72:75], a[8:11], v[32:35]
s_add_u32 m0, s75, s59
v_exp_f32 v61, v61
v_mfma_f32_16x16x32_bf16 v[32:35], a[76:79], a[12:15], v[32:35]
s_waitcnt lgkmcnt(1)
s_add_u32 s78, s1, 0x3000
v_cvt_pk_bf16_f32 v78, v60, v61
v_mfma_f32_16x16x32_bf16 v[36:39], a[92:95], a[12:15], v[96:99]
v_exp_f32 v62, v62
v_mfma_f32_16x16x32_bf16 v[36:39], a[88:91], a[8:11], v[36:39]
ds_read_b128 a[100:103], v26 offset:17408
buffer_load_dwordx4 v1, s[4:7], s89 offen sc1 lds
v_mfma_f32_16x16x32_bf16 v[36:39], a[84:87], a[4:7], v[36:39]
buffer_store_dwordx4 a[236:239], v1, s[4:7], s78 offen offset:1024 sc1
v_exp_f32 v63, v63
v_mfma_f32_16x16x32_bf16 v[36:39], a[80:83], a[0:3], v[36:39]
v_cvt_pk_bf16_f32 v79, v62, v63
v_mfma_f32_16x16x32_bf16 v[40:43], a[64:67], a[16:19], v[100:103]
v_exp_f32 v32, v32
v_mfma_f32_16x16x32_bf16 v[40:43], a[68:71], a[20:23], v[40:43]
ds_read_b128 a[104:107], v26 offset:18432
v_mfma_f32_16x16x32_bf16 v[40:43], a[72:75], a[24:27], v[40:43]
v_exp_f32 v33, v33
v_mfma_f32_16x16x32_bf16 v[40:43], a[76:79], a[28:31], v[40:43]
v_cvt_pk_bf16_f32 v80, v32, v33
v_mfma_f32_16x16x32_bf16 v[44:47], a[92:95], a[28:31], v[100:103]
v_exp_f32 v34, v34
v_mfma_f32_16x16x32_bf16 v[44:47], a[88:91], a[24:27], v[44:47]
ds_read_b128 a[108:111], v26 offset:19456
v_mfma_f32_16x16x32_bf16 v[44:47], a[84:87], a[20:23], v[44:47]
v_exp_f32 v35, v35
v_mfma_f32_16x16x32_bf16 v[44:47], a[80:83], a[16:19], v[44:47]
v_cvt_pk_bf16_f32 v81, v34, v35
v_mfma_f32_16x16x32_bf16 v[48:51], a[64:67], a[32:35], v[104:107]
v_exp_f32 v36, v36
v_mfma_f32_16x16x32_bf16 v[48:51], a[68:71], a[36:39], v[48:51]
ds_read_b128 a[112:115], v26 offset:20480
v_mfma_f32_16x16x32_bf16 v[48:51], a[72:75], a[40:43], v[48:51]
v_exp_f32 v37, v37
v_mfma_f32_16x16x32_bf16 v[48:51], a[76:79], a[44:47], v[48:51]
v_cvt_pk_bf16_f32 v82, v36, v37
v_mfma_f32_16x16x32_bf16 v[52:55], a[92:95], a[44:47], v[104:107]
v_exp_f32 v38, v38
v_mfma_f32_16x16x32_bf16 v[52:55], a[88:91], a[40:43], v[52:55]
ds_read_b128 a[116:119], v26 offset:21504
buffer_load_dwordx4 v1, s[4:7], s89 offen offset:1024 sc1 lds
v_mfma_f32_16x16x32_bf16 v[52:55], a[84:87], a[36:39], v[52:55]
v_exp_f32 v39, v39
v_mfma_f32_16x16x32_bf16 v[52:55], a[80:83], a[32:35], v[52:55]
v_cvt_pk_bf16_f32 v83, v38, v39
v_mfma_f32_16x16x32_bf16 v[56:59], a[64:67], a[48:51], v[108:111]
v_exp_f32 v40, v40
v_mfma_f32_16x16x32_bf16 v[56:59], a[68:71], a[52:55], v[56:59]
ds_read_b128 a[120:123], v26 offset:22528
v_mfma_f32_16x16x32_bf16 v[56:59], a[72:75], a[56:59], v[56:59]
v_exp_f32 v41, v41
v_mfma_f32_16x16x32_bf16 v[56:59], a[76:79], a[60:63], v[56:59]
v_cvt_pk_bf16_f32 v84, v40, v41
v_mfma_f32_16x16x32_bf16 v[60:63], a[92:95], a[60:63], v[108:111]
v_exp_f32 v42, v42
v_mfma_f32_16x16x32_bf16 v[60:63], a[88:91], a[56:59], v[60:63]
ds_read_b128 a[124:127], v26 offset:23552
v_mfma_f32_16x16x32_bf16 v[60:63], a[84:87], a[52:55], v[60:63]
v_exp_f32 v43, v43
v_mfma_f32_16x16x32_bf16 v[60:63], a[80:83], a[48:51], v[60:63]
s_waitcnt lgkmcnt(7)
v_cvt_pk_bf16_f32 v85, v42, v43
v_mfma_f32_16x16x32_bf16 v[128:131], a[96:99], v[64:67], v[128:131]
v_exp_f32 v44, v44
v_mfma_f32_16x16x32_bf16 v[160:163], a[96:99], v[68:71], v[160:163]
ds_read_b128 a[64:67], v26
v_mfma_f32_16x16x32_bf16 v[192:195], a[96:99], v[72:75], v[192:195]
v_exp_f32 v45, v45
v_mfma_f32_16x16x32_bf16 v[224:227], a[96:99], v[76:79], v[224:227]
s_waitcnt lgkmcnt(7)
v_cvt_pk_bf16_f32 v86, v44, v45
v_mfma_f32_16x16x32_bf16 v[228:231], a[100:103], v[76:79], v[228:231]
v_exp_f32 v46, v46
v_mfma_f32_16x16x32_bf16 v[196:199], a[100:103], v[72:75], v[196:199]
ds_read_b128 a[68:71], v26 offset:1024
buffer_load_dwordx4 v1, s[4:7], s89 offen offset:2048 sc1 lds
v_mfma_f32_16x16x32_bf16 v[164:167], a[100:103], v[68:71], v[164:167]
v_exp_f32 v47, v47
v_mfma_f32_16x16x32_bf16 v[132:135], a[100:103], v[64:67], v[132:135]
s_waitcnt lgkmcnt(7)
v_cvt_pk_bf16_f32 v87, v46, v47
v_mfma_f32_16x16x32_bf16 v[136:139], a[104:107], v[64:67], v[136:139]
v_exp_f32 v48, v48
v_mfma_f32_16x16x32_bf16 v[168:171], a[104:107], v[68:71], v[168:171]
ds_read_b128 a[72:75], v26 offset:2048
v_mfma_f32_16x16x32_bf16 v[200:203], a[104:107], v[72:75], v[200:203]
v_exp_f32 v49, v49
v_mfma_f32_16x16x32_bf16 v[232:235], a[104:107], v[76:79], v[232:235]
s_waitcnt lgkmcnt(7)
v_cvt_pk_bf16_f32 v88, v48, v49
v_mfma_f32_16x16x32_bf16 v[236:239], a[108:111], v[76:79], v[236:239]
v_exp_f32 v50, v50
v_mfma_f32_16x16x32_bf16 v[204:207], a[108:111], v[72:75], v[204:207]
ds_read_b128 a[76:79], v26 offset:3072
v_mfma_f32_16x16x32_bf16 v[172:175], a[108:111], v[68:71], v[172:175]
v_exp_f32 v51, v51
v_mfma_f32_16x16x32_bf16 v[140:143], a[108:111], v[64:67], v[140:143]
s_waitcnt lgkmcnt(7)
v_cvt_pk_bf16_f32 v89, v50, v51
v_mfma_f32_16x16x32_bf16 v[144:147], a[112:115], v[64:67], v[144:147]
v_exp_f32 v52, v52
v_mfma_f32_16x16x32_bf16 v[176:179], a[112:115], v[68:71], v[176:179]
ds_read_b128 a[92:95], v26 offset:7168
v_mfma_f32_16x16x32_bf16 v[208:211], a[112:115], v[72:75], v[208:211]
v_exp_f32 v53, v53
v_mfma_f32_16x16x32_bf16 v[240:243], a[112:115], v[76:79], v[240:243]
s_waitcnt lgkmcnt(7)
v_cvt_pk_bf16_f32 v90, v52, v53
v_mfma_f32_16x16x32_bf16 v[244:247], a[116:119], v[76:79], v[244:247]
v_exp_f32 v54, v54
v_mfma_f32_16x16x32_bf16 v[212:215], a[116:119], v[72:75], v[212:215]
ds_read_b128 a[88:91], v26 offset:6144
buffer_load_dwordx4 v1, s[4:7], s89 offen offset:3072 sc1 lds
s_add_u32 s89, s89, 0x4000
v_mfma_f32_16x16x32_bf16 v[180:183], a[116:119], v[68:71], v[180:183]
v_exp_f32 v55, v55
v_mfma_f32_16x16x32_bf16 v[148:151], a[116:119], v[64:67], v[148:151]
s_waitcnt vmcnt(3) lgkmcnt(7)
buffer_store_dword v18, v20, s[4:7], s67 offen sc1
v_cvt_pk_bf16_f32 v91, v54, v55
v_mfma_f32_16x16x32_bf16 v[152:155], a[120:123], v[64:67], v[152:155]
v_exp_f32 v56, v56
v_mfma_f32_16x16x32_bf16 v[184:187], a[120:123], v[68:71], v[184:187]
ds_read_b128 a[84:87], v26 offset:5120
v_mfma_f32_16x16x32_bf16 v[216:219], a[120:123], v[72:75], v[216:219]
v_exp_f32 v57, v57
v_mfma_f32_16x16x32_bf16 v[248:251], a[120:123], v[76:79], v[248:251]
s_waitcnt lgkmcnt(7)
v_cvt_pk_bf16_f32 v92, v56, v57
v_mfma_f32_16x16x32_bf16 v[252:255], a[124:127], v[76:79], v[252:255]
v_exp_f32 v58, v58
v_mfma_f32_16x16x32_bf16 v[220:223], a[124:127], v[72:75], v[220:223]
ds_read_b128 a[80:83], v26 offset:4096
v_mfma_f32_16x16x32_bf16 v[188:191], a[124:127], v[68:71], v[188:191]
v_exp_f32 v59, v59
v_mfma_f32_16x16x32_bf16 v[156:159], a[124:127], v[64:67], v[156:159]
s_cmp_eq_u32 s87, s60
s_cbranch_scc1 L_setca2
L_back_setca2:
v_cvt_pk_bf16_f32 v93, v58, v59
v_mfma_f32_16x16x32_bf16 a[128:131], a[144:147], v[64:67], a[128:131]
v_mfma_f32_16x16x32_bf16 a[132:135], a[144:147], v[68:71], a[132:135]
v_mfma_f32_16x16x32_bf16 a[136:139], a[144:147], v[72:75], a[136:139]
v_mfma_f32_16x16x32_bf16 a[140:143], a[144:147], v[76:79], a[140:143]
s_waitcnt lgkmcnt(4)
v_mfma_f32_16x16x32_bf16 v[32:35], a[64:67], a[0:3], v[112:115]
v_exp_f32 v60, v60
v_mfma_f32_16x16x32_bf16 v[32:35], a[68:71], a[4:7], v[32:35]
ds_read_b128 a[96:99], v26 offset:24576
v_mfma_f32_16x16x32_bf16 v[32:35], a[72:75], a[8:11], v[32:35]
s_add_u32 m0, m0, 0x4000
v_exp_f32 v61, v61
v_mfma_f32_16x16x32_bf16 v[32:35], a[76:79], a[12:15], v[32:35]
s_waitcnt lgkmcnt(1)
v_cvt_pk_bf16_f32 v94, v60, v61
v_mfma_f32_16x16x32_bf16 v[36:39], a[92:95], a[12:15], v[116:119]
v_exp_f32 v62, v62
v_mfma_f32_16x16x32_bf16 v[36:39], a[88:91], a[8:11], v[36:39]
ds_read_b128 a[100:103], v26 offset:25600
buffer_load_dwordx4 v1, s[4:7], s90 offen sc1 lds
v_mfma_f32_16x16x32_bf16 v[36:39], a[84:87], a[4:7], v[36:39]
v_exp_f32 v63, v63
v_mfma_f32_16x16x32_bf16 v[36:39], a[80:83], a[0:3], v[36:39]
v_cvt_pk_bf16_f32 v95, v62, v63
v_mfma_f32_16x16x32_bf16 v[40:43], a[64:67], a[16:19], v[100:103]
v_exp_f32 v32, v32
v_mfma_f32_16x16x32_bf16 v[40:43], a[68:71], a[20:23], v[40:43]
ds_read_b128 a[104:107], v26 offset:26624
v_mfma_f32_16x16x32_bf16 v[40:43], a[72:75], a[24:27], v[40:43]
v_exp_f32 v33, v33
v_mfma_f32_16x16x32_bf16 v[40:43], a[76:79], a[28:31], v[40:43]
v_cvt_pk_bf16_f32 v64, v32, v33
v_mfma_f32_16x16x32_bf16 v[44:47], a[92:95], a[28:31], v[100:103]
v_exp_f32 v34, v34
v_mfma_f32_16x16x32_bf16 v[44:47], a[88:91], a[24:27], v[44:47]
ds_read_b128 a[108:111], v26 offset:27648
v_mfma_f32_16x16x32_bf16 v[44:47], a[84:87], a[20:23], v[44:47]
v_exp_f32 v35, v35
v_mfma_f32_16x16x32_bf16 v[44:47], a[80:83], a[16:19], v[44:47]
v_cvt_pk_bf16_f32 v65, v34, v35
v_mfma_f32_16x16x32_bf16 v[48:51], a[64:67], a[32:35], v[104:107]
v_exp_f32 v36, v36
v_mfma_f32_16x16x32_bf16 v[48:51], a[68:71], a[36:39], v[48:51]
ds_read_b128 a[112:115], v26 offset:28672
v_mfma_f32_16x16x32_bf16 v[48:51], a[72:75], a[40:43], v[48:51]
v_exp_f32 v37, v37
v_mfma_f32_16x16x32_bf16 v[48:51], a[76:79], a[44:47], v[48:51]
v_cvt_pk_bf16_f32 v66, v36, v37
v_mfma_f32_16x16x32_bf16 v[52:55], a[92:95], a[44:47], v[104:107]
v_exp_f32 v38, v38
v_mfma_f32_16x16x32_bf16 v[52:55], a[88:91], a[40:43], v[52:55]
ds_read_b128 a[116:119], v26 offset:29696
buffer_load_dwordx4 v1, s[4:7], s90 offen offset:1024 sc1 lds
v_mfma_f32_16x16x32_bf16 v[52:55], a[84:87], a[36:39], v[52:55]
v_exp_f32 v39, v39
v_mfma_f32_16x16x32_bf16 v[52:55], a[80:83], a[32:35], v[52:55]
v_cvt_pk_bf16_f32 v67, v38, v39
v_mfma_f32_16x16x32_bf16 v[56:59], a[64:67], a[48:51], v[108:111]
v_exp_f32 v40, v40
v_mfma_f32_16x16x32_bf16 v[56:59], a[68:71], a[52:55], v[56:59]
ds_read_b128 a[120:123], v26 offset:30720
v_mfma_f32_16x16x32_bf16 v[56:59], a[72:75], a[56:59], v[56:59]
v_exp_f32 v41, v41
v_mfma_f32_16x16x32_bf16 v[56:59], a[76:79], a[60:63], v[56:59]
v_cvt_pk_bf16_f32 v68, v40, v41
v_mfma_f32_16x16x32_bf16 v[60:63], a[92:95], a[60:63], v[108:111]
v_exp_f32 v42, v42
v_mfma_f32_16x16x32_bf16 v[60:63], a[88:91], a[56:59], v[60:63]
ds_read_b128 a[124:127], v26 offset:31744
v_mfma_f32_16x16x32_bf16 v[60:63], a[84:87], a[52:55], v[60:63]
v_exp_f32 v43, v43
v_mfma_f32_16x16x32_bf16 v[60:63], a[80:83], a[48:51], v[60:63]
s_waitcnt lgkmcnt(7)
v_cvt_pk_bf16_f32 v69, v42, v43
v_mfma_f32_16x16x32_bf16 v[128:131], a[96:99], v[80:83], v[128:131]
s_sub_u32 s87, s87, 1
v_exp_f32 v44, v44
v_mfma_f32_16x16x32_bf16 v[160:163], a[96:99], v[84:87], v[160:163]
ds_read_b128 a[64:67], v26 offset:8192
v_mfma_f32_16x16x32_bf16 v[192:195], a[96:99], v[88:91], v[192:195]
v_exp_f32 v45, v45
v_mfma_f32_16x16x32_bf16 v[224:227], a[96:99], v[92:95], v[224:227]
s_waitcnt lgkmcnt(7)
v_cvt_pk_bf16_f32 v70, v44, v45
v_mfma_f32_16x16x32_bf16 v[228:231], a[100:103], v[92:95], v[228:231]
v_exp_f32 v46, v46
v_mfma_f32_16x16x32_bf16 v[196:199], a[100:103], v[88:91], v[196:199]
ds_read_b128 a[68:71], v26 offset:9216
buffer_load_dwordx4 v1, s[4:7], s90 offen offset:2048 sc1 lds
v_mfma_f32_16x16x32_bf16 v[164:167], a[100:103], v[84:87], v[164:167]
v_exp_f32 v47, v47
v_mfma_f32_16x16x32_bf16 v[132:135], a[100:103], v[80:83], v[132:135]
s_waitcnt lgkmcnt(7)
v_cvt_pk_bf16_f32 v71, v46, v47
v_mfma_f32_16x16x32_bf16 v[136:139], a[104:107], v[80:83], v[136:139]
v_exp_f32 v48, v48
v_mfma_f32_16x16x32_bf16 v[168:171], a[104:107], v[84:87], v[168:171]
ds_read_b128 a[72:75], v26 offset:10240
v_mfma_f32_16x16x32_bf16 v[200:203], a[104:107], v[88:91], v[200:203]
v_exp_f32 v49, v49
v_mfma_f32_16x16x32_bf16 v[232:235], a[104:107], v[92:95], v[232:235]
s_waitcnt lgkmcnt(7)
v_cvt_pk_bf16_f32 v72, v48, v49
v_mfma_f32_16x16x32_bf16 v[236:239], a[108:111], v[92:95], v[236:239]
v_exp_f32 v50, v50
v_mfma_f32_16x16x32_bf16 v[204:207], a[108:111], v[88:91], v[204:207]
ds_read_b128 a[76:79], v26 offset:11264
v_mfma_f32_16x16x32_bf16 v[172:175], a[108:111], v[84:87], v[172:175]
v_exp_f32 v51, v51
v_mfma_f32_16x16x32_bf16 v[140:143], a[108:111], v[80:83], v[140:143]
s_waitcnt lgkmcnt(7)
v_cvt_pk_bf16_f32 v73, v50, v51
v_mfma_f32_16x16x32_bf16 v[144:147], a[112:115], v[80:83], v[144:147]
v_exp_f32 v52, v52
v_mfma_f32_16x16x32_bf16 v[176:179], a[112:115], v[84:87], v[176:179]
ds_read_b128 a[92:95], v26 offset:15360
v_mfma_f32_16x16x32_bf16 v[208:211], a[112:115], v[88:91], v[208:211]
v_exp_f32 v53, v53
v_mfma_f32_16x16x32_bf16 v[240:243], a[112:115], v[92:95], v[240:243]
s_waitcnt lgkmcnt(7)
v_cvt_pk_bf16_f32 v74, v52, v53
v_mfma_f32_16x16x32_bf16 v[244:247], a[116:119], v[92:95], v[244:247]
v_exp_f32 v54, v54
v_mfma_f32_16x16x32_bf16 v[212:215], a[116:119], v[88:91], v[212:215]
ds_read_b128 a[88:91], v26 offset:14336
buffer_load_dwordx4 v1, s[4:7], s90 offen offset:3072 sc1 lds
s_add_u32 s90, s90, 0x4000
v_mfma_f32_16x16x32_bf16 v[180:183], a[116:119], v[84:87], v[180:183]
v_exp_f32 v55, v55
v_mfma_f32_16x16x32_bf16 v[148:151], a[116:119], v[80:83], v[148:151]
s_waitcnt lgkmcnt(7)
v_cvt_pk_bf16_f32 v75, v54, v55
v_mfma_f32_16x16x32_bf16 v[152:155], a[120:123], v[80:83], v[152:155]
v_exp_f32 v56, v56
v_mfma_f32_16x16x32_bf16 v[184:187], a[120:123], v[84:87], v[184:187]
ds_read_b128 a[84:87], v26 offset:13312
v_mfma_f32_16x16x32_bf16 v[216:219], a[120:123], v[88:91], v[216:219]
s_nop 0
v_cndmask_b32_e64 v120, v96, v29, s[80:81]
v_cndmask_b32_e64 v121, v96, v29, s[82:83]
v_cmp_gt_i32_e64 s[80:81], 2, v27
v_cmp_gt_i32_e64 s[82:83], 3, v27
s_nop 0
v_cndmask_b32_e64 v122, v96, v29, s[80:81]
v_cndmask_b32_e64 v123, v96, v29, s[82:83]
v_cmp_gt_i32_e64 s[80:81], 16, v27
v_cmp_gt_i32_e64 s[82:83], 17, v27
s_nop 0
v_cndmask_b32_e64 v124, v96, v29, s[80:81]
v_cndmask_b32_e64 v125, v96, v29, s[82:83]
v_cmp_gt_i32_e64 s[80:81], 18, v27
v_cmp_gt_i32_e64 s[82:83], 19, v27
s_nop 0
v_cndmask_b32_e64 v126, v96, v29, s[80:81]
v_cndmask_b32_e64 v127, v96, v29, s[82:83]
v_exp_f32 v57, v57
v_mfma_f32_16x16x32_bf16 v[248:251], a[120:123], v[92:95], v[248:251]
s_waitcnt lgkmcnt(7)
v_cvt_pk_bf16_f32 v76, v56, v57
v_mfma_f32_16x16x32_bf16 v[252:255], a[124:127], v[92:95], v[252:255]
v_exp_f32 v58, v58
v_mfma_f32_16x16x32_bf16 v[220:223], a[124:127], v[88:91], v[220:223]
ds_read_b128 a[80:83], v26 offset:12288
v_mfma_f32_16x16x32_bf16 v[188:191], a[124:127], v[84:87], v[188:191]
s_add_u32 s91, s91, 0x8000
v_exp_f32 v59, v59
v_mfma_f32_16x16x32_bf16 v[156:159], a[124:127], v[80:83], v[156:159]
s_and_b32 s91, s91, 0x18000
v_cvt_pk_bf16_f32 v77, v58, v59
v_mfma_f32_16x16x32_bf16 a[128:131], a[144:147], v[80:83], a[128:131]
v_mfma_f32_16x16x32_bf16 a[132:135], a[144:147], v[84:87], a[132:135]
v_mfma_f32_16x16x32_bf16 a[136:139], a[144:147], v[88:91], a[136:139]
s_barrier
v_mfma_f32_16x16x32_bf16 a[140:143], a[144:147], v[92:95], a[140:143]
v_add_u32 v26, s91, v2
s_cmp_eq_u32 s87, 0
s_cbranch_scc1 L_dual_done
.p2align 6
L_dual:
s_waitcnt lgkmcnt(4)
v_mfma_f32_16x16x32_bf16 v[32:35], a[64:67], a[0:3], v[96:99]
s_sub_u32 s72, s72, 1
s_cbranch_scc1 L_fv3
L_back_fv3:
v_exp_f32 v60, v60
v_mfma_f32_16x16x32_bf16 v[32:35], a[68:71], a[4:7], v[32:35]
s_xor_b32 s75, s91, 0x10000
ds_read_b128 a[96:99], v26 offset:16384
v_mfma_f32_16x16x32_bf16 v[32:35], a[72:75], a[8:11], v[32:35]
s_add_u32 m0, s75, s59
v_exp_f32 v61, v61
v_mfma_f32_16x16x32_bf16 v[32:35], a[76:79], a[12:15], v[32:35]
s_waitcnt lgkmcnt(1)
v_cvt_pk_bf16_f32 v78, v60, v61
v_mfma_f32_16x16x32_bf16 v[36:39], a[92:95], a[12:15], v[96:99]
v_exp_f32 v62, v62
v_mfma_f32_16x16x32_bf16 v[36:39], a[88:91], a[8:11], v[36:39]
ds_read_b128 a[100:103], v26 offset:17408
buffer_load_dwordx4 v1, s[4:7], s89 offen sc1 lds
v_mfma_f32_16x16x32_bf16 v[36:39], a[84:87], a[4:7], v[36:39]
v_exp_f32 v63, v63
v_mfma_f32_16x16x32_bf16 v[36:39], a[80:83], a[0:3], v[36:39]
v_cvt_pk_bf16_f32 v79, v62, v63
v_mfma_f32_16x16x32_bf16 v[40:43], a[64:67], a[16:19], v[100:103]
v_exp_f32 v32, v32
v_mfma_f32_16x16x32_bf16 v[40:43], a[68:71], a[20:23], v[40:43]
ds_read_b128 a[104:107], v26 offset:18432
v_mfma_f32_16x16x32_bf16 v[40:43], a[72:75], a[24:27], v[40:43]
v_exp_f32 v33, v33
v_mfma_f32_16x16x32_bf16 v[40:43], a[76:79], a[28:31], v[40:43]
v_cvt_pk_bf16_f32 v80, v32, v33
v_mfma_f32_16x16x32_bf16 v[44:47], a[92:95], a[28:31], v[100:103]
v_exp_f32 v34, v34
v_mfma_f32_16x16x32_bf16 v[44:47], a[88:91], a[24:27], v[44:47]
ds_read_b128 a[108:111], v26 offset:19456
v_mfma_f32_16x16x32_bf16 v[44:47], a[84:87], a[20:23], v[44:47]
v_exp_f32 v35, v35
v_mfma_f32_16x16x32_bf16 v[44:47], a[80:83], a[16:19], v[44:47]
v_cvt_pk_bf16_f32 v81, v34, v35
v_mfma_f32_16x16x32_bf16 v[48:51], a[64:67], a[32:35], v[104:107]
v_exp_f32 v36, v36
v_mfma_f32_16x16x32_bf16 v[48:51], a[68:71], a[36:39], v[48:51]
ds_read_b128 a[112:115], v26 offset:20480
v_mfma_f32_16x16x32_bf16 v[48:51], a[72:75], a[40:43], v[48:51]
v_exp_f32 v37, v37
v_mfma_f32_16x16x32_bf16 v[48:51], a[76:79], a[44:47], v[48:51]
v_cvt_pk_bf16_f32 v82, v36, v37
v_mfma_f32_16x16x32_bf16 v[52:55], a[92:95], a[44:47], v[104:107]
v_exp_f32 v38, v38
v_mfma_f32_16x16x32_bf16 v[52:55], a[88:91], a[40:43], v[52:55]
ds_read_b128 a[116:119], v26 offset:21504
buffer_load_dwordx4 v1, s[4:7], s89 offen offset:1024 sc1 lds
v_mfma_f32_16x16x32_bf16 v[52:55], a[84:87], a[36:39], v[52:55]
v_exp_f32 v39, v39
v_mfma_f32_16x16x32_bf16 v[52:55], a[80:83], a[32:35], v[52:55]
v_cvt_pk_bf16_f32 v83, v38, v39
v_mfma_f32_16x16x32_bf16 v[56:59], a[64:67], a[48:51], v[108:111]
v_exp_f32 v40, v40
v_mfma_f32_16x16x32_bf16 v[56:59], a[68:71], a[52:55], v[56:59]
ds_read_b128 a[120:123], v26 offset:22528
v_mfma_f32_16x16x32_bf16 v[56:59], a[72:75], a[56:59], v[56:59]
v_exp_f32 v41, v41
v_mfma_f32_16x16x32_bf16 v[56:59], a[76:79], a[60:63], v[56:59]
v_cvt_pk_bf16_f32 v84, v40, v41
v_mfma_f32_16x16x32_bf16 v[60:63], a[92:95], a[60:63], v[108:111]
v_exp_f32 v42, v42
v_mfma_f32_16x16x32_bf16 v[60:63], a[88:91], a[56:59], v[60:63]
ds_read_b128 a[124:127], v26 offset:23552
v_mfma_f32_16x16x32_bf16 v[60:63], a[84:87], a[52:55], v[60:63]
v_exp_f32 v43, v43
v_mfma_f32_16x16x32_bf16 v[60:63], a[80:83], a[48:51], v[60:63]
s_waitcnt lgkmcnt(7)
v_cvt_pk_bf16_f32 v85, v42, v43
v_mfma_f32_16x16x32_bf16 v[128:131], a[96:99], v[64:67], v[128:131]
v_exp_f32 v44, v44
v_mfma_f32_16x16x32_bf16 v[160:163], a[96:99], v[68:71], v[160:163]
ds_read_b128 a[64:67], v26
v_mfma_f32_16x16x32_bf16 v[192:195], a[96:99], v[72:75], v[192:195]
v_exp_f32 v45, v45
v_mfma_f32_16x16x32_bf16 v[224:227], a[96:99], v[76:79], v[224:227]
s_waitcnt lgkmcnt(7)
v_cvt_pk_bf16_f32 v86, v44, v45
v_mfma_f32_16x16x32_bf16 v[228:231], a[100:103], v[76:79], v[228:231]
v_exp_f32 v46, v46
v_mfma_f32_16x16x32_bf16 v[196:199], a[100:103], v[72:75], v[196:199]
ds_read_b128 a[68:71], v26 offset:1024
buffer_load_dwordx4 v1, s[4:7], s89 offen offset:2048 sc1 lds
v_mfma_f32_16x16x32_bf16 v[164:167], a[100:103], v[68:71], v[164:167]
v_exp_f32 v47, v47
v_mfma_f32_16x16x32_bf16 v[132:135], a[100:103], v[64:67], v[132:135]
s_waitcnt lgkmcnt(7)
v_cvt_pk_bf16_f32 v87, v46, v47
v_mfma_f32_16x16x32_bf16 v[136:139], a[104:107], v[64:67], v[136:139]
v_exp_f32 v48, v48
v_mfma_f32_16x16x32_bf16 v[168:171], a[104:107], v[68:71], v[168:171]
ds_read_b128 a[72:75], v26 offset:2048
v_mfma_f32_16x16x32_bf16 v[200:203], a[104:107], v[72:75], v[200:203]
v_exp_f32 v49, v49
v_mfma_f32_16x16x32_bf16 v[232:235], a[104:107], v[76:79], v[232:235]
s_waitcnt lgkmcnt(7)
v_cvt_pk_bf16_f32 v88, v48, v49
v_mfma_f32_16x16x32_bf16 v[236:239], a[108:111], v[76:79], v[236:239]
v_exp_f32 v50, v50
v_mfma_f32_16x16x32_bf16 v[204:207], a[108:111], v[72:75], v[204:207]
ds_read_b128 a[76:79], v26 offset:3072
v_mfma_f32_16x16x32_bf16 v[172:175], a[108:111], v[68:71], v[172:175]
v_exp_f32 v51, v51
v_mfma_f32_16x16x32_bf16 v[140:143], a[108:111], v[64:67], v[140:143]
s_waitcnt lgkmcnt(7)
v_cvt_pk_bf16_f32 v89, v50, v51
v_mfma_f32_16x16x32_bf16 v[144:147], a[112:115], v[64:67], v[144:147]
v_exp_f32 v52, v52
v_mfma_f32_16x16x32_bf16 v[176:179], a[112:115], v[68:71], v[176:179]
ds_read_b128 a[92:95], v26 offset:7168
v_mfma_f32_16x16x32_bf16 v[208:211], a[112:115], v[72:75], v[208:211]
v_exp_f32 v53, v53
v_mfma_f32_16x16x32_bf16 v[240:243], a[112:115], v[76:79], v[240:243]
s_waitcnt lgkmcnt(7)
v_cvt_pk_bf16_f32 v90, v52, v53
v_mfma_f32_16x16x32_bf16 v[244:247], a[116:119], v[76:79], v[244:247]
v_exp_f32 v54, v54
v_mfma_f32_16x16x32_bf16 v[212:215], a[116:119], v[72:75], v[212:215]
ds_read_b128 a[88:91], v26 offset:6144
buffer_load_dwordx4 v1, s[4:7], s89 offen offset:3072 sc1 lds
s_add_u32 s89, s89, 0x4000
v_mfma_f32_16x16x32_bf16 v[180:183], a[116:119], v[68:71], v[180:183]
v_exp_f32 v55, v55
v_mfma_f32_16x16x32_bf16 v[148:151], a[116:119], v[64:67], v[148:151]
s_waitcnt lgkmcnt(7)
v_cvt_pk_bf16_f32 v91, v54, v55
v_mfma_f32_16x16x32_bf16 v[152:155], a[120:123], v[64:67], v[152:155]
v_exp_f32 v56, v56
v_mfma_f32_16x16x32_bf16 v[184:187], a[120:123], v[68:71], v[184:187]
ds_read_b128 a[84:87], v26 offset:5120
v_mfma_f32_16x16x32_bf16 v[216:219], a[120:123], v[72:75], v[216:219]
v_exp_f32 v57, v57
v_mfma_f32_16x16x32_bf16 v[248:251], a[120:123], v[76:79], v[248:251]
s_waitcnt lgkmcnt(7)
v_cvt_pk_bf16_f32 v92, v56, v57
v_mfma_f32_16x16x32_bf16 v[252:255], a[124:127], v[76:79], v[252:255]
v_exp_f32 v58, v58
v_mfma_f32_16x16x32_bf16 v[220:223], a[124:127], v[72:75], v[220:223]
ds_read_b128 a[80:83], v26 offset:4096
v_mfma_f32_16x16x32_bf16 v[188:191], a[124:127], v[68:71], v[188:191]
v_exp_f32 v59, v59
v_mfma_f32_16x16x32_bf16 v[156:159], a[124:127], v[64:67], v[156:159]
v_cvt_pk_bf16_f32 v93, v58, v59
v_mfma_f32_16x16x32_bf16 a[128:131], a[144:147], v[64:67], a[128:131]
v_mfma_f32_16x16x32_bf16 a[132:135], a[144:147], v[68:71], a[132:135]
v_mfma_f32_16x16x32_bf16 a[136:139], a[144:147], v[72:75], a[136:139]
v_mfma_f32_16x16x32_bf16 a[140:143], a[144:147], v[76:79], a[140:143]
s_waitcnt lgkmcnt(4)
v_mfma_f32_16x16x32_bf16 v[32:35], a[64:67], a[0:3], v[112:115]
v_exp_f32 v60, v60
v_mfma_f32_16x16x32_bf16 v[32:35], a[68:71], a[4:7], v[32:35]
ds_read_b128 a[96:99], v26 offset:24576
v_mfma_f32_16x16x32_bf16 v[32:35], a[72:75], a[8:11], v[32:35]
s_add_u32 m0, m0, 0x4000
v_exp_f32 v61, v61
v_mfma_f32_16x16x32_bf16 v[32:35], a[76:79], a[12:15], v[32:35]
s_waitcnt lgkmcnt(1)
v_cvt_pk_bf16_f32 v94, v60, v61
v_mfma_f32_16x16x32_bf16 v[36:39], a[92:95], a[12:15], v[116:119]
v_exp_f32 v62, v62
v_mfma_f32_16x16x32_bf16 v[36:39], a[88:91], a[8:11], v[36:39]
ds_read_b128 a[100:103], v26 offset:25600
buffer_load_dwordx4 v1, s[4:7], s90 offen sc1 lds
v_mfma_f32_16x16x32_bf16 v[36:39], a[84:87], a[4:7], v[36:39]
v_exp_f32 v63, v63
v_mfma_f32_16x16x32_bf16 v[36:39], a[80:83], a[0:3], v[36:39]
v_cvt_pk_bf16_f32 v95, v62, v63
v_mfma_f32_16x16x32_bf16 v[40:43], a[64:67], a[16:19], v[100:103]
v_exp_f32 v32, v32
v_mfma_f32_16x16x32_bf16 v[40:43], a[68:71], a[20:23], v[40:43]
ds_read_b128 a[104:107], v26 offset:26624
v_mfma_f32_16x16x32_bf16 v[40:43], a[72:75], a[24:27], v[40:43]
v_exp_f32 v33, v33
v_mfma_f32_16x16x32_bf16 v[40:43], a[76:79], a[28:31], v[40:43]
v_cvt_pk_bf16_f32 v64, v32, v33
v_mfma_f32_16x16x32_bf16 v[44:47], a[92:95], a[28:31], v[100:103]
v_exp_f32 v34, v34
v_mfma_f32_16x16x32_bf16 v[44:47], a[88:91], a[24:27], v[44:47]
ds_read_b128 a[108:111], v26 offset:27648
v_mfma_f32_16x16x32_bf16 v[44:47], a[84:87], a[20:23], v[44:47]
v_exp_f32 v35, v35
v_mfma_f32_16x16x32_bf16 v[44:47], a[80:83], a[16:19], v[44:47]
v_cvt_pk_bf16_f32 v65, v34, v35
v_mfma_f32_16x16x32_bf16 v[48:51], a[64:67], a[32:35], v[104:107]
v_exp_f32 v36, v36
v_mfma_f32_16x16x32_bf16 v[48:51], a[68:71], a[36:39], v[48:51]
ds_read_b128 a[112:115], v26 offset:28672
v_mfma_f32_16x16x32_bf16 v[48:51], a[72:75], a[40:43], v[48:51]
v_exp_f32 v37, v37
v_mfma_f32_16x16x32_bf16 v[48:51], a[76:79], a[44:47], v[48:51]
v_cvt_pk_bf16_f32 v66, v36, v37
v_mfma_f32_16x16x32_bf16 v[52:55], a[92:95], a[44:47], v[104:107]
v_exp_f32 v38, v38
v_mfma_f32_16x16x32_bf16 v[52:55], a[88:91], a[40:43], v[52:55]
ds_read_b128 a[116:119], v26 offset:29696
buffer_load_dwordx4 v1, s[4:7], s90 offen offset:1024 sc1 lds
v_mfma_f32_16x16x32_bf16 v[52:55], a[84:87], a[36:39], v[52:55]
v_exp_f32 v39, v39
v_mfma_f32_16x16x32_bf16 v[52:55], a[80:83], a[32:35], v[52:55]
v_cvt_pk_bf16_f32 v67, v38, v39
v_mfma_f32_16x16x32_bf16 v[56:59], a[64:67], a[48:51], v[108:111]
v_exp_f32 v40, v40
v_mfma_f32_16x16x32_bf16 v[56:59], a[68:71], a[52:55], v[56:59]
ds_read_b128 a[120:123], v26 offset:30720
v_mfma_f32_16x16x32_bf16 v[56:59], a[72:75], a[56:59], v[56:59]
v_exp_f32 v41, v41
v_mfma_f32_16x16x32_bf16 v[56:59], a[76:79], a[60:63], v[56:59]
v_cvt_pk_bf16_f32 v68, v40, v41
v_mfma_f32_16x16x32_bf16 v[60:63], a[92:95], a[60:63], v[108:111]
v_exp_f32 v42, v42
v_mfma_f32_16x16x32_bf16 v[60:63], a[88:91], a[56:59], v[60:63]
ds_read_b128 a[124:127], v26 offset:31744
v_mfma_f32_16x16x32_bf16 v[60:63], a[84:87], a[52:55], v[60:63]
v_exp_f32 v43, v43
v_mfma_f32_16x16x32_bf16 v[60:63], a[80:83], a[48:51], v[60:63]
s_waitcnt lgkmcnt(7)
v_cvt_pk_bf16_f32 v69, v42, v43
v_mfma_f32_16x16x32_bf16 v[128:131], a[96:99], v[80:83], v[128:131]
s_sub_u32 s87, s87, 1
v_exp_f32 v44, v44
v_mfma_f32_16x16x32_bf16 v[160:163], a[96:99], v[84:87], v[160:163]
ds_read_b128 a[64:67], v26 offset:8192
v_mfma_f32_16x16x32_bf16 v[192:195], a[96:99], v[88:91], v[192:195]
v_exp_f32 v45, v45
v_mfma_f32_16x16x32_bf16 v[224:227], a[96:99], v[92:95], v[224:227]
s_waitcnt lgkmcnt(7)
v_cvt_pk_bf16_f32 v70, v44, v45
v_mfma_f32_16x16x32_bf16 v[228:231], a[100:103], v[92:95], v[228:231]
v_exp_f32 v46, v46
v_mfma_f32_16x16x32_bf16 v[196:199], a[100:103], v[88:91], v[196:199]
ds_read_b128 a[68:71], v26 offset:9216
buffer_load_dwordx4 v1, s[4:7], s90 offen offset:2048 sc1 lds
v_mfma_f32_16x16x32_bf16 v[164:167], a[100:103], v[84:87], v[164:167]
v_exp_f32 v47, v47
v_mfma_f32_16x16x32_bf16 v[132:135], a[100:103], v[80:83], v[132:135]
s_waitcnt lgkmcnt(7)
v_cvt_pk_bf16_f32 v71, v46, v47
v_mfma_f32_16x16x32_bf16 v[136:139], a[104:107], v[80:83], v[136:139]
v_exp_f32 v48, v48
v_mfma_f32_16x16x32_bf16 v[168:171], a[104:107], v[84:87], v[168:171]
ds_read_b128 a[72:75], v26 offset:10240
v_mfma_f32_16x16x32_bf16 v[200:203], a[104:107], v[88:91], v[200:203]
v_exp_f32 v49, v49
v_mfma_f32_16x16x32_bf16 v[232:235], a[104:107], v[92:95], v[232:235]
s_waitcnt lgkmcnt(7)
v_cvt_pk_bf16_f32 v72, v48, v49
v_mfma_f32_16x16x32_bf16 v[236:239], a[108:111], v[92:95], v[236:239]
v_exp_f32 v50, v50
v_mfma_f32_16x16x32_bf16 v[204:207], a[108:111], v[88:91], v[204:207]
ds_read_b128 a[76:79], v26 offset:11264
v_mfma_f32_16x16x32_bf16 v[172:175], a[108:111], v[84:87], v[172:175]
v_exp_f32 v51, v51
v_mfma_f32_16x16x32_bf16 v[140:143], a[108:111], v[80:83], v[140:143]
s_waitcnt lgkmcnt(7)
v_cvt_pk_bf16_f32 v73, v50, v51
v_mfma_f32_16x16x32_bf16 v[144:147], a[112:115], v[80:83], v[144:147]
v_exp_f32 v52, v52
v_mfma_f32_16x16x32_bf16 v[176:179], a[112:115], v[84:87], v[176:179]
ds_read_b128 a[92:95], v26 offset:15360
v_mfma_f32_16x16x32_bf16 v[208:211], a[112:115], v[88:91], v[208:211]
v_exp_f32 v53, v53
v_mfma_f32_16x16x32_bf16 v[240:243], a[112:115], v[92:95], v[240:243]
s_waitcnt lgkmcnt(7)
v_cvt_pk_bf16_f32 v74, v52, v53
v_mfma_f32_16x16x32_bf16 v[244:247], a[116:119], v[92:95], v[244:247]
v_exp_f32 v54, v54
v_mfma_f32_16x16x32_bf16 v[212:215], a[116:119], v[88:91], v[212:215]
ds_read_b128 a[88:91], v26 offset:14336
buffer_load_dwordx4 v1, s[4:7], s90 offen offset:3072 sc1 lds
s_add_u32 s90, s90, 0x4000
v_mfma_f32_16x16x32_bf16 v[180:183], a[116:119], v[84:87], v[180:183]
v_exp_f32 v55, v55
v_mfma_f32_16x16x32_bf16 v[148:151], a[116:119], v[80:83], v[148:151]
s_waitcnt lgkmcnt(7)
v_cvt_pk_bf16_f32 v75, v54, v55
v_mfma_f32_16x16x32_bf16 v[152:155], a[120:123], v[80:83], v[152:155]
v_exp_f32 v56, v56
v_mfma_f32_16x16x32_bf16 v[184:187], a[120:123], v[84:87], v[184:187]
ds_read_b128 a[84:87], v26 offset:13312
v_mfma_f32_16x16x32_bf16 v[216:219], a[120:123], v[88:91], v[216:219]
v_exp_f32 v57, v57
v_mfma_f32_16x16x32_bf16 v[248:251], a[120:123], v[92:95], v[248:251]
s_waitcnt lgkmcnt(7)
v_cvt_pk_bf16_f32 v76, v56, v57
v_mfma_f32_16x16x32_bf16 v[252:255], a[124:127], v[92:95], v[252:255]
v_exp_f32 v58, v58
v_mfma_f32_16x16x32_bf16 v[220:223], a[124:127], v[88:91], v[220:223]
ds_read_b128 a[80:83], v26 offset:12288
v_mfma_f32_16x16x32_bf16 v[188:191], a[124:127], v[84:87], v[188:191]
s_add_u32 s91, s91, 0x8000
v_exp_f32 v59, v59
v_mfma_f32_16x16x32_bf16 v[156:159], a[124:127], v[80:83], v[156:159]
s_and_b32 s91, s91, 0x18000
v_cvt_pk_bf16_f32 v77, v58, v59
v_mfma_f32_16x16x32_bf16 a[128:131], a[144:147], v[80:83], a[128:131]
v_mfma_f32_16x16x32_bf16 a[132:135], a[144:147], v[84:87], a[132:135]
v_mfma_f32_16x16x32_bf16 a[136:139], a[144:147], v[88:91], a[136:139]
s_waitcnt vmcnt(8)
s_barrier
v_mfma_f32_16x16x32_bf16 a[140:143], a[144:147], v[92:95], a[140:143]
s_waitcnt lgkmcnt(4)
v_add_u32 v26, s91, v2
v_mfma_f32_16x16x32_bf16 v[32:35], a[64:67], a[0:3], v[96:99]
s_sub_u32 s72, s72, 1
s_cbranch_scc1 L_fv4
L_back_fv4:
v_exp_f32 v60, v60
v_mfma_f32_16x16x32_bf16 v[32:35], a[68:71], a[4:7], v[32:35]
s_xor_b32 s75, s91, 0x10000
ds_read_b128 a[96:99], v26 offset:16384
v_mfma_f32_16x16x32_bf16 v[32:35], a[72:75], a[8:11], v[32:35]
s_add_u32 m0, s75, s59
v_exp_f32 v61, v61
v_mfma_f32_16x16x32_bf16 v[32:35], a[76:79], a[12:15], v[32:35]
s_waitcnt lgkmcnt(1)
v_cvt_pk_bf16_f32 v78, v60, v61
v_mfma_f32_16x16x32_bf16 v[36:39], a[92:95], a[12:15], v[96:99]
v_exp_f32 v62, v62
v_mfma_f32_16x16x32_bf16 v[36:39], a[88:91], a[8:11], v[36:39]
ds_read_b128 a[100:103], v26 offset:17408
buffer_load_dwordx4 v1, s[4:7], s89 offen sc1 lds
v_mfma_f32_16x16x32_bf16 v[36:39], a[84:87], a[4:7], v[36:39]
v_exp_f32 v63, v63
v_mfma_f32_16x16x32_bf16 v[36:39], a[80:83], a[0:3], v[36:39]
v_cvt_pk_bf16_f32 v79, v62, v63
v_mfma_f32_16x16x32_bf16 v[40:43], a[64:67], a[16:19], v[100:103]
v_exp_f32 v32, v32
v_mfma_f32_16x16x32_bf16 v[40:43], a[68:71], a[20:23], v[40:43]
ds_read_b128 a[104:107], v26 offset:18432
v_mfma_f32_16x16x32_bf16 v[40:43], a[72:75], a[24:27], v[40:43]
v_exp_f32 v33, v33
v_mfma_f32_16x16x32_bf16 v[40:43], a[76:79], a[28:31], v[40:43]
v_cvt_pk_bf16_f32 v80, v32, v33
v_mfma_f32_16x16x32_bf16 v[44:47], a[92:95], a[28:31], v[100:103]
v_exp_f32 v34, v34
v_mfma_f32_16x16x32_bf16 v[44:47], a[88:91], a[24:27], v[44:47]
ds_read_b128 a[108:111], v26 offset:19456
v_mfma_f32_16x16x32_bf16 v[44:47], a[84:87], a[20:23], v[44:47]
v_exp_f32 v35, v35
v_mfma_f32_16x16x32_bf16 v[44:47], a[80:83], a[16:19], v[44:47]
v_cvt_pk_bf16_f32 v81, v34, v35
v_mfma_f32_16x16x32_bf16 v[48:51], a[64:67], a[32:35], v[104:107]
v_exp_f32 v36, v36
v_mfma_f32_16x16x32_bf16 v[48:51], a[68:71], a[36:39], v[48:51]
ds_read_b128 a[112:115], v26 offset:20480
v_mfma_f32_16x16x32_bf16 v[48:51], a[72:75], a[40:43], v[48:51]
v_exp_f32 v37, v37
v_mfma_f32_16x16x32_bf16 v[48:51], a[76:79], a[44:47], v[48:51]
v_cvt_pk_bf16_f32 v82, v36, v37
v_mfma_f32_16x16x32_bf16 v[52:55], a[92:95], a[44:47], v[104:107]
v_exp_f32 v38, v38
v_mfma_f32_16x16x32_bf16 v[52:55], a[88:91], a[40:43], v[52:55]
ds_read_b128 a[116:119], v26 offset:21504
buffer_load_dwordx4 v1, s[4:7], s89 offen offset:1024 sc1 lds
v_mfma_f32_16x16x32_bf16 v[52:55], a[84:87], a[36:39], v[52:55]
v_exp_f32 v39, v39
v_mfma_f32_16x16x32_bf16 v[52:55], a[80:83], a[32:35], v[52:55]
v_cvt_pk_bf16_f32 v83, v38, v39
v_mfma_f32_16x16x32_bf16 v[56:59], a[64:67], a[48:51], v[108:111]
v_exp_f32 v40, v40
v_mfma_f32_16x16x32_bf16 v[56:59], a[68:71], a[52:55], v[56:59]
ds_read_b128 a[120:123], v26 offset:22528
v_mfma_f32_16x16x32_bf16 v[56:59], a[72:75], a[56:59], v[56:59]
v_exp_f32 v41, v41
v_mfma_f32_16x16x32_bf16 v[56:59], a[76:79], a[60:63], v[56:59]
v_cvt_pk_bf16_f32 v84, v40, v41
v_mfma_f32_16x16x32_bf16 v[60:63], a[92:95], a[60:63], v[108:111]
v_exp_f32 v42, v42
v_mfma_f32_16x16x32_bf16 v[60:63], a[88:91], a[56:59], v[60:63]
ds_read_b128 a[124:127], v26 offset:23552
v_mfma_f32_16x16x32_bf16 v[60:63], a[84:87], a[52:55], v[60:63]
v_exp_f32 v43, v43
v_mfma_f32_16x16x32_bf16 v[60:63], a[80:83], a[48:51], v[60:63]
s_waitcnt lgkmcnt(7)
v_cvt_pk_bf16_f32 v85, v42, v43
v_mfma_f32_16x16x32_bf16 v[128:131], a[96:99], v[64:67], v[128:131]
v_exp_f32 v44, v44
v_mfma_f32_16x16x32_bf16 v[160:163], a[96:99], v[68:71], v[160:163]
ds_read_b128 a[64:67], v26
v_mfma_f32_16x16x32_bf16 v[192:195], a[96:99], v[72:75], v[192:195]
v_exp_f32 v45, v45
v_mfma_f32_16x16x32_bf16 v[224:227], a[96:99], v[76:79], v[224:227]
s_waitcnt lgkmcnt(7)
v_cvt_pk_bf16_f32 v86, v44, v45
v_mfma_f32_16x16x32_bf16 v[228:231], a[100:103], v[76:79], v[228:231]
v_exp_f32 v46, v46
v_mfma_f32_16x16x32_bf16 v[196:199], a[100:103], v[72:75], v[196:199]
ds_read_b128 a[68:71], v26 offset:1024
buffer_load_dwordx4 v1, s[4:7], s89 offen offset:2048 sc1 lds
v_mfma_f32_16x16x32_bf16 v[164:167], a[100:103], v[68:71], v[164:167]
v_exp_f32 v47, v47
v_mfma_f32_16x16x32_bf16 v[132:135], a[100:103], v[64:67], v[132:135]
s_waitcnt lgkmcnt(7)
v_cvt_pk_bf16_f32 v87, v46, v47
v_mfma_f32_16x16x32_bf16 v[136:139], a[104:107], v[64:67], v[136:139]
v_exp_f32 v48, v48
v_mfma_f32_16x16x32_bf16 v[168:171], a[104:107], v[68:71], v[168:171]
ds_read_b128 a[72:75], v26 offset:2048
v_mfma_f32_16x16x32_bf16 v[200:203], a[104:107], v[72:75], v[200:203]
v_exp_f32 v49, v49
v_mfma_f32_16x16x32_bf16 v[232:235], a[104:107], v[76:79], v[232:235]
s_waitcnt lgkmcnt(7)
v_cvt_pk_bf16_f32 v88, v48, v49
v_mfma_f32_16x16x32_bf16 v[236:239], a[108:111], v[76:79], v[236:239]
v_exp_f32 v50, v50
v_mfma_f32_16x16x32_bf16 v[204:207], a[108:111], v[72:75], v[204:207]
ds_read_b128 a[76:79], v26 offset:3072
v_mfma_f32_16x16x32_bf16 v[172:175], a[108:111], v[68:71], v[172:175]
v_exp_f32 v51, v51
v_mfma_f32_16x16x32_bf16 v[140:143], a[108:111], v[64:67], v[140:143]
s_waitcnt lgkmcnt(7)
v_cvt_pk_bf16_f32 v89, v50, v51
v_mfma_f32_16x16x32_bf16 v[144:147], a[112:115], v[64:67], v[144:147]
v_exp_f32 v52, v52
v_mfma_f32_16x16x32_bf16 v[176:179], a[112:115], v[68:71], v[176:179]
ds_read_b128 a[92:95], v26 offset:7168
v_mfma_f32_16x16x32_bf16 v[208:211], a[112:115], v[72:75], v[208:211]
v_exp_f32 v53, v53
v_mfma_f32_16x16x32_bf16 v[240:243], a[112:115], v[76:79], v[240:243]
s_waitcnt lgkmcnt(7)
v_cvt_pk_bf16_f32 v90, v52, v53
v_mfma_f32_16x16x32_bf16 v[244:247], a[116:119], v[76:79], v[244:247]
v_exp_f32 v54, v54
v_mfma_f32_16x16x32_bf16 v[212:215], a[116:119], v[72:75], v[212:215]
ds_read_b128 a[88:91], v26 offset:6144
buffer_load_dwordx4 v1, s[4:7], s89 offen offset:3072 sc1 lds
s_add_u32 s89, s89, 0x4000
v_mfma_f32_16x16x32_bf16 v[180:183], a[116:119], v[68:71], v[180:183]
v_exp_f32 v55, v55
v_mfma_f32_16x16x32_bf16 v[148:151], a[116:119], v[64:67], v[148:151]
s_waitcnt lgkmcnt(7)
v_cvt_pk_bf16_f32 v91, v54, v55
v_mfma_f32_16x16x32_bf16 v[152:155], a[120:123], v[64:67], v[152:155]
v_exp_f32 v56, v56
v_mfma_f32_16x16x32_bf16 v[184:187], a[120:123], v[68:71], v[184:187]
ds_read_b128 a[84:87], v26 offset:5120
v_mfma_f32_16x16x32_bf16 v[216:219], a[120:123], v[72:75], v[216:219]
v_exp_f32 v57, v57
v_mfma_f32_16x16x32_bf16 v[248:251], a[120:123], v[76:79], v[248:251]
s_waitcnt lgkmcnt(7)
v_cvt_pk_bf16_f32 v92, v56, v57
v_mfma_f32_16x16x32_bf16 v[252:255], a[124:127], v[76:79], v[252:255]
v_exp_f32 v58, v58
v_mfma_f32_16x16x32_bf16 v[220:223], a[124:127], v[72:75], v[220:223]
ds_read_b128 a[80:83], v26 offset:4096
v_mfma_f32_16x16x32_bf16 v[188:191], a[124:127], v[68:71], v[188:191]
v_exp_f32 v59, v59
v_mfma_f32_16x16x32_bf16 v[156:159], a[124:127], v[64:67], v[156:159]
s_cmp_eq_u32 s87, s60
s_cbranch_scc1 L_setca1
L_back_setca1:
v_cvt_pk_bf16_f32 v93, v58, v59
v_mfma_f32_16x16x32_bf16 a[128:131], a[144:147], v[64:67], a[128:131]
v_mfma_f32_16x16x32_bf16 a[132:135], a[144:147], v[68:71], a[132:135]
v_mfma_f32_16x16x32_bf16 a[136:139], a[144:147], v[72:75], a[136:139]
v_mfma_f32_16x16x32_bf16 a[140:143], a[144:147], v[76:79], a[140:143]
s_waitcnt lgkmcnt(4)
v_mfma_f32_16x16x32_bf16 v[32:35], a[64:67], a[0:3], v[112:115]
v_exp_f32 v60, v60
v_mfma_f32_16x16x32_bf16 v[32:35], a[68:71], a[4:7], v[32:35]
ds_read_b128 a[96:99], v26 offset:24576
v_mfma_f32_16x16x32_bf16 v[32:35], a[72:75], a[8:11], v[32:35]
s_add_u32 m0, m0, 0x4000
v_exp_f32 v61, v61
v_mfma_f32_16x16x32_bf16 v[32:35], a[76:79], a[12:15], v[32:35]
s_waitcnt lgkmcnt(1)
v_cvt_pk_bf16_f32 v94, v60, v61
v_mfma_f32_16x16x32_bf16 v[36:39], a[92:95], a[12:15], v[116:119]
v_exp_f32 v62, v62
v_mfma_f32_16x16x32_bf16 v[36:39], a[88:91], a[8:11], v[36:39]
ds_read_b128 a[100:103], v26 offset:25600
buffer_load_dwordx4 v1, s[4:7], s90 offen sc1 lds
v_mfma_f32_16x16x32_bf16 v[36:39], a[84:87], a[4:7], v[36:39]
v_exp_f32 v63, v63
v_mfma_f32_16x16x32_bf16 v[36:39], a[80:83], a[0:3], v[36:39]
v_cvt_pk_bf16_f32 v95, v62, v63
v_mfma_f32_16x16x32_bf16 v[40:43], a[64:67], a[16:19], v[100:103]
v_exp_f32 v32, v32
v_mfma_f32_16x16x32_bf16 v[40:43], a[68:71], a[20:23], v[40:43]
ds_read_b128 a[104:107], v26 offset:26624
v_mfma_f32_16x16x32_bf16 v[40:43], a[72:75], a[24:27], v[40:43]
v_exp_f32 v33, v33
v_mfma_f32_16x16x32_bf16 v[40:43], a[76:79], a[28:31], v[40:43]
v_cvt_pk_bf16_f32 v64, v32, v33
v_mfma_f32_16x16x32_bf16 v[44:47], a[92:95], a[28:31], v[100:103]
v_exp_f32 v34, v34
v_mfma_f32_16x16x32_bf16 v[44:47], a[88:91], a[24:27], v[44:47]
ds_read_b128 a[108:111], v26 offset:27648
v_mfma_f32_16x16x32_bf16 v[44:47], a[84:87], a[20:23], v[44:47]
v_exp_f32 v35, v35
v_mfma_f32_16x16x32_bf16 v[44:47], a[80:83], a[16:19], v[44:47]
v_cvt_pk_bf16_f32 v65, v34, v35
v_mfma_f32_16x16x32_bf16 v[48:51], a[64:67], a[32:35], v[104:107]
v_exp_f32 v36, v36
v_mfma_f32_16x16x32_bf16 v[48:51], a[68:71], a[36:39], v[48:51]
ds_read_b128 a[112:115], v26 offset:28672
v_mfma_f32_16x16x32_bf16 v[48:51], a[72:75], a[40:43], v[48:51]
v_exp_f32 v37, v37
v_mfma_f32_16x16x32_bf16 v[48:51], a[76:79], a[44:47], v[48:51]
v_cvt_pk_bf16_f32 v66, v36, v37
v_mfma_f32_16x16x32_bf16 v[52:55], a[92:95], a[44:47], v[104:107]
v_exp_f32 v38, v38
v_mfma_f32_16x16x32_bf16 v[52:55], a[88:91], a[40:43], v[52:55]
ds_read_b128 a[116:119], v26 offset:29696
buffer_load_dwordx4 v1, s[4:7], s90 offen offset:1024 sc1 lds
v_mfma_f32_16x16x32_bf16 v[52:55], a[84:87], a[36:39], v[52:55]
v_exp_f32 v39, v39
v_mfma_f32_16x16x32_bf16 v[52:55], a[80:83], a[32:35], v[52:55]
v_cvt_pk_bf16_f32 v67, v38, v39
v_mfma_f32_16x16x32_bf16 v[56:59], a[64:67], a[48:51], v[108:111]
v_exp_f32 v40, v40
v_mfma_f32_16x16x32_bf16 v[56:59], a[68:71], a[52:55], v[56:59]
ds_read_b128 a[120:123], v26 offset:30720
v_mfma_f32_16x16x32_bf16 v[56:59], a[72:75], a[56:59], v[56:59]
v_exp_f32 v41, v41
v_mfma_f32_16x16x32_bf16 v[56:59], a[76:79], a[60:63], v[56:59]
v_cvt_pk_bf16_f32 v68, v40, v41
v_mfma_f32_16x16x32_bf16 v[60:63], a[92:95], a[60:63], v[108:111]
v_exp_f32 v42, v42
v_mfma_f32_16x16x32_bf16 v[60:63], a[88:91], a[56:59], v[60:63]
ds_read_b128 a[124:127], v26 offset:31744
v_mfma_f32_16x16x32_bf16 v[60:63], a[84:87], a[52:55], v[60:63]
v_exp_f32 v43, v43
v_mfma_f32_16x16x32_bf16 v[60:63], a[80:83], a[48:51], v[60:63]
s_waitcnt lgkmcnt(7)
v_cvt_pk_bf16_f32 v69, v42, v43
v_mfma_f32_16x16x32_bf16 v[128:131], a[96:99], v[80:83], v[128:131]
s_sub_u32 s87, s87, 1
v_exp_f32 v44, v44
v_mfma_f32_16x16x32_bf16 v[160:163], a[96:99], v[84:87], v[160:163]
ds_read_b128 a[64:67], v26 offset:8192
v_mfma_f32_16x16x32_bf16 v[192:195], a[96:99], v[88:91], v[192:195]
v_exp_f32 v45, v45
v_mfma_f32_16x16x32_bf16 v[224:227], a[96:99], v[92:95], v[224:227]
s_waitcnt lgkmcnt(7)
v_cvt_pk_bf16_f32 v70, v44, v45
v_mfma_f32_16x16x32_bf16 v[228:231], a[100:103], v[92:95], v[228:231]
v_exp_f32 v46, v46
v_mfma_f32_16x16x32_bf16 v[196:199], a[100:103], v[88:91], v[196:199]
ds_read_b128 a[68:71], v26 offset:9216
buffer_load_dwordx4 v1, s[4:7], s90 offen offset:2048 sc1 lds
v_mfma_f32_16x16x32_bf16 v[164:167], a[100:103], v[84:87], v[164:167]
v_exp_f32 v47, v47
v_mfma_f32_16x16x32_bf16 v[132:135], a[100:103], v[80:83], v[132:135]
s_waitcnt lgkmcnt(7)
v_cvt_pk_bf16_f32 v71, v46, v47
v_mfma_f32_16x16x32_bf16 v[136:139], a[104:107], v[80:83], v[136:139]
v_exp_f32 v48, v48
v_mfma_f32_16x16x32_bf16 v[168:171], a[104:107], v[84:87], v[168:171]
ds_read_b128 a[72:75], v26 offset:10240
v_mfma_f32_16x16x32_bf16 v[200:203], a[104:107], v[88:91], v[200:203]
v_exp_f32 v49, v49
v_mfma_f32_16x16x32_bf16 v[232:235], a[104:107], v[92:95], v[232:235]
s_waitcnt lgkmcnt(7)
v_cvt_pk_bf16_f32 v72, v48, v49
v_mfma_f32_16x16x32_bf16 v[236:239], a[108:111], v[92:95], v[236:239]
v_exp_f32 v50, v50
v_mfma_f32_16x16x32_bf16 v[204:207], a[108:111], v[88:91], v[204:207]
ds_read_b128 a[76:79], v26 offset:11264
v_mfma_f32_16x16x32_bf16 v[172:175], a[108:111], v[84:87], v[172:175]
v_exp_f32 v51, v51
v_mfma_f32_16x16x32_bf16 v[140:143], a[108:111], v[80:83], v[140:143]
s_waitcnt lgkmcnt(7)
v_cvt_pk_bf16_f32 v73, v50, v51
v_mfma_f32_16x16x32_bf16 v[144:147], a[112:115], v[80:83], v[144:147]
v_exp_f32 v52, v52
v_mfma_f32_16x16x32_bf16 v[176:179], a[112:115], v[84:87], v[176:179]
ds_read_b128 a[92:95], v26 offset:15360
v_mfma_f32_16x16x32_bf16 v[208:211], a[112:115], v[88:91], v[208:211]
v_exp_f32 v53, v53
v_mfma_f32_16x16x32_bf16 v[240:243], a[112:115], v[92:95], v[240:243]
s_waitcnt lgkmcnt(7)
v_cvt_pk_bf16_f32 v74, v52, v53
v_mfma_f32_16x16x32_bf16 v[244:247], a[116:119], v[92:95], v[244:247]
v_exp_f32 v54, v54
v_mfma_f32_16x16x32_bf16 v[212:215], a[116:119], v[88:91], v[212:215]
ds_read_b128 a[88:91], v26 offset:14336
buffer_load_dwordx4 v1, s[4:7], s90 offen offset:3072 sc1 lds
s_add_u32 s90, s90, 0x4000
v_mfma_f32_16x16x32_bf16 v[180:183], a[116:119], v[84:87], v[180:183]
v_exp_f32 v55, v55
v_mfma_f32_16x16x32_bf16 v[148:151], a[116:119], v[80:83], v[148:151]
s_waitcnt lgkmcnt(7)
v_cvt_pk_bf16_f32 v75, v54, v55
v_mfma_f32_16x16x32_bf16 v[152:155], a[120:123], v[80:83], v[152:155]
v_exp_f32 v56, v56
v_mfma_f32_16x16x32_bf16 v[184:187], a[120:123], v[84:87], v[184:187]
ds_read_b128 a[84:87], v26 offset:13312
v_mfma_f32_16x16x32_bf16 v[216:219], a[120:123], v[88:91], v[216:219]
v_exp_f32 v57, v57
v_mfma_f32_16x16x32_bf16 v[248:251], a[120:123], v[92:95], v[248:251]
s_waitcnt lgkmcnt(7)
v_cvt_pk_bf16_f32 v76, v56, v57
v_mfma_f32_16x16x32_bf16 v[252:255], a[124:127], v[92:95], v[252:255]
v_exp_f32 v58, v58
v_mfma_f32_16x16x32_bf16 v[220:223], a[124:127], v[88:91], v[220:223]
ds_read_b128 a[80:83], v26 offset:12288
v_mfma_f32_16x16x32_bf16 v[188:191], a[124:127], v[84:87], v[188:191]
s_add_u32 s91, s91, 0x8000
v_exp_f32 v59, v59
v_mfma_f32_16x16x32_bf16 v[156:159], a[124:127], v[80:83], v[156:159]
s_and_b32 s91, s91, 0x18000
v_cvt_pk_bf16_f32 v77, v58, v59
v_mfma_f32_16x16x32_bf16 a[128:131], a[144:147], v[80:83], a[128:131]
v_mfma_f32_16x16x32_bf16 a[132:135], a[144:147], v[84:87], a[132:135]
v_mfma_f32_16x16x32_bf16 a[136:139], a[144:147], v[88:91], a[136:139]
s_waitcnt vmcnt(8)
s_barrier
v_mfma_f32_16x16x32_bf16 a[140:143], a[144:147], v[92:95], a[140:143]
v_add_u32 v26, s91, v2
s_cmp_lg_u32 s87, 0
s_cbranch_scc1 L_dual
L_dual_done:
s_cmp_ge_u32 s48, 2
s_cbranch_scc1 L_adY
L_adX:
s_waitcnt lgkmcnt(3)
v_mfma_f32_16x16x32_bf16 v[40:43], a[64:67], a[16:19], v[100:103]
s_sub_u32 s72, s72, 1
s_cbranch_scc1 L_fv5
L_back_fv5:
s_xor_b32 s75, s91, 0x10000
v_mfma_f32_16x16x32_bf16 v[40:43], a[68:71], a[20:23], v[40:43]
s_add_u32 m0, s75, s59
v_exp_f32 v60, v60
v_mfma_f32_16x16x32_bf16 v[40:43], a[72:75], a[24:27], v[40:43]
buffer_load_dwordx4 v1, s[4:7], s89 offen sc1 lds
ds_read_b128 a[96:99], v26 offset:16384
v_mfma_f32_16x16x32_bf16 v[40:43], a[76:79], a[28:31], v[40:43]
v_exp_f32 v61, v61
v_mfma_f32_16x16x32_bf16 v[44:47], a[92:95], a[28:31], v[100:103]
s_waitcnt lgkmcnt(1)
ds_read_b128 a[100:103], v26 offset:17408
v_cvt_pk_bf16_f32 v78, v60, v61
v_mfma_f32_16x16x32_bf16 v[44:47], a[88:91], a[24:27], v[44:47]
v_exp_f32 v62, v62
v_mfma_f32_16x16x32_bf16 v[44:47], a[84:87], a[20:23], v[44:47]
v_exp_f32 v63, v63
v_mfma_f32_16x16x32_bf16 v[44:47], a[80:83], a[16:19], v[44:47]
ds_read_b128 a[104:107], v26 offset:18432
v_cvt_pk_bf16_f32 v79, v62, v63
v_mfma_f32_16x16x32_bf16 v[48:51], a[64:67], a[32:35], v[104:107]
v_exp_f32 v40, v40
v_mfma_f32_16x16x32_bf16 v[48:51], a[68:71], a[36:39], v[48:51]
ds_read_b128 a[108:111], v26 offset:19456
v_mfma_f32_16x16x32_bf16 v[48:51], a[72:75], a[40:43], v[48:51]
v_exp_f32 v41, v41
v_mfma_f32_16x16x32_bf16 v[48:51], a[76:79], a[44:47], v[48:51]
v_cvt_pk_bf16_f32 v84, v40, v41
v_mfma_f32_16x16x32_bf16 v[52:55], a[92:95], a[44:47], v[104:107]
ds_read_b128 a[112:115], v26 offset:20480
v_mfma_f32_16x16x32_bf16 v[52:55], a[88:91], a[40:43], v[52:55]
v_exp_f32 v42, v42
v_mfma_f32_16x16x32_bf16 v[52:55], a[84:87], a[36:39], v[52:55]
buffer_load_dwordx4 v1, s[4:7], s89 offen offset:1024 sc1 lds
v_mfma_f32_16x16x32_bf16 v[52:55], a[80:83], a[32:35], v[52:55]
ds_read_b128 a[116:119], v26 offset:21504
v_mfma_f32_16x16x32_bf16 v[56:59], a[64:67], a[48:51], v[108:111]
v_exp_f32 v43, v43
v_mfma_f32_16x16x32_bf16 v[56:59], a[68:71], a[52:55], v[56:59]
v_cvt_pk_bf16_f32 v85, v42, v43
v_mfma_f32_16x16x32_bf16 v[56:59], a[72:75], a[56:59], v[56:59]
ds_read_b128 a[120:123], v26 offset:22528
v_mfma_f32_16x16x32_bf16 v[56:59], a[76:79], a[60:63], v[56:59]
v_exp_f32 v44, v44
v_mfma_f32_16x16x32_bf16 v[60:63], a[92:95], a[60:63], v[108:111]
v_exp_f32 v45, v45
v_mfma_f32_16x16x32_bf16 v[60:63], a[88:91], a[56:59], v[60:63]
ds_read_b128 a[124:127], v26 offset:23552
v_cvt_pk_bf16_f32 v86, v44, v45
v_mfma_f32_16x16x32_bf16 v[60:63], a[84:87], a[52:55], v[60:63]
v_exp_f32 v46, v46
v_mfma_f32_16x16x32_bf16 v[60:63], a[80:83], a[48:51], v[60:63]
s_waitcnt lgkmcnt(7)
ds_read_b128 a[64:67], v26
v_mfma_f32_16x16x32_bf16 v[128:131], a[96:99], v[64:67], v[128:131]
v_exp_f32 v47, v47
v_mfma_f32_16x16x32_bf16 v[160:163], a[96:99], v[68:71], v[160:163]
v_cvt_pk_bf16_f32 v87, v46, v47
v_mfma_f32_16x16x32_bf16 v[192:195], a[96:99], v[72:75], v[192:195]
v_exp_f32 v48, v48
v_mfma_f32_16x16x32_bf16 v[224:227], a[96:99], v[76:79], v[224:227]
s_waitcnt lgkmcnt(7)
buffer_load_dwordx4 v1, s[4:7], s89 offen offset:2048 sc1 lds
ds_read_b128 a[68:71], v26 offset:1024
v_mfma_f32_16x16x32_bf16 v[228:231], a[100:103], v[76:79], v[228:231]
v_exp_f32 v49, v49
v_mfma_f32_16x16x32_bf16 v[196:199], a[100:103], v[72:75], v[196:199]
v_cvt_pk_bf16_f32 v88, v48, v49
v_mfma_f32_16x16x32_bf16 v[164:167], a[100:103], v[68:71], v[164:167]
v_exp_f32 v50, v50
v_mfma_f32_16x16x32_bf16 v[132:135], a[100:103], v[64:67], v[132:135]
s_waitcnt lgkmcnt(7)
ds_read_b128 a[72:75], v26 offset:2048
v_mfma_f32_16x16x32_bf16 v[136:139], a[104:107], v[64:67], v[136:139]
v_exp_f32 v51, v51
v_mfma_f32_16x16x32_bf16 v[168:171], a[104:107], v[68:71], v[168:171]
v_cvt_pk_bf16_f32 v89, v50, v51
v_mfma_f32_16x16x32_bf16 v[200:203], a[104:107], v[72:75], v[200:203]
v_exp_f32 v52, v52
v_mfma_f32_16x16x32_bf16 v[232:235], a[104:107], v[76:79], v[232:235]
s_waitcnt lgkmcnt(7)
ds_read_b128 a[76:79], v26 offset:3072
v_mfma_f32_16x16x32_bf16 v[236:239], a[108:111], v[76:79], v[236:239]
v_exp_f32 v53, v53
v_mfma_f32_16x16x32_bf16 v[204:207], a[108:111], v[72:75], v[204:207]
v_cvt_pk_bf16_f32 v90, v52, v53
v_mfma_f32_16x16x32_bf16 v[172:175], a[108:111], v[68:71], v[172:175]
v_exp_f32 v54, v54
v_mfma_f32_16x16x32_bf16 v[140:143], a[108:111], v[64:67], v[140:143]
s_waitcnt lgkmcnt(7)
ds_read_b128 a[92:95], v26 offset:7168
v_mfma_f32_16x16x32_bf16 v[144:147], a[112:115], v[64:67], v[144:147]
s_lshl_b32 s76, s48, 13
s_add_u32 s76, s76, L_peel-L_pc
v_lshlrev_b32 v30, 7, v0
v_add_u32 v30, s76, v30
v_min_u32 v30, L_codeend-L_pc-4, v30
global_load_dword v24, v30, s[98:99]
v_mfma_f32_16x16x32_bf16 v[176:179], a[112:115], v[68:71], v[176:179]
buffer_load_dwordx4 v1, s[4:7], s89 offen offset:3072 sc1 lds
s_add_u32 s89, s89, 0x4000
v_mfma_f32_16x16x32_bf16 v[208:211], a[112:115], v[72:75], v[208:211]
v_exp_f32 v55, v55
v_mfma_f32_16x16x32_bf16 v[240:243], a[112:115], v[76:79], v[240:243]
s_waitcnt lgkmcnt(7)
ds_read_b128 a[88:91], v26 offset:6144
v_cvt_pk_bf16_f32 v91, v54, v55
v_mfma_f32_16x16x32_bf16 v[244:247], a[116:119], v[76:79], v[244:247]
v_add_u32 v30, L_table-L_pc, v1
global_load_dwordx4 v[4:7], v30, s[98:99]
v_mfma_f32_16x16x32_bf16 v[212:215], a[116:119], v[72:75], v[212:215]
v_exp_f32 v56, v56
v_mfma_f32_16x16x32_bf16 v[180:183], a[116:119], v[68:71], v[180:183]
v_exp_f32 v57, v57
v_mfma_f32_16x16x32_bf16 v[148:151], a[116:119], v[64:67], v[148:151]
s_waitcnt lgkmcnt(7)
ds_read_b128 a[84:87], v26 offset:5120
v_cvt_pk_bf16_f32 v92, v56, v57
v_mfma_f32_16x16x32_bf16 v[152:155], a[120:123], v[64:67], v[152:155]
v_exp_f32 v58, v58
v_mfma_f32_16x16x32_bf16 v[184:187], a[120:123], v[68:71], v[184:187]
v_add_u32 v30, L_table-L_pc, v1
global_load_dwordx4 v[8:11], v30, s[98:99] offset:1024
v_mfma_f32_16x16x32_bf16 v[216:219], a[120:123], v[72:75], v[216:219]
v_exp_f32 v59, v59
v_mfma_f32_16x16x32_bf16 v[248:251], a[120:123], v[76:79], v[248:251]
s_waitcnt lgkmcnt(7)
ds_read_b128 a[80:83], v26 offset:4096
v_cvt_pk_bf16_f32 v93, v58, v59
v_mfma_f32_16x16x32_bf16 v[252:255], a[124:127], v[76:79], v[252:255]
s_add_u32 m0, m0, 0x4000
v_exp_f32 v60, v60
v_mfma_f32_16x16x32_bf16 v[220:223], a[124:127], v[72:75], v[220:223]
buffer_load_dwordx4 v1, s[4:7], s90 offen sc1 lds
v_mfma_f32_16x16x32_bf16 v[188:191], a[124:127], v[68:71], v[188:191]
v_add_u32 v30, L_table-L_pc, v1
global_load_dwordx4 v[12:15], v30, s[98:99] offset:2048
v_mfma_f32_16x16x32_bf16 v[156:159], a[124:127], v[64:67], v[156:159]
v_exp_f32 v61, v61
v_mfma_f32_16x16x32_bf16 a[128:131], a[144:147], v[64:67], a[128:131]
v_cvt_pk_bf16_f32 v94, v60, v61
v_mfma_f32_16x16x32_bf16 a[132:135], a[144:147], v[68:71], a[132:135]
v_exp_f32 v62, v62
v_mfma_f32_16x16x32_bf16 a[136:139], a[144:147], v[72:75], a[136:139]
v_exp_f32 v63, v63
v_mfma_f32_16x16x32_bf16 a[140:143], a[144:147], v[76:79], a[140:143]
s_waitcnt lgkmcnt(4)
v_add_u32 v30, L_table-L_pc, v1
global_load_dword v16, v30, s[98:99] offset:3072
v_mfma_f32_16x16x32_bf16 v[40:43], a[64:67], a[16:19], v[100:103]
ds_read_b128 a[96:99], v26 offset:24576
v_cvt_pk_bf16_f32 v95, v62, v63
v_mfma_f32_16x16x32_bf16 v[40:43], a[68:71], a[20:23], v[40:43]
v_cmp_gt_i32_e64 s[80:81], 0, v28
v_cmp_gt_i32_e64 s[82:83], 1, v28
v_mfma_f32_16x16x32_bf16 v[40:43], a[72:75], a[24:27], v[40:43]
ds_read_b128 a[100:103], v26 offset:25600
v_mfma_f32_16x16x32_bf16 v[40:43], a[76:79], a[28:31], v[40:43]
s_waitcnt lgkmcnt(2)
v_mfma_f32_16x16x32_bf16 v[44:47], a[92:95], a[28:31], v[100:103]
v_mfma_f32_16x16x32_bf16 v[44:47], a[88:91], a[24:27], v[44:47]
buffer_load_dwordx4 v1, s[4:7], s90 offen offset:1024 sc1 lds
ds_read_b128 a[104:107], v26 offset:26624
v_mfma_f32_16x16x32_bf16 v[44:47], a[84:87], a[20:23], v[44:47]
v_mfma_f32_16x16x32_bf16 v[44:47], a[80:83], a[16:19], v[44:47]
v_mfma_f32_16x16x32_bf16 v[48:51], a[64:67], a[32:35], v[104:107]
v_accvgpr_read_b32 v32, a128
s_mov_b32 s76, 0x21800000
v_cmp_nle_f32_e64 s[94:95], s76, v32
s_mov_b32 s76, 0x5d800000
v_cmp_nge_f32 vcc, s76, v32
s_or_b64 vcc, vcc, s[94:95]
s_cbranch_scc1 L_slow0X
L_back_slow0X:
v_mfma_f32_16x16x32_bf16 v[48:51], a[68:71], a[36:39], v[48:51]
ds_read_b128 a[108:111], v26 offset:27648
v_accvgpr_read_b32 v32, a128
v_mfma_f32_16x16x32_bf16 v[48:51], a[72:75], a[40:43], v[48:51]
v_exp_f32 v40, v40
v_mfma_f32_16x16x32_bf16 v[48:51], a[76:79], a[44:47], v[48:51]
v_rcp_f32 v32, v32
s_nop 0
v_mfma_f32_16x16x32_bf16 v[52:55], a[92:95], a[44:47], v[104:107]
v_mul_f32 v128, v32, v128
v_mul_f32 v129, v32, v129
v_mfma_f32_16x16x32_bf16 v[52:55], a[88:91], a[40:43], v[52:55]
v_mul_f32 v130, v32, v130
v_mul_f32 v131, v32, v131
v_mfma_f32_16x16x32_bf16 v[52:55], a[84:87], a[36:39], v[52:55]
ds_read_b128 a[112:115], v26 offset:28672
v_mul_f32 v132, v32, v132
v_mfma_f32_16x16x32_bf16 v[52:55], a[80:83], a[32:35], v[52:55]
ds_read_b128 a[116:119], v26 offset:29696
v_mul_f32 v133, v32, v133
v_mfma_f32_16x16x32_bf16 v[56:59], a[64:67], a[48:51], v[108:111]
v_exp_f32 v41, v41
v_mfma_f32_16x16x32_bf16 v[56:59], a[68:71], a[52:55], v[56:59]
ds_read_b128 a[120:123], v26 offset:30720
v_mul_f32 v134, v32, v134
v_mfma_f32_16x16x32_bf16 v[56:59], a[72:75], a[56:59], v[56:59]
buffer_load_dwordx4 v1, s[4:7], s90 offen offset:2048 sc1 lds
v_mul_f32 v135, v32, v135
v_mfma_f32_16x16x32_bf16 v[56:59], a[76:79], a[60:63], v[56:59]
v_cvt_pk_bf16_f32 v68, v40, v41
v_mfma_f32_16x16x32_bf16 v[60:63], a[92:95], a[60:63], v[108:111]
ds_read_b128 a[124:127], v26 offset:31744
v_cvt_pk_bf16_f32 v128, v128, v129
v_mfma_f32_16x16x32_bf16 v[60:63], a[88:91], a[56:59], v[60:63]
v_cvt_pk_bf16_f32 v129, v130, v131
v_mfma_f32_16x16x32_bf16 v[60:63], a[84:87], a[52:55], v[60:63]
v_exp_f32 v42, v42
v_mfma_f32_16x16x32_bf16 v[60:63], a[80:83], a[48:51], v[60:63]
s_waitcnt lgkmcnt(6)
ds_read_b128 a[64:67], v26 offset:8192
v_cvt_pk_bf16_f32 v130, v132, v133
v_mfma_f32_16x16x32_bf16 v[160:163], a[96:99], v[84:87], v[160:163]
v_cvt_pk_bf16_f32 v131, v134, v135
v_mfma_f32_16x16x32_bf16 v[192:195], a[96:99], v[88:91], v[192:195]
v_exp_f32 v43, v43
v_mfma_f32_16x16x32_bf16 v[224:227], a[96:99], v[92:95], v[224:227]
buffer_store_dwordx4 v[128:131], v1, s[4:7], s55 offen sc1
ds_read_b128 a[68:71], v26 offset:9216
v_mfma_f32_16x16x32_bf16 v[228:231], a[100:103], v[92:95], v[228:231]
v_mul_f32 v136, v32, v136
v_cvt_pk_bf16_f32 v69, v42, v43
v_mfma_f32_16x16x32_bf16 v[196:199], a[100:103], v[88:91], v[196:199]
v_exp_f32 v44, v44
v_mfma_f32_16x16x32_bf16 v[164:167], a[100:103], v[84:87], v[164:167]
s_waitcnt lgkmcnt(6)
ds_read_b128 a[72:75], v26 offset:10240
v_mul_f32 v137, v32, v137
v_mfma_f32_16x16x32_bf16 v[168:171], a[104:107], v[84:87], v[168:171]
v_mul_f32 v138, v32, v138
v_mfma_f32_16x16x32_bf16 v[200:203], a[104:107], v[88:91], v[200:203]
buffer_load_dwordx4 v1, s[4:7], s90 offen offset:3072 sc1 lds
s_add_u32 s90, s90, 0x4000
v_mfma_f32_16x16x32_bf16 v[232:235], a[104:107], v[92:95], v[232:235]
ds_read_b128 a[76:79], v26 offset:11264
v_mul_f32 v139, v32, v139
v_mfma_f32_16x16x32_bf16 v[236:239], a[108:111], v[92:95], v[236:239]
v_mul_f32 v140, v32, v140
v_mfma_f32_16x16x32_bf16 v[204:207], a[108:111], v[88:91], v[204:207]
v_exp_f32 v45, v45
v_mfma_f32_16x16x32_bf16 v[172:175], a[108:111], v[84:87], v[172:175]
s_waitcnt lgkmcnt(7)
ds_read_b128 a[92:95], v26 offset:15360
v_mul_f32 v141, v32, v141
v_mfma_f32_16x16x32_bf16 v[176:179], a[112:115], v[84:87], v[176:179]
v_mul_f32 v142, v32, v142
v_cvt_pk_bf16_f32 v70, v44, v45
v_mfma_f32_16x16x32_bf16 v[208:211], a[112:115], v[88:91], v[208:211]
v_exp_f32 v46, v46
v_mfma_f32_16x16x32_bf16 v[240:243], a[112:115], v[92:95], v[240:243]
s_waitcnt lgkmcnt(6)
ds_read_b128 a[88:91], v26 offset:14336
v_mul_f32 v143, v32, v143
v_mfma_f32_16x16x32_bf16 v[244:247], a[116:119], v[92:95], v[244:247]
v_cvt_pk_bf16_f32 v136, v136, v137
v_mfma_f32_16x16x32_bf16 v[212:215], a[116:119], v[88:91], v[212:215]
v_exp_f32 v47, v47
v_mfma_f32_16x16x32_bf16 v[180:183], a[116:119], v[84:87], v[180:183]
ds_read_b128 a[84:87], v26 offset:13312
v_cvt_pk_bf16_f32 v137, v138, v139
v_mfma_f32_16x16x32_bf16 v[184:187], a[120:123], v[84:87], v[184:187]
v_cvt_pk_bf16_f32 v138, v140, v141
v_cvt_pk_bf16_f32 v71, v46, v47
v_mfma_f32_16x16x32_bf16 v[216:219], a[120:123], v[88:91], v[216:219]
s_waitcnt lgkmcnt(7)
v_exp_f32 v48, v48
v_mfma_f32_16x16x32_bf16 v[248:251], a[120:123], v[92:95], v[248:251]
s_add_u32 s91, s91, 0x8000
ds_read_b128 a[80:83], v26 offset:12288
v_cvt_pk_bf16_f32 v139, v142, v143
v_mfma_f32_16x16x32_bf16 v[252:255], a[124:127], v[92:95], v[252:255]
s_and_b32 s91, s91, 0x18000
buffer_store_dwordx4 v[136:139], v1, s[4:7], s55 offen offset:1024 sc1
v_mfma_f32_16x16x32_bf16 v[220:223], a[124:127], v[88:91], v[220:223]
v_exp_f32 v49, v49
v_mfma_f32_16x16x32_bf16 v[188:191], a[124:127], v[84:87], v[188:191]
v_mul_f32 v144, v32, v144
v_cvt_pk_bf16_f32 v72, v48, v49
v_mfma_f32_16x16x32_bf16 a[132:135], a[144:147], v[84:87], a[132:135]
s_nop 0
v_cndmask_b32_e64 v112, v100, v29, s[80:81]
v_cndmask_b32_e64 v113, v100, v29, s[82:83]
v_cmp_gt_i32_e64 s[80:81], 2, v28
v_cmp_gt_i32_e64 s[82:83], 3, v28
s_nop 0
v_cndmask_b32_e64 v114, v100, v29, s[80:81]
v_cndmask_b32_e64 v115, v100, v29, s[82:83]
v_cmp_gt_i32_e64 s[80:81], 16, v28
v_cmp_gt_i32_e64 s[82:83], 17, v28
s_nop 0
v_cndmask_b32_e64 v116, v100, v29, s[80:81]
v_cndmask_b32_e64 v117, v100, v29, s[82:83]
v_cmp_gt_i32_e64 s[80:81], 18, v28
v_cmp_gt_i32_e64 s[82:83], 19, v28
s_nop 0
v_cndmask_b32_e64 v118, v100, v29, s[80:81]
v_cndmask_b32_e64 v119, v100, v29, s[82:83]
s_waitcnt vmcnt(15)
s_barrier
v_mfma_f32_16x16x32_bf16 a[136:139], a[144:147], v[88:91], a[136:139]
s_waitcnt lgkmcnt(5)
v_add_u32 v26, s91, v2
v_mul_f32 v145, v32, v145
v_mfma_f32_16x16x32_bf16 a[140:143], a[144:147], v[92:95], a[140:143]
s_sub_u32 s72, s72, 1
s_cbranch_scc1 L_fv6
L_back_fv6:
v_mfma_f32_16x16x32_bf16 v[40:43], a[64:67], a[16:19], v[112:115]
s_xor_b32 s75, s91, 0x10000
v_mul_f32 v146, v32, v146
v_mul_f32 v147, v32, v147
v_mfma_f32_16x16x32_bf16 v[40:43], a[68:71], a[20:23], v[40:43]
s_add_u32 m0, s75, s59
v_exp_f32 v50, v50
v_mfma_f32_16x16x32_bf16 v[40:43], a[72:75], a[24:27], v[40:43]
s_waitcnt lgkmcnt(2)
v_exp_f32 v51, v51
v_mfma_f32_16x16x32_bf16 v[40:43], a[76:79], a[28:31], v[40:43]
v_mul_f32 v148, v32, v148
v_cvt_pk_bf16_f32 v73, v50, v51
v_mfma_f32_16x16x32_bf16 v[44:47], a[92:95], a[28:31], v[116:119]
buffer_load_dwordx4 v1, s[4:7], s89 offen sc1 lds
v_mul_f32 v149, v32, v149
v_mfma_f32_16x16x32_bf16 v[44:47], a[88:91], a[24:27], v[44:47]
s_waitcnt lgkmcnt(0)
v_exp_f32 v52, v52
v_mfma_f32_16x16x32_bf16 v[44:47], a[84:87], a[20:23], v[44:47]
v_exp_f32 v53, v53
v_mfma_f32_16x16x32_bf16 v[44:47], a[80:83], a[16:19], v[44:47]
v_mul_f32 v150, v32, v150
v_cvt_pk_bf16_f32 v74, v52, v53
v_mfma_f32_16x16x32_bf16 v[48:51], a[64:67], a[32:35], v[104:107]
v_exp_f32 v54, v54
v_mfma_f32_16x16x32_bf16 v[48:51], a[68:71], a[36:39], v[48:51]
v_exp_f32 v55, v55
v_mfma_f32_16x16x32_bf16 v[48:51], a[72:75], a[40:43], v[48:51]
v_mul_f32 v151, v32, v151
v_cvt_pk_bf16_f32 v75, v54, v55
v_mfma_f32_16x16x32_bf16 v[48:51], a[76:79], a[44:47], v[48:51]
v_cvt_pk_bf16_f32 v144, v144, v145
v_cvt_pk_bf16_f32 v145, v146, v147
v_mfma_f32_16x16x32_bf16 v[52:55], a[92:95], a[44:47], v[104:107]
v_exp_f32 v56, v56
v_mfma_f32_16x16x32_bf16 v[52:55], a[88:91], a[40:43], v[52:55]
v_exp_f32 v57, v57
v_mfma_f32_16x16x32_bf16 v[52:55], a[84:87], a[36:39], v[52:55]
v_cvt_pk_bf16_f32 v76, v56, v57
v_exp_f32 v58, v58
v_exp_f32 v59, v59
v_mfma_f32_16x16x32_bf16 v[52:55], a[80:83], a[32:35], v[52:55]
v_cvt_pk_bf16_f32 v77, v58, v59
v_cvt_pk_bf16_f32 v146, v148, v149
v_mfma_f32_16x16x32_bf16 v[56:59], a[64:67], a[48:51], v[108:111]
ds_read_b128 a[96:99], v26 offset:16384
v_cvt_pk_bf16_f32 v147, v150, v151
v_mfma_f32_16x16x32_bf16 v[56:59], a[68:71], a[52:55], v[56:59]
buffer_load_dwordx4 v1, s[4:7], s89 offen offset:1024 sc1 lds
v_exp_f32 v60, v60
v_exp_f32 v61, v61
v_mfma_f32_16x16x32_bf16 v[56:59], a[72:75], a[56:59], v[56:59]
buffer_store_dwordx4 v[144:147], v1, s[4:7], s55 offen offset:2048 sc1
v_cvt_pk_bf16_f32 v78, v60, v61
v_exp_f32 v62, v62
v_exp_f32 v63, v63
v_mfma_f32_16x16x32_bf16 v[56:59], a[76:79], a[60:63], v[56:59]
v_cvt_pk_bf16_f32 v79, v62, v63
v_mul_f32 v152, v32, v152
v_mfma_f32_16x16x32_bf16 v[60:63], a[92:95], a[60:63], v[108:111]
ds_read_b128 a[100:103], v26 offset:17408
v_mul_f32 v153, v32, v153
v_mfma_f32_16x16x32_bf16 v[60:63], a[88:91], a[56:59], v[60:63]
ds_read_b128 a[104:107], v26 offset:18432
v_mul_f32 v154, v32, v154
v_mfma_f32_16x16x32_bf16 v[60:63], a[84:87], a[52:55], v[60:63]
v_mul_f32 v155, v32, v155
v_mul_f32 v156, v32, v156
v_mfma_f32_16x16x32_bf16 v[60:63], a[80:83], a[48:51], v[60:63]
s_waitcnt lgkmcnt(2)
ds_read_b128 a[108:111], v26 offset:19456
v_mul_f32 v157, v32, v157
v_mfma_f32_16x16x32_bf16 v[160:163], a[96:99], v[68:71], v[160:163]
buffer_load_dwordx4 v1, s[4:7], s89 offen offset:2048 sc1 lds
v_mul_f32 v158, v32, v158
v_mfma_f32_16x16x32_bf16 v[192:195], a[96:99], v[72:75], v[192:195]
ds_read_b128 a[112:115], v26 offset:20480
v_mul_f32 v159, v32, v159
v_mfma_f32_16x16x32_bf16 v[224:227], a[96:99], v[76:79], v[224:227]
s_waitcnt lgkmcnt(3)
ds_read_b128 a[116:119], v26 offset:21504
v_mov_b32 v120, v104
v_mfma_f32_16x16x32_bf16 v[228:231], a[100:103], v[76:79], v[228:231]
ds_read_b128 a[120:123], v26 offset:22528
v_cvt_pk_bf16_f32 v152, v152, v153
v_mfma_f32_16x16x32_bf16 v[196:199], a[100:103], v[72:75], v[196:199]
ds_read_b128 a[124:127], v26 offset:23552
v_cvt_pk_bf16_f32 v153, v154, v155
v_mfma_f32_16x16x32_bf16 v[164:167], a[100:103], v[68:71], v[164:167]
s_waitcnt lgkmcnt(5)
v_mov_b32 v121, v104
v_mov_b32 v122, v104
v_mfma_f32_16x16x32_bf16 v[168:171], a[104:107], v[68:71], v[168:171]
v_cvt_pk_bf16_f32 v154, v156, v157
v_mov_b32 v123, v104
v_mfma_f32_16x16x32_bf16 v[200:203], a[104:107], v[72:75], v[200:203]
v_cvt_pk_bf16_f32 v155, v158, v159
v_mov_b32 v124, v104
v_mfma_f32_16x16x32_bf16 v[232:235], a[104:107], v[76:79], v[232:235]
s_waitcnt lgkmcnt(4)
v_mov_b32 v125, v104
v_mov_b32 v126, v104
v_mfma_f32_16x16x32_bf16 v[236:239], a[108:111], v[76:79], v[236:239]
buffer_store_dwordx4 v[152:155], v1, s[4:7], s55 offen offset:3072 sc1
buffer_load_dwordx4 v1, s[4:7], s89 offen offset:3072 sc1 lds
s_add_u32 s89, s89, 0x4000
v_mfma_f32_16x16x32_bf16 v[204:207], a[108:111], v[72:75], v[204:207]
ds_read_b128 a[64:67], v26
v_mov_b32 v127, v104
v_mfma_f32_16x16x32_bf16 v[172:175], a[108:111], v[68:71], v[172:175]
s_waitcnt lgkmcnt(3)
v_exp_f32 v40, v40
v_mfma_f32_16x16x32_bf16 v[176:179], a[112:115], v[68:71], v[176:179]
v_exp_f32 v41, v41
v_mfma_f32_16x16x32_bf16 v[208:211], a[112:115], v[72:75], v[208:211]
s_cmp_eq_u32 s88, 0
s_cbranch_scc1 L_setcb0
L_back_setcb0:
v_mfma_f32_16x16x32_bf16 v[240:243], a[112:115], v[76:79], v[240:243]
ds_read_b128 a[68:71], v26 offset:1024
v_cvt_pk_bf16_f32 v84, v40, v41
v_mfma_f32_16x16x32_bf16 v[244:247], a[116:119], v[76:79], v[244:247]
v_exp_f32 v42, v42
v_mfma_f32_16x16x32_bf16 v[212:215], a[116:119], v[72:75], v[212:215]
v_exp_f32 v43, v43
v_mfma_f32_16x16x32_bf16 v[180:183], a[116:119], v[68:71], v[180:183]
s_waitcnt lgkmcnt(2)
ds_read_b128 a[72:75], v26 offset:2048
v_cvt_pk_bf16_f32 v85, v42, v43
v_mfma_f32_16x16x32_bf16 v[184:187], a[120:123], v[68:71], v[184:187]
v_exp_f32 v44, v44
v_mfma_f32_16x16x32_bf16 v[216:219], a[120:123], v[72:75], v[216:219]
s_add_u32 m0, m0, 0x4000
v_exp_f32 v45, v45
v_mfma_f32_16x16x32_bf16 v[248:251], a[120:123], v[76:79], v[248:251]
ds_read_b128 a[76:79], v26 offset:3072
v_cvt_pk_bf16_f32 v86, v44, v45
v_mfma_f32_16x16x32_bf16 v[252:255], a[124:127], v[76:79], v[252:255]
v_exp_f32 v46, v46
v_mfma_f32_16x16x32_bf16 v[220:223], a[124:127], v[72:75], v[220:223]
v_exp_f32 v47, v47
v_mfma_f32_16x16x32_bf16 v[188:191], a[124:127], v[68:71], v[188:191]
ds_read_b128 a[92:95], v26 offset:7168
v_cvt_pk_bf16_f32 v87, v46, v47
v_mfma_f32_16x16x32_bf16 a[132:135], a[144:147], v[68:71], a[132:135]
v_exp_f32 v48, v48
v_exp_f32 v49, v49
v_mfma_f32_16x16x32_bf16 a[136:139], a[144:147], v[72:75], a[136:139]
ds_read_b128 a[88:91], v26 offset:6144
buffer_load_dwordx4 v1, s[4:7], s90 offen sc1 lds
v_cvt_pk_bf16_f32 v88, v48, v49
v_exp_f32 v50, v50
v_exp_f32 v51, v51
v_mfma_f32_16x16x32_bf16 a[140:143], a[144:147], v[76:79], a[140:143]
s_waitcnt lgkmcnt(3)
ds_read_b128 a[84:87], v26 offset:5120
v_cvt_pk_bf16_f32 v89, v50, v51
v_mfma_f32_16x16x32_bf16 v[48:51], a[64:67], a[32:35], v[120:123]
ds_read_b128 a[80:83], v26 offset:4096
v_mfma_f32_16x16x32_bf16 v[48:51], a[68:71], a[36:39], v[48:51]
v_exp_f32 v52, v52
v_exp_f32 v53, v53
v_mfma_f32_16x16x32_bf16 v[48:51], a[72:75], a[40:43], v[48:51]
s_waitcnt lgkmcnt(4)
v_cvt_pk_bf16_f32 v90, v52, v53
v_exp_f32 v54, v54
v_exp_f32 v55, v55
v_mfma_f32_16x16x32_bf16 v[48:51], a[76:79], a[44:47], v[48:51]
s_waitcnt lgkmcnt(3)
ds_read_b128 a[96:99], v26 offset:24576
v_cvt_pk_bf16_f32 v91, v54, v55
v_mfma_f32_16x16x32_bf16 v[52:55], a[92:95], a[44:47], v[124:127]
s_waitcnt lgkmcnt(3)
v_exp_f32 v56, v56
v_mfma_f32_16x16x32_bf16 v[52:55], a[88:91], a[40:43], v[52:55]
s_waitcnt lgkmcnt(2)
v_exp_f32 v57, v57
v_mfma_f32_16x16x32_bf16 v[52:55], a[84:87], a[36:39], v[52:55]
s_waitcnt lgkmcnt(1)
v_cvt_pk_bf16_f32 v92, v56, v57
v_exp_f32 v58, v58
v_exp_f32 v59, v59
v_mfma_f32_16x16x32_bf16 v[52:55], a[80:83], a[32:35], v[52:55]
buffer_load_dwordx4 v1, s[4:7], s90 offen offset:1024 sc1 lds
v_cvt_pk_bf16_f32 v93, v58, v59
v_mfma_f32_16x16x32_bf16 v[56:59], a[64:67], a[48:51], v[108:111]
v_exp_f32 v60, v60
v_mfma_f32_16x16x32_bf16 v[56:59], a[68:71], a[52:55], v[56:59]
v_exp_f32 v61, v61
v_mfma_f32_16x16x32_bf16 v[56:59], a[72:75], a[56:59], v[56:59]
v_cvt_pk_bf16_f32 v94, v60, v61
v_exp_f32 v62, v62
v_exp_f32 v63, v63
v_mfma_f32_16x16x32_bf16 v[56:59], a[76:79], a[60:63], v[56:59]
ds_read_b128 a[100:103], v26 offset:25600
v_cvt_pk_bf16_f32 v95, v62, v63
v_mfma_f32_16x16x32_bf16 v[60:63], a[92:95], a[60:63], v[108:111]
ds_read_b128 a[104:107], v26 offset:26624
v_mfma_f32_16x16x32_bf16 v[60:63], a[88:91], a[56:59], v[60:63]
ds_read_b128 a[108:111], v26 offset:27648
v_mfma_f32_16x16x32_bf16 v[60:63], a[84:87], a[52:55], v[60:63]
buffer_load_dwordx4 v1, s[4:7], s90 offen offset:2048 sc1 lds
ds_read_b128 a[112:115], v26 offset:28672
v_mfma_f32_16x16x32_bf16 v[60:63], a[80:83], a[48:51], v[60:63]
s_waitcnt lgkmcnt(4)
ds_read_b128 a[116:119], v26 offset:29696
v_mfma_f32_16x16x32_bf16 v[160:163], a[96:99], v[84:87], v[160:163]
ds_read_b128 a[120:123], v26 offset:30720
v_mfma_f32_16x16x32_bf16 v[192:195], a[96:99], v[88:91], v[192:195]
ds_read_b128 a[124:127], v26 offset:31744
v_mfma_f32_16x16x32_bf16 v[224:227], a[96:99], v[92:95], v[224:227]
s_waitcnt lgkmcnt(6)
v_exp_f32 v48, v48
v_mfma_f32_16x16x32_bf16 v[228:231], a[100:103], v[92:95], v[228:231]
v_exp_f32 v49, v49
v_mfma_f32_16x16x32_bf16 v[196:199], a[100:103], v[88:91], v[196:199]
ds_read_b128 a[64:67], v26 offset:8192
v_cvt_pk_bf16_f32 v72, v48, v49
v_mfma_f32_16x16x32_bf16 v[164:167], a[100:103], v[84:87], v[164:167]
s_waitcnt lgkmcnt(5)
v_exp_f32 v50, v50
v_mfma_f32_16x16x32_bf16 v[168:171], a[104:107], v[84:87], v[168:171]
v_exp_f32 v51, v51
v_mfma_f32_16x16x32_bf16 v[200:203], a[104:107], v[88:91], v[200:203]
ds_read_b128 a[68:71], v26 offset:9216
v_cvt_pk_bf16_f32 v73, v50, v51
v_mfma_f32_16x16x32_bf16 v[232:235], a[104:107], v[92:95], v[232:235]
v_exp_f32 v52, v52
v_mfma_f32_16x16x32_bf16 v[236:239], a[108:111], v[92:95], v[236:239]
buffer_load_dwordx4 v1, s[4:7], s90 offen offset:3072 sc1 lds
s_add_u32 s90, s90, 0x4000
ds_read_b128 a[72:75], v26 offset:10240
v_mfma_f32_16x16x32_bf16 v[204:207], a[108:111], v[88:91], v[204:207]
v_exp_f32 v53, v53
v_mfma_f32_16x16x32_bf16 v[172:175], a[108:111], v[84:87], v[172:175]
s_waitcnt lgkmcnt(5)
ds_read_b128 a[76:79], v26 offset:11264
v_cvt_pk_bf16_f32 v74, v52, v53
v_mfma_f32_16x16x32_bf16 v[176:179], a[112:115], v[84:87], v[176:179]
v_exp_f32 v54, v54
v_mfma_f32_16x16x32_bf16 v[208:211], a[112:115], v[88:91], v[208:211]
v_exp_f32 v55, v55
v_mfma_f32_16x16x32_bf16 v[240:243], a[112:115], v[92:95], v[240:243]
ds_read_b128 a[92:95], v26 offset:15360
v_cvt_pk_bf16_f32 v75, v54, v55
v_mfma_f32_16x16x32_bf16 v[244:247], a[116:119], v[92:95], v[244:247]
ds_read_b128 a[88:91], v26 offset:14336
v_mfma_f32_16x16x32_bf16 v[212:215], a[116:119], v[88:91], v[212:215]
v_exp_f32 v56, v56
v_mfma_f32_16x16x32_bf16 v[180:183], a[116:119], v[84:87], v[180:183]
s_waitcnt lgkmcnt(6)
ds_read_b128 a[84:87], v26 offset:13312
v_mfma_f32_16x16x32_bf16 v[184:187], a[120:123], v[84:87], v[184:187]
v_exp_f32 v57, v57
v_mfma_f32_16x16x32_bf16 v[216:219], a[120:123], v[88:91], v[216:219]
v_cvt_pk_bf16_f32 v76, v56, v57
v_mfma_f32_16x16x32_bf16 v[248:251], a[120:123], v[92:95], v[248:251]
s_add_u32 s91, s91, 0x8000
ds_read_b128 a[80:83], v26 offset:12288
v_mfma_f32_16x16x32_bf16 v[252:255], a[124:127], v[92:95], v[252:255]
s_and_b32 s91, s91, 0x18000
v_exp_f32 v58, v58
v_mfma_f32_16x16x32_bf16 v[220:223], a[124:127], v[88:91], v[220:223]
v_exp_f32 v59, v59
v_mfma_f32_16x16x32_bf16 v[188:191], a[124:127], v[84:87], v[188:191]
v_cmp_gt_i32_e64 s[80:81], 0, v28
v_cmp_gt_i32_e64 s[82:83], 1, v28
v_mfma_f32_16x16x32_bf16 a[132:135], a[144:147], v[84:87], a[132:135]
s_waitcnt vmcnt(11)
s_barrier
v_mfma_f32_16x16x32_bf16 a[136:139], a[144:147], v[88:91], a[136:139]
v_cvt_pk_bf16_f32 v77, v58, v59
v_add_u32 v26, s91, v2
v_mfma_f32_16x16x32_bf16 a[140:143], a[144:147], v[92:95], a[140:143]
s_nop 0
v_cndmask_b32_e64 v112, v108, v29, s[80:81]
v_cndmask_b32_e64 v113, v108, v29, s[82:83]
v_cmp_gt_i32_e64 s[80:81], 2, v28
v_cmp_gt_i32_e64 s[82:83], 3, v28
s_nop 0
v_cndmask_b32_e64 v114, v108, v29, s[80:81]
v_cndmask_b32_e64 v115, v108, v29, s[82:83]
v_cmp_gt_i32_e64 s[80:81], 16, v28
v_cmp_gt_i32_e64 s[82:83], 17, v28
s_nop 0
v_cndmask_b32_e64 v116, v108, v29, s[80:81]
v_cndmask_b32_e64 v117, v108, v29, s[82:83]
v_cmp_gt_i32_e64 s[80:81], 18, v28
v_cmp_gt_i32_e64 s[82:83], 19, v28
s_nop 0
v_cndmask_b32_e64 v118, v108, v29, s[80:81]
v_cndmask_b32_e64 v119, v108, v29, s[82:83]
s_nop 7
v_accvgpr_read_b32 v40, a132
s_mov_b32 s76, 0x21800000
v_cmp_nle_f32_e64 s[94:95], s76, v40
s_mov_b32 s76, 0x5d800000
v_cmp_nge_f32 vcc, s76, v40
s_or_b64 vcc, vcc, s[94:95]
s_cbranch_scc1 L_slow1X
L_back_slow1X:
v_accvgpr_read_b32 v40, a132
v_rcp_f32 v40, v40
s_nop 0
v_pk_mul_f32 v[160:161], v[160:161], v[40:41] op_sel_hi:[1,0]
v_pk_mul_f32 v[162:163], v[162:163], v[40:41] op_sel_hi:[1,0]
v_pk_mul_f32 v[164:165], v[164:165], v[40:41] op_sel_hi:[1,0]
v_pk_mul_f32 v[166:167], v[166:167], v[40:41] op_sel_hi:[1,0]
v_cvt_pk_bf16_f32 v160, v160, v161
v_cvt_pk_bf16_f32 v161, v162, v163
v_cvt_pk_bf16_f32 v162, v164, v165
v_cvt_pk_bf16_f32 v163, v166, v167
buffer_store_dwordx4 v[160:163], v1, s[4:7], s56 offen sc1
v_pk_mul_f32 v[168:169], v[168:169], v[40:41] op_sel_hi:[1,0]
v_pk_mul_f32 v[170:171], v[170:171], v[40:41] op_sel_hi:[1,0]
v_pk_mul_f32 v[172:173], v[172:173], v[40:41] op_sel_hi:[1,0]
v_pk_mul_f32 v[174:175], v[174:175], v[40:41] op_sel_hi:[1,0]
v_cvt_pk_bf16_f32 v168, v168, v169
v_cvt_pk_bf16_f32 v169, v170, v171
v_cvt_pk_bf16_f32 v170, v172, v173
v_cvt_pk_bf16_f32 v171, v174, v175
buffer_store_dwordx4 v[168:171], v1, s[4:7], s56 offen offset:1024 sc1
v_pk_mul_f32 v[176:177], v[176:177], v[40:41] op_sel_hi:[1,0]
v_pk_mul_f32 v[178:179], v[178:179], v[40:41] op_sel_hi:[1,0]
v_pk_mul_f32 v[180:181], v[180:181], v[40:41] op_sel_hi:[1,0]
v_pk_mul_f32 v[182:183], v[182:183], v[40:41] op_sel_hi:[1,0]
v_cvt_pk_bf16_f32 v176, v176, v177
v_cvt_pk_bf16_f32 v177, v178, v179
v_cvt_pk_bf16_f32 v178, v180, v181
v_cvt_pk_bf16_f32 v179, v182, v183
buffer_store_dwordx4 v[176:179], v1, s[4:7], s56 offen offset:2048 sc1
v_pk_mul_f32 v[184:185], v[184:185], v[40:41] op_sel_hi:[1,0]
v_pk_mul_f32 v[186:187], v[186:187], v[40:41] op_sel_hi:[1,0]
v_pk_mul_f32 v[188:189], v[188:189], v[40:41] op_sel_hi:[1,0]
v_pk_mul_f32 v[190:191], v[190:191], v[40:41] op_sel_hi:[1,0]
v_cvt_pk_bf16_f32 v184, v184, v185
v_cvt_pk_bf16_f32 v185, v186, v187
v_cvt_pk_bf16_f32 v186, v188, v189
v_cvt_pk_bf16_f32 v187, v190, v191
buffer_store_dwordx4 v[184:187], v1, s[4:7], s56 offen offset:3072 sc1
s_branch L_single_entry
L_spin_fb:
s_mov_b32 s93, 0x8000
L_spinloop_fb:
buffer_load_dword v28, v21, s[4:7], s74 offen sc1
s_waitcnt vmcnt(0)
v_cmp_ne_u32 vcc, v28, v18
s_nop 1
s_cbranch_vccz L_back_fb
s_sub_u32 s93, s93, 1
s_cmp_lg_u32 s93, 0
s_cbranch_scc1 L_spinloop_fb
v_mov_b32 v19, 5
buffer_store_dword v19, v20, s[44:47], 0 offen offset:4
s_branch L_back_fb
L_spin_kv:
s_mov_b32 s93, 0x8000
L_spinloop_kv:
buffer_load_dword v19, v3, s[4:7], s78 offen sc1
s_waitcnt vmcnt(0)
v_cmp_ne_u32 vcc, v19, v18
s_nop 1
s_cbranch_vccz L_back_kv
s_sub_u32 s93, s93, 1
s_cmp_lg_u32 s93, 0
s_cbranch_scc1 L_spinloop_kv
v_mov_b32 v19, 2
buffer_store_dword v19, v20, s[44:47], 0 offen offset:4
s_branch L_back_kv
L_setca0:
s_nop 7
v_cmp_gt_i32_e64 s[80:81], 0, v27
v_cmp_gt_i32_e64 s[82:83], 1, v27
s_nop 0
v_cndmask_b32_e64 v112, v96, v29, s[80:81]
v_cndmask_b32_e64 v113, v96, v29, s[82:83]
v_cmp_gt_i32_e64 s[80:81], 2, v27
v_cmp_gt_i32_e64 s[82:83], 3, v27
s_nop 0
v_cndmask_b32_e64 v114, v96, v29, s[80:81]
v_cndmask_b32_e64 v115, v96, v29, s[82:83]
v_cmp_gt_i32_e64 s[80:81], 16, v27
v_cmp_gt_i32_e64 s[82:83], 17, v27
s_nop 0
v_cndmask_b32_e64 v116, v96, v29, s[80:81]
v_cndmask_b32_e64 v117, v96, v29, s[82:83]
v_cmp_gt_i32_e64 s[80:81], 18, v27
v_cmp_gt_i32_e64 s[82:83], 19, v27
s_nop 0
v_cndmask_b32_e64 v118, v96, v29, s[80:81]
v_cndmask_b32_e64 v119, v96, v29, s[82:83]
s_nop 1
s_branch L_back_setca0
L_fv1:
s_lshl_b32 s77, s49, 7
s_add_u32 s77, s77, 83922944
v_max_u32 v3, 32, v21
s_cmp_eq_u32 s85, 1
s_cbranch_scc1 L_fv1_chk
s_mov_b32 s85, 1
s_mov_b32 s72, 1
buffer_load_dword v19, v3, s[4:7], s77 offen sc1
v_lshlrev_b32 v22, 7, v0
s_sub_u32 s77, s92, 0x100
s_cmp_ge_u32 s77, 0x240
s_cbranch_scc1 L_tch21
s_add_u32 s77, s77, 0
s_lshl_b32 s77, s77, 13
buffer_load_dword v23, v22, s[32:35], s77 offen
L_tch21:
s_sub_u32 s77, s92, 0x3af
s_cmp_ge_u32 s77, 0x51
s_cbranch_scc1 L_tch22
s_add_u32 s77, s77, 0
s_lshl_b32 s77, s77, 13
buffer_load_dword v23, v22, s[36:39], s77 offen
L_tch22:
s_branch L_back_fv1
L_fv1_chk:
s_mov_b32 s72, 0x7fffffff
s_waitcnt vmcnt(16)
v_cmp_ne_u32 vcc, v19, v18
s_nop 1
s_cbranch_vccnz L_spin_fv1
s_branch L_back_fv1
L_fv2:
s_lshl_b32 s77, s49, 7
s_add_u32 s77, s77, 83922944
v_max_u32 v3, 32, v21
s_cmp_eq_u32 s85, 1
s_cbranch_scc1 L_fv2_chk
s_mov_b32 s85, 1
s_mov_b32 s72, 1
buffer_load_dword v19, v3, s[4:7], s77 offen sc1
v_lshlrev_b32 v22, 7, v0
s_sub_u32 s77, s92, 0x100
s_cmp_ge_u32 s77, 0x240
s_cbranch_scc1 L_tch23
s_add_u32 s77, s77, 0
s_lshl_b32 s77, s77, 13
buffer_load_dword v23, v22, s[32:35], s77 offen
L_tch23:
s_sub_u32 s77, s92, 0x3af
s_cmp_ge_u32 s77, 0x51
s_cbranch_scc1 L_tch24
s_add_u32 s77, s77, 0
s_lshl_b32 s77, s77, 13
buffer_load_dword v23, v22, s[36:39], s77 offen
L_tch24:
s_branch L_back_fv2
L_fv2_chk:
s_mov_b32 s72, 0x7fffffff
s_waitcnt vmcnt(16)
v_cmp_ne_u32 vcc, v19, v18
s_nop 1
s_cbranch_vccnz L_spin_fv2
s_branch L_back_fv2
L_setca2:
s_nop 7
v_cmp_gt_i32_e64 s[80:81], 0, v27
v_cmp_gt_i32_e64 s[82:83], 1, v27
s_nop 0
v_cndmask_b32_e64 v112, v96, v29, s[80:81]
v_cndmask_b32_e64 v113, v96, v29, s[82:83]
v_cmp_gt_i32_e64 s[80:81], 2, v27
v_cmp_gt_i32_e64 s[82:83], 3, v27
s_nop 0
v_cndmask_b32_e64 v114, v96, v29, s[80:81]
v_cndmask_b32_e64 v115, v96, v29, s[82:83]
v_cmp_gt_i32_e64 s[80:81], 16, v27
v_cmp_gt_i32_e64 s[82:83], 17, v27
s_nop 0
v_cndmask_b32_e64 v116, v96, v29, s[80:81]
v_cndmask_b32_e64 v117, v96, v29, s[82:83]
v_cmp_gt_i32_e64 s[80:81], 18, v27
v_cmp_gt_i32_e64 s[82:83], 19, v27
s_nop 0
v_cndmask_b32_e64 v118, v96, v29, s[80:81]
v_cndmask_b32_e64 v119, v96, v29, s[82:83]
s_nop 1
s_branch L_back_setca2
L_fv3:
s_lshl_b32 s77, s49, 7
s_add_u32 s77, s77, 83922944
v_max_u32 v3, 32, v21
s_cmp_eq_u32 s85, 1
s_cbranch_scc1 L_fv3_chk
s_mov_b32 s85, 1
s_mov_b32 s72, 1
buffer_load_dword v19, v3, s[4:7], s77 offen sc1
v_lshlrev_b32 v22, 7, v0
s_sub_u32 s77, s92, 0x100
s_cmp_ge_u32 s77, 0x240
s_cbranch_scc1 L_tch25
s_add_u32 s77, s77, 0
s_lshl_b32 s77, s77, 13
buffer_load_dword v23, v22, s[32:35], s77 offen
L_tch25:
s_sub_u32 s77, s92, 0x3af
s_cmp_ge_u32 s77, 0x51
s_cbranch_scc1 L_tch26
s_add_u32 s77, s77, 0
s_lshl_b32 s77, s77, 13
buffer_load_dword v23, v22, s[36:39], s77 offen
L_tch26:
s_branch L_back_fv3
L_fv3_chk:
s_mov_b32 s72, 0x7fffffff
s_waitcnt vmcnt(16)
v_cmp_ne_u32 vcc, v19, v18
s_nop 1
s_cbranch_vccnz L_spin_fv3
s_branch L_back_fv3
L_fv4:
s_lshl_b32 s77, s49, 7
s_add_u32 s77, s77, 83922944
v_max_u32 v3, 32, v21
s_cmp_eq_u32 s85, 1
s_cbranch_scc1 L_fv4_chk
s_mov_b32 s85, 1
s_mov_b32 s72, 1
buffer_load_dword v19, v3, s[4:7], s77 offen sc1
v_lshlrev_b32 v22, 7, v0
s_sub_u32 s77, s92, 0x100
s_cmp_ge_u32 s77, 0x240
s_cbranch_scc1 L_tch27
s_add_u32 s77, s77, 0
s_lshl_b32 s77, s77, 13
buffer_load_dword v23, v22, s[32:35], s77 offen
L_tch27:
s_sub_u32 s77, s92, 0x3af
s_cmp_ge_u32 s77, 0x51
s_cbranch_scc1 L_tch28
s_add_u32 s77, s77, 0
s_lshl_b32 s77, s77, 13
buffer_load_dword v23, v22, s[36:39], s77 offen
L_tch28:
s_branch L_back_fv4
L_fv4_chk:
s_mov_b32 s72, 0x7fffffff
s_waitcnt vmcnt(16)
v_cmp_ne_u32 vcc, v19, v18
s_nop 1
s_cbranch_vccnz L_spin_fv4
s_branch L_back_fv4
L_setca1:
s_nop 7
v_cmp_gt_i32_e64 s[80:81], 0, v27
v_cmp_gt_i32_e64 s[82:83], 1, v27
s_nop 0
v_cndmask_b32_e64 v112, v96, v29, s[80:81]
v_cndmask_b32_e64 v113, v96, v29, s[82:83]
v_cmp_gt_i32_e64 s[80:81], 2, v27
v_cmp_gt_i32_e64 s[82:83], 3, v27
s_nop 0
v_cndmask_b32_e64 v114, v96, v29, s[80:81]
v_cndmask_b32_e64 v115, v96, v29, s[82:83]
v_cmp_gt_i32_e64 s[80:81], 16, v27
v_cmp_gt_i32_e64 s[82:83], 17, v27
s_nop 0
v_cndmask_b32_e64 v116, v96, v29, s[80:81]
v_cndmask_b32_e64 v117, v96, v29, s[82:83]
v_cmp_gt_i32_e64 s[80:81], 18, v27
v_cmp_gt_i32_e64 s[82:83], 19, v27
s_nop 0
v_cndmask_b32_e64 v118, v96, v29, s[80:81]
v_cndmask_b32_e64 v119, v96, v29, s[82:83]
s_nop 1
s_branch L_back_setca1
L_fv5:
s_lshl_b32 s77, s49, 7
s_add_u32 s77, s77, 83922944
v_max_u32 v3, 32, v21
s_cmp_eq_u32 s85, 1
s_cbranch_scc1 L_fv5_chk
s_mov_b32 s85, 1
s_mov_b32 s72, 1
buffer_load_dword v19, v3, s[4:7], s77 offen sc1
v_lshlrev_b32 v22, 7, v0
s_sub_u32 s77, s92, 0x100
s_cmp_ge_u32 s77, 0x240
s_cbranch_scc1 L_tch29
s_add_u32 s77, s77, 0
s_lshl_b32 s77, s77, 13
buffer_load_dword v23, v22, s[32:35], s77 offen
L_tch29:
s_sub_u32 s77, s92, 0x3af
s_cmp_ge_u32 s77, 0x51
s_cbranch_scc1 L_tch30
s_add_u32 s77, s77, 0
s_lshl_b32 s77, s77, 13
buffer_load_dword v23, v22, s[36:39], s77 offen
L_tch30:
s_branch L_back_fv5
L_fv5_chk:
s_mov_b32 s72, 0x7fffffff
s_waitcnt vmcnt(16)
v_cmp_ne_u32 vcc, v19, v18
s_nop 1
s_cbranch_vccnz L_spin_fv5
s_branch L_back_fv5
L_fv6:
s_lshl_b32 s77, s49, 7
s_add_u32 s77, s77, 83922944
v_max_u32 v3, 32, v21
s_cmp_eq_u32 s85, 1
s_cbranch_scc1 L_fv6_chk
s_mov_b32 s85, 1
s_mov_b32 s72, 1
buffer_load_dword v19, v3, s[4:7], s77 offen sc1
v_lshlrev_b32 v22, 7, v0
s_sub_u32 s77, s92, 0x100
s_cmp_ge_u32 s77, 0x240
s_cbranch_scc1 L_tch31
s_add_u32 s77, s77, 0
s_lshl_b32 s77, s77, 13
buffer_load_dword v23, v22, s[32:35], s77 offen
L_tch31:
s_sub_u32 s77, s92, 0x3af
s_cmp_ge_u32 s77, 0x51
s_cbranch_scc1 L_tch32
s_add_u32 s77, s77, 0
s_lshl_b32 s77, s77, 13
buffer_load_dword v23, v22, s[36:39], s77 offen
L_tch32:
s_branch L_back_fv6
L_fv6_chk:
s_mov_b32 s72, 0x7fffffff
s_waitcnt vmcnt(16)
v_cmp_ne_u32 vcc, v19, v18
s_nop 1
s_cbranch_vccnz L_spin_fv6
s_branch L_back_fv6
L_setcb0:
s_nop 7
v_cmp_gt_i32_e64 s[80:81], 0, v27
v_cmp_gt_i32_e64 s[82:83], 1, v27
s_nop 0
v_cndmask_b32_e64 v120, v104, v29, s[80:81]
v_cndmask_b32_e64 v121, v104, v29, s[82:83]
v_cmp_gt_i32_e64 s[80:81], 2, v27
v_cmp_gt_i32_e64 s[82:83], 3, v27
s_nop 0
v_cndmask_b32_e64 v122, v104, v29, s[80:81]
v_cndmask_b32_e64 v123, v104, v29, s[82:83]
v_cmp_gt_i32_e64 s[80:81], 16, v27
v_cmp_gt_i32_e64 s[82:83], 17, v27
s_nop 0
v_cndmask_b32_e64 v124, v104, v29, s[80:81]
v_cndmask_b32_e64 v125, v104, v29, s[82:83]
v_cmp_gt_i32_e64 s[80:81], 18, v27
v_cmp_gt_i32_e64 s[82:83], 19, v27
s_nop 0
v_cndmask_b32_e64 v126, v104, v29, s[80:81]
v_cndmask_b32_e64 v127, v104, v29, s[82:83]
s_nop 1
s_branch L_back_setcb0
L_fv7:
s_lshl_b32 s77, s49, 7
s_add_u32 s77, s77, 83922944
v_max_u32 v3, 32, v21
s_cmp_eq_u32 s85, 1
s_cbranch_scc1 L_fv7_chk
s_mov_b32 s85, 1
s_mov_b32 s72, 1
buffer_load_dword v19, v3, s[4:7], s77 offen sc1
v_lshlrev_b32 v22, 7, v0
s_sub_u32 s77, s92, 0x100
s_cmp_ge_u32 s77, 0x240
s_cbranch_scc1 L_tch33
s_add_u32 s77, s77, 0
s_lshl_b32 s77, s77, 13
buffer_load_dword v23, v22, s[32:35], s77 offen
L_tch33:
s_sub_u32 s77, s92, 0x3af
s_cmp_ge_u32 s77, 0x51
s_cbranch_scc1 L_tch34
s_add_u32 s77, s77, 0
s_lshl_b32 s77, s77, 13
buffer_load_dword v23, v22, s[36:39], s77 offen
L_tch34:
s_branch L_back_fv7
L_fv7_chk:
s_mov_b32 s72, 0x7fffffff
s_waitcnt vmcnt(16)
v_cmp_ne_u32 vcc, v19, v18
s_nop 1
s_cbranch_vccnz L_spin_fv7
s_branch L_back_fv7
L_fv8:
s_lshl_b32 s77, s49, 7
s_add_u32 s77, s77, 83922944
v_max_u32 v3, 32, v21
s_cmp_eq_u32 s85, 1
s_cbranch_scc1 L_fv8_chk
s_mov_b32 s85, 1
s_mov_b32 s72, 1
buffer_load_dword v19, v3, s[4:7], s77 offen sc1
v_lshlrev_b32 v22, 7, v0
s_sub_u32 s77, s92, 0x100
s_cmp_ge_u32 s77, 0x240
s_cbranch_scc1 L_tch35
s_add_u32 s77, s77, 0
s_lshl_b32 s77, s77, 13
buffer_load_dword v23, v22, s[32:35], s77 offen
L_tch35:
s_sub_u32 s77, s92, 0x3af
s_cmp_ge_u32 s77, 0x51
s_cbranch_scc1 L_tch36
s_add_u32 s77, s77, 0
s_lshl_b32 s77, s77, 13
buffer_load_dword v23, v22, s[36:39], s77 offen
L_tch36:
s_branch L_back_fv8
L_fv8_chk:
s_mov_b32 s72, 0x7fffffff
s_waitcnt vmcnt(16)
v_cmp_ne_u32 vcc, v19, v18
s_nop 1
s_cbranch_vccnz L_spin_fv8
s_branch L_back_fv8
L_fv9:
s_lshl_b32 s77, s49, 7
s_add_u32 s77, s77, 83922944
v_max_u32 v3, 32, v21
s_cmp_eq_u32 s85, 1
s_cbranch_scc1 L_fv9_chk
s_mov_b32 s85, 1
s_mov_b32 s72, 1
buffer_load_dword v19, v3, s[4:7], s77 offen sc1
v_lshlrev_b32 v22, 7, v0
s_sub_u32 s77, s92, 0x100
s_cmp_ge_u32 s77, 0x240
s_cbranch_scc1 L_tch37
s_add_u32 s77, s77, 0
s_lshl_b32 s77, s77, 13
buffer_load_dword v23, v22, s[32:35], s77 offen
L_tch37:
s_sub_u32 s77, s92, 0x3af
s_cmp_ge_u32 s77, 0x51
s_cbranch_scc1 L_tch38
s_add_u32 s77, s77, 0
s_lshl_b32 s77, s77, 13
buffer_load_dword v23, v22, s[36:39], s77 offen
L_tch38:
s_branch L_back_fv9
L_fv9_chk:
s_mov_b32 s72, 0x7fffffff
s_waitcnt vmcnt(16)
v_cmp_ne_u32 vcc, v19, v18
s_nop 1
s_cbranch_vccnz L_spin_fv9
s_branch L_back_fv9
L_fv10:
s_lshl_b32 s77, s49, 7
s_add_u32 s77, s77, 83922944
v_max_u32 v3, 32, v21
s_cmp_eq_u32 s85, 1
s_cbranch_scc1 L_fv10_chk
s_mov_b32 s85, 1
s_mov_b32 s72, 1
buffer_load_dword v19, v3, s[4:7], s77 offen sc1
v_lshlrev_b32 v22, 7, v0
s_sub_u32 s77, s92, 0x100
s_cmp_ge_u32 s77, 0x240
s_cbranch_scc1 L_tch39
s_add_u32 s77, s77, 0
s_lshl_b32 s77, s77, 13
buffer_load_dword v23, v22, s[32:35], s77 offen
L_tch39:
s_sub_u32 s77, s92, 0x3af
s_cmp_ge_u32 s77, 0x51
s_cbranch_scc1 L_tch40
s_add_u32 s77, s77, 0
s_lshl_b32 s77, s77, 13
buffer_load_dword v23, v22, s[36:39], s77 offen
L_tch40:
s_branch L_back_fv10
L_fv10_chk:
s_mov_b32 s72, 0x7fffffff
s_waitcnt vmcnt(16)
v_cmp_ne_u32 vcc, v19, v18
s_nop 1
s_cbranch_vccnz L_spin_fv10
s_branch L_back_fv10
L_fv11:
s_lshl_b32 s77, s49, 7
s_add_u32 s77, s77, 83922944
v_max_u32 v3, 32, v21
s_cmp_eq_u32 s85, 1
s_cbranch_scc1 L_fv11_chk
s_mov_b32 s85, 1
s_mov_b32 s72, 1
buffer_load_dword v19, v3, s[4:7], s77 offen sc1
v_lshlrev_b32 v22, 7, v0
s_sub_u32 s77, s92, 0x100
s_cmp_ge_u32 s77, 0x240
s_cbranch_scc1 L_tch41
s_add_u32 s77, s77, 0
s_lshl_b32 s77, s77, 13
buffer_load_dword v23, v22, s[32:35], s77 offen
L_tch41:
s_sub_u32 s77, s92, 0x3af
s_cmp_ge_u32 s77, 0x51
s_cbranch_scc1 L_tch42
s_add_u32 s77, s77, 0
s_lshl_b32 s77, s77, 13
buffer_load_dword v23, v22, s[36:39], s77 offen
L_tch42:
s_branch L_back_fv11
L_fv11_chk:
s_mov_b32 s72, 0x7fffffff
s_waitcnt vmcnt(16)
v_cmp_ne_u32 vcc, v19, v18
s_nop 1
s_cbranch_vccnz L_spin_fv11
s_branch L_back_fv11
L_fv12:
s_lshl_b32 s77, s49, 7
s_add_u32 s77, s77, 83922944
v_max_u32 v3, 32, v21
s_cmp_eq_u32 s85, 1
s_cbranch_scc1 L_fv12_chk
s_mov_b32 s85, 1
s_mov_b32 s72, 1
buffer_load_dword v19, v3, s[4:7], s77 offen sc1
v_lshlrev_b32 v22, 7, v0
s_sub_u32 s77, s92, 0x100
s_cmp_ge_u32 s77, 0x240
s_cbranch_scc1 L_tch43
s_add_u32 s77, s77, 0
s_lshl_b32 s77, s77, 13
buffer_load_dword v23, v22, s[32:35], s77 offen
L_tch43:
s_sub_u32 s77, s92, 0x3af
s_cmp_ge_u32 s77, 0x51
s_cbranch_scc1 L_tch44
s_add_u32 s77, s77, 0
s_lshl_b32 s77, s77, 13
buffer_load_dword v23, v22, s[36:39], s77 offen
L_tch44:
s_branch L_back_fv12
L_fv12_chk:
s_mov_b32 s72, 0x7fffffff
s_waitcnt vmcnt(16)
v_cmp_ne_u32 vcc, v19, v18
s_nop 1
s_cbranch_vccnz L_spin_fv12
s_branch L_back_fv12
L_fv13:
s_lshl_b32 s77, s49, 7
s_add_u32 s77, s77, 83922944
v_max_u32 v3, 32, v21
s_cmp_eq_u32 s85, 1
s_cbranch_scc1 L_fv13_chk
s_mov_b32 s85, 1
s_mov_b32 s72, 1
buffer_load_dword v19, v3, s[4:7], s77 offen sc1
v_lshlrev_b32 v22, 7, v0
s_sub_u32 s77, s92, 0x100
s_cmp_ge_u32 s77, 0x240
s_cbranch_scc1 L_tch45
s_add_u32 s77, s77, 0
s_lshl_b32 s77, s77, 13
buffer_load_dword v23, v22, s[32:35], s77 offen
L_tch45:
s_sub_u32 s77, s92, 0x3af
s_cmp_ge_u32 s77, 0x51
s_cbranch_scc1 L_tch46
s_add_u32 s77, s77, 0
s_lshl_b32 s77, s77, 13
buffer_load_dword v23, v22, s[36:39], s77 offen
L_tch46:
s_branch L_back_fv13
L_fv13_chk:
s_mov_b32 s72, 0x7fffffff
s_waitcnt vmcnt(16)
v_cmp_ne_u32 vcc, v19, v18
s_nop 1
s_cbranch_vccnz L_spin_fv13
s_branch L_back_fv13
L_fv14:
s_lshl_b32 s77, s49, 7
s_add_u32 s77, s77, 83922944
v_max_u32 v3, 32, v21
s_cmp_eq_u32 s85, 1
s_cbranch_scc1 L_fv14_chk
s_mov_b32 s85, 1
s_mov_b32 s72, 1
buffer_load_dword v19, v3, s[4:7], s77 offen sc1
v_lshlrev_b32 v22, 7, v0
s_sub_u32 s77, s92, 0x100
s_cmp_ge_u32 s77, 0x240
s_cbranch_scc1 L_tch47
s_add_u32 s77, s77, 0
s_lshl_b32 s77, s77, 13
buffer_load_dword v23, v22, s[32:35], s77 offen
L_tch47:
s_sub_u32 s77, s92, 0x3af
s_cmp_ge_u32 s77, 0x51
s_cbranch_scc1 L_tch48
s_add_u32 s77, s77, 0
s_lshl_b32 s77, s77, 13
buffer_load_dword v23, v22, s[36:39], s77 offen
L_tch48:
s_branch L_back_fv14
L_fv14_chk:
s_mov_b32 s72, 0x7fffffff
s_waitcnt vmcnt(16)
v_cmp_ne_u32 vcc, v19, v18
s_nop 1
s_cbranch_vccnz L_spin_fv14
s_branch L_back_fv14
L_fv15:
s_lshl_b32 s77, s49, 7
s_add_u32 s77, s77, 83922944
v_max_u32 v3, 32, v21
s_cmp_eq_u32 s85, 1
s_cbranch_scc1 L_fv15_chk
s_mov_b32 s85, 1
s_mov_b32 s72, 1
buffer_load_dword v19, v3, s[4:7], s77 offen sc1
v_lshlrev_b32 v22, 7, v0
s_sub_u32 s77, s92, 0x100
s_cmp_ge_u32 s77, 0x240
s_cbranch_scc1 L_tch49
s_add_u32 s77, s77, 0
s_lshl_b32 s77, s77, 13
buffer_load_dword v23, v22, s[32:35], s77 offen
L_tch49:
s_sub_u32 s77, s92, 0x3af
s_cmp_ge_u32 s77, 0x51
s_cbranch_scc1 L_tch50
s_add_u32 s77, s77, 0
s_lshl_b32 s77, s77, 13
buffer_load_dword v23, v22, s[36:39], s77 offen
L_tch50:
s_branch L_back_fv15
L_fv15_chk:
s_mov_b32 s72, 0x7fffffff
s_waitcnt vmcnt(16)
v_cmp_ne_u32 vcc, v19, v18
s_nop 1
s_cbranch_vccnz L_spin_fv15
s_branch L_back_fv15
L_fv16:
s_lshl_b32 s77, s49, 7
s_add_u32 s77, s77, 83922944
v_max_u32 v3, 32, v21
s_cmp_eq_u32 s85, 1
s_cbranch_scc1 L_fv16_chk
s_mov_b32 s85, 1
s_mov_b32 s72, 1
buffer_load_dword v19, v3, s[4:7], s77 offen sc1
v_lshlrev_b32 v22, 7, v0
s_sub_u32 s77, s92, 0x100
s_cmp_ge_u32 s77, 0x240
s_cbranch_scc1 L_tch51
s_add_u32 s77, s77, 0
s_lshl_b32 s77, s77, 13
buffer_load_dword v23, v22, s[32:35], s77 offen
L_tch51:
s_sub_u32 s77, s92, 0x3af
s_cmp_ge_u32 s77, 0x51
s_cbranch_scc1 L_tch52
s_add_u32 s77, s77, 0
s_lshl_b32 s77, s77, 13
buffer_load_dword v23, v22, s[36:39], s77 offen
L_tch52:
s_branch L_back_fv16
L_fv16_chk:
s_mov_b32 s72, 0x7fffffff
s_waitcnt vmcnt(16)
v_cmp_ne_u32 vcc, v19, v18
s_nop 1
s_cbranch_vccnz L_spin_fv16
s_branch L_back_fv16
L_fv17:
s_lshl_b32 s77, s49, 7
s_add_u32 s77, s77, 83922944
v_max_u32 v3, 32, v21
s_cmp_eq_u32 s85, 1
s_cbranch_scc1 L_fv17_chk
s_mov_b32 s85, 1
s_mov_b32 s72, 1
buffer_load_dword v19, v3, s[4:7], s77 offen sc1
v_lshlrev_b32 v22, 7, v0
s_sub_u32 s77, s92, 0x100
s_cmp_ge_u32 s77, 0x240
s_cbranch_scc1 L_tch53
s_add_u32 s77, s77, 0
s_lshl_b32 s77, s77, 13
buffer_load_dword v23, v22, s[32:35], s77 offen
L_tch53:
s_sub_u32 s77, s92, 0x3af
s_cmp_ge_u32 s77, 0x51
s_cbranch_scc1 L_tch54
s_add_u32 s77, s77, 0
s_lshl_b32 s77, s77, 13
buffer_load_dword v23, v22, s[36:39], s77 offen
L_tch54:
s_branch L_back_fv17
L_fv17_chk:
s_mov_b32 s72, 0x7fffffff
s_waitcnt vmcnt(16)
v_cmp_ne_u32 vcc, v19, v18
s_nop 1
s_cbranch_vccnz L_spin_fv17
s_branch L_back_fv17
L_fv18:
s_lshl_b32 s77, s49, 7
s_add_u32 s77, s77, 83922944
v_max_u32 v3, 32, v21
s_cmp_eq_u32 s85, 1
s_cbranch_scc1 L_fv18_chk
s_mov_b32 s85, 1
s_mov_b32 s72, 1
buffer_load_dword v19, v3, s[4:7], s77 offen sc1
v_lshlrev_b32 v22, 7, v0
s_sub_u32 s77, s92, 0x100
s_cmp_ge_u32 s77, 0x240
s_cbranch_scc1 L_tch55
s_add_u32 s77, s77, 0
s_lshl_b32 s77, s77, 13
buffer_load_dword v23, v22, s[32:35], s77 offen
L_tch55:
s_sub_u32 s77, s92, 0x3af
s_cmp_ge_u32 s77, 0x51
s_cbranch_scc1 L_tch56
s_add_u32 s77, s77, 0
s_lshl_b32 s77, s77, 13
buffer_load_dword v23, v22, s[36:39], s77 offen
L_tch56:
s_branch L_back_fv18
L_fv18_chk:
s_mov_b32 s72, 0x7fffffff
s_waitcnt vmcnt(16)
v_cmp_ne_u32 vcc, v19, v18
s_nop 1
s_cbranch_vccnz L_spin_fv18
s_branch L_back_fv18
L_adY:
s_waitcnt lgkmcnt(3)
v_mfma_f32_16x16x32_bf16 v[32:35], a[64:67], a[0:3], v[120:123]
s_sub_u32 s72, s72, 1
s_cbranch_scc1 L_fv7
L_back_fv7:
s_xor_b32 s75, s91, 0x10000
v_mfma_f32_16x16x32_bf16 v[32:35], a[68:71], a[4:7], v[32:35]
s_add_u32 m0, s75, s59
v_exp_f32 v60, v60
v_mfma_f32_16x16x32_bf16 v[32:35], a[72:75], a[8:11], v[32:35]
buffer_load_dwordx4 v1, s[4:7], s89 offen sc1 lds
ds_read_b128 a[96:99], v26 offset:16384
v_mfma_f32_16x16x32_bf16 v[32:35], a[76:79], a[12:15], v[32:35]
v_exp_f32 v61, v61
v_mfma_f32_16x16x32_bf16 v[36:39], a[92:95], a[12:15], v[124:127]
s_waitcnt lgkmcnt(1)
ds_read_b128 a[100:103], v26 offset:17408
v_cvt_pk_bf16_f32 v78, v60, v61
v_mfma_f32_16x16x32_bf16 v[36:39], a[88:91], a[8:11], v[36:39]
v_exp_f32 v62, v62
v_mfma_f32_16x16x32_bf16 v[36:39], a[84:87], a[4:7], v[36:39]
v_exp_f32 v63, v63
v_mfma_f32_16x16x32_bf16 v[36:39], a[80:83], a[0:3], v[36:39]
v_cvt_pk_bf16_f32 v79, v62, v63
v_mfma_f32_16x16x32_bf16 v[40:43], a[64:67], a[16:19], v[100:103]
ds_read_b128 a[104:107], v26 offset:18432
v_mfma_f32_16x16x32_bf16 v[40:43], a[68:71], a[20:23], v[40:43]
v_exp_f32 v32, v32
v_mfma_f32_16x16x32_bf16 v[40:43], a[72:75], a[24:27], v[40:43]
v_exp_f32 v33, v33
v_mfma_f32_16x16x32_bf16 v[40:43], a[76:79], a[28:31], v[40:43]
v_cvt_pk_bf16_f32 v80, v32, v33
v_mfma_f32_16x16x32_bf16 v[44:47], a[92:95], a[28:31], v[100:103]
ds_read_b128 a[108:111], v26 offset:19456
v_mfma_f32_16x16x32_bf16 v[44:47], a[88:91], a[24:27], v[44:47]
v_exp_f32 v34, v34
v_mfma_f32_16x16x32_bf16 v[44:47], a[84:87], a[20:23], v[44:47]
v_exp_f32 v35, v35
v_mfma_f32_16x16x32_bf16 v[44:47], a[80:83], a[16:19], v[44:47]
v_cvt_pk_bf16_f32 v81, v34, v35
v_mfma_f32_16x16x32_bf16 v[48:51], a[64:67], a[32:35], v[104:107]
buffer_load_dwordx4 v1, s[4:7], s89 offen offset:1024 sc1 lds
ds_read_b128 a[112:115], v26 offset:20480
v_mfma_f32_16x16x32_bf16 v[48:51], a[68:71], a[36:39], v[48:51]
v_exp_f32 v36, v36
v_mfma_f32_16x16x32_bf16 v[48:51], a[72:75], a[40:43], v[48:51]
v_exp_f32 v37, v37
v_mfma_f32_16x16x32_bf16 v[48:51], a[76:79], a[44:47], v[48:51]
v_cvt_pk_bf16_f32 v82, v36, v37
v_mfma_f32_16x16x32_bf16 v[52:55], a[92:95], a[44:47], v[104:107]
ds_read_b128 a[116:119], v26 offset:21504
v_mfma_f32_16x16x32_bf16 v[52:55], a[88:91], a[40:43], v[52:55]
v_exp_f32 v38, v38
v_mfma_f32_16x16x32_bf16 v[52:55], a[84:87], a[36:39], v[52:55]
v_exp_f32 v39, v39
v_mfma_f32_16x16x32_bf16 v[52:55], a[80:83], a[32:35], v[52:55]
v_cmp_gt_i32_e64 s[80:81], 0, v28
v_cmp_gt_i32_e64 s[82:83], 1, v28
v_mfma_f32_16x16x32_bf16 v[56:59], a[64:67], a[48:51], v[108:111]
ds_read_b128 a[120:123], v26 offset:22528
v_cvt_pk_bf16_f32 v83, v38, v39
v_mfma_f32_16x16x32_bf16 v[56:59], a[68:71], a[52:55], v[56:59]
v_exp_f32 v40, v40
v_mfma_f32_16x16x32_bf16 v[56:59], a[72:75], a[56:59], v[56:59]
v_exp_f32 v41, v41
v_mfma_f32_16x16x32_bf16 v[56:59], a[76:79], a[60:63], v[56:59]
v_cvt_pk_bf16_f32 v84, v40, v41
v_mfma_f32_16x16x32_bf16 v[60:63], a[92:95], a[60:63], v[108:111]
ds_read_b128 a[124:127], v26 offset:23552
v_mfma_f32_16x16x32_bf16 v[60:63], a[88:91], a[56:59], v[60:63]
v_exp_f32 v42, v42
v_mfma_f32_16x16x32_bf16 v[60:63], a[84:87], a[52:55], v[60:63]
v_exp_f32 v43, v43
v_mfma_f32_16x16x32_bf16 v[60:63], a[80:83], a[48:51], v[60:63]
s_waitcnt lgkmcnt(7)
buffer_load_dwordx4 v1, s[4:7], s89 offen offset:2048 sc1 lds
ds_read_b128 a[64:67], v26
v_mfma_f32_16x16x32_bf16 v[128:131], a[96:99], v[64:67], v[128:131]
v_cvt_pk_bf16_f32 v85, v42, v43
v_mfma_f32_16x16x32_bf16 v[160:163], a[96:99], v[68:71], v[160:163]
v_exp_f32 v44, v44
v_mfma_f32_16x16x32_bf16 v[192:195], a[96:99], v[72:75], v[192:195]
v_exp_f32 v45, v45
v_mfma_f32_16x16x32_bf16 v[224:227], a[96:99], v[76:79], v[224:227]
s_waitcnt lgkmcnt(7)
ds_read_b128 a[68:71], v26 offset:1024
v_cvt_pk_bf16_f32 v86, v44, v45
v_mfma_f32_16x16x32_bf16 v[228:231], a[100:103], v[76:79], v[228:231]
v_exp_f32 v46, v46
v_mfma_f32_16x16x32_bf16 v[196:199], a[100:103], v[72:75], v[196:199]
v_exp_f32 v47, v47
v_mfma_f32_16x16x32_bf16 v[164:167], a[100:103], v[68:71], v[164:167]
v_cvt_pk_bf16_f32 v87, v46, v47
v_mfma_f32_16x16x32_bf16 v[132:135], a[100:103], v[64:67], v[132:135]
s_waitcnt lgkmcnt(7)
ds_read_b128 a[72:75], v26 offset:2048
v_mfma_f32_16x16x32_bf16 v[136:139], a[104:107], v[64:67], v[136:139]
s_lshl_b32 s76, s48, 13
s_add_u32 s76, s76, L_peel-L_pc
v_lshlrev_b32 v30, 7, v0
v_add_u32 v30, s76, v30
v_min_u32 v30, L_codeend-L_pc-4, v30
global_load_dword v24, v30, s[98:99]
v_mfma_f32_16x16x32_bf16 v[168:171], a[104:107], v[68:71], v[168:171]
v_exp_f32 v48, v48
v_mfma_f32_16x16x32_bf16 v[200:203], a[104:107], v[72:75], v[200:203]
v_exp_f32 v49, v49
v_mfma_f32_16x16x32_bf16 v[232:235], a[104:107], v[76:79], v[232:235]
s_waitcnt lgkmcnt(6)
ds_read_b128 a[76:79], v26 offset:3072
v_cvt_pk_bf16_f32 v88, v48, v49
v_mfma_f32_16x16x32_bf16 v[236:239], a[108:111], v[76:79], v[236:239]
v_add_u32 v30, L_table-L_pc, v1
global_load_dwordx4 v[4:7], v30, s[98:99]
v_mfma_f32_16x16x32_bf16 v[204:207], a[108:111], v[72:75], v[204:207]
v_exp_f32 v50, v50
v_mfma_f32_16x16x32_bf16 v[172:175], a[108:111], v[68:71], v[172:175]
buffer_load_dwordx4 v1, s[4:7], s89 offen offset:3072 sc1 lds
s_add_u32 s89, s89, 0x4000
v_mfma_f32_16x16x32_bf16 v[140:143], a[108:111], v[64:67], v[140:143]
ds_read_b128 a[92:95], v26 offset:7168
v_mfma_f32_16x16x32_bf16 v[144:147], a[112:115], v[64:67], v[144:147]
v_exp_f32 v51, v51
v_mfma_f32_16x16x32_bf16 v[176:179], a[112:115], v[68:71], v[176:179]
v_add_u32 v30, L_table-L_pc, v1
global_load_dwordx4 v[8:11], v30, s[98:99] offset:1024
v_mfma_f32_16x16x32_bf16 v[208:211], a[112:115], v[72:75], v[208:211]
v_cvt_pk_bf16_f32 v89, v50, v51
v_mfma_f32_16x16x32_bf16 v[240:243], a[112:115], v[76:79], v[240:243]
s_waitcnt lgkmcnt(7)
ds_read_b128 a[88:91], v26 offset:6144
v_mfma_f32_16x16x32_bf16 v[244:247], a[116:119], v[76:79], v[244:247]
v_exp_f32 v52, v52
v_mfma_f32_16x16x32_bf16 v[212:215], a[116:119], v[72:75], v[212:215]
v_exp_f32 v53, v53
v_mfma_f32_16x16x32_bf16 v[180:183], a[116:119], v[68:71], v[180:183]
v_add_u32 v30, L_table-L_pc, v1
global_load_dwordx4 v[12:15], v30, s[98:99] offset:2048
v_mfma_f32_16x16x32_bf16 v[148:151], a[116:119], v[64:67], v[148:151]
s_waitcnt lgkmcnt(7)
ds_read_b128 a[84:87], v26 offset:5120
v_cvt_pk_bf16_f32 v90, v52, v53
v_mfma_f32_16x16x32_bf16 v[152:155], a[120:123], v[64:67], v[152:155]
v_exp_f32 v54, v54
v_mfma_f32_16x16x32_bf16 v[184:187], a[120:123], v[68:71], v[184:187]
v_exp_f32 v55, v55
v_mfma_f32_16x16x32_bf16 v[216:219], a[120:123], v[72:75], v[216:219]
v_cvt_pk_bf16_f32 v91, v54, v55
v_mfma_f32_16x16x32_bf16 v[248:251], a[120:123], v[76:79], v[248:251]
s_waitcnt lgkmcnt(7)
v_add_u32 v30, L_table-L_pc, v1
global_load_dword v16, v30, s[98:99] offset:3072
v_mfma_f32_16x16x32_bf16 v[252:255], a[124:127], v[76:79], v[252:255]
s_add_u32 m0, m0, 0x4000
ds_read_b128 a[80:83], v26 offset:4096
v_mfma_f32_16x16x32_bf16 v[220:223], a[124:127], v[72:75], v[220:223]
buffer_load_dwordx4 v1, s[4:7], s90 offen sc1 lds
v_mfma_f32_16x16x32_bf16 v[188:191], a[124:127], v[68:71], v[188:191]
v_exp_f32 v56, v56
v_mfma_f32_16x16x32_bf16 v[156:159], a[124:127], v[64:67], v[156:159]
v_exp_f32 v57, v57
v_mfma_f32_16x16x32_bf16 a[128:131], a[144:147], v[64:67], a[128:131]
v_cvt_pk_bf16_f32 v92, v56, v57
v_mfma_f32_16x16x32_bf16 a[132:135], a[144:147], v[68:71], a[132:135]
s_nop 0
v_cndmask_b32_e64 v112, v100, v29, s[80:81]
v_cndmask_b32_e64 v113, v100, v29, s[82:83]
v_cmp_gt_i32_e64 s[80:81], 2, v28
v_cmp_gt_i32_e64 s[82:83], 3, v28
s_nop 0
v_cndmask_b32_e64 v114, v100, v29, s[80:81]
v_cndmask_b32_e64 v115, v100, v29, s[82:83]
v_cmp_gt_i32_e64 s[80:81], 16, v28
v_cmp_gt_i32_e64 s[82:83], 17, v28
s_nop 0
v_cndmask_b32_e64 v116, v100, v29, s[80:81]
v_cndmask_b32_e64 v117, v100, v29, s[82:83]
v_cmp_gt_i32_e64 s[80:81], 18, v28
v_cmp_gt_i32_e64 s[82:83], 19, v28
s_nop 0
v_cndmask_b32_e64 v118, v100, v29, s[80:81]
v_cndmask_b32_e64 v119, v100, v29, s[82:83]
v_mfma_f32_16x16x32_bf16 a[136:139], a[144:147], v[72:75], a[136:139]
v_exp_f32 v58, v58
v_mfma_f32_16x16x32_bf16 a[140:143], a[144:147], v[76:79], a[140:143]
s_waitcnt lgkmcnt(4)
v_exp_f32 v59, v59
v_mfma_f32_16x16x32_bf16 v[40:43], a[64:67], a[16:19], v[112:115]
ds_read_b128 a[96:99], v26 offset:24576
v_cvt_pk_bf16_f32 v93, v58, v59
v_mfma_f32_16x16x32_bf16 v[40:43], a[68:71], a[20:23], v[40:43]
v_exp_f32 v60, v60
v_mfma_f32_16x16x32_bf16 v[40:43], a[72:75], a[24:27], v[40:43]
v_exp_f32 v61, v61
v_mfma_f32_16x16x32_bf16 v[40:43], a[76:79], a[28:31], v[40:43]
s_waitcnt lgkmcnt(1)
ds_read_b128 a[100:103], v26 offset:25600
v_cvt_pk_bf16_f32 v94, v60, v61
v_mfma_f32_16x16x32_bf16 v[44:47], a[92:95], a[28:31], v[116:119]
v_exp_f32 v62, v62
v_mfma_f32_16x16x32_bf16 v[44:47], a[88:91], a[24:27], v[44:47]
v_exp_f32 v63, v63
v_mfma_f32_16x16x32_bf16 v[44:47], a[84:87], a[20:23], v[44:47]
ds_read_b128 a[104:107], v26 offset:26624
v_cvt_pk_bf16_f32 v95, v62, v63
v_mfma_f32_16x16x32_bf16 v[44:47], a[80:83], a[16:19], v[44:47]
v_mov_b32 v120, v104
v_mov_b32 v121, v104
v_mfma_f32_16x16x32_bf16 v[48:51], a[64:67], a[32:35], v[104:107]
buffer_load_dwordx4 v1, s[4:7], s90 offen offset:1024 sc1 lds
ds_read_b128 a[108:111], v26 offset:27648
v_mfma_f32_16x16x32_bf16 v[48:51], a[68:71], a[36:39], v[48:51]
v_exp_f32 v40, v40
v_mfma_f32_16x16x32_bf16 v[48:51], a[72:75], a[40:43], v[48:51]
v_exp_f32 v41, v41
v_mfma_f32_16x16x32_bf16 v[48:51], a[76:79], a[44:47], v[48:51]
ds_read_b128 a[112:115], v26 offset:28672
v_cvt_pk_bf16_f32 v68, v40, v41
v_mfma_f32_16x16x32_bf16 v[52:55], a[92:95], a[44:47], v[104:107]
v_exp_f32 v42, v42
v_mfma_f32_16x16x32_bf16 v[52:55], a[88:91], a[40:43], v[52:55]
v_exp_f32 v43, v43
v_mfma_f32_16x16x32_bf16 v[52:55], a[84:87], a[36:39], v[52:55]
ds_read_b128 a[116:119], v26 offset:29696
v_cvt_pk_bf16_f32 v69, v42, v43
v_mfma_f32_16x16x32_bf16 v[52:55], a[80:83], a[32:35], v[52:55]
v_exp_f32 v44, v44
v_mfma_f32_16x16x32_bf16 v[56:59], a[64:67], a[48:51], v[108:111]
v_exp_f32 v45, v45
v_mfma_f32_16x16x32_bf16 v[56:59], a[68:71], a[52:55], v[56:59]
ds_read_b128 a[120:123], v26 offset:30720
v_cvt_pk_bf16_f32 v70, v44, v45
v_mfma_f32_16x16x32_bf16 v[56:59], a[72:75], a[56:59], v[56:59]
v_exp_f32 v46, v46
v_mfma_f32_16x16x32_bf16 v[56:59], a[76:79], a[60:63], v[56:59]
v_exp_f32 v47, v47
v_mfma_f32_16x16x32_bf16 v[60:63], a[92:95], a[60:63], v[108:111]
ds_read_b128 a[124:127], v26 offset:31744
v_cvt_pk_bf16_f32 v71, v46, v47
v_mfma_f32_16x16x32_bf16 v[60:63], a[88:91], a[56:59], v[60:63]
v_exp_f32 v48, v48
v_mfma_f32_16x16x32_bf16 v[60:63], a[84:87], a[52:55], v[60:63]
v_exp_f32 v49, v49
v_mfma_f32_16x16x32_bf16 v[60:63], a[80:83], a[48:51], v[60:63]
s_waitcnt lgkmcnt(7)
buffer_load_dwordx4 v1, s[4:7], s90 offen offset:2048 sc1 lds
ds_read_b128 a[64:67], v26 offset:8192
v_mfma_f32_16x16x32_bf16 v[128:131], a[96:99], v[80:83], v[128:131]
v_cvt_pk_bf16_f32 v72, v48, v49
v_mov_b32 v122, v104
v_mfma_f32_16x16x32_bf16 v[160:163], a[96:99], v[84:87], v[160:163]
v_exp_f32 v50, v50
v_mfma_f32_16x16x32_bf16 v[192:195], a[96:99], v[88:91], v[192:195]
v_exp_f32 v51, v51
v_mfma_f32_16x16x32_bf16 v[224:227], a[96:99], v[92:95], v[224:227]
s_waitcnt lgkmcnt(7)
ds_read_b128 a[68:71], v26 offset:9216
v_cvt_pk_bf16_f32 v73, v50, v51
v_mfma_f32_16x16x32_bf16 v[228:231], a[100:103], v[92:95], v[228:231]
v_exp_f32 v52, v52
v_mfma_f32_16x16x32_bf16 v[196:199], a[100:103], v[88:91], v[196:199]
v_exp_f32 v53, v53
v_mfma_f32_16x16x32_bf16 v[164:167], a[100:103], v[84:87], v[164:167]
v_cvt_pk_bf16_f32 v74, v52, v53
v_mov_b32 v123, v104
v_mfma_f32_16x16x32_bf16 v[132:135], a[100:103], v[80:83], v[132:135]
s_waitcnt lgkmcnt(7)
ds_read_b128 a[72:75], v26 offset:10240
v_mov_b32 v124, v104
v_mfma_f32_16x16x32_bf16 v[136:139], a[104:107], v[80:83], v[136:139]
v_exp_f32 v54, v54
v_mfma_f32_16x16x32_bf16 v[168:171], a[104:107], v[84:87], v[168:171]
v_exp_f32 v55, v55
v_mfma_f32_16x16x32_bf16 v[200:203], a[104:107], v[88:91], v[200:203]
v_cvt_pk_bf16_f32 v75, v54, v55
v_mov_b32 v125, v104
v_mfma_f32_16x16x32_bf16 v[232:235], a[104:107], v[92:95], v[232:235]
s_waitcnt lgkmcnt(7)
ds_read_b128 a[76:79], v26 offset:11264
v_mov_b32 v126, v104
v_mfma_f32_16x16x32_bf16 v[236:239], a[108:111], v[92:95], v[236:239]
v_exp_f32 v56, v56
v_mfma_f32_16x16x32_bf16 v[204:207], a[108:111], v[88:91], v[204:207]
v_exp_f32 v57, v57
v_mfma_f32_16x16x32_bf16 v[172:175], a[108:111], v[84:87], v[172:175]
buffer_load_dwordx4 v1, s[4:7], s90 offen offset:3072 sc1 lds
s_add_u32 s90, s90, 0x4000
v_cvt_pk_bf16_f32 v76, v56, v57
v_mfma_f32_16x16x32_bf16 v[140:143], a[108:111], v[80:83], v[140:143]
s_waitcnt lgkmcnt(7)
ds_read_b128 a[92:95], v26 offset:15360
v_mov_b32 v127, v104
v_mfma_f32_16x16x32_bf16 v[144:147], a[112:115], v[80:83], v[144:147]
v_exp_f32 v58, v58
v_mfma_f32_16x16x32_bf16 v[176:179], a[112:115], v[84:87], v[176:179]
v_exp_f32 v59, v59
v_mfma_f32_16x16x32_bf16 v[208:211], a[112:115], v[88:91], v[208:211]
v_cvt_pk_bf16_f32 v77, v58, v59
v_mfma_f32_16x16x32_bf16 v[240:243], a[112:115], v[92:95], v[240:243]
s_waitcnt lgkmcnt(7)
ds_read_b128 a[88:91], v26 offset:14336
v_mfma_f32_16x16x32_bf16 v[244:247], a[116:119], v[92:95], v[244:247]
v_exp_f32 v60, v60
v_mfma_f32_16x16x32_bf16 v[212:215], a[116:119], v[88:91], v[212:215]
v_exp_f32 v61, v61
v_mfma_f32_16x16x32_bf16 v[180:183], a[116:119], v[84:87], v[180:183]
v_cvt_pk_bf16_f32 v78, v60, v61
v_mfma_f32_16x16x32_bf16 v[148:151], a[116:119], v[80:83], v[148:151]
s_waitcnt lgkmcnt(7)
ds_read_b128 a[84:87], v26 offset:13312
v_mfma_f32_16x16x32_bf16 v[152:155], a[120:123], v[80:83], v[152:155]
v_exp_f32 v62, v62
v_mfma_f32_16x16x32_bf16 v[184:187], a[120:123], v[84:87], v[184:187]
v_exp_f32 v63, v63
v_mfma_f32_16x16x32_bf16 v[216:219], a[120:123], v[88:91], v[216:219]
v_cvt_pk_bf16_f32 v79, v62, v63
v_mfma_f32_16x16x32_bf16 v[248:251], a[120:123], v[92:95], v[248:251]
s_waitcnt lgkmcnt(7)
ds_read_b128 a[80:83], v26 offset:12288
v_mfma_f32_16x16x32_bf16 v[252:255], a[124:127], v[92:95], v[252:255]
v_cmp_gt_i32_e64 s[80:81], 0, v27
v_cmp_gt_i32_e64 s[82:83], 1, v27
v_mfma_f32_16x16x32_bf16 v[220:223], a[124:127], v[88:91], v[220:223]
s_add_u32 s91, s91, 0x8000
v_mfma_f32_16x16x32_bf16 v[188:191], a[124:127], v[84:87], v[188:191]
s_and_b32 s91, s91, 0x18000
v_mfma_f32_16x16x32_bf16 v[156:159], a[124:127], v[80:83], v[156:159]
v_mfma_f32_16x16x32_bf16 a[128:131], a[144:147], v[80:83], a[128:131]
v_mfma_f32_16x16x32_bf16 a[132:135], a[144:147], v[84:87], a[132:135]
s_waitcnt vmcnt(13)
s_barrier
v_mfma_f32_16x16x32_bf16 a[136:139], a[144:147], v[88:91], a[136:139]
s_waitcnt lgkmcnt(1)
v_add_u32 v26, s91, v2
v_mfma_f32_16x16x32_bf16 a[140:143], a[144:147], v[92:95], a[140:143]
s_sub_u32 s72, s72, 1
s_cbranch_scc1 L_fv8
L_back_fv8:
v_mfma_f32_16x16x32_bf16 v[48:51], a[64:67], a[32:35], v[104:107]
s_xor_b32 s75, s91, 0x10000
ds_read_b128 a[96:99], v26 offset:16384
v_mfma_f32_16x16x32_bf16 v[48:51], a[68:71], a[36:39], v[48:51]
s_add_u32 m0, s75, s59
ds_read_b128 a[100:103], v26 offset:17408
v_mfma_f32_16x16x32_bf16 v[48:51], a[72:75], a[40:43], v[48:51]
buffer_load_dwordx4 v1, s[4:7], s89 offen sc1 lds
v_mfma_f32_16x16x32_bf16 v[48:51], a[76:79], a[44:47], v[48:51]
ds_read_b128 a[104:107], v26 offset:18432
v_mfma_f32_16x16x32_bf16 v[52:55], a[92:95], a[44:47], v[104:107]
v_mfma_f32_16x16x32_bf16 v[52:55], a[88:91], a[40:43], v[52:55]
ds_read_b128 a[108:111], v26 offset:19456
v_mfma_f32_16x16x32_bf16 v[52:55], a[84:87], a[36:39], v[52:55]
s_waitcnt lgkmcnt(4)
v_accvgpr_read_b32 v32, a128
s_mov_b32 s76, 0x21800000
v_cmp_nle_f32_e64 s[94:95], s76, v32
s_mov_b32 s76, 0x5d800000
v_cmp_nge_f32 vcc, s76, v32
s_or_b64 vcc, vcc, s[94:95]
s_cbranch_scc1 L_slow0Y
L_back_slow0Y:
v_accvgpr_read_b32 v32, a128
v_mfma_f32_16x16x32_bf16 v[52:55], a[80:83], a[32:35], v[52:55]
v_rcp_f32 v32, v32
s_nop 0
v_mfma_f32_16x16x32_bf16 v[56:59], a[64:67], a[48:51], v[108:111]
v_mul_f32 v128, v32, v128
v_mul_f32 v129, v32, v129
v_mfma_f32_16x16x32_bf16 v[56:59], a[68:71], a[52:55], v[56:59]
v_mul_f32 v130, v32, v130
v_mul_f32 v131, v32, v131
v_mfma_f32_16x16x32_bf16 v[56:59], a[72:75], a[56:59], v[56:59]
v_mul_f32 v132, v32, v132
v_mul_f32 v133, v32, v133
v_mfma_f32_16x16x32_bf16 v[56:59], a[76:79], a[60:63], v[56:59]
v_mul_f32 v134, v32, v134
v_mul_f32 v135, v32, v135
v_mfma_f32_16x16x32_bf16 v[60:63], a[92:95], a[60:63], v[108:111]
buffer_load_dwordx4 v1, s[4:7], s89 offen offset:1024 sc1 lds
v_cvt_pk_bf16_f32 v128, v128, v129
v_mfma_f32_16x16x32_bf16 v[60:63], a[88:91], a[56:59], v[60:63]
v_cvt_pk_bf16_f32 v129, v130, v131
v_cvt_pk_bf16_f32 v130, v132, v133
v_mfma_f32_16x16x32_bf16 v[60:63], a[84:87], a[52:55], v[60:63]
ds_read_b128 a[112:115], v26 offset:20480
v_cvt_pk_bf16_f32 v131, v134, v135
v_mfma_f32_16x16x32_bf16 v[60:63], a[80:83], a[48:51], v[60:63]
s_waitcnt lgkmcnt(4)
buffer_store_dwordx4 v[128:131], v1, s[4:7], s55 offen sc1
v_mul_f32 v136, v32, v136
v_mfma_f32_16x16x32_bf16 v[160:163], a[96:99], v[68:71], v[160:163]
ds_read_b128 a[116:119], v26 offset:21504
v_mul_f32 v137, v32, v137
v_mfma_f32_16x16x32_bf16 v[192:195], a[96:99], v[72:75], v[192:195]
ds_read_b128 a[120:123], v26 offset:22528
v_mul_f32 v138, v32, v138
v_mfma_f32_16x16x32_bf16 v[224:227], a[96:99], v[76:79], v[224:227]
s_waitcnt lgkmcnt(5)
v_mul_f32 v139, v32, v139
v_mul_f32 v140, v32, v140
v_mfma_f32_16x16x32_bf16 v[228:231], a[100:103], v[76:79], v[228:231]
buffer_load_dwordx4 v1, s[4:7], s89 offen offset:2048 sc1 lds
v_mul_f32 v141, v32, v141
v_mfma_f32_16x16x32_bf16 v[196:199], a[100:103], v[72:75], v[196:199]
ds_read_b128 a[124:127], v26 offset:23552
v_mul_f32 v142, v32, v142
v_mfma_f32_16x16x32_bf16 v[164:167], a[100:103], v[68:71], v[164:167]
s_waitcnt lgkmcnt(4)
v_mul_f32 v143, v32, v143
v_cvt_pk_bf16_f32 v136, v136, v137
v_mfma_f32_16x16x32_bf16 v[168:171], a[104:107], v[68:71], v[168:171]
ds_read_b128 a[64:67], v26
v_cvt_pk_bf16_f32 v137, v138, v139
v_mfma_f32_16x16x32_bf16 v[200:203], a[104:107], v[72:75], v[200:203]
ds_read_b128 a[68:71], v26 offset:1024
v_cvt_pk_bf16_f32 v138, v140, v141
v_mfma_f32_16x16x32_bf16 v[232:235], a[104:107], v[76:79], v[232:235]
v_cvt_pk_bf16_f32 v139, v142, v143
buffer_store_dwordx4 v[136:139], v1, s[4:7], s55 offen offset:1024 sc1
v_mfma_f32_16x16x32_bf16 v[236:239], a[108:111], v[76:79], v[236:239]
ds_read_b128 a[72:75], v26 offset:2048
v_mul_f32 v144, v32, v144
v_mfma_f32_16x16x32_bf16 v[204:207], a[108:111], v[72:75], v[204:207]
v_mul_f32 v145, v32, v145
v_mul_f32 v146, v32, v146
v_mfma_f32_16x16x32_bf16 v[172:175], a[108:111], v[68:71], v[172:175]
s_waitcnt lgkmcnt(6)
buffer_load_dwordx4 v1, s[4:7], s89 offen offset:3072 sc1 lds
s_add_u32 s89, s89, 0x4000
v_mul_f32 v147, v32, v147
v_mfma_f32_16x16x32_bf16 v[176:179], a[112:115], v[68:71], v[176:179]
ds_read_b128 a[76:79], v26 offset:3072
v_mul_f32 v148, v32, v148
v_mfma_f32_16x16x32_bf16 v[208:211], a[112:115], v[72:75], v[208:211]
v_mul_f32 v149, v32, v149
v_mul_f32 v150, v32, v150
v_mfma_f32_16x16x32_bf16 v[240:243], a[112:115], v[76:79], v[240:243]
s_waitcnt lgkmcnt(6)
ds_read_b128 a[92:95], v26 offset:7168
v_mul_f32 v151, v32, v151
v_mfma_f32_16x16x32_bf16 v[244:247], a[116:119], v[76:79], v[244:247]
ds_read_b128 a[88:91], v26 offset:6144
v_cvt_pk_bf16_f32 v144, v144, v145
v_mfma_f32_16x16x32_bf16 v[212:215], a[116:119], v[72:75], v[212:215]
v_cvt_pk_bf16_f32 v145, v146, v147
v_cvt_pk_bf16_f32 v146, v148, v149
v_mfma_f32_16x16x32_bf16 v[180:183], a[116:119], v[68:71], v[180:183]
s_waitcnt lgkmcnt(6)
ds_read_b128 a[84:87], v26 offset:5120
v_cvt_pk_bf16_f32 v147, v150, v151
v_mfma_f32_16x16x32_bf16 v[184:187], a[120:123], v[68:71], v[184:187]
buffer_store_dwordx4 v[144:147], v1, s[4:7], s55 offen offset:2048 sc1
v_mfma_f32_16x16x32_bf16 v[216:219], a[120:123], v[72:75], v[216:219]
s_add_u32 m0, m0, 0x4000
v_mul_f32 v152, v32, v152
v_mul_f32 v153, v32, v153
v_mfma_f32_16x16x32_bf16 v[248:251], a[120:123], v[76:79], v[248:251]
buffer_load_dwordx4 v1, s[4:7], s90 offen sc1 lds
v_mul_f32 v154, v32, v154
v_mfma_f32_16x16x32_bf16 v[252:255], a[124:127], v[76:79], v[252:255]
ds_read_b128 a[80:83], v26 offset:4096
v_mul_f32 v155, v32, v155
v_mfma_f32_16x16x32_bf16 v[220:223], a[124:127], v[72:75], v[220:223]
v_exp_f32 v48, v48
v_mfma_f32_16x16x32_bf16 v[188:191], a[124:127], v[68:71], v[188:191]
v_exp_f32 v49, v49
v_mfma_f32_16x16x32_bf16 a[132:135], a[144:147], v[68:71], a[132:135]
v_mul_f32 v156, v32, v156
v_cvt_pk_bf16_f32 v88, v48, v49
v_mfma_f32_16x16x32_bf16 a[136:139], a[144:147], v[72:75], a[136:139]
v_exp_f32 v50, v50
v_exp_f32 v51, v51
v_mul_f32 v157, v32, v157
v_mul_f32 v158, v32, v158
v_mfma_f32_16x16x32_bf16 a[140:143], a[144:147], v[76:79], a[140:143]
s_waitcnt lgkmcnt(6)
v_cvt_pk_bf16_f32 v89, v50, v51
v_mul_f32 v159, v32, v159
v_mfma_f32_16x16x32_bf16 v[48:51], a[64:67], a[32:35], v[120:123]
v_cvt_pk_bf16_f32 v152, v152, v153
v_cvt_pk_bf16_f32 v153, v154, v155
v_mfma_f32_16x16x32_bf16 v[48:51], a[68:71], a[36:39], v[48:51]
s_waitcnt lgkmcnt(4)
v_exp_f32 v52, v52
v_exp_f32 v53, v53
v_cvt_pk_bf16_f32 v154, v156, v157
v_mfma_f32_16x16x32_bf16 v[48:51], a[72:75], a[40:43], v[48:51]
v_cvt_pk_bf16_f32 v90, v52, v53
v_exp_f32 v54, v54
v_exp_f32 v55, v55
v_cvt_pk_bf16_f32 v155, v158, v159
v_mfma_f32_16x16x32_bf16 v[48:51], a[76:79], a[44:47], v[48:51]
s_waitcnt lgkmcnt(2)
buffer_store_dwordx4 v[152:155], v1, s[4:7], s55 offen offset:3072 sc1
v_cvt_pk_bf16_f32 v91, v54, v55
v_mfma_f32_16x16x32_bf16 v[52:55], a[92:95], a[44:47], v[124:127]
v_exp_f32 v56, v56
v_mfma_f32_16x16x32_bf16 v[52:55], a[88:91], a[40:43], v[52:55]
s_waitcnt lgkmcnt(0)
v_exp_f32 v57, v57
v_accvgpr_read_b32 v40, a132
s_mov_b32 s76, 0x21800000
v_cmp_nle_f32_e64 s[94:95], s76, v40
s_mov_b32 s76, 0x5d800000
v_cmp_nge_f32 vcc, s76, v40
s_or_b64 vcc, vcc, s[94:95]
s_cbranch_scc1 L_slow1Y
L_back_slow1Y:
v_mfma_f32_16x16x32_bf16 v[52:55], a[84:87], a[36:39], v[52:55]
buffer_load_dwordx4 v1, s[4:7], s90 offen offset:1024 sc1 lds
v_cvt_pk_bf16_f32 v92, v56, v57
v_exp_f32 v58, v58
v_exp_f32 v59, v59
v_accvgpr_read_b32 v40, a132
v_rcp_f32 v40, v40
s_nop 0
v_mfma_f32_16x16x32_bf16 v[52:55], a[80:83], a[32:35], v[52:55]
v_cvt_pk_bf16_f32 v93, v58, v59
v_mul_f32 v160, v40, v160
v_mul_f32 v161, v40, v161
v_mfma_f32_16x16x32_bf16 v[56:59], a[64:67], a[48:51], v[108:111]
v_mul_f32 v162, v40, v162
v_mul_f32 v163, v40, v163
v_mfma_f32_16x16x32_bf16 v[56:59], a[68:71], a[52:55], v[56:59]
ds_read_b128 a[96:99], v26 offset:24576
v_exp_f32 v60, v60
v_exp_f32 v61, v61
v_mul_f32 v164, v40, v164
v_mul_f32 v165, v40, v165
v_mfma_f32_16x16x32_bf16 v[56:59], a[72:75], a[56:59], v[56:59]
v_cvt_pk_bf16_f32 v94, v60, v61
v_exp_f32 v62, v62
v_exp_f32 v63, v63
v_mul_f32 v166, v40, v166
v_mul_f32 v167, v40, v167
v_mfma_f32_16x16x32_bf16 v[56:59], a[76:79], a[60:63], v[56:59]
ds_read_b128 a[100:103], v26 offset:25600
v_cvt_pk_bf16_f32 v95, v62, v63
v_cvt_pk_bf16_f32 v160, v160, v161
v_cvt_pk_bf16_f32 v161, v162, v163
v_mfma_f32_16x16x32_bf16 v[60:63], a[92:95], a[60:63], v[108:111]
v_cvt_pk_bf16_f32 v162, v164, v165
v_cvt_pk_bf16_f32 v163, v166, v167
v_mfma_f32_16x16x32_bf16 v[60:63], a[88:91], a[56:59], v[60:63]
ds_read_b128 a[104:107], v26 offset:26624
buffer_store_dwordx4 v[160:163], v1, s[4:7], s56 offen sc1
v_mul_f32 v168, v40, v168
v_mfma_f32_16x16x32_bf16 v[60:63], a[84:87], a[52:55], v[60:63]
v_mul_f32 v169, v40, v169
v_mul_f32 v170, v40, v170
v_mfma_f32_16x16x32_bf16 v[60:63], a[80:83], a[48:51], v[60:63]
s_waitcnt lgkmcnt(2)
ds_read_b128 a[108:111], v26 offset:27648
buffer_load_dwordx4 v1, s[4:7], s90 offen offset:2048 sc1 lds
v_mul_f32 v171, v40, v171
v_mul_f32 v172, v40, v172
v_mfma_f32_16x16x32_bf16 v[192:195], a[96:99], v[88:91], v[192:195]
v_mul_f32 v173, v40, v173
v_mul_f32 v174, v40, v174
v_mfma_f32_16x16x32_bf16 v[224:227], a[96:99], v[92:95], v[224:227]
s_waitcnt lgkmcnt(2)
ds_read_b128 a[112:115], v26 offset:28672
v_mul_f32 v175, v40, v175
v_cvt_pk_bf16_f32 v168, v168, v169
v_mfma_f32_16x16x32_bf16 v[228:231], a[100:103], v[92:95], v[228:231]
v_cvt_pk_bf16_f32 v169, v170, v171
v_cvt_pk_bf16_f32 v170, v172, v173
v_mfma_f32_16x16x32_bf16 v[196:199], a[100:103], v[88:91], v[196:199]
s_waitcnt lgkmcnt(2)
ds_read_b128 a[116:119], v26 offset:29696
v_cvt_pk_bf16_f32 v171, v174, v175
buffer_store_dwordx4 v[168:171], v1, s[4:7], s56 offen offset:1024 sc1
v_mfma_f32_16x16x32_bf16 v[200:203], a[104:107], v[88:91], v[200:203]
v_mul_f32 v176, v40, v176
v_mul_f32 v177, v40, v177
v_mfma_f32_16x16x32_bf16 v[232:235], a[104:107], v[92:95], v[232:235]
s_waitcnt lgkmcnt(2)
ds_read_b128 a[120:123], v26 offset:30720
v_mul_f32 v178, v40, v178
v_mul_f32 v179, v40, v179
v_mfma_f32_16x16x32_bf16 v[236:239], a[108:111], v[92:95], v[236:239]
v_mul_f32 v180, v40, v180
v_mul_f32 v181, v40, v181
v_mfma_f32_16x16x32_bf16 v[204:207], a[108:111], v[88:91], v[204:207]
s_waitcnt lgkmcnt(2)
ds_read_b128 a[124:127], v26 offset:31744
buffer_load_dwordx4 v1, s[4:7], s90 offen offset:3072 sc1 lds
v_mul_f32 v182, v40, v182
v_mul_f32 v183, v40, v183
v_mfma_f32_16x16x32_bf16 v[208:211], a[112:115], v[88:91], v[208:211]
s_add_u32 s90, s90, 0x4000
v_cvt_pk_bf16_f32 v176, v176, v177
v_cvt_pk_bf16_f32 v177, v178, v179
v_mfma_f32_16x16x32_bf16 v[240:243], a[112:115], v[92:95], v[240:243]
s_waitcnt lgkmcnt(2)
v_cvt_pk_bf16_f32 v178, v180, v181
v_cvt_pk_bf16_f32 v179, v182, v183
v_mfma_f32_16x16x32_bf16 v[244:247], a[116:119], v[92:95], v[244:247]
buffer_store_dwordx4 v[176:179], v1, s[4:7], s56 offen offset:2048 sc1
v_mul_f32 v184, v40, v184
v_mfma_f32_16x16x32_bf16 v[212:215], a[116:119], v[88:91], v[212:215]
s_waitcnt lgkmcnt(1)
ds_read_b128 a[64:67], v26 offset:8192
v_exp_f32 v48, v48
v_exp_f32 v49, v49
v_mul_f32 v185, v40, v185
v_mul_f32 v186, v40, v186
v_mfma_f32_16x16x32_bf16 v[216:219], a[120:123], v[88:91], v[216:219]
ds_read_b128 a[68:71], v26 offset:9216
v_cvt_pk_bf16_f32 v72, v48, v49
v_exp_f32 v50, v50
v_exp_f32 v51, v51
v_mul_f32 v187, v40, v187
v_mul_f32 v188, v40, v188
v_mfma_f32_16x16x32_bf16 v[248:251], a[120:123], v[92:95], v[248:251]
s_waitcnt lgkmcnt(2)
ds_read_b128 a[72:75], v26 offset:10240
v_cvt_pk_bf16_f32 v73, v50, v51
v_exp_f32 v52, v52
v_exp_f32 v53, v53
v_mul_f32 v189, v40, v189
v_mul_f32 v190, v40, v190
v_mfma_f32_16x16x32_bf16 v[252:255], a[124:127], v[92:95], v[252:255]
s_add_u32 s91, s91, 0x8000
ds_read_b128 a[76:79], v26 offset:11264
ds_read_b128 a[92:95], v26 offset:15360
ds_read_b128 a[88:91], v26 offset:14336
ds_read_b128 a[84:87], v26 offset:13312
ds_read_b128 a[80:83], v26 offset:12288
v_cvt_pk_bf16_f32 v74, v52, v53
v_exp_f32 v54, v54
v_exp_f32 v55, v55
v_mul_f32 v191, v40, v191
v_cvt_pk_bf16_f32 v184, v184, v185
v_mfma_f32_16x16x32_bf16 v[220:223], a[124:127], v[88:91], v[220:223]
s_and_b32 s91, s91, 0x18000
v_cvt_pk_bf16_f32 v75, v54, v55
v_exp_f32 v56, v56
v_exp_f32 v57, v57
v_cvt_pk_bf16_f32 v185, v186, v187
v_cvt_pk_bf16_f32 v186, v188, v189
s_waitcnt vmcnt(15)
s_barrier
v_mfma_f32_16x16x32_bf16 a[136:139], a[144:147], v[88:91], a[136:139]
v_cvt_pk_bf16_f32 v76, v56, v57
v_exp_f32 v58, v58
v_exp_f32 v59, v59
v_cvt_pk_bf16_f32 v187, v190, v191
buffer_store_dwordx4 v[184:187], v1, s[4:7], s56 offen offset:3072 sc1
v_mfma_f32_16x16x32_bf16 a[140:143], a[144:147], v[92:95], a[140:143]
s_nop 0
v_cndmask_b32_e64 v112, v104, v29, s[80:81]
v_cndmask_b32_e64 v113, v104, v29, s[82:83]
v_cmp_gt_i32_e64 s[80:81], 2, v27
v_cmp_gt_i32_e64 s[82:83], 3, v27
s_nop 0
v_cndmask_b32_e64 v114, v104, v29, s[80:81]
v_cndmask_b32_e64 v115, v104, v29, s[82:83]
v_cmp_gt_i32_e64 s[80:81], 16, v27
v_cmp_gt_i32_e64 s[82:83], 17, v27
s_nop 0
v_cndmask_b32_e64 v116, v104, v29, s[80:81]
v_cndmask_b32_e64 v117, v104, v29, s[82:83]
v_cmp_gt_i32_e64 s[80:81], 18, v27
v_cmp_gt_i32_e64 s[82:83], 19, v27
s_nop 0
v_cndmask_b32_e64 v118, v104, v29, s[80:81]
v_cndmask_b32_e64 v119, v104, v29, s[82:83]
v_cvt_pk_bf16_f32 v77, v58, v59
v_add_u32 v26, s91, v2
L_single_entry:
s_lshl_b32 s63, s50, 3
s_add_u32 s63, s63, s51
s_lshl_b32 s63, s63, 3
s_add_u32 s63, s63, s48
s_lshl_b32 s63, s63, 2
s_add_u32 s63, s63, s52
s_lshl_b32 s63, s63, 2
s_add_u32 s63, s63, 0x5003000
s_cmp_eq_u32 s88, 0
s_cbranch_scc1 L_catch
s_sub_u32 s88, s88, 4
s_cmp_eq_u32 s88, 0
s_cbranch_scc1 L_peel
.p2align 6
L_single:
s_waitcnt lgkmcnt(4)
v_mfma_f32_16x16x32_bf16 v[48:51], a[64:67], a[32:35], v[104:107]
s_sub_u32 s72, s72, 1
s_cbranch_scc1 L_fv13
L_back_fv13:
v_exp_f32 v60, v60
v_mfma_f32_16x16x32_bf16 v[48:51], a[68:71], a[36:39], v[48:51]
s_xor_b32 s75, s91, 0x10000
ds_read_b128 a[96:99], v26 offset:16384
v_mfma_f32_16x16x32_bf16 v[48:51], a[72:75], a[40:43], v[48:51]
s_add_u32 m0, s75, s59
v_exp_f32 v61, v61
v_mfma_f32_16x16x32_bf16 v[48:51], a[76:79], a[44:47], v[48:51]
s_waitcnt lgkmcnt(1)
ds_read_b128 a[100:103], v26 offset:17408
v_cvt_pk_bf16_f32 v78, v60, v61
v_mfma_f32_16x16x32_bf16 v[52:55], a[92:95], a[44:47], v[104:107]
v_exp_f32 v62, v62
v_mfma_f32_16x16x32_bf16 v[52:55], a[88:91], a[40:43], v[52:55]
ds_read_b128 a[104:107], v26 offset:18432
buffer_load_dwordx4 v1, s[4:7], s89 offen sc1 lds
v_mfma_f32_16x16x32_bf16 v[52:55], a[84:87], a[36:39], v[52:55]
v_exp_f32 v63, v63
v_mfma_f32_16x16x32_bf16 v[52:55], a[80:83], a[32:35], v[52:55]
ds_read_b128 a[108:111], v26 offset:19456
v_cvt_pk_bf16_f32 v79, v62, v63
v_mfma_f32_16x16x32_bf16 v[56:59], a[64:67], a[48:51], v[108:111]
v_exp_f32 v48, v48
v_mfma_f32_16x16x32_bf16 v[56:59], a[68:71], a[52:55], v[56:59]
ds_read_b128 a[112:115], v26 offset:20480
v_mfma_f32_16x16x32_bf16 v[56:59], a[72:75], a[56:59], v[56:59]
v_exp_f32 v49, v49
v_mfma_f32_16x16x32_bf16 v[56:59], a[76:79], a[60:63], v[56:59]
ds_read_b128 a[116:119], v26 offset:21504
v_cvt_pk_bf16_f32 v88, v48, v49
v_mfma_f32_16x16x32_bf16 v[60:63], a[92:95], a[60:63], v[108:111]
v_exp_f32 v50, v50
v_mfma_f32_16x16x32_bf16 v[60:63], a[88:91], a[56:59], v[60:63]
ds_read_b128 a[120:123], v26 offset:22528
buffer_load_dwordx4 v1, s[4:7], s89 offen offset:1024 sc1 lds
v_mfma_f32_16x16x32_bf16 v[60:63], a[84:87], a[52:55], v[60:63]
v_exp_f32 v51, v51
v_mfma_f32_16x16x32_bf16 v[60:63], a[80:83], a[48:51], v[60:63]
s_waitcnt lgkmcnt(5)
ds_read_b128 a[124:127], v26 offset:23552
v_cvt_pk_bf16_f32 v89, v50, v51
v_mfma_f32_16x16x32_bf16 v[192:195], a[96:99], v[72:75], v[192:195]
v_exp_f32 v52, v52
v_mfma_f32_16x16x32_bf16 v[224:227], a[96:99], v[76:79], v[224:227]
ds_read_b128 a[64:67], v26
v_mfma_f32_16x16x32_bf16 v[228:231], a[100:103], v[76:79], v[228:231]
v_exp_f32 v53, v53
v_mfma_f32_16x16x32_bf16 v[196:199], a[100:103], v[72:75], v[196:199]
s_waitcnt lgkmcnt(5)
ds_read_b128 a[68:71], v26 offset:1024
v_cvt_pk_bf16_f32 v90, v52, v53
v_mfma_f32_16x16x32_bf16 v[200:203], a[104:107], v[72:75], v[200:203]
v_exp_f32 v54, v54
v_mfma_f32_16x16x32_bf16 v[232:235], a[104:107], v[76:79], v[232:235]
ds_read_b128 a[72:75], v26 offset:2048
buffer_load_dwordx4 v1, s[4:7], s89 offen offset:2048 sc1 lds
v_mfma_f32_16x16x32_bf16 v[236:239], a[108:111], v[76:79], v[236:239]
v_exp_f32 v55, v55
v_mfma_f32_16x16x32_bf16 v[204:207], a[108:111], v[72:75], v[204:207]
s_waitcnt lgkmcnt(5)
ds_read_b128 a[76:79], v26 offset:3072
v_cvt_pk_bf16_f32 v91, v54, v55
v_mfma_f32_16x16x32_bf16 v[208:211], a[112:115], v[72:75], v[208:211]
v_exp_f32 v56, v56
v_mfma_f32_16x16x32_bf16 v[240:243], a[112:115], v[76:79], v[240:243]
ds_read_b128 a[92:95], v26 offset:7168
v_mfma_f32_16x16x32_bf16 v[244:247], a[116:119], v[76:79], v[244:247]
v_exp_f32 v57, v57
v_mfma_f32_16x16x32_bf16 v[212:215], a[116:119], v[72:75], v[212:215]
s_waitcnt lgkmcnt(5)
ds_read_b128 a[88:91], v26 offset:6144
v_cvt_pk_bf16_f32 v92, v56, v57
v_mfma_f32_16x16x32_bf16 v[216:219], a[120:123], v[72:75], v[216:219]
v_exp_f32 v58, v58
v_mfma_f32_16x16x32_bf16 v[248:251], a[120:123], v[76:79], v[248:251]
ds_read_b128 a[84:87], v26 offset:5120
buffer_load_dwordx4 v1, s[4:7], s89 offen offset:3072 sc1 lds
s_add_u32 s89, s89, 0x4000
v_mfma_f32_16x16x32_bf16 v[252:255], a[124:127], v[76:79], v[252:255]
v_exp_f32 v59, v59
v_mfma_f32_16x16x32_bf16 v[220:223], a[124:127], v[72:75], v[220:223]
ds_read_b128 a[80:83], v26 offset:4096
v_cvt_pk_bf16_f32 v93, v58, v59
v_mfma_f32_16x16x32_bf16 a[136:139], a[144:147], v[72:75], a[136:139]
v_mfma_f32_16x16x32_bf16 a[140:143], a[144:147], v[76:79], a[140:143]
s_waitcnt lgkmcnt(4)
v_mfma_f32_16x16x32_bf16 v[48:51], a[64:67], a[32:35], v[120:123]
v_exp_f32 v60, v60
v_mfma_f32_16x16x32_bf16 v[48:51], a[68:71], a[36:39], v[48:51]
ds_read_b128 a[96:99], v26 offset:24576
v_mfma_f32_16x16x32_bf16 v[48:51], a[72:75], a[40:43], v[48:51]
s_add_u32 m0, m0, 0x4000
v_exp_f32 v61, v61
v_mfma_f32_16x16x32_bf16 v[48:51], a[76:79], a[44:47], v[48:51]
s_waitcnt lgkmcnt(2)
ds_read_b128 a[100:103], v26 offset:25600
v_cvt_pk_bf16_f32 v94, v60, v61
v_mfma_f32_16x16x32_bf16 v[52:55], a[92:95], a[44:47], v[124:127]
v_exp_f32 v62, v62
v_mfma_f32_16x16x32_bf16 v[52:55], a[88:91], a[40:43], v[52:55]
ds_read_b128 a[104:107], v26 offset:26624
buffer_load_dwordx4 v1, s[4:7], s90 offen sc1 lds
v_mfma_f32_16x16x32_bf16 v[52:55], a[84:87], a[36:39], v[52:55]
s_waitcnt lgkmcnt(3)
v_exp_f32 v63, v63
v_mfma_f32_16x16x32_bf16 v[52:55], a[80:83], a[32:35], v[52:55]
ds_read_b128 a[108:111], v26 offset:27648
v_cvt_pk_bf16_f32 v95, v62, v63
v_mfma_f32_16x16x32_bf16 v[56:59], a[64:67], a[48:51], v[108:111]
v_exp_f32 v48, v48
v_mfma_f32_16x16x32_bf16 v[56:59], a[68:71], a[52:55], v[56:59]
ds_read_b128 a[112:115], v26 offset:28672
v_mfma_f32_16x16x32_bf16 v[56:59], a[72:75], a[56:59], v[56:59]
v_exp_f32 v49, v49
v_mfma_f32_16x16x32_bf16 v[56:59], a[76:79], a[60:63], v[56:59]
ds_read_b128 a[116:119], v26 offset:29696
v_cvt_pk_bf16_f32 v72, v48, v49
v_mfma_f32_16x16x32_bf16 v[60:63], a[92:95], a[60:63], v[108:111]
v_exp_f32 v50, v50
v_mfma_f32_16x16x32_bf16 v[60:63], a[88:91], a[56:59], v[60:63]
ds_read_b128 a[120:123], v26 offset:30720
buffer_load_dwordx4 v1, s[4:7], s90 offen offset:1024 sc1 lds
v_mfma_f32_16x16x32_bf16 v[60:63], a[84:87], a[52:55], v[60:63]
v_exp_f32 v51, v51
v_mfma_f32_16x16x32_bf16 v[60:63], a[80:83], a[48:51], v[60:63]
s_waitcnt lgkmcnt(5)
ds_read_b128 a[124:127], v26 offset:31744
v_cvt_pk_bf16_f32 v73, v50, v51
v_mfma_f32_16x16x32_bf16 v[192:195], a[96:99], v[88:91], v[192:195]
v_exp_f32 v52, v52
v_mfma_f32_16x16x32_bf16 v[224:227], a[96:99], v[92:95], v[224:227]
ds_read_b128 a[64:67], v26 offset:8192
v_mfma_f32_16x16x32_bf16 v[228:231], a[100:103], v[92:95], v[228:231]
v_exp_f32 v53, v53
v_mfma_f32_16x16x32_bf16 v[196:199], a[100:103], v[88:91], v[196:199]
s_waitcnt lgkmcnt(5)
ds_read_b128 a[68:71], v26 offset:9216
v_cvt_pk_bf16_f32 v74, v52, v53
v_mfma_f32_16x16x32_bf16 v[200:203], a[104:107], v[88:91], v[200:203]
v_exp_f32 v54, v54
v_mfma_f32_16x16x32_bf16 v[232:235], a[104:107], v[92:95], v[232:235]
ds_read_b128 a[72:75], v26 offset:10240
buffer_load_dwordx4 v1, s[4:7], s90 offen offset:2048 sc1 lds
v_mfma_f32_16x16x32_bf16 v[236:239], a[108:111], v[92:95], v[236:239]
v_exp_f32 v55, v55
v_mfma_f32_16x16x32_bf16 v[204:207], a[108:111], v[88:91], v[204:207]
s_waitcnt lgkmcnt(5)
ds_read_b128 a[76:79], v26 offset:11264
v_cvt_pk_bf16_f32 v75, v54, v55
v_mfma_f32_16x16x32_bf16 v[208:211], a[112:115], v[88:91], v[208:211]
v_exp_f32 v56, v56
v_mfma_f32_16x16x32_bf16 v[240:243], a[112:115], v[92:95], v[240:243]
ds_read_b128 a[92:95], v26 offset:15360
v_mfma_f32_16x16x32_bf16 v[244:247], a[116:119], v[92:95], v[244:247]
v_exp_f32 v57, v57
v_mfma_f32_16x16x32_bf16 v[212:215], a[116:119], v[88:91], v[212:215]
s_waitcnt lgkmcnt(5)
ds_read_b128 a[88:91], v26 offset:14336
v_cvt_pk_bf16_f32 v76, v56, v57
v_mfma_f32_16x16x32_bf16 v[216:219], a[120:123], v[88:91], v[216:219]
s_add_u32 s91, s91, 0x8000
v_exp_f32 v58, v58
v_mfma_f32_16x16x32_bf16 v[248:251], a[120:123], v[92:95], v[248:251]
s_and_b32 s91, s91, 0x18000
ds_read_b128 a[84:87], v26 offset:13312
buffer_load_dwordx4 v1, s[4:7], s90 offen offset:3072 sc1 lds
v_mfma_f32_16x16x32_bf16 v[252:255], a[124:127], v[92:95], v[252:255]
s_add_u32 s90, s90, 0x4000
v_exp_f32 v59, v59
v_mfma_f32_16x16x32_bf16 v[220:223], a[124:127], v[88:91], v[220:223]
ds_read_b128 a[80:83], v26 offset:12288
v_cvt_pk_bf16_f32 v77, v58, v59
v_mfma_f32_16x16x32_bf16 a[136:139], a[144:147], v[88:91], a[136:139]
s_waitcnt vmcnt(8)
s_barrier
v_mfma_f32_16x16x32_bf16 a[140:143], a[144:147], v[92:95], a[140:143]
s_waitcnt lgkmcnt(4)
buffer_store_dword v18, v20, s[4:7], s63 offen sc1
v_add_u32 v26, s91, v2
v_mfma_f32_16x16x32_bf16 v[48:51], a[64:67], a[32:35], v[104:107]
s_sub_u32 s72, s72, 1
s_cbranch_scc1 L_fv14
L_back_fv14:
v_exp_f32 v60, v60
v_mfma_f32_16x16x32_bf16 v[48:51], a[68:71], a[36:39], v[48:51]
s_xor_b32 s75, s91, 0x10000
ds_read_b128 a[96:99], v26 offset:16384
v_mfma_f32_16x16x32_bf16 v[48:51], a[72:75], a[40:43], v[48:51]
s_add_u32 m0, s75, s59
v_exp_f32 v61, v61
v_mfma_f32_16x16x32_bf16 v[48:51], a[76:79], a[44:47], v[48:51]
s_waitcnt lgkmcnt(2)
ds_read_b128 a[100:103], v26 offset:17408
v_cvt_pk_bf16_f32 v78, v60, v61
v_mfma_f32_16x16x32_bf16 v[52:55], a[92:95], a[44:47], v[104:107]
v_exp_f32 v62, v62
v_mfma_f32_16x16x32_bf16 v[52:55], a[88:91], a[40:43], v[52:55]
ds_read_b128 a[104:107], v26 offset:18432
buffer_load_dwordx4 v1, s[4:7], s89 offen sc1 lds
v_mfma_f32_16x16x32_bf16 v[52:55], a[84:87], a[36:39], v[52:55]
s_waitcnt lgkmcnt(3)
v_exp_f32 v63, v63
v_mfma_f32_16x16x32_bf16 v[52:55], a[80:83], a[32:35], v[52:55]
ds_read_b128 a[108:111], v26 offset:19456
v_cvt_pk_bf16_f32 v79, v62, v63
v_mfma_f32_16x16x32_bf16 v[56:59], a[64:67], a[48:51], v[108:111]
v_exp_f32 v48, v48
v_mfma_f32_16x16x32_bf16 v[56:59], a[68:71], a[52:55], v[56:59]
ds_read_b128 a[112:115], v26 offset:20480
v_mfma_f32_16x16x32_bf16 v[56:59], a[72:75], a[56:59], v[56:59]
v_exp_f32 v49, v49
v_mfma_f32_16x16x32_bf16 v[56:59], a[76:79], a[60:63], v[56:59]
ds_read_b128 a[116:119], v26 offset:21504
v_cvt_pk_bf16_f32 v88, v48, v49
v_mfma_f32_16x16x32_bf16 v[60:63], a[92:95], a[60:63], v[108:111]
v_exp_f32 v50, v50
v_mfma_f32_16x16x32_bf16 v[60:63], a[88:91], a[56:59], v[60:63]
ds_read_b128 a[120:123], v26 offset:22528
buffer_load_dwordx4 v1, s[4:7], s89 offen offset:1024 sc1 lds
v_mfma_f32_16x16x32_bf16 v[60:63], a[84:87], a[52:55], v[60:63]
v_exp_f32 v51, v51
v_mfma_f32_16x16x32_bf16 v[60:63], a[80:83], a[48:51], v[60:63]
s_waitcnt lgkmcnt(5)
ds_read_b128 a[124:127], v26 offset:23552
v_cvt_pk_bf16_f32 v89, v50, v51
v_mfma_f32_16x16x32_bf16 v[192:195], a[96:99], v[72:75], v[192:195]
v_exp_f32 v52, v52
v_mfma_f32_16x16x32_bf16 v[224:227], a[96:99], v[76:79], v[224:227]
ds_read_b128 a[64:67], v26
v_mfma_f32_16x16x32_bf16 v[228:231], a[100:103], v[76:79], v[228:231]
v_exp_f32 v53, v53
v_mfma_f32_16x16x32_bf16 v[196:199], a[100:103], v[72:75], v[196:199]
s_waitcnt lgkmcnt(5)
ds_read_b128 a[68:71], v26 offset:1024
v_cvt_pk_bf16_f32 v90, v52, v53
v_mfma_f32_16x16x32_bf16 v[200:203], a[104:107], v[72:75], v[200:203]
v_exp_f32 v54, v54
v_mfma_f32_16x16x32_bf16 v[232:235], a[104:107], v[76:79], v[232:235]
ds_read_b128 a[72:75], v26 offset:2048
buffer_load_dwordx4 v1, s[4:7], s89 offen offset:2048 sc1 lds
v_mfma_f32_16x16x32_bf16 v[236:239], a[108:111], v[76:79], v[236:239]
v_exp_f32 v55, v55
v_mfma_f32_16x16x32_bf16 v[204:207], a[108:111], v[72:75], v[204:207]
s_waitcnt lgkmcnt(5)
ds_read_b128 a[76:79], v26 offset:3072
v_cvt_pk_bf16_f32 v91, v54, v55
v_mfma_f32_16x16x32_bf16 v[208:211], a[112:115], v[72:75], v[208:211]
v_exp_f32 v56, v56
v_mfma_f32_16x16x32_bf16 v[240:243], a[112:115], v[76:79], v[240:243]
ds_read_b128 a[92:95], v26 offset:7168
v_mfma_f32_16x16x32_bf16 v[244:247], a[116:119], v[76:79], v[244:247]
v_exp_f32 v57, v57
v_mfma_f32_16x16x32_bf16 v[212:215], a[116:119], v[72:75], v[212:215]
s_waitcnt lgkmcnt(5)
ds_read_b128 a[88:91], v26 offset:6144
v_cvt_pk_bf16_f32 v92, v56, v57
v_mfma_f32_16x16x32_bf16 v[216:219], a[120:123], v[72:75], v[216:219]
v_exp_f32 v58, v58
v_mfma_f32_16x16x32_bf16 v[248:251], a[120:123], v[76:79], v[248:251]
ds_read_b128 a[84:87], v26 offset:5120
buffer_load_dwordx4 v1, s[4:7], s89 offen offset:3072 sc1 lds
s_add_u32 s89, s89, 0x4000
v_mfma_f32_16x16x32_bf16 v[252:255], a[124:127], v[76:79], v[252:255]
v_exp_f32 v59, v59
v_mfma_f32_16x16x32_bf16 v[220:223], a[124:127], v[72:75], v[220:223]
ds_read_b128 a[80:83], v26 offset:4096
v_cvt_pk_bf16_f32 v93, v58, v59
v_mfma_f32_16x16x32_bf16 a[136:139], a[144:147], v[72:75], a[136:139]
v_mfma_f32_16x16x32_bf16 a[140:143], a[144:147], v[76:79], a[140:143]
s_waitcnt lgkmcnt(4)
v_mfma_f32_16x16x32_bf16 v[48:51], a[64:67], a[32:35], v[120:123]
v_exp_f32 v60, v60
v_mfma_f32_16x16x32_bf16 v[48:51], a[68:71], a[36:39], v[48:51]
ds_read_b128 a[96:99], v26 offset:24576
v_mfma_f32_16x16x32_bf16 v[48:51], a[72:75], a[40:43], v[48:51]
s_add_u32 m0, m0, 0x4000
v_exp_f32 v61, v61
v_mfma_f32_16x16x32_bf16 v[48:51], a[76:79], a[44:47], v[48:51]
s_waitcnt lgkmcnt(2)
ds_read_b128 a[100:103], v26 offset:25600
v_cvt_pk_bf16_f32 v94, v60, v61
v_mfma_f32_16x16x32_bf16 v[52:55], a[92:95], a[44:47], v[124:127]
v_exp_f32 v62, v62
v_mfma_f32_16x16x32_bf16 v[52:55], a[88:91], a[40:43], v[52:55]
ds_read_b128 a[104:107], v26 offset:26624
buffer_load_dwordx4 v1, s[4:7], s90 offen sc1 lds
v_mfma_f32_16x16x32_bf16 v[52:55], a[84:87], a[36:39], v[52:55]
s_waitcnt lgkmcnt(3)
v_exp_f32 v63, v63
v_mfma_f32_16x16x32_bf16 v[52:55], a[80:83], a[32:35], v[52:55]
ds_read_b128 a[108:111], v26 offset:27648
v_cvt_pk_bf16_f32 v95, v62, v63
v_mfma_f32_16x16x32_bf16 v[56:59], a[64:67], a[48:51], v[108:111]
v_exp_f32 v48, v48
v_mfma_f32_16x16x32_bf16 v[56:59], a[68:71], a[52:55], v[56:59]
ds_read_b128 a[112:115], v26 offset:28672
v_mfma_f32_16x16x32_bf16 v[56:59], a[72:75], a[56:59], v[56:59]
v_exp_f32 v49, v49
v_mfma_f32_16x16x32_bf16 v[56:59], a[76:79], a[60:63], v[56:59]
ds_read_b128 a[116:119], v26 offset:29696
v_cvt_pk_bf16_f32 v72, v48, v49
v_mfma_f32_16x16x32_bf16 v[60:63], a[92:95], a[60:63], v[108:111]
v_exp_f32 v50, v50
v_mfma_f32_16x16x32_bf16 v[60:63], a[88:91], a[56:59], v[60:63]
ds_read_b128 a[120:123], v26 offset:30720
buffer_load_dwordx4 v1, s[4:7], s90 offen offset:1024 sc1 lds
v_mfma_f32_16x16x32_bf16 v[60:63], a[84:87], a[52:55], v[60:63]
v_exp_f32 v51, v51
v_mfma_f32_16x16x32_bf16 v[60:63], a[80:83], a[48:51], v[60:63]
s_waitcnt lgkmcnt(5)
ds_read_b128 a[124:127], v26 offset:31744
v_cvt_pk_bf16_f32 v73, v50, v51
v_mfma_f32_16x16x32_bf16 v[192:195], a[96:99], v[88:91], v[192:195]
s_sub_u32 s88, s88, 2
v_exp_f32 v52, v52
v_mfma_f32_16x16x32_bf16 v[224:227], a[96:99], v[92:95], v[224:227]
ds_read_b128 a[64:67], v26 offset:8192
v_mfma_f32_16x16x32_bf16 v[228:231], a[100:103], v[92:95], v[228:231]
v_exp_f32 v53, v53
v_mfma_f32_16x16x32_bf16 v[196:199], a[100:103], v[88:91], v[196:199]
s_waitcnt lgkmcnt(5)
ds_read_b128 a[68:71], v26 offset:9216
v_cvt_pk_bf16_f32 v74, v52, v53
v_mfma_f32_16x16x32_bf16 v[200:203], a[104:107], v[88:91], v[200:203]
v_exp_f32 v54, v54
v_mfma_f32_16x16x32_bf16 v[232:235], a[104:107], v[92:95], v[232:235]
ds_read_b128 a[72:75], v26 offset:10240
buffer_load_dwordx4 v1, s[4:7], s90 offen offset:2048 sc1 lds
v_mfma_f32_16x16x32_bf16 v[236:239], a[108:111], v[92:95], v[236:239]
v_exp_f32 v55, v55
v_mfma_f32_16x16x32_bf16 v[204:207], a[108:111], v[88:91], v[204:207]
s_waitcnt lgkmcnt(5)
ds_read_b128 a[76:79], v26 offset:11264
v_cvt_pk_bf16_f32 v75, v54, v55
v_mfma_f32_16x16x32_bf16 v[208:211], a[112:115], v[88:91], v[208:211]
v_exp_f32 v56, v56
v_mfma_f32_16x16x32_bf16 v[240:243], a[112:115], v[92:95], v[240:243]
ds_read_b128 a[92:95], v26 offset:15360
v_mfma_f32_16x16x32_bf16 v[244:247], a[116:119], v[92:95], v[244:247]
v_exp_f32 v57, v57
v_mfma_f32_16x16x32_bf16 v[212:215], a[116:119], v[88:91], v[212:215]
s_waitcnt lgkmcnt(5)
ds_read_b128 a[88:91], v26 offset:14336
v_cvt_pk_bf16_f32 v76, v56, v57
v_mfma_f32_16x16x32_bf16 v[216:219], a[120:123], v[88:91], v[216:219]
s_add_u32 s91, s91, 0x8000
v_exp_f32 v58, v58
v_mfma_f32_16x16x32_bf16 v[248:251], a[120:123], v[92:95], v[248:251]
s_and_b32 s91, s91, 0x18000
ds_read_b128 a[84:87], v26 offset:13312
buffer_load_dwordx4 v1, s[4:7], s90 offen offset:3072 sc1 lds
v_mfma_f32_16x16x32_bf16 v[252:255], a[124:127], v[92:95], v[252:255]
s_add_u32 s90, s90, 0x4000
v_exp_f32 v59, v59
v_mfma_f32_16x16x32_bf16 v[220:223], a[124:127], v[88:91], v[220:223]
ds_read_b128 a[80:83], v26 offset:12288
v_cvt_pk_bf16_f32 v77, v58, v59
v_mfma_f32_16x16x32_bf16 a[136:139], a[144:147], v[88:91], a[136:139]
s_waitcnt vmcnt(9)
s_barrier
v_mfma_f32_16x16x32_bf16 a[140:143], a[144:147], v[92:95], a[140:143]
v_add_u32 v26, s91, v2
s_cmp_lg_u32 s88, 0
s_cbranch_scc1 L_single
L_peel:
s_waitcnt lgkmcnt(4)
v_mfma_f32_16x16x32_bf16 v[48:51], a[64:67], a[32:35], v[104:107]
s_sub_u32 s72, s72, 1
s_cbranch_scc1 L_fv15
L_back_fv15:
v_exp_f32 v60, v60
v_mfma_f32_16x16x32_bf16 v[48:51], a[68:71], a[36:39], v[48:51]
s_lshl_b32 s78, s53, 7
s_add_u32 s78, s78, 0x500a000
ds_read_b128 a[96:99], v26 offset:16384
v_mfma_f32_16x16x32_bf16 v[48:51], a[72:75], a[40:43], v[48:51]
s_xor_b32 s84, s91, 0x10000
v_exp_f32 v61, v61
v_mfma_f32_16x16x32_bf16 v[48:51], a[76:79], a[44:47], v[48:51]
s_waitcnt lgkmcnt(2)
buffer_load_dword v23, v21, s[4:7], s78 offen sc1
ds_read_b128 a[100:103], v26 offset:17408
v_cvt_pk_bf16_f32 v78, v60, v61
v_mfma_f32_16x16x32_bf16 v[52:55], a[92:95], a[44:47], v[104:107]
s_lshl_b32 s76, s50, 3
s_add_u32 s76, s76, s51
s_lshl_b32 s76, s76, 3
s_add_u32 s76, s76, s48
s_lshl_b32 s76, s76, 2
s_lshl_b32 s76, s76, 2
s_add_u32 s76, s76, 0x5003000
v_and_b32 v3, 12, v21
s_add_u32 s84, s84, s59
v_exp_f32 v62, v62
v_mfma_f32_16x16x32_bf16 v[52:55], a[88:91], a[40:43], v[52:55]
s_add_u32 m0, s84, 0
buffer_load_dword v19, v3, s[4:7], s76 offen sc1
ds_read_b128 a[104:107], v26 offset:18432
v_mfma_f32_16x16x32_bf16 v[52:55], a[84:87], a[36:39], v[52:55]
s_waitcnt lgkmcnt(3)
v_exp_f32 v63, v63
v_mfma_f32_16x16x32_bf16 v[52:55], a[80:83], a[32:35], v[52:55]
ds_read_b128 a[108:111], v26 offset:19456
v_cvt_pk_bf16_f32 v79, v62, v63
v_mfma_f32_16x16x32_bf16 v[56:59], a[64:67], a[48:51], v[108:111]
v_exp_f32 v48, v48
v_mfma_f32_16x16x32_bf16 v[56:59], a[68:71], a[52:55], v[56:59]
ds_read_b128 a[112:115], v26 offset:20480
buffer_load_dwordx4 v1, s[4:7], s89 offen sc1 lds
v_mfma_f32_16x16x32_bf16 v[56:59], a[72:75], a[56:59], v[56:59]
s_mul_i32 s64, s51, 0x90000
s_mul_i32 s70, s52, 0x120
s_add_u32 s64, s64, s70
s_add_u32 s70, s48, 0
s_lshr_b32 s71, s70, 2
s_add_u32 s71, s71, s52
s_and_b32 s71, s71, 3
s_lshl_b32 s71, s71, 2
s_and_b32 s70, s70, 3
s_add_u32 s70, s70, s71
s_mul_i32 s70, s70, 0x9000
s_add_u32 s85, s64, s70
s_mul_i32 s67, s48, 0x2400
s_cmp_lt_u32 s48, 3
s_cselect_b32 s67, s67, 0x28000
s_cselect_b32 s85, s85, 0x40000000
s_add_u32 m0, s67, 0
v_exp_f32 v49, v49
v_mfma_f32_16x16x32_bf16 v[56:59], a[76:79], a[60:63], v[56:59]
buffer_load_dwordx4 v4, s[32:35], s85 offen lds
ds_read_b128 a[116:119], v26 offset:21504
v_cvt_pk_bf16_f32 v88, v48, v49
v_mfma_f32_16x16x32_bf16 v[60:63], a[92:95], a[60:63], v[108:111]
s_add_u32 m0, s84, 0
v_exp_f32 v50, v50
v_mfma_f32_16x16x32_bf16 v[60:63], a[88:91], a[56:59], v[60:63]
ds_read_b128 a[120:123], v26 offset:22528
buffer_load_dwordx4 v1, s[4:7], s89 offen offset:1024 sc1 lds
v_mfma_f32_16x16x32_bf16 v[60:63], a[84:87], a[52:55], v[60:63]
s_waitcnt lgkmcnt(5)
v_exp_f32 v51, v51
v_mfma_f32_16x16x32_bf16 v[60:63], a[80:83], a[48:51], v[60:63]
s_add_u32 m0, s67, 0
ds_read_b128 a[124:127], v26 offset:23552
v_cvt_pk_bf16_f32 v89, v50, v51
v_mfma_f32_16x16x32_bf16 v[192:195], a[96:99], v[72:75], v[192:195]
v_exp_f32 v52, v52
v_mfma_f32_16x16x32_bf16 v[224:227], a[96:99], v[76:79], v[224:227]
ds_read_b128 a[64:67], v26
buffer_load_dwordx4 v5, s[32:35], s85 offen offset:1024 lds
v_mfma_f32_16x16x32_bf16 v[228:231], a[100:103], v[76:79], v[228:231]
v_exp_f32 v53, v53
v_mfma_f32_16x16x32_bf16 v[196:199], a[100:103], v[72:75], v[196:199]
s_waitcnt lgkmcnt(5)
ds_read_b128 a[68:71], v26 offset:1024
v_cvt_pk_bf16_f32 v90, v52, v53
v_mfma_f32_16x16x32_bf16 v[200:203], a[104:107], v[72:75], v[200:203]
s_add_u32 m0, s84, 0
v_exp_f32 v54, v54
v_mfma_f32_16x16x32_bf16 v[232:235], a[104:107], v[76:79], v[232:235]
ds_read_b128 a[72:75], v26 offset:2048
buffer_load_dwordx4 v1, s[4:7], s89 offen offset:2048 sc1 lds
v_mfma_f32_16x16x32_bf16 v[236:239], a[108:111], v[76:79], v[236:239]
v_exp_f32 v55, v55
v_mfma_f32_16x16x32_bf16 v[204:207], a[108:111], v[72:75], v[204:207]
s_waitcnt lgkmcnt(5)
ds_read_b128 a[76:79], v26 offset:3072
v_cvt_pk_bf16_f32 v91, v54, v55
v_mfma_f32_16x16x32_bf16 v[208:211], a[112:115], v[72:75], v[208:211]
s_add_u32 m0, s67, 0
v_exp_f32 v56, v56
v_mfma_f32_16x16x32_bf16 v[240:243], a[112:115], v[76:79], v[240:243]
ds_read_b128 a[92:95], v26 offset:7168
buffer_load_dwordx4 v6, s[32:35], s85 offen offset:2048 lds
v_mfma_f32_16x16x32_bf16 v[244:247], a[116:119], v[76:79], v[244:247]
v_exp_f32 v57, v57
v_mfma_f32_16x16x32_bf16 v[212:215], a[116:119], v[72:75], v[212:215]
s_waitcnt lgkmcnt(5)
ds_read_b128 a[88:91], v26 offset:6144
v_cvt_pk_bf16_f32 v92, v56, v57
v_mfma_f32_16x16x32_bf16 v[216:219], a[120:123], v[72:75], v[216:219]
s_add_u32 m0, s84, 0
v_exp_f32 v58, v58
v_mfma_f32_16x16x32_bf16 v[248:251], a[120:123], v[76:79], v[248:251]
ds_read_b128 a[84:87], v26 offset:5120
buffer_load_dwordx4 v1, s[4:7], s89 offen offset:3072 sc1 lds
s_add_u32 s89, s89, 0x4000
v_mfma_f32_16x16x32_bf16 v[252:255], a[124:127], v[76:79], v[252:255]
v_exp_f32 v59, v59
v_mfma_f32_16x16x32_bf16 v[220:223], a[124:127], v[72:75], v[220:223]
ds_read_b128 a[80:83], v26 offset:4096
v_cvt_pk_bf16_f32 v93, v58, v59
v_mfma_f32_16x16x32_bf16 a[136:139], a[144:147], v[72:75], a[136:139]
s_add_u32 m0, s67, 0
v_mfma_f32_16x16x32_bf16 a[140:143], a[144:147], v[76:79], a[140:143]
s_waitcnt lgkmcnt(4)
buffer_load_dwordx4 v7, s[32:35], s85 offen offset:3072 lds
v_mfma_f32_16x16x32_bf16 v[48:51], a[64:67], a[32:35], v[120:123]
v_exp_f32 v60, v60
v_mfma_f32_16x16x32_bf16 v[48:51], a[68:71], a[36:39], v[48:51]
ds_read_b128 a[96:99], v26 offset:24576
v_mfma_f32_16x16x32_bf16 v[48:51], a[72:75], a[40:43], v[48:51]
v_exp_f32 v61, v61
v_mfma_f32_16x16x32_bf16 v[48:51], a[76:79], a[44:47], v[48:51]
s_waitcnt lgkmcnt(2)
ds_read_b128 a[100:103], v26 offset:25600
v_cvt_pk_bf16_f32 v94, v60, v61
v_mfma_f32_16x16x32_bf16 v[52:55], a[92:95], a[44:47], v[124:127]
s_add_u32 m0, s84, 0x4000
v_exp_f32 v62, v62
v_mfma_f32_16x16x32_bf16 v[52:55], a[88:91], a[40:43], v[52:55]
ds_read_b128 a[104:107], v26 offset:26624
buffer_load_dwordx4 v1, s[4:7], s90 offen sc1 lds
v_mfma_f32_16x16x32_bf16 v[52:55], a[84:87], a[36:39], v[52:55]
s_waitcnt lgkmcnt(3)
v_exp_f32 v63, v63
v_mfma_f32_16x16x32_bf16 v[52:55], a[80:83], a[32:35], v[52:55]
s_add_u32 m0, s67, 0x1000
ds_read_b128 a[108:111], v26 offset:27648
v_cvt_pk_bf16_f32 v95, v62, v63
v_mfma_f32_16x16x32_bf16 v[56:59], a[64:67], a[48:51], v[108:111]
v_exp_f32 v48, v48
v_mfma_f32_16x16x32_bf16 v[56:59], a[68:71], a[52:55], v[56:59]
ds_read_b128 a[112:115], v26 offset:28672
buffer_load_dwordx4 v8, s[32:35], s85 offen lds
v_mfma_f32_16x16x32_bf16 v[56:59], a[72:75], a[56:59], v[56:59]
v_exp_f32 v49, v49
v_mfma_f32_16x16x32_bf16 v[56:59], a[76:79], a[60:63], v[56:59]
ds_read_b128 a[116:119], v26 offset:29696
v_cvt_pk_bf16_f32 v72, v48, v49
v_mfma_f32_16x16x32_bf16 v[60:63], a[92:95], a[60:63], v[108:111]
s_add_u32 m0, s84, 0x4000
v_exp_f32 v50, v50
v_mfma_f32_16x16x32_bf16 v[60:63], a[88:91], a[56:59], v[60:63]
ds_read_b128 a[120:123], v26 offset:30720
buffer_load_dwordx4 v1, s[4:7], s90 offen offset:1024 sc1 lds
v_mfma_f32_16x16x32_bf16 v[60:63], a[84:87], a[52:55], v[60:63]
s_waitcnt lgkmcnt(5)
v_exp_f32 v51, v51
v_mfma_f32_16x16x32_bf16 v[60:63], a[80:83], a[48:51], v[60:63]
s_add_u32 m0, s67, 0x1000
ds_read_b128 a[124:127], v26 offset:31744
v_cvt_pk_bf16_f32 v73, v50, v51
v_mfma_f32_16x16x32_bf16 v[192:195], a[96:99], v[88:91], v[192:195]
v_exp_f32 v52, v52
v_mfma_f32_16x16x32_bf16 v[224:227], a[96:99], v[92:95], v[224:227]
ds_read_b128 a[64:67], v26 offset:8192
buffer_load_dwordx4 v9, s[32:35], s85 offen offset:1024 lds
v_mfma_f32_16x16x32_bf16 v[228:231], a[100:103], v[92:95], v[228:231]
v_exp_f32 v53, v53
v_mfma_f32_16x16x32_bf16 v[196:199], a[100:103], v[88:91], v[196:199]
s_waitcnt lgkmcnt(5)
ds_read_b128 a[68:71], v26 offset:9216
v_cvt_pk_bf16_f32 v74, v52, v53
v_mfma_f32_16x16x32_bf16 v[200:203], a[104:107], v[88:91], v[200:203]
s_add_u32 m0, s84, 0x4000
v_exp_f32 v54, v54
v_mfma_f32_16x16x32_bf16 v[232:235], a[104:107], v[92:95], v[232:235]
ds_read_b128 a[72:75], v26 offset:10240
buffer_load_dwordx4 v1, s[4:7], s90 offen offset:2048 sc1 lds
v_mfma_f32_16x16x32_bf16 v[236:239], a[108:111], v[92:95], v[236:239]
v_exp_f32 v55, v55
v_mfma_f32_16x16x32_bf16 v[204:207], a[108:111], v[88:91], v[204:207]
s_waitcnt lgkmcnt(5)
ds_read_b128 a[76:79], v26 offset:11264
v_cvt_pk_bf16_f32 v75, v54, v55
v_mfma_f32_16x16x32_bf16 v[208:211], a[112:115], v[88:91], v[208:211]
s_add_u32 m0, s67, 0x1000
v_exp_f32 v56, v56
v_mfma_f32_16x16x32_bf16 v[240:243], a[112:115], v[92:95], v[240:243]
ds_read_b128 a[92:95], v26 offset:15360
buffer_load_dwordx4 v10, s[32:35], s85 offen offset:2048 lds
v_mfma_f32_16x16x32_bf16 v[244:247], a[116:119], v[92:95], v[244:247]
v_exp_f32 v57, v57
v_mfma_f32_16x16x32_bf16 v[212:215], a[116:119], v[88:91], v[212:215]
s_waitcnt lgkmcnt(5)
ds_read_b128 a[88:91], v26 offset:14336
v_cvt_pk_bf16_f32 v76, v56, v57
v_mfma_f32_16x16x32_bf16 v[216:219], a[120:123], v[88:91], v[216:219]
s_add_u32 m0, s84, 0x4000
v_exp_f32 v58, v58
v_mfma_f32_16x16x32_bf16 v[248:251], a[120:123], v[92:95], v[248:251]
s_add_u32 s91, s91, 0x8000
ds_read_b128 a[84:87], v26 offset:13312
buffer_load_dwordx4 v1, s[4:7], s90 offen offset:3072 sc1 lds
v_mfma_f32_16x16x32_bf16 v[252:255], a[124:127], v[92:95], v[252:255]
s_and_b32 s91, s91, 0x18000
v_exp_f32 v59, v59
v_mfma_f32_16x16x32_bf16 v[220:223], a[124:127], v[88:91], v[220:223]
s_add_u32 s90, s90, 0x4000
ds_read_b128 a[80:83], v26 offset:12288
v_cvt_pk_bf16_f32 v77, v58, v59
v_mfma_f32_16x16x32_bf16 a[136:139], a[144:147], v[88:91], a[136:139]
s_waitcnt vmcnt(17)
s_barrier
v_mfma_f32_16x16x32_bf16 a[140:143], a[144:147], v[92:95], a[140:143]
s_waitcnt lgkmcnt(4)
s_add_u32 m0, s67, 0x1000
buffer_store_dword v18, v20, s[4:7], s63 offen sc1
v_add_u32 v26, s91, v2
v_mfma_f32_16x16x32_bf16 v[48:51], a[64:67], a[32:35], v[104:107]
buffer_load_dwordx4 v11, s[32:35], s85 offen offset:3072 lds
s_sub_u32 s72, s72, 1
s_cbranch_scc1 L_fv16
L_back_fv16:
v_exp_f32 v60, v60
v_mfma_f32_16x16x32_bf16 v[48:51], a[68:71], a[36:39], v[48:51]
s_xor_b32 s84, s91, 0x10000
ds_read_b128 a[96:99], v26 offset:16384
v_mfma_f32_16x16x32_bf16 v[48:51], a[72:75], a[40:43], v[48:51]
s_add_u32 s84, s84, s59
v_exp_f32 v61, v61
v_mfma_f32_16x16x32_bf16 v[48:51], a[76:79], a[44:47], v[48:51]
s_waitcnt lgkmcnt(2)
ds_read_b128 a[100:103], v26 offset:17408
v_cvt_pk_bf16_f32 v78, v60, v61
v_mfma_f32_16x16x32_bf16 v[52:55], a[92:95], a[44:47], v[104:107]
s_add_u32 m0, s84, 0
v_exp_f32 v62, v62
v_mfma_f32_16x16x32_bf16 v[52:55], a[88:91], a[40:43], v[52:55]
ds_read_b128 a[104:107], v26 offset:18432
buffer_load_dwordx4 v1, s[4:7], s89 offen sc1 lds
v_mfma_f32_16x16x32_bf16 v[52:55], a[84:87], a[36:39], v[52:55]
s_waitcnt lgkmcnt(3)
v_exp_f32 v63, v63
v_mfma_f32_16x16x32_bf16 v[52:55], a[80:83], a[32:35], v[52:55]
s_add_u32 m0, s67, 0x2000
ds_read_b128 a[108:111], v26 offset:19456
v_cvt_pk_bf16_f32 v79, v62, v63
v_mfma_f32_16x16x32_bf16 v[56:59], a[64:67], a[48:51], v[108:111]
v_exp_f32 v48, v48
v_mfma_f32_16x16x32_bf16 v[56:59], a[68:71], a[52:55], v[56:59]
ds_read_b128 a[112:115], v26 offset:20480
buffer_load_dwordx4 v12, s[32:35], s85 offen lds
v_mfma_f32_16x16x32_bf16 v[56:59], a[72:75], a[56:59], v[56:59]
v_exp_f32 v49, v49
v_mfma_f32_16x16x32_bf16 v[56:59], a[76:79], a[60:63], v[56:59]
ds_read_b128 a[116:119], v26 offset:21504
v_cvt_pk_bf16_f32 v88, v48, v49
v_mfma_f32_16x16x32_bf16 v[60:63], a[92:95], a[60:63], v[108:111]
s_add_u32 m0, s84, 0
v_exp_f32 v50, v50
v_mfma_f32_16x16x32_bf16 v[60:63], a[88:91], a[56:59], v[60:63]
ds_read_b128 a[120:123], v26 offset:22528
buffer_load_dwordx4 v1, s[4:7], s89 offen offset:1024 sc1 lds
v_mfma_f32_16x16x32_bf16 v[60:63], a[84:87], a[52:55], v[60:63]
v_exp_f32 v51, v51
v_mfma_f32_16x16x32_bf16 v[60:63], a[80:83], a[48:51], v[60:63]
s_waitcnt lgkmcnt(5)
ds_read_b128 a[124:127], v26 offset:23552
v_cvt_pk_bf16_f32 v89, v50, v51
v_mfma_f32_16x16x32_bf16 v[192:195], a[96:99], v[72:75], v[192:195]
v_exp_f32 v52, v52
v_mfma_f32_16x16x32_bf16 v[224:227], a[96:99], v[76:79], v[224:227]
ds_read_b128 a[64:67], v26
v_mfma_f32_16x16x32_bf16 v[228:231], a[100:103], v[76:79], v[228:231]
v_exp_f32 v53, v53
v_mfma_f32_16x16x32_bf16 v[196:199], a[100:103], v[72:75], v[196:199]
s_waitcnt lgkmcnt(5)
ds_read_b128 a[68:71], v26 offset:1024
v_cvt_pk_bf16_f32 v90, v52, v53
v_mfma_f32_16x16x32_bf16 v[200:203], a[104:107], v[72:75], v[200:203]
s_add_u32 m0, s84, 0
v_exp_f32 v54, v54
v_mfma_f32_16x16x32_bf16 v[232:235], a[104:107], v[76:79], v[232:235]
ds_read_b128 a[72:75], v26 offset:2048
buffer_load_dwordx4 v1, s[4:7], s89 offen offset:2048 sc1 lds
v_mfma_f32_16x16x32_bf16 v[236:239], a[108:111], v[76:79], v[236:239]
v_exp_f32 v55, v55
v_mfma_f32_16x16x32_bf16 v[204:207], a[108:111], v[72:75], v[204:207]
s_waitcnt lgkmcnt(5)
ds_read_b128 a[76:79], v26 offset:3072
v_cvt_pk_bf16_f32 v91, v54, v55
v_mfma_f32_16x16x32_bf16 v[208:211], a[112:115], v[72:75], v[208:211]
v_exp_f32 v56, v56
v_mfma_f32_16x16x32_bf16 v[240:243], a[112:115], v[76:79], v[240:243]
ds_read_b128 a[92:95], v26 offset:7168
v_mfma_f32_16x16x32_bf16 v[244:247], a[116:119], v[76:79], v[244:247]
v_exp_f32 v57, v57
v_mfma_f32_16x16x32_bf16 v[212:215], a[116:119], v[72:75], v[212:215]
s_waitcnt lgkmcnt(5)
ds_read_b128 a[88:91], v26 offset:6144
v_cvt_pk_bf16_f32 v92, v56, v57
v_mfma_f32_16x16x32_bf16 v[216:219], a[120:123], v[72:75], v[216:219]
s_add_u32 m0, s84, 0
v_exp_f32 v58, v58
v_mfma_f32_16x16x32_bf16 v[248:251], a[120:123], v[76:79], v[248:251]
ds_read_b128 a[84:87], v26 offset:5120
buffer_load_dwordx4 v1, s[4:7], s89 offen offset:3072 sc1 lds
s_add_u32 s89, s89, 0x4000
v_mfma_f32_16x16x32_bf16 v[252:255], a[124:127], v[76:79], v[252:255]
v_exp_f32 v59, v59
v_mfma_f32_16x16x32_bf16 v[220:223], a[124:127], v[72:75], v[220:223]
ds_read_b128 a[80:83], v26 offset:4096
v_cvt_pk_bf16_f32 v93, v58, v59
v_mfma_f32_16x16x32_bf16 a[136:139], a[144:147], v[72:75], a[136:139]
v_mfma_f32_16x16x32_bf16 a[140:143], a[144:147], v[76:79], a[140:143]
s_waitcnt lgkmcnt(4)
v_mfma_f32_16x16x32_bf16 v[48:51], a[64:67], a[32:35], v[120:123]
v_exp_f32 v60, v60
v_mfma_f32_16x16x32_bf16 v[48:51], a[68:71], a[36:39], v[48:51]
ds_read_b128 a[96:99], v26 offset:24576
v_mfma_f32_16x16x32_bf16 v[48:51], a[72:75], a[40:43], v[48:51]
v_exp_f32 v61, v61
v_mfma_f32_16x16x32_bf16 v[48:51], a[76:79], a[44:47], v[48:51]
s_waitcnt lgkmcnt(2)
ds_read_b128 a[100:103], v26 offset:25600
v_cvt_pk_bf16_f32 v94, v60, v61
v_mfma_f32_16x16x32_bf16 v[52:55], a[92:95], a[44:47], v[124:127]
s_add_u32 m0, s84, 0x4000
v_exp_f32 v62, v62
v_mfma_f32_16x16x32_bf16 v[52:55], a[88:91], a[40:43], v[52:55]
ds_read_b128 a[104:107], v26 offset:26624
buffer_load_dwordx4 v1, s[4:7], s90 offen sc1 lds
v_mfma_f32_16x16x32_bf16 v[52:55], a[84:87], a[36:39], v[52:55]
s_waitcnt lgkmcnt(3)
v_exp_f32 v63, v63
v_mfma_f32_16x16x32_bf16 v[52:55], a[80:83], a[32:35], v[52:55]
ds_read_b128 a[108:111], v26 offset:27648
v_cvt_pk_bf16_f32 v95, v62, v63
v_mfma_f32_16x16x32_bf16 v[56:59], a[64:67], a[48:51], v[108:111]
v_exp_f32 v48, v48
v_mfma_f32_16x16x32_bf16 v[56:59], a[68:71], a[52:55], v[56:59]
ds_read_b128 a[112:115], v26 offset:28672
v_mfma_f32_16x16x32_bf16 v[56:59], a[72:75], a[56:59], v[56:59]
v_exp_f32 v49, v49
v_mfma_f32_16x16x32_bf16 v[56:59], a[76:79], a[60:63], v[56:59]
ds_read_b128 a[116:119], v26 offset:29696
v_cvt_pk_bf16_f32 v72, v48, v49
v_mfma_f32_16x16x32_bf16 v[60:63], a[92:95], a[60:63], v[108:111]
s_add_u32 m0, s84, 0x4000
v_exp_f32 v50, v50
v_mfma_f32_16x16x32_bf16 v[60:63], a[88:91], a[56:59], v[60:63]
ds_read_b128 a[120:123], v26 offset:30720
buffer_load_dwordx4 v1, s[4:7], s90 offen offset:1024 sc1 lds
v_mfma_f32_16x16x32_bf16 v[60:63], a[84:87], a[52:55], v[60:63]
v_exp_f32 v51, v51
v_mfma_f32_16x16x32_bf16 v[60:63], a[80:83], a[48:51], v[60:63]
s_waitcnt lgkmcnt(5)
ds_read_b128 a[124:127], v26 offset:31744
v_cvt_pk_bf16_f32 v73, v50, v51
v_mfma_f32_16x16x32_bf16 v[192:195], a[96:99], v[88:91], v[192:195]
v_exp_f32 v52, v52
v_mfma_f32_16x16x32_bf16 v[224:227], a[96:99], v[92:95], v[224:227]
ds_read_b128 a[64:67], v26 offset:8192
v_mfma_f32_16x16x32_bf16 v[228:231], a[100:103], v[92:95], v[228:231]
v_exp_f32 v53, v53
v_mfma_f32_16x16x32_bf16 v[196:199], a[100:103], v[88:91], v[196:199]
s_waitcnt lgkmcnt(5)
ds_read_b128 a[68:71], v26 offset:9216
v_cvt_pk_bf16_f32 v74, v52, v53
v_mfma_f32_16x16x32_bf16 v[200:203], a[104:107], v[88:91], v[200:203]
s_add_u32 m0, s84, 0x4000
v_exp_f32 v54, v54
v_mfma_f32_16x16x32_bf16 v[232:235], a[104:107], v[92:95], v[232:235]
ds_read_b128 a[72:75], v26 offset:10240
buffer_load_dwordx4 v1, s[4:7], s90 offen offset:2048 sc1 lds
v_mfma_f32_16x16x32_bf16 v[236:239], a[108:111], v[92:95], v[236:239]
v_exp_f32 v55, v55
v_mfma_f32_16x16x32_bf16 v[204:207], a[108:111], v[88:91], v[204:207]
s_waitcnt lgkmcnt(5)
ds_read_b128 a[76:79], v26 offset:11264
v_cvt_pk_bf16_f32 v75, v54, v55
v_mfma_f32_16x16x32_bf16 v[208:211], a[112:115], v[88:91], v[208:211]
v_exp_f32 v56, v56
v_mfma_f32_16x16x32_bf16 v[240:243], a[112:115], v[92:95], v[240:243]
ds_read_b128 a[92:95], v26 offset:15360
v_mfma_f32_16x16x32_bf16 v[244:247], a[116:119], v[92:95], v[244:247]
v_exp_f32 v57, v57
v_mfma_f32_16x16x32_bf16 v[212:215], a[116:119], v[88:91], v[212:215]
s_waitcnt lgkmcnt(5)
ds_read_b128 a[88:91], v26 offset:14336
v_cvt_pk_bf16_f32 v76, v56, v57
v_mfma_f32_16x16x32_bf16 v[216:219], a[120:123], v[88:91], v[216:219]
s_add_u32 m0, s84, 0x4000
v_exp_f32 v58, v58
v_mfma_f32_16x16x32_bf16 v[248:251], a[120:123], v[92:95], v[248:251]
s_add_u32 s91, s91, 0x8000
ds_read_b128 a[84:87], v26 offset:13312
buffer_load_dwordx4 v1, s[4:7], s90 offen offset:3072 sc1 lds
v_mfma_f32_16x16x32_bf16 v[252:255], a[124:127], v[92:95], v[252:255]
s_and_b32 s91, s91, 0x18000
v_exp_f32 v59, v59
v_mfma_f32_16x16x32_bf16 v[220:223], a[124:127], v[88:91], v[220:223]
s_add_u32 s90, s90, 0x4000
ds_read_b128 a[80:83], v26 offset:12288
v_cvt_pk_bf16_f32 v77, v58, v59
v_mfma_f32_16x16x32_bf16 a[136:139], a[144:147], v[88:91], a[136:139]
s_waitcnt vmcnt(11)
s_barrier
v_mfma_f32_16x16x32_bf16 a[140:143], a[144:147], v[92:95], a[140:143]
s_waitcnt lgkmcnt(4)
v_add_u32 v26, s91, v2
v_mfma_f32_16x16x32_bf16 v[48:51], a[64:67], a[32:35], v[104:107]
s_sub_u32 s72, s72, 1
s_cbranch_scc1 L_fv17
L_back_fv17:
v_exp_f32 v60, v60
v_mfma_f32_16x16x32_bf16 v[48:51], a[68:71], a[36:39], v[48:51]
s_xor_b32 s84, s91, 0x10000
ds_read_b128 a[96:99], v26 offset:16384
v_mfma_f32_16x16x32_bf16 v[48:51], a[72:75], a[40:43], v[48:51]
s_add_u32 s84, s84, s59
v_exp_f32 v61, v61
v_mfma_f32_16x16x32_bf16 v[48:51], a[76:79], a[44:47], v[48:51]
s_waitcnt lgkmcnt(2)
ds_read_b128 a[100:103], v26 offset:17408
v_cmp_ne_u32 vcc, v23, v18
s_nop 1
s_cbranch_vccnz L_spin_fb2P
L_back_fb2P:
s_lshl_b32 s78, s53, 12
s_add_u32 s78, s78, 0x4e00000
v_cvt_pk_bf16_f32 v78, v60, v61
v_mfma_f32_16x16x32_bf16 v[52:55], a[92:95], a[44:47], v[104:107]
s_add_u32 m0, s84, 0
v_exp_f32 v62, v62
v_mfma_f32_16x16x32_bf16 v[52:55], a[88:91], a[40:43], v[52:55]
ds_read_b128 a[104:107], v26 offset:18432
v_cmp_ne_u32 vcc, v19, v18
s_nop 1
s_cbranch_vccnz L_spin_caP
L_back_caP:
v_mfma_f32_16x16x32_bf16 v[52:55], a[84:87], a[36:39], v[52:55]
s_waitcnt lgkmcnt(3)
v_exp_f32 v63, v63
v_mfma_f32_16x16x32_bf16 v[52:55], a[80:83], a[32:35], v[52:55]
s_add_u32 s70, s52, 1
s_and_b32 s70, s70, 3
s_sub_u32 s70, s70, s52
s_lshl_b32 s70, s70, 12
s_add_u32 s65, s55, s70
s_add_u32 s66, s56, s70
ds_read_b128 a[108:111], v26 offset:19456
v_cvt_pk_bf16_f32 v79, v62, v63
v_mfma_f32_16x16x32_bf16 v[56:59], a[64:67], a[48:51], v[108:111]
buffer_load_dwordx4 a[148:151], v1, s[4:7], s65 offen sc1
v_exp_f32 v48, v48
v_mfma_f32_16x16x32_bf16 v[56:59], a[68:71], a[52:55], v[56:59]
ds_read_b128 a[112:115], v26 offset:20480
buffer_load_dwordx4 v1, s[4:7], s89 offen sc1 lds
v_mfma_f32_16x16x32_bf16 v[56:59], a[72:75], a[56:59], v[56:59]
v_exp_f32 v49, v49
v_mfma_f32_16x16x32_bf16 v[56:59], a[76:79], a[60:63], v[56:59]
ds_read_b128 a[116:119], v26 offset:21504
v_cvt_pk_bf16_f32 v88, v48, v49
v_mfma_f32_16x16x32_bf16 v[60:63], a[92:95], a[60:63], v[108:111]
s_add_u32 m0, s84, 0
v_exp_f32 v50, v50
v_mfma_f32_16x16x32_bf16 v[60:63], a[88:91], a[56:59], v[60:63]
ds_read_b128 a[120:123], v26 offset:22528
buffer_load_dwordx4 a[152:155], v1, s[4:7], s66 offen sc1
v_mfma_f32_16x16x32_bf16 v[60:63], a[84:87], a[52:55], v[60:63]
v_exp_f32 v51, v51
v_mfma_f32_16x16x32_bf16 v[60:63], a[80:83], a[48:51], v[60:63]
s_waitcnt lgkmcnt(5)
ds_read_b128 a[124:127], v26 offset:23552
v_cvt_pk_bf16_f32 v89, v50, v51
v_mfma_f32_16x16x32_bf16 v[192:195], a[96:99], v[72:75], v[192:195]
v_exp_f32 v52, v52
v_mfma_f32_16x16x32_bf16 v[224:227], a[96:99], v[76:79], v[224:227]
ds_read_b128 a[64:67], v26
buffer_load_dwordx4 v1, s[4:7], s89 offen offset:1024 sc1 lds
v_mfma_f32_16x16x32_bf16 v[228:231], a[100:103], v[76:79], v[228:231]
v_exp_f32 v53, v53
v_mfma_f32_16x16x32_bf16 v[196:199], a[100:103], v[72:75], v[196:199]
s_waitcnt lgkmcnt(5)
ds_read_b128 a[68:71], v26 offset:1024
v_cvt_pk_bf16_f32 v90, v52, v53
v_mfma_f32_16x16x32_bf16 v[200:203], a[104:107], v[72:75], v[200:203]
s_add_u32 m0, s84, 0
v_exp_f32 v54, v54
v_mfma_f32_16x16x32_bf16 v[232:235], a[104:107], v[76:79], v[232:235]
ds_read_b128 a[72:75], v26 offset:2048
buffer_load_dwordx4 v1, s[4:7], s89 offen offset:2048 sc1 lds
v_mfma_f32_16x16x32_bf16 v[236:239], a[108:111], v[76:79], v[236:239]
v_exp_f32 v55, v55
v_mfma_f32_16x16x32_bf16 v[204:207], a[108:111], v[72:75], v[204:207]
s_waitcnt lgkmcnt(5)
buffer_load_dwordx4 a[156:159], v1, s[4:7], s65 offen offset:1024 sc1
ds_read_b128 a[76:79], v26 offset:3072
v_cvt_pk_bf16_f32 v91, v54, v55
v_mfma_f32_16x16x32_bf16 v[208:211], a[112:115], v[72:75], v[208:211]
v_exp_f32 v56, v56
v_mfma_f32_16x16x32_bf16 v[240:243], a[112:115], v[76:79], v[240:243]
ds_read_b128 a[92:95], v26 offset:7168
v_mfma_f32_16x16x32_bf16 v[244:247], a[116:119], v[76:79], v[244:247]
v_exp_f32 v57, v57
v_mfma_f32_16x16x32_bf16 v[212:215], a[116:119], v[72:75], v[212:215]
s_waitcnt lgkmcnt(5)
ds_read_b128 a[88:91], v26 offset:6144
v_cvt_pk_bf16_f32 v92, v56, v57
v_mfma_f32_16x16x32_bf16 v[216:219], a[120:123], v[72:75], v[216:219]
s_add_u32 m0, s84, 0
v_exp_f32 v58, v58
v_mfma_f32_16x16x32_bf16 v[248:251], a[120:123], v[76:79], v[248:251]
ds_read_b128 a[84:87], v26 offset:5120
buffer_load_dwordx4 v1, s[4:7], s89 offen offset:3072 sc1 lds
s_add_u32 s89, s89, 0x4000
v_mfma_f32_16x16x32_bf16 v[252:255], a[124:127], v[76:79], v[252:255]
v_exp_f32 v59, v59
v_mfma_f32_16x16x32_bf16 v[220:223], a[124:127], v[72:75], v[220:223]
buffer_load_dwordx4 a[160:163], v1, s[4:7], s66 offen offset:1024 sc1
ds_read_b128 a[80:83], v26 offset:4096
v_cvt_pk_bf16_f32 v93, v58, v59
v_mfma_f32_16x16x32_bf16 a[136:139], a[144:147], v[72:75], a[136:139]
v_mfma_f32_16x16x32_bf16 a[140:143], a[144:147], v[76:79], a[140:143]
s_waitcnt lgkmcnt(4)
v_mfma_f32_16x16x32_bf16 v[48:51], a[64:67], a[32:35], v[120:123]
v_exp_f32 v60, v60
v_mfma_f32_16x16x32_bf16 v[48:51], a[68:71], a[36:39], v[48:51]
ds_read_b128 a[96:99], v26 offset:24576
v_mfma_f32_16x16x32_bf16 v[48:51], a[72:75], a[40:43], v[48:51]
v_exp_f32 v61, v61
v_mfma_f32_16x16x32_bf16 v[48:51], a[76:79], a[44:47], v[48:51]
s_waitcnt lgkmcnt(2)
ds_read_b128 a[100:103], v26 offset:25600
v_cvt_pk_bf16_f32 v94, v60, v61
v_mfma_f32_16x16x32_bf16 v[52:55], a[92:95], a[44:47], v[124:127]
s_add_u32 m0, s84, 0x4000
v_exp_f32 v62, v62
v_mfma_f32_16x16x32_bf16 v[52:55], a[88:91], a[40:43], v[52:55]
ds_read_b128 a[104:107], v26 offset:26624
buffer_load_dwordx4 a[164:167], v1, s[4:7], s65 offen offset:2048 sc1
v_mfma_f32_16x16x32_bf16 v[52:55], a[84:87], a[36:39], v[52:55]
s_waitcnt lgkmcnt(3)
v_exp_f32 v63, v63
v_mfma_f32_16x16x32_bf16 v[52:55], a[80:83], a[32:35], v[52:55]
ds_read_b128 a[108:111], v26 offset:27648
v_cvt_pk_bf16_f32 v95, v62, v63
v_mfma_f32_16x16x32_bf16 v[56:59], a[64:67], a[48:51], v[108:111]
v_exp_f32 v48, v48
v_mfma_f32_16x16x32_bf16 v[56:59], a[68:71], a[52:55], v[56:59]
ds_read_b128 a[112:115], v26 offset:28672
buffer_load_dwordx4 v1, s[4:7], s90 offen sc1 lds
v_mfma_f32_16x16x32_bf16 v[56:59], a[72:75], a[56:59], v[56:59]
v_exp_f32 v49, v49
v_mfma_f32_16x16x32_bf16 v[56:59], a[76:79], a[60:63], v[56:59]
ds_read_b128 a[116:119], v26 offset:29696
v_cvt_pk_bf16_f32 v72, v48, v49
v_mfma_f32_16x16x32_bf16 v[60:63], a[92:95], a[60:63], v[108:111]
s_add_u32 m0, s84, 0x4000
v_exp_f32 v50, v50
v_mfma_f32_16x16x32_bf16 v[60:63], a[88:91], a[56:59], v[60:63]
ds_read_b128 a[120:123], v26 offset:30720
buffer_load_dwordx4 a[168:171], v1, s[4:7], s66 offen offset:2048 sc1
v_mfma_f32_16x16x32_bf16 v[60:63], a[84:87], a[52:55], v[60:63]
v_exp_f32 v51, v51
v_mfma_f32_16x16x32_bf16 v[60:63], a[80:83], a[48:51], v[60:63]
s_waitcnt lgkmcnt(5)
ds_read_b128 a[124:127], v26 offset:31744
v_cvt_pk_bf16_f32 v73, v50, v51
v_mfma_f32_16x16x32_bf16 v[192:195], a[96:99], v[88:91], v[192:195]
v_exp_f32 v52, v52
v_mfma_f32_16x16x32_bf16 v[224:227], a[96:99], v[92:95], v[224:227]
ds_read_b128 a[64:67], v26 offset:8192
buffer_load_dwordx4 v1, s[4:7], s90 offen offset:1024 sc1 lds
v_mfma_f32_16x16x32_bf16 v[228:231], a[100:103], v[92:95], v[228:231]
v_exp_f32 v53, v53
v_mfma_f32_16x16x32_bf16 v[196:199], a[100:103], v[88:91], v[196:199]
s_waitcnt lgkmcnt(5)
ds_read_b128 a[68:71], v26 offset:9216
v_cvt_pk_bf16_f32 v74, v52, v53
v_mfma_f32_16x16x32_bf16 v[200:203], a[104:107], v[88:91], v[200:203]
s_add_u32 m0, s84, 0x4000
v_exp_f32 v54, v54
v_mfma_f32_16x16x32_bf16 v[232:235], a[104:107], v[92:95], v[232:235]
ds_read_b128 a[72:75], v26 offset:10240
buffer_load_dwordx4 v1, s[4:7], s90 offen offset:2048 sc1 lds
v_mfma_f32_16x16x32_bf16 v[236:239], a[108:111], v[92:95], v[236:239]
v_exp_f32 v55, v55
v_mfma_f32_16x16x32_bf16 v[204:207], a[108:111], v[88:91], v[204:207]
s_waitcnt lgkmcnt(5)
buffer_load_dwordx4 a[172:175], v1, s[4:7], s65 offen offset:3072 sc1
ds_read_b128 a[76:79], v26 offset:11264
v_cvt_pk_bf16_f32 v75, v54, v55
v_mfma_f32_16x16x32_bf16 v[208:211], a[112:115], v[88:91], v[208:211]
v_exp_f32 v56, v56
v_mfma_f32_16x16x32_bf16 v[240:243], a[112:115], v[92:95], v[240:243]
ds_read_b128 a[92:95], v26 offset:15360
v_mfma_f32_16x16x32_bf16 v[244:247], a[116:119], v[92:95], v[244:247]
v_exp_f32 v57, v57
v_mfma_f32_16x16x32_bf16 v[212:215], a[116:119], v[88:91], v[212:215]
s_waitcnt lgkmcnt(5)
ds_read_b128 a[88:91], v26 offset:14336
v_cvt_pk_bf16_f32 v76, v56, v57
v_mfma_f32_16x16x32_bf16 v[216:219], a[120:123], v[88:91], v[216:219]
s_add_u32 m0, s84, 0x4000
v_exp_f32 v58, v58
v_mfma_f32_16x16x32_bf16 v[248:251], a[120:123], v[92:95], v[248:251]
s_add_u32 s91, s91, 0x8000
ds_read_b128 a[84:87], v26 offset:13312
buffer_load_dwordx4 v1, s[4:7], s90 offen offset:3072 sc1 lds
v_mfma_f32_16x16x32_bf16 v[252:255], a[124:127], v[92:95], v[252:255]
s_and_b32 s91, s91, 0x18000
v_exp_f32 v59, v59
v_mfma_f32_16x16x32_bf16 v[220:223], a[124:127], v[88:91], v[220:223]
buffer_load_dwordx4 a[176:179], v1, s[4:7], s66 offen offset:3072 sc1
ds_read_b128 a[80:83], v26 offset:12288
v_cvt_pk_bf16_f32 v77, v58, v59
v_mfma_f32_16x16x32_bf16 a[136:139], a[144:147], v[88:91], a[136:139]
s_waitcnt vmcnt(16)
s_barrier
v_mfma_f32_16x16x32_bf16 a[140:143], a[144:147], v[92:95], a[140:143]
s_waitcnt lgkmcnt(4)
s_add_u32 s90, s90, 0x4000
v_add_u32 v26, s91, v2
v_mfma_f32_16x16x32_bf16 v[48:51], a[64:67], a[32:35], v[104:107]
s_sub_u32 s72, s72, 1
s_cbranch_scc1 L_fv18
L_back_fv18:
v_exp_f32 v60, v60
v_mfma_f32_16x16x32_bf16 v[48:51], a[68:71], a[36:39], v[48:51]
s_xor_b32 s84, s91, 0x10000
ds_read_b128 a[96:99], v26 offset:16384
v_mfma_f32_16x16x32_bf16 v[48:51], a[72:75], a[40:43], v[48:51]
s_add_u32 s84, s84, s59
v_exp_f32 v61, v61
v_mfma_f32_16x16x32_bf16 v[48:51], a[76:79], a[44:47], v[48:51]
s_waitcnt lgkmcnt(2)
ds_read_b128 a[100:103], v26 offset:17408
v_cvt_pk_bf16_f32 v78, v60, v61
v_mfma_f32_16x16x32_bf16 v[52:55], a[92:95], a[44:47], v[104:107]
s_add_u32 m0, s84, 0
v_exp_f32 v62, v62
v_mfma_f32_16x16x32_bf16 v[52:55], a[88:91], a[40:43], v[52:55]
ds_read_b128 a[104:107], v26 offset:18432
buffer_load_dwordx4 v1, s[4:7], s89 offen sc1 lds
v_mfma_f32_16x16x32_bf16 v[52:55], a[84:87], a[36:39], v[52:55]
s_waitcnt lgkmcnt(3)
v_exp_f32 v63, v63
v_mfma_f32_16x16x32_bf16 v[52:55], a[80:83], a[32:35], v[52:55]
s_add_u32 s70, s52, 2
s_and_b32 s70, s70, 3
s_sub_u32 s70, s70, s52
s_lshl_b32 s70, s70, 12
s_add_u32 s65, s55, s70
s_add_u32 s66, s56, s70
ds_read_b128 a[108:111], v26 offset:19456
v_cvt_pk_bf16_f32 v79, v62, v63
v_mfma_f32_16x16x32_bf16 v[56:59], a[64:67], a[48:51], v[108:111]
buffer_load_dwordx4 a[180:183], v1, s[4:7], s65 offen sc1
v_exp_f32 v48, v48
v_mfma_f32_16x16x32_bf16 v[56:59], a[68:71], a[52:55], v[56:59]
ds_read_b128 a[112:115], v26 offset:20480
v_mfma_f32_16x16x32_bf16 v[56:59], a[72:75], a[56:59], v[56:59]
v_exp_f32 v49, v49
v_mfma_f32_16x16x32_bf16 v[56:59], a[76:79], a[60:63], v[56:59]
ds_read_b128 a[116:119], v26 offset:21504
v_cvt_pk_bf16_f32 v88, v48, v49
v_mfma_f32_16x16x32_bf16 v[60:63], a[92:95], a[60:63], v[108:111]
s_add_u32 m0, s84, 0
v_exp_f32 v50, v50
v_mfma_f32_16x16x32_bf16 v[60:63], a[88:91], a[56:59], v[60:63]
ds_read_b128 a[120:123], v26 offset:22528
buffer_load_dwordx4 a[184:187], v1, s[4:7], s66 offen sc1
v_mfma_f32_16x16x32_bf16 v[60:63], a[84:87], a[52:55], v[60:63]
v_exp_f32 v51, v51
v_mfma_f32_16x16x32_bf16 v[60:63], a[80:83], a[48:51], v[60:63]
s_waitcnt lgkmcnt(5)
ds_read_b128 a[124:127], v26 offset:23552
v_cvt_pk_bf16_f32 v89, v50, v51
v_mfma_f32_16x16x32_bf16 v[192:195], a[96:99], v[72:75], v[192:195]
v_exp_f32 v52, v52
v_mfma_f32_16x16x32_bf16 v[224:227], a[96:99], v[76:79], v[224:227]
ds_read_b128 a[64:67], v26
buffer_load_dwordx4 v1, s[4:7], s89 offen offset:1024 sc1 lds
v_mfma_f32_16x16x32_bf16 v[228:231], a[100:103], v[76:79], v[228:231]
v_exp_f32 v53, v53
v_mfma_f32_16x16x32_bf16 v[196:199], a[100:103], v[72:75], v[196:199]
s_waitcnt lgkmcnt(5)
ds_read_b128 a[68:71], v26 offset:1024
v_cvt_pk_bf16_f32 v90, v52, v53
v_mfma_f32_16x16x32_bf16 v[200:203], a[104:107], v[72:75], v[200:203]
s_add_u32 m0, s84, 0
v_exp_f32 v54, v54
v_mfma_f32_16x16x32_bf16 v[232:235], a[104:107], v[76:79], v[232:235]
ds_read_b128 a[72:75], v26 offset:2048
buffer_load_dwordx4 v1, s[4:7], s89 offen offset:2048 sc1 lds
v_mfma_f32_16x16x32_bf16 v[236:239], a[108:111], v[76:79], v[236:239]
v_exp_f32 v55, v55
v_mfma_f32_16x16x32_bf16 v[204:207], a[108:111], v[72:75], v[204:207]
s_waitcnt lgkmcnt(5)
buffer_load_dwordx4 a[188:191], v1, s[4:7], s65 offen offset:1024 sc1
ds_read_b128 a[76:79], v26 offset:3072
v_cvt_pk_bf16_f32 v91, v54, v55
v_mfma_f32_16x16x32_bf16 v[208:211], a[112:115], v[72:75], v[208:211]
v_exp_f32 v56, v56
v_mfma_f32_16x16x32_bf16 v[240:243], a[112:115], v[76:79], v[240:243]
ds_read_b128 a[92:95], v26 offset:7168
v_mfma_f32_16x16x32_bf16 v[244:247], a[116:119], v[76:79], v[244:247]
v_exp_f32 v57, v57
v_mfma_f32_16x16x32_bf16 v[212:215], a[116:119], v[72:75], v[212:215]
s_waitcnt lgkmcnt(5)
ds_read_b128 a[88:91], v26 offset:6144
v_cvt_pk_bf16_f32 v92, v56, v57
v_mfma_f32_16x16x32_bf16 v[216:219], a[120:123], v[72:75], v[216:219]
s_add_u32 m0, s84, 0
v_exp_f32 v58, v58
v_mfma_f32_16x16x32_bf16 v[248:251], a[120:123], v[76:79], v[248:251]
s_cmp_lt_u32 s48, 2
s_cbranch_scc1 L_setcb1
L_back_setcb1:
ds_read_b128 a[84:87], v26 offset:5120
v_mfma_f32_16x16x32_bf16 v[252:255], a[124:127], v[76:79], v[252:255]
v_exp_f32 v59, v59
v_mfma_f32_16x16x32_bf16 v[220:223], a[124:127], v[72:75], v[220:223]
buffer_load_dwordx4 a[192:195], v1, s[4:7], s66 offen offset:1024 sc1
ds_read_b128 a[80:83], v26 offset:4096
v_cvt_pk_bf16_f32 v93, v58, v59
v_mfma_f32_16x16x32_bf16 a[136:139], a[144:147], v[72:75], a[136:139]
buffer_load_dwordx4 v1, s[4:7], s89 offen offset:3072 sc1 lds
s_add_u32 s89, s89, 0x4000
v_mfma_f32_16x16x32_bf16 a[140:143], a[144:147], v[76:79], a[140:143]
s_waitcnt lgkmcnt(4)
v_mfma_f32_16x16x32_bf16 v[48:51], a[64:67], a[32:35], v[120:123]
v_exp_f32 v60, v60
v_mfma_f32_16x16x32_bf16 v[48:51], a[68:71], a[36:39], v[48:51]
ds_read_b128 a[96:99], v26 offset:24576
v_mfma_f32_16x16x32_bf16 v[48:51], a[72:75], a[40:43], v[48:51]
v_exp_f32 v61, v61
v_mfma_f32_16x16x32_bf16 v[48:51], a[76:79], a[44:47], v[48:51]
s_waitcnt lgkmcnt(2)
ds_read_b128 a[100:103], v26 offset:25600
v_cvt_pk_bf16_f32 v94, v60, v61
v_mfma_f32_16x16x32_bf16 v[52:55], a[92:95], a[44:47], v[124:127]
s_add_u32 m0, s84, 0x4000
v_exp_f32 v62, v62
v_mfma_f32_16x16x32_bf16 v[52:55], a[88:91], a[40:43], v[52:55]
ds_read_b128 a[104:107], v26 offset:26624
buffer_load_dwordx4 v[64:67], v1, s[4:7], s78 offen sc1
v_mfma_f32_16x16x32_bf16 v[52:55], a[84:87], a[36:39], v[52:55]
s_waitcnt lgkmcnt(3)
v_exp_f32 v63, v63
v_mfma_f32_16x16x32_bf16 v[52:55], a[80:83], a[32:35], v[52:55]
ds_read_b128 a[108:111], v26 offset:27648
v_cvt_pk_bf16_f32 v95, v62, v63
v_mfma_f32_16x16x32_bf16 v[56:59], a[64:67], a[48:51], v[108:111]
v_exp_f32 v48, v48
v_mfma_f32_16x16x32_bf16 v[56:59], a[68:71], a[52:55], v[56:59]
ds_read_b128 a[112:115], v26 offset:28672
buffer_load_dwordx4 v1, s[4:7], s90 offen sc1 lds
v_mfma_f32_16x16x32_bf16 v[56:59], a[72:75], a[56:59], v[56:59]
v_exp_f32 v49, v49
v_mfma_f32_16x16x32_bf16 v[56:59], a[76:79], a[60:63], v[56:59]
ds_read_b128 a[116:119], v26 offset:29696
v_cvt_pk_bf16_f32 v72, v48, v49
v_mfma_f32_16x16x32_bf16 v[60:63], a[92:95], a[60:63], v[108:111]
s_add_u32 m0, s84, 0x4000
v_exp_f32 v50, v50
v_mfma_f32_16x16x32_bf16 v[60:63], a[88:91], a[56:59], v[60:63]
ds_read_b128 a[120:123], v26 offset:30720
buffer_load_dwordx4 v[68:71], v1, s[4:7], s78 offen offset:1024 sc1
v_mfma_f32_16x16x32_bf16 v[60:63], a[84:87], a[52:55], v[60:63]
v_exp_f32 v51, v51
v_mfma_f32_16x16x32_bf16 v[60:63], a[80:83], a[48:51], v[60:63]
s_waitcnt lgkmcnt(5)
ds_read_b128 a[124:127], v26 offset:31744
v_cvt_pk_bf16_f32 v73, v50, v51
v_mfma_f32_16x16x32_bf16 v[192:195], a[96:99], v[88:91], v[192:195]
v_exp_f32 v52, v52
v_mfma_f32_16x16x32_bf16 v[224:227], a[96:99], v[92:95], v[224:227]
ds_read_b128 a[64:67], v26 offset:8192
buffer_load_dwordx4 v1, s[4:7], s90 offen offset:1024 sc1 lds
v_mfma_f32_16x16x32_bf16 v[228:231], a[100:103], v[92:95], v[228:231]
v_exp_f32 v53, v53
v_mfma_f32_16x16x32_bf16 v[196:199], a[100:103], v[88:91], v[196:199]
s_waitcnt lgkmcnt(5)
ds_read_b128 a[68:71], v26 offset:9216
v_cvt_pk_bf16_f32 v74, v52, v53
v_mfma_f32_16x16x32_bf16 v[200:203], a[104:107], v[88:91], v[200:203]
s_add_u32 m0, s84, 0x4000
v_exp_f32 v54, v54
v_mfma_f32_16x16x32_bf16 v[232:235], a[104:107], v[92:95], v[232:235]
ds_read_b128 a[72:75], v26 offset:10240
buffer_load_dwordx4 v1, s[4:7], s90 offen offset:2048 sc1 lds
v_mfma_f32_16x16x32_bf16 v[236:239], a[108:111], v[92:95], v[236:239]
v_exp_f32 v55, v55
v_mfma_f32_16x16x32_bf16 v[204:207], a[108:111], v[88:91], v[204:207]
s_waitcnt lgkmcnt(5)
buffer_load_dwordx4 v[80:83], v1, s[4:7], s78 offen offset:2048 sc1
ds_read_b128 a[76:79], v26 offset:11264
v_cvt_pk_bf16_f32 v75, v54, v55
v_mfma_f32_16x16x32_bf16 v[208:211], a[112:115], v[88:91], v[208:211]
v_exp_f32 v56, v56
v_mfma_f32_16x16x32_bf16 v[240:243], a[112:115], v[92:95], v[240:243]
ds_read_b128 a[92:95], v26 offset:15360
v_mfma_f32_16x16x32_bf16 v[244:247], a[116:119], v[92:95], v[244:247]
v_exp_f32 v57, v57
v_mfma_f32_16x16x32_bf16 v[212:215], a[116:119], v[88:91], v[212:215]
s_waitcnt lgkmcnt(5)
ds_read_b128 a[88:91], v26 offset:14336
v_cvt_pk_bf16_f32 v76, v56, v57
v_mfma_f32_16x16x32_bf16 v[216:219], a[120:123], v[88:91], v[216:219]
s_add_u32 m0, s84, 0x4000
v_exp_f32 v58, v58
v_mfma_f32_16x16x32_bf16 v[248:251], a[120:123], v[92:95], v[248:251]
s_add_u32 s91, s91, 0x8000
ds_read_b128 a[84:87], v26 offset:13312
buffer_load_dwordx4 v1, s[4:7], s90 offen offset:3072 sc1 lds
v_mfma_f32_16x16x32_bf16 v[252:255], a[124:127], v[92:95], v[252:255]
s_and_b32 s91, s91, 0x18000
v_exp_f32 v59, v59
v_mfma_f32_16x16x32_bf16 v[220:223], a[124:127], v[88:91], v[220:223]
s_add_u32 s90, s90, 0x4000
ds_read_b128 a[80:83], v26 offset:12288
v_cvt_pk_bf16_f32 v77, v58, v59
v_mfma_f32_16x16x32_bf16 a[136:139], a[144:147], v[88:91], a[136:139]
s_waitcnt vmcnt(16)
s_barrier
v_mfma_f32_16x16x32_bf16 a[140:143], a[144:147], v[92:95], a[140:143]
v_add_u32 v26, s91, v2
L_single_done:
s_add_u32 s62, s91, 0x8000
s_xor_b32 s61, s91, 0x10000
s_add_u32 s61, s61, 0x8000
v_add_u32 v17, s61, v13
v_add_u32 v25, s62, v13
s_cmp_ge_u32 s48, 2
s_cbranch_scc1 L_bdY
L_bdX:
s_waitcnt lgkmcnt(3)
v_mfma_f32_16x16x32_bf16 v[48:51], a[64:67], a[48:51], v[108:111]
ds_read_b128 a[96:99], v26 offset:16384
v_mfma_f32_16x16x32_bf16 v[48:51], a[68:71], a[52:55], v[48:51]
ds_read_b128 a[100:103], v26 offset:17408
v_mfma_f32_16x16x32_bf16 v[48:51], a[72:75], a[56:59], v[48:51]
v_exp_f32 v60, v60
v_mfma_f32_16x16x32_bf16 v[48:51], a[76:79], a[60:63], v[48:51]
s_add_u32 s70, s48, 3
s_lshr_b32 s71, s70, 2
s_add_u32 s71, s71, s52
s_and_b32 s71, s71, 3
s_lshl_b32 s71, s71, 2
s_and_b32 s70, s70, 3
s_add_u32 s70, s70, s71
s_mul_i32 s70, s70, 0x9000
s_add_u32 s85, s64, s70
s_mul_i32 s67, s48, 0x2400
s_add_u32 s67, s67, s61
s_cmp_lt_u32 s48, 3
s_cselect_b32 s67, s67, 0x28000
s_cselect_b32 s85, s85, 0x40000000
s_add_u32 m0, s67, 0
v_mfma_f32_16x16x32_bf16 v[52:55], a[92:95], a[60:63], v[108:111]
s_waitcnt lgkmcnt(2)
buffer_load_dwordx4 v4, s[32:35], s85 offen lds
v_exp_f32 v61, v61
v_mfma_f32_16x16x32_bf16 v[52:55], a[88:91], a[56:59], v[52:55]
ds_read_b128 a[104:107], v26 offset:18432
v_cvt_pk_bf16_f32 v78, v60, v61
v_exp_f32 v62, v62
v_exp_f32 v63, v63
v_mfma_f32_16x16x32_bf16 v[52:55], a[84:87], a[52:55], v[52:55]
s_add_u32 m0, s67, 0
ds_read_b128 a[108:111], v26 offset:19456
v_cvt_pk_bf16_f32 v79, v62, v63
v_mfma_f32_16x16x32_bf16 v[52:55], a[80:83], a[48:51], v[52:55]
s_waitcnt lgkmcnt(2)
buffer_load_dwordx4 v5, s[32:35], s85 offen offset:1024 lds
s_add_u32 m0, s67, 0
ds_read_b128 a[112:115], v26 offset:20480
v_mfma_f32_16x16x32_bf16 v[192:195], a[96:99], v[72:75], v[192:195]
ds_read_b128 a[116:119], v26 offset:21504
buffer_load_dwordx4 v6, s[32:35], s85 offen offset:2048 lds
v_mfma_f32_16x16x32_bf16 v[224:227], a[96:99], v[76:79], v[224:227]
ds_read_b128 a[120:123], v26 offset:22528
v_mfma_f32_16x16x32_bf16 v[228:231], a[100:103], v[76:79], v[228:231]
s_add_u32 m0, s67, 0
ds_read_b128 a[124:127], v26 offset:23552
v_mfma_f32_16x16x32_bf16 v[196:199], a[100:103], v[72:75], v[196:199]
s_waitcnt lgkmcnt(5)
buffer_load_dwordx4 v7, s[32:35], s85 offen offset:3072 lds
ds_read_b128 a[64:67], v26
v_mfma_f32_16x16x32_bf16 v[200:203], a[104:107], v[72:75], v[200:203]
ds_read_b128 a[68:71], v26 offset:1024
v_mfma_f32_16x16x32_bf16 v[232:235], a[104:107], v[76:79], v[232:235]
s_waitcnt lgkmcnt(6)
ds_read_b128 a[72:75], v26 offset:2048
v_mfma_f32_16x16x32_bf16 v[236:239], a[108:111], v[76:79], v[236:239]
ds_read_b128 a[76:79], v26 offset:3072
v_mfma_f32_16x16x32_bf16 v[204:207], a[108:111], v[72:75], v[204:207]
s_waitcnt lgkmcnt(7)
s_cmp_eq_u32 s50, 7
s_cbranch_scc1 L_latecaX
L_back_latecaX:
s_add_u32 m0, s67, 0x1000
v_mfma_f32_16x16x32_bf16 v[208:211], a[112:115], v[72:75], v[208:211]
buffer_load_dwordx4 v8, s[32:35], s85 offen lds
ds_read_b128 a[92:95], v26 offset:7168
v_mfma_f32_16x16x32_bf16 v[240:243], a[112:115], v[76:79], v[240:243]
s_waitcnt lgkmcnt(6)
ds_read_b128 a[88:91], v26 offset:6144
v_mfma_f32_16x16x32_bf16 v[244:247], a[116:119], v[76:79], v[244:247]
s_add_u32 m0, s67, 0x1000
v_exp_f32 v48, v48
v_mfma_f32_16x16x32_bf16 v[212:215], a[116:119], v[72:75], v[212:215]
buffer_load_dwordx4 v9, s[32:35], s85 offen offset:1024 lds
ds_read_b128 a[84:87], v26 offset:5120
v_mfma_f32_16x16x32_bf16 v[216:219], a[120:123], v[72:75], v[216:219]
s_waitcnt lgkmcnt(7)
v_exp_f32 v49, v49
v_mfma_f32_16x16x32_bf16 v[248:251], a[120:123], v[76:79], v[248:251]
s_add_u32 m0, s67, 0x1000
ds_read_b128 a[80:83], v26 offset:4096
v_cvt_pk_bf16_f32 v92, v48, v49
v_mfma_f32_16x16x32_bf16 v[252:255], a[124:127], v[76:79], v[252:255]
buffer_load_dwordx4 v10, s[32:35], s85 offen offset:2048 lds
v_mfma_f32_16x16x32_bf16 v[220:223], a[124:127], v[72:75], v[220:223]
v_exp_f32 v50, v50
v_mfma_f32_16x16x32_bf16 a[136:139], a[144:147], v[72:75], a[136:139]
s_waitcnt lgkmcnt(4)
v_exp_f32 v51, v51
v_mfma_f32_16x16x32_bf16 a[140:143], a[144:147], v[76:79], a[140:143]
s_add_u32 m0, s67, 0x1000
ds_read_b128 a[96:99], v26 offset:24576
v_cvt_pk_bf16_f32 v93, v50, v51
v_mfma_f32_16x16x32_bf16 v[56:59], a[64:67], a[48:51], v[108:111]
ds_read_b128 a[100:103], v26 offset:25600
buffer_load_dwordx4 v11, s[32:35], s85 offen offset:3072 lds
v_mfma_f32_16x16x32_bf16 v[56:59], a[68:71], a[52:55], v[56:59]
v_exp_f32 v52, v52
v_mfma_f32_16x16x32_bf16 v[56:59], a[72:75], a[56:59], v[56:59]
s_add_u32 m0, s67, 0x2000
v_exp_f32 v53, v53
v_mfma_f32_16x16x32_bf16 v[56:59], a[76:79], a[60:63], v[56:59]
s_waitcnt lgkmcnt(4)
ds_read_b128 a[104:107], v26 offset:26624
v_cvt_pk_bf16_f32 v94, v52, v53
v_mfma_f32_16x16x32_bf16 v[60:63], a[92:95], a[60:63], v[108:111]
ds_read_b128 a[108:111], v26 offset:27648
v_exp_f32 v54, v54
v_exp_f32 v55, v55
v_mfma_f32_16x16x32_bf16 v[60:63], a[88:91], a[56:59], v[60:63]
s_waitcnt lgkmcnt(4)
ds_read_b128 a[112:115], v26 offset:28672
v_cvt_pk_bf16_f32 v95, v54, v55
v_accvgpr_read_b32 v120, a136
s_mov_b32 s76, 0x21800000
v_cmp_nle_f32_e64 s[94:95], s76, v120
s_mov_b32 s76, 0x5d800000
v_cmp_nge_f32 vcc, s76, v120
s_or_b64 vcc, vcc, s[94:95]
s_cbranch_scc1 L_slow2X
L_back_slow2X:
v_mfma_f32_16x16x32_bf16 v[60:63], a[84:87], a[52:55], v[60:63]
buffer_load_dwordx4 v12, s[32:35], s85 offen lds
ds_read_b128 a[116:119], v26 offset:29696
v_accvgpr_read_b32 v120, a136
v_mfma_f32_16x16x32_bf16 v[60:63], a[80:83], a[48:51], v[60:63]
s_waitcnt lgkmcnt(4)
ds_read_b128 a[120:123], v26 offset:30720
v_rcp_f32 v120, v120
s_nop 0
v_mul_f32 v192, v120, v192
v_mfma_f32_16x16x32_bf16 v[224:227], a[96:99], v[92:95], v[224:227]
ds_read_b128 a[124:127], v26 offset:31744
v_mul_f32 v193, v120, v193
v_mfma_f32_16x16x32_bf16 v[228:231], a[100:103], v[92:95], v[228:231]
s_waitcnt lgkmcnt(5)
v_mul_f32 v194, v120, v194
v_mul_f32 v195, v120, v195
v_mfma_f32_16x16x32_bf16 v[232:235], a[104:107], v[92:95], v[232:235]
s_waitcnt lgkmcnt(4)
s_add_u32 s91, s91, 0x8000
ds_read_b128 a[64:67], v26 offset:8192
v_mul_f32 v196, v120, v196
v_mfma_f32_16x16x32_bf16 v[236:239], a[108:111], v[92:95], v[236:239]
s_waitcnt lgkmcnt(4)
ds_read_b128 a[68:71], v26 offset:9216
v_mul_f32 v197, v120, v197
v_mul_f32 v198, v120, v198
v_mfma_f32_16x16x32_bf16 v[240:243], a[112:115], v[92:95], v[240:243]
s_waitcnt lgkmcnt(4)
s_and_b32 s91, s91, 0x18000
ds_read_b128 a[72:75], v26 offset:10240
v_mul_f32 v199, v120, v199
v_mfma_f32_16x16x32_bf16 v[244:247], a[116:119], v[92:95], v[244:247]
s_waitcnt lgkmcnt(4)
ds_read_b128 a[76:79], v26 offset:11264
ds_read_b128 a[92:95], v26 offset:15360
ds_read_b128 a[88:91], v26 offset:14336
ds_read_b128 a[84:87], v26 offset:13312
ds_read_b128 a[80:83], v26 offset:12288
v_cvt_pk_bf16_f32 v192, v192, v193
v_cvt_pk_bf16_f32 v193, v194, v195
v_mfma_f32_16x16x32_bf16 v[248:251], a[120:123], v[92:95], v[248:251]
v_cvt_pk_bf16_f32 v194, v196, v197
s_waitcnt vmcnt(9)
s_barrier
s_waitcnt lgkmcnt(8)
v_mfma_f32_16x16x32_bf16 v[252:255], a[124:127], v[92:95], v[252:255]
v_cvt_pk_bf16_f32 v195, v198, v199
buffer_store_dwordx4 v[192:195], v1, s[4:7], s57 offen sc1
v_mfma_f32_16x16x32_bf16 a[140:143], a[144:147], v[92:95], a[140:143]
s_waitcnt lgkmcnt(7)
s_cmp_eq_u32 s50, 7
s_cbranch_scc1 L_latecbX
L_back_latecbX:
v_mul_f32 v200, v120, v200
v_add_u32 v26, s91, v2
v_mfma_f32_16x16x32_bf16 v[48:51], a[64:67], a[48:51], v[112:115]
s_waitcnt lgkmcnt(6)
v_mul_f32 v201, v120, v201
v_mul_f32 v202, v120, v202
v_mfma_f32_16x16x32_bf16 v[48:51], a[68:71], a[52:55], v[48:51]
s_waitcnt lgkmcnt(5)
ds_read_b128 a[96:99], v26 offset:16384
v_exp_f32 v56, v56
v_exp_f32 v57, v57
v_mul_f32 v203, v120, v203
v_mfma_f32_16x16x32_bf16 v[48:51], a[72:75], a[56:59], v[48:51]
s_waitcnt lgkmcnt(4)
ds_read_b128 a[100:103], v26 offset:17408
v_cvt_pk_bf16_f32 v76, v56, v57
v_exp_f32 v58, v58
v_exp_f32 v59, v59
v_mul_f32 v204, v120, v204
v_mul_f32 v205, v120, v205
v_mfma_f32_16x16x32_bf16 v[48:51], a[76:79], a[60:63], v[48:51]
ds_read_b128 a[104:107], v26 offset:18432
v_cvt_pk_bf16_f32 v77, v58, v59
v_exp_f32 v60, v60
v_exp_f32 v61, v61
v_mul_f32 v206, v120, v206
v_mfma_f32_16x16x32_bf16 v[52:55], a[92:95], a[60:63], v[116:119]
s_waitcnt lgkmcnt(3)
ds_read_b128 a[108:111], v26 offset:19456
v_cvt_pk_bf16_f32 v78, v60, v61
v_exp_f32 v62, v62
v_exp_f32 v63, v63
v_mul_f32 v207, v120, v207
v_cvt_pk_bf16_f32 v200, v200, v201
v_mfma_f32_16x16x32_bf16 v[52:55], a[88:91], a[56:59], v[52:55]
ds_read_b128 a[112:115], v26 offset:20480
v_cvt_pk_bf16_f32 v79, v62, v63
v_cvt_pk_bf16_f32 v201, v202, v203
v_mfma_f32_16x16x32_bf16 v[52:55], a[84:87], a[52:55], v[52:55]
ds_read_b128 a[116:119], v26 offset:21504
v_cvt_pk_bf16_f32 v202, v204, v205
v_cvt_pk_bf16_f32 v203, v206, v207
v_mfma_f32_16x16x32_bf16 v[52:55], a[80:83], a[48:51], v[52:55]
s_waitcnt lgkmcnt(5)
s_cmp_eq_u32 s50, 7
s_cbranch_scc1 L_lateccX
L_back_lateccX:
ds_read_b128 a[120:123], v26 offset:22528
buffer_store_dwordx4 v[200:203], v1, s[4:7], s57 offen offset:1024 sc1
v_mul_f32 v208, v120, v208
v_mfma_f32_16x16x32_bf16 v[224:227], a[96:99], v[76:79], v[224:227]
s_waitcnt lgkmcnt(5)
ds_read_b128 a[124:127], v26 offset:23552
v_mul_f32 v209, v120, v209
v_mfma_f32_16x16x32_bf16 v[228:231], a[100:103], v[76:79], v[228:231]
s_waitcnt lgkmcnt(5)
s_add_u32 s70, s48, 6
s_lshr_b32 s71, s70, 2
s_add_u32 s71, s71, s52
s_and_b32 s71, s71, 3
s_lshl_b32 s71, s71, 2
s_and_b32 s70, s70, 3
s_add_u32 s70, s70, s71
s_mul_i32 s70, s70, 0x9000
s_add_u32 s85, s64, s70
s_mul_i32 s67, s48, 0x2400
s_add_u32 s67, s67, s61
s_add_u32 s67, s67, 0x6c00
s_add_u32 m0, s67, 0
v_mul_f32 v210, v120, v210
v_mul_f32 v211, v120, v211
v_mfma_f32_16x16x32_bf16 v[232:235], a[104:107], v[76:79], v[232:235]
s_waitcnt lgkmcnt(3)
buffer_load_dwordx4 v4, s[32:35], s85 offen lds
ds_read_b128 a[96:99], v26 offset:24576
v_exp_f32 v48, v48
v_exp_f32 v49, v49
v_mul_f32 v212, v120, v212
v_mfma_f32_16x16x32_bf16 v[236:239], a[108:111], v[76:79], v[236:239]
s_waitcnt lgkmcnt(2)
ds_read_b128 a[100:103], v26 offset:25600
v_cvt_pk_bf16_f32 v92, v48, v49
v_exp_f32 v50, v50
v_exp_f32 v51, v51
v_mul_f32 v213, v120, v213
v_mul_f32 v214, v120, v214
v_mfma_f32_16x16x32_bf16 v[240:243], a[112:115], v[76:79], v[240:243]
s_add_u32 m0, s67, 0
ds_read_b128 a[104:107], v26 offset:26624
v_cvt_pk_bf16_f32 v93, v50, v51
v_mul_f32 v215, v120, v215
v_exp_f32 v52, v52
v_exp_f32 v53, v53
v_mfma_f32_16x16x32_bf16 v[244:247], a[116:119], v[76:79], v[244:247]
buffer_load_dwordx4 v5, s[32:35], s85 offen offset:1024 lds
ds_read_b128 a[108:111], v26 offset:27648
v_cvt_pk_bf16_f32 v208, v208, v209
v_cvt_pk_bf16_f32 v209, v210, v211
v_cvt_pk_bf16_f32 v94, v52, v53
v_exp_f32 v54, v54
v_exp_f32 v55, v55
v_mfma_f32_16x16x32_bf16 v[248:251], a[120:123], v[76:79], v[248:251]
s_waitcnt lgkmcnt(4)
ds_read_b128 a[112:115], v26 offset:28672
v_cvt_pk_bf16_f32 v210, v212, v213
v_cvt_pk_bf16_f32 v95, v54, v55
v_mfma_f32_16x16x32_bf16 v[252:255], a[124:127], v[76:79], v[252:255]
s_waitcnt lgkmcnt(4)
ds_read_b128 a[116:119], v26 offset:29696
v_cvt_pk_bf16_f32 v211, v214, v215
buffer_store_dwordx4 v[208:211], v1, s[4:7], s57 offen offset:2048 sc1
v_mfma_f32_16x16x32_bf16 a[140:143], a[144:147], v[76:79], a[140:143]
s_add_u32 m0, s67, 0
ds_read_b128 a[120:123], v26 offset:30720
v_mul_f32 v216, v120, v216
v_mfma_f32_16x16x32_bf16 v[224:227], a[96:99], v[92:95], v[224:227]
s_waitcnt lgkmcnt(5)
buffer_load_dwordx4 v6, s[32:35], s85 offen offset:2048 lds
ds_read_b128 a[124:127], v26 offset:31744
v_mul_f32 v217, v120, v217
v_mul_f32 v218, v120, v218
v_mfma_f32_16x16x32_bf16 v[228:231], a[100:103], v[92:95], v[228:231]
s_waitcnt lgkmcnt(5)
s_add_u32 m0, s67, 0
v_mul_f32 v219, v120, v219
v_mul_f32 v220, v120, v220
v_mfma_f32_16x16x32_bf16 v[232:235], a[104:107], v[92:95], v[232:235]
s_waitcnt lgkmcnt(4)
buffer_load_dwordx4 v7, s[32:35], s85 offen offset:3072 lds
v_mul_f32 v221, v120, v221
v_mfma_f32_16x16x32_bf16 v[236:239], a[108:111], v[92:95], v[236:239]
s_waitcnt lgkmcnt(3)
s_add_u32 m0, s67, 0x1000
v_mul_f32 v222, v120, v222
v_mul_f32 v223, v120, v223
v_mfma_f32_16x16x32_bf16 v[240:243], a[112:115], v[92:95], v[240:243]
s_waitcnt lgkmcnt(2)
v_cvt_pk_bf16_f32 v216, v216, v217
v_cvt_pk_bf16_f32 v217, v218, v219
v_mfma_f32_16x16x32_bf16 v[244:247], a[116:119], v[92:95], v[244:247]
s_waitcnt lgkmcnt(1)
v_cvt_pk_bf16_f32 v218, v220, v221
v_cvt_pk_bf16_f32 v219, v222, v223
v_mfma_f32_16x16x32_bf16 v[248:251], a[120:123], v[92:95], v[248:251]
s_waitcnt lgkmcnt(0)
buffer_load_dwordx4 v8, s[32:35], s85 offen lds
buffer_store_dwordx4 v[216:219], v1, s[4:7], s57 offen offset:3072 sc1
v_mfma_f32_16x16x32_bf16 v[252:255], a[124:127], v[92:95], v[252:255]
s_add_u32 m0, s67, 0x1000
v_mfma_f32_16x16x32_bf16 a[140:143], a[144:147], v[92:95], a[140:143]
buffer_load_dwordx4 v9, s[32:35], s85 offen offset:1024 lds
s_add_u32 m0, s67, 0x1000
s_nop 0
buffer_load_dwordx4 v10, s[32:35], s85 offen offset:2048 lds
s_add_u32 m0, s67, 0x1000
s_nop 0
buffer_load_dwordx4 v11, s[32:35], s85 offen offset:3072 lds
s_add_u32 m0, s67, 0x2000
s_nop 0
buffer_load_dwordx4 v12, s[32:35], s85 offen lds
s_branch L_tail
L_setcb1:
s_nop 7
v_cmp_gt_i32_e64 s[80:81], 0, v27
v_cmp_gt_i32_e64 s[82:83], 1, v27
s_nop 0
v_cndmask_b32_e64 v120, v104, v29, s[80:81]
v_cndmask_b32_e64 v121, v104, v29, s[82:83]
v_cmp_gt_i32_e64 s[80:81], 2, v27
v_cmp_gt_i32_e64 s[82:83], 3, v27
s_nop 0
v_cndmask_b32_e64 v122, v104, v29, s[80:81]
v_cndmask_b32_e64 v123, v104, v29, s[82:83]
v_cmp_gt_i32_e64 s[80:81], 16, v27
v_cmp_gt_i32_e64 s[82:83], 17, v27
s_nop 0
v_cndmask_b32_e64 v124, v104, v29, s[80:81]
v_cndmask_b32_e64 v125, v104, v29, s[82:83]
v_cmp_gt_i32_e64 s[80:81], 18, v27
v_cmp_gt_i32_e64 s[82:83], 19, v27
s_nop 0
v_cndmask_b32_e64 v126, v104, v29, s[80:81]
v_cndmask_b32_e64 v127, v104, v29, s[82:83]
s_nop 1
s_branch L_back_setcb1
L_spin_caP:
s_mov_b32 s93, 0x8000
L_spinloop_caP:
buffer_load_dword v19, v3, s[4:7], s76 offen sc1
s_waitcnt vmcnt(0)
v_cmp_ne_u32 vcc, v19, v18
s_nop 1
s_cbranch_vccz L_back_caP
s_sub_u32 s93, s93, 1
s_cmp_lg_u32 s93, 0
s_cbranch_scc1 L_spinloop_caP
v_mov_b32 v19, 3
buffer_store_dword v19, v20, s[44:47], 0 offen offset:4
s_branch L_back_caP
L_spin_caX:
s_mov_b32 s93, 0x8000
L_spinloop_caX:
buffer_load_dword v19, v3, s[4:7], s77 offen sc1
s_waitcnt vmcnt(0)
v_cmp_ne_u32 vcc, v19, v18
s_nop 1
s_cbranch_vccz L_back_caX
s_sub_u32 s93, s93, 1
s_cmp_lg_u32 s93, 0
s_cbranch_scc1 L_spinloop_caX
v_mov_b32 v19, 3
buffer_store_dword v19, v20, s[44:47], 0 offen offset:4
s_branch L_back_caX
L_latecaX:
s_nop 0
s_lshl_b32 s77, s50, 3
s_add_u32 s77, s77, s51
s_lshl_b32 s77, s77, 3
s_add_u32 s77, s77, s48
s_lshl_b32 s77, s77, 2
s_lshl_b32 s77, s77, 2
s_add_u32 s77, s77, 0x5003000
v_and_b32 v3, 12, v21
buffer_load_dword v19, v3, s[4:7], s77 offen sc1
s_nop 1
s_branch L_back_latecaX
L_latecbX:
s_nop 0
s_lshl_b32 s77, s50, 3
s_add_u32 s77, s77, s51
s_lshl_b32 s77, s77, 3
s_add_u32 s77, s77, s48
s_lshl_b32 s77, s77, 2
s_lshl_b32 s77, s77, 2
s_add_u32 s77, s77, 0x5003000
s_waitcnt vmcnt(5)
v_cmp_ne_u32 vcc, v19, v18
s_nop 1
s_cbranch_vccnz L_spin_caX
L_back_caX:
s_add_u32 s70, s52, 1
s_and_b32 s70, s70, 3
s_sub_u32 s70, s70, s52
s_lshl_b32 s70, s70, 12
s_add_u32 s65, s55, s70
s_add_u32 s66, s56, s70
buffer_load_dwordx4 a[148:151], v1, s[4:7], s65 offen sc1
buffer_load_dwordx4 a[152:155], v1, s[4:7], s66 offen sc1
buffer_load_dwordx4 a[156:159], v1, s[4:7], s65 offen offset:1024 sc1
buffer_load_dwordx4 a[160:163], v1, s[4:7], s66 offen offset:1024 sc1
buffer_load_dwordx4 a[164:167], v1, s[4:7], s65 offen offset:2048 sc1
buffer_load_dwordx4 a[168:171], v1, s[4:7], s66 offen offset:2048 sc1
s_nop 1
s_branch L_back_latecbX
L_lateccX:
s_nop 0
buffer_load_dwordx4 a[172:175], v1, s[4:7], s65 offen offset:3072 sc1
buffer_load_dwordx4 a[176:179], v1, s[4:7], s66 offen offset:3072 sc1
s_add_u32 s70, s52, 2
s_and_b32 s70, s70, 3
s_sub_u32 s70, s70, s52
s_lshl_b32 s70, s70, 12
s_add_u32 s65, s55, s70
s_add_u32 s66, s56, s70
buffer_load_dwordx4 a[180:183], v1, s[4:7], s65 offen sc1
buffer_load_dwordx4 a[184:187], v1, s[4:7], s66 offen sc1
buffer_load_dwordx4 a[188:191], v1, s[4:7], s65 offen offset:1024 sc1
buffer_load_dwordx4 a[192:195], v1, s[4:7], s66 offen offset:1024 sc1
s_nop 1
s_branch L_back_lateccX
L_spin_caY:
s_mov_b32 s93, 0x8000
L_spinloop_caY:
buffer_load_dword v19, v3, s[4:7], s77 offen sc1
s_waitcnt vmcnt(0)
v_cmp_ne_u32 vcc, v19, v18
s_nop 1
s_cbranch_vccz L_back_caY
s_sub_u32 s93, s93, 1
s_cmp_lg_u32 s93, 0
s_cbranch_scc1 L_spinloop_caY
v_mov_b32 v19, 3
buffer_store_dword v19, v20, s[44:47], 0 offen offset:4
s_branch L_back_caY
L_latecaY:
s_nop 0
s_lshl_b32 s77, s50, 3
s_add_u32 s77, s77, s51
s_lshl_b32 s77, s77, 3
s_add_u32 s77, s77, s48
s_lshl_b32 s77, s77, 2
s_lshl_b32 s77, s77, 2
s_add_u32 s77, s77, 0x5003000
v_and_b32 v3, 12, v21
buffer_load_dword v19, v3, s[4:7], s77 offen sc1
s_nop 1
s_branch L_back_latecaY
L_latecbY:
s_nop 0
s_lshl_b32 s77, s50, 3
s_add_u32 s77, s77, s51
s_lshl_b32 s77, s77, 3
s_add_u32 s77, s77, s48
s_lshl_b32 s77, s77, 2
s_lshl_b32 s77, s77, 2
s_add_u32 s77, s77, 0x5003000
s_waitcnt vmcnt(5)
v_cmp_ne_u32 vcc, v19, v18
s_nop 1
s_cbranch_vccnz L_spin_caY
L_back_caY:
s_add_u32 s70, s52, 1
s_and_b32 s70, s70, 3
s_sub_u32 s70, s70, s52
s_lshl_b32 s70, s70, 12
s_add_u32 s65, s55, s70
s_add_u32 s66, s56, s70
buffer_load_dwordx4 a[148:151], v1, s[4:7], s65 offen sc1
buffer_load_dwordx4 a[152:155], v1, s[4:7], s66 offen sc1
buffer_load_dwordx4 a[156:159], v1, s[4:7], s65 offen offset:1024 sc1
buffer_load_dwordx4 a[160:163], v1, s[4:7], s66 offen offset:1024 sc1
buffer_load_dwordx4 a[164:167], v1, s[4:7], s65 offen offset:2048 sc1
buffer_load_dwordx4 a[168:171], v1, s[4:7], s66 offen offset:2048 sc1
s_nop 1
s_branch L_back_latecbY
L_lateccY:
s_nop 0
buffer_load_dwordx4 a[172:175], v1, s[4:7], s65 offen offset:3072 sc1
buffer_load_dwordx4 a[176:179], v1, s[4:7], s66 offen offset:3072 sc1
s_add_u32 s70, s52, 2
s_and_b32 s70, s70, 3
s_sub_u32 s70, s70, s52
s_lshl_b32 s70, s70, 12
s_add_u32 s65, s55, s70
s_add_u32 s66, s56, s70
buffer_load_dwordx4 a[180:183], v1, s[4:7], s65 offen sc1
buffer_load_dwordx4 a[184:187], v1, s[4:7], s66 offen sc1
buffer_load_dwordx4 a[188:191], v1, s[4:7], s65 offen offset:1024 sc1
buffer_load_dwordx4 a[192:195], v1, s[4:7], s66 offen offset:1024 sc1
s_nop 1
s_branch L_back_lateccY
L_bdY:
s_waitcnt lgkmcnt(4)
v_mfma_f32_16x16x32_bf16 v[48:51], a[64:67], a[32:35], v[112:115]
v_exp_f32 v60, v60
v_mfma_f32_16x16x32_bf16 v[48:51], a[68:71], a[36:39], v[48:51]
v_exp_f32 v61, v61
v_mfma_f32_16x16x32_bf16 v[48:51], a[72:75], a[40:43], v[48:51]
s_waitcnt lgkmcnt(1)
ds_read_b128 a[96:99], v26 offset:16384
v_cvt_pk_bf16_f32 v78, v60, v61
v_mfma_f32_16x16x32_bf16 v[48:51], a[76:79], a[44:47], v[48:51]
s_add_u32 s70, s48, 3
s_lshr_b32 s71, s70, 2
s_add_u32 s71, s71, s52
s_and_b32 s71, s71, 3
s_lshl_b32 s71, s71, 2
s_and_b32 s70, s70, 3
s_add_u32 s70, s70, s71
s_mul_i32 s70, s70, 0x9000
s_add_u32 s85, s64, s70
s_mul_i32 s67, s48, 0x2400
s_add_u32 s67, s67, s61
s_cmp_lt_u32 s48, 3
s_cselect_b32 s67, s67, 0x28000
s_cselect_b32 s85, s85, 0x40000000
s_add_u32 m0, s67, 0
v_mfma_f32_16x16x32_bf16 v[52:55], a[92:95], a[44:47], v[116:119]
buffer_load_dwordx4 v4, s[32:35], s85 offen lds
s_add_u32 m0, s67, 0
ds_read_b128 a[100:103], v26 offset:17408
v_mfma_f32_16x16x32_bf16 v[52:55], a[88:91], a[40:43], v[52:55]
buffer_load_dwordx4 v5, s[32:35], s85 offen offset:1024 lds
ds_read_b128 a[104:107], v26 offset:18432
v_mfma_f32_16x16x32_bf16 v[52:55], a[84:87], a[36:39], v[52:55]
s_waitcnt lgkmcnt(3)
v_exp_f32 v62, v62
v_mfma_f32_16x16x32_bf16 v[52:55], a[80:83], a[32:35], v[52:55]
s_add_u32 m0, s67, 0
v_exp_f32 v63, v63
v_mfma_f32_16x16x32_bf16 v[56:59], a[64:67], a[48:51], v[108:111]
buffer_load_dwordx4 v6, s[32:35], s85 offen offset:2048 lds
v_cvt_pk_bf16_f32 v79, v62, v63
v_mfma_f32_16x16x32_bf16 v[56:59], a[68:71], a[52:55], v[56:59]
ds_read_b128 a[108:111], v26 offset:19456
v_mfma_f32_16x16x32_bf16 v[56:59], a[72:75], a[56:59], v[56:59]
s_add_u32 m0, s67, 0
ds_read_b128 a[112:115], v26 offset:20480
v_mfma_f32_16x16x32_bf16 v[56:59], a[76:79], a[60:63], v[56:59]
buffer_load_dwordx4 v7, s[32:35], s85 offen offset:3072 lds
ds_read_b128 a[116:119], v26 offset:21504
v_mfma_f32_16x16x32_bf16 v[60:63], a[92:95], a[60:63], v[108:111]
ds_read_b128 a[120:123], v26 offset:22528
v_mfma_f32_16x16x32_bf16 v[60:63], a[88:91], a[56:59], v[60:63]
v_cmp_gt_i32_e64 s[80:81], 0, v28
v_cmp_gt_i32_e64 s[82:83], 1, v28
v_mfma_f32_16x16x32_bf16 v[60:63], a[84:87], a[52:55], v[60:63]
s_waitcnt lgkmcnt(4)
ds_read_b128 a[124:127], v26 offset:23552
v_mfma_f32_16x16x32_bf16 v[60:63], a[80:83], a[48:51], v[60:63]
s_cmp_eq_u32 s50, 7
s_cbranch_scc1 L_latecaY
L_back_latecaY:
s_add_u32 m0, s67, 0x1000
v_mfma_f32_16x16x32_bf16 v[192:195], a[96:99], v[72:75], v[192:195]
buffer_load_dwordx4 v8, s[32:35], s85 offen lds
ds_read_b128 a[64:67], v26
v_mfma_f32_16x16x32_bf16 v[224:227], a[96:99], v[76:79], v[224:227]
ds_read_b128 a[68:71], v26 offset:1024
v_mfma_f32_16x16x32_bf16 v[228:231], a[100:103], v[76:79], v[228:231]
s_add_u32 m0, s67, 0x1000
v_exp_f32 v48, v48
v_mfma_f32_16x16x32_bf16 v[196:199], a[100:103], v[72:75], v[196:199]
buffer_load_dwordx4 v9, s[32:35], s85 offen offset:1024 lds
ds_read_b128 a[72:75], v26 offset:2048
v_mfma_f32_16x16x32_bf16 v[200:203], a[104:107], v[72:75], v[200:203]
s_waitcnt lgkmcnt(5)
v_exp_f32 v49, v49
v_mfma_f32_16x16x32_bf16 v[232:235], a[104:107], v[76:79], v[232:235]
s_add_u32 m0, s67, 0x1000
ds_read_b128 a[76:79], v26 offset:3072
v_cvt_pk_bf16_f32 v88, v48, v49
v_mfma_f32_16x16x32_bf16 v[236:239], a[108:111], v[76:79], v[236:239]
buffer_load_dwordx4 v10, s[32:35], s85 offen offset:2048 lds
v_mfma_f32_16x16x32_bf16 v[204:207], a[108:111], v[72:75], v[204:207]
ds_read_b128 a[92:95], v26 offset:7168
v_mfma_f32_16x16x32_bf16 v[208:211], a[112:115], v[72:75], v[208:211]
v_exp_f32 v50, v50
v_mfma_f32_16x16x32_bf16 v[240:243], a[112:115], v[76:79], v[240:243]
s_add_u32 m0, s67, 0x1000
v_exp_f32 v51, v51
v_mfma_f32_16x16x32_bf16 v[244:247], a[116:119], v[76:79], v[244:247]
buffer_load_dwordx4 v11, s[32:35], s85 offen offset:3072 lds
ds_read_b128 a[88:91], v26 offset:6144
v_mfma_f32_16x16x32_bf16 v[212:215], a[116:119], v[72:75], v[212:215]
s_waitcnt lgkmcnt(6)
ds_read_b128 a[84:87], v26 offset:5120
v_cvt_pk_bf16_f32 v89, v50, v51
v_mfma_f32_16x16x32_bf16 v[216:219], a[120:123], v[72:75], v[216:219]
s_add_u32 m0, s67, 0x2000
v_exp_f32 v52, v52
v_mfma_f32_16x16x32_bf16 v[248:251], a[120:123], v[76:79], v[248:251]
buffer_load_dwordx4 v12, s[32:35], s85 offen lds
ds_read_b128 a[80:83], v26 offset:4096
v_mfma_f32_16x16x32_bf16 v[252:255], a[124:127], v[76:79], v[252:255]
v_exp_f32 v53, v53
v_mfma_f32_16x16x32_bf16 v[220:223], a[124:127], v[72:75], v[220:223]
s_nop 0
v_cndmask_b32_e64 v120, v108, v29, s[80:81]
v_cndmask_b32_e64 v121, v108, v29, s[82:83]
v_cmp_gt_i32_e64 s[80:81], 2, v28
v_cmp_gt_i32_e64 s[82:83], 3, v28
s_nop 0
v_cndmask_b32_e64 v122, v108, v29, s[80:81]
v_cndmask_b32_e64 v123, v108, v29, s[82:83]
v_cmp_gt_i32_e64 s[80:81], 16, v28
v_cmp_gt_i32_e64 s[82:83], 17, v28
s_nop 0
v_cndmask_b32_e64 v124, v108, v29, s[80:81]
v_cndmask_b32_e64 v125, v108, v29, s[82:83]
v_cmp_gt_i32_e64 s[80:81], 18, v28
v_cmp_gt_i32_e64 s[82:83], 19, v28
s_nop 0
v_cndmask_b32_e64 v126, v108, v29, s[80:81]
v_cndmask_b32_e64 v127, v108, v29, s[82:83]
v_mfma_f32_16x16x32_bf16 a[136:139], a[144:147], v[72:75], a[136:139]
v_cvt_pk_bf16_f32 v90, v52, v53
v_mfma_f32_16x16x32_bf16 a[140:143], a[144:147], v[76:79], a[140:143]
s_waitcnt lgkmcnt(5)
v_exp_f32 v54, v54
v_mfma_f32_16x16x32_bf16 v[48:51], a[64:67], a[48:51], v[120:123]
v_exp_f32 v55, v55
v_mfma_f32_16x16x32_bf16 v[48:51], a[68:71], a[52:55], v[48:51]
ds_read_b128 a[96:99], v26 offset:24576
v_cvt_pk_bf16_f32 v91, v54, v55
v_mfma_f32_16x16x32_bf16 v[48:51], a[72:75], a[56:59], v[48:51]
s_waitcnt lgkmcnt(4)
v_exp_f32 v56, v56
v_exp_f32 v57, v57
v_mfma_f32_16x16x32_bf16 v[48:51], a[76:79], a[60:63], v[48:51]
ds_read_b128 a[100:103], v26 offset:25600
v_cvt_pk_bf16_f32 v92, v56, v57
v_exp_f32 v58, v58
v_exp_f32 v59, v59
v_mfma_f32_16x16x32_bf16 v[52:55], a[92:95], a[60:63], v[124:127]
s_waitcnt lgkmcnt(2)
v_cvt_pk_bf16_f32 v93, v58, v59
v_exp_f32 v60, v60
v_exp_f32 v61, v61
v_mfma_f32_16x16x32_bf16 v[52:55], a[88:91], a[56:59], v[52:55]
ds_read_b128 a[104:107], v26 offset:26624
v_cvt_pk_bf16_f32 v94, v60, v61
v_exp_f32 v62, v62
v_exp_f32 v63, v63
v_mfma_f32_16x16x32_bf16 v[52:55], a[84:87], a[52:55], v[52:55]
ds_read_b128 a[108:111], v26 offset:27648
v_cvt_pk_bf16_f32 v95, v62, v63
v_mfma_f32_16x16x32_bf16 v[52:55], a[80:83], a[48:51], v[52:55]
s_waitcnt lgkmcnt(3)
ds_read_b128 a[112:115], v26 offset:28672
v_mfma_f32_16x16x32_bf16 v[192:195], a[96:99], v[88:91], v[192:195]
ds_read_b128 a[116:119], v26 offset:29696
v_mfma_f32_16x16x32_bf16 v[224:227], a[96:99], v[92:95], v[224:227]
s_waitcnt lgkmcnt(4)
ds_read_b128 a[120:123], v26 offset:30720
v_mfma_f32_16x16x32_bf16 v[228:231], a[100:103], v[92:95], v[228:231]
ds_read_b128 a[124:127], v26 offset:31744
v_mfma_f32_16x16x32_bf16 v[196:199], a[100:103], v[88:91], v[196:199]
s_waitcnt lgkmcnt(5)
v_exp_f32 v48, v48
v_mfma_f32_16x16x32_bf16 v[200:203], a[104:107], v[88:91], v[200:203]
s_add_u32 s91, s91, 0x8000
v_exp_f32 v49, v49
v_mfma_f32_16x16x32_bf16 v[232:235], a[104:107], v[92:95], v[232:235]
s_waitcnt lgkmcnt(4)
s_and_b32 s91, s91, 0x18000
v_cvt_pk_bf16_f32 v76, v48, v49
v_mfma_f32_16x16x32_bf16 v[236:239], a[108:111], v[92:95], v[236:239]
v_exp_f32 v50, v50
v_mfma_f32_16x16x32_bf16 v[204:207], a[108:111], v[88:91], v[204:207]
s_waitcnt lgkmcnt(3)
v_exp_f32 v51, v51
v_mfma_f32_16x16x32_bf16 v[208:211], a[112:115], v[88:91], v[208:211]
s_waitcnt vmcnt(9)
s_barrier
v_mfma_f32_16x16x32_bf16 v[240:243], a[112:115], v[92:95], v[240:243]
s_waitcnt lgkmcnt(1)
v_add_u32 v26, s91, v2
ds_read_b128 a[96:99], v26 offset:16384
v_mfma_f32_16x16x32_bf16 v[244:247], a[116:119], v[92:95], v[244:247]
s_cmp_eq_u32 s50, 7
s_cbranch_scc1 L_latecbY
L_back_latecbY:
v_mfma_f32_16x16x32_bf16 v[212:215], a[116:119], v[88:91], v[212:215]
ds_read_b128 a[100:103], v26 offset:17408
v_cvt_pk_bf16_f32 v77, v50, v51
v_mfma_f32_16x16x32_bf16 v[216:219], a[120:123], v[88:91], v[216:219]
v_exp_f32 v52, v52
v_mfma_f32_16x16x32_bf16 v[248:251], a[120:123], v[92:95], v[248:251]
s_waitcnt lgkmcnt(2)
ds_read_b128 a[104:107], v26 offset:18432
v_exp_f32 v53, v53
v_mfma_f32_16x16x32_bf16 v[252:255], a[124:127], v[92:95], v[252:255]
ds_read_b128 a[108:111], v26 offset:19456
v_cvt_pk_bf16_f32 v78, v52, v53
v_exp_f32 v54, v54
v_exp_f32 v55, v55
v_mfma_f32_16x16x32_bf16 v[220:223], a[124:127], v[88:91], v[220:223]
ds_read_b128 a[112:115], v26 offset:20480
v_cvt_pk_bf16_f32 v79, v54, v55
v_mfma_f32_16x16x32_bf16 a[136:139], a[144:147], v[88:91], a[136:139]
ds_read_b128 a[116:119], v26 offset:21504
v_mfma_f32_16x16x32_bf16 a[140:143], a[144:147], v[92:95], a[140:143]
s_waitcnt lgkmcnt(5)
ds_read_b128 a[120:123], v26 offset:22528
v_mfma_f32_16x16x32_bf16 v[224:227], a[96:99], v[76:79], v[224:227]
s_waitcnt lgkmcnt(5)
s_cmp_eq_u32 s50, 7
s_cbranch_scc1 L_lateccY
L_back_lateccY:
ds_read_b128 a[124:127], v26 offset:23552
v_mfma_f32_16x16x32_bf16 v[228:231], a[100:103], v[76:79], v[228:231]
s_waitcnt lgkmcnt(5)
v_mfma_f32_16x16x32_bf16 v[232:235], a[104:107], v[76:79], v[232:235]
s_waitcnt lgkmcnt(4)
s_add_u32 s70, s48, 6
s_lshr_b32 s71, s70, 2
s_add_u32 s71, s71, s52
s_and_b32 s71, s71, 3
s_lshl_b32 s71, s71, 2
s_and_b32 s70, s70, 3
s_add_u32 s70, s70, s71
s_mul_i32 s70, s70, 0x9000
s_add_u32 s85, s64, s70
s_mul_i32 s67, s48, 0x2400
s_add_u32 s67, s67, s61
s_add_u32 s67, s67, 0x6c00
s_add_u32 m0, s67, 0
v_mfma_f32_16x16x32_bf16 v[236:239], a[108:111], v[76:79], v[236:239]
s_waitcnt lgkmcnt(3)
buffer_load_dwordx4 v4, s[32:35], s85 offen lds
s_add_u32 m0, s67, 0
v_mfma_f32_16x16x32_bf16 v[240:243], a[112:115], v[76:79], v[240:243]
s_waitcnt lgkmcnt(2)
v_accvgpr_read_b32 v112, a136
s_mov_b32 s76, 0x21800000
v_cmp_nle_f32_e64 s[94:95], s76, v112
s_mov_b32 s76, 0x5d800000
v_cmp_nge_f32 vcc, s76, v112
s_or_b64 vcc, vcc, s[94:95]
s_cbranch_scc1 L_slow2Y
L_back_slow2Y:
v_accvgpr_read_b32 v112, a136
v_rcp_f32 v112, v112
s_nop 0
v_mul_f32 v192, v112, v192
v_mul_f32 v193, v112, v193
v_mul_f32 v194, v112, v194
v_mul_f32 v195, v112, v195
v_mul_f32 v196, v112, v196
v_mul_f32 v197, v112, v197
v_mul_f32 v198, v112, v198
v_mul_f32 v199, v112, v199
v_cvt_pk_bf16_f32 v192, v192, v193
v_mfma_f32_16x16x32_bf16 v[244:247], a[116:119], v[76:79], v[244:247]
s_waitcnt lgkmcnt(1)
v_cvt_pk_bf16_f32 v193, v194, v195
v_cvt_pk_bf16_f32 v194, v196, v197
v_cvt_pk_bf16_f32 v195, v198, v199
buffer_store_dwordx4 v[192:195], v1, s[4:7], s57 offen sc1
v_mul_f32 v200, v112, v200
v_mul_f32 v201, v112, v201
v_mul_f32 v202, v112, v202
v_mul_f32 v203, v112, v203
v_mul_f32 v204, v112, v204
v_mul_f32 v205, v112, v205
v_mul_f32 v206, v112, v206
v_mul_f32 v207, v112, v207
v_cvt_pk_bf16_f32 v200, v200, v201
v_cvt_pk_bf16_f32 v201, v202, v203
v_mfma_f32_16x16x32_bf16 v[248:251], a[120:123], v[76:79], v[248:251]
s_waitcnt lgkmcnt(0)
buffer_load_dwordx4 v5, s[32:35], s85 offen offset:1024 lds
v_cvt_pk_bf16_f32 v202, v204, v205
v_cvt_pk_bf16_f32 v203, v206, v207
buffer_store_dwordx4 v[200:203], v1, s[4:7], s57 offen offset:1024 sc1
v_mul_f32 v208, v112, v208
v_mul_f32 v209, v112, v209
v_mul_f32 v210, v112, v210
v_mul_f32 v211, v112, v211
v_mul_f32 v212, v112, v212
v_mul_f32 v213, v112, v213
v_mul_f32 v214, v112, v214
v_mul_f32 v215, v112, v215
v_cvt_pk_bf16_f32 v208, v208, v209
v_cvt_pk_bf16_f32 v209, v210, v211
v_cvt_pk_bf16_f32 v210, v212, v213
v_cvt_pk_bf16_f32 v211, v214, v215
v_mfma_f32_16x16x32_bf16 v[252:255], a[124:127], v[76:79], v[252:255]
buffer_store_dwordx4 v[208:211], v1, s[4:7], s57 offen offset:2048 sc1
v_mul_f32 v216, v112, v216
v_mul_f32 v217, v112, v217
v_mul_f32 v218, v112, v218
v_mul_f32 v219, v112, v219
v_mul_f32 v220, v112, v220
v_mul_f32 v221, v112, v221
v_mul_f32 v222, v112, v222
v_mul_f32 v223, v112, v223
v_cvt_pk_bf16_f32 v216, v216, v217
v_cvt_pk_bf16_f32 v217, v218, v219
v_cvt_pk_bf16_f32 v218, v220, v221
v_cvt_pk_bf16_f32 v219, v222, v223
buffer_store_dwordx4 v[216:219], v1, s[4:7], s57 offen offset:3072 sc1
v_mfma_f32_16x16x32_bf16 a[140:143], a[144:147], v[76:79], a[140:143]
s_add_u32 m0, s67, 0
s_nop 0
buffer_load_dwordx4 v6, s[32:35], s85 offen offset:2048 lds
s_add_u32 m0, s67, 0
s_nop 0
buffer_load_dwordx4 v7, s[32:35], s85 offen offset:3072 lds
s_add_u32 m0, s67, 0x1000
s_nop 0
buffer_load_dwordx4 v8, s[32:35], s85 offen lds
s_add_u32 m0, s67, 0x1000
s_nop 0
buffer_load_dwordx4 v9, s[32:35], s85 offen offset:1024 lds
s_add_u32 m0, s67, 0x1000
s_nop 0
buffer_load_dwordx4 v10, s[32:35], s85 offen offset:2048 lds
s_add_u32 m0, s67, 0x1000
s_nop 0
buffer_load_dwordx4 v11, s[32:35], s85 offen offset:3072 lds
s_add_u32 m0, s67, 0x2000
s_nop 0
buffer_load_dwordx4 v12, s[32:35], s85 offen lds
L_tail:
s_nop 7
v_accvgpr_read_b32 v112, a140
s_mov_b32 s76, 0x21800000
v_cmp_nle_f32_e64 s[94:95], s76, v112
s_mov_b32 s76, 0x5d800000
v_cmp_nge_f32 vcc, s76, v112
s_or_b64 vcc, vcc, s[94:95]
s_cbranch_scc1 L_slow3
L_back_slow3:
s_waitcnt vmcnt(13)
s_barrier
ds_read_b64_tr_b16 a[64:65], v13
ds_read_b64_tr_b16 a[66:67], v13 offset:4608
ds_read_b64_tr_b16 a[68:69], v13 offset:9216
ds_read_b64_tr_b16 a[70:71], v13 offset:13824
ds_read_b64_tr_b16 a[72:73], v13 offset:32
ds_read_b64_tr_b16 a[74:75], v13 offset:4640
ds_read_b64_tr_b16 a[76:77], v13 offset:9248
ds_read_b64_tr_b16 a[78:79], v13 offset:13856
v_accvgpr_read_b32 v112, a140
v_rcp_f32 v112, v112
s_nop 0
s_waitcnt lgkmcnt(6)
v_mfma_f32_16x16x32_bf16 v[32:35], a[64:67], v[128:131], 0
s_waitcnt lgkmcnt(4)
ds_read_b64_tr_b16 a[80:81], v13 offset:64
v_mul_f32 v224, v112, v224
v_mfma_f32_16x16x32_bf16 v[32:35], a[68:71], v[136:139], v[32:35]
ds_read_b64_tr_b16 a[82:83], v13 offset:4672
v_mul_f32 v225, v112, v225
v_mfma_f32_16x16x32_bf16 v[36:39], a[68:71], v[168:171], 0
s_add_u32 s70, s48, 10
s_lshr_b32 s71, s70, 2
s_add_u32 s71, s71, s52
s_and_b32 s71, s71, 3
s_lshl_b32 s71, s71, 2
s_and_b32 s70, s70, 3
s_add_u32 s70, s70, s71
s_mul_i32 s70, s70, 0x9000
s_add_u32 s85, s64, s70
s_mul_i32 s67, s48, 0x2400
s_add_u32 s67, s67, s62
s_add_u32 m0, s67, 0
ds_read_b64_tr_b16 a[84:85], v13 offset:9280
ds_read_b64_tr_b16 a[86:87], v13 offset:13888
v_mfma_f32_16x16x32_bf16 v[36:39], a[64:67], v[160:163], v[36:39]
s_waitcnt lgkmcnt(5)
buffer_load_dwordx4 v4, s[32:35], s85 offen lds
v_mul_f32 v226, v112, v226
v_mul_f32 v227, v112, v227
v_mfma_f32_16x16x32_bf16 v[44:47], a[72:75], v[160:163], 0
s_waitcnt lgkmcnt(4)
s_add_u32 m0, s67, 0
ds_read_b64_tr_b16 a[88:89], v13 offset:96
v_mul_f32 v228, v112, v228
v_mfma_f32_16x16x32_bf16 v[44:47], a[76:79], v[168:171], v[44:47]
ds_read_b64_tr_b16 a[90:91], v13 offset:4704
buffer_load_dwordx4 v5, s[32:35], s85 offen offset:1024 lds
v_mul_f32 v229, v112, v229
v_mfma_f32_16x16x32_bf16 v[40:43], a[76:79], v[136:139], 0
ds_read_b64_tr_b16 a[92:93], v13 offset:9312
ds_read_b64_tr_b16 a[94:95], v13 offset:13920
v_mul_f32 v230, v112, v230
v_mul_f32 v231, v112, v231
v_mfma_f32_16x16x32_bf16 v[40:43], a[72:75], v[128:131], v[40:43]
s_waitcnt lgkmcnt(6)
s_add_u32 m0, s67, 0
v_cvt_pk_bf16_f32 v224, v224, v225
v_cvt_pk_bf16_f32 v225, v226, v227
v_mfma_f32_16x16x32_bf16 v[48:51], a[80:83], v[128:131], 0
s_waitcnt lgkmcnt(4)
buffer_load_dwordx4 v6, s[32:35], s85 offen offset:2048 lds
s_add_u32 m0, s67, 0
v_cvt_pk_bf16_f32 v226, v228, v229
v_mfma_f32_16x16x32_bf16 v[48:51], a[84:87], v[136:139], v[48:51]
ds_read_b64_tr_b16 a[64:65], v13 offset:128
ds_read_b64_tr_b16 a[66:67], v13 offset:4736
v_mfma_f32_16x16x32_bf16 v[52:55], a[84:87], v[168:171], 0
ds_read_b64_tr_b16 a[68:69], v13 offset:9344
ds_read_b64_tr_b16 a[70:71], v13 offset:13952
buffer_load_dwordx4 v7, s[32:35], s85 offen offset:3072 lds
v_cvt_pk_bf16_f32 v227, v230, v231
v_mul_f32 v232, v112, v232
v_mfma_f32_16x16x32_bf16 v[52:55], a[80:83], v[160:163], v[52:55]
s_waitcnt lgkmcnt(6)
s_add_u32 m0, s67, 0x1000
v_mul_f32 v233, v112, v233
v_mul_f32 v234, v112, v234
v_mfma_f32_16x16x32_bf16 v[60:63], a[88:91], v[160:163], 0
s_waitcnt lgkmcnt(4)
v_mul_f32 v235, v112, v235
v_mul_f32 v236, v112, v236
v_mfma_f32_16x16x32_bf16 v[60:63], a[92:95], v[168:171], v[60:63]
ds_read_b64_tr_b16 a[72:73], v13 offset:160
ds_read_b64_tr_b16 a[74:75], v13 offset:4768
buffer_load_dwordx4 v8, s[32:35], s85 offen lds
v_mfma_f32_16x16x32_bf16 v[56:59], a[92:95], v[136:139], 0
ds_read_b64_tr_b16 a[76:77], v13 offset:9376
ds_read_b64_tr_b16 a[78:79], v13 offset:13984
v_mul_f32 v237, v112, v237
v_mfma_f32_16x16x32_bf16 v[56:59], a[88:91], v[128:131], v[56:59]
s_waitcnt lgkmcnt(6)
s_add_u32 m0, s67, 0x1000
v_mul_f32 v238, v112, v238
v_mul_f32 v239, v112, v239
v_mfma_f32_16x16x32_bf16 v[132:135], a[64:67], v[128:131], 0
s_waitcnt lgkmcnt(4)
buffer_load_dwordx4 v9, s[32:35], s85 offen offset:1024 lds
s_add_u32 m0, s67, 0x1000
v_cvt_pk_bf16_f32 v232, v232, v233
v_mfma_f32_16x16x32_bf16 v[132:135], a[68:71], v[136:139], v[132:135]
ds_read_b64_tr_b16 a[80:81], v13 offset:192
ds_read_b64_tr_b16 a[82:83], v13 offset:4800
v_cvt_pk_bf16_f32 v233, v234, v235
v_mfma_f32_16x16x32_bf16 v[140:143], a[68:71], v[168:171], 0
ds_read_b64_tr_b16 a[84:85], v13 offset:9408
ds_read_b64_tr_b16 a[86:87], v13 offset:14016
buffer_load_dwordx4 v10, s[32:35], s85 offen offset:2048 lds
v_cvt_pk_bf16_f32 v234, v236, v237
v_mfma_f32_16x16x32_bf16 v[140:143], a[64:67], v[160:163], v[140:143]
s_waitcnt lgkmcnt(6)
s_add_u32 m0, s67, 0x1000
v_cvt_pk_bf16_f32 v235, v238, v239
v_mul_f32 v240, v112, v240
v_mfma_f32_16x16x32_bf16 v[156:159], a[72:75], v[160:163], 0
s_waitcnt lgkmcnt(4)
v_mul_f32 v241, v112, v241
v_mul_f32 v242, v112, v242
v_mfma_f32_16x16x32_bf16 v[156:159], a[76:79], v[168:171], v[156:159]
ds_read_b64_tr_b16 a[88:89], v13 offset:224
ds_read_b64_tr_b16 a[90:91], v13 offset:4832
buffer_load_dwordx4 v11, s[32:35], s85 offen offset:3072 lds
buffer_store_dwordx4 v[224:227], v1, s[4:7], s58 offen sc1
v_mfma_f32_16x16x32_bf16 v[148:151], a[76:79], v[136:139], 0
ds_read_b64_tr_b16 a[92:93], v13 offset:9440
ds_read_b64_tr_b16 a[94:95], v13 offset:14048
v_mul_f32 v243, v112, v243
v_mfma_f32_16x16x32_bf16 v[148:151], a[72:75], v[128:131], v[148:151]
s_waitcnt lgkmcnt(6)
s_add_u32 m0, s67, 0x2000
v_mul_f32 v244, v112, v244
v_mul_f32 v245, v112, v245
v_mfma_f32_16x16x32_bf16 v[164:167], a[80:83], v[128:131], 0
s_waitcnt lgkmcnt(4)
buffer_load_dwordx4 v12, s[32:35], s85 offen lds
v_mul_f32 v246, v112, v246
v_mfma_f32_16x16x32_bf16 v[164:167], a[84:87], v[136:139], v[164:167]
ds_read_b64_tr_b16 a[64:65], v13 offset:256
ds_read_b64_tr_b16 a[66:67], v13 offset:4864
v_mul_f32 v247, v112, v247
v_mfma_f32_16x16x32_bf16 v[172:175], a[84:87], v[168:171], 0
s_add_u32 s70, s52, 2
s_and_b32 s70, s70, 3
s_sub_u32 s70, s70, s52
s_lshl_b32 s70, s70, 12
s_add_u32 s65, s55, s70
s_add_u32 s66, s56, s70
ds_read_b64_tr_b16 a[68:69], v13 offset:9472
ds_read_b64_tr_b16 a[70:71], v13 offset:14080
v_cvt_pk_bf16_f32 v240, v240, v241
v_cvt_pk_bf16_f32 v241, v242, v243
v_mfma_f32_16x16x32_bf16 v[172:175], a[80:83], v[160:163], v[172:175]
s_waitcnt lgkmcnt(6)
buffer_load_dwordx4 a[200:203], v1, s[4:7], s65 offen offset:2048 sc1
v_cvt_pk_bf16_f32 v242, v244, v245
v_mfma_f32_16x16x32_bf16 v[188:191], a[88:91], v[160:163], 0
s_waitcnt lgkmcnt(4)
buffer_load_dwordx4 a[208:211], v1, s[4:7], s66 offen offset:2048 sc1
v_cvt_pk_bf16_f32 v243, v246, v247
v_mfma_f32_16x16x32_bf16 v[188:191], a[92:95], v[168:171], v[188:191]
ds_read_b64_tr_b16 a[72:73], v13 offset:18432
ds_read_b64_tr_b16 a[74:75], v13 offset:23040
v_mul_f32 v248, v112, v248
v_mfma_f32_16x16x32_bf16 v[180:183], a[92:95], v[136:139], 0
ds_read_b64_tr_b16 a[76:77], v17
ds_read_b64_tr_b16 a[78:79], v17 offset:4608
buffer_load_dwordx4 a[216:219], v1, s[4:7], s65 offen offset:3072 sc1
v_mul_f32 v249, v112, v249
v_mul_f32 v250, v112, v250
v_mfma_f32_16x16x32_bf16 v[180:183], a[88:91], v[128:131], v[180:183]
s_waitcnt lgkmcnt(6)
v_mul_f32 v251, v112, v251
v_mul_f32 v252, v112, v252
v_mfma_f32_16x16x32_bf16 v[120:123], a[64:67], v[128:131], 0
s_waitcnt lgkmcnt(4)
v_mul_f32 v253, v112, v253
v_mul_f32 v254, v112, v254
v_mfma_f32_16x16x32_bf16 v[120:123], a[68:71], v[136:139], v[120:123]
ds_read_b64_tr_b16 a[80:81], v13 offset:18464
ds_read_b64_tr_b16 a[82:83], v13 offset:23072
buffer_load_dwordx4 a[224:227], v1, s[4:7], s66 offen offset:3072 sc1
v_mfma_f32_16x16x32_bf16 v[124:127], a[68:71], v[168:171], 0
ds_read_b64_tr_b16 a[84:85], v17 offset:32
ds_read_b64_tr_b16 a[86:87], v17 offset:4640
v_mul_f32 v255, v112, v255
v_mfma_f32_16x16x32_bf16 v[124:127], a[64:67], v[160:163], v[124:127]
s_waitcnt lgkmcnt(6)
v_cvt_pk_bf16_f32 v248, v248, v249
v_cvt_pk_bf16_f32 v249, v250, v251
v_mfma_f32_16x16x32_bf16 v[36:39], a[72:75], v[176:179], v[36:39]
s_waitcnt lgkmcnt(4)
s_add_u32 s70, s48, 14
s_lshr_b32 s71, s70, 2
s_add_u32 s71, s71, s52
s_and_b32 s71, s71, 3
s_lshl_b32 s71, s71, 2
s_and_b32 s70, s70, 3
s_add_u32 s70, s70, s71
s_mul_i32 s70, s70, 0x9000
s_add_u32 s85, s64, s70
s_mul_i32 s67, s48, 0x2400
s_add_u32 s67, s67, s62
s_add_u32 s67, s67, 0x9000
s_cmp_lt_u32 s48, 2
s_cselect_b32 s67, s67, 0x28000
s_cselect_b32 s85, s85, 0x40000000
s_add_u32 m0, s67, 0
v_cvt_pk_bf16_f32 v250, v252, v253
v_mfma_f32_16x16x32_bf16 v[36:39], a[76:79], v[184:187], v[36:39]
ds_read_b64_tr_b16 a[88:89], v13 offset:18496
ds_read_b64_tr_b16 a[90:91], v13 offset:23104
buffer_load_dwordx4 v4, s[32:35], s85 offen lds
v_cvt_pk_bf16_f32 v251, v254, v255
v_mfma_f32_16x16x32_bf16 v[32:35], a[76:79], v[152:155], v[32:35]
s_add_u32 m0, s67, 0
ds_read_b64_tr_b16 a[92:93], v17 offset:64
ds_read_b64_tr_b16 a[94:95], v17 offset:4672
v_mfma_f32_16x16x32_bf16 v[32:35], a[72:75], v[144:147], v[32:35]
s_waitcnt lgkmcnt(4)
buffer_load_dwordx4 v5, s[32:35], s85 offen offset:1024 lds
ds_read_b64_tr_b16 a[64:65], v13 offset:18528
v_mfma_f32_16x16x32_bf16 v[40:43], a[80:83], v[144:147], v[40:43]
s_add_u32 m0, s67, 0
ds_read_b64_tr_b16 a[66:67], v13 offset:23136
buffer_store_dwordx4 v[232:235], v1, s[4:7], s58 offen offset:1024 sc1
v_mfma_f32_16x16x32_bf16 v[40:43], a[84:87], v[152:155], v[40:43]
ds_read_b64_tr_b16 a[68:69], v17 offset:96
buffer_load_dwordx4 v6, s[32:35], s85 offen offset:2048 lds
v_mfma_f32_16x16x32_bf16 v[44:47], a[84:87], v[184:187], v[44:47]
s_add_u32 m0, s67, 0
ds_read_b64_tr_b16 a[70:71], v17 offset:4704
v_cmp_gt_u32_e64 s[94:95], 16, v0
v_mfma_f32_16x16x32_bf16 v[44:47], a[80:83], v[176:179], v[44:47]
s_waitcnt lgkmcnt(6)
ds_read_b64_tr_b16 a[72:73], v13 offset:18560
buffer_load_dwordx4 v7, s[32:35], s85 offen offset:3072 lds
v_mfma_f32_16x16x32_bf16 v[52:55], a[88:91], v[176:179], v[52:55]
s_waitcnt lgkmcnt(5)
ds_read_b64_tr_b16 a[74:75], v13 offset:23168
v_cvt_pk_bf16_f32 v72, v64, v65
v_mfma_f32_16x16x32_bf16 v[52:55], a[92:95], v[184:187], v[52:55]
s_add_u32 m0, s67, 0x1000
ds_read_b64_tr_b16 a[76:77], v17 offset:128
v_cvt_pk_bf16_f32 v73, v66, v67
v_mfma_f32_16x16x32_bf16 v[48:51], a[92:95], v[152:155], v[48:51]
ds_read_b64_tr_b16 a[78:79], v17 offset:4736
buffer_load_dwordx4 v8, s[32:35], s85 offen lds
v_mfma_f32_16x16x32_bf16 v[48:51], a[88:91], v[144:147], v[48:51]
s_waitcnt lgkmcnt(6)
s_add_u32 m0, s67, 0x1000
ds_read_b64_tr_b16 a[80:81], v13 offset:18592
v_cvt_pk_bf16_f32 v76, v68, v69
v_mfma_f32_16x16x32_bf16 v[56:59], a[64:67], v[144:147], v[56:59]
s_waitcnt lgkmcnt(5)
ds_read_b64_tr_b16 a[82:83], v13 offset:23200
buffer_load_dwordx4 v9, s[32:35], s85 offen offset:1024 lds
v_mfma_f32_16x16x32_bf16 v[56:59], a[68:71], v[152:155], v[56:59]
ds_read_b64_tr_b16 a[84:85], v17 offset:160
v_cvt_pk_bf16_f32 v77, v70, v71
v_mfma_f32_16x16x32_bf16 v[60:63], a[68:71], v[184:187], v[60:63]
s_add_u32 m0, s67, 0x1000
ds_read_b64_tr_b16 a[86:87], v17 offset:4768
v_cvt_pk_bf16_f32 v74, v80, v81
v_mfma_f32_16x16x32_bf16 v[60:63], a[64:67], v[176:179], v[60:63]
s_waitcnt lgkmcnt(6)
ds_read_b64_tr_b16 a[88:89], v13 offset:18624
buffer_load_dwordx4 v10, s[32:35], s85 offen offset:2048 lds
v_mfma_f32_16x16x32_bf16 v[140:143], a[72:75], v[176:179], v[140:143]
s_waitcnt lgkmcnt(5)
ds_read_b64_tr_b16 a[90:91], v13 offset:23232
v_cvt_pk_bf16_f32 v78, v82, v83
v_mfma_f32_16x16x32_bf16 v[140:143], a[76:79], v[184:187], v[140:143]
s_add_u32 m0, s67, 0x1000
ds_read_b64_tr_b16 a[92:93], v17 offset:192
v_mov_b32 v75, 0
v_mfma_f32_16x16x32_bf16 v[132:135], a[76:79], v[152:155], v[132:135]
ds_read_b64_tr_b16 a[94:95], v17 offset:4800
buffer_load_dwordx4 v11, s[32:35], s85 offen offset:3072 lds
v_mfma_f32_16x16x32_bf16 v[132:135], a[72:75], v[144:147], v[132:135]
s_waitcnt lgkmcnt(6)
s_add_u32 m0, s67, 0x2000
ds_read_b64_tr_b16 a[64:65], v13 offset:18656
v_mov_b32 v79, 0
v_mfma_f32_16x16x32_bf16 v[148:151], a[80:83], v[144:147], v[148:151]
s_waitcnt lgkmcnt(5)
ds_read_b64_tr_b16 a[66:67], v13 offset:23264
buffer_load_dwordx4 v12, s[32:35], s85 offen lds
v_mfma_f32_16x16x32_bf16 v[148:151], a[84:87], v[152:155], v[148:151]
ds_read_b64_tr_b16 a[68:69], v17 offset:224
v_mov_b32 v87, 0
v_mfma_f32_16x16x32_bf16 v[156:159], a[84:87], v[184:187], v[156:159]
ds_read_b64_tr_b16 a[70:71], v17 offset:4832
v_cndmask_b32_e64 v74, 0, v74, s[94:95]
v_mfma_f32_16x16x32_bf16 v[156:159], a[80:83], v[176:179], v[156:159]
s_waitcnt lgkmcnt(6)
ds_read_b64_tr_b16 a[72:73], v13 offset:18688
v_cndmask_b32_e64 v78, 0, v78, s[94:95]
v_mfma_f32_16x16x32_bf16 v[172:175], a[88:91], v[176:179], v[172:175]
s_waitcnt lgkmcnt(5)
ds_read_b64_tr_b16 a[74:75], v13 offset:23296
v_mfma_f32_16x16x32_bf16 v[172:175], a[92:95], v[184:187], v[172:175]
s_add_u32 s70, s52, 3
s_and_b32 s70, s70, 3
s_sub_u32 s70, s70, s52
s_lshl_b32 s70, s70, 12
s_add_u32 s65, s55, s70
s_add_u32 s66, s56, s70
v_mfma_f32_16x16x32_bf16 v[164:167], a[92:95], v[152:155], v[164:167]
ds_read_b64_tr_b16 a[76:77], v17 offset:256
ds_read_b64_tr_b16 a[78:79], v17 offset:4864
buffer_load_dwordx4 a[232:235], v1, s[4:7], s65 offen sc1
buffer_store_dwordx4 v[240:243], v1, s[4:7], s58 offen offset:2048 sc1
v_mfma_f32_16x16x32_bf16 v[164:167], a[88:91], v[144:147], v[164:167]
s_waitcnt lgkmcnt(6)
buffer_load_dwordx4 a[240:243], v1, s[4:7], s66 offen sc1
v_mfma_f32_16x16x32_bf16 v[180:183], a[64:67], v[144:147], v[180:183]
s_waitcnt lgkmcnt(4)
v_mfma_f32_16x16x32_bf16 v[180:183], a[68:71], v[152:155], v[180:183]
buffer_load_dwordx4 a[248:251], v1, s[4:7], s65 offen offset:1024 sc1
v_mfma_f32_16x16x32_bf16 v[188:191], a[68:71], v[184:187], v[188:191]
v_mfma_f32_16x16x32_bf16 v[188:191], a[64:67], v[176:179], v[188:191]
s_waitcnt lgkmcnt(2)
v_mfma_f32_16x16x32_bf16 v[124:127], a[72:75], v[176:179], v[124:127]
s_waitcnt lgkmcnt(0)
buffer_load_dwordx4 a[196:199], v1, s[4:7], s66 offen offset:1024 sc1
v_mfma_f32_16x16x32_bf16 v[124:127], a[76:79], v[184:187], v[124:127]
s_nop 1
v_mov_b32_dpp v84, v76 row_newbcast:4 row_mask:0xf bank_mask:0xf
v_mov_b32_dpp v85, v77 row_newbcast:4 row_mask:0xf bank_mask:0xf
v_mov_b32_dpp v86, v78 row_newbcast:4 row_mask:0xf bank_mask:0xf
v_and_b32 v104, 15, v0
v_cmp_gt_u32_e64 s[94:95], 2, v104
v_lshlrev_b32 v104, 5, v104
v_lshrrev_b32 v105, 4, v0
v_lshl_add_u32 v104, v105, 3, v104
v_mov_b32 v105, 0x40000000
v_cndmask_b32_e64 v105, v105, v104, s[94:95]
s_lshl_b32 s87, s54, 2
s_add_u32 s87, s87, s48
s_mul_i32 s87, s87, 0x12000
s_mul_i32 s70, s53, 0x240
s_add_u32 s87, s87, s70
s_add_u32 s87, s87, 0x4800000
v_mfma_f32_16x16x32_bf16 v[120:123], a[76:79], v[152:155], v[120:123]
buffer_load_dwordx4 a[228:231], v1, s[4:7], s65 offen offset:2048 sc1
ds_read_b64_tr_b16 a[80:81], v17 offset:9216
v_mfma_f32_16x16x32_bf16 v[120:123], a[72:75], v[144:147], v[120:123]
ds_read_b64_tr_b16 a[82:83], v17 offset:13824
v_mfma_f32_16x16x32_bf16 v[128:131], a[212:215], v[72:75], 0
ds_read_b64_tr_b16 a[84:85], v17 offset:18432
v_mfma_f32_16x16x32_bf16 v[136:139], a[212:215], v[76:79], 0
buffer_load_dwordx4 a[204:207], v1, s[4:7], s66 offen offset:2048 sc1
ds_read_b64_tr_b16 a[86:87], v17 offset:23040
v_mfma_f32_16x16x32_bf16 v[144:147], a[212:215], v[84:87], 0
ds_read_b64_tr_b16 a[88:89], v17 offset:9248
v_mfma_f32_16x16x32_bf16 v[152:155], a[244:247], v[72:75], 0
buffer_load_dwordx4 a[236:239], v1, s[4:7], s65 offen offset:3072 sc1
ds_read_b64_tr_b16 a[90:91], v17 offset:13856
v_mfma_f32_16x16x32_bf16 v[160:163], a[244:247], v[76:79], 0
ds_read_b64_tr_b16 a[92:93], v17 offset:18464
v_mfma_f32_16x16x32_bf16 v[168:171], a[244:247], v[84:87], 0
ds_read_b64_tr_b16 a[94:95], v17 offset:23072
v_mfma_f32_16x16x32_bf16 v[176:179], a[220:223], v[72:75], 0
buffer_load_dwordx4 a[0:3], v1, s[4:7], s66 offen offset:3072 sc1
ds_read_b64_tr_b16 a[64:65], v17 offset:9280
v_mfma_f32_16x16x32_bf16 v[184:187], a[220:223], v[76:79], 0
ds_read_b64_tr_b16 a[66:67], v17 offset:13888
v_mfma_f32_16x16x32_bf16 v[88:91], a[220:223], v[84:87], 0
buffer_store_dwordx4 v[248:251], v1, s[4:7], s58 offen offset:3072 sc1
ds_read_b64_tr_b16 a[68:69], v17 offset:18496
v_mfma_f32_16x16x32_bf16 v[92:95], a[252:255], v[72:75], 0
ds_read_b64_tr_b16 a[70:71], v17 offset:23104
v_mfma_f32_16x16x32_bf16 v[96:99], a[252:255], v[76:79], 0
s_waitcnt vmcnt(44) lgkmcnt(7)
ds_read_b64_tr_b16 a[72:73], v17 offset:9312
v_mfma_f32_16x16x32_bf16 v[100:103], a[252:255], v[84:87], 0
s_mul_i32 s85, s52, 0x120
s_add_u32 s67, s62, 0xd800
s_cmp_eq_u32 s48, 0
s_cselect_b32 s67, s67, 0x28000
s_cselect_b32 s85, s85, 0x40000000
s_add_u32 m0, s67, 0
v_mfma_f32_16x16x32_bf16 v[32:35], a[80:83], a[148:151], v[32:35]
buffer_load_dwordx4 v4, s[36:39], s85 offen lds
s_add_u32 m0, s67, 0
ds_read_b64_tr_b16 a[74:75], v17 offset:13920
v_mfma_f32_16x16x32_bf16 v[32:35], a[84:87], a[156:159], v[32:35]
buffer_load_dwordx4 v5, s[36:39], s85 offen offset:1024 lds
s_add_u32 m0, s67, 0
ds_read_b64_tr_b16 a[76:77], v17 offset:18528
v_mfma_f32_16x16x32_bf16 v[36:39], a[84:87], a[160:163], v[36:39]
buffer_load_dwordx4 v6, s[36:39], s85 offen offset:2048 lds
s_add_u32 m0, s67, 0
ds_read_b64_tr_b16 a[78:79], v17 offset:23136
v_mfma_f32_16x16x32_bf16 v[36:39], a[80:83], a[152:155], v[36:39]
s_waitcnt lgkmcnt(6)
buffer_load_dwordx4 v7, s[36:39], s85 offen offset:3072 lds
s_add_u32 m0, s67, 0x1000
ds_read_b64_tr_b16 a[80:81], v17 offset:9344
v_mfma_f32_16x16x32_bf16 v[44:47], a[88:91], a[152:155], v[44:47]
buffer_load_dwordx4 v8, s[36:39], s85 offen lds
s_add_u32 m0, s67, 0x1000
ds_read_b64_tr_b16 a[82:83], v17 offset:13952
v_mfma_f32_16x16x32_bf16 v[44:47], a[92:95], a[160:163], v[44:47]
buffer_load_dwordx4 v9, s[36:39], s85 offen offset:1024 lds
s_add_u32 m0, s67, 0x1000
ds_read_b64_tr_b16 a[84:85], v17 offset:18560
v_mfma_f32_16x16x32_bf16 v[40:43], a[92:95], a[156:159], v[40:43]
buffer_load_dwordx4 v10, s[36:39], s85 offen offset:2048 lds
s_add_u32 m0, s67, 0x1000
ds_read_b64_tr_b16 a[86:87], v17 offset:23168
v_mfma_f32_16x16x32_bf16 v[40:43], a[88:91], a[148:151], v[40:43]
buffer_load_dwordx4 v11, s[36:39], s85 offen offset:3072 lds
s_add_u32 m0, s67, 0x2000
ds_read_b64_tr_b16 a[88:89], v17 offset:9376
v_mfma_f32_16x16x32_bf16 v[48:51], a[64:67], a[148:151], v[48:51]
s_waitcnt lgkmcnt(7)
buffer_load_dwordx4 v12, s[36:39], s85 offen lds
ds_read_b64_tr_b16 a[90:91], v17 offset:13984
v_mfma_f32_16x16x32_bf16 v[48:51], a[68:71], a[156:159], v[48:51]
ds_read_b64_tr_b16 a[92:93], v17 offset:18592
v_add_f32 v144, s86, v144
v_mfma_f32_16x16x32_bf16 v[52:55], a[68:71], a[160:163], v[52:55]
ds_read_b64_tr_b16 a[94:95], v17 offset:23200
v_add_f32 v145, s86, v145
v_mfma_f32_16x16x32_bf16 v[52:55], a[64:67], a[152:155], v[52:55]
ds_read_b64_tr_b16 a[64:65], v17 offset:9408
v_add_f32 v146, s86, v146
v_mfma_f32_16x16x32_bf16 v[60:63], a[72:75], a[152:155], v[60:63]
s_waitcnt lgkmcnt(7)
ds_read_b64_tr_b16 a[66:67], v17 offset:14016
v_add_f32 v147, s86, v147
v_mfma_f32_16x16x32_bf16 v[60:63], a[76:79], a[160:163], v[60:63]
ds_read_b64_tr_b16 a[68:69], v17 offset:18624
v_add_f32 v168, s86, v168
v_mfma_f32_16x16x32_bf16 v[56:59], a[76:79], a[156:159], v[56:59]
ds_read_b64_tr_b16 a[70:71], v17 offset:23232
v_add_f32 v169, s86, v169
v_mfma_f32_16x16x32_bf16 v[56:59], a[72:75], a[148:151], v[56:59]
ds_read_b64_tr_b16 a[72:73], v17 offset:9440
v_add_f32 v170, s86, v170
v_mfma_f32_16x16x32_bf16 v[132:135], a[80:83], a[148:151], v[132:135]
s_waitcnt lgkmcnt(7)
ds_read_b64_tr_b16 a[74:75], v17 offset:14048
v_add_f32 v171, s86, v171
v_mfma_f32_16x16x32_bf16 v[132:135], a[84:87], a[156:159], v[132:135]
ds_read_b64_tr_b16 a[76:77], v17 offset:18656
v_mfma_f32_16x16x32_bf16 v[140:143], a[84:87], a[160:163], v[140:143]
ds_read_b64_tr_b16 a[78:79], v17 offset:23264
v_mfma_f32_16x16x32_bf16 v[140:143], a[80:83], a[152:155], v[140:143]
ds_read_b64_tr_b16 a[80:81], v17 offset:9472
v_mfma_f32_16x16x32_bf16 v[156:159], a[88:91], a[152:155], v[156:159]
s_waitcnt lgkmcnt(7)
ds_read_b64_tr_b16 a[82:83], v17 offset:14080
v_mfma_f32_16x16x32_bf16 v[156:159], a[92:95], a[160:163], v[156:159]
ds_read_b64_tr_b16 a[84:85], v17 offset:18688
ds_read_b64_tr_b16 a[86:87], v17 offset:23296
s_waitcnt vmcnt(43)
s_barrier
v_mfma_f32_16x16x32_bf16 v[148:151], a[92:95], a[156:159], v[148:151]
v_rcp_f32 v144, v144
v_mfma_f32_16x16x32_bf16 v[148:151], a[88:91], a[148:151], v[148:151]
ds_read_b64_tr_b16 a[88:89], v17 offset:27648
v_mul_f32 v128, v128, v144
v_mfma_f32_16x16x32_bf16 v[164:167], a[64:67], a[148:151], v[164:167]
s_waitcnt lgkmcnt(7)
ds_read_b64_tr_b16 a[90:91], v17 offset:32256
v_mul_f32 v136, v136, v144
v_mfma_f32_16x16x32_bf16 v[164:167], a[68:71], a[156:159], v[164:167]
v_rcp_f32 v145, v145
v_mfma_f32_16x16x32_bf16 v[172:175], a[68:71], a[160:163], v[172:175]
v_rcp_f32 v146, v146
v_mfma_f32_16x16x32_bf16 v[172:175], a[64:67], a[152:155], v[172:175]
v_rcp_f32 v147, v147
v_mfma_f32_16x16x32_bf16 v[188:191], a[72:75], a[152:155], v[188:191]
s_waitcnt lgkmcnt(6)
v_mul_f32 v129, v129, v145
v_mul_f32 v130, v130, v146
v_mfma_f32_16x16x32_bf16 v[188:191], a[76:79], a[160:163], v[188:191]
v_mul_f32 v131, v131, v147
v_mul_f32 v137, v137, v145
v_mfma_f32_16x16x32_bf16 v[180:183], a[76:79], a[156:159], v[180:183]
ds_read_b64_tr_b16 a[92:93], v17 offset:36864
ds_read_b64_tr_b16 a[94:95], v17 offset:41472
v_mul_f32 v138, v138, v146
v_mul_f32 v139, v139, v147
v_cvt_pk_bf16_f32 v128, v128, v129
v_cvt_pk_bf16_f32 v129, v130, v131
v_cvt_pk_bf16_f32 v136, v136, v137
v_cvt_pk_bf16_f32 v137, v138, v139
v_mfma_f32_16x16x32_bf16 v[180:183], a[72:75], a[148:151], v[180:183]
s_waitcnt lgkmcnt(4)
buffer_store_dwordx2 v[128:129], v104, s[4:7], s87 offen sc1
ds_read_b64_tr_b16 a[64:65], v17 offset:27680
v_mfma_f32_16x16x32_bf16 v[120:123], a[80:83], a[148:151], v[120:123]
ds_read_b64_tr_b16 a[66:67], v17 offset:32288
v_add_f32 v88, s86, v88
v_mfma_f32_16x16x32_bf16 v[120:123], a[84:87], a[156:159], v[120:123]
ds_read_b64_tr_b16 a[68:69], v17 offset:36896
v_add_f32 v89, s86, v89
v_mfma_f32_16x16x32_bf16 v[124:127], a[84:87], a[160:163], v[124:127]
ds_read_b64_tr_b16 a[70:71], v17 offset:41504
v_add_f32 v90, s86, v90
v_mfma_f32_16x16x32_bf16 v[124:127], a[80:83], a[152:155], v[124:127]
s_waitcnt lgkmcnt(6)
buffer_store_dwordx2 v[136:137], v105, s[4:7], s87 offen offset:512 sc1
s_add_u32 s87, s87, 0x4800
v_mfma_f32_16x16x32_bf16 v[36:39], a[88:91], a[168:171], v[36:39]
s_waitcnt lgkmcnt(4)
ds_read_b64_tr_b16 a[72:73], v17 offset:27712
v_add_f32 v91, s86, v91
v_mfma_f32_16x16x32_bf16 v[36:39], a[92:95], a[176:179], v[36:39]
ds_read_b64_tr_b16 a[74:75], v17 offset:32320
v_mfma_f32_16x16x32_bf16 v[32:35], a[92:95], a[172:175], v[32:35]
ds_read_b64_tr_b16 a[76:77], v17 offset:36928
ds_read_b64_tr_b16 a[78:79], v17 offset:41536
v_mfma_f32_16x16x32_bf16 v[32:35], a[88:91], a[164:167], v[32:35]
s_waitcnt lgkmcnt(6)
ds_read_b64_tr_b16 a[80:81], v17 offset:27744
v_mfma_f32_16x16x32_bf16 v[40:43], a[64:67], a[164:167], v[40:43]
s_waitcnt lgkmcnt(5)
ds_read_b64_tr_b16 a[82:83], v17 offset:32352
v_mfma_f32_16x16x32_bf16 v[40:43], a[68:71], a[172:175], v[40:43]
ds_read_b64_tr_b16 a[84:85], v17 offset:36960
v_mfma_f32_16x16x32_bf16 v[44:47], a[68:71], a[176:179], v[44:47]
ds_read_b64_tr_b16 a[86:87], v17 offset:41568
v_mfma_f32_16x16x32_bf16 v[44:47], a[64:67], a[168:171], v[44:47]
s_waitcnt lgkmcnt(6)
s_lshl_b32 s76, s50, 3
s_add_u32 s76, s76, s51
s_lshl_b32 s76, s76, 3
s_add_u32 s76, s76, s48
s_lshl_b32 s76, s76, 2
s_add_u32 s76, s76, s52
s_lshl_b32 s76, s76, 2
s_add_u32 s76, s76, 0x5005000
v_mfma_f32_16x16x32_bf16 v[52:55], a[72:75], a[168:171], v[52:55]
s_waitcnt vmcnt(11) lgkmcnt(4)
buffer_store_dword v18, v20, s[4:7], s76 offen sc1
ds_read_b64_tr_b16 a[88:89], v17 offset:27776
v_mfma_f32_16x16x32_bf16 v[52:55], a[76:79], a[176:179], v[52:55]
ds_read_b64_tr_b16 a[90:91], v17 offset:32384
v_mfma_f32_16x16x32_bf16 v[48:51], a[76:79], a[172:175], v[48:51]
ds_read_b64_tr_b16 a[92:93], v17 offset:36992
ds_read_b64_tr_b16 a[94:95], v17 offset:41600
v_mfma_f32_16x16x32_bf16 v[48:51], a[72:75], a[164:167], v[48:51]
s_waitcnt lgkmcnt(6)
ds_read_b64_tr_b16 a[64:65], v17 offset:27808
v_mfma_f32_16x16x32_bf16 v[56:59], a[80:83], a[164:167], v[56:59]
s_waitcnt lgkmcnt(5)
ds_read_b64_tr_b16 a[66:67], v17 offset:32416
v_mfma_f32_16x16x32_bf16 v[56:59], a[84:87], a[172:175], v[56:59]
ds_read_b64_tr_b16 a[68:69], v17 offset:37024
v_mfma_f32_16x16x32_bf16 v[60:63], a[84:87], a[176:179], v[60:63]
ds_read_b64_tr_b16 a[70:71], v17 offset:41632
v_mfma_f32_16x16x32_bf16 v[60:63], a[80:83], a[168:171], v[60:63]
s_waitcnt lgkmcnt(6)
ds_read_b64_tr_b16 a[72:73], v17 offset:27840
v_mfma_f32_16x16x32_bf16 v[140:143], a[88:91], a[168:171], v[140:143]
s_waitcnt lgkmcnt(5)
ds_read_b64_tr_b16 a[74:75], v17 offset:32448
v_mfma_f32_16x16x32_bf16 v[140:143], a[92:95], a[176:179], v[140:143]
ds_read_b64_tr_b16 a[76:77], v17 offset:37056
v_mfma_f32_16x16x32_bf16 v[132:135], a[92:95], a[172:175], v[132:135]
ds_read_b64_tr_b16 a[78:79], v17 offset:41664
v_mfma_f32_16x16x32_bf16 v[132:135], a[88:91], a[164:167], v[132:135]
s_waitcnt lgkmcnt(6)
v_rcp_f32 v168, v168
v_mfma_f32_16x16x32_bf16 v[148:151], a[64:67], a[164:167], v[148:151]
s_waitcnt lgkmcnt(4)
v_rcp_f32 v169, v169
v_rcp_f32 v170, v170
v_rcp_f32 v171, v171
v_mul_f32 v152, v152, v168
v_mul_f32 v153, v153, v169
v_mul_f32 v154, v154, v170
v_mul_f32 v155, v155, v171
v_mul_f32 v160, v160, v168
v_mul_f32 v161, v161, v169
v_mul_f32 v162, v162, v170
v_mul_f32 v163, v163, v171
v_cvt_pk_bf16_f32 v152, v152, v153
v_cvt_pk_bf16_f32 v153, v154, v155
v_cvt_pk_bf16_f32 v160, v160, v161
v_cvt_pk_bf16_f32 v161, v162, v163
v_mfma_f32_16x16x32_bf16 v[148:151], a[68:71], a[172:175], v[148:151]
ds_read_b64_tr_b16 a[80:81], v17 offset:27872
ds_read_b64_tr_b16 a[82:83], v17 offset:32480
v_mfma_f32_16x16x32_bf16 v[156:159], a[68:71], a[176:179], v[156:159]
ds_read_b64_tr_b16 a[84:85], v17 offset:37088
ds_read_b64_tr_b16 a[86:87], v17 offset:41696
buffer_store_dwordx2 v[152:153], v104, s[4:7], s87 offen sc1
v_mfma_f32_16x16x32_bf16 v[156:159], a[64:67], a[168:171], v[156:159]
s_waitcnt lgkmcnt(4)
ds_read_b64_tr_b16 a[88:89], v17 offset:27904
v_add_f32 v100, s86, v100
v_mfma_f32_16x16x32_bf16 v[172:175], a[72:75], a[168:171], v[172:175]
ds_read_b64_tr_b16 a[90:91], v17 offset:32512
v_add_f32 v101, s86, v101
v_mfma_f32_16x16x32_bf16 v[172:175], a[76:79], a[176:179], v[172:175]
buffer_store_dwordx2 v[160:161], v105, s[4:7], s87 offen offset:512 sc1
s_add_u32 s87, s87, 0x4800
v_mfma_f32_16x16x32_bf16 v[164:167], a[76:79], a[172:175], v[164:167]
ds_read_b64_tr_b16 a[92:93], v17 offset:37120
ds_read_b64_tr_b16 a[94:95], v17 offset:41728
v_mfma_f32_16x16x32_bf16 v[164:167], a[72:75], a[164:167], v[164:167]
s_waitcnt lgkmcnt(6)
ds_read_b64_tr_b16 a[64:65], v17 offset:46080
v_add_f32 v102, s86, v102
v_mfma_f32_16x16x32_bf16 v[180:183], a[80:83], a[164:167], v[180:183]
s_waitcnt lgkmcnt(5)
ds_read_b64_tr_b16 a[66:67], v17 offset:50688
v_add_f32 v103, s86, v103
v_mfma_f32_16x16x32_bf16 v[180:183], a[84:87], a[172:175], v[180:183]
ds_read_b64_tr_b16 a[68:69], v17 offset:55296
v_mfma_f32_16x16x32_bf16 v[188:191], a[84:87], a[176:179], v[188:191]
ds_read_b64_tr_b16 a[70:71], v17 offset:59904
v_mfma_f32_16x16x32_bf16 v[188:191], a[80:83], a[168:171], v[188:191]
s_waitcnt lgkmcnt(6)
ds_read_b64_tr_b16 a[72:73], v17 offset:46112
v_mfma_f32_16x16x32_bf16 v[124:127], a[88:91], a[168:171], v[124:127]
s_waitcnt lgkmcnt(5)
ds_read_b64_tr_b16 a[74:75], v17 offset:50720
v_mfma_f32_16x16x32_bf16 v[124:127], a[92:95], a[176:179], v[124:127]
ds_read_b64_tr_b16 a[76:77], v17 offset:55328
v_mfma_f32_16x16x32_bf16 v[120:123], a[92:95], a[172:175], v[120:123]
s_lshl_b32 s88, s48, 13
s_add_u32 s88, s88, L_catch-24576-L_pc
v_lshlrev_b32 v30, 7, v0
v_add_u32 v30, s88, v30
v_min_u32 v30, L_codeend-L_pc-4, v30
global_load_dword v31, v30, s[98:99]
ds_read_b64_tr_b16 a[78:79], v17 offset:59936
v_mfma_f32_16x16x32_bf16 v[120:123], a[88:91], a[164:167], v[120:123]
s_waitcnt lgkmcnt(6)
ds_read_b64_tr_b16 a[80:81], v17 offset:46144
v_mfma_f32_16x16x32_bf16 v[32:35], a[64:67], a[180:183], v[32:35]
s_waitcnt lgkmcnt(5)
ds_read_b64_tr_b16 a[82:83], v17 offset:50752
v_mfma_f32_16x16x32_bf16 v[32:35], a[68:71], a[188:191], v[32:35]
ds_read_b64_tr_b16 a[84:85], v17 offset:55360
v_mfma_f32_16x16x32_bf16 v[36:39], a[68:71], a[192:195], v[36:39]
ds_read_b64_tr_b16 a[86:87], v17 offset:59968
v_mfma_f32_16x16x32_bf16 v[36:39], a[64:67], a[184:187], v[36:39]
s_waitcnt lgkmcnt(6)
ds_read_b64_tr_b16 a[88:89], v17 offset:46176
v_mfma_f32_16x16x32_bf16 v[44:47], a[72:75], a[184:187], v[44:47]
s_waitcnt lgkmcnt(5)
ds_read_b64_tr_b16 a[90:91], v17 offset:50784
v_mfma_f32_16x16x32_bf16 v[44:47], a[76:79], a[192:195], v[44:47]
ds_read_b64_tr_b16 a[92:93], v17 offset:55392
v_mfma_f32_16x16x32_bf16 v[40:43], a[76:79], a[188:191], v[40:43]
ds_read_b64_tr_b16 a[94:95], v17 offset:60000
v_mfma_f32_16x16x32_bf16 v[40:43], a[72:75], a[180:183], v[40:43]
s_waitcnt lgkmcnt(6)
ds_read_b64_tr_b16 a[64:65], v17 offset:46208
v_mfma_f32_16x16x32_bf16 v[48:51], a[80:83], a[180:183], v[48:51]
s_waitcnt lgkmcnt(5)
ds_read_b64_tr_b16 a[66:67], v17 offset:50816
v_mfma_f32_16x16x32_bf16 v[48:51], a[84:87], a[188:191], v[48:51]
v_rcp_f32 v88, v88
v_mfma_f32_16x16x32_bf16 v[52:55], a[84:87], a[192:195], v[52:55]
ds_read_b64_tr_b16 a[68:69], v17 offset:55424
ds_read_b64_tr_b16 a[70:71], v17 offset:60032
v_rcp_f32 v89, v89
v_rcp_f32 v90, v90
v_rcp_f32 v91, v91
v_mul_f32 v176, v176, v88
v_mul_f32 v177, v177, v89
v_mul_f32 v178, v178, v90
v_mul_f32 v179, v179, v91
v_mul_f32 v184, v184, v88
v_mul_f32 v185, v185, v89
v_mul_f32 v186, v186, v90
v_mul_f32 v187, v187, v91
v_cvt_pk_bf16_f32 v176, v176, v177
v_cvt_pk_bf16_f32 v177, v178, v179
v_cvt_pk_bf16_f32 v184, v184, v185
v_cvt_pk_bf16_f32 v185, v186, v187
v_mfma_f32_16x16x32_bf16 v[52:55], a[80:83], a[184:187], v[52:55]
s_waitcnt lgkmcnt(4)
buffer_store_dwordx2 v[176:177], v104, s[4:7], s87 offen sc1
ds_read_b64_tr_b16 a[72:73], v17 offset:46240
v_mfma_f32_16x16x32_bf16 v[60:63], a[88:91], a[184:187], v[60:63]
ds_read_b64_tr_b16 a[74:75], v17 offset:50848
v_mfma_f32_16x16x32_bf16 v[60:63], a[92:95], a[192:195], v[60:63]
ds_read_b64_tr_b16 a[76:77], v17 offset:55456
v_mfma_f32_16x16x32_bf16 v[56:59], a[92:95], a[188:191], v[56:59]
ds_read_b64_tr_b16 a[78:79], v17 offset:60064
v_mfma_f32_16x16x32_bf16 v[56:59], a[88:91], a[180:183], v[56:59]
s_waitcnt lgkmcnt(4)
buffer_store_dwordx2 v[184:185], v105, s[4:7], s87 offen offset:512 sc1
s_add_u32 s87, s87, 0x4800
v_mfma_f32_16x16x32_bf16 v[132:135], a[64:67], a[180:183], v[132:135]
ds_read_b64_tr_b16 a[80:81], v17 offset:46272
v_mfma_f32_16x16x32_bf16 v[132:135], a[68:71], a[188:191], v[132:135]
ds_read_b64_tr_b16 a[82:83], v17 offset:50880
v_mfma_f32_16x16x32_bf16 v[140:143], a[68:71], a[192:195], v[140:143]
ds_read_b64_tr_b16 a[84:85], v17 offset:55488
ds_read_b64_tr_b16 a[86:87], v17 offset:60096
v_mfma_f32_16x16x32_bf16 v[140:143], a[64:67], a[184:187], v[140:143]
s_waitcnt lgkmcnt(6)
ds_read_b64_tr_b16 a[88:89], v17 offset:46304
v_mfma_f32_16x16x32_bf16 v[156:159], a[72:75], a[184:187], v[156:159]
s_waitcnt lgkmcnt(5)
ds_read_b64_tr_b16 a[90:91], v17 offset:50912
v_mfma_f32_16x16x32_bf16 v[156:159], a[76:79], a[192:195], v[156:159]
ds_read_b64_tr_b16 a[92:93], v17 offset:55520
ds_read_b64_tr_b16 a[94:95], v17 offset:60128
ds_read_b64_tr_b16 a[64:65], v17 offset:46336
ds_read_b64_tr_b16 a[66:67], v17 offset:50944
ds_read_b64_tr_b16 a[68:69], v17 offset:55552
ds_read_b64_tr_b16 a[70:71], v17 offset:60160
s_barrier
v_mfma_f32_16x16x32_bf16 v[148:151], a[76:79], a[188:191], v[148:151]
v_rcp_f32 v100, v100
v_mfma_f32_16x16x32_bf16 v[148:151], a[72:75], a[180:183], v[148:151]
s_waitcnt lgkmcnt(10)
ds_read_b64_tr_b16 a[72:73], v25
v_mul_f32 v92, v92, v100
v_mfma_f32_16x16x32_bf16 v[164:167], a[80:83], a[180:183], v[164:167]
s_waitcnt lgkmcnt(9)
ds_read_b64_tr_b16 a[74:75], v25 offset:4608
v_mul_f32 v96, v96, v100
v_mfma_f32_16x16x32_bf16 v[164:167], a[84:87], a[188:191], v[164:167]
ds_read_b64_tr_b16 a[76:77], v25 offset:9216
v_mfma_f32_16x16x32_bf16 v[172:175], a[84:87], a[192:195], v[172:175]
ds_read_b64_tr_b16 a[78:79], v25 offset:13824
v_mfma_f32_16x16x32_bf16 v[172:175], a[80:83], a[184:187], v[172:175]
s_waitcnt lgkmcnt(10)
ds_read_b64_tr_b16 a[80:81], v25 offset:32
v_mfma_f32_16x16x32_bf16 v[188:191], a[88:91], a[184:187], v[188:191]
s_waitcnt lgkmcnt(7)
ds_read_b64_tr_b16 a[82:83], v25 offset:4640
v_mfma_f32_16x16x32_bf16 v[188:191], a[92:95], a[192:195], v[188:191]
ds_read_b64_tr_b16 a[84:85], v25 offset:9248
v_mfma_f32_16x16x32_bf16 v[180:183], a[92:95], a[188:191], v[180:183]
ds_read_b64_tr_b16 a[86:87], v25 offset:13856
v_mfma_f32_16x16x32_bf16 v[180:183], a[88:91], a[180:183], v[180:183]
v_rcp_f32 v101, v101
v_mfma_f32_16x16x32_bf16 v[120:123], a[64:67], a[180:183], v[120:123]
s_waitcnt lgkmcnt(8)
v_rcp_f32 v102, v102
v_mfma_f32_16x16x32_bf16 v[120:123], a[68:71], a[188:191], v[120:123]
v_rcp_f32 v103, v103
v_mfma_f32_16x16x32_bf16 v[124:127], a[68:71], a[192:195], v[124:127]
v_mul_f32 v93, v93, v101
v_mul_f32 v94, v94, v102
v_mfma_f32_16x16x32_bf16 v[124:127], a[64:67], a[184:187], v[124:127]
s_waitcnt lgkmcnt(6)
v_mul_f32 v95, v95, v103
v_mul_f32 v97, v97, v101
v_mfma_f32_16x16x32_bf16 v[36:39], a[72:75], a[208:211], v[36:39]
s_waitcnt lgkmcnt(2)
v_mul_f32 v98, v98, v102
v_mul_f32 v99, v99, v103
v_cvt_pk_bf16_f32 v92, v92, v93
v_cvt_pk_bf16_f32 v93, v94, v95
v_cvt_pk_bf16_f32 v96, v96, v97
v_cvt_pk_bf16_f32 v97, v98, v99
v_mfma_f32_16x16x32_bf16 v[36:39], a[76:79], a[224:227], v[36:39]
ds_read_b64_tr_b16 a[88:89], v25 offset:64
ds_read_b64_tr_b16 a[90:91], v25 offset:4672
v_mfma_f32_16x16x32_bf16 v[32:35], a[76:79], a[216:219], v[32:35]
ds_read_b64_tr_b16 a[92:93], v25 offset:9280
ds_read_b64_tr_b16 a[94:95], v25 offset:13888
buffer_store_dwordx2 v[92:93], v104, s[4:7], s87 offen sc1
v_mfma_f32_16x16x32_bf16 v[32:35], a[72:75], a[200:203], v[32:35]
ds_read_b64_tr_b16 a[64:65], v25 offset:96
v_mfma_f32_16x16x32_bf16 v[40:43], a[80:83], a[200:203], v[40:43]
s_waitcnt lgkmcnt(5)
ds_read_b64_tr_b16 a[66:67], v25 offset:4704
v_mfma_f32_16x16x32_bf16 v[40:43], a[84:87], a[216:219], v[40:43]
buffer_store_dwordx2 v[96:97], v105, s[4:7], s87 offen offset:512 sc1
s_add_u32 s87, s87, 0x4800
v_mfma_f32_16x16x32_bf16 v[44:47], a[84:87], a[224:227], v[44:47]
ds_read_b64_tr_b16 a[68:69], v25 offset:9312
ds_read_b64_tr_b16 a[70:71], v25 offset:13920
v_mfma_f32_16x16x32_bf16 v[44:47], a[80:83], a[208:211], v[44:47]
s_waitcnt lgkmcnt(6)
ds_read_b64_tr_b16 a[72:73], v25 offset:128
v_mfma_f32_16x16x32_bf16 v[52:55], a[88:91], a[208:211], v[52:55]
s_waitcnt lgkmcnt(5)
ds_read_b64_tr_b16 a[74:75], v25 offset:4736
v_mfma_f32_16x16x32_bf16 v[52:55], a[92:95], a[224:227], v[52:55]
ds_read_b64_tr_b16 a[76:77], v25 offset:9344
v_mfma_f32_16x16x32_bf16 v[48:51], a[92:95], a[216:219], v[48:51]
ds_read_b64_tr_b16 a[78:79], v25 offset:13952
v_mfma_f32_16x16x32_bf16 v[48:51], a[88:91], a[200:203], v[48:51]
s_waitcnt lgkmcnt(6)
ds_read_b64_tr_b16 a[80:81], v25 offset:160
v_mfma_f32_16x16x32_bf16 v[56:59], a[64:67], a[200:203], v[56:59]
s_waitcnt lgkmcnt(5)
ds_read_b64_tr_b16 a[82:83], v25 offset:4768
v_mfma_f32_16x16x32_bf16 v[56:59], a[68:71], a[216:219], v[56:59]
ds_read_b64_tr_b16 a[84:85], v25 offset:9376
v_mfma_f32_16x16x32_bf16 v[60:63], a[68:71], a[224:227], v[60:63]
ds_read_b64_tr_b16 a[86:87], v25 offset:13984
v_mfma_f32_16x16x32_bf16 v[60:63], a[64:67], a[208:211], v[60:63]
s_waitcnt lgkmcnt(6)
ds_read_b64_tr_b16 a[88:89], v25 offset:192
v_mfma_f32_16x16x32_bf16 v[140:143], a[72:75], a[208:211], v[140:143]
s_waitcnt lgkmcnt(5)
ds_read_b64_tr_b16 a[90:91], v25 offset:4800
v_mfma_f32_16x16x32_bf16 v[140:143], a[76:79], a[224:227], v[140:143]
ds_read_b64_tr_b16 a[92:93], v25 offset:9408
v_mfma_f32_16x16x32_bf16 v[132:135], a[76:79], a[216:219], v[132:135]
ds_read_b64_tr_b16 a[94:95], v25 offset:14016
v_mfma_f32_16x16x32_bf16 v[132:135], a[72:75], a[200:203], v[132:135]
s_waitcnt lgkmcnt(6)
ds_read_b64_tr_b16 a[64:65], v25 offset:224
v_mfma_f32_16x16x32_bf16 v[148:151], a[80:83], a[200:203], v[148:151]
s_waitcnt lgkmcnt(5)
ds_read_b64_tr_b16 a[66:67], v25 offset:4832
v_mfma_f32_16x16x32_bf16 v[148:151], a[84:87], a[216:219], v[148:151]
ds_read_b64_tr_b16 a[68:69], v25 offset:9440
ds_read_b64_tr_b16 a[70:71], v25 offset:14048
ds_read_b64_tr_b16 a[72:73], v25 offset:256
ds_read_b64_tr_b16 a[74:75], v25 offset:4864
ds_read_b64_tr_b16 a[76:77], v25 offset:9472
ds_read_b64_tr_b16 a[78:79], v25 offset:14080
s_barrier
v_mfma_f32_16x16x32_bf16 v[156:159], a[84:87], a[224:227], v[156:159]
v_mfma_f32_16x16x32_bf16 v[156:159], a[80:83], a[208:211], v[156:159]
s_waitcnt lgkmcnt(10)
ds_read_b64_tr_b16 a[80:81], v25 offset:18432
v_mfma_f32_16x16x32_bf16 v[172:175], a[88:91], a[208:211], v[172:175]
s_waitcnt lgkmcnt(9)
ds_read_b64_tr_b16 a[82:83], v25 offset:23040
v_mfma_f32_16x16x32_bf16 v[172:175], a[92:95], a[224:227], v[172:175]
ds_read_b64_tr_b16 a[84:85], v25 offset:27648
v_mfma_f32_16x16x32_bf16 v[164:167], a[92:95], a[216:219], v[164:167]
ds_read_b64_tr_b16 a[86:87], v25 offset:32256
v_mfma_f32_16x16x32_bf16 v[164:167], a[88:91], a[200:203], v[164:167]
s_waitcnt lgkmcnt(10)
ds_read_b64_tr_b16 a[88:89], v25 offset:36864
v_mfma_f32_16x16x32_bf16 v[180:183], a[64:67], a[200:203], v[180:183]
s_waitcnt lgkmcnt(7)
ds_read_b64_tr_b16 a[90:91], v25 offset:41472
v_mfma_f32_16x16x32_bf16 v[180:183], a[68:71], a[216:219], v[180:183]
ds_read_b64_tr_b16 a[92:93], v25 offset:46080
v_mfma_f32_16x16x32_bf16 v[188:191], a[68:71], a[224:227], v[188:191]
ds_read_b64_tr_b16 a[94:95], v25 offset:50688
v_mfma_f32_16x16x32_bf16 v[188:191], a[64:67], a[208:211], v[188:191]
ds_read_b64_tr_b16 a[64:65], v25 offset:18464
v_mfma_f32_16x16x32_bf16 v[124:127], a[72:75], a[208:211], v[124:127]
s_waitcnt lgkmcnt(7)
ds_read_b64_tr_b16 a[66:67], v25 offset:23072
v_mfma_f32_16x16x32_bf16 v[124:127], a[76:79], a[224:227], v[124:127]
ds_read_b64_tr_b16 a[68:69], v25 offset:27680
v_mfma_f32_16x16x32_bf16 v[120:123], a[76:79], a[216:219], v[120:123]
ds_read_b64_tr_b16 a[70:71], v25 offset:32288
v_mfma_f32_16x16x32_bf16 v[120:123], a[72:75], a[200:203], v[120:123]
ds_read_b64_tr_b16 a[72:73], v25 offset:36896
v_mfma_f32_16x16x32_bf16 v[32:35], a[80:83], a[232:235], v[32:35]
s_waitcnt lgkmcnt(7)
ds_read_b64_tr_b16 a[74:75], v25 offset:41504
v_mfma_f32_16x16x32_bf16 v[32:35], a[84:87], a[248:251], v[32:35]
ds_read_b64_tr_b16 a[76:77], v25 offset:46112
v_mfma_f32_16x16x32_bf16 v[36:39], a[84:87], a[196:199], v[36:39]
ds_read_b64_tr_b16 a[78:79], v25 offset:50720
v_mfma_f32_16x16x32_bf16 v[36:39], a[80:83], a[240:243], v[36:39]
s_waitcnt lgkmcnt(7)
ds_read_b64_tr_b16 a[80:81], v25 offset:18496
v_mfma_f32_16x16x32_bf16 v[36:39], a[88:91], a[204:207], v[36:39]
s_lshl_b32 s77, s50, 3
s_add_u32 s77, s77, s51
s_lshl_b32 s77, s77, 3
s_add_u32 s77, s77, s48
s_lshl_b32 s77, s77, 2
s_lshl_b32 s77, s77, 2
s_add_u32 s77, s77, 0x5005000
v_and_b32 v3, 12, v21
v_mfma_f32_16x16x32_bf16 v[36:39], a[92:95], a[0:3], v[36:39]
buffer_load_dword v19, v3, s[4:7], s77 offen sc1
ds_read_b64_tr_b16 a[82:83], v25 offset:23104
v_mfma_f32_16x16x32_bf16 v[32:35], a[92:95], a[236:239], v[32:35]
ds_read_b64_tr_b16 a[84:85], v25 offset:27712
v_mfma_f32_16x16x32_bf16 v[32:35], a[88:91], a[228:231], v[32:35]
s_waitcnt lgkmcnt(5)
ds_read_b64_tr_b16 a[86:87], v25 offset:32320
v_mfma_f32_16x16x32_bf16 v[40:43], a[64:67], a[232:235], v[40:43]
ds_read_b64_tr_b16 a[88:89], v25 offset:36928
v_mfma_f32_16x16x32_bf16 v[40:43], a[68:71], a[248:251], v[40:43]
ds_read_b64_tr_b16 a[90:91], v25 offset:41536
v_mfma_f32_16x16x32_bf16 v[44:47], a[68:71], a[196:199], v[44:47]
ds_read_b64_tr_b16 a[92:93], v25 offset:46144
v_mfma_f32_16x16x32_bf16 v[44:47], a[64:67], a[240:243], v[44:47]
ds_read_b64_tr_b16 a[94:95], v25 offset:50752
v_mfma_f32_16x16x32_bf16 v[44:47], a[72:75], a[204:207], v[44:47]
s_waitcnt lgkmcnt(7)
ds_read_b64_tr_b16 a[64:65], v25 offset:18528
v_mfma_f32_16x16x32_bf16 v[44:47], a[76:79], a[0:3], v[44:47]
ds_read_b64_tr_b16 a[66:67], v25 offset:23136
v_mfma_f32_16x16x32_bf16 v[40:43], a[76:79], a[236:239], v[40:43]
s_waitcnt lgkmcnt(7)
ds_read_b64_tr_b16 a[68:69], v25 offset:27744
v_mfma_f32_16x16x32_bf16 v[40:43], a[72:75], a[228:231], v[40:43]
s_lshl_b32 s78, s54, 2
s_add_u32 s78, s78, s48
s_lshl_b32 s78, s78, 5
s_add_u32 s78, s78, s53
s_lshl_b32 s78, s78, 2
s_add_u32 s78, s78, 0x5002000
v_mfma_f32_16x16x32_bf16 v[48:51], a[80:83], a[232:235], v[48:51]
s_waitcnt vmcnt(1) lgkmcnt(6)
buffer_store_dword v18, v20, s[4:7], s78 offen sc1
ds_read_b64_tr_b16 a[70:71], v25 offset:32352
v_mfma_f32_16x16x32_bf16 v[48:51], a[84:87], a[248:251], v[48:51]
ds_read_b64_tr_b16 a[72:73], v25 offset:36960
v_mfma_f32_16x16x32_bf16 v[52:55], a[84:87], a[196:199], v[52:55]
ds_read_b64_tr_b16 a[74:75], v25 offset:41568
v_mfma_f32_16x16x32_bf16 v[52:55], a[80:83], a[240:243], v[52:55]
s_waitcnt lgkmcnt(6)
ds_read_b64_tr_b16 a[76:77], v25 offset:46176
v_mfma_f32_16x16x32_bf16 v[52:55], a[88:91], a[204:207], v[52:55]
ds_read_b64_tr_b16 a[78:79], v25 offset:50784
v_mfma_f32_16x16x32_bf16 v[52:55], a[92:95], a[0:3], v[52:55]
s_lshl_b32 s68, s50, 2
s_add_u32 s68, s68, s52
s_mul_i32 s68, s68, 0x50000
s_add_u32 s68, s68, 0x3000000
s_mul_i32 s71, s51, 0x1400
s_add_u32 s68, s68, s71
s_sub_u32 s72, 7, s48
s_mul_i32 s72, s72, 0xa000
s_add_u32 s72, s72, s68
s_mul_i32 s71, s48, 0xa000
s_add_u32 s68, s68, s71
v_mfma_f32_16x16x32_bf16 v[48:51], a[92:95], a[236:239], v[48:51]
v_cvt_pk_bf16_f32 v32, v32, v33
v_cvt_pk_bf16_f32 v33, v34, v35
v_cvt_pk_bf16_f32 v34, v40, v41
v_cvt_pk_bf16_f32 v35, v42, v43
v_mfma_f32_16x16x32_bf16 v[48:51], a[88:91], a[228:231], v[48:51]
s_waitcnt lgkmcnt(4)
buffer_store_dwordx4 v[32:35], v1, s[4:7], s68 offen sc1
ds_read_b64_tr_b16 a[80:81], v25 offset:18560
v_mfma_f32_16x16x32_bf16 v[56:59], a[64:67], a[232:235], v[56:59]
ds_read_b64_tr_b16 a[82:83], v25 offset:23168
v_cvt_pk_bf16_f32 v36, v36, v37
v_mfma_f32_16x16x32_bf16 v[56:59], a[68:71], a[248:251], v[56:59]
ds_read_b64_tr_b16 a[84:85], v25 offset:27776
v_cvt_pk_bf16_f32 v37, v38, v39
v_mfma_f32_16x16x32_bf16 v[60:63], a[68:71], a[196:199], v[60:63]
ds_read_b64_tr_b16 a[86:87], v25 offset:32384
v_cvt_pk_bf16_f32 v38, v44, v45
v_mfma_f32_16x16x32_bf16 v[60:63], a[64:67], a[240:243], v[60:63]
s_waitcnt lgkmcnt(4)
ds_read_b64_tr_b16 a[88:89], v25 offset:36992
v_cvt_pk_bf16_f32 v39, v46, v47
v_mfma_f32_16x16x32_bf16 v[60:63], a[72:75], a[204:207], v[60:63]
ds_read_b64_tr_b16 a[90:91], v25 offset:41600
v_mfma_f32_16x16x32_bf16 v[60:63], a[76:79], a[0:3], v[60:63]
ds_read_b64_tr_b16 a[92:93], v25 offset:46208
v_mfma_f32_16x16x32_bf16 v[56:59], a[76:79], a[236:239], v[56:59]
ds_read_b64_tr_b16 a[94:95], v25 offset:50816
v_mfma_f32_16x16x32_bf16 v[56:59], a[72:75], a[228:231], v[56:59]
s_waitcnt lgkmcnt(6)
ds_read_b64_tr_b16 a[64:65], v25 offset:18592
v_mfma_f32_16x16x32_bf16 v[132:135], a[80:83], a[232:235], v[132:135]
s_waitcnt lgkmcnt(5)
ds_read_b64_tr_b16 a[66:67], v25 offset:23200
v_mfma_f32_16x16x32_bf16 v[132:135], a[84:87], a[248:251], v[132:135]
ds_read_b64_tr_b16 a[68:69], v25 offset:27808
v_mfma_f32_16x16x32_bf16 v[140:143], a[84:87], a[196:199], v[140:143]
ds_read_b64_tr_b16 a[70:71], v25 offset:32416
v_mfma_f32_16x16x32_bf16 v[140:143], a[80:83], a[240:243], v[140:143]
s_waitcnt lgkmcnt(6)
ds_read_b64_tr_b16 a[72:73], v25 offset:37024
v_cvt_pk_bf16_f32 v48, v48, v49
v_mfma_f32_16x16x32_bf16 v[140:143], a[88:91], a[204:207], v[140:143]
s_waitcnt lgkmcnt(5)
ds_read_b64_tr_b16 a[74:75], v25 offset:41632
v_cvt_pk_bf16_f32 v49, v50, v51
v_mfma_f32_16x16x32_bf16 v[140:143], a[92:95], a[0:3], v[140:143]
ds_read_b64_tr_b16 a[76:77], v25 offset:46240
buffer_store_dwordx4 v[36:39], v1, s[4:7], s72 offen sc1
v_mfma_f32_16x16x32_bf16 v[132:135], a[92:95], a[236:239], v[132:135]
ds_read_b64_tr_b16 a[78:79], v25 offset:50848
v_cvt_pk_bf16_f32 v50, v56, v57
v_mfma_f32_16x16x32_bf16 v[132:135], a[88:91], a[228:231], v[132:135]
s_waitcnt lgkmcnt(6)
ds_read_b64_tr_b16 a[80:81], v25 offset:18624
v_cvt_pk_bf16_f32 v51, v58, v59
v_mfma_f32_16x16x32_bf16 v[148:151], a[64:67], a[232:235], v[148:151]
s_waitcnt lgkmcnt(5)
ds_read_b64_tr_b16 a[82:83], v25 offset:23232
v_cvt_pk_bf16_f32 v52, v52, v53
v_mfma_f32_16x16x32_bf16 v[148:151], a[68:71], a[248:251], v[148:151]
ds_read_b64_tr_b16 a[84:85], v25 offset:27840
v_cvt_pk_bf16_f32 v53, v54, v55
v_mfma_f32_16x16x32_bf16 v[156:159], a[68:71], a[196:199], v[156:159]
ds_read_b64_tr_b16 a[86:87], v25 offset:32448
v_cvt_pk_bf16_f32 v54, v60, v61
v_mfma_f32_16x16x32_bf16 v[156:159], a[64:67], a[240:243], v[156:159]
s_waitcnt lgkmcnt(6)
ds_read_b64_tr_b16 a[88:89], v25 offset:37056
v_cvt_pk_bf16_f32 v55, v62, v63
v_mfma_f32_16x16x32_bf16 v[156:159], a[72:75], a[204:207], v[156:159]
s_waitcnt lgkmcnt(5)
ds_read_b64_tr_b16 a[90:91], v25 offset:41664
v_mfma_f32_16x16x32_bf16 v[156:159], a[76:79], a[0:3], v[156:159]
ds_read_b64_tr_b16 a[92:93], v25 offset:46272
v_mfma_f32_16x16x32_bf16 v[148:151], a[76:79], a[236:239], v[148:151]
ds_read_b64_tr_b16 a[94:95], v25 offset:50880
v_mfma_f32_16x16x32_bf16 v[148:151], a[72:75], a[228:231], v[148:151]
s_waitcnt lgkmcnt(6)
ds_read_b64_tr_b16 a[64:65], v25 offset:18656
v_mfma_f32_16x16x32_bf16 v[164:167], a[80:83], a[232:235], v[164:167]
s_waitcnt lgkmcnt(5)
ds_read_b64_tr_b16 a[66:67], v25 offset:23264
v_mfma_f32_16x16x32_bf16 v[164:167], a[84:87], a[248:251], v[164:167]
ds_read_b64_tr_b16 a[68:69], v25 offset:27872
v_mfma_f32_16x16x32_bf16 v[172:175], a[84:87], a[196:199], v[172:175]
ds_read_b64_tr_b16 a[70:71], v25 offset:32480
v_mfma_f32_16x16x32_bf16 v[172:175], a[80:83], a[240:243], v[172:175]
s_waitcnt lgkmcnt(6)
buffer_store_dwordx4 v[48:51], v1, s[4:7], s68 offen offset:1024 sc1
ds_read_b64_tr_b16 a[72:73], v25 offset:37088
v_mfma_f32_16x16x32_bf16 v[172:175], a[88:91], a[204:207], v[172:175]
s_waitcnt lgkmcnt(5)
ds_read_b64_tr_b16 a[74:75], v25 offset:41696
v_cvt_pk_bf16_f32 v132, v132, v133
v_mfma_f32_16x16x32_bf16 v[172:175], a[92:95], a[0:3], v[172:175]
ds_read_b64_tr_b16 a[76:77], v25 offset:46304
v_cvt_pk_bf16_f32 v133, v134, v135
v_mfma_f32_16x16x32_bf16 v[164:167], a[92:95], a[236:239], v[164:167]
ds_read_b64_tr_b16 a[78:79], v25 offset:50912
v_cvt_pk_bf16_f32 v134, v148, v149
v_mfma_f32_16x16x32_bf16 v[164:167], a[88:91], a[228:231], v[164:167]
s_waitcnt lgkmcnt(6)
ds_read_b64_tr_b16 a[80:81], v25 offset:18688
v_cvt_pk_bf16_f32 v135, v150, v151
v_mfma_f32_16x16x32_bf16 v[180:183], a[64:67], a[232:235], v[180:183]
s_waitcnt lgkmcnt(5)
ds_read_b64_tr_b16 a[82:83], v25 offset:23296
v_cvt_pk_bf16_f32 v140, v140, v141
v_mfma_f32_16x16x32_bf16 v[180:183], a[68:71], a[248:251], v[180:183]
ds_read_b64_tr_b16 a[84:85], v25 offset:27904
v_cvt_pk_bf16_f32 v141, v142, v143
v_mfma_f32_16x16x32_bf16 v[188:191], a[68:71], a[196:199], v[188:191]
ds_read_b64_tr_b16 a[86:87], v25 offset:32512
v_cvt_pk_bf16_f32 v142, v156, v157
v_mfma_f32_16x16x32_bf16 v[188:191], a[64:67], a[240:243], v[188:191]
s_waitcnt lgkmcnt(6)
ds_read_b64_tr_b16 a[88:89], v25 offset:37120
v_cvt_pk_bf16_f32 v143, v158, v159
v_mfma_f32_16x16x32_bf16 v[188:191], a[72:75], a[204:207], v[188:191]
s_waitcnt lgkmcnt(5)
ds_read_b64_tr_b16 a[90:91], v25 offset:41728
v_mfma_f32_16x16x32_bf16 v[188:191], a[76:79], a[0:3], v[188:191]
ds_read_b64_tr_b16 a[92:93], v25 offset:46336
v_mfma_f32_16x16x32_bf16 v[180:183], a[76:79], a[236:239], v[180:183]
ds_read_b64_tr_b16 a[94:95], v25 offset:50944
v_mfma_f32_16x16x32_bf16 v[180:183], a[72:75], a[228:231], v[180:183]
s_waitcnt lgkmcnt(6)
ds_read_b64_tr_b16 a[64:65], v13
v_mfma_f32_16x16x32_bf16 v[120:123], a[80:83], a[232:235], v[120:123]
s_waitcnt lgkmcnt(5)
ds_read_b64_tr_b16 a[66:67], v13 offset:4608
v_mfma_f32_16x16x32_bf16 v[120:123], a[84:87], a[248:251], v[120:123]
ds_read_b64_tr_b16 a[68:69], v13 offset:9216
buffer_store_dwordx4 v[52:55], v1, s[4:7], s72 offen offset:1024 sc1
v_mfma_f32_16x16x32_bf16 v[124:127], a[84:87], a[196:199], v[124:127]
ds_read_b64_tr_b16 a[70:71], v13 offset:13824
v_mfma_f32_16x16x32_bf16 v[124:127], a[80:83], a[240:243], v[124:127]
s_waitcnt lgkmcnt(6)
ds_read_b64_tr_b16 a[72:73], v13 offset:32
v_cvt_pk_bf16_f32 v164, v164, v165
v_mfma_f32_16x16x32_bf16 v[124:127], a[88:91], a[204:207], v[124:127]
s_waitcnt lgkmcnt(5)
ds_read_b64_tr_b16 a[74:75], v13 offset:4640
v_cvt_pk_bf16_f32 v165, v166, v167
v_mfma_f32_16x16x32_bf16 v[124:127], a[92:95], a[0:3], v[124:127]
ds_read_b64_tr_b16 a[76:77], v13 offset:9248
v_cvt_pk_bf16_f32 v166, v180, v181
v_mfma_f32_16x16x32_bf16 v[120:123], a[92:95], a[236:239], v[120:123]
ds_read_b64_tr_b16 a[78:79], v13 offset:13856
v_cvt_pk_bf16_f32 v167, v182, v183
v_mfma_f32_16x16x32_bf16 v[120:123], a[88:91], a[228:231], v[120:123]
s_waitcnt lgkmcnt(6)
ds_read_b64_tr_b16 a[80:81], v13 offset:64
v_cvt_pk_bf16_f32 v172, v172, v173
v_mfma_f32_16x16x32_bf16 v[196:199], a[64:67], v[192:195], 0
s_waitcnt lgkmcnt(5)
ds_read_b64_tr_b16 a[82:83], v13 offset:4672
v_cvt_pk_bf16_f32 v173, v174, v175
v_mfma_f32_16x16x32_bf16 v[196:199], a[68:71], v[200:203], v[196:199]
s_waitcnt vmcnt(5)
v_cmp_ne_u32 vcc, v19, v18
s_nop 1
s_cbranch_vccnz L_spin_cb
L_back_cb:
v_mfma_f32_16x16x32_bf16 v[204:207], a[68:71], v[232:235], 0
s_add_u32 s70, s52, 1
s_and_b32 s70, s70, 3
s_sub_u32 s70, s70, s52
s_lshl_b32 s70, s70, 12
s_add_u32 s65, s57, s70
s_add_u32 s66, s58, s70
ds_read_b64_tr_b16 a[84:85], v13 offset:9280
ds_read_b64_tr_b16 a[86:87], v13 offset:13888
v_mfma_f32_16x16x32_bf16 v[204:207], a[64:67], v[224:227], v[204:207]
s_waitcnt lgkmcnt(6)
buffer_load_dwordx4 a[4:7], v1, s[4:7], s65 offen sc1
buffer_load_dwordx4 a[8:11], v1, s[4:7], s66 offen sc1
v_mfma_f32_16x16x32_bf16 v[220:223], a[72:75], v[224:227], 0
s_waitcnt lgkmcnt(4)
ds_read_b64_tr_b16 a[88:89], v13 offset:96
v_cvt_pk_bf16_f32 v174, v188, v189
v_mfma_f32_16x16x32_bf16 v[220:223], a[76:79], v[232:235], v[220:223]
ds_read_b64_tr_b16 a[90:91], v13 offset:4704
v_cvt_pk_bf16_f32 v175, v190, v191
v_mfma_f32_16x16x32_bf16 v[212:215], a[76:79], v[200:203], 0
ds_read_b64_tr_b16 a[92:93], v13 offset:9312
ds_read_b64_tr_b16 a[94:95], v13 offset:13920
v_mfma_f32_16x16x32_bf16 v[212:215], a[72:75], v[192:195], v[212:215]
s_waitcnt lgkmcnt(6)
s_lshr_b32 s78, s51, 1
s_lshl_b32 s71, s50, 2
s_add_u32 s78, s78, s71
s_lshl_b32 s78, s78, 7
s_add_u32 s78, s78, 0x5002000
buffer_load_dwordx4 a[12:15], v1, s[4:7], s65 offen offset:1024 sc1
v_mfma_f32_16x16x32_bf16 v[228:231], a[80:83], v[192:195], 0
s_waitcnt lgkmcnt(4)
buffer_load_dword v19, v21, s[4:7], s78 offen sc1
ds_read_b64_tr_b16 a[64:65], v13 offset:128
v_mfma_f32_16x16x32_bf16 v[228:231], a[84:87], v[200:203], v[228:231]
ds_read_b64_tr_b16 a[66:67], v13 offset:4736
buffer_store_dwordx4 v[132:135], v1, s[4:7], s68 offen offset:2048 sc1
v_mfma_f32_16x16x32_bf16 v[236:239], a[84:87], v[232:235], 0
ds_read_b64_tr_b16 a[68:69], v13 offset:9344
ds_read_b64_tr_b16 a[70:71], v13 offset:13952
v_mfma_f32_16x16x32_bf16 v[236:239], a[80:83], v[224:227], v[236:239]
s_waitcnt lgkmcnt(6)
ds_read_b64_tr_b16 a[72:73], v13 offset:160
v_cvt_pk_bf16_f32 v120, v120, v121
v_mfma_f32_16x16x32_bf16 v[252:255], a[88:91], v[224:227], 0
s_waitcnt lgkmcnt(5)
ds_read_b64_tr_b16 a[74:75], v13 offset:4768
v_cvt_pk_bf16_f32 v121, v122, v123
v_mfma_f32_16x16x32_bf16 v[252:255], a[92:95], v[232:235], v[252:255]
ds_read_b64_tr_b16 a[76:77], v13 offset:9376
v_cvt_pk_bf16_f32 v124, v124, v125
v_mfma_f32_16x16x32_bf16 v[244:247], a[92:95], v[200:203], 0
ds_read_b64_tr_b16 a[78:79], v13 offset:13984
v_cvt_pk_bf16_f32 v125, v126, v127
v_mfma_f32_16x16x32_bf16 v[244:247], a[88:91], v[192:195], v[244:247]
s_waitcnt lgkmcnt(6)
buffer_load_dwordx4 a[16:19], v1, s[4:7], s66 offen offset:1024 sc1
ds_read_b64_tr_b16 a[80:81], v13 offset:192
v_mfma_f32_16x16x32_bf16 v[64:67], a[64:67], v[192:195], 0
s_waitcnt lgkmcnt(5)
ds_read_b64_tr_b16 a[82:83], v13 offset:4800
v_mfma_f32_16x16x32_bf16 v[64:67], a[68:71], v[200:203], v[64:67]
ds_read_b64_tr_b16 a[84:85], v13 offset:9408
buffer_load_dwordx4 a[20:23], v1, s[4:7], s65 offen offset:2048 sc1
v_mfma_f32_16x16x32_bf16 v[68:71], a[68:71], v[232:235], 0
ds_read_b64_tr_b16 a[86:87], v13 offset:14016
v_mfma_f32_16x16x32_bf16 v[68:71], a[64:67], v[224:227], v[68:71]
s_waitcnt lgkmcnt(6)
ds_read_b64_tr_b16 a[88:89], v13 offset:224
v_mfma_f32_16x16x32_bf16 v[76:79], a[72:75], v[224:227], 0
s_waitcnt lgkmcnt(5)
ds_read_b64_tr_b16 a[90:91], v13 offset:4832
buffer_load_dwordx4 a[24:27], v1, s[4:7], s66 offen offset:2048 sc1
v_mfma_f32_16x16x32_bf16 v[76:79], a[76:79], v[232:235], v[76:79]
ds_read_b64_tr_b16 a[92:93], v13 offset:9440
v_mfma_f32_16x16x32_bf16 v[72:75], a[76:79], v[200:203], 0
ds_read_b64_tr_b16 a[94:95], v13 offset:14048
v_mfma_f32_16x16x32_bf16 v[72:75], a[72:75], v[192:195], v[72:75]
s_waitcnt lgkmcnt(6)
buffer_store_dwordx4 v[140:143], v1, s[4:7], s72 offen offset:2048 sc1
ds_read_b64_tr_b16 a[64:65], v13 offset:256
v_mfma_f32_16x16x32_bf16 v[80:83], a[80:83], v[192:195], 0
s_waitcnt lgkmcnt(5)
ds_read_b64_tr_b16 a[66:67], v13 offset:4864
v_mfma_f32_16x16x32_bf16 v[80:83], a[84:87], v[200:203], v[80:83]
ds_read_b64_tr_b16 a[68:69], v13 offset:9472
v_mfma_f32_16x16x32_bf16 v[84:87], a[84:87], v[232:235], 0
ds_read_b64_tr_b16 a[70:71], v13 offset:14080
v_mfma_f32_16x16x32_bf16 v[84:87], a[80:83], v[224:227], v[84:87]
s_waitcnt lgkmcnt(6)
ds_read_b64_tr_b16 a[72:73], v13 offset:18432
v_mfma_f32_16x16x32_bf16 v[92:95], a[88:91], v[224:227], 0
s_waitcnt lgkmcnt(5)
ds_read_b64_tr_b16 a[74:75], v13 offset:23040
v_mfma_f32_16x16x32_bf16 v[92:95], a[92:95], v[232:235], v[92:95]
ds_read_b64_tr_b16 a[76:77], v17
buffer_load_dwordx4 a[28:31], v1, s[4:7], s65 offen offset:3072 sc1
v_mfma_f32_16x16x32_bf16 v[88:91], a[92:95], v[200:203], 0
ds_read_b64_tr_b16 a[78:79], v17 offset:4608
v_mfma_f32_16x16x32_bf16 v[88:91], a[88:91], v[192:195], v[88:91]
s_waitcnt lgkmcnt(6)
ds_read_b64_tr_b16 a[80:81], v13 offset:18464
v_mfma_f32_16x16x32_bf16 v[96:99], a[64:67], v[192:195], 0
s_waitcnt lgkmcnt(5)
ds_read_b64_tr_b16 a[82:83], v13 offset:23072
buffer_load_dwordx4 a[32:35], v1, s[4:7], s66 offen offset:3072 sc1
v_mfma_f32_16x16x32_bf16 v[96:99], a[68:71], v[200:203], v[96:99]
ds_read_b64_tr_b16 a[84:85], v17 offset:32
v_mfma_f32_16x16x32_bf16 v[100:103], a[68:71], v[232:235], 0
ds_read_b64_tr_b16 a[86:87], v17 offset:4640
v_mfma_f32_16x16x32_bf16 v[100:103], a[64:67], v[224:227], v[100:103]
s_waitcnt lgkmcnt(6)
ds_read_b64_tr_b16 a[88:89], v13 offset:18496
v_mfma_f32_16x16x32_bf16 v[204:207], a[72:75], v[240:243], v[204:207]
s_waitcnt lgkmcnt(5)
s_add_u32 s70, s52, 2
s_and_b32 s70, s70, 3
s_sub_u32 s70, s70, s52
s_lshl_b32 s70, s70, 12
s_add_u32 s65, s57, s70
s_add_u32 s66, s58, s70
v_mfma_f32_16x16x32_bf16 v[204:207], a[76:79], v[248:251], v[204:207]
ds_read_b64_tr_b16 a[90:91], v13 offset:23104
buffer_load_dwordx4 a[36:39], v1, s[4:7], s65 offen sc1
v_mfma_f32_16x16x32_bf16 v[196:199], a[76:79], v[216:219], v[196:199]
ds_read_b64_tr_b16 a[92:93], v17 offset:64
ds_read_b64_tr_b16 a[94:95], v17 offset:4672
buffer_store_dwordx4 v[164:167], v1, s[4:7], s68 offen offset:3072 sc1
v_mfma_f32_16x16x32_bf16 v[196:199], a[72:75], v[208:211], v[196:199]
s_waitcnt lgkmcnt(6)
ds_read_b64_tr_b16 a[64:65], v13 offset:18528
v_mfma_f32_16x16x32_bf16 v[212:215], a[80:83], v[208:211], v[212:215]
s_waitcnt lgkmcnt(5)
ds_read_b64_tr_b16 a[66:67], v13 offset:23136
v_mfma_f32_16x16x32_bf16 v[212:215], a[84:87], v[216:219], v[212:215]
ds_read_b64_tr_b16 a[68:69], v17 offset:96
v_mfma_f32_16x16x32_bf16 v[220:223], a[84:87], v[248:251], v[220:223]
ds_read_b64_tr_b16 a[70:71], v17 offset:4704
v_mfma_f32_16x16x32_bf16 v[220:223], a[80:83], v[240:243], v[220:223]
s_waitcnt lgkmcnt(6)
buffer_load_dwordx4 a[40:43], v1, s[4:7], s66 offen sc1
ds_read_b64_tr_b16 a[72:73], v13 offset:18560
v_mfma_f32_16x16x32_bf16 v[236:239], a[88:91], v[240:243], v[236:239]
s_waitcnt lgkmcnt(5)
ds_read_b64_tr_b16 a[74:75], v13 offset:23168
v_mfma_f32_16x16x32_bf16 v[236:239], a[92:95], v[248:251], v[236:239]
ds_read_b64_tr_b16 a[76:77], v17 offset:128
v_mfma_f32_16x16x32_bf16 v[228:231], a[92:95], v[216:219], v[228:231]
ds_read_b64_tr_b16 a[78:79], v17 offset:4736
buffer_load_dwordx4 a[44:47], v1, s[4:7], s65 offen offset:1024 sc1
v_mfma_f32_16x16x32_bf16 v[228:231], a[88:91], v[208:211], v[228:231]
s_waitcnt lgkmcnt(6)
ds_read_b64_tr_b16 a[80:81], v13 offset:18592
v_mfma_f32_16x16x32_bf16 v[244:247], a[64:67], v[208:211], v[244:247]
s_waitcnt lgkmcnt(5)
ds_read_b64_tr_b16 a[82:83], v13 offset:23200
v_mfma_f32_16x16x32_bf16 v[244:247], a[68:71], v[216:219], v[244:247]
ds_read_b64_tr_b16 a[84:85], v17 offset:160
buffer_store_dwordx4 v[172:175], v1, s[4:7], s72 offen offset:3072 sc1
v_mfma_f32_16x16x32_bf16 v[252:255], a[68:71], v[248:251], v[252:255]
ds_read_b64_tr_b16 a[86:87], v17 offset:4768
v_mfma_f32_16x16x32_bf16 v[252:255], a[64:67], v[240:243], v[252:255]
s_waitcnt lgkmcnt(6)
ds_read_b64_tr_b16 a[88:89], v13 offset:18624
v_mfma_f32_16x16x32_bf16 v[68:71], a[72:75], v[240:243], v[68:71]
s_waitcnt lgkmcnt(5)
ds_read_b64_tr_b16 a[90:91], v13 offset:23232
v_mfma_f32_16x16x32_bf16 v[68:71], a[76:79], v[248:251], v[68:71]
ds_read_b64_tr_b16 a[92:93], v17 offset:192
v_mfma_f32_16x16x32_bf16 v[64:67], a[76:79], v[216:219], v[64:67]
ds_read_b64_tr_b16 a[94:95], v17 offset:4800
v_mfma_f32_16x16x32_bf16 v[64:67], a[72:75], v[208:211], v[64:67]
s_waitcnt lgkmcnt(6)
buffer_load_dwordx4 a[48:51], v1, s[4:7], s66 offen offset:1024 sc1
ds_read_b64_tr_b16 a[64:65], v13 offset:18656
v_mfma_f32_16x16x32_bf16 v[72:75], a[80:83], v[208:211], v[72:75]
s_waitcnt lgkmcnt(5)
ds_read_b64_tr_b16 a[66:67], v13 offset:23264
v_mfma_f32_16x16x32_bf16 v[72:75], a[84:87], v[216:219], v[72:75]
ds_read_b64_tr_b16 a[68:69], v17 offset:224
v_mfma_f32_16x16x32_bf16 v[76:79], a[84:87], v[248:251], v[76:79]
ds_read_b64_tr_b16 a[70:71], v17 offset:4832
buffer_load_dwordx4 a[52:55], v1, s[4:7], s65 offen offset:2048 sc1
v_mfma_f32_16x16x32_bf16 v[76:79], a[80:83], v[240:243], v[76:79]
s_waitcnt lgkmcnt(6)
ds_read_b64_tr_b16 a[72:73], v13 offset:18688
v_mfma_f32_16x16x32_bf16 v[84:87], a[88:91], v[240:243], v[84:87]
s_waitcnt lgkmcnt(5)
s_lshr_b32 s88, s48, 1
s_lshl_b32 s88, s88, 7
v_add_u32 v22, s88, v13
s_lshr_b32 s88, s48, 1
s_lshl_b32 s88, s88, 7
v_add_u32 v23, s88, v17
s_lshr_b32 s88, s48, 1
s_lshl_b32 s88, s88, 7
v_add_u32 v24, s88, v25
v_mfma_f32_16x16x32_bf16 v[84:87], a[92:95], v[248:251], v[84:87]
ds_read_b64_tr_b16 a[74:75], v13 offset:23296
buffer_load_dwordx4 a[56:59], v1, s[4:7], s66 offen offset:2048 sc1
v_mfma_f32_16x16x32_bf16 v[80:83], a[92:95], v[216:219], v[80:83]
ds_read_b64_tr_b16 a[76:77], v17 offset:256
ds_read_b64_tr_b16 a[78:79], v17 offset:4864
v_mfma_f32_16x16x32_bf16 v[80:83], a[88:91], v[208:211], v[80:83]
s_waitcnt lgkmcnt(6)
s_add_u32 s68, s68, 0x1000
buffer_store_dwordx2 v[120:121], v14, s[4:7], s68 offen sc1
v_mfma_f32_16x16x32_bf16 v[88:91], a[64:67], v[208:211], v[88:91]
s_waitcnt lgkmcnt(4)
ds_read_b64_tr_b16 a[80:81], v17 offset:9216
v_mfma_f32_16x16x32_bf16 v[88:91], a[68:71], v[216:219], v[88:91]
ds_read_b64_tr_b16 a[82:83], v17 offset:13824
v_mfma_f32_16x16x32_bf16 v[92:95], a[68:71], v[248:251], v[92:95]
ds_read_b64_tr_b16 a[84:85], v17 offset:18432
ds_read_b64_tr_b16 a[86:87], v17 offset:23040
v_mfma_f32_16x16x32_bf16 v[92:95], a[64:67], v[240:243], v[92:95]
s_waitcnt lgkmcnt(6)
buffer_load_dwordx4 a[60:63], v1, s[4:7], s65 offen offset:3072 sc1
ds_read_b64_tr_b16 a[88:89], v17 offset:9248
v_mfma_f32_16x16x32_bf16 v[100:103], a[72:75], v[240:243], v[100:103]
s_waitcnt lgkmcnt(5)
ds_read_b64_tr_b16 a[90:91], v17 offset:13856
v_mfma_f32_16x16x32_bf16 v[100:103], a[76:79], v[248:251], v[100:103]
ds_read_b64_tr_b16 a[92:93], v17 offset:18464
buffer_load_dwordx4 a[148:151], v1, s[4:7], s66 offen offset:3072 sc1
v_mfma_f32_16x16x32_bf16 v[96:99], a[76:79], v[216:219], v[96:99]
ds_read_b64_tr_b16 a[94:95], v17 offset:23072
v_mfma_f32_16x16x32_bf16 v[96:99], a[72:75], v[208:211], v[96:99]
s_waitcnt vmcnt(16) lgkmcnt(6)
ds_read_b64_tr_b16 a[64:65], v17 offset:9280
v_mfma_f32_16x16x32_bf16 v[196:199], a[80:83], a[4:7], v[196:199]
s_barrier
s_waitcnt lgkmcnt(5)
v_mfma_f32_16x16x32_bf16 v[196:199], a[84:87], a[12:15], v[196:199]
s_add_u32 s70, s52, 3
s_and_b32 s70, s70, 3
s_sub_u32 s70, s70, s52
s_lshl_b32 s70, s70, 12
s_add_u32 s65, s57, s70
s_add_u32 s66, s58, s70
ds_read_b64_tr_b16 a[66:67], v17 offset:13888
v_mfma_f32_16x16x32_bf16 v[204:207], a[84:87], a[16:19], v[204:207]
ds_read_b64_tr_b16 a[68:69], v17 offset:18496
ds_read_b64_tr_b16 a[70:71], v17 offset:23104
buffer_load_dwordx4 a[152:155], v1, s[4:7], s65 offen sc1
v_mfma_f32_16x16x32_bf16 v[204:207], a[80:83], a[8:11], v[204:207]
s_waitcnt lgkmcnt(6)
v_cmp_ne_u32 vcc, v19, v18
s_nop 1
s_cbranch_vccnz L_spin_fo
L_back_fo:
v_mfma_f32_16x16x32_bf16 v[220:223], a[88:91], a[8:11], v[220:223]
s_waitcnt lgkmcnt(4)
s_lshl_b32 s85, s50, 3
s_add_u32 s85, s85, s51
s_lshl_b32 s85, s85, 2
s_add_u32 s85, s85, s48
s_mul_i32 s85, s85, 0x2400
s_add_u32 s85, s85, 0x4800000
s_mul_i32 s67, s48, 0x2400
s_cmp_lt_u32 s48, 3
s_cselect_b32 s67, s67, s61
s_add_u32 m0, s67, 0
v_mfma_f32_16x16x32_bf16 v[220:223], a[92:95], a[16:19], v[220:223]
ds_read_b64_tr_b16 a[72:73], v17 offset:9312
ds_read_b64_tr_b16 a[74:75], v17 offset:13920
buffer_load_dwordx4 v1, s[4:7], s85 offen sc1 lds
v_mfma_f32_16x16x32_bf16 v[212:215], a[92:95], a[12:15], v[212:215]
s_add_u32 s72, s72, 0x1000
buffer_store_dwordx2 v[124:125], v14, s[4:7], s72 offen sc1
ds_read_b64_tr_b16 a[76:77], v17 offset:18528
ds_read_b64_tr_b16 a[78:79], v17 offset:23136
v_mfma_f32_16x16x32_bf16 v[212:215], a[88:91], a[4:7], v[212:215]
s_waitcnt lgkmcnt(6)
s_add_u32 m0, s67, 0
ds_read_b64_tr_b16 a[80:81], v17 offset:9344
v_mfma_f32_16x16x32_bf16 v[228:231], a[64:67], a[4:7], v[228:231]
s_waitcnt lgkmcnt(5)
ds_read_b64_tr_b16 a[82:83], v17 offset:13952
buffer_load_dwordx4 v1, s[4:7], s85 offen offset:1024 sc1 lds
v_mfma_f32_16x16x32_bf16 v[228:231], a[68:71], a[12:15], v[228:231]
s_add_u32 m0, s67, 0
ds_read_b64_tr_b16 a[84:85], v17 offset:18560
v_mfma_f32_16x16x32_bf16 v[236:239], a[68:71], a[16:19], v[236:239]
ds_read_b64_tr_b16 a[86:87], v17 offset:23168
buffer_load_dwordx4 v1, s[4:7], s85 offen offset:2048 sc1 lds
v_mfma_f32_16x16x32_bf16 v[236:239], a[64:67], a[8:11], v[236:239]
s_waitcnt lgkmcnt(6)
ds_read_b64_tr_b16 a[88:89], v17 offset:9376
v_mfma_f32_16x16x32_bf16 v[252:255], a[72:75], a[8:11], v[252:255]
s_waitcnt lgkmcnt(5)
s_add_u32 m0, s67, 0
ds_read_b64_tr_b16 a[90:91], v17 offset:13984
v_mfma_f32_16x16x32_bf16 v[252:255], a[76:79], a[16:19], v[252:255]
ds_read_b64_tr_b16 a[92:93], v17 offset:18592
buffer_load_dwordx4 v1, s[4:7], s85 offen offset:3072 sc1 lds
v_mfma_f32_16x16x32_bf16 v[244:247], a[76:79], a[12:15], v[244:247]
ds_read_b64_tr_b16 a[94:95], v17 offset:23200
v_mfma_f32_16x16x32_bf16 v[244:247], a[72:75], a[4:7], v[244:247]
s_waitcnt lgkmcnt(6)
s_add_u32 s85, s85, 0x1000
s_add_u32 m0, s67, 0x1000
ds_read_b64_tr_b16 a[64:65], v17 offset:9408
v_mfma_f32_16x16x32_bf16 v[64:67], a[80:83], a[4:7], v[64:67]
s_waitcnt lgkmcnt(5)
ds_read_b64_tr_b16 a[66:67], v17 offset:14016
buffer_load_dwordx4 v1, s[4:7], s85 offen sc1 lds
v_mfma_f32_16x16x32_bf16 v[64:67], a[84:87], a[12:15], v[64:67]
s_add_u32 m0, s67, 0x1000
ds_read_b64_tr_b16 a[68:69], v17 offset:18624
v_mfma_f32_16x16x32_bf16 v[68:71], a[84:87], a[16:19], v[68:71]
ds_read_b64_tr_b16 a[70:71], v17 offset:23232
buffer_load_dwordx4 v1, s[4:7], s85 offen offset:1024 sc1 lds
v_mfma_f32_16x16x32_bf16 v[68:71], a[80:83], a[8:11], v[68:71]
s_waitcnt lgkmcnt(6)
ds_read_b64_tr_b16 a[72:73], v17 offset:9440
v_mfma_f32_16x16x32_bf16 v[76:79], a[88:91], a[8:11], v[76:79]
s_waitcnt lgkmcnt(5)
s_add_u32 m0, s67, 0x1000
ds_read_b64_tr_b16 a[74:75], v17 offset:14048
v_mfma_f32_16x16x32_bf16 v[76:79], a[92:95], a[16:19], v[76:79]
ds_read_b64_tr_b16 a[76:77], v17 offset:18656
buffer_load_dwordx4 v1, s[4:7], s85 offen offset:2048 sc1 lds
v_mfma_f32_16x16x32_bf16 v[72:75], a[92:95], a[12:15], v[72:75]
s_add_u32 m0, s67, 0x1000
ds_read_b64_tr_b16 a[78:79], v17 offset:23264
v_mfma_f32_16x16x32_bf16 v[72:75], a[88:91], a[4:7], v[72:75]
s_waitcnt lgkmcnt(6)
ds_read_b64_tr_b16 a[80:81], v17 offset:9472
buffer_load_dwordx4 v1, s[4:7], s85 offen offset:3072 sc1 lds
v_mfma_f32_16x16x32_bf16 v[80:83], a[64:67], a[4:7], v[80:83]
s_waitcnt lgkmcnt(5)
ds_read_b64_tr_b16 a[82:83], v17 offset:14080
v_mfma_f32_16x16x32_bf16 v[80:83], a[68:71], a[12:15], v[80:83]
s_add_u32 s85, s85, 0x1000
s_add_u32 m0, s67, 0x2000
ds_read_b64_tr_b16 a[84:85], v17 offset:18688
v_mfma_f32_16x16x32_bf16 v[84:87], a[68:71], a[16:19], v[84:87]
ds_read_b64_tr_b16 a[86:87], v17 offset:23296
buffer_load_dwordx4 v1, s[4:7], s85 offen sc1 lds
v_mfma_f32_16x16x32_bf16 v[84:87], a[64:67], a[8:11], v[84:87]
s_waitcnt lgkmcnt(6)
ds_read_b64_tr_b16 a[88:89], v17 offset:27648
v_mfma_f32_16x16x32_bf16 v[92:95], a[72:75], a[8:11], v[92:95]
s_waitcnt lgkmcnt(5)
ds_read_b64_tr_b16 a[90:91], v17 offset:32256
v_mfma_f32_16x16x32_bf16 v[92:95], a[76:79], a[16:19], v[92:95]
ds_read_b64_tr_b16 a[92:93], v17 offset:36864
buffer_load_dwordx4 a[156:159], v1, s[4:7], s66 offen sc1
v_mfma_f32_16x16x32_bf16 v[88:91], a[76:79], a[12:15], v[88:91]
ds_read_b64_tr_b16 a[94:95], v17 offset:41472
v_mfma_f32_16x16x32_bf16 v[88:91], a[72:75], a[4:7], v[88:91]
s_waitcnt lgkmcnt(6)
buffer_load_dwordx4 a[160:163], v1, s[4:7], s65 offen offset:1024 sc1
ds_read_b64_tr_b16 a[64:65], v17 offset:27680
v_mfma_f32_16x16x32_bf16 v[96:99], a[80:83], a[4:7], v[96:99]
s_waitcnt lgkmcnt(5)
ds_read_b64_tr_b16 a[66:67], v17 offset:32288
v_mfma_f32_16x16x32_bf16 v[96:99], a[84:87], a[12:15], v[96:99]
ds_read_b64_tr_b16 a[68:69], v17 offset:36896
v_mfma_f32_16x16x32_bf16 v[100:103], a[84:87], a[16:19], v[100:103]
ds_read_b64_tr_b16 a[70:71], v17 offset:41504
buffer_load_dwordx4 a[164:167], v1, s[4:7], s66 offen offset:1024 sc1
v_mfma_f32_16x16x32_bf16 v[100:103], a[80:83], a[8:11], v[100:103]
s_waitcnt vmcnt(25) lgkmcnt(6)
ds_read_b64_tr_b16 a[72:73], v17 offset:27712
v_mfma_f32_16x16x32_bf16 v[204:207], a[88:91], a[24:27], v[204:207]
s_waitcnt lgkmcnt(5)
ds_read_b64_tr_b16 a[74:75], v17 offset:32320
buffer_load_dwordx4 a[168:171], v1, s[4:7], s65 offen offset:2048 sc1
v_mfma_f32_16x16x32_bf16 v[204:207], a[92:95], a[32:35], v[204:207]
ds_read_b64_tr_b16 a[76:77], v17 offset:36928
v_mfma_f32_16x16x32_bf16 v[196:199], a[92:95], a[28:31], v[196:199]
ds_read_b64_tr_b16 a[78:79], v17 offset:41536
v_mfma_f32_16x16x32_bf16 v[196:199], a[88:91], a[20:23], v[196:199]
s_waitcnt lgkmcnt(6)
buffer_load_dwordx4 a[172:175], v1, s[4:7], s66 offen offset:2048 sc1
ds_read_b64_tr_b16 a[80:81], v17 offset:27744
v_mfma_f32_16x16x32_bf16 v[212:215], a[64:67], a[20:23], v[212:215]
s_waitcnt lgkmcnt(5)
ds_read_b64_tr_b16 a[82:83], v17 offset:32352
v_mfma_f32_16x16x32_bf16 v[212:215], a[68:71], a[28:31], v[212:215]
ds_read_b64_tr_b16 a[84:85], v17 offset:36960
v_mfma_f32_16x16x32_bf16 v[220:223], a[68:71], a[32:35], v[220:223]
ds_read_b64_tr_b16 a[86:87], v17 offset:41568
buffer_load_dwordx4 a[176:179], v1, s[4:7], s65 offen offset:3072 sc1
v_mfma_f32_16x16x32_bf16 v[220:223], a[64:67], a[24:27], v[220:223]
s_waitcnt lgkmcnt(6)
ds_read_b64_tr_b16 a[88:89], v17 offset:27776
v_mfma_f32_16x16x32_bf16 v[236:239], a[72:75], a[24:27], v[236:239]
s_waitcnt lgkmcnt(5)
ds_read_b64_tr_b16 a[90:91], v17 offset:32384
buffer_load_dwordx4 a[180:183], v1, s[4:7], s66 offen offset:3072 sc1
v_mfma_f32_16x16x32_bf16 v[236:239], a[76:79], a[32:35], v[236:239]
ds_read_b64_tr_b16 a[92:93], v17 offset:36992
v_mfma_f32_16x16x32_bf16 v[228:231], a[76:79], a[28:31], v[228:231]
ds_read_b64_tr_b16 a[94:95], v17 offset:41600
v_mfma_f32_16x16x32_bf16 v[228:231], a[72:75], a[20:23], v[228:231]
s_waitcnt lgkmcnt(6)
ds_read_b64_tr_b16 a[64:65], v17 offset:27808
v_mfma_f32_16x16x32_bf16 v[244:247], a[80:83], a[20:23], v[244:247]
s_waitcnt lgkmcnt(5)
ds_read_b64_tr_b16 a[66:67], v17 offset:32416
v_mfma_f32_16x16x32_bf16 v[244:247], a[84:87], a[28:31], v[244:247]
ds_read_b64_tr_b16 a[68:69], v17 offset:37024
v_mfma_f32_16x16x32_bf16 v[252:255], a[84:87], a[32:35], v[252:255]
ds_read_b64_tr_b16 a[70:71], v17 offset:41632
v_mfma_f32_16x16x32_bf16 v[252:255], a[80:83], a[24:27], v[252:255]
s_waitcnt lgkmcnt(6)
ds_read_b64_tr_b16 a[72:73], v17 offset:27840
v_mfma_f32_16x16x32_bf16 v[68:71], a[88:91], a[24:27], v[68:71]
s_waitcnt lgkmcnt(5)
s_lshl_b32 s68, s50, 2
s_add_u32 s68, s68, s52
s_lshl_b32 s68, s68, 2
s_add_u32 s68, s68, s48
s_lshl_b32 s68, s68, 3
s_add_u32 s68, s68, s51
s_lshl_b32 s68, s68, 2
s_add_u32 s68, s68, 0x5007000
v_mfma_f32_16x16x32_bf16 v[68:71], a[92:95], a[32:35], v[68:71]
ds_read_b64_tr_b16 a[74:75], v17 offset:32448
s_waitcnt vmcnt(15)
buffer_store_dword v18, v20, s[4:7], s68 offen sc1
v_mfma_f32_16x16x32_bf16 v[64:67], a[92:95], a[28:31], v[64:67]
ds_read_b64_tr_b16 a[76:77], v17 offset:37056
ds_read_b64_tr_b16 a[78:79], v17 offset:41664
v_mfma_f32_16x16x32_bf16 v[64:67], a[88:91], a[20:23], v[64:67]
s_waitcnt lgkmcnt(6)
ds_read_b64_tr_b16 a[80:81], v17 offset:27872
v_mfma_f32_16x16x32_bf16 v[72:75], a[64:67], a[20:23], v[72:75]
s_waitcnt lgkmcnt(5)
ds_read_b64_tr_b16 a[82:83], v17 offset:32480
v_mfma_f32_16x16x32_bf16 v[72:75], a[68:71], a[28:31], v[72:75]
ds_read_b64_tr_b16 a[84:85], v17 offset:37088
v_mfma_f32_16x16x32_bf16 v[76:79], a[68:71], a[32:35], v[76:79]
ds_read_b64_tr_b16 a[86:87], v17 offset:41696
v_mfma_f32_16x16x32_bf16 v[76:79], a[64:67], a[24:27], v[76:79]
s_waitcnt lgkmcnt(6)
ds_read_b64_tr_b16 a[88:89], v17 offset:27904
v_mfma_f32_16x16x32_bf16 v[84:87], a[72:75], a[24:27], v[84:87]
s_waitcnt lgkmcnt(5)
ds_read_b64_tr_b16 a[90:91], v17 offset:32512
v_mfma_f32_16x16x32_bf16 v[84:87], a[76:79], a[32:35], v[84:87]
ds_read_b64_tr_b16 a[92:93], v17 offset:37120
v_mfma_f32_16x16x32_bf16 v[80:83], a[76:79], a[28:31], v[80:83]
ds_read_b64_tr_b16 a[94:95], v17 offset:41728
v_mfma_f32_16x16x32_bf16 v[80:83], a[72:75], a[20:23], v[80:83]
s_waitcnt lgkmcnt(6)
ds_read_b64_tr_b16 a[64:65], v17 offset:46080
v_mfma_f32_16x16x32_bf16 v[88:91], a[80:83], a[20:23], v[88:91]
s_waitcnt lgkmcnt(5)
ds_read_b64_tr_b16 a[66:67], v17 offset:50688
v_mfma_f32_16x16x32_bf16 v[88:91], a[84:87], a[28:31], v[88:91]
ds_read_b64_tr_b16 a[68:69], v17 offset:55296
v_mfma_f32_16x16x32_bf16 v[92:95], a[84:87], a[32:35], v[92:95]
ds_read_b64_tr_b16 a[70:71], v17 offset:59904
v_mfma_f32_16x16x32_bf16 v[92:95], a[80:83], a[24:27], v[92:95]
s_waitcnt lgkmcnt(6)
s_cmp_eq_u32 s48, 3
s_cselect_b32 s87, 0, 0x40000000
v_add_u32 v110, s87, v14
v_add_u32 v111, s87, v16
s_and_b32 s87, s48, 1
s_cselect_b32 s70, s61, 0x2400
s_mul_i32 s87, s87, 0x4800
v_add_u32 v116, s87, v14
v_add_u32 v117, s70, v14
v_and_b32 v112, 15, v0
v_lshrrev_b32 v112, 2, v112
v_lshrrev_b32 v113, 4, v0
v_cmp_eq_u32_e64 s[94:95], v112, v113
v_and_b32 v112, 1, v0
v_lshlrev_b32 v112, 4, v112
v_mov_b32 v113, 0x3f80
v_lshlrev_b32 v112, v112, v113
v_cndmask_b32_e64 v112, 0, v112, s[94:95]
v_and_b32 v113, 2, v0
v_cmp_eq_u32_e64 s[94:95], 0, v113
v_mov_b32 v104, 0
v_mov_b32 v105, 0
v_mov_b32 v108, 0
v_mov_b32 v109, 0
v_cndmask_b32_e64 v106, 0, v112, s[94:95]
v_cndmask_b32_e64 v107, v112, 0, s[94:95]
v_mov_b32 v112, v106
v_mov_b32 v113, v107
v_mov_b32 v114, v106
v_mov_b32 v115, v107
v_mfma_f32_16x16x32_bf16 v[100:103], a[88:91], a[24:27], v[100:103]
s_waitcnt lgkmcnt(0)
ds_read_b64_tr_b16 a[72:73], v17 offset:46112
v_mfma_f32_16x16x32_bf16 v[100:103], a[92:95], a[32:35], v[100:103]
ds_read_b64_tr_b16 a[74:75], v17 offset:50720
v_mfma_f32_16x16x32_bf16 v[96:99], a[92:95], a[28:31], v[96:99]
ds_read_b64_tr_b16 a[76:77], v17 offset:55328
ds_read_b64_tr_b16 a[78:79], v17 offset:59936
v_mfma_f32_16x16x32_bf16 v[96:99], a[88:91], a[20:23], v[96:99]
ds_read_b64_tr_b16 a[80:81], v17 offset:46144
v_mfma_f32_16x16x32_bf16 v[196:199], a[64:67], a[36:39], v[196:199]
s_waitcnt vmcnt(8)
s_barrier
v_mfma_f32_16x16x32_bf16 v[196:199], a[68:71], a[44:47], v[196:199]
ds_read_b64_tr_b16 a[82:83], v17 offset:50752
v_mfma_f32_16x16x32_bf16 v[204:207], a[68:71], a[48:51], v[204:207]
ds_read_b64_tr_b16 a[84:85], v17 offset:55360
ds_read_b64_tr_b16 a[86:87], v17 offset:59968
v_mfma_f32_16x16x32_bf16 v[204:207], a[64:67], a[40:43], v[204:207]
s_waitcnt lgkmcnt(6)
ds_read_b64_tr_b16 a[88:89], v17 offset:46176
v_mfma_f32_16x16x32_bf16 v[220:223], a[72:75], a[40:43], v[220:223]
s_waitcnt lgkmcnt(5)
s_mul_i32 s85, s48, 0x9000
s_mul_i32 s70, s52, 0x120
s_add_u32 s85, s85, s70
s_add_u32 s85, s85, 0x9000
s_mul_i32 s67, s48, 0x2400
s_add_u32 s67, s67, s61
s_add_u32 s67, s67, 0x2400
s_add_u32 m0, s67, 0
v_mfma_f32_16x16x32_bf16 v[220:223], a[76:79], a[48:51], v[220:223]
ds_read_b64_tr_b16 a[90:91], v17 offset:50784
buffer_load_dwordx4 v4, s[36:39], s85 offen lds
s_add_u32 m0, s67, 0
v_mfma_f32_16x16x32_bf16 v[212:215], a[76:79], a[44:47], v[212:215]
ds_read_b64_tr_b16 a[92:93], v17 offset:55392
ds_read_b64_tr_b16 a[94:95], v17 offset:60000
v_mfma_f32_16x16x32_bf16 v[212:215], a[72:75], a[36:39], v[212:215]
s_waitcnt lgkmcnt(6)
buffer_load_dwordx4 v5, s[36:39], s85 offen offset:1024 lds
s_add_u32 m0, s67, 0
ds_read_b64_tr_b16 a[64:65], v17 offset:46208
v_mfma_f32_16x16x32_bf16 v[228:231], a[80:83], a[36:39], v[228:231]
s_waitcnt lgkmcnt(5)
ds_read_b64_tr_b16 a[66:67], v17 offset:50816
buffer_load_dwordx4 v6, s[36:39], s85 offen offset:2048 lds
s_add_u32 m0, s67, 0
v_mfma_f32_16x16x32_bf16 v[228:231], a[84:87], a[44:47], v[228:231]
ds_read_b64_tr_b16 a[68:69], v17 offset:55424
buffer_load_dwordx4 v7, s[36:39], s85 offen offset:3072 lds
v_mfma_f32_16x16x32_bf16 v[236:239], a[84:87], a[48:51], v[236:239]
ds_read_b64_tr_b16 a[70:71], v17 offset:60032
v_mfma_f32_16x16x32_bf16 v[236:239], a[80:83], a[40:43], v[236:239]
s_waitcnt lgkmcnt(6)
s_add_u32 m0, s67, 0x1000
ds_read_b64_tr_b16 a[72:73], v17 offset:46240
v_mfma_f32_16x16x32_bf16 v[252:255], a[88:91], a[40:43], v[252:255]
s_waitcnt lgkmcnt(5)
ds_read_b64_tr_b16 a[74:75], v17 offset:50848
buffer_load_dwordx4 v8, s[36:39], s85 offen lds
v_mfma_f32_16x16x32_bf16 v[252:255], a[92:95], a[48:51], v[252:255]
ds_read_b64_tr_b16 a[76:77], v17 offset:55456
v_mfma_f32_16x16x32_bf16 v[244:247], a[92:95], a[44:47], v[244:247]
s_add_u32 m0, s67, 0x1000
ds_read_b64_tr_b16 a[78:79], v17 offset:60064
v_mfma_f32_16x16x32_bf16 v[244:247], a[88:91], a[36:39], v[244:247]
s_waitcnt lgkmcnt(6)
ds_read_b64_tr_b16 a[80:81], v17 offset:46272
buffer_load_dwordx4 v9, s[36:39], s85 offen offset:1024 lds
v_mfma_f32_16x16x32_bf16 v[64:67], a[64:67], a[36:39], v[64:67]
s_waitcnt lgkmcnt(5)
s_add_u32 m0, s67, 0x1000
ds_read_b64_tr_b16 a[82:83], v17 offset:50880
v_mfma_f32_16x16x32_bf16 v[64:67], a[68:71], a[44:47], v[64:67]
ds_read_b64_tr_b16 a[84:85], v17 offset:55488
buffer_load_dwordx4 v10, s[36:39], s85 offen offset:2048 lds
v_mfma_f32_16x16x32_bf16 v[68:71], a[68:71], a[48:51], v[68:71]
ds_read_b64_tr_b16 a[86:87], v17 offset:60096
v_mfma_f32_16x16x32_bf16 v[68:71], a[64:67], a[40:43], v[68:71]
s_waitcnt lgkmcnt(6)
s_add_u32 m0, s67, 0x1000
ds_read_b64_tr_b16 a[88:89], v17 offset:46304
v_mfma_f32_16x16x32_bf16 v[76:79], a[72:75], a[40:43], v[76:79]
s_waitcnt lgkmcnt(5)
ds_read_b64_tr_b16 a[90:91], v17 offset:50912
buffer_load_dwordx4 v11, s[36:39], s85 offen offset:3072 lds
v_mfma_f32_16x16x32_bf16 v[76:79], a[76:79], a[48:51], v[76:79]
s_add_u32 m0, s67, 0x2000
ds_read_b64_tr_b16 a[92:93], v17 offset:55520
v_mfma_f32_16x16x32_bf16 v[72:75], a[76:79], a[44:47], v[72:75]
ds_read_b64_tr_b16 a[94:95], v17 offset:60128
buffer_load_dwordx4 v12, s[36:39], s85 offen lds
v_mfma_f32_16x16x32_bf16 v[72:75], a[72:75], a[36:39], v[72:75]
s_waitcnt lgkmcnt(6)
ds_read_b64_tr_b16 a[64:65], v17 offset:46336
v_mfma_f32_16x16x32_bf16 v[80:83], a[80:83], a[36:39], v[80:83]
s_waitcnt lgkmcnt(5)
ds_read_b64_tr_b16 a[66:67], v17 offset:50944
v_mfma_f32_16x16x32_bf16 v[80:83], a[84:87], a[44:47], v[80:83]
ds_read_b64_tr_b16 a[68:69], v17 offset:55552
v_mfma_f32_16x16x32_bf16 v[84:87], a[84:87], a[48:51], v[84:87]
ds_read_b64_tr_b16 a[70:71], v17 offset:60160
v_mfma_f32_16x16x32_bf16 v[84:87], a[80:83], a[40:43], v[84:87]
s_waitcnt lgkmcnt(6)
ds_read_b64_tr_b16 a[72:73], v25
v_mfma_f32_16x16x32_bf16 v[92:95], a[88:91], a[40:43], v[92:95]
s_waitcnt lgkmcnt(5)
ds_read_b64_tr_b16 a[74:75], v25 offset:4608
v_mfma_f32_16x16x32_bf16 v[92:95], a[92:95], a[48:51], v[92:95]
ds_read_b64_tr_b16 a[76:77], v25 offset:9216
v_mfma_f32_16x16x32_bf16 v[88:91], a[92:95], a[44:47], v[88:91]
ds_read_b64_tr_b16 a[78:79], v25 offset:13824
v_mfma_f32_16x16x32_bf16 v[88:91], a[88:91], a[36:39], v[88:91]
s_waitcnt lgkmcnt(6)
ds_read_b64_tr_b16 a[80:81], v25 offset:32
v_mfma_f32_16x16x32_bf16 v[96:99], a[64:67], a[36:39], v[96:99]
s_waitcnt lgkmcnt(5)
ds_read_b64_tr_b16 a[82:83], v25 offset:4640
v_mfma_f32_16x16x32_bf16 v[96:99], a[68:71], a[44:47], v[96:99]
ds_read_b64_tr_b16 a[84:85], v25 offset:9248
v_mfma_f32_16x16x32_bf16 v[100:103], a[68:71], a[48:51], v[100:103]
ds_read_b64_tr_b16 a[86:87], v25 offset:13856
v_mfma_f32_16x16x32_bf16 v[100:103], a[64:67], a[40:43], v[100:103]
s_waitcnt lgkmcnt(6)
ds_read_b64_tr_b16 a[88:89], v25 offset:64
v_mfma_f32_16x16x32_bf16 v[204:207], a[72:75], a[56:59], v[204:207]
s_waitcnt lgkmcnt(5)
ds_read_b64_tr_b16 a[90:91], v25 offset:4672
v_mfma_f32_16x16x32_bf16 v[204:207], a[76:79], a[148:151], v[204:207]
ds_read_b64_tr_b16 a[92:93], v25 offset:9280
v_mfma_f32_16x16x32_bf16 v[196:199], a[76:79], a[60:63], v[196:199]
ds_read_b64_tr_b16 a[94:95], v25 offset:13888
v_mfma_f32_16x16x32_bf16 v[196:199], a[72:75], a[52:55], v[196:199]
s_waitcnt lgkmcnt(6)
ds_read_b64_tr_b16 a[64:65], v25 offset:96
v_mfma_f32_16x16x32_bf16 v[212:215], a[80:83], a[52:55], v[212:215]
s_waitcnt lgkmcnt(5)
ds_read_b64_tr_b16 a[66:67], v25 offset:4704
v_mfma_f32_16x16x32_bf16 v[212:215], a[84:87], a[60:63], v[212:215]
ds_read_b64_tr_b16 a[68:69], v25 offset:9312
v_mfma_f32_16x16x32_bf16 v[220:223], a[84:87], a[148:151], v[220:223]
ds_read_b64_tr_b16 a[70:71], v25 offset:13920
v_mfma_f32_16x16x32_bf16 v[220:223], a[80:83], a[56:59], v[220:223]
s_waitcnt lgkmcnt(6)
ds_read_b64_tr_b16 a[72:73], v25 offset:128
v_mfma_f32_16x16x32_bf16 v[236:239], a[88:91], a[56:59], v[236:239]
s_waitcnt lgkmcnt(5)
ds_read_b64_tr_b16 a[74:75], v25 offset:4736
v_mfma_f32_16x16x32_bf16 v[236:239], a[92:95], a[148:151], v[236:239]
ds_read_b64_tr_b16 a[76:77], v25 offset:9344
v_mfma_f32_16x16x32_bf16 v[228:231], a[92:95], a[60:63], v[228:231]
ds_read_b64_tr_b16 a[78:79], v25 offset:13952
v_mfma_f32_16x16x32_bf16 v[228:231], a[88:91], a[52:55], v[228:231]
s_waitcnt lgkmcnt(6)
ds_read_b64_tr_b16 a[80:81], v25 offset:160
v_mfma_f32_16x16x32_bf16 v[244:247], a[64:67], a[52:55], v[244:247]
s_waitcnt lgkmcnt(5)
ds_read_b64_tr_b16 a[82:83], v25 offset:4768
v_mfma_f32_16x16x32_bf16 v[244:247], a[68:71], a[60:63], v[244:247]
ds_read_b64_tr_b16 a[84:85], v25 offset:9376
v_mfma_f32_16x16x32_bf16 v[252:255], a[68:71], a[148:151], v[252:255]
ds_read_b64_tr_b16 a[86:87], v25 offset:13984
v_mfma_f32_16x16x32_bf16 v[252:255], a[64:67], a[56:59], v[252:255]
s_waitcnt lgkmcnt(6)
ds_read_b64_tr_b16 a[88:89], v25 offset:192
v_mfma_f32_16x16x32_bf16 v[68:71], a[72:75], a[56:59], v[68:71]
s_waitcnt lgkmcnt(5)
ds_read_b64_tr_b16 a[90:91], v25 offset:4800
v_mfma_f32_16x16x32_bf16 v[68:71], a[76:79], a[148:151], v[68:71]
ds_read_b64_tr_b16 a[92:93], v25 offset:9408
v_mfma_f32_16x16x32_bf16 v[64:67], a[76:79], a[60:63], v[64:67]
ds_read_b64_tr_b16 a[94:95], v25 offset:14016
v_mfma_f32_16x16x32_bf16 v[64:67], a[72:75], a[52:55], v[64:67]
s_waitcnt lgkmcnt(6)
ds_read_b64_tr_b16 a[64:65], v25 offset:224
v_mfma_f32_16x16x32_bf16 v[72:75], a[80:83], a[52:55], v[72:75]
s_waitcnt lgkmcnt(5)
ds_read_b64_tr_b16 a[66:67], v25 offset:4832
v_mfma_f32_16x16x32_bf16 v[72:75], a[84:87], a[60:63], v[72:75]
ds_read_b64_tr_b16 a[68:69], v25 offset:9440
v_mfma_f32_16x16x32_bf16 v[76:79], a[84:87], a[148:151], v[76:79]
ds_read_b64_tr_b16 a[70:71], v25 offset:14048
v_mfma_f32_16x16x32_bf16 v[76:79], a[80:83], a[56:59], v[76:79]
s_waitcnt lgkmcnt(6)
ds_read_b64_tr_b16 a[72:73], v25 offset:256
v_mfma_f32_16x16x32_bf16 v[84:87], a[88:91], a[56:59], v[84:87]
s_waitcnt lgkmcnt(5)
ds_read_b64_tr_b16 a[74:75], v25 offset:4864
ds_read_b64_tr_b16 a[96:97], v24 offset:55296
v_mfma_f32_16x16x32_bf16 v[84:87], a[92:95], a[148:151], v[84:87]
ds_read_b64_tr_b16 a[76:77], v25 offset:9472
ds_read_b64_tr_b16 a[98:99], v24 offset:59904
v_mfma_f32_16x16x32_bf16 v[80:83], a[92:95], a[60:63], v[80:83]
ds_read_b64_tr_b16 a[78:79], v25 offset:14080
ds_read_b64_tr_b16 a[100:101], v24 offset:55328
v_mfma_f32_16x16x32_bf16 v[80:83], a[88:91], a[52:55], v[80:83]
s_waitcnt lgkmcnt(9)
ds_read_b64_tr_b16 a[102:103], v24 offset:59936
ds_read_b64_tr_b16 a[104:105], v24 offset:55360
v_mfma_f32_16x16x32_bf16 v[88:91], a[64:67], a[52:55], v[88:91]
s_waitcnt lgkmcnt(9)
ds_read_b64_tr_b16 a[106:107], v24 offset:59968
ds_read_b64_tr_b16 a[108:109], v24 offset:55392
ds_read_b64_tr_b16 a[110:111], v24 offset:60000
ds_read_b64_tr_b16 a[112:113], v24 offset:55424
ds_read_b64_tr_b16 a[114:115], v24 offset:60032
ds_read_b64_tr_b16 a[4:5], v116
ds_read_b64_tr_b16 a[6:7], v116 offset:512
ds_read_b64_tr_b16 a[8:9], v116 offset:1024
ds_read_b64_tr_b16 a[10:11], v116 offset:1536
ds_read_b64_tr_b16 a[12:13], v116 offset:2048
ds_read_b64_tr_b16 a[14:15], v116 offset:2560
ds_read_b64_tr_b16 a[16:17], v116 offset:3072
ds_read_b64_tr_b16 a[18:19], v116 offset:3584
ds_read_b64_tr_b16 a[20:21], v116 offset:4096
ds_read_b64_tr_b16 a[22:23], v116 offset:4608
ds_read_b64_tr_b16 a[24:25], v116 offset:5120
ds_read_b64_tr_b16 a[26:27], v116 offset:5632
ds_read_b64_tr_b16 a[28:29], v116 offset:6144
ds_read_b64_tr_b16 a[30:31], v116 offset:6656
ds_read_b64_tr_b16 a[32:33], v116 offset:7168
ds_read_b64_tr_b16 a[34:35], v116 offset:7680
ds_read_b64_tr_b16 a[184:185], v116 offset:8192
ds_read_b64_tr_b16 a[186:187], v116 offset:8704
ds_read_b64_tr_b16 a[188:189], v117
ds_read_b64_tr_b16 a[190:191], v117 offset:512
ds_read_b64_tr_b16 a[192:193], v117 offset:1024
ds_read_b64_tr_b16 a[194:195], v117 offset:1536
ds_read_b64_tr_b16 a[200:201], v117 offset:2048
ds_read_b64_tr_b16 a[202:203], v117 offset:2560
ds_read_b64_tr_b16 a[208:209], v117 offset:3072
ds_read_b64_tr_b16 a[210:211], v117 offset:3584
ds_read_b64_tr_b16 a[216:217], v117 offset:4096
ds_read_b64_tr_b16 a[218:219], v117 offset:4608
ds_read_b64_tr_b16 a[224:225], v117 offset:5120
ds_read_b64_tr_b16 a[226:227], v117 offset:5632
ds_read_b64_tr_b16 a[232:233], v117 offset:6144
ds_read_b64_tr_b16 a[234:235], v117 offset:6656
ds_read_b64_tr_b16 a[240:241], v117 offset:7168
ds_read_b64_tr_b16 a[242:243], v117 offset:7680
ds_read_b64_tr_b16 a[248:249], v117 offset:8192
ds_read_b64_tr_b16 a[250:251], v117 offset:8704
v_mfma_f32_16x16x32_bf16 v[88:91], a[68:71], a[60:63], v[88:91]
ds_read_b64_tr_b16 a[80:81], v25 offset:18432
ds_read_b64_tr_b16 a[82:83], v25 offset:23040
v_mfma_f32_16x16x32_bf16 v[92:95], a[68:71], a[148:151], v[92:95]
ds_read_b64_tr_b16 a[84:85], v25 offset:27648
ds_read_b64_tr_b16 a[86:87], v25 offset:32256
v_mfma_f32_16x16x32_bf16 v[92:95], a[64:67], a[56:59], v[92:95]
s_waitcnt lgkmcnt(15)
ds_read_b64_tr_b16 a[88:89], v25 offset:36864
v_mfma_f32_16x16x32_bf16 v[100:103], a[72:75], a[56:59], v[100:103]
ds_read_b64_tr_b16 a[90:91], v25 offset:41472
v_mfma_f32_16x16x32_bf16 v[100:103], a[76:79], a[148:151], v[100:103]
ds_read_b64_tr_b16 a[92:93], v25 offset:46080
v_mfma_f32_16x16x32_bf16 v[96:99], a[76:79], a[60:63], v[96:99]
ds_read_b64_tr_b16 a[94:95], v25 offset:50688
v_mfma_f32_16x16x32_bf16 v[96:99], a[72:75], a[52:55], v[96:99]
s_waitcnt lgkmcnt(6)
s_lshl_b32 s78, s50, 2
s_add_u32 s78, s78, s52
s_lshl_b32 s78, s78, 2
s_sub_u32 s71, 7, s51
s_min_u32 s71, s71, s51
s_add_u32 s78, s78, s71
s_lshl_b32 s78, s78, 3
s_lshl_b32 s78, s78, 2
s_add_u32 s78, s78, 0x5007000
v_and_b32 v3, 28, v21
v_mfma_f32_16x16x32_bf16 v[196:199], a[80:83], a[152:155], v[196:199]
buffer_load_dword v19, v3, s[4:7], s78 offen sc1
s_barrier
s_waitcnt vmcnt(11) lgkmcnt(4)
v_mfma_f32_16x16x32_bf16 v[196:199], a[84:87], a[160:163], v[196:199]
ds_read_b64_tr_b16 a[64:65], v25 offset:18464
ds_read_b64_tr_b16 a[66:67], v25 offset:23072
v_mfma_f32_16x16x32_bf16 v[204:207], a[84:87], a[164:167], v[204:207]
ds_read_b64_tr_b16 a[68:69], v25 offset:27680
ds_read_b64_tr_b16 a[70:71], v25 offset:32288
v_mfma_f32_16x16x32_bf16 v[204:207], a[80:83], a[156:159], v[204:207]
s_waitcnt lgkmcnt(6)
ds_read_b64_tr_b16 a[72:73], v25 offset:36896
v_mfma_f32_16x16x32_bf16 v[204:207], a[88:91], a[172:175], v[204:207]
s_waitcnt lgkmcnt(5)
s_mul_i32 s85, s48, 0x9000
s_mul_i32 s70, s52, 0x120
s_add_u32 s85, s85, s70
s_add_u32 s85, s85, 0x2d000
s_mul_i32 s67, s48, 0x2400
s_add_u32 s70, s61, 0xb400
s_sub_u32 s71, s62, 0x4800
s_cmp_lt_u32 s48, 2
s_cselect_b32 s70, s70, s71
s_add_u32 s67, s67, s70
s_add_u32 m0, s67, 0
v_mfma_f32_16x16x32_bf16 v[204:207], a[92:95], a[180:183], v[204:207]
ds_read_b64_tr_b16 a[74:75], v25 offset:41504
buffer_load_dwordx4 v4, s[36:39], s85 offen lds
s_add_u32 m0, s67, 0
v_mfma_f32_16x16x32_bf16 v[196:199], a[92:95], a[176:179], v[196:199]
ds_read_b64_tr_b16 a[76:77], v25 offset:46112
ds_read_b64_tr_b16 a[78:79], v25 offset:50720
v_mfma_f32_16x16x32_bf16 v[196:199], a[88:91], a[168:171], v[196:199]
s_waitcnt lgkmcnt(6)
buffer_load_dwordx4 v5, s[36:39], s85 offen offset:1024 lds
s_add_u32 m0, s67, 0
ds_read_b64_tr_b16 a[80:81], v25 offset:18496
v_mfma_f32_16x16x32_bf16 v[212:215], a[64:67], a[152:155], v[212:215]
s_waitcnt lgkmcnt(5)
ds_read_b64_tr_b16 a[82:83], v25 offset:23104
buffer_load_dwordx4 v6, s[36:39], s85 offen offset:2048 lds
s_add_u32 m0, s67, 0
v_mfma_f32_16x16x32_bf16 v[212:215], a[68:71], a[160:163], v[212:215]
ds_read_b64_tr_b16 a[84:85], v25 offset:27712
buffer_load_dwordx4 v7, s[36:39], s85 offen offset:3072 lds
v_mfma_f32_16x16x32_bf16 v[220:223], a[68:71], a[164:167], v[220:223]
ds_read_b64_tr_b16 a[86:87], v25 offset:32320
v_mfma_f32_16x16x32_bf16 v[220:223], a[64:67], a[156:159], v[220:223]
s_waitcnt lgkmcnt(6)
s_add_u32 m0, s67, 0x1000
ds_read_b64_tr_b16 a[88:89], v25 offset:36928
v_mfma_f32_16x16x32_bf16 v[220:223], a[72:75], a[172:175], v[220:223]
s_waitcnt lgkmcnt(5)
ds_read_b64_tr_b16 a[90:91], v25 offset:41536
buffer_load_dwordx4 v8, s[36:39], s85 offen lds
v_mfma_f32_16x16x32_bf16 v[220:223], a[76:79], a[180:183], v[220:223]
ds_read_b64_tr_b16 a[92:93], v25 offset:46144
v_mfma_f32_16x16x32_bf16 v[212:215], a[76:79], a[176:179], v[212:215]
s_add_u32 m0, s67, 0x1000
ds_read_b64_tr_b16 a[94:95], v25 offset:50752
v_mfma_f32_16x16x32_bf16 v[212:215], a[72:75], a[168:171], v[212:215]
s_waitcnt lgkmcnt(6)
ds_read_b64_tr_b16 a[64:65], v25 offset:18528
buffer_load_dwordx4 v9, s[36:39], s85 offen offset:1024 lds
v_mfma_f32_16x16x32_bf16 v[228:231], a[80:83], a[152:155], v[228:231]
s_waitcnt lgkmcnt(5)
s_add_u32 m0, s67, 0x1000
ds_read_b64_tr_b16 a[66:67], v25 offset:23136
v_mfma_f32_16x16x32_bf16 v[228:231], a[84:87], a[160:163], v[228:231]
ds_read_b64_tr_b16 a[68:69], v25 offset:27744
buffer_load_dwordx4 v10, s[36:39], s85 offen offset:2048 lds
v_mfma_f32_16x16x32_bf16 v[236:239], a[84:87], a[164:167], v[236:239]
ds_read_b64_tr_b16 a[70:71], v25 offset:32352
v_mfma_f32_16x16x32_bf16 v[236:239], a[80:83], a[156:159], v[236:239]
s_waitcnt lgkmcnt(6)
s_add_u32 m0, s67, 0x1000
ds_read_b64_tr_b16 a[72:73], v25 offset:36960
v_mfma_f32_16x16x32_bf16 v[236:239], a[88:91], a[172:175], v[236:239]
s_waitcnt lgkmcnt(5)
ds_read_b64_tr_b16 a[74:75], v25 offset:41568
buffer_load_dwordx4 v11, s[36:39], s85 offen offset:3072 lds
v_mfma_f32_16x16x32_bf16 v[236:239], a[92:95], a[180:183], v[236:239]
s_lshl_b32 s59, s50, 2
s_add_u32 s59, s59, s52
s_mul_i32 s59, s59, 0x50000
s_add_u32 s59, s59, 0x3a00000
s_mul_i32 s71, s51, 0x1400
s_add_u32 s59, s59, s71
s_sub_u32 s60, 7, s48
s_mul_i32 s60, s60, 0xa000
s_add_u32 s60, s60, s59
s_mul_i32 s71, s48, 0xa000
s_add_u32 s59, s59, s71
v_mfma_f32_16x16x32_bf16 v[228:231], a[92:95], a[176:179], v[228:231]
s_waitcnt lgkmcnt(4)
ds_read_b64_tr_b16 a[76:77], v25 offset:46176
ds_read_b64_tr_b16 a[78:79], v25 offset:50784
v_cvt_pk_bf16_f32 v196, v196, v197
v_cvt_pk_bf16_f32 v197, v198, v199
v_cvt_pk_bf16_f32 v198, v212, v213
v_cvt_pk_bf16_f32 v199, v214, v215
v_mfma_f32_16x16x32_bf16 v[228:231], a[88:91], a[168:171], v[228:231]
s_add_u32 m0, s67, 0x2000
ds_read_b64_tr_b16 a[80:81], v25 offset:18560
v_cvt_pk_bf16_f32 v204, v204, v205
v_mfma_f32_16x16x32_bf16 v[244:247], a[64:67], a[152:155], v[244:247]
s_waitcnt lgkmcnt(5)
ds_read_b64_tr_b16 a[82:83], v25 offset:23168
buffer_load_dwordx4 v12, s[36:39], s85 offen lds
v_mfma_f32_16x16x32_bf16 v[244:247], a[68:71], a[160:163], v[244:247]
ds_read_b64_tr_b16 a[84:85], v25 offset:27776
v_cvt_pk_bf16_f32 v205, v206, v207
v_mfma_f32_16x16x32_bf16 v[252:255], a[68:71], a[164:167], v[252:255]
ds_read_b64_tr_b16 a[86:87], v25 offset:32384
buffer_store_dwordx4 v[196:199], v1, s[4:7], s59 offen sc1
v_cvt_pk_bf16_f32 v206, v220, v221
v_cvt_pk_bf16_f32 v207, v222, v223
v_mfma_f32_16x16x32_bf16 v[252:255], a[64:67], a[156:159], v[252:255]
s_waitcnt lgkmcnt(6)
buffer_store_dwordx4 v[204:207], v1, s[4:7], s60 offen sc1
ds_read_b64_tr_b16 a[88:89], v25 offset:36992
v_mfma_f32_16x16x32_bf16 v[252:255], a[72:75], a[172:175], v[252:255]
s_waitcnt lgkmcnt(5)
ds_read_b64_tr_b16 a[90:91], v25 offset:41600
v_mfma_f32_16x16x32_bf16 v[252:255], a[76:79], a[180:183], v[252:255]
ds_read_b64_tr_b16 a[92:93], v25 offset:46208
v_mfma_f32_16x16x32_bf16 v[244:247], a[76:79], a[176:179], v[244:247]
ds_read_b64_tr_b16 a[94:95], v25 offset:50816
v_mfma_f32_16x16x32_bf16 v[244:247], a[72:75], a[168:171], v[244:247]
s_waitcnt lgkmcnt(6)
ds_read_b64_tr_b16 a[64:65], v25 offset:18592
v_mfma_f32_16x16x32_bf16 v[64:67], a[80:83], a[152:155], v[64:67]
s_waitcnt lgkmcnt(5)
ds_read_b64_tr_b16 a[66:67], v25 offset:23200
v_mfma_f32_16x16x32_bf16 v[64:67], a[84:87], a[160:163], v[64:67]
ds_read_b64_tr_b16 a[68:69], v25 offset:27808
v_mfma_f32_16x16x32_bf16 v[68:71], a[84:87], a[164:167], v[68:71]
ds_read_b64_tr_b16 a[70:71], v25 offset:32416
v_mfma_f32_16x16x32_bf16 v[68:71], a[80:83], a[156:159], v[68:71]
s_waitcnt lgkmcnt(6)
ds_read_b64_tr_b16 a[72:73], v25 offset:37024
v_cvt_pk_bf16_f32 v228, v228, v229
v_mfma_f32_16x16x32_bf16 v[68:71], a[88:91], a[172:175], v[68:71]
s_waitcnt lgkmcnt(5)
ds_read_b64_tr_b16 a[74:75], v25 offset:41632
v_cvt_pk_bf16_f32 v229, v230, v231
v_mfma_f32_16x16x32_bf16 v[68:71], a[92:95], a[180:183], v[68:71]
ds_read_b64_tr_b16 a[76:77], v25 offset:46240
v_cvt_pk_bf16_f32 v230, v244, v245
v_mfma_f32_16x16x32_bf16 v[64:67], a[92:95], a[176:179], v[64:67]
ds_read_b64_tr_b16 a[78:79], v25 offset:50848
v_cvt_pk_bf16_f32 v231, v246, v247
v_mfma_f32_16x16x32_bf16 v[64:67], a[88:91], a[168:171], v[64:67]
s_waitcnt lgkmcnt(6)
buffer_store_dwordx4 v[228:231], v1, s[4:7], s59 offen offset:1024 sc1
ds_read_b64_tr_b16 a[80:81], v25 offset:18624
v_mfma_f32_16x16x32_bf16 v[72:75], a[64:67], a[152:155], v[72:75]
s_waitcnt lgkmcnt(5)
ds_read_b64_tr_b16 a[82:83], v25 offset:23232
v_cvt_pk_bf16_f32 v236, v236, v237
v_mfma_f32_16x16x32_bf16 v[72:75], a[68:71], a[160:163], v[72:75]
ds_read_b64_tr_b16 a[84:85], v25 offset:27840
v_cvt_pk_bf16_f32 v237, v238, v239
v_mfma_f32_16x16x32_bf16 v[76:79], a[68:71], a[164:167], v[76:79]
ds_read_b64_tr_b16 a[86:87], v25 offset:32448
v_cvt_pk_bf16_f32 v238, v252, v253
v_cvt_pk_bf16_f32 v239, v254, v255
v_mfma_f32_16x16x32_bf16 v[76:79], a[64:67], a[156:159], v[76:79]
s_waitcnt lgkmcnt(6)
buffer_store_dwordx4 v[236:239], v1, s[4:7], s60 offen offset:1024 sc1
ds_read_b64_tr_b16 a[88:89], v25 offset:37056
v_mfma_f32_16x16x32_bf16 v[76:79], a[72:75], a[172:175], v[76:79]
s_waitcnt lgkmcnt(5)
ds_read_b64_tr_b16 a[90:91], v25 offset:41664
v_mfma_f32_16x16x32_bf16 v[76:79], a[76:79], a[180:183], v[76:79]
ds_read_b64_tr_b16 a[92:93], v25 offset:46272
v_mfma_f32_16x16x32_bf16 v[72:75], a[76:79], a[176:179], v[72:75]
ds_read_b64_tr_b16 a[94:95], v25 offset:50880
v_mfma_f32_16x16x32_bf16 v[72:75], a[72:75], a[168:171], v[72:75]
s_waitcnt lgkmcnt(6)
ds_read_b64_tr_b16 a[64:65], v25 offset:18656
v_mfma_f32_16x16x32_bf16 v[80:83], a[80:83], a[152:155], v[80:83]
s_waitcnt lgkmcnt(5)
ds_read_b64_tr_b16 a[66:67], v25 offset:23264
v_mfma_f32_16x16x32_bf16 v[80:83], a[84:87], a[160:163], v[80:83]
ds_read_b64_tr_b16 a[68:69], v25 offset:27872
v_mfma_f32_16x16x32_bf16 v[84:87], a[84:87], a[164:167], v[84:87]
ds_read_b64_tr_b16 a[70:71], v25 offset:32480
v_mfma_f32_16x16x32_bf16 v[84:87], a[80:83], a[156:159], v[84:87]
s_waitcnt lgkmcnt(6)
ds_read_b64_tr_b16 a[72:73], v25 offset:37088
v_cvt_pk_bf16_f32 v64, v64, v65
v_mfma_f32_16x16x32_bf16 v[84:87], a[88:91], a[172:175], v[84:87]
s_waitcnt lgkmcnt(5)
ds_read_b64_tr_b16 a[74:75], v25 offset:41696
v_cvt_pk_bf16_f32 v65, v66, v67
v_mfma_f32_16x16x32_bf16 v[84:87], a[92:95], a[180:183], v[84:87]
ds_read_b64_tr_b16 a[76:77], v25 offset:46304
v_cvt_pk_bf16_f32 v66, v72, v73
v_mfma_f32_16x16x32_bf16 v[80:83], a[92:95], a[176:179], v[80:83]
ds_read_b64_tr_b16 a[78:79], v25 offset:50912
v_cvt_pk_bf16_f32 v67, v74, v75
v_mfma_f32_16x16x32_bf16 v[80:83], a[88:91], a[168:171], v[80:83]
s_waitcnt lgkmcnt(6)
buffer_store_dwordx4 v[64:67], v1, s[4:7], s59 offen offset:2048 sc1
ds_read_b64_tr_b16 a[80:81], v25 offset:18688
v_mfma_f32_16x16x32_bf16 v[88:91], a[64:67], a[152:155], v[88:91]
s_waitcnt lgkmcnt(5)
ds_read_b64_tr_b16 a[82:83], v25 offset:23296
v_cvt_pk_bf16_f32 v68, v68, v69
v_mfma_f32_16x16x32_bf16 v[88:91], a[68:71], a[160:163], v[88:91]
ds_read_b64_tr_b16 a[84:85], v25 offset:27904
v_cvt_pk_bf16_f32 v69, v70, v71
v_mfma_f32_16x16x32_bf16 v[92:95], a[68:71], a[164:167], v[92:95]
ds_read_b64_tr_b16 a[86:87], v25 offset:32512
v_cvt_pk_bf16_f32 v70, v76, v77
v_cvt_pk_bf16_f32 v71, v78, v79
v_mfma_f32_16x16x32_bf16 v[92:95], a[64:67], a[156:159], v[92:95]
s_waitcnt lgkmcnt(6)
buffer_store_dwordx4 v[68:71], v1, s[4:7], s60 offen offset:2048 sc1
ds_read_b64_tr_b16 a[88:89], v25 offset:37120
v_mfma_f32_16x16x32_bf16 v[92:95], a[72:75], a[172:175], v[92:95]
s_waitcnt lgkmcnt(5)
ds_read_b64_tr_b16 a[90:91], v25 offset:41728
v_mfma_f32_16x16x32_bf16 v[92:95], a[76:79], a[180:183], v[92:95]
ds_read_b64_tr_b16 a[92:93], v25 offset:46336
v_mfma_f32_16x16x32_bf16 v[88:91], a[76:79], a[176:179], v[88:91]
ds_read_b64_tr_b16 a[94:95], v25 offset:50944
v_mfma_f32_16x16x32_bf16 v[88:91], a[72:75], a[168:171], v[88:91]
s_waitcnt lgkmcnt(6)
v_mfma_f32_16x16x32_bf16 v[96:99], a[80:83], a[152:155], v[96:99]
s_waitcnt lgkmcnt(4)
v_mfma_f32_16x16x32_bf16 v[96:99], a[84:87], a[160:163], v[96:99]
v_mfma_f32_16x16x32_bf16 v[100:103], a[84:87], a[164:167], v[100:103]
v_mfma_f32_16x16x32_bf16 v[100:103], a[80:83], a[156:159], v[100:103]
s_waitcnt lgkmcnt(2)
v_cvt_pk_bf16_f32 v80, v80, v81
v_cvt_pk_bf16_f32 v81, v82, v83
v_mfma_f32_16x16x32_bf16 v[100:103], a[88:91], a[172:175], v[100:103]
s_waitcnt lgkmcnt(0)
v_cvt_pk_bf16_f32 v82, v88, v89
v_cvt_pk_bf16_f32 v83, v90, v91
v_mfma_f32_16x16x32_bf16 v[100:103], a[92:95], a[180:183], v[100:103]
v_cvt_pk_bf16_f32 v84, v84, v85
v_cvt_pk_bf16_f32 v85, v86, v87
v_mfma_f32_16x16x32_bf16 v[96:99], a[92:95], a[176:179], v[96:99]
v_cvt_pk_bf16_f32 v86, v92, v93
v_cvt_pk_bf16_f32 v87, v94, v95
v_mfma_f32_16x16x32_bf16 v[96:99], a[88:91], a[168:171], v[96:99]
s_waitcnt vmcnt(16)
s_barrier
ds_read_b64_tr_b16 a[116:117], v23 offset:9216
ds_read_b64_tr_b16 a[118:119], v23 offset:13824
ds_read_b64_tr_b16 a[120:121], v23 offset:18432
ds_read_b64_tr_b16 a[122:123], v23 offset:23040
v_mfma_f32_16x16x32_bf16 v[128:131], a[96:99], a[4:7], 0
ds_read_b64_tr_b16 a[124:125], v23 offset:18464
ds_read_b64_tr_b16 a[126:127], v23 offset:23072
buffer_store_dwordx4 v[80:83], v1, s[4:7], s59 offen offset:3072 sc1
v_mfma_f32_16x16x32_bf16 v[136:139], a[100:103], a[4:7], 0
ds_read_b64_tr_b16 a[64:65], v23 offset:9248
ds_read_b64_tr_b16 a[66:67], v23 offset:13856
v_mfma_f32_16x16x32_bf16 v[144:147], a[104:107], a[4:7], 0
ds_read_b64_tr_b16 a[68:69], v23 offset:9280
ds_read_b64_tr_b16 a[70:71], v23 offset:13888
v_mfma_f32_16x16x32_bf16 v[152:155], a[108:111], a[4:7], 0
ds_read_b64_tr_b16 a[72:73], v23 offset:18496
ds_read_b64_tr_b16 a[74:75], v23 offset:23104
v_mfma_f32_16x16x32_bf16 v[160:163], a[112:115], a[4:7], 0
s_waitcnt lgkmcnt(10)
ds_read_b64_tr_b16 a[76:77], v23 offset:18528
ds_read_b64_tr_b16 a[78:79], v23 offset:23136
buffer_store_dwordx4 v[84:87], v1, s[4:7], s60 offen offset:3072 sc1
v_mfma_f32_16x16x32_bf16 v[128:131], a[116:119], a[8:11], v[128:131]
s_waitcnt lgkmcnt(10)
ds_read_b64_tr_b16 a[80:81], v23 offset:9312
ds_read_b64_tr_b16 a[82:83], v23 offset:13920
v_mfma_f32_16x16x32_bf16 v[128:131], a[120:123], a[12:15], v[128:131]
s_waitcnt lgkmcnt(10)
ds_read_b64_tr_b16 a[84:85], v23 offset:9344
ds_read_b64_tr_b16 a[86:87], v23 offset:13952
v_cvt_pk_bf16_f32 v96, v96, v97
v_cvt_pk_bf16_f32 v97, v98, v99
v_mfma_f32_16x16x32_bf16 v[136:139], a[124:127], a[12:15], v[136:139]
s_waitcnt lgkmcnt(10)
ds_read_b64_tr_b16 a[88:89], v23 offset:18560
ds_read_b64_tr_b16 a[90:91], v23 offset:23168
v_mfma_f32_16x16x32_bf16 v[136:139], a[64:67], a[8:11], v[136:139]
s_waitcnt lgkmcnt(10)
s_add_u32 s59, s59, 0x1000
buffer_store_dwordx2 v[96:97], v14, s[4:7], s59 offen sc1
ds_read_b64_tr_b16 a[92:93], v23 offset:27648
ds_read_b64_tr_b16 a[94:95], v23 offset:32256
v_mfma_f32_16x16x32_bf16 v[144:147], a[68:71], a[8:11], v[144:147]
s_waitcnt lgkmcnt(10)
ds_read_b64_tr_b16 a[96:97], v23 offset:36864
ds_read_b64_tr_b16 a[98:99], v23 offset:41472
v_mfma_f32_16x16x32_bf16 v[144:147], a[72:75], a[12:15], v[144:147]
s_waitcnt lgkmcnt(10)
ds_read_b64_tr_b16 a[100:101], v23 offset:36896
ds_read_b64_tr_b16 a[102:103], v23 offset:41504
v_cvt_pk_bf16_f32 v100, v100, v101
v_cvt_pk_bf16_f32 v101, v102, v103
v_mfma_f32_16x16x32_bf16 v[152:155], a[76:79], a[12:15], v[152:155]
s_waitcnt lgkmcnt(10)
ds_read_b64_tr_b16 a[104:105], v23 offset:27680
ds_read_b64_tr_b16 a[106:107], v23 offset:32288
v_mfma_f32_16x16x32_bf16 v[152:155], a[80:83], a[8:11], v[152:155]
s_waitcnt lgkmcnt(10)
s_add_u32 s60, s60, 0x1000
buffer_store_dwordx2 v[100:101], v14, s[4:7], s60 offen sc1
ds_read_b64_tr_b16 a[108:109], v23 offset:27712
ds_read_b64_tr_b16 a[110:111], v23 offset:32320
v_mfma_f32_16x16x32_bf16 v[160:163], a[84:87], a[8:11], v[160:163]
ds_read_b64_tr_b16 a[112:113], v23 offset:36928
ds_read_b64_tr_b16 a[114:115], v23 offset:41536
ds_read_b64_tr_b16 a[116:117], v23 offset:36960
ds_read_b64_tr_b16 a[118:119], v23 offset:41568
ds_read_b64_tr_b16 a[120:121], v23 offset:27744
ds_read_b64_tr_b16 a[122:123], v23 offset:32352
ds_read_b64_tr_b16 a[124:125], v23 offset:27776
ds_read_b64_tr_b16 a[126:127], v23 offset:32384
ds_read_b64_tr_b16 a[64:65], v23 offset:36992
ds_read_b64_tr_b16 a[66:67], v23 offset:41600
s_waitcnt vmcnt(10)
s_barrier
s_waitcnt lgkmcnt(15)
v_mfma_f32_16x16x32_bf16 v[160:163], a[88:91], a[12:15], v[160:163]
s_mul_i32 s85, s48, 0x9000
s_mul_i32 s70, s52, 0x120
s_add_u32 s85, s85, s70
s_add_u32 s85, s85, 0x51000
s_mul_i32 s67, s48, 0x2400
s_cmp_lt_u32 s48, 3
s_cselect_b32 s67, s67, s61
s_add_u32 m0, s67, 0
v_mfma_f32_16x16x32_bf16 v[128:131], a[92:95], a[16:19], v[128:131]
buffer_load_dwordx4 v4, s[36:39], s85 offen lds
s_add_u32 m0, s67, 0
ds_read_b64_tr_b16 a[68:69], v23 offset:46080
v_mfma_f32_16x16x32_bf16 v[128:131], a[96:99], a[20:23], v[128:131]
s_waitcnt lgkmcnt(13)
buffer_load_dwordx4 v5, s[36:39], s85 offen offset:1024 lds
s_add_u32 m0, s67, 0
ds_read_b64_tr_b16 a[70:71], v23 offset:50688
v_mfma_f32_16x16x32_bf16 v[136:139], a[100:103], a[20:23], v[136:139]
buffer_load_dwordx4 v6, s[36:39], s85 offen offset:2048 lds
s_add_u32 m0, s67, 0
ds_read_b64_tr_b16 a[72:73], v23 offset:55296
v_mfma_f32_16x16x32_bf16 v[136:139], a[104:107], a[16:19], v[136:139]
s_waitcnt lgkmcnt(8)
buffer_load_dwordx4 v7, s[36:39], s85 offen offset:3072 lds
s_add_u32 m0, s67, 0x1000
ds_read_b64_tr_b16 a[74:75], v23 offset:59904
v_mfma_f32_16x16x32_bf16 v[144:147], a[108:111], a[16:19], v[144:147]
buffer_load_dwordx4 v8, s[36:39], s85 offen lds
s_add_u32 m0, s67, 0x1000
ds_read_b64_tr_b16 a[76:77], v23 offset:55328
v_mfma_f32_16x16x32_bf16 v[144:147], a[112:115], a[20:23], v[144:147]
ds_read_b64_tr_b16 a[78:79], v23 offset:59936
buffer_load_dwordx4 v9, s[36:39], s85 offen offset:1024 lds
s_add_u32 m0, s67, 0x1000
v_mfma_f32_16x16x32_bf16 v[152:155], a[116:119], a[20:23], v[152:155]
s_waitcnt lgkmcnt(6)
ds_read_b64_tr_b16 a[80:81], v23 offset:46112
ds_read_b64_tr_b16 a[82:83], v23 offset:50720
buffer_load_dwordx4 v10, s[36:39], s85 offen offset:2048 lds
s_add_u32 m0, s67, 0x1000
v_mfma_f32_16x16x32_bf16 v[152:155], a[120:123], a[16:19], v[152:155]
ds_read_b64_tr_b16 a[84:85], v23 offset:46144
ds_read_b64_tr_b16 a[86:87], v23 offset:50752
buffer_load_dwordx4 v11, s[36:39], s85 offen offset:3072 lds
s_add_u32 m0, s67, 0x2000
v_mfma_f32_16x16x32_bf16 v[160:163], a[124:127], a[16:19], v[160:163]
ds_read_b64_tr_b16 a[88:89], v23 offset:55360
ds_read_b64_tr_b16 a[90:91], v23 offset:59968
buffer_load_dwordx4 v12, s[36:39], s85 offen lds
s_mul_i32 s85, s48, 0x9000
s_mul_i32 s70, s52, 0x120
s_add_u32 s85, s85, s70
s_add_u32 s85, s85, 0x75000
s_mul_i32 s67, s48, 0x2400
s_add_u32 s67, s67, s62
s_add_u32 s67, s67, 0xd800
s_cmp_lt_u32 s48, 1
s_cselect_b32 s67, s67, 0x28000
s_cselect_b32 s85, s85, 0x40000000
s_add_u32 m0, s67, 0
v_mfma_f32_16x16x32_bf16 v[160:163], a[64:67], a[20:23], v[160:163]
s_waitcnt lgkmcnt(7)
ds_read_b64_tr_b16 a[92:93], v23 offset:55392
ds_read_b64_tr_b16 a[94:95], v23 offset:60000
buffer_load_dwordx4 v4, s[36:39], s85 offen lds
s_add_u32 m0, s67, 0
v_mfma_f32_16x16x32_bf16 v[128:131], a[68:71], a[24:27], v[128:131]
s_lshl_b32 s59, s50, 2
s_add_u32 s59, s59, s52
s_lshl_b32 s59, s59, 2
s_add_u32 s59, s59, s48
s_lshl_b32 s59, s59, 3
s_add_u32 s59, s59, s51
s_lshl_b32 s59, s59, 2
s_add_u32 s59, s59, 0x5008000
ds_read_b64_tr_b16 a[96:97], v23 offset:46176
ds_read_b64_tr_b16 a[98:99], v23 offset:50784
buffer_load_dwordx4 v5, s[36:39], s85 offen offset:1024 lds
v_mfma_f32_16x16x32_bf16 v[128:131], a[72:75], a[28:31], v[128:131]
s_waitcnt lgkmcnt(4)
s_add_u32 m0, s67, 0
ds_read_b64_tr_b16 a[100:101], v23 offset:46208
ds_read_b64_tr_b16 a[102:103], v23 offset:50816
s_waitcnt vmcnt(11)
buffer_store_dword v18, v20, s[4:7], s59 offen sc1
v_mfma_f32_16x16x32_bf16 v[136:139], a[76:79], a[28:31], v[136:139]
ds_read_b64_tr_b16 a[104:105], v23 offset:55424
ds_read_b64_tr_b16 a[106:107], v23 offset:60032
buffer_load_dwordx4 v6, s[36:39], s85 offen offset:2048 lds
s_add_u32 m0, s67, 0
v_mfma_f32_16x16x32_bf16 v[136:139], a[80:83], a[24:27], v[136:139]
ds_read_b64_tr_b16 a[108:109], v24
ds_read_b64_tr_b16 a[110:111], v24 offset:4608
buffer_load_dwordx4 v7, s[36:39], s85 offen offset:3072 lds
s_add_u32 m0, s67, 0x1000
v_mfma_f32_16x16x32_bf16 v[144:147], a[84:87], a[24:27], v[144:147]
ds_read_b64_tr_b16 a[112:113], v24 offset:9216
ds_read_b64_tr_b16 a[114:115], v24 offset:13824
buffer_load_dwordx4 v8, s[36:39], s85 offen lds
s_add_u32 m0, s67, 0x1000
v_mfma_f32_16x16x32_bf16 v[144:147], a[88:91], a[28:31], v[144:147]
s_waitcnt lgkmcnt(10)
ds_read_b64_tr_b16 a[116:117], v24 offset:9248
ds_read_b64_tr_b16 a[118:119], v24 offset:13856
buffer_load_dwordx4 v9, s[36:39], s85 offen offset:1024 lds
s_add_u32 m0, s67, 0x1000
v_mfma_f32_16x16x32_bf16 v[152:155], a[92:95], a[28:31], v[152:155]
s_waitcnt lgkmcnt(10)
ds_read_b64_tr_b16 a[120:121], v24 offset:32
ds_read_b64_tr_b16 a[122:123], v24 offset:4640
buffer_load_dwordx4 v10, s[36:39], s85 offen offset:2048 lds
s_add_u32 m0, s67, 0x1000
v_mfma_f32_16x16x32_bf16 v[152:155], a[96:99], a[24:27], v[152:155]
s_waitcnt lgkmcnt(10)
ds_read_b64_tr_b16 a[124:125], v24 offset:64
ds_read_b64_tr_b16 a[126:127], v24 offset:4672
buffer_load_dwordx4 v11, s[36:39], s85 offen offset:3072 lds
s_add_u32 m0, s67, 0x2000
v_mfma_f32_16x16x32_bf16 v[160:163], a[100:103], a[24:27], v[160:163]
ds_read_b64_tr_b16 a[64:65], v24 offset:9280
ds_read_b64_tr_b16 a[66:67], v24 offset:13888
ds_read_b64_tr_b16 a[68:69], v24 offset:9312
ds_read_b64_tr_b16 a[70:71], v24 offset:13920
ds_read_b64_tr_b16 a[72:73], v24 offset:96
ds_read_b64_tr_b16 a[74:75], v24 offset:4704
ds_read_b64_tr_b16 a[76:77], v24 offset:128
ds_read_b64_tr_b16 a[78:79], v24 offset:4736
ds_read_b64_tr_b16 a[80:81], v24 offset:9344
ds_read_b64_tr_b16 a[82:83], v24 offset:13952
buffer_load_dwordx4 v12, s[36:39], s85 offen lds
s_mul_i32 s85, s48, 0x9000
s_mul_i32 s70, s52, 0x120
s_add_u32 s85, s85, s70
s_add_u32 s85, s85, 0x7e000
s_mul_i32 s67, s48, 0x2400
s_add_u32 s67, s67, s62
s_add_u32 s67, s67, 0x4800
s_add_u32 m0, s67, 0
s_waitcnt vmcnt(10)
s_barrier
s_waitcnt lgkmcnt(14)
v_mfma_f32_16x16x32_bf16 v[160:163], a[104:107], a[28:31], v[160:163]
buffer_load_dwordx4 v4, s[36:39], s85 offen lds
s_add_u32 m0, s67, 0
ds_read_b64_tr_b16 a[84:85], v22
v_mfma_f32_16x16x32_bf16 v[128:131], a[108:111], a[32:35], v[128:131]
buffer_load_dwordx4 v5, s[36:39], s85 offen offset:1024 lds
s_add_u32 m0, s67, 0
ds_read_b64_tr_b16 a[86:87], v22 offset:4608
v_mfma_f32_16x16x32_bf16 v[128:131], a[112:115], a[184:187], v[128:131]
buffer_load_dwordx4 v6, s[36:39], s85 offen offset:2048 lds
s_add_u32 m0, s67, 0
ds_read_b64_tr_b16 a[88:89], v22 offset:9216
v_mfma_f32_16x16x32_bf16 v[136:139], a[116:119], a[184:187], v[136:139]
s_waitcnt lgkmcnt(8)
buffer_load_dwordx4 v7, s[36:39], s85 offen offset:3072 lds
s_add_u32 m0, s67, 0x1000
ds_read_b64_tr_b16 a[90:91], v22 offset:13824
v_mfma_f32_16x16x32_bf16 v[136:139], a[120:123], a[32:35], v[136:139]
buffer_load_dwordx4 v8, s[36:39], s85 offen lds
s_add_u32 m0, s67, 0x1000
ds_read_b64_tr_b16 a[92:93], v22 offset:9248
v_mfma_f32_16x16x32_bf16 v[144:147], a[124:127], a[32:35], v[144:147]
buffer_load_dwordx4 v9, s[36:39], s85 offen offset:1024 lds
s_add_u32 m0, s67, 0x1000
ds_read_b64_tr_b16 a[94:95], v22 offset:13856
v_mfma_f32_16x16x32_bf16 v[144:147], a[64:67], a[184:187], v[144:147]
buffer_load_dwordx4 v10, s[36:39], s85 offen offset:2048 lds
s_add_u32 m0, s67, 0x1000
ds_read_b64_tr_b16 a[96:97], v22 offset:32
v_mfma_f32_16x16x32_bf16 v[152:155], a[68:71], a[184:187], v[152:155]
s_waitcnt lgkmcnt(7)
ds_read_b64_tr_b16 a[98:99], v22 offset:4640
buffer_load_dwordx4 v11, s[36:39], s85 offen offset:3072 lds
s_add_u32 m0, s67, 0x2000
v_mfma_f32_16x16x32_bf16 v[152:155], a[72:75], a[32:35], v[152:155]
ds_read_b64_tr_b16 a[100:101], v22 offset:64
ds_read_b64_tr_b16 a[102:103], v22 offset:4672
buffer_load_dwordx4 v12, s[36:39], s85 offen lds
v_mfma_f32_16x16x32_bf16 v[160:163], a[76:79], a[32:35], v[160:163]
ds_read_b64_tr_b16 a[104:105], v22 offset:9280
ds_read_b64_tr_b16 a[106:107], v22 offset:13888
v_mfma_f32_16x16x32_bf16 v[160:163], a[80:83], a[184:187], v[160:163]
s_waitcnt lgkmcnt(9)
ds_read_b64_tr_b16 a[108:109], v22 offset:9312
ds_read_b64_tr_b16 a[110:111], v22 offset:13920
v_mfma_f32_16x16x32_bf16 v[128:131], a[84:87], a[188:191], v[128:131]
s_waitcnt lgkmcnt(10)
ds_read_b64_tr_b16 a[112:113], v22 offset:96
ds_read_b64_tr_b16 a[114:115], v22 offset:4704
v_mfma_f32_16x16x32_bf16 v[128:131], a[88:91], a[192:195], v[128:131]
s_waitcnt lgkmcnt(10)
ds_read_b64_tr_b16 a[116:117], v22 offset:128
ds_read_b64_tr_b16 a[118:119], v22 offset:4736
v_mfma_f32_16x16x32_bf16 v[136:139], a[92:95], a[192:195], v[136:139]
s_waitcnt lgkmcnt(10)
ds_read_b64_tr_b16 a[120:121], v22 offset:9344
ds_read_b64_tr_b16 a[122:123], v22 offset:13952
v_mfma_f32_16x16x32_bf16 v[136:139], a[96:99], a[188:191], v[136:139]
s_waitcnt lgkmcnt(10)
ds_read_b64_tr_b16 a[124:125], v22 offset:18432
ds_read_b64_tr_b16 a[126:127], v22 offset:23040
v_mfma_f32_16x16x32_bf16 v[144:147], a[100:103], a[188:191], v[144:147]
s_waitcnt lgkmcnt(10)
ds_read_b64_tr_b16 a[64:65], v23
ds_read_b64_tr_b16 a[66:67], v23 offset:4608
v_mfma_f32_16x16x32_bf16 v[144:147], a[104:107], a[192:195], v[144:147]
s_waitcnt lgkmcnt(10)
ds_read_b64_tr_b16 a[68:69], v23 offset:32
ds_read_b64_tr_b16 a[70:71], v23 offset:4640
v_mfma_f32_16x16x32_bf16 v[152:155], a[108:111], a[192:195], v[152:155]
s_waitcnt lgkmcnt(10)
ds_read_b64_tr_b16 a[72:73], v22 offset:18464
ds_read_b64_tr_b16 a[74:75], v22 offset:23072
v_mfma_f32_16x16x32_bf16 v[152:155], a[112:115], a[188:191], v[152:155]
s_waitcnt lgkmcnt(10)
ds_read_b64_tr_b16 a[76:77], v22 offset:18496
ds_read_b64_tr_b16 a[78:79], v22 offset:23104
v_mfma_f32_16x16x32_bf16 v[160:163], a[116:119], a[188:191], v[160:163]
ds_read_b64_tr_b16 a[80:81], v23 offset:64
ds_read_b64_tr_b16 a[82:83], v23 offset:4672
ds_read_b64_tr_b16 a[84:85], v23 offset:96
ds_read_b64_tr_b16 a[86:87], v23 offset:4704
ds_read_b64_tr_b16 a[88:89], v22 offset:18528
ds_read_b64_tr_b16 a[90:91], v22 offset:23136
ds_read_b64_tr_b16 a[92:93], v22 offset:18560
ds_read_b64_tr_b16 a[94:95], v22 offset:23168
ds_read_b64_tr_b16 a[96:97], v23 offset:128
ds_read_b64_tr_b16 a[98:99], v23 offset:4736
s_waitcnt vmcnt(0)
s_barrier
s_waitcnt lgkmcnt(15)
v_mfma_f32_16x16x32_bf16 v[160:163], a[120:123], a[192:195], v[160:163]
ds_read_b64_tr_b16 a[100:101], v24 offset:55296
v_mfma_f32_16x16x32_bf16 v[128:131], a[124:127], a[200:203], v[128:131]
ds_read_b64_tr_b16 a[102:103], v24 offset:59904
v_mfma_f32_16x16x32_bf16 v[128:131], a[64:67], a[208:211], v[128:131]
s_waitcnt lgkmcnt(15)
ds_read_b64_tr_b16 a[104:105], v24 offset:18432
v_mfma_f32_16x16x32_bf16 v[136:139], a[68:71], a[208:211], v[136:139]
s_waitcnt lgkmcnt(15)
ds_read_b64_tr_b16 a[106:107], v24 offset:23040
v_mfma_f32_16x16x32_bf16 v[136:139], a[72:75], a[200:203], v[136:139]
s_waitcnt lgkmcnt(14)
ds_read_b64_tr_b16 a[108:109], v24 offset:18464
v_mfma_f32_16x16x32_bf16 v[144:147], a[76:79], a[200:203], v[144:147]
s_waitcnt lgkmcnt(11)
ds_read_b64_tr_b16 a[110:111], v24 offset:23072
v_mfma_f32_16x16x32_bf16 v[144:147], a[80:83], a[208:211], v[144:147]
ds_read_b64_tr_b16 a[112:113], v24 offset:55328
v_mfma_f32_16x16x32_bf16 v[152:155], a[84:87], a[208:211], v[152:155]
s_waitcnt lgkmcnt(7)
ds_read_b64_tr_b16 a[114:115], v24 offset:59936
v_mfma_f32_16x16x32_bf16 v[152:155], a[88:91], a[200:203], v[152:155]
ds_read_b64_tr_b16 a[116:117], v24 offset:55360
ds_read_b64_tr_b16 a[118:119], v24 offset:59968
v_mfma_f32_16x16x32_bf16 v[160:163], a[92:95], a[200:203], v[160:163]
ds_read_b64_tr_b16 a[120:121], v24 offset:18496
ds_read_b64_tr_b16 a[122:123], v24 offset:23104
v_mfma_f32_16x16x32_bf16 v[160:163], a[96:99], a[208:211], v[160:163]
s_waitcnt lgkmcnt(9)
ds_read_b64_tr_b16 a[124:125], v24 offset:18528
ds_read_b64_tr_b16 a[126:127], v24 offset:23136
v_mfma_f32_16x16x32_bf16 v[128:131], a[100:103], a[216:219], v[128:131]
s_waitcnt lgkmcnt(10)
ds_read_b64_tr_b16 a[64:65], v24 offset:55392
ds_read_b64_tr_b16 a[66:67], v24 offset:60000
v_mfma_f32_16x16x32_bf16 v[128:131], a[104:107], a[224:227], v[128:131]
s_waitcnt lgkmcnt(10)
ds_read_b64_tr_b16 a[68:69], v24 offset:55424
ds_read_b64_tr_b16 a[70:71], v24 offset:60032
v_mfma_f32_16x16x32_bf16 v[136:139], a[108:111], a[224:227], v[136:139]
s_waitcnt lgkmcnt(10)
ds_read_b64_tr_b16 a[72:73], v24 offset:18560
ds_read_b64_tr_b16 a[74:75], v24 offset:23168
v_mfma_f32_16x16x32_bf16 v[136:139], a[112:115], a[216:219], v[136:139]
s_waitcnt lgkmcnt(10)
ds_read_b64_tr_b16 a[76:77], v24 offset:27648
ds_read_b64_tr_b16 a[78:79], v24 offset:32256
v_mfma_f32_16x16x32_bf16 v[144:147], a[116:119], a[216:219], v[144:147]
s_waitcnt lgkmcnt(10)
ds_read_b64_tr_b16 a[80:81], v24 offset:36864
ds_read_b64_tr_b16 a[82:83], v24 offset:41472
v_mfma_f32_16x16x32_bf16 v[144:147], a[120:123], a[224:227], v[144:147]
s_waitcnt lgkmcnt(10)
ds_read_b64_tr_b16 a[84:85], v24 offset:36896
ds_read_b64_tr_b16 a[86:87], v24 offset:41504
v_mfma_f32_16x16x32_bf16 v[152:155], a[124:127], a[224:227], v[152:155]
s_waitcnt lgkmcnt(10)
ds_read_b64_tr_b16 a[88:89], v24 offset:27680
ds_read_b64_tr_b16 a[90:91], v24 offset:32288
v_mfma_f32_16x16x32_bf16 v[152:155], a[64:67], a[216:219], v[152:155]
s_waitcnt lgkmcnt(10)
ds_read_b64_tr_b16 a[92:93], v24 offset:27712
ds_read_b64_tr_b16 a[94:95], v24 offset:32320
v_mfma_f32_16x16x32_bf16 v[160:163], a[68:71], a[216:219], v[160:163]
s_waitcnt lgkmcnt(10)
ds_read_b64_tr_b16 a[96:97], v24 offset:36928
ds_read_b64_tr_b16 a[98:99], v24 offset:41536
v_mfma_f32_16x16x32_bf16 v[160:163], a[72:75], a[224:227], v[160:163]
s_waitcnt lgkmcnt(10)
ds_read_b64_tr_b16 a[100:101], v24 offset:36960
ds_read_b64_tr_b16 a[102:103], v24 offset:41568
v_mfma_f32_16x16x32_bf16 v[128:131], a[76:79], a[232:235], v[128:131]
s_waitcnt lgkmcnt(10)
ds_read_b64_tr_b16 a[104:105], v24 offset:27744
ds_read_b64_tr_b16 a[106:107], v24 offset:32352
v_mfma_f32_16x16x32_bf16 v[128:131], a[80:83], a[240:243], v[128:131]
s_waitcnt lgkmcnt(10)
ds_read_b64_tr_b16 a[108:109], v24 offset:27776
ds_read_b64_tr_b16 a[110:111], v24 offset:32384
v_mfma_f32_16x16x32_bf16 v[136:139], a[84:87], a[240:243], v[136:139]
s_waitcnt lgkmcnt(10)
ds_read_b64_tr_b16 a[112:113], v24 offset:36992
ds_read_b64_tr_b16 a[114:115], v24 offset:41600
v_mfma_f32_16x16x32_bf16 v[136:139], a[88:91], a[232:235], v[136:139]
s_waitcnt lgkmcnt(10)
ds_read_b64_tr_b16 a[116:117], v24 offset:46080
ds_read_b64_tr_b16 a[118:119], v24 offset:50688
v_mfma_f32_16x16x32_bf16 v[144:147], a[92:95], a[232:235], v[144:147]
s_waitcnt lgkmcnt(10)
ds_read_b64_tr_b16 a[120:121], v24 offset:46112
ds_read_b64_tr_b16 a[122:123], v24 offset:50720
v_mfma_f32_16x16x32_bf16 v[144:147], a[96:99], a[240:243], v[144:147]
s_waitcnt lgkmcnt(10)
ds_read_b64_tr_b16 a[124:125], v24 offset:46144
ds_read_b64_tr_b16 a[126:127], v24 offset:50752
v_mfma_f32_16x16x32_bf16 v[152:155], a[100:103], a[240:243], v[152:155]
s_waitcnt lgkmcnt(10)
ds_read_b64_tr_b16 a[64:65], v24 offset:46176
ds_read_b64_tr_b16 a[66:67], v24 offset:50784
v_mfma_f32_16x16x32_bf16 v[152:155], a[104:107], a[232:235], v[152:155]
s_waitcnt lgkmcnt(10)
ds_read_b64_tr_b16 a[68:69], v24 offset:46208
ds_read_b64_tr_b16 a[70:71], v24 offset:50816
v_mfma_f32_16x16x32_bf16 v[160:163], a[108:111], a[232:235], v[160:163]
s_waitcnt lgkmcnt(10)
v_mfma_f32_16x16x32_bf16 v[160:163], a[112:115], a[240:243], v[160:163]
s_waitcnt lgkmcnt(8)
v_mfma_f32_16x16x32_bf16 v[128:131], a[116:119], a[248:251], v[128:131]
s_waitcnt lgkmcnt(6)
v_mfma_f32_16x16x32_bf16 v[136:139], a[120:123], a[248:251], v[136:139]
s_waitcnt lgkmcnt(4)
v_mfma_f32_16x16x32_bf16 v[144:147], a[124:127], a[248:251], v[144:147]
s_waitcnt lgkmcnt(2)
v_mfma_f32_16x16x32_bf16 v[152:155], a[64:67], a[248:251], v[152:155]
s_waitcnt lgkmcnt(0)
v_mfma_f32_16x16x32_bf16 v[160:163], a[68:71], a[248:251], v[160:163]
v_cmp_ne_u32 vcc, v19, v18
s_nop 1
s_cbranch_vccnz L_spin_pe
L_back_pe:
s_lshl_b32 s90, s50, 2
s_add_u32 s90, s90, s52
s_mul_i32 s90, s90, 0x50000
s_add_u32 s90, s90, 0x3000000
s_mul_i32 s89, s51, 0xa000
s_add_u32 s90, s90, s89
s_lshl_b32 s89, s48, 10
s_add_u32 s89, s89, s90
s_add_u32 s90, s90, 0x1000
buffer_load_dwordx4 v[32:35], v1, s[4:7], s89 offen sc1
s_add_u32 s89, s89, 0x1400
buffer_load_dwordx4 v[36:39], v1, s[4:7], s89 offen sc1
s_add_u32 s89, s89, 0x1400
buffer_load_dwordx4 v[40:43], v1, s[4:7], s89 offen sc1
s_add_u32 s89, s89, 0x1400
buffer_load_dwordx4 v[44:47], v1, s[4:7], s89 offen sc1
s_add_u32 s89, s89, 0x1400
buffer_load_dwordx4 v[48:51], v1, s[4:7], s89 offen sc1
s_add_u32 s89, s89, 0x1400
buffer_load_dwordx4 v[52:55], v1, s[4:7], s89 offen sc1
s_add_u32 s89, s89, 0x1400
buffer_load_dwordx4 v[56:59], v1, s[4:7], s89 offen sc1
s_add_u32 s89, s89, 0x1400
buffer_load_dwordx4 v[60:63], v1, s[4:7], s89 offen sc1
s_add_u32 s89, s89, 0x1400
buffer_load_dwordx2 v[132:133], v110, s[4:7], s90 offen sc1
s_add_u32 s90, s90, 0x1400
buffer_load_dwordx2 v[134:135], v110, s[4:7], s90 offen sc1
s_add_u32 s90, s90, 0x1400
buffer_load_dwordx2 v[140:141], v110, s[4:7], s90 offen sc1
s_add_u32 s90, s90, 0x1400
buffer_load_dwordx2 v[142:143], v110, s[4:7], s90 offen sc1
s_add_u32 s90, s90, 0x1400
buffer_load_dwordx2 v[148:149], v110, s[4:7], s90 offen sc1
s_add_u32 s90, s90, 0x1400
buffer_load_dwordx2 v[150:151], v110, s[4:7], s90 offen sc1
s_add_u32 s90, s90, 0x1400
buffer_load_dwordx2 v[156:157], v110, s[4:7], s90 offen sc1
s_add_u32 s90, s90, 0x1400
buffer_load_dwordx2 v[158:159], v110, s[4:7], s90 offen sc1
s_add_u32 s90, s90, 0x1400
s_lshl_b32 s69, s50, 3
s_add_u32 s69, s69, s51
s_lshl_b32 s69, s69, 1
s_and_b32 s70, s48, 1
s_add_u32 s69, s69, s70
s_mul_i32 s69, s69, 0x9000
s_mul_i32 s70, s52, 0x120
s_add_u32 s69, s69, s70
s_add_u32 s65, s69, 0x480
s_lshr_b32 s70, s48, 1
s_lshl_b32 s70, s70, 7
s_add_u32 s65, s65, s70
v_cvt_pk_bf16_f32 v192, v128, v129
v_cvt_pk_bf16_f32 v193, v130, v131
ds_bpermute_b32 v194, v15, v192
ds_bpermute_b32 v195, v15, v193
v_cvt_pk_bf16_f32 v200, v136, v137
v_cvt_pk_bf16_f32 v201, v138, v139
ds_bpermute_b32 v202, v15, v200
ds_bpermute_b32 v203, v15, v201
v_cvt_pk_bf16_f32 v208, v144, v145
v_cvt_pk_bf16_f32 v209, v146, v147
ds_bpermute_b32 v210, v15, v208
ds_bpermute_b32 v211, v15, v209
v_cvt_pk_bf16_f32 v216, v152, v153
v_cvt_pk_bf16_f32 v217, v154, v155
ds_bpermute_b32 v218, v15, v216
ds_bpermute_b32 v219, v15, v217
v_cvt_pk_bf16_f32 v224, v160, v161
v_cvt_pk_bf16_f32 v225, v162, v163
ds_bpermute_b32 v226, v15, v224
ds_bpermute_b32 v227, v15, v225
s_lshl_b32 s78, s50, 2
s_add_u32 s78, s78, s52
s_lshl_b32 s78, s78, 2
s_sub_u32 s71, 7, s51
s_min_u32 s71, s71, s51
s_add_u32 s78, s78, s71
s_lshl_b32 s78, s78, 3
s_lshl_b32 s78, s78, 2
s_add_u32 s78, s78, 0x5008000
v_and_b32 v3, 28, v21
buffer_load_dword v19, v3, s[4:7], s78 offen sc1
s_waitcnt vmcnt(16)
v_mfma_f32_16x16x32_bf16 v[164:167], v[106:109], v[32:35], 0
v_mfma_f32_16x16x32_bf16 v[172:175], v[104:107], v[32:35], 0
s_waitcnt vmcnt(15)
v_mfma_f32_16x16x32_bf16 v[164:167], v[106:109], v[36:39], v[164:167]
v_mfma_f32_16x16x32_bf16 v[172:175], v[104:107], v[36:39], v[172:175]
s_waitcnt vmcnt(14)
v_mfma_f32_16x16x32_bf16 v[164:167], v[106:109], v[40:43], v[164:167]
v_mfma_f32_16x16x32_bf16 v[172:175], v[104:107], v[40:43], v[172:175]
s_waitcnt vmcnt(13)
v_mfma_f32_16x16x32_bf16 v[164:167], v[106:109], v[44:47], v[164:167]
v_mfma_f32_16x16x32_bf16 v[172:175], v[104:107], v[44:47], v[172:175]
s_waitcnt vmcnt(12)
v_mfma_f32_16x16x32_bf16 v[164:167], v[106:109], v[48:51], v[164:167]
v_mfma_f32_16x16x32_bf16 v[172:175], v[104:107], v[48:51], v[172:175]
s_waitcnt vmcnt(11)
v_mfma_f32_16x16x32_bf16 v[164:167], v[106:109], v[52:55], v[164:167]
v_mfma_f32_16x16x32_bf16 v[172:175], v[104:107], v[52:55], v[172:175]
s_waitcnt vmcnt(10)
v_mfma_f32_16x16x32_bf16 v[164:167], v[106:109], v[56:59], v[164:167]
v_mfma_f32_16x16x32_bf16 v[172:175], v[104:107], v[56:59], v[172:175]
s_waitcnt vmcnt(9)
v_mfma_f32_16x16x32_bf16 v[164:167], v[106:109], v[60:63], v[164:167]
v_mfma_f32_16x16x32_bf16 v[172:175], v[104:107], v[60:63], v[172:175]
s_waitcnt vmcnt(7)
v_mfma_f32_16x16x32_bf16 v[180:183], v[112:115], v[132:135], 0
s_waitcnt vmcnt(5)
v_mfma_f32_16x16x32_bf16 v[180:183], v[112:115], v[140:143], v[180:183]
s_waitcnt vmcnt(3)
v_mfma_f32_16x16x32_bf16 v[180:183], v[112:115], v[148:151], v[180:183]
s_waitcnt vmcnt(1)
v_mfma_f32_16x16x32_bf16 v[180:183], v[112:115], v[156:159], v[180:183]
s_nop 7
s_lshl_b32 s64, s50, 3
s_add_u32 s64, s64, s51
s_mul_i32 s64, s64, 0x9000
s_mul_i32 s66, s52, 0x120
s_add_u32 s64, s64, s66
s_lshl_b32 s66, s48, 6
s_add_u32 s66, s66, s64
v_cvt_pk_bf16_f32 v168, v164, v165
v_cvt_pk_bf16_f32 v169, v166, v167
ds_bpermute_b32 v170, v15, v168
ds_bpermute_b32 v171, v15, v169
v_cvt_pk_bf16_f32 v176, v172, v173
v_cvt_pk_bf16_f32 v177, v174, v175
ds_bpermute_b32 v178, v15, v176
ds_bpermute_b32 v179, v15, v177
v_cvt_pk_bf16_f32 v184, v180, v181
v_cvt_pk_bf16_f32 v185, v182, v183
ds_bpermute_b32 v186, v15, v184
ds_bpermute_b32 v187, v15, v185
s_waitcnt lgkmcnt(6)
buffer_store_dwordx2 v[194:195], v16, s[40:43], s65 offen
buffer_store_dwordx2 v[202:203], v16, s[40:43], s65 offen offset:32
buffer_store_dwordx2 v[210:211], v16, s[40:43], s65 offen offset:64
buffer_store_dwordx2 v[218:219], v16, s[40:43], s65 offen offset:96
buffer_store_dwordx2 v[226:227], v16, s[40:43], s65 offen offset:128
s_waitcnt lgkmcnt(4)
buffer_store_dwordx2 v[170:171], v16, s[40:43], s66 offen
s_waitcnt lgkmcnt(2)
buffer_store_dwordx2 v[178:179], v16, s[40:43], s66 offen offset:32
s_waitcnt lgkmcnt(0)
buffer_store_dwordx2 v[186:187], v111, s[40:43], s64 offen offset:256
s_waitcnt vmcnt(8)
v_cmp_ne_u32 vcc, v19, v18
s_nop 1
s_cbranch_vccnz L_spin_pl
L_back_pl:
s_lshl_b32 s90, s50, 2
s_add_u32 s90, s90, s52
s_mul_i32 s90, s90, 0x50000
s_add_u32 s90, s90, 0x3a00000
s_mul_i32 s89, s51, 0xa000
s_add_u32 s90, s90, s89
s_lshl_b32 s89, s48, 10
s_add_u32 s89, s89, s90
s_add_u32 s90, s90, 0x1000
buffer_load_dwordx4 v[32:35], v1, s[4:7], s89 offen sc1
s_add_u32 s89, s89, 0x1400
buffer_load_dwordx4 v[36:39], v1, s[4:7], s89 offen sc1
s_add_u32 s89, s89, 0x1400
buffer_load_dwordx4 v[40:43], v1, s[4:7], s89 offen sc1
s_add_u32 s89, s89, 0x1400
buffer_load_dwordx4 v[44:47], v1, s[4:7], s89 offen sc1
s_add_u32 s89, s89, 0x1400
buffer_load_dwordx4 v[48:51], v1, s[4:7], s89 offen sc1
s_add_u32 s89, s89, 0x1400
buffer_load_dwordx4 v[52:55], v1, s[4:7], s89 offen sc1
s_add_u32 s89, s89, 0x1400
buffer_load_dwordx4 v[56:59], v1, s[4:7], s89 offen sc1
s_add_u32 s89, s89, 0x1400
buffer_load_dwordx4 v[60:63], v1, s[4:7], s89 offen sc1
s_add_u32 s89, s89, 0x1400
buffer_load_dwordx2 v[132:133], v110, s[4:7], s90 offen sc1
s_add_u32 s90, s90, 0x1400
buffer_load_dwordx2 v[134:135], v110, s[4:7], s90 offen sc1
s_add_u32 s90, s90, 0x1400
buffer_load_dwordx2 v[140:141], v110, s[4:7], s90 offen sc1
s_add_u32 s90, s90, 0x1400
buffer_load_dwordx2 v[142:143], v110, s[4:7], s90 offen sc1
s_add_u32 s90, s90, 0x1400
buffer_load_dwordx2 v[148:149], v110, s[4:7], s90 offen sc1
s_add_u32 s90, s90, 0x1400
buffer_load_dwordx2 v[150:151], v110, s[4:7], s90 offen sc1
s_add_u32 s90, s90, 0x1400
buffer_load_dwordx2 v[156:157], v110, s[4:7], s90 offen sc1
s_add_u32 s90, s90, 0x1400
buffer_load_dwordx2 v[158:159], v110, s[4:7], s90 offen sc1
s_add_u32 s90, s90, 0x1400
s_waitcnt vmcnt(15)
v_mfma_f32_16x16x32_bf16 v[164:167], v[106:109], v[32:35], 0
v_mfma_f32_16x16x32_bf16 v[172:175], v[104:107], v[32:35], 0
s_waitcnt vmcnt(14)
v_mfma_f32_16x16x32_bf16 v[164:167], v[106:109], v[36:39], v[164:167]
v_mfma_f32_16x16x32_bf16 v[172:175], v[104:107], v[36:39], v[172:175]
s_waitcnt vmcnt(13)
v_mfma_f32_16x16x32_bf16 v[164:167], v[106:109], v[40:43], v[164:167]
v_mfma_f32_16x16x32_bf16 v[172:175], v[104:107], v[40:43], v[172:175]
s_waitcnt vmcnt(12)
v_mfma_f32_16x16x32_bf16 v[164:167], v[106:109], v[44:47], v[164:167]
v_mfma_f32_16x16x32_bf16 v[172:175], v[104:107], v[44:47], v[172:175]
s_waitcnt vmcnt(11)
v_mfma_f32_16x16x32_bf16 v[164:167], v[106:109], v[48:51], v[164:167]
v_mfma_f32_16x16x32_bf16 v[172:175], v[104:107], v[48:51], v[172:175]
s_waitcnt vmcnt(10)
v_mfma_f32_16x16x32_bf16 v[164:167], v[106:109], v[52:55], v[164:167]
v_mfma_f32_16x16x32_bf16 v[172:175], v[104:107], v[52:55], v[172:175]
s_waitcnt vmcnt(9)
v_mfma_f32_16x16x32_bf16 v[164:167], v[106:109], v[56:59], v[164:167]
v_mfma_f32_16x16x32_bf16 v[172:175], v[104:107], v[56:59], v[172:175]
s_waitcnt vmcnt(8)
v_mfma_f32_16x16x32_bf16 v[164:167], v[106:109], v[60:63], v[164:167]
v_mfma_f32_16x16x32_bf16 v[172:175], v[104:107], v[60:63], v[172:175]
s_waitcnt vmcnt(6)
v_mfma_f32_16x16x32_bf16 v[180:183], v[112:115], v[132:135], 0
s_waitcnt vmcnt(4)
v_mfma_f32_16x16x32_bf16 v[180:183], v[112:115], v[140:143], v[180:183]
s_waitcnt vmcnt(2)
v_mfma_f32_16x16x32_bf16 v[180:183], v[112:115], v[148:151], v[180:183]
s_waitcnt vmcnt(0)
v_mfma_f32_16x16x32_bf16 v[180:183], v[112:115], v[156:159], v[180:183]
s_nop 7
s_lshl_b32 s67, s50, 3
s_sub_u32 s67, 0x78, s67
s_add_u32 s67, s67, s51
s_mul_i32 s67, s67, 0x9000
s_mul_i32 s68, s52, 0x120
s_add_u32 s67, s67, s68
s_lshl_b32 s68, s48, 6
s_add_u32 s68, s68, s67
v_cvt_pk_bf16_f32 v188, v164, v165
v_cvt_pk_bf16_f32 v189, v166, v167
ds_bpermute_b32 v190, v15, v188
ds_bpermute_b32 v191, v15, v189
v_cvt_pk_bf16_f32 v120, v172, v173
v_cvt_pk_bf16_f32 v121, v174, v175
ds_bpermute_b32 v122, v15, v120
ds_bpermute_b32 v123, v15, v121
v_cvt_pk_bf16_f32 v124, v180, v181
v_cvt_pk_bf16_f32 v125, v182, v183
ds_bpermute_b32 v126, v15, v124
ds_bpermute_b32 v127, v15, v125
s_waitcnt lgkmcnt(4)
buffer_store_dwordx2 v[190:191], v16, s[40:43], s68 offen
s_waitcnt lgkmcnt(2)
buffer_store_dwordx2 v[122:123], v16, s[40:43], s68 offen offset:32
s_waitcnt lgkmcnt(0)
buffer_store_dwordx2 v[126:127], v111, s[40:43], s67 offen offset:256
s_branch L_end
L_spin_cb:
s_mov_b32 s93, 0x8000
L_spinloop_cb:
buffer_load_dword v19, v3, s[4:7], s77 offen sc1
s_waitcnt vmcnt(0)
v_cmp_ne_u32 vcc, v19, v18
s_nop 1
s_cbranch_vccz L_back_cb
s_sub_u32 s93, s93, 1
s_cmp_lg_u32 s93, 0
s_cbranch_scc1 L_spinloop_cb
v_mov_b32 v19, 4
buffer_store_dword v19, v20, s[44:47], 0 offen offset:4
s_branch L_back_cb
L_spin_fo:
s_mov_b32 s93, 0x8000
L_spinloop_fo:
buffer_load_dword v19, v21, s[4:7], s78 offen sc1
s_waitcnt vmcnt(0)
v_cmp_ne_u32 vcc, v19, v18
s_nop 1
s_cbranch_vccz L_back_fo
s_sub_u32 s93, s93, 1
s_cmp_lg_u32 s93, 0
s_cbranch_scc1 L_spinloop_fo
v_mov_b32 v19, 6
buffer_store_dword v19, v20, s[44:47], 0 offen offset:4
s_branch L_back_fo
L_spin_pe:
s_mov_b32 s93, 0x8000
L_spinloop_pe:
buffer_load_dword v19, v3, s[4:7], s78 offen sc1
s_waitcnt vmcnt(0)
v_cmp_ne_u32 vcc, v19, v18
s_nop 1
s_cbranch_vccz L_back_pe
s_sub_u32 s93, s93, 1
s_cmp_lg_u32 s93, 0
s_cbranch_scc1 L_spinloop_pe
v_mov_b32 v19, 7
buffer_store_dword v19, v20, s[44:47], 0 offen offset:4
s_branch L_back_pe
L_spin_pl:
s_mov_b32 s93, 0x8000
L_spinloop_pl:
buffer_load_dword v19, v3, s[4:7], s78 offen sc1
s_waitcnt vmcnt(0)
v_cmp_ne_u32 vcc, v19, v18
s_nop 1
s_cbranch_vccz L_back_pl
s_sub_u32 s93, s93, 1
s_cmp_lg_u32 s93, 0
s_cbranch_scc1 L_spinloop_pl
v_mov_b32 v19, 8
buffer_store_dword v19, v20, s[44:47], 0 offen offset:4
s_branch L_back_pl
L_catch:
s_lshl_b32 s78, s53, 7
s_add_u32 s78, s78, 0x500a000
buffer_load_dword v19, v21, s[4:7], s78 offen sc1
s_waitcnt vmcnt(1)
buffer_store_dword v18, v20, s[4:7], s63 offen sc1
s_waitcnt vmcnt(1)
v_cmp_ne_u32 vcc, v19, v18
s_nop 1
s_cbranch_vccnz L_spin_fb2C
L_back_fb2C:
s_lshl_b32 s78, s53, 12
s_add_u32 s78, s78, 0x4e00000
buffer_load_dwordx4 v[64:67], v1, s[4:7], s78 offen sc1
buffer_load_dwordx4 v[68:71], v1, s[4:7], s78 offen offset:1024 sc1
buffer_load_dwordx4 v[80:83], v1, s[4:7], s78 offen offset:2048 sc1
s_mul_i32 s64, s51, 0x90000
s_mul_i32 s70, s52, 0x120
s_add_u32 s64, s64, s70
s_add_u32 s70, s48, 0
s_lshr_b32 s71, s70, 2
s_add_u32 s71, s71, s52
s_and_b32 s71, s71, 3
s_lshl_b32 s71, s71, 2
s_and_b32 s70, s70, 3
s_add_u32 s70, s70, s71
s_mul_i32 s70, s70, 0x9000
s_add_u32 s85, s64, s70
s_mul_i32 s67, s48, 0x2400
s_cmp_lt_u32 s48, 3
s_cselect_b32 s67, s67, 0x28000
s_cselect_b32 s85, s85, 0x40000000
s_add_u32 m0, s67, 0
s_nop 0
buffer_load_dwordx4 v4, s[32:35], s85 offen lds
s_add_u32 m0, s67, 0
s_nop 0
buffer_load_dwordx4 v5, s[32:35], s85 offen offset:1024 lds
s_add_u32 m0, s67, 0
s_nop 0
buffer_load_dwordx4 v6, s[32:35], s85 offen offset:2048 lds
s_add_u32 m0, s67, 0
s_nop 0
buffer_load_dwordx4 v7, s[32:35], s85 offen offset:3072 lds
s_add_u32 m0, s67, 0x1000
s_nop 0
buffer_load_dwordx4 v8, s[32:35], s85 offen lds
s_add_u32 m0, s67, 0x1000
s_nop 0
buffer_load_dwordx4 v9, s[32:35], s85 offen offset:1024 lds
s_add_u32 m0, s67, 0x1000
s_nop 0
buffer_load_dwordx4 v10, s[32:35], s85 offen offset:2048 lds
s_add_u32 m0, s67, 0x1000
s_nop 0
buffer_load_dwordx4 v11, s[32:35], s85 offen offset:3072 lds
s_add_u32 m0, s67, 0x2000
s_nop 0
buffer_load_dwordx4 v12, s[32:35], s85 offen lds
s_branch L_single_done
L_zero:
v_cmp_gt_i32_e64 s[80:81], 0, v27
v_cmp_gt_i32_e64 s[82:83], 1, v27
s_nop 0
v_cndmask_b32_e64 v120, v96, v29, s[80:81]
v_cndmask_b32_e64 v121, v96, v29, s[82:83]
v_cmp_gt_i32_e64 s[80:81], 2, v27
v_cmp_gt_i32_e64 s[82:83], 3, v27
s_nop 0
v_cndmask_b32_e64 v122, v96, v29, s[80:81]
v_cndmask_b32_e64 v123, v96, v29, s[82:83]
v_cmp_gt_i32_e64 s[80:81], 16, v27
v_cmp_gt_i32_e64 s[82:83], 17, v27
s_nop 0
v_cndmask_b32_e64 v124, v96, v29, s[80:81]
v_cndmask_b32_e64 v125, v96, v29, s[82:83]
v_cmp_gt_i32_e64 s[80:81], 18, v27
v_cmp_gt_i32_e64 s[82:83], 19, v27
s_nop 0
v_cndmask_b32_e64 v126, v96, v29, s[80:81]
v_cndmask_b32_e64 v127, v96, v29, s[82:83]
s_cmp_ge_u32 s48, 2
s_cbranch_scc1 L_ad0Y
L_ad0X:
v_mfma_f32_16x16x32_bf16 v[40:43], a[64:67], a[16:19], v[100:103]
s_sub_u32 s72, s72, 1
s_cbranch_scc1 L_fv9
L_back_fv9:
s_xor_b32 s75, s91, 0x10000
v_mfma_f32_16x16x32_bf16 v[40:43], a[68:71], a[20:23], v[40:43]
s_add_u32 m0, s75, s59
v_exp_f32 v60, v60
v_mfma_f32_16x16x32_bf16 v[40:43], a[72:75], a[24:27], v[40:43]
buffer_load_dwordx4 v1, s[4:7], s89 offen sc1 lds
ds_read_b128 a[96:99], v26 offset:16384
v_mfma_f32_16x16x32_bf16 v[40:43], a[76:79], a[28:31], v[40:43]
v_exp_f32 v61, v61
v_mfma_f32_16x16x32_bf16 v[44:47], a[92:95], a[28:31], v[100:103]
ds_read_b128 a[100:103], v26 offset:17408
v_cvt_pk_bf16_f32 v78, v60, v61
v_mfma_f32_16x16x32_bf16 v[44:47], a[88:91], a[24:27], v[44:47]
v_exp_f32 v62, v62
v_mfma_f32_16x16x32_bf16 v[44:47], a[84:87], a[20:23], v[44:47]
v_exp_f32 v63, v63
v_mfma_f32_16x16x32_bf16 v[44:47], a[80:83], a[16:19], v[44:47]
ds_read_b128 a[104:107], v26 offset:18432
v_cvt_pk_bf16_f32 v79, v62, v63
v_mfma_f32_16x16x32_bf16 v[48:51], a[64:67], a[32:35], v[104:107]
v_exp_f32 v40, v40
v_mfma_f32_16x16x32_bf16 v[48:51], a[68:71], a[36:39], v[48:51]
ds_read_b128 a[108:111], v26 offset:19456
v_mfma_f32_16x16x32_bf16 v[48:51], a[72:75], a[40:43], v[48:51]
v_exp_f32 v41, v41
v_mfma_f32_16x16x32_bf16 v[48:51], a[76:79], a[44:47], v[48:51]
v_cvt_pk_bf16_f32 v84, v40, v41
v_mfma_f32_16x16x32_bf16 v[52:55], a[92:95], a[44:47], v[104:107]
ds_read_b128 a[112:115], v26 offset:20480
v_mfma_f32_16x16x32_bf16 v[52:55], a[88:91], a[40:43], v[52:55]
v_exp_f32 v42, v42
v_mfma_f32_16x16x32_bf16 v[52:55], a[84:87], a[36:39], v[52:55]
buffer_load_dwordx4 v1, s[4:7], s89 offen offset:1024 sc1 lds
v_mfma_f32_16x16x32_bf16 v[52:55], a[80:83], a[32:35], v[52:55]
ds_read_b128 a[116:119], v26 offset:21504
v_mfma_f32_16x16x32_bf16 v[56:59], a[64:67], a[48:51], v[108:111]
v_exp_f32 v43, v43
v_mfma_f32_16x16x32_bf16 v[56:59], a[68:71], a[52:55], v[56:59]
v_cvt_pk_bf16_f32 v85, v42, v43
v_mfma_f32_16x16x32_bf16 v[56:59], a[72:75], a[56:59], v[56:59]
ds_read_b128 a[120:123], v26 offset:22528
v_mfma_f32_16x16x32_bf16 v[56:59], a[76:79], a[60:63], v[56:59]
v_exp_f32 v44, v44
v_mfma_f32_16x16x32_bf16 v[60:63], a[92:95], a[60:63], v[108:111]
v_exp_f32 v45, v45
v_mfma_f32_16x16x32_bf16 v[60:63], a[88:91], a[56:59], v[60:63]
ds_read_b128 a[124:127], v26 offset:23552
v_cvt_pk_bf16_f32 v86, v44, v45
v_mfma_f32_16x16x32_bf16 v[60:63], a[84:87], a[52:55], v[60:63]
v_exp_f32 v46, v46
v_mfma_f32_16x16x32_bf16 v[60:63], a[80:83], a[48:51], v[60:63]
s_waitcnt lgkmcnt(7)
ds_read_b128 a[64:67], v26
v_mfma_f32_16x16x32_bf16 v[128:131], a[96:99], v[64:67], 0
v_exp_f32 v47, v47
v_mfma_f32_16x16x32_bf16 v[160:163], a[96:99], v[68:71], 0
v_cvt_pk_bf16_f32 v87, v46, v47
v_mfma_f32_16x16x32_bf16 v[192:195], a[96:99], v[72:75], 0
v_exp_f32 v48, v48
v_mfma_f32_16x16x32_bf16 v[224:227], a[96:99], v[76:79], 0
s_waitcnt lgkmcnt(7)
buffer_load_dwordx4 v1, s[4:7], s89 offen offset:2048 sc1 lds
ds_read_b128 a[68:71], v26 offset:1024
v_mfma_f32_16x16x32_bf16 v[228:231], a[100:103], v[76:79], 0
v_exp_f32 v49, v49
v_mfma_f32_16x16x32_bf16 v[196:199], a[100:103], v[72:75], 0
v_cvt_pk_bf16_f32 v88, v48, v49
v_mfma_f32_16x16x32_bf16 v[164:167], a[100:103], v[68:71], 0
v_exp_f32 v50, v50
v_mfma_f32_16x16x32_bf16 v[132:135], a[100:103], v[64:67], 0
s_waitcnt lgkmcnt(7)
ds_read_b128 a[72:75], v26 offset:2048
v_mfma_f32_16x16x32_bf16 v[136:139], a[104:107], v[64:67], 0
v_exp_f32 v51, v51
v_mfma_f32_16x16x32_bf16 v[168:171], a[104:107], v[68:71], 0
v_cvt_pk_bf16_f32 v89, v50, v51
v_mfma_f32_16x16x32_bf16 v[200:203], a[104:107], v[72:75], 0
v_exp_f32 v52, v52
v_mfma_f32_16x16x32_bf16 v[232:235], a[104:107], v[76:79], 0
s_waitcnt lgkmcnt(7)
ds_read_b128 a[76:79], v26 offset:3072
v_mfma_f32_16x16x32_bf16 v[236:239], a[108:111], v[76:79], 0
v_exp_f32 v53, v53
v_mfma_f32_16x16x32_bf16 v[204:207], a[108:111], v[72:75], 0
v_cvt_pk_bf16_f32 v90, v52, v53
v_mfma_f32_16x16x32_bf16 v[172:175], a[108:111], v[68:71], 0
v_exp_f32 v54, v54
v_mfma_f32_16x16x32_bf16 v[140:143], a[108:111], v[64:67], 0
s_waitcnt lgkmcnt(7)
ds_read_b128 a[92:95], v26 offset:7168
v_mfma_f32_16x16x32_bf16 v[144:147], a[112:115], v[64:67], 0
s_lshl_b32 s76, s48, 13
s_add_u32 s76, s76, L_peel-L_pc
v_lshlrev_b32 v30, 7, v0
v_add_u32 v30, s76, v30
v_min_u32 v30, L_codeend-L_pc-4, v30
global_load_dword v24, v30, s[98:99]
v_mfma_f32_16x16x32_bf16 v[176:179], a[112:115], v[68:71], 0
buffer_load_dwordx4 v1, s[4:7], s89 offen offset:3072 sc1 lds
s_add_u32 s89, s89, 0x4000
v_mfma_f32_16x16x32_bf16 v[208:211], a[112:115], v[72:75], 0
v_exp_f32 v55, v55
v_mfma_f32_16x16x32_bf16 v[240:243], a[112:115], v[76:79], 0
s_waitcnt lgkmcnt(7)
ds_read_b128 a[88:91], v26 offset:6144
v_cvt_pk_bf16_f32 v91, v54, v55
v_mfma_f32_16x16x32_bf16 v[244:247], a[116:119], v[76:79], 0
v_add_u32 v30, L_table-L_pc, v1
global_load_dwordx4 v[4:7], v30, s[98:99]
v_mfma_f32_16x16x32_bf16 v[212:215], a[116:119], v[72:75], 0
v_exp_f32 v56, v56
v_mfma_f32_16x16x32_bf16 v[180:183], a[116:119], v[68:71], 0
v_exp_f32 v57, v57
v_mfma_f32_16x16x32_bf16 v[148:151], a[116:119], v[64:67], 0
s_waitcnt lgkmcnt(7)
ds_read_b128 a[84:87], v26 offset:5120
v_cvt_pk_bf16_f32 v92, v56, v57
v_mfma_f32_16x16x32_bf16 v[152:155], a[120:123], v[64:67], 0
v_exp_f32 v58, v58
v_mfma_f32_16x16x32_bf16 v[184:187], a[120:123], v[68:71], 0
v_add_u32 v30, L_table-L_pc, v1
global_load_dwordx4 v[8:11], v30, s[98:99] offset:1024
v_mfma_f32_16x16x32_bf16 v[216:219], a[120:123], v[72:75], 0
v_exp_f32 v59, v59
v_mfma_f32_16x16x32_bf16 v[248:251], a[120:123], v[76:79], 0
s_waitcnt lgkmcnt(7)
ds_read_b128 a[80:83], v26 offset:4096
v_cvt_pk_bf16_f32 v93, v58, v59
v_mfma_f32_16x16x32_bf16 v[252:255], a[124:127], v[76:79], 0
s_add_u32 m0, m0, 0x4000
v_exp_f32 v60, v60
v_mfma_f32_16x16x32_bf16 v[220:223], a[124:127], v[72:75], 0
buffer_load_dwordx4 v1, s[4:7], s90 offen sc1 lds
v_mfma_f32_16x16x32_bf16 v[188:191], a[124:127], v[68:71], 0
v_add_u32 v30, L_table-L_pc, v1
global_load_dwordx4 v[12:15], v30, s[98:99] offset:2048
v_mfma_f32_16x16x32_bf16 v[156:159], a[124:127], v[64:67], 0
v_exp_f32 v61, v61
v_mfma_f32_16x16x32_bf16 a[128:131], a[144:147], v[64:67], 0
v_cvt_pk_bf16_f32 v94, v60, v61
v_mfma_f32_16x16x32_bf16 a[132:135], a[144:147], v[68:71], 0
v_exp_f32 v62, v62
v_mfma_f32_16x16x32_bf16 a[136:139], a[144:147], v[72:75], 0
v_exp_f32 v63, v63
v_mfma_f32_16x16x32_bf16 a[140:143], a[144:147], v[76:79], 0
s_waitcnt lgkmcnt(4)
v_add_u32 v30, L_table-L_pc, v1
global_load_dword v16, v30, s[98:99] offset:3072
v_mfma_f32_16x16x32_bf16 v[40:43], a[64:67], a[16:19], v[100:103]
ds_read_b128 a[96:99], v26 offset:24576
v_cvt_pk_bf16_f32 v95, v62, v63
v_mfma_f32_16x16x32_bf16 v[40:43], a[68:71], a[20:23], v[40:43]
v_cmp_gt_i32_e64 s[80:81], 0, v28
v_cmp_gt_i32_e64 s[82:83], 1, v28
v_mfma_f32_16x16x32_bf16 v[40:43], a[72:75], a[24:27], v[40:43]
ds_read_b128 a[100:103], v26 offset:25600
v_mfma_f32_16x16x32_bf16 v[40:43], a[76:79], a[28:31], v[40:43]
s_waitcnt lgkmcnt(2)
v_mfma_f32_16x16x32_bf16 v[44:47], a[92:95], a[28:31], v[100:103]
v_mfma_f32_16x16x32_bf16 v[44:47], a[88:91], a[24:27], v[44:47]
buffer_load_dwordx4 v1, s[4:7], s90 offen offset:1024 sc1 lds
ds_read_b128 a[104:107], v26 offset:26624
v_mfma_f32_16x16x32_bf16 v[44:47], a[84:87], a[20:23], v[44:47]
v_mfma_f32_16x16x32_bf16 v[44:47], a[80:83], a[16:19], v[44:47]
v_mfma_f32_16x16x32_bf16 v[48:51], a[64:67], a[32:35], v[104:107]
v_accvgpr_read_b32 v32, a128
s_mov_b32 s76, 0x21800000
v_cmp_nle_f32_e64 s[94:95], s76, v32
s_mov_b32 s76, 0x5d800000
v_cmp_nge_f32 vcc, s76, v32
s_or_b64 vcc, vcc, s[94:95]
s_cbranch_scc1 L_slow0X0
L_back_slow0X0:
v_mfma_f32_16x16x32_bf16 v[48:51], a[68:71], a[36:39], v[48:51]
ds_read_b128 a[108:111], v26 offset:27648
v_accvgpr_read_b32 v32, a128
v_mfma_f32_16x16x32_bf16 v[48:51], a[72:75], a[40:43], v[48:51]
v_exp_f32 v40, v40
v_mfma_f32_16x16x32_bf16 v[48:51], a[76:79], a[44:47], v[48:51]
v_rcp_f32 v32, v32
s_nop 0
v_mfma_f32_16x16x32_bf16 v[52:55], a[92:95], a[44:47], v[104:107]
v_mul_f32 v128, v32, v128
v_mul_f32 v129, v32, v129
v_mfma_f32_16x16x32_bf16 v[52:55], a[88:91], a[40:43], v[52:55]
v_mul_f32 v130, v32, v130
v_mul_f32 v131, v32, v131
v_mfma_f32_16x16x32_bf16 v[52:55], a[84:87], a[36:39], v[52:55]
ds_read_b128 a[112:115], v26 offset:28672
v_mul_f32 v132, v32, v132
v_mfma_f32_16x16x32_bf16 v[52:55], a[80:83], a[32:35], v[52:55]
ds_read_b128 a[116:119], v26 offset:29696
v_mul_f32 v133, v32, v133
v_mfma_f32_16x16x32_bf16 v[56:59], a[64:67], a[48:51], v[108:111]
v_exp_f32 v41, v41
v_mfma_f32_16x16x32_bf16 v[56:59], a[68:71], a[52:55], v[56:59]
ds_read_b128 a[120:123], v26 offset:30720
v_mul_f32 v134, v32, v134
v_mfma_f32_16x16x32_bf16 v[56:59], a[72:75], a[56:59], v[56:59]
buffer_load_dwordx4 v1, s[4:7], s90 offen offset:2048 sc1 lds
v_mul_f32 v135, v32, v135
v_mfma_f32_16x16x32_bf16 v[56:59], a[76:79], a[60:63], v[56:59]
v_cvt_pk_bf16_f32 v68, v40, v41
v_mfma_f32_16x16x32_bf16 v[60:63], a[92:95], a[60:63], v[108:111]
ds_read_b128 a[124:127], v26 offset:31744
v_cvt_pk_bf16_f32 v128, v128, v129
v_mfma_f32_16x16x32_bf16 v[60:63], a[88:91], a[56:59], v[60:63]
v_cvt_pk_bf16_f32 v129, v130, v131
v_mfma_f32_16x16x32_bf16 v[60:63], a[84:87], a[52:55], v[60:63]
v_exp_f32 v42, v42
v_mfma_f32_16x16x32_bf16 v[60:63], a[80:83], a[48:51], v[60:63]
s_waitcnt lgkmcnt(6)
ds_read_b128 a[64:67], v26 offset:8192
v_cvt_pk_bf16_f32 v130, v132, v133
v_mfma_f32_16x16x32_bf16 v[160:163], a[96:99], v[84:87], v[160:163]
v_cvt_pk_bf16_f32 v131, v134, v135
v_mfma_f32_16x16x32_bf16 v[192:195], a[96:99], v[88:91], v[192:195]
v_exp_f32 v43, v43
v_mfma_f32_16x16x32_bf16 v[224:227], a[96:99], v[92:95], v[224:227]
buffer_store_dwordx4 v[128:131], v1, s[4:7], s55 offen sc1
ds_read_b128 a[68:71], v26 offset:9216
v_mfma_f32_16x16x32_bf16 v[228:231], a[100:103], v[92:95], v[228:231]
v_mul_f32 v136, v32, v136
v_cvt_pk_bf16_f32 v69, v42, v43
v_mfma_f32_16x16x32_bf16 v[196:199], a[100:103], v[88:91], v[196:199]
v_exp_f32 v44, v44
v_mfma_f32_16x16x32_bf16 v[164:167], a[100:103], v[84:87], v[164:167]
s_waitcnt lgkmcnt(6)
ds_read_b128 a[72:75], v26 offset:10240
v_mul_f32 v137, v32, v137
v_mfma_f32_16x16x32_bf16 v[168:171], a[104:107], v[84:87], v[168:171]
v_mul_f32 v138, v32, v138
v_mfma_f32_16x16x32_bf16 v[200:203], a[104:107], v[88:91], v[200:203]
buffer_load_dwordx4 v1, s[4:7], s90 offen offset:3072 sc1 lds
s_add_u32 s90, s90, 0x4000
v_mfma_f32_16x16x32_bf16 v[232:235], a[104:107], v[92:95], v[232:235]
ds_read_b128 a[76:79], v26 offset:11264
v_mul_f32 v139, v32, v139
v_mfma_f32_16x16x32_bf16 v[236:239], a[108:111], v[92:95], v[236:239]
v_mul_f32 v140, v32, v140
v_mfma_f32_16x16x32_bf16 v[204:207], a[108:111], v[88:91], v[204:207]
v_exp_f32 v45, v45
v_mfma_f32_16x16x32_bf16 v[172:175], a[108:111], v[84:87], v[172:175]
s_waitcnt lgkmcnt(7)
ds_read_b128 a[92:95], v26 offset:15360
v_mul_f32 v141, v32, v141
v_mfma_f32_16x16x32_bf16 v[176:179], a[112:115], v[84:87], v[176:179]
v_mul_f32 v142, v32, v142
v_cvt_pk_bf16_f32 v70, v44, v45
v_mfma_f32_16x16x32_bf16 v[208:211], a[112:115], v[88:91], v[208:211]
v_exp_f32 v46, v46
v_mfma_f32_16x16x32_bf16 v[240:243], a[112:115], v[92:95], v[240:243]
s_waitcnt lgkmcnt(6)
ds_read_b128 a[88:91], v26 offset:14336
v_mul_f32 v143, v32, v143
v_mfma_f32_16x16x32_bf16 v[244:247], a[116:119], v[92:95], v[244:247]
v_cvt_pk_bf16_f32 v136, v136, v137
v_mfma_f32_16x16x32_bf16 v[212:215], a[116:119], v[88:91], v[212:215]
v_exp_f32 v47, v47
v_mfma_f32_16x16x32_bf16 v[180:183], a[116:119], v[84:87], v[180:183]
ds_read_b128 a[84:87], v26 offset:13312
v_cvt_pk_bf16_f32 v137, v138, v139
v_mfma_f32_16x16x32_bf16 v[184:187], a[120:123], v[84:87], v[184:187]
v_cvt_pk_bf16_f32 v138, v140, v141
v_cvt_pk_bf16_f32 v71, v46, v47
v_mfma_f32_16x16x32_bf16 v[216:219], a[120:123], v[88:91], v[216:219]
s_waitcnt lgkmcnt(7)
v_exp_f32 v48, v48
v_mfma_f32_16x16x32_bf16 v[248:251], a[120:123], v[92:95], v[248:251]
s_add_u32 s91, s91, 0x8000
ds_read_b128 a[80:83], v26 offset:12288
v_cvt_pk_bf16_f32 v139, v142, v143
v_mfma_f32_16x16x32_bf16 v[252:255], a[124:127], v[92:95], v[252:255]
s_and_b32 s91, s91, 0x18000
buffer_store_dwordx4 v[136:139], v1, s[4:7], s55 offen offset:1024 sc1
v_mfma_f32_16x16x32_bf16 v[220:223], a[124:127], v[88:91], v[220:223]
v_exp_f32 v49, v49
v_mfma_f32_16x16x32_bf16 v[188:191], a[124:127], v[84:87], v[188:191]
v_mul_f32 v144, v32, v144
v_cvt_pk_bf16_f32 v72, v48, v49
v_mfma_f32_16x16x32_bf16 a[132:135], a[144:147], v[84:87], a[132:135]
s_nop 0
v_cndmask_b32_e64 v112, v100, v29, s[80:81]
v_cndmask_b32_e64 v113, v100, v29, s[82:83]
v_cmp_gt_i32_e64 s[80:81], 2, v28
v_cmp_gt_i32_e64 s[82:83], 3, v28
s_nop 0
v_cndmask_b32_e64 v114, v100, v29, s[80:81]
v_cndmask_b32_e64 v115, v100, v29, s[82:83]
v_cmp_gt_i32_e64 s[80:81], 16, v28
v_cmp_gt_i32_e64 s[82:83], 17, v28
s_nop 0
v_cndmask_b32_e64 v116, v100, v29, s[80:81]
v_cndmask_b32_e64 v117, v100, v29, s[82:83]
v_cmp_gt_i32_e64 s[80:81], 18, v28
v_cmp_gt_i32_e64 s[82:83], 19, v28
s_nop 0
v_cndmask_b32_e64 v118, v100, v29, s[80:81]
v_cndmask_b32_e64 v119, v100, v29, s[82:83]
s_waitcnt vmcnt(16)
s_barrier
v_mfma_f32_16x16x32_bf16 a[136:139], a[144:147], v[88:91], a[136:139]
s_waitcnt lgkmcnt(5)
v_add_u32 v26, s91, v2
v_mul_f32 v145, v32, v145
v_mfma_f32_16x16x32_bf16 a[140:143], a[144:147], v[92:95], a[140:143]
s_sub_u32 s72, s72, 1
s_cbranch_scc1 L_fv10
L_back_fv10:
v_mfma_f32_16x16x32_bf16 v[40:43], a[64:67], a[16:19], v[112:115]
s_xor_b32 s75, s91, 0x10000
v_mul_f32 v146, v32, v146
v_mul_f32 v147, v32, v147
v_mfma_f32_16x16x32_bf16 v[40:43], a[68:71], a[20:23], v[40:43]
s_add_u32 m0, s75, s59
v_exp_f32 v50, v50
v_mfma_f32_16x16x32_bf16 v[40:43], a[72:75], a[24:27], v[40:43]
s_waitcnt lgkmcnt(2)
v_exp_f32 v51, v51
v_mfma_f32_16x16x32_bf16 v[40:43], a[76:79], a[28:31], v[40:43]
v_mul_f32 v148, v32, v148
v_cvt_pk_bf16_f32 v73, v50, v51
v_mfma_f32_16x16x32_bf16 v[44:47], a[92:95], a[28:31], v[116:119]
buffer_load_dwordx4 v1, s[4:7], s89 offen sc1 lds
v_mul_f32 v149, v32, v149
v_mfma_f32_16x16x32_bf16 v[44:47], a[88:91], a[24:27], v[44:47]
s_waitcnt lgkmcnt(0)
v_exp_f32 v52, v52
v_mfma_f32_16x16x32_bf16 v[44:47], a[84:87], a[20:23], v[44:47]
v_exp_f32 v53, v53
v_mfma_f32_16x16x32_bf16 v[44:47], a[80:83], a[16:19], v[44:47]
v_mul_f32 v150, v32, v150
v_cvt_pk_bf16_f32 v74, v52, v53
v_mfma_f32_16x16x32_bf16 v[48:51], a[64:67], a[32:35], v[104:107]
v_exp_f32 v54, v54
v_mfma_f32_16x16x32_bf16 v[48:51], a[68:71], a[36:39], v[48:51]
v_exp_f32 v55, v55
v_mfma_f32_16x16x32_bf16 v[48:51], a[72:75], a[40:43], v[48:51]
v_mul_f32 v151, v32, v151
v_cvt_pk_bf16_f32 v75, v54, v55
v_mfma_f32_16x16x32_bf16 v[48:51], a[76:79], a[44:47], v[48:51]
v_cvt_pk_bf16_f32 v144, v144, v145
v_cvt_pk_bf16_f32 v145, v146, v147
v_mfma_f32_16x16x32_bf16 v[52:55], a[92:95], a[44:47], v[104:107]
v_exp_f32 v56, v56
v_mfma_f32_16x16x32_bf16 v[52:55], a[88:91], a[40:43], v[52:55]
v_exp_f32 v57, v57
v_mfma_f32_16x16x32_bf16 v[52:55], a[84:87], a[36:39], v[52:55]
v_cvt_pk_bf16_f32 v76, v56, v57
v_exp_f32 v58, v58
v_exp_f32 v59, v59
v_mfma_f32_16x16x32_bf16 v[52:55], a[80:83], a[32:35], v[52:55]
v_cvt_pk_bf16_f32 v77, v58, v59
v_cvt_pk_bf16_f32 v146, v148, v149
v_mfma_f32_16x16x32_bf16 v[56:59], a[64:67], a[48:51], v[108:111]
ds_read_b128 a[96:99], v26 offset:16384
v_cvt_pk_bf16_f32 v147, v150, v151
v_mfma_f32_16x16x32_bf16 v[56:59], a[68:71], a[52:55], v[56:59]
buffer_load_dwordx4 v1, s[4:7], s89 offen offset:1024 sc1 lds
v_exp_f32 v60, v60
v_exp_f32 v61, v61
v_mfma_f32_16x16x32_bf16 v[56:59], a[72:75], a[56:59], v[56:59]
buffer_store_dwordx4 v[144:147], v1, s[4:7], s55 offen offset:2048 sc1
v_cvt_pk_bf16_f32 v78, v60, v61
v_exp_f32 v62, v62
v_exp_f32 v63, v63
v_mfma_f32_16x16x32_bf16 v[56:59], a[76:79], a[60:63], v[56:59]
v_cvt_pk_bf16_f32 v79, v62, v63
v_mul_f32 v152, v32, v152
v_mfma_f32_16x16x32_bf16 v[60:63], a[92:95], a[60:63], v[108:111]
ds_read_b128 a[100:103], v26 offset:17408
v_mul_f32 v153, v32, v153
v_mfma_f32_16x16x32_bf16 v[60:63], a[88:91], a[56:59], v[60:63]
ds_read_b128 a[104:107], v26 offset:18432
v_mul_f32 v154, v32, v154
v_mfma_f32_16x16x32_bf16 v[60:63], a[84:87], a[52:55], v[60:63]
v_mul_f32 v155, v32, v155
v_mul_f32 v156, v32, v156
v_mfma_f32_16x16x32_bf16 v[60:63], a[80:83], a[48:51], v[60:63]
s_waitcnt lgkmcnt(2)
ds_read_b128 a[108:111], v26 offset:19456
v_mul_f32 v157, v32, v157
v_mfma_f32_16x16x32_bf16 v[160:163], a[96:99], v[68:71], v[160:163]
buffer_load_dwordx4 v1, s[4:7], s89 offen offset:2048 sc1 lds
v_mul_f32 v158, v32, v158
v_mfma_f32_16x16x32_bf16 v[192:195], a[96:99], v[72:75], v[192:195]
ds_read_b128 a[112:115], v26 offset:20480
v_mul_f32 v159, v32, v159
v_mfma_f32_16x16x32_bf16 v[224:227], a[96:99], v[76:79], v[224:227]
s_waitcnt lgkmcnt(3)
ds_read_b128 a[116:119], v26 offset:21504
v_mov_b32 v120, v104
v_mfma_f32_16x16x32_bf16 v[228:231], a[100:103], v[76:79], v[228:231]
ds_read_b128 a[120:123], v26 offset:22528
v_cvt_pk_bf16_f32 v152, v152, v153
v_mfma_f32_16x16x32_bf16 v[196:199], a[100:103], v[72:75], v[196:199]
ds_read_b128 a[124:127], v26 offset:23552
v_cvt_pk_bf16_f32 v153, v154, v155
v_mfma_f32_16x16x32_bf16 v[164:167], a[100:103], v[68:71], v[164:167]
s_waitcnt lgkmcnt(5)
v_mov_b32 v121, v104
v_mov_b32 v122, v104
v_mfma_f32_16x16x32_bf16 v[168:171], a[104:107], v[68:71], v[168:171]
v_cvt_pk_bf16_f32 v154, v156, v157
v_mov_b32 v123, v104
v_mfma_f32_16x16x32_bf16 v[200:203], a[104:107], v[72:75], v[200:203]
v_cvt_pk_bf16_f32 v155, v158, v159
v_mov_b32 v124, v104
v_mfma_f32_16x16x32_bf16 v[232:235], a[104:107], v[76:79], v[232:235]
s_waitcnt lgkmcnt(4)
v_mov_b32 v125, v104
v_mov_b32 v126, v104
v_mfma_f32_16x16x32_bf16 v[236:239], a[108:111], v[76:79], v[236:239]
buffer_store_dwordx4 v[152:155], v1, s[4:7], s55 offen offset:3072 sc1
buffer_load_dwordx4 v1, s[4:7], s89 offen offset:3072 sc1 lds
s_add_u32 s89, s89, 0x4000
v_mfma_f32_16x16x32_bf16 v[204:207], a[108:111], v[72:75], v[204:207]
ds_read_b128 a[64:67], v26
v_mov_b32 v127, v104
v_mfma_f32_16x16x32_bf16 v[172:175], a[108:111], v[68:71], v[172:175]
s_waitcnt lgkmcnt(3)
v_exp_f32 v40, v40
v_mfma_f32_16x16x32_bf16 v[176:179], a[112:115], v[68:71], v[176:179]
v_exp_f32 v41, v41
v_mfma_f32_16x16x32_bf16 v[208:211], a[112:115], v[72:75], v[208:211]
ds_read_b128 a[68:71], v26 offset:1024
v_cvt_pk_bf16_f32 v84, v40, v41
v_mfma_f32_16x16x32_bf16 v[240:243], a[112:115], v[76:79], v[240:243]
v_exp_f32 v42, v42
v_mfma_f32_16x16x32_bf16 v[244:247], a[116:119], v[76:79], v[244:247]
v_exp_f32 v43, v43
v_mfma_f32_16x16x32_bf16 v[212:215], a[116:119], v[72:75], v[212:215]
ds_read_b128 a[72:75], v26 offset:2048
v_cvt_pk_bf16_f32 v85, v42, v43
v_mfma_f32_16x16x32_bf16 v[180:183], a[116:119], v[68:71], v[180:183]
s_waitcnt lgkmcnt(3)
v_exp_f32 v44, v44
v_mfma_f32_16x16x32_bf16 v[184:187], a[120:123], v[68:71], v[184:187]
v_exp_f32 v45, v45
v_mfma_f32_16x16x32_bf16 v[216:219], a[120:123], v[72:75], v[216:219]
s_add_u32 m0, m0, 0x4000
ds_read_b128 a[76:79], v26 offset:3072
v_cvt_pk_bf16_f32 v86, v44, v45
v_mfma_f32_16x16x32_bf16 v[248:251], a[120:123], v[76:79], v[248:251]
v_exp_f32 v46, v46
v_mfma_f32_16x16x32_bf16 v[252:255], a[124:127], v[76:79], v[252:255]
v_exp_f32 v47, v47
v_mfma_f32_16x16x32_bf16 v[220:223], a[124:127], v[72:75], v[220:223]
ds_read_b128 a[92:95], v26 offset:7168
v_cvt_pk_bf16_f32 v87, v46, v47
v_mfma_f32_16x16x32_bf16 v[188:191], a[124:127], v[68:71], v[188:191]
v_exp_f32 v48, v48
v_mfma_f32_16x16x32_bf16 a[132:135], a[144:147], v[68:71], a[132:135]
v_exp_f32 v49, v49
v_mfma_f32_16x16x32_bf16 a[136:139], a[144:147], v[72:75], a[136:139]
ds_read_b128 a[88:91], v26 offset:6144
buffer_load_dwordx4 v1, s[4:7], s90 offen sc1 lds
v_cvt_pk_bf16_f32 v88, v48, v49
v_exp_f32 v50, v50
v_exp_f32 v51, v51
v_mfma_f32_16x16x32_bf16 a[140:143], a[144:147], v[76:79], a[140:143]
s_waitcnt lgkmcnt(3)
ds_read_b128 a[84:87], v26 offset:5120
v_cvt_pk_bf16_f32 v89, v50, v51
v_mfma_f32_16x16x32_bf16 v[48:51], a[64:67], a[32:35], v[120:123]
ds_read_b128 a[80:83], v26 offset:4096
v_mfma_f32_16x16x32_bf16 v[48:51], a[68:71], a[36:39], v[48:51]
v_exp_f32 v52, v52
v_exp_f32 v53, v53
v_mfma_f32_16x16x32_bf16 v[48:51], a[72:75], a[40:43], v[48:51]
s_waitcnt lgkmcnt(4)
v_cvt_pk_bf16_f32 v90, v52, v53
v_exp_f32 v54, v54
v_exp_f32 v55, v55
v_mfma_f32_16x16x32_bf16 v[48:51], a[76:79], a[44:47], v[48:51]
s_waitcnt lgkmcnt(3)
ds_read_b128 a[96:99], v26 offset:24576
v_cvt_pk_bf16_f32 v91, v54, v55
v_mfma_f32_16x16x32_bf16 v[52:55], a[92:95], a[44:47], v[124:127]
s_waitcnt lgkmcnt(3)
v_exp_f32 v56, v56
v_mfma_f32_16x16x32_bf16 v[52:55], a[88:91], a[40:43], v[52:55]
s_waitcnt lgkmcnt(2)
v_exp_f32 v57, v57
v_mfma_f32_16x16x32_bf16 v[52:55], a[84:87], a[36:39], v[52:55]
s_waitcnt lgkmcnt(1)
v_cvt_pk_bf16_f32 v92, v56, v57
v_exp_f32 v58, v58
v_exp_f32 v59, v59
v_mfma_f32_16x16x32_bf16 v[52:55], a[80:83], a[32:35], v[52:55]
buffer_load_dwordx4 v1, s[4:7], s90 offen offset:1024 sc1 lds
v_cvt_pk_bf16_f32 v93, v58, v59
v_mfma_f32_16x16x32_bf16 v[56:59], a[64:67], a[48:51], v[108:111]
v_exp_f32 v60, v60
v_mfma_f32_16x16x32_bf16 v[56:59], a[68:71], a[52:55], v[56:59]
v_exp_f32 v61, v61
v_mfma_f32_16x16x32_bf16 v[56:59], a[72:75], a[56:59], v[56:59]
v_cvt_pk_bf16_f32 v94, v60, v61
v_exp_f32 v62, v62
v_exp_f32 v63, v63
v_mfma_f32_16x16x32_bf16 v[56:59], a[76:79], a[60:63], v[56:59]
ds_read_b128 a[100:103], v26 offset:25600
v_cvt_pk_bf16_f32 v95, v62, v63
v_mfma_f32_16x16x32_bf16 v[60:63], a[92:95], a[60:63], v[108:111]
ds_read_b128 a[104:107], v26 offset:26624
v_mfma_f32_16x16x32_bf16 v[60:63], a[88:91], a[56:59], v[60:63]
ds_read_b128 a[108:111], v26 offset:27648
v_mfma_f32_16x16x32_bf16 v[60:63], a[84:87], a[52:55], v[60:63]
buffer_load_dwordx4 v1, s[4:7], s90 offen offset:2048 sc1 lds
ds_read_b128 a[112:115], v26 offset:28672
v_mfma_f32_16x16x32_bf16 v[60:63], a[80:83], a[48:51], v[60:63]
s_waitcnt lgkmcnt(4)
ds_read_b128 a[116:119], v26 offset:29696
v_mfma_f32_16x16x32_bf16 v[160:163], a[96:99], v[84:87], v[160:163]
ds_read_b128 a[120:123], v26 offset:30720
v_mfma_f32_16x16x32_bf16 v[192:195], a[96:99], v[88:91], v[192:195]
ds_read_b128 a[124:127], v26 offset:31744
v_mfma_f32_16x16x32_bf16 v[224:227], a[96:99], v[92:95], v[224:227]
s_waitcnt lgkmcnt(6)
v_exp_f32 v48, v48
v_mfma_f32_16x16x32_bf16 v[228:231], a[100:103], v[92:95], v[228:231]
v_exp_f32 v49, v49
v_mfma_f32_16x16x32_bf16 v[196:199], a[100:103], v[88:91], v[196:199]
ds_read_b128 a[64:67], v26 offset:8192
v_cvt_pk_bf16_f32 v72, v48, v49
v_mfma_f32_16x16x32_bf16 v[164:167], a[100:103], v[84:87], v[164:167]
s_waitcnt lgkmcnt(5)
v_exp_f32 v50, v50
v_mfma_f32_16x16x32_bf16 v[168:171], a[104:107], v[84:87], v[168:171]
v_exp_f32 v51, v51
v_mfma_f32_16x16x32_bf16 v[200:203], a[104:107], v[88:91], v[200:203]
ds_read_b128 a[68:71], v26 offset:9216
v_cvt_pk_bf16_f32 v73, v50, v51
v_mfma_f32_16x16x32_bf16 v[232:235], a[104:107], v[92:95], v[232:235]
v_exp_f32 v52, v52
v_mfma_f32_16x16x32_bf16 v[236:239], a[108:111], v[92:95], v[236:239]
buffer_load_dwordx4 v1, s[4:7], s90 offen offset:3072 sc1 lds
s_add_u32 s90, s90, 0x4000
ds_read_b128 a[72:75], v26 offset:10240
v_mfma_f32_16x16x32_bf16 v[204:207], a[108:111], v[88:91], v[204:207]
v_exp_f32 v53, v53
v_mfma_f32_16x16x32_bf16 v[172:175], a[108:111], v[84:87], v[172:175]
s_waitcnt lgkmcnt(5)
ds_read_b128 a[76:79], v26 offset:11264
v_cvt_pk_bf16_f32 v74, v52, v53
v_mfma_f32_16x16x32_bf16 v[176:179], a[112:115], v[84:87], v[176:179]
v_exp_f32 v54, v54
v_mfma_f32_16x16x32_bf16 v[208:211], a[112:115], v[88:91], v[208:211]
v_exp_f32 v55, v55
v_mfma_f32_16x16x32_bf16 v[240:243], a[112:115], v[92:95], v[240:243]
ds_read_b128 a[92:95], v26 offset:15360
v_cvt_pk_bf16_f32 v75, v54, v55
v_mfma_f32_16x16x32_bf16 v[244:247], a[116:119], v[92:95], v[244:247]
ds_read_b128 a[88:91], v26 offset:14336
v_mfma_f32_16x16x32_bf16 v[212:215], a[116:119], v[88:91], v[212:215]
v_exp_f32 v56, v56
v_mfma_f32_16x16x32_bf16 v[180:183], a[116:119], v[84:87], v[180:183]
s_waitcnt lgkmcnt(6)
ds_read_b128 a[84:87], v26 offset:13312
v_mfma_f32_16x16x32_bf16 v[184:187], a[120:123], v[84:87], v[184:187]
v_exp_f32 v57, v57
v_mfma_f32_16x16x32_bf16 v[216:219], a[120:123], v[88:91], v[216:219]
v_cvt_pk_bf16_f32 v76, v56, v57
v_mfma_f32_16x16x32_bf16 v[248:251], a[120:123], v[92:95], v[248:251]
s_add_u32 s91, s91, 0x8000
ds_read_b128 a[80:83], v26 offset:12288
v_mfma_f32_16x16x32_bf16 v[252:255], a[124:127], v[92:95], v[252:255]
s_and_b32 s91, s91, 0x18000
v_exp_f32 v58, v58
v_mfma_f32_16x16x32_bf16 v[220:223], a[124:127], v[88:91], v[220:223]
v_exp_f32 v59, v59
v_mfma_f32_16x16x32_bf16 v[188:191], a[124:127], v[84:87], v[188:191]
v_cmp_gt_i32_e64 s[80:81], 0, v28
v_cmp_gt_i32_e64 s[82:83], 1, v28
v_mfma_f32_16x16x32_bf16 a[132:135], a[144:147], v[84:87], a[132:135]
s_waitcnt vmcnt(11)
s_barrier
v_mfma_f32_16x16x32_bf16 a[136:139], a[144:147], v[88:91], a[136:139]
v_cvt_pk_bf16_f32 v77, v58, v59
v_add_u32 v26, s91, v2
v_mfma_f32_16x16x32_bf16 a[140:143], a[144:147], v[92:95], a[140:143]
s_nop 0
v_cndmask_b32_e64 v112, v108, v29, s[80:81]
v_cndmask_b32_e64 v113, v108, v29, s[82:83]
v_cmp_gt_i32_e64 s[80:81], 2, v28
v_cmp_gt_i32_e64 s[82:83], 3, v28
s_nop 0
v_cndmask_b32_e64 v114, v108, v29, s[80:81]
v_cndmask_b32_e64 v115, v108, v29, s[82:83]
v_cmp_gt_i32_e64 s[80:81], 16, v28
v_cmp_gt_i32_e64 s[82:83], 17, v28
s_nop 0
v_cndmask_b32_e64 v116, v108, v29, s[80:81]
v_cndmask_b32_e64 v117, v108, v29, s[82:83]
v_cmp_gt_i32_e64 s[80:81], 18, v28
v_cmp_gt_i32_e64 s[82:83], 19, v28
s_nop 0
v_cndmask_b32_e64 v118, v108, v29, s[80:81]
v_cndmask_b32_e64 v119, v108, v29, s[82:83]
s_nop 7
v_accvgpr_read_b32 v40, a132
s_mov_b32 s76, 0x21800000
v_cmp_nle_f32_e64 s[94:95], s76, v40
s_mov_b32 s76, 0x5d800000
v_cmp_nge_f32 vcc, s76, v40
s_or_b64 vcc, vcc, s[94:95]
s_cbranch_scc1 L_slow1X0
L_back_slow1X0:
v_accvgpr_read_b32 v40, a132
v_rcp_f32 v40, v40
s_nop 0
v_pk_mul_f32 v[160:161], v[160:161], v[40:41] op_sel_hi:[1,0]
v_pk_mul_f32 v[162:163], v[162:163], v[40:41] op_sel_hi:[1,0]
v_pk_mul_f32 v[164:165], v[164:165], v[40:41] op_sel_hi:[1,0]
v_pk_mul_f32 v[166:167], v[166:167], v[40:41] op_sel_hi:[1,0]
v_cvt_pk_bf16_f32 v160, v160, v161
v_cvt_pk_bf16_f32 v161, v162, v163
v_cvt_pk_bf16_f32 v162, v164, v165
v_cvt_pk_bf16_f32 v163, v166, v167
buffer_store_dwordx4 v[160:163], v1, s[4:7], s56 offen sc1
v_pk_mul_f32 v[168:169], v[168:169], v[40:41] op_sel_hi:[1,0]
v_pk_mul_f32 v[170:171], v[170:171], v[40:41] op_sel_hi:[1,0]
v_pk_mul_f32 v[172:173], v[172:173], v[40:41] op_sel_hi:[1,0]
v_pk_mul_f32 v[174:175], v[174:175], v[40:41] op_sel_hi:[1,0]
v_cvt_pk_bf16_f32 v168, v168, v169
v_cvt_pk_bf16_f32 v169, v170, v171
v_cvt_pk_bf16_f32 v170, v172, v173
v_cvt_pk_bf16_f32 v171, v174, v175
buffer_store_dwordx4 v[168:171], v1, s[4:7], s56 offen offset:1024 sc1
v_pk_mul_f32 v[176:177], v[176:177], v[40:41] op_sel_hi:[1,0]
v_pk_mul_f32 v[178:179], v[178:179], v[40:41] op_sel_hi:[1,0]
v_pk_mul_f32 v[180:181], v[180:181], v[40:41] op_sel_hi:[1,0]
v_pk_mul_f32 v[182:183], v[182:183], v[40:41] op_sel_hi:[1,0]
v_cvt_pk_bf16_f32 v176, v176, v177
v_cvt_pk_bf16_f32 v177, v178, v179
v_cvt_pk_bf16_f32 v178, v180, v181
v_cvt_pk_bf16_f32 v179, v182, v183
buffer_store_dwordx4 v[176:179], v1, s[4:7], s56 offen offset:2048 sc1
v_pk_mul_f32 v[184:185], v[184:185], v[40:41] op_sel_hi:[1,0]
v_pk_mul_f32 v[186:187], v[186:187], v[40:41] op_sel_hi:[1,0]
v_pk_mul_f32 v[188:189], v[188:189], v[40:41] op_sel_hi:[1,0]
v_pk_mul_f32 v[190:191], v[190:191], v[40:41] op_sel_hi:[1,0]
v_cvt_pk_bf16_f32 v184, v184, v185
v_cvt_pk_bf16_f32 v185, v186, v187
v_cvt_pk_bf16_f32 v186, v188, v189
v_cvt_pk_bf16_f32 v187, v190, v191
buffer_store_dwordx4 v[184:187], v1, s[4:7], s56 offen offset:3072 sc1
s_branch L_single_entry
L_ad0Y:
v_mfma_f32_16x16x32_bf16 v[32:35], a[64:67], a[0:3], v[120:123]
s_sub_u32 s72, s72, 1
s_cbranch_scc1 L_fv11
L_back_fv11:
s_xor_b32 s75, s91, 0x10000
v_mfma_f32_16x16x32_bf16 v[32:35], a[68:71], a[4:7], v[32:35]
s_add_u32 m0, s75, s59
v_exp_f32 v60, v60
v_mfma_f32_16x16x32_bf16 v[32:35], a[72:75], a[8:11], v[32:35]
buffer_load_dwordx4 v1, s[4:7], s89 offen sc1 lds
ds_read_b128 a[96:99], v26 offset:16384
v_mfma_f32_16x16x32_bf16 v[32:35], a[76:79], a[12:15], v[32:35]
v_exp_f32 v61, v61
v_mfma_f32_16x16x32_bf16 v[36:39], a[92:95], a[12:15], v[124:127]
ds_read_b128 a[100:103], v26 offset:17408
v_cvt_pk_bf16_f32 v78, v60, v61
v_mfma_f32_16x16x32_bf16 v[36:39], a[88:91], a[8:11], v[36:39]
v_exp_f32 v62, v62
v_mfma_f32_16x16x32_bf16 v[36:39], a[84:87], a[4:7], v[36:39]
v_exp_f32 v63, v63
v_mfma_f32_16x16x32_bf16 v[36:39], a[80:83], a[0:3], v[36:39]
v_cvt_pk_bf16_f32 v79, v62, v63
v_mfma_f32_16x16x32_bf16 v[40:43], a[64:67], a[16:19], v[100:103]
ds_read_b128 a[104:107], v26 offset:18432
v_mfma_f32_16x16x32_bf16 v[40:43], a[68:71], a[20:23], v[40:43]
v_exp_f32 v32, v32
v_mfma_f32_16x16x32_bf16 v[40:43], a[72:75], a[24:27], v[40:43]
v_exp_f32 v33, v33
v_mfma_f32_16x16x32_bf16 v[40:43], a[76:79], a[28:31], v[40:43]
v_cvt_pk_bf16_f32 v80, v32, v33
v_mfma_f32_16x16x32_bf16 v[44:47], a[92:95], a[28:31], v[100:103]
ds_read_b128 a[108:111], v26 offset:19456
v_mfma_f32_16x16x32_bf16 v[44:47], a[88:91], a[24:27], v[44:47]
v_exp_f32 v34, v34
v_mfma_f32_16x16x32_bf16 v[44:47], a[84:87], a[20:23], v[44:47]
v_exp_f32 v35, v35
v_mfma_f32_16x16x32_bf16 v[44:47], a[80:83], a[16:19], v[44:47]
v_cvt_pk_bf16_f32 v81, v34, v35
v_mfma_f32_16x16x32_bf16 v[48:51], a[64:67], a[32:35], v[104:107]
buffer_load_dwordx4 v1, s[4:7], s89 offen offset:1024 sc1 lds
ds_read_b128 a[112:115], v26 offset:20480
v_mfma_f32_16x16x32_bf16 v[48:51], a[68:71], a[36:39], v[48:51]
v_exp_f32 v36, v36
v_mfma_f32_16x16x32_bf16 v[48:51], a[72:75], a[40:43], v[48:51]
v_exp_f32 v37, v37
v_mfma_f32_16x16x32_bf16 v[48:51], a[76:79], a[44:47], v[48:51]
v_cvt_pk_bf16_f32 v82, v36, v37
v_mfma_f32_16x16x32_bf16 v[52:55], a[92:95], a[44:47], v[104:107]
ds_read_b128 a[116:119], v26 offset:21504
v_mfma_f32_16x16x32_bf16 v[52:55], a[88:91], a[40:43], v[52:55]
v_exp_f32 v38, v38
v_mfma_f32_16x16x32_bf16 v[52:55], a[84:87], a[36:39], v[52:55]
v_exp_f32 v39, v39
v_mfma_f32_16x16x32_bf16 v[52:55], a[80:83], a[32:35], v[52:55]
v_cmp_gt_i32_e64 s[80:81], 0, v28
v_cmp_gt_i32_e64 s[82:83], 1, v28
v_mfma_f32_16x16x32_bf16 v[56:59], a[64:67], a[48:51], v[108:111]
ds_read_b128 a[120:123], v26 offset:22528
v_cvt_pk_bf16_f32 v83, v38, v39
v_mfma_f32_16x16x32_bf16 v[56:59], a[68:71], a[52:55], v[56:59]
v_exp_f32 v40, v40
v_mfma_f32_16x16x32_bf16 v[56:59], a[72:75], a[56:59], v[56:59]
v_exp_f32 v41, v41
v_mfma_f32_16x16x32_bf16 v[56:59], a[76:79], a[60:63], v[56:59]
v_cvt_pk_bf16_f32 v84, v40, v41
v_mfma_f32_16x16x32_bf16 v[60:63], a[92:95], a[60:63], v[108:111]
ds_read_b128 a[124:127], v26 offset:23552
v_mfma_f32_16x16x32_bf16 v[60:63], a[88:91], a[56:59], v[60:63]
v_exp_f32 v42, v42
v_mfma_f32_16x16x32_bf16 v[60:63], a[84:87], a[52:55], v[60:63]
v_exp_f32 v43, v43
v_mfma_f32_16x16x32_bf16 v[60:63], a[80:83], a[48:51], v[60:63]
s_waitcnt lgkmcnt(7)
buffer_load_dwordx4 v1, s[4:7], s89 offen offset:2048 sc1 lds
ds_read_b128 a[64:67], v26
v_mfma_f32_16x16x32_bf16 v[128:131], a[96:99], v[64:67], 0
v_cvt_pk_bf16_f32 v85, v42, v43
v_mfma_f32_16x16x32_bf16 v[160:163], a[96:99], v[68:71], 0
v_exp_f32 v44, v44
v_mfma_f32_16x16x32_bf16 v[192:195], a[96:99], v[72:75], 0
v_exp_f32 v45, v45
v_mfma_f32_16x16x32_bf16 v[224:227], a[96:99], v[76:79], 0
s_waitcnt lgkmcnt(7)
ds_read_b128 a[68:71], v26 offset:1024
v_cvt_pk_bf16_f32 v86, v44, v45
v_mfma_f32_16x16x32_bf16 v[228:231], a[100:103], v[76:79], 0
v_exp_f32 v46, v46
v_mfma_f32_16x16x32_bf16 v[196:199], a[100:103], v[72:75], 0
v_exp_f32 v47, v47
v_mfma_f32_16x16x32_bf16 v[164:167], a[100:103], v[68:71], 0
v_cvt_pk_bf16_f32 v87, v46, v47
v_mfma_f32_16x16x32_bf16 v[132:135], a[100:103], v[64:67], 0
s_waitcnt lgkmcnt(7)
ds_read_b128 a[72:75], v26 offset:2048
v_mfma_f32_16x16x32_bf16 v[136:139], a[104:107], v[64:67], 0
s_lshl_b32 s76, s48, 13
s_add_u32 s76, s76, L_peel-L_pc
v_lshlrev_b32 v30, 7, v0
v_add_u32 v30, s76, v30
v_min_u32 v30, L_codeend-L_pc-4, v30
global_load_dword v24, v30, s[98:99]
v_mfma_f32_16x16x32_bf16 v[168:171], a[104:107], v[68:71], 0
v_exp_f32 v48, v48
v_mfma_f32_16x16x32_bf16 v[200:203], a[104:107], v[72:75], 0
v_exp_f32 v49, v49
v_mfma_f32_16x16x32_bf16 v[232:235], a[104:107], v[76:79], 0
s_waitcnt lgkmcnt(6)
ds_read_b128 a[76:79], v26 offset:3072
v_cvt_pk_bf16_f32 v88, v48, v49
v_mfma_f32_16x16x32_bf16 v[236:239], a[108:111], v[76:79], 0
v_add_u32 v30, L_table-L_pc, v1
global_load_dwordx4 v[4:7], v30, s[98:99]
v_mfma_f32_16x16x32_bf16 v[204:207], a[108:111], v[72:75], 0
v_exp_f32 v50, v50
v_mfma_f32_16x16x32_bf16 v[172:175], a[108:111], v[68:71], 0
buffer_load_dwordx4 v1, s[4:7], s89 offen offset:3072 sc1 lds
s_add_u32 s89, s89, 0x4000
v_mfma_f32_16x16x32_bf16 v[140:143], a[108:111], v[64:67], 0
ds_read_b128 a[92:95], v26 offset:7168
v_mfma_f32_16x16x32_bf16 v[144:147], a[112:115], v[64:67], 0
v_exp_f32 v51, v51
v_mfma_f32_16x16x32_bf16 v[176:179], a[112:115], v[68:71], 0
v_add_u32 v30, L_table-L_pc, v1
global_load_dwordx4 v[8:11], v30, s[98:99] offset:1024
v_mfma_f32_16x16x32_bf16 v[208:211], a[112:115], v[72:75], 0
v_cvt_pk_bf16_f32 v89, v50, v51
v_mfma_f32_16x16x32_bf16 v[240:243], a[112:115], v[76:79], 0
s_waitcnt lgkmcnt(7)
ds_read_b128 a[88:91], v26 offset:6144
v_mfma_f32_16x16x32_bf16 v[244:247], a[116:119], v[76:79], 0
v_exp_f32 v52, v52
v_mfma_f32_16x16x32_bf16 v[212:215], a[116:119], v[72:75], 0
v_exp_f32 v53, v53
v_mfma_f32_16x16x32_bf16 v[180:183], a[116:119], v[68:71], 0
v_add_u32 v30, L_table-L_pc, v1
global_load_dwordx4 v[12:15], v30, s[98:99] offset:2048
v_mfma_f32_16x16x32_bf16 v[148:151], a[116:119], v[64:67], 0
s_waitcnt lgkmcnt(7)
ds_read_b128 a[84:87], v26 offset:5120
v_cvt_pk_bf16_f32 v90, v52, v53
v_mfma_f32_16x16x32_bf16 v[152:155], a[120:123], v[64:67], 0
v_exp_f32 v54, v54
v_mfma_f32_16x16x32_bf16 v[184:187], a[120:123], v[68:71], 0
v_exp_f32 v55, v55
v_mfma_f32_16x16x32_bf16 v[216:219], a[120:123], v[72:75], 0
v_cvt_pk_bf16_f32 v91, v54, v55
v_mfma_f32_16x16x32_bf16 v[248:251], a[120:123], v[76:79], 0
s_waitcnt lgkmcnt(7)
v_add_u32 v30, L_table-L_pc, v1
global_load_dword v16, v30, s[98:99] offset:3072
v_mfma_f32_16x16x32_bf16 v[252:255], a[124:127], v[76:79], 0
s_add_u32 m0, m0, 0x4000
ds_read_b128 a[80:83], v26 offset:4096
v_mfma_f32_16x16x32_bf16 v[220:223], a[124:127], v[72:75], 0
buffer_load_dwordx4 v1, s[4:7], s90 offen sc1 lds
v_mfma_f32_16x16x32_bf16 v[188:191], a[124:127], v[68:71], 0
v_exp_f32 v56, v56
v_mfma_f32_16x16x32_bf16 v[156:159], a[124:127], v[64:67], 0
v_exp_f32 v57, v57
v_mfma_f32_16x16x32_bf16 a[128:131], a[144:147], v[64:67], 0
v_cvt_pk_bf16_f32 v92, v56, v57
v_mfma_f32_16x16x32_bf16 a[132:135], a[144:147], v[68:71], 0
s_nop 0
v_cndmask_b32_e64 v112, v100, v29, s[80:81]
v_cndmask_b32_e64 v113, v100, v29, s[82:83]
v_cmp_gt_i32_e64 s[80:81], 2, v28
v_cmp_gt_i32_e64 s[82:83], 3, v28
s_nop 0
v_cndmask_b32_e64 v114, v100, v29, s[80:81]
v_cndmask_b32_e64 v115, v100, v29, s[82:83]
v_cmp_gt_i32_e64 s[80:81], 16, v28
v_cmp_gt_i32_e64 s[82:83], 17, v28
s_nop 0
v_cndmask_b32_e64 v116, v100, v29, s[80:81]
v_cndmask_b32_e64 v117, v100, v29, s[82:83]
v_cmp_gt_i32_e64 s[80:81], 18, v28
v_cmp_gt_i32_e64 s[82:83], 19, v28
s_nop 0
v_cndmask_b32_e64 v118, v100, v29, s[80:81]
v_cndmask_b32_e64 v119, v100, v29, s[82:83]
v_mfma_f32_16x16x32_bf16 a[136:139], a[144:147], v[72:75], 0
v_exp_f32 v58, v58
v_mfma_f32_16x16x32_bf16 a[140:143], a[144:147], v[76:79], 0
s_waitcnt lgkmcnt(4)
v_exp_f32 v59, v59
v_mfma_f32_16x16x32_bf16 v[40:43], a[64:67], a[16:19], v[112:115]
ds_read_b128 a[96:99], v26 offset:24576
v_cvt_pk_bf16_f32 v93, v58, v59
v_mfma_f32_16x16x32_bf16 v[40:43], a[68:71], a[20:23], v[40:43]
v_exp_f32 v60, v60
v_mfma_f32_16x16x32_bf16 v[40:43], a[72:75], a[24:27], v[40:43]
v_exp_f32 v61, v61
v_mfma_f32_16x16x32_bf16 v[40:43], a[76:79], a[28:31], v[40:43]
s_waitcnt lgkmcnt(1)
ds_read_b128 a[100:103], v26 offset:25600
v_cvt_pk_bf16_f32 v94, v60, v61
v_mfma_f32_16x16x32_bf16 v[44:47], a[92:95], a[28:31], v[116:119]
v_exp_f32 v62, v62
v_mfma_f32_16x16x32_bf16 v[44:47], a[88:91], a[24:27], v[44:47]
v_exp_f32 v63, v63
v_mfma_f32_16x16x32_bf16 v[44:47], a[84:87], a[20:23], v[44:47]
ds_read_b128 a[104:107], v26 offset:26624
v_cvt_pk_bf16_f32 v95, v62, v63
v_mfma_f32_16x16x32_bf16 v[44:47], a[80:83], a[16:19], v[44:47]
v_mov_b32 v120, v104
v_mov_b32 v121, v104
v_mfma_f32_16x16x32_bf16 v[48:51], a[64:67], a[32:35], v[104:107]
buffer_load_dwordx4 v1, s[4:7], s90 offen offset:1024 sc1 lds
ds_read_b128 a[108:111], v26 offset:27648
v_mfma_f32_16x16x32_bf16 v[48:51], a[68:71], a[36:39], v[48:51]
v_exp_f32 v40, v40
v_mfma_f32_16x16x32_bf16 v[48:51], a[72:75], a[40:43], v[48:51]
v_exp_f32 v41, v41
v_mfma_f32_16x16x32_bf16 v[48:51], a[76:79], a[44:47], v[48:51]
ds_read_b128 a[112:115], v26 offset:28672
v_cvt_pk_bf16_f32 v68, v40, v41
v_mfma_f32_16x16x32_bf16 v[52:55], a[92:95], a[44:47], v[104:107]
v_exp_f32 v42, v42
v_mfma_f32_16x16x32_bf16 v[52:55], a[88:91], a[40:43], v[52:55]
v_exp_f32 v43, v43
v_mfma_f32_16x16x32_bf16 v[52:55], a[84:87], a[36:39], v[52:55]
ds_read_b128 a[116:119], v26 offset:29696
v_cvt_pk_bf16_f32 v69, v42, v43
v_mfma_f32_16x16x32_bf16 v[52:55], a[80:83], a[32:35], v[52:55]
v_exp_f32 v44, v44
v_mfma_f32_16x16x32_bf16 v[56:59], a[64:67], a[48:51], v[108:111]
v_exp_f32 v45, v45
v_mfma_f32_16x16x32_bf16 v[56:59], a[68:71], a[52:55], v[56:59]
ds_read_b128 a[120:123], v26 offset:30720
v_cvt_pk_bf16_f32 v70, v44, v45
v_mfma_f32_16x16x32_bf16 v[56:59], a[72:75], a[56:59], v[56:59]
v_exp_f32 v46, v46
v_mfma_f32_16x16x32_bf16 v[56:59], a[76:79], a[60:63], v[56:59]
v_exp_f32 v47, v47
v_mfma_f32_16x16x32_bf16 v[60:63], a[92:95], a[60:63], v[108:111]
ds_read_b128 a[124:127], v26 offset:31744
v_cvt_pk_bf16_f32 v71, v46, v47
v_mfma_f32_16x16x32_bf16 v[60:63], a[88:91], a[56:59], v[60:63]
v_exp_f32 v48, v48
v_mfma_f32_16x16x32_bf16 v[60:63], a[84:87], a[52:55], v[60:63]
v_exp_f32 v49, v49
v_mfma_f32_16x16x32_bf16 v[60:63], a[80:83], a[48:51], v[60:63]
s_waitcnt lgkmcnt(7)
buffer_load_dwordx4 v1, s[4:7], s90 offen offset:2048 sc1 lds
ds_read_b128 a[64:67], v26 offset:8192
v_mfma_f32_16x16x32_bf16 v[128:131], a[96:99], v[80:83], v[128:131]
v_cvt_pk_bf16_f32 v72, v48, v49
v_mov_b32 v122, v104
v_mfma_f32_16x16x32_bf16 v[160:163], a[96:99], v[84:87], v[160:163]
v_exp_f32 v50, v50
v_mfma_f32_16x16x32_bf16 v[192:195], a[96:99], v[88:91], v[192:195]
v_exp_f32 v51, v51
v_mfma_f32_16x16x32_bf16 v[224:227], a[96:99], v[92:95], v[224:227]
s_waitcnt lgkmcnt(7)
ds_read_b128 a[68:71], v26 offset:9216
v_cvt_pk_bf16_f32 v73, v50, v51
v_mfma_f32_16x16x32_bf16 v[228:231], a[100:103], v[92:95], v[228:231]
v_exp_f32 v52, v52
v_mfma_f32_16x16x32_bf16 v[196:199], a[100:103], v[88:91], v[196:199]
v_exp_f32 v53, v53
v_mfma_f32_16x16x32_bf16 v[164:167], a[100:103], v[84:87], v[164:167]
v_cvt_pk_bf16_f32 v74, v52, v53
v_mov_b32 v123, v104
v_mfma_f32_16x16x32_bf16 v[132:135], a[100:103], v[80:83], v[132:135]
s_waitcnt lgkmcnt(7)
ds_read_b128 a[72:75], v26 offset:10240
v_mov_b32 v124, v104
v_mfma_f32_16x16x32_bf16 v[136:139], a[104:107], v[80:83], v[136:139]
v_exp_f32 v54, v54
v_mfma_f32_16x16x32_bf16 v[168:171], a[104:107], v[84:87], v[168:171]
v_exp_f32 v55, v55
v_mfma_f32_16x16x32_bf16 v[200:203], a[104:107], v[88:91], v[200:203]
v_cvt_pk_bf16_f32 v75, v54, v55
v_mov_b32 v125, v104
v_mfma_f32_16x16x32_bf16 v[232:235], a[104:107], v[92:95], v[232:235]
s_waitcnt lgkmcnt(7)
ds_read_b128 a[76:79], v26 offset:11264
v_mov_b32 v126, v104
v_mfma_f32_16x16x32_bf16 v[236:239], a[108:111], v[92:95], v[236:239]
v_exp_f32 v56, v56
v_mfma_f32_16x16x32_bf16 v[204:207], a[108:111], v[88:91], v[204:207]
v_exp_f32 v57, v57
v_mfma_f32_16x16x32_bf16 v[172:175], a[108:111], v[84:87], v[172:175]
buffer_load_dwordx4 v1, s[4:7], s90 offen offset:3072 sc1 lds
s_add_u32 s90, s90, 0x4000
v_cvt_pk_bf16_f32 v76, v56, v57
v_mfma_f32_16x16x32_bf16 v[140:143], a[108:111], v[80:83], v[140:143]
s_waitcnt lgkmcnt(7)
ds_read_b128 a[92:95], v26 offset:15360
v_mov_b32 v127, v104
v_mfma_f32_16x16x32_bf16 v[144:147], a[112:115], v[80:83], v[144:147]
v_exp_f32 v58, v58
v_mfma_f32_16x16x32_bf16 v[176:179], a[112:115], v[84:87], v[176:179]
v_exp_f32 v59, v59
v_mfma_f32_16x16x32_bf16 v[208:211], a[112:115], v[88:91], v[208:211]
v_cvt_pk_bf16_f32 v77, v58, v59
v_mfma_f32_16x16x32_bf16 v[240:243], a[112:115], v[92:95], v[240:243]
s_waitcnt lgkmcnt(7)
ds_read_b128 a[88:91], v26 offset:14336
v_mfma_f32_16x16x32_bf16 v[244:247], a[116:119], v[92:95], v[244:247]
v_exp_f32 v60, v60
v_mfma_f32_16x16x32_bf16 v[212:215], a[116:119], v[88:91], v[212:215]
v_exp_f32 v61, v61
v_mfma_f32_16x16x32_bf16 v[180:183], a[116:119], v[84:87], v[180:183]
v_cvt_pk_bf16_f32 v78, v60, v61
v_mfma_f32_16x16x32_bf16 v[148:151], a[116:119], v[80:83], v[148:151]
s_waitcnt lgkmcnt(7)
ds_read_b128 a[84:87], v26 offset:13312
v_mfma_f32_16x16x32_bf16 v[152:155], a[120:123], v[80:83], v[152:155]
v_exp_f32 v62, v62
v_mfma_f32_16x16x32_bf16 v[184:187], a[120:123], v[84:87], v[184:187]
v_exp_f32 v63, v63
v_mfma_f32_16x16x32_bf16 v[216:219], a[120:123], v[88:91], v[216:219]
v_cvt_pk_bf16_f32 v79, v62, v63
v_mfma_f32_16x16x32_bf16 v[248:251], a[120:123], v[92:95], v[248:251]
s_waitcnt lgkmcnt(7)
ds_read_b128 a[80:83], v26 offset:12288
v_mfma_f32_16x16x32_bf16 v[252:255], a[124:127], v[92:95], v[252:255]
v_cmp_gt_i32_e64 s[80:81], 0, v27
v_cmp_gt_i32_e64 s[82:83], 1, v27
v_mfma_f32_16x16x32_bf16 v[220:223], a[124:127], v[88:91], v[220:223]
s_add_u32 s91, s91, 0x8000
v_mfma_f32_16x16x32_bf16 v[188:191], a[124:127], v[84:87], v[188:191]
s_and_b32 s91, s91, 0x18000
v_mfma_f32_16x16x32_bf16 v[156:159], a[124:127], v[80:83], v[156:159]
v_mfma_f32_16x16x32_bf16 a[128:131], a[144:147], v[80:83], a[128:131]
v_mfma_f32_16x16x32_bf16 a[132:135], a[144:147], v[84:87], a[132:135]
s_waitcnt vmcnt(14)
s_barrier
v_mfma_f32_16x16x32_bf16 a[136:139], a[144:147], v[88:91], a[136:139]
s_waitcnt lgkmcnt(1)
v_add_u32 v26, s91, v2
v_mfma_f32_16x16x32_bf16 a[140:143], a[144:147], v[92:95], a[140:143]
s_sub_u32 s72, s72, 1
s_cbranch_scc1 L_fv12
L_back_fv12:
v_mfma_f32_16x16x32_bf16 v[48:51], a[64:67], a[32:35], v[104:107]
s_xor_b32 s75, s91, 0x10000
ds_read_b128 a[96:99], v26 offset:16384
v_mfma_f32_16x16x32_bf16 v[48:51], a[68:71], a[36:39], v[48:51]
s_add_u32 m0, s75, s59
ds_read_b128 a[100:103], v26 offset:17408
v_mfma_f32_16x16x32_bf16 v[48:51], a[72:75], a[40:43], v[48:51]
buffer_load_dwordx4 v1, s[4:7], s89 offen sc1 lds
v_mfma_f32_16x16x32_bf16 v[48:51], a[76:79], a[44:47], v[48:51]
ds_read_b128 a[104:107], v26 offset:18432
v_mfma_f32_16x16x32_bf16 v[52:55], a[92:95], a[44:47], v[104:107]
v_mfma_f32_16x16x32_bf16 v[52:55], a[88:91], a[40:43], v[52:55]
ds_read_b128 a[108:111], v26 offset:19456
v_mfma_f32_16x16x32_bf16 v[52:55], a[84:87], a[36:39], v[52:55]
s_waitcnt lgkmcnt(4)
v_accvgpr_read_b32 v32, a128
s_mov_b32 s76, 0x21800000
v_cmp_nle_f32_e64 s[94:95], s76, v32
s_mov_b32 s76, 0x5d800000
v_cmp_nge_f32 vcc, s76, v32
s_or_b64 vcc, vcc, s[94:95]
s_cbranch_scc1 L_slow0Y0
L_back_slow0Y0:
v_accvgpr_read_b32 v32, a128
v_mfma_f32_16x16x32_bf16 v[52:55], a[80:83], a[32:35], v[52:55]
v_rcp_f32 v32, v32
s_nop 0
v_mfma_f32_16x16x32_bf16 v[56:59], a[64:67], a[48:51], v[108:111]
v_mul_f32 v128, v32, v128
v_mul_f32 v129, v32, v129
v_mfma_f32_16x16x32_bf16 v[56:59], a[68:71], a[52:55], v[56:59]
v_mul_f32 v130, v32, v130
v_mul_f32 v131, v32, v131
v_mfma_f32_16x16x32_bf16 v[56:59], a[72:75], a[56:59], v[56:59]
v_mul_f32 v132, v32, v132
v_mul_f32 v133, v32, v133
v_mfma_f32_16x16x32_bf16 v[56:59], a[76:79], a[60:63], v[56:59]
v_mul_f32 v134, v32, v134
v_mul_f32 v135, v32, v135
v_mfma_f32_16x16x32_bf16 v[60:63], a[92:95], a[60:63], v[108:111]
buffer_load_dwordx4 v1, s[4:7], s89 offen offset:1024 sc1 lds
v_cvt_pk_bf16_f32 v128, v128, v129
v_mfma_f32_16x16x32_bf16 v[60:63], a[88:91], a[56:59], v[60:63]
v_cvt_pk_bf16_f32 v129, v130, v131
v_cvt_pk_bf16_f32 v130, v132, v133
v_mfma_f32_16x16x32_bf16 v[60:63], a[84:87], a[52:55], v[60:63]
ds_read_b128 a[112:115], v26 offset:20480
v_cvt_pk_bf16_f32 v131, v134, v135
v_mfma_f32_16x16x32_bf16 v[60:63], a[80:83], a[48:51], v[60:63]
s_waitcnt lgkmcnt(4)
buffer_store_dwordx4 v[128:131], v1, s[4:7], s55 offen sc1
v_mul_f32 v136, v32, v136
v_mfma_f32_16x16x32_bf16 v[160:163], a[96:99], v[68:71], v[160:163]
ds_read_b128 a[116:119], v26 offset:21504
v_mul_f32 v137, v32, v137
v_mfma_f32_16x16x32_bf16 v[192:195], a[96:99], v[72:75], v[192:195]
ds_read_b128 a[120:123], v26 offset:22528
v_mul_f32 v138, v32, v138
v_mfma_f32_16x16x32_bf16 v[224:227], a[96:99], v[76:79], v[224:227]
s_waitcnt lgkmcnt(5)
v_mul_f32 v139, v32, v139
v_mul_f32 v140, v32, v140
v_mfma_f32_16x16x32_bf16 v[228:231], a[100:103], v[76:79], v[228:231]
buffer_load_dwordx4 v1, s[4:7], s89 offen offset:2048 sc1 lds
v_mul_f32 v141, v32, v141
v_mfma_f32_16x16x32_bf16 v[196:199], a[100:103], v[72:75], v[196:199]
ds_read_b128 a[124:127], v26 offset:23552
v_mul_f32 v142, v32, v142
v_mfma_f32_16x16x32_bf16 v[164:167], a[100:103], v[68:71], v[164:167]
s_waitcnt lgkmcnt(4)
v_mul_f32 v143, v32, v143
v_cvt_pk_bf16_f32 v136, v136, v137
v_mfma_f32_16x16x32_bf16 v[168:171], a[104:107], v[68:71], v[168:171]
ds_read_b128 a[64:67], v26
v_cvt_pk_bf16_f32 v137, v138, v139
v_mfma_f32_16x16x32_bf16 v[200:203], a[104:107], v[72:75], v[200:203]
ds_read_b128 a[68:71], v26 offset:1024
v_cvt_pk_bf16_f32 v138, v140, v141
v_mfma_f32_16x16x32_bf16 v[232:235], a[104:107], v[76:79], v[232:235]
v_cvt_pk_bf16_f32 v139, v142, v143
buffer_store_dwordx4 v[136:139], v1, s[4:7], s55 offen offset:1024 sc1
v_mfma_f32_16x16x32_bf16 v[236:239], a[108:111], v[76:79], v[236:239]
ds_read_b128 a[72:75], v26 offset:2048
v_mul_f32 v144, v32, v144
v_mfma_f32_16x16x32_bf16 v[204:207], a[108:111], v[72:75], v[204:207]
v_mul_f32 v145, v32, v145
v_mul_f32 v146, v32, v146
v_mfma_f32_16x16x32_bf16 v[172:175], a[108:111], v[68:71], v[172:175]
s_waitcnt lgkmcnt(6)
buffer_load_dwordx4 v1, s[4:7], s89 offen offset:3072 sc1 lds
s_add_u32 s89, s89, 0x4000
v_mul_f32 v147, v32, v147
v_mfma_f32_16x16x32_bf16 v[176:179], a[112:115], v[68:71], v[176:179]
ds_read_b128 a[76:79], v26 offset:3072
v_mul_f32 v148, v32, v148
v_mfma_f32_16x16x32_bf16 v[208:211], a[112:115], v[72:75], v[208:211]
v_mul_f32 v149, v32, v149
v_mul_f32 v150, v32, v150
v_mfma_f32_16x16x32_bf16 v[240:243], a[112:115], v[76:79], v[240:243]
s_waitcnt lgkmcnt(6)
ds_read_b128 a[92:95], v26 offset:7168
v_mul_f32 v151, v32, v151
v_mfma_f32_16x16x32_bf16 v[244:247], a[116:119], v[76:79], v[244:247]
ds_read_b128 a[88:91], v26 offset:6144
v_cvt_pk_bf16_f32 v144, v144, v145
v_mfma_f32_16x16x32_bf16 v[212:215], a[116:119], v[72:75], v[212:215]
v_cvt_pk_bf16_f32 v145, v146, v147
v_cvt_pk_bf16_f32 v146, v148, v149
v_mfma_f32_16x16x32_bf16 v[180:183], a[116:119], v[68:71], v[180:183]
s_waitcnt lgkmcnt(6)
ds_read_b128 a[84:87], v26 offset:5120
v_cvt_pk_bf16_f32 v147, v150, v151
v_mfma_f32_16x16x32_bf16 v[184:187], a[120:123], v[68:71], v[184:187]
buffer_store_dwordx4 v[144:147], v1, s[4:7], s55 offen offset:2048 sc1
v_mfma_f32_16x16x32_bf16 v[216:219], a[120:123], v[72:75], v[216:219]
s_add_u32 m0, m0, 0x4000
v_mul_f32 v152, v32, v152
v_mul_f32 v153, v32, v153
v_mfma_f32_16x16x32_bf16 v[248:251], a[120:123], v[76:79], v[248:251]
buffer_load_dwordx4 v1, s[4:7], s90 offen sc1 lds
v_mul_f32 v154, v32, v154
v_mfma_f32_16x16x32_bf16 v[252:255], a[124:127], v[76:79], v[252:255]
ds_read_b128 a[80:83], v26 offset:4096
v_mul_f32 v155, v32, v155
v_mfma_f32_16x16x32_bf16 v[220:223], a[124:127], v[72:75], v[220:223]
v_exp_f32 v48, v48
v_mfma_f32_16x16x32_bf16 v[188:191], a[124:127], v[68:71], v[188:191]
v_exp_f32 v49, v49
v_mfma_f32_16x16x32_bf16 a[132:135], a[144:147], v[68:71], a[132:135]
v_mul_f32 v156, v32, v156
v_cvt_pk_bf16_f32 v88, v48, v49
v_mfma_f32_16x16x32_bf16 a[136:139], a[144:147], v[72:75], a[136:139]
v_exp_f32 v50, v50
v_exp_f32 v51, v51
v_mul_f32 v157, v32, v157
v_mul_f32 v158, v32, v158
v_mfma_f32_16x16x32_bf16 a[140:143], a[144:147], v[76:79], a[140:143]
s_waitcnt lgkmcnt(6)
v_cvt_pk_bf16_f32 v89, v50, v51
v_mul_f32 v159, v32, v159
v_mfma_f32_16x16x32_bf16 v[48:51], a[64:67], a[32:35], v[120:123]
v_cvt_pk_bf16_f32 v152, v152, v153
v_cvt_pk_bf16_f32 v153, v154, v155
v_mfma_f32_16x16x32_bf16 v[48:51], a[68:71], a[36:39], v[48:51]
s_waitcnt lgkmcnt(4)
v_exp_f32 v52, v52
v_exp_f32 v53, v53
v_cvt_pk_bf16_f32 v154, v156, v157
v_mfma_f32_16x16x32_bf16 v[48:51], a[72:75], a[40:43], v[48:51]
v_cvt_pk_bf16_f32 v90, v52, v53
v_exp_f32 v54, v54
v_exp_f32 v55, v55
v_cvt_pk_bf16_f32 v155, v158, v159
v_mfma_f32_16x16x32_bf16 v[48:51], a[76:79], a[44:47], v[48:51]
s_waitcnt lgkmcnt(2)
buffer_store_dwordx4 v[152:155], v1, s[4:7], s55 offen offset:3072 sc1
v_cvt_pk_bf16_f32 v91, v54, v55
v_mfma_f32_16x16x32_bf16 v[52:55], a[92:95], a[44:47], v[124:127]
v_exp_f32 v56, v56
v_mfma_f32_16x16x32_bf16 v[52:55], a[88:91], a[40:43], v[52:55]
s_waitcnt lgkmcnt(0)
v_exp_f32 v57, v57
v_accvgpr_read_b32 v40, a132
s_mov_b32 s76, 0x21800000
v_cmp_nle_f32_e64 s[94:95], s76, v40
s_mov_b32 s76, 0x5d800000
v_cmp_nge_f32 vcc, s76, v40
s_or_b64 vcc, vcc, s[94:95]
s_cbranch_scc1 L_slow1Y0
L_back_slow1Y0:
v_mfma_f32_16x16x32_bf16 v[52:55], a[84:87], a[36:39], v[52:55]
buffer_load_dwordx4 v1, s[4:7], s90 offen offset:1024 sc1 lds
v_cvt_pk_bf16_f32 v92, v56, v57
v_exp_f32 v58, v58
v_exp_f32 v59, v59
v_accvgpr_read_b32 v40, a132
v_rcp_f32 v40, v40
s_nop 0
v_mfma_f32_16x16x32_bf16 v[52:55], a[80:83], a[32:35], v[52:55]
v_cvt_pk_bf16_f32 v93, v58, v59
v_mul_f32 v160, v40, v160
v_mul_f32 v161, v40, v161
v_mfma_f32_16x16x32_bf16 v[56:59], a[64:67], a[48:51], v[108:111]
v_mul_f32 v162, v40, v162
v_mul_f32 v163, v40, v163
v_mfma_f32_16x16x32_bf16 v[56:59], a[68:71], a[52:55], v[56:59]
ds_read_b128 a[96:99], v26 offset:24576
v_exp_f32 v60, v60
v_exp_f32 v61, v61
v_mul_f32 v164, v40, v164
v_mul_f32 v165, v40, v165
v_mfma_f32_16x16x32_bf16 v[56:59], a[72:75], a[56:59], v[56:59]
v_cvt_pk_bf16_f32 v94, v60, v61
v_exp_f32 v62, v62
v_exp_f32 v63, v63
v_mul_f32 v166, v40, v166
v_mul_f32 v167, v40, v167
v_mfma_f32_16x16x32_bf16 v[56:59], a[76:79], a[60:63], v[56:59]
ds_read_b128 a[100:103], v26 offset:25600
v_cvt_pk_bf16_f32 v95, v62, v63
v_cvt_pk_bf16_f32 v160, v160, v161
v_cvt_pk_bf16_f32 v161, v162, v163
v_mfma_f32_16x16x32_bf16 v[60:63], a[92:95], a[60:63], v[108:111]
v_cvt_pk_bf16_f32 v162, v164, v165
v_cvt_pk_bf16_f32 v163, v166, v167
v_mfma_f32_16x16x32_bf16 v[60:63], a[88:91], a[56:59], v[60:63]
ds_read_b128 a[104:107], v26 offset:26624
buffer_store_dwordx4 v[160:163], v1, s[4:7], s56 offen sc1
v_mul_f32 v168, v40, v168
v_mfma_f32_16x16x32_bf16 v[60:63], a[84:87], a[52:55], v[60:63]
v_mul_f32 v169, v40, v169
v_mul_f32 v170, v40, v170
v_mfma_f32_16x16x32_bf16 v[60:63], a[80:83], a[48:51], v[60:63]
s_waitcnt lgkmcnt(2)
ds_read_b128 a[108:111], v26 offset:27648
buffer_load_dwordx4 v1, s[4:7], s90 offen offset:2048 sc1 lds
v_mul_f32 v171, v40, v171
v_mul_f32 v172, v40, v172
v_mfma_f32_16x16x32_bf16 v[192:195], a[96:99], v[88:91], v[192:195]
v_mul_f32 v173, v40, v173
v_mul_f32 v174, v40, v174
v_mfma_f32_16x16x32_bf16 v[224:227], a[96:99], v[92:95], v[224:227]
s_waitcnt lgkmcnt(2)
ds_read_b128 a[112:115], v26 offset:28672
v_mul_f32 v175, v40, v175
v_cvt_pk_bf16_f32 v168, v168, v169
v_mfma_f32_16x16x32_bf16 v[228:231], a[100:103], v[92:95], v[228:231]
v_cvt_pk_bf16_f32 v169, v170, v171
v_cvt_pk_bf16_f32 v170, v172, v173
v_mfma_f32_16x16x32_bf16 v[196:199], a[100:103], v[88:91], v[196:199]
s_waitcnt lgkmcnt(2)
ds_read_b128 a[116:119], v26 offset:29696
v_cvt_pk_bf16_f32 v171, v174, v175
buffer_store_dwordx4 v[168:171], v1, s[4:7], s56 offen offset:1024 sc1
v_mfma_f32_16x16x32_bf16 v[200:203], a[104:107], v[88:91], v[200:203]
v_mul_f32 v176, v40, v176
v_mul_f32 v177, v40, v177
v_mfma_f32_16x16x32_bf16 v[232:235], a[104:107], v[92:95], v[232:235]
s_waitcnt lgkmcnt(2)
ds_read_b128 a[120:123], v26 offset:30720
v_mul_f32 v178, v40, v178
v_mul_f32 v179, v40, v179
v_mfma_f32_16x16x32_bf16 v[236:239], a[108:111], v[92:95], v[236:239]
v_mul_f32 v180, v40, v180
v_mul_f32 v181, v40, v181
v_mfma_f32_16x16x32_bf16 v[204:207], a[108:111], v[88:91], v[204:207]
s_waitcnt lgkmcnt(2)
ds_read_b128 a[124:127], v26 offset:31744
buffer_load_dwordx4 v1, s[4:7], s90 offen offset:3072 sc1 lds
v_mul_f32 v182, v40, v182
v_mul_f32 v183, v40, v183
v_mfma_f32_16x16x32_bf16 v[208:211], a[112:115], v[88:91], v[208:211]
s_add_u32 s90, s90, 0x4000
v_cvt_pk_bf16_f32 v176, v176, v177
v_cvt_pk_bf16_f32 v177, v178, v179
v_mfma_f32_16x16x32_bf16 v[240:243], a[112:115], v[92:95], v[240:243]
s_waitcnt lgkmcnt(2)
v_cvt_pk_bf16_f32 v178, v180, v181
v_cvt_pk_bf16_f32 v179, v182, v183
v_mfma_f32_16x16x32_bf16 v[244:247], a[116:119], v[92:95], v[244:247]
buffer_store_dwordx4 v[176:179], v1, s[4:7], s56 offen offset:2048 sc1
v_mul_f32 v184, v40, v184
v_mfma_f32_16x16x32_bf16 v[212:215], a[116:119], v[88:91], v[212:215]
s_waitcnt lgkmcnt(1)
ds_read_b128 a[64:67], v26 offset:8192
v_exp_f32 v48, v48
v_exp_f32 v49, v49
v_mul_f32 v185, v40, v185
v_mul_f32 v186, v40, v186
v_mfma_f32_16x16x32_bf16 v[216:219], a[120:123], v[88:91], v[216:219]
ds_read_b128 a[68:71], v26 offset:9216
v_cvt_pk_bf16_f32 v72, v48, v49
v_exp_f32 v50, v50
v_exp_f32 v51, v51
v_mul_f32 v187, v40, v187
v_mul_f32 v188, v40, v188
v_mfma_f32_16x16x32_bf16 v[248:251], a[120:123], v[92:95], v[248:251]
s_waitcnt lgkmcnt(2)
ds_read_b128 a[72:75], v26 offset:10240
v_cvt_pk_bf16_f32 v73, v50, v51
v_exp_f32 v52, v52
v_exp_f32 v53, v53
v_mul_f32 v189, v40, v189
v_mul_f32 v190, v40, v190
v_mfma_f32_16x16x32_bf16 v[252:255], a[124:127], v[92:95], v[252:255]
s_add_u32 s91, s91, 0x8000
ds_read_b128 a[76:79], v26 offset:11264
ds_read_b128 a[92:95], v26 offset:15360
ds_read_b128 a[88:91], v26 offset:14336
ds_read_b128 a[84:87], v26 offset:13312
ds_read_b128 a[80:83], v26 offset:12288
v_cvt_pk_bf16_f32 v74, v52, v53
v_exp_f32 v54, v54
v_exp_f32 v55, v55
v_mul_f32 v191, v40, v191
v_cvt_pk_bf16_f32 v184, v184, v185
v_mfma_f32_16x16x32_bf16 v[220:223], a[124:127], v[88:91], v[220:223]
s_and_b32 s91, s91, 0x18000
v_cvt_pk_bf16_f32 v75, v54, v55
v_exp_f32 v56, v56
v_exp_f32 v57, v57
v_cvt_pk_bf16_f32 v185, v186, v187
v_cvt_pk_bf16_f32 v186, v188, v189
s_waitcnt vmcnt(15)
s_barrier
v_mfma_f32_16x16x32_bf16 a[136:139], a[144:147], v[88:91], a[136:139]
v_cvt_pk_bf16_f32 v76, v56, v57
v_exp_f32 v58, v58
v_exp_f32 v59, v59
v_cvt_pk_bf16_f32 v187, v190, v191
buffer_store_dwordx4 v[184:187], v1, s[4:7], s56 offen offset:3072 sc1
v_mfma_f32_16x16x32_bf16 a[140:143], a[144:147], v[92:95], a[140:143]
s_nop 0
v_cndmask_b32_e64 v112, v104, v29, s[80:81]
v_cndmask_b32_e64 v113, v104, v29, s[82:83]
v_cmp_gt_i32_e64 s[80:81], 2, v27
v_cmp_gt_i32_e64 s[82:83], 3, v27
s_nop 0
v_cndmask_b32_e64 v114, v104, v29, s[80:81]
v_cndmask_b32_e64 v115, v104, v29, s[82:83]
v_cmp_gt_i32_e64 s[80:81], 16, v27
v_cmp_gt_i32_e64 s[82:83], 17, v27
s_nop 0
v_cndmask_b32_e64 v116, v104, v29, s[80:81]
v_cndmask_b32_e64 v117, v104, v29, s[82:83]
v_cmp_gt_i32_e64 s[80:81], 18, v27
v_cmp_gt_i32_e64 s[82:83], 19, v27
s_nop 0
v_cndmask_b32_e64 v118, v104, v29, s[80:81]
v_cndmask_b32_e64 v119, v104, v29, s[82:83]
v_cvt_pk_bf16_f32 v77, v58, v59
v_add_u32 v26, s91, v2
s_branch L_single_entry
L_end:
s_endpgm
L_spin_nonce:
s_mov_b32 s93, 0x8000
L_spinloop_nonce:
buffer_load_dword v18, v19, s[44:47], 0 offen sc1
s_waitcnt vmcnt(0)
v_cmp_eq_u32 vcc, 0, v18
s_nop 1
s_cbranch_vccz L_back_nonce
s_sub_u32 s93, s93, 1
s_cmp_lg_u32 s93, 0
s_cbranch_scc1 L_spinloop_nonce
v_mov_b32 v19, 1
buffer_store_dword v19, v20, s[44:47], 0 offen offset:4
s_branch L_back_nonce
L_spin_fv1:
s_mov_b32 s93, 0x8000
L_spinloop_fv1:
buffer_load_dword v19, v3, s[4:7], s77 offen sc1
s_waitcnt vmcnt(0)
v_cmp_ne_u32 vcc, v19, v18
s_nop 1
s_cbranch_vccz L_back_fv1
s_sub_u32 s93, s93, 1
s_cmp_lg_u32 s93, 0
s_cbranch_scc1 L_spinloop_fv1
v_mov_b32 v19, 9
buffer_store_dword v19, v20, s[44:47], 0 offen offset:4
s_branch L_back_fv1
L_spin_fv2:
s_mov_b32 s93, 0x8000
L_spinloop_fv2:
buffer_load_dword v19, v3, s[4:7], s77 offen sc1
s_waitcnt vmcnt(0)
v_cmp_ne_u32 vcc, v19, v18
s_nop 1
s_cbranch_vccz L_back_fv2
s_sub_u32 s93, s93, 1
s_cmp_lg_u32 s93, 0
s_cbranch_scc1 L_spinloop_fv2
v_mov_b32 v19, 9
buffer_store_dword v19, v20, s[44:47], 0 offen offset:4
s_branch L_back_fv2
L_spin_fv3:
s_mov_b32 s93, 0x8000
L_spinloop_fv3:
buffer_load_dword v19, v3, s[4:7], s77 offen sc1
s_waitcnt vmcnt(0)
v_cmp_ne_u32 vcc, v19, v18
s_nop 1
s_cbranch_vccz L_back_fv3
s_sub_u32 s93, s93, 1
s_cmp_lg_u32 s93, 0
s_cbranch_scc1 L_spinloop_fv3
v_mov_b32 v19, 9
buffer_store_dword v19, v20, s[44:47], 0 offen offset:4
s_branch L_back_fv3
L_spin_fv4:
s_mov_b32 s93, 0x8000
L_spinloop_fv4:
buffer_load_dword v19, v3, s[4:7], s77 offen sc1
s_waitcnt vmcnt(0)
v_cmp_ne_u32 vcc, v19, v18
s_nop 1
s_cbranch_vccz L_back_fv4
s_sub_u32 s93, s93, 1
s_cmp_lg_u32 s93, 0
s_cbranch_scc1 L_spinloop_fv4
v_mov_b32 v19, 9
buffer_store_dword v19, v20, s[44:47], 0 offen offset:4
s_branch L_back_fv4
L_spin_fv5:
s_mov_b32 s93, 0x8000
L_spinloop_fv5:
buffer_load_dword v19, v3, s[4:7], s77 offen sc1
s_waitcnt vmcnt(0)
v_cmp_ne_u32 vcc, v19, v18
s_nop 1
s_cbranch_vccz L_back_fv5
s_sub_u32 s93, s93, 1
s_cmp_lg_u32 s93, 0
s_cbranch_scc1 L_spinloop_fv5
v_mov_b32 v19, 9
buffer_store_dword v19, v20, s[44:47], 0 offen offset:4
s_branch L_back_fv5
L_spin_fv6:
s_mov_b32 s93, 0x8000
L_spinloop_fv6:
buffer_load_dword v19, v3, s[4:7], s77 offen sc1
s_waitcnt vmcnt(0)
v_cmp_ne_u32 vcc, v19, v18
s_nop 1
s_cbranch_vccz L_back_fv6
s_sub_u32 s93, s93, 1
s_cmp_lg_u32 s93, 0
s_cbranch_scc1 L_spinloop_fv6
v_mov_b32 v19, 9
buffer_store_dword v19, v20, s[44:47], 0 offen offset:4
s_branch L_back_fv6
L_slow0X:
s_waitcnt vmcnt(0)
s_nop 7
s_lshl_b32 s76, s50, 2
s_add_u32 s76, s76, 4
s_lshl_b32 s77, s49, 19
s_mov_b32 s94, 0
v_mov_b32 v96, v29
v_mov_b32 v97, 0
v_mov_b32 v128, 0
v_mov_b32 v129, 0
v_mov_b32 v130, 0
v_mov_b32 v131, 0
v_mov_b32 v132, 0
v_mov_b32 v133, 0
v_mov_b32 v134, 0
v_mov_b32 v135, 0
v_mov_b32 v136, 0
v_mov_b32 v137, 0
v_mov_b32 v138, 0
v_mov_b32 v139, 0
v_mov_b32 v140, 0
v_mov_b32 v141, 0
v_mov_b32 v142, 0
v_mov_b32 v143, 0
v_mov_b32 v144, 0
v_mov_b32 v145, 0
v_mov_b32 v146, 0
v_mov_b32 v147, 0
v_mov_b32 v148, 0
v_mov_b32 v149, 0
v_mov_b32 v150, 0
v_mov_b32 v151, 0
v_mov_b32 v152, 0
v_mov_b32 v153, 0
v_mov_b32 v154, 0
v_mov_b32 v155, 0
v_mov_b32 v156, 0
v_mov_b32 v157, 0
v_mov_b32 v158, 0
v_mov_b32 v159, 0
s_sub_u32 s78, s55, 33554432
s_lshr_b32 s78, s78, 17
s_lshl_b32 s78, s78, 4
v_and_b32 v80, 15, v0
v_lshrrev_b32 v98, 4, v0
v_lshlrev_b32 v98, 2, v98
v_sub_u32 v80, v80, v98
v_add_u32 v80, s78, v80
L_slow0X_loop:
s_add_u32 s78, s77, 16777216
buffer_load_dwordx4 a[148:151], v1, s[4:7], s77 offen offset:0 sc1
buffer_load_dwordx4 a[180:183], v1, s[4:7], s78 offen offset:0 sc1
buffer_load_dwordx4 a[152:155], v1, s[4:7], s77 offen offset:1024 sc1
buffer_load_dwordx4 a[184:187], v1, s[4:7], s78 offen offset:1024 sc1
buffer_load_dwordx4 a[156:159], v1, s[4:7], s77 offen offset:2048 sc1
buffer_load_dwordx4 a[188:191], v1, s[4:7], s78 offen offset:2048 sc1
buffer_load_dwordx4 a[160:163], v1, s[4:7], s77 offen offset:3072 sc1
buffer_load_dwordx4 a[192:195], v1, s[4:7], s78 offen offset:3072 sc1
s_add_u32 s77, s77, 4096
s_add_u32 s78, s78, 4096
buffer_load_dwordx4 a[164:167], v1, s[4:7], s77 offen offset:0 sc1
buffer_load_dwordx4 a[200:203], v1, s[4:7], s78 offen offset:0 sc1
buffer_load_dwordx4 a[168:171], v1, s[4:7], s77 offen offset:1024 sc1
buffer_load_dwordx4 a[208:211], v1, s[4:7], s78 offen offset:1024 sc1
buffer_load_dwordx4 a[172:175], v1, s[4:7], s77 offen offset:2048 sc1
buffer_load_dwordx4 a[216:219], v1, s[4:7], s78 offen offset:2048 sc1
buffer_load_dwordx4 a[176:179], v1, s[4:7], s77 offen offset:3072 sc1
buffer_load_dwordx4 a[224:227], v1, s[4:7], s78 offen offset:3072 sc1
s_add_u32 s77, s77, 4096
s_waitcnt vmcnt(0)
v_mfma_f32_16x16x32_bf16 v[32:35], a[148:151], a[0:3], 0
v_mfma_f32_16x16x32_bf16 v[32:35], a[152:155], a[4:7], v[32:35]
v_mfma_f32_16x16x32_bf16 v[32:35], a[156:159], a[8:11], v[32:35]
v_mfma_f32_16x16x32_bf16 v[32:35], a[160:163], a[12:15], v[32:35]
v_mfma_f32_16x16x32_bf16 v[36:39], a[164:167], a[0:3], 0
v_mfma_f32_16x16x32_bf16 v[36:39], a[168:171], a[4:7], v[36:39]
v_mfma_f32_16x16x32_bf16 v[36:39], a[172:175], a[8:11], v[36:39]
v_mfma_f32_16x16x32_bf16 v[36:39], a[176:179], a[12:15], v[36:39]
s_nop 7
s_nop 3
v_cmp_gt_i32 vcc, 0, v80
s_nop 1
v_cndmask_b32 v32, v32, v29, vcc
v_cmp_gt_i32 vcc, 1, v80
s_nop 1
v_cndmask_b32 v33, v33, v29, vcc
v_cmp_gt_i32 vcc, 2, v80
s_nop 1
v_cndmask_b32 v34, v34, v29, vcc
v_cmp_gt_i32 vcc, 3, v80
s_nop 1
v_cndmask_b32 v35, v35, v29, vcc
v_cmp_gt_i32 vcc, 16, v80
s_nop 1
v_cndmask_b32 v36, v36, v29, vcc
v_cmp_gt_i32 vcc, 17, v80
s_nop 1
v_cndmask_b32 v37, v37, v29, vcc
v_cmp_gt_i32 vcc, 18, v80
s_nop 1
v_cndmask_b32 v38, v38, v29, vcc
v_cmp_gt_i32 vcc, 19, v80
s_nop 1
v_cndmask_b32 v39, v39, v29, vcc
v_mov_b32 v98, v96
v_max_f32 v98, v98, v32
v_max_f32 v98, v98, v33
v_max_f32 v98, v98, v34
v_max_f32 v98, v98, v35
v_max_f32 v98, v98, v36
v_max_f32 v98, v98, v37
v_max_f32 v98, v98, v38
v_max_f32 v98, v98, v39
v_mov_b32 v99, v98
s_nop 1
v_permlane16_swap_b32 v98, v99
s_nop 1
v_max_f32 v98, v98, v99
v_mov_b32 v99, v98
s_nop 1
v_permlane32_swap_b32 v98, v99
s_nop 1
v_max_f32 v98, v98, v99
v_sub_f32 v99, v96, v98
v_mov_b32 v96, v98
v_exp_f32 v99, v99
v_sub_f32 v32, v32, v96
v_exp_f32 v32, v32
v_sub_f32 v33, v33, v96
v_exp_f32 v33, v33
v_sub_f32 v34, v34, v96
v_exp_f32 v34, v34
v_sub_f32 v35, v35, v96
v_exp_f32 v35, v35
v_sub_f32 v36, v36, v96
v_exp_f32 v36, v36
v_sub_f32 v37, v37, v96
v_exp_f32 v37, v37
v_sub_f32 v38, v38, v96
v_exp_f32 v38, v38
v_sub_f32 v39, v39, v96
v_exp_f32 v39, v39
v_mul_f32 v97, v97, v99
v_add_f32 v97, v97, v32
v_add_f32 v97, v97, v33
v_add_f32 v97, v97, v34
v_add_f32 v97, v97, v35
v_add_f32 v97, v97, v36
v_add_f32 v97, v97, v37
v_add_f32 v97, v97, v38
v_add_f32 v97, v97, v39
v_cvt_pk_bf16_f32 v64, v32, v33
v_cvt_pk_bf16_f32 v65, v34, v35
v_cvt_pk_bf16_f32 v66, v36, v37
v_cvt_pk_bf16_f32 v67, v38, v39
v_mul_f32 v128, v99, v128
v_mul_f32 v129, v99, v129
v_mul_f32 v130, v99, v130
v_mul_f32 v131, v99, v131
v_mul_f32 v132, v99, v132
v_mul_f32 v133, v99, v133
v_mul_f32 v134, v99, v134
v_mul_f32 v135, v99, v135
v_mul_f32 v136, v99, v136
v_mul_f32 v137, v99, v137
v_mul_f32 v138, v99, v138
v_mul_f32 v139, v99, v139
v_mul_f32 v140, v99, v140
v_mul_f32 v141, v99, v141
v_mul_f32 v142, v99, v142
v_mul_f32 v143, v99, v143
v_mul_f32 v144, v99, v144
v_mul_f32 v145, v99, v145
v_mul_f32 v146, v99, v146
v_mul_f32 v147, v99, v147
v_mul_f32 v148, v99, v148
v_mul_f32 v149, v99, v149
v_mul_f32 v150, v99, v150
v_mul_f32 v151, v99, v151
v_mul_f32 v152, v99, v152
v_mul_f32 v153, v99, v153
v_mul_f32 v154, v99, v154
v_mul_f32 v155, v99, v155
v_mul_f32 v156, v99, v156
v_mul_f32 v157, v99, v157
v_mul_f32 v158, v99, v158
v_mul_f32 v159, v99, v159
v_subrev_u32 v80, 32, v80
s_nop 1
v_mfma_f32_16x16x32_bf16 v[128:131], a[180:183], v[64:67], v[128:131]
v_mfma_f32_16x16x32_bf16 v[132:135], a[184:187], v[64:67], v[132:135]
v_mfma_f32_16x16x32_bf16 v[136:139], a[188:191], v[64:67], v[136:139]
v_mfma_f32_16x16x32_bf16 v[140:143], a[192:195], v[64:67], v[140:143]
v_mfma_f32_16x16x32_bf16 v[144:147], a[200:203], v[64:67], v[144:147]
v_mfma_f32_16x16x32_bf16 v[148:151], a[208:211], v[64:67], v[148:151]
v_mfma_f32_16x16x32_bf16 v[152:155], a[216:219], v[64:67], v[152:155]
v_mfma_f32_16x16x32_bf16 v[156:159], a[224:227], v[64:67], v[156:159]
s_nop 7
s_nop 3
s_add_u32 s94, s94, 1
s_cmp_lt_u32 s94, s76
s_cbranch_scc1 L_slow0X_loop
v_mov_b32 v99, v97
s_nop 1
v_permlane16_swap_b32 v97, v99
s_nop 1
v_add_f32 v97, v97, v99
v_mov_b32 v99, v97
s_nop 1
v_permlane32_swap_b32 v97, v99
s_nop 1
v_add_f32 v97, v97, v99
v_accvgpr_write_b32 a128, v97
s_nop 3
s_branch L_back_slow0X
L_slow1X:
s_waitcnt vmcnt(0)
s_nop 7
s_lshl_b32 s76, s50, 2
s_add_u32 s76, s76, 4
s_lshl_b32 s77, s49, 19
s_mov_b32 s94, 0
v_mov_b32 v100, v29
v_mov_b32 v101, 0
v_mov_b32 v160, 0
v_mov_b32 v161, 0
v_mov_b32 v162, 0
v_mov_b32 v163, 0
v_mov_b32 v164, 0
v_mov_b32 v165, 0
v_mov_b32 v166, 0
v_mov_b32 v167, 0
v_mov_b32 v168, 0
v_mov_b32 v169, 0
v_mov_b32 v170, 0
v_mov_b32 v171, 0
v_mov_b32 v172, 0
v_mov_b32 v173, 0
v_mov_b32 v174, 0
v_mov_b32 v175, 0
v_mov_b32 v176, 0
v_mov_b32 v177, 0
v_mov_b32 v178, 0
v_mov_b32 v179, 0
v_mov_b32 v180, 0
v_mov_b32 v181, 0
v_mov_b32 v182, 0
v_mov_b32 v183, 0
v_mov_b32 v184, 0
v_mov_b32 v185, 0
v_mov_b32 v186, 0
v_mov_b32 v187, 0
v_mov_b32 v188, 0
v_mov_b32 v189, 0
v_mov_b32 v190, 0
v_mov_b32 v191, 0
s_sub_u32 s78, s56, 33554432
s_lshr_b32 s78, s78, 17
s_lshl_b32 s78, s78, 4
v_and_b32 v84, 15, v0
v_lshrrev_b32 v102, 4, v0
v_lshlrev_b32 v102, 2, v102
v_sub_u32 v84, v84, v102
v_add_u32 v84, s78, v84
L_slow1X_loop:
s_add_u32 s78, s77, 16777216
buffer_load_dwordx4 a[148:151], v1, s[4:7], s77 offen offset:0 sc1
buffer_load_dwordx4 a[180:183], v1, s[4:7], s78 offen offset:0 sc1
buffer_load_dwordx4 a[152:155], v1, s[4:7], s77 offen offset:1024 sc1
buffer_load_dwordx4 a[184:187], v1, s[4:7], s78 offen offset:1024 sc1
buffer_load_dwordx4 a[156:159], v1, s[4:7], s77 offen offset:2048 sc1
buffer_load_dwordx4 a[188:191], v1, s[4:7], s78 offen offset:2048 sc1
buffer_load_dwordx4 a[160:163], v1, s[4:7], s77 offen offset:3072 sc1
buffer_load_dwordx4 a[192:195], v1, s[4:7], s78 offen offset:3072 sc1
s_add_u32 s77, s77, 4096
s_add_u32 s78, s78, 4096
buffer_load_dwordx4 a[164:167], v1, s[4:7], s77 offen offset:0 sc1
buffer_load_dwordx4 a[200:203], v1, s[4:7], s78 offen offset:0 sc1
buffer_load_dwordx4 a[168:171], v1, s[4:7], s77 offen offset:1024 sc1
buffer_load_dwordx4 a[208:211], v1, s[4:7], s78 offen offset:1024 sc1
buffer_load_dwordx4 a[172:175], v1, s[4:7], s77 offen offset:2048 sc1
buffer_load_dwordx4 a[216:219], v1, s[4:7], s78 offen offset:2048 sc1
buffer_load_dwordx4 a[176:179], v1, s[4:7], s77 offen offset:3072 sc1
buffer_load_dwordx4 a[224:227], v1, s[4:7], s78 offen offset:3072 sc1
s_add_u32 s77, s77, 4096
s_waitcnt vmcnt(0)
v_mfma_f32_16x16x32_bf16 v[40:43], a[148:151], a[16:19], 0
v_mfma_f32_16x16x32_bf16 v[40:43], a[152:155], a[20:23], v[40:43]
v_mfma_f32_16x16x32_bf16 v[40:43], a[156:159], a[24:27], v[40:43]
v_mfma_f32_16x16x32_bf16 v[40:43], a[160:163], a[28:31], v[40:43]
v_mfma_f32_16x16x32_bf16 v[44:47], a[164:167], a[16:19], 0
v_mfma_f32_16x16x32_bf16 v[44:47], a[168:171], a[20:23], v[44:47]
v_mfma_f32_16x16x32_bf16 v[44:47], a[172:175], a[24:27], v[44:47]
v_mfma_f32_16x16x32_bf16 v[44:47], a[176:179], a[28:31], v[44:47]
s_nop 7
s_nop 3
v_cmp_gt_i32 vcc, 0, v84
s_nop 1
v_cndmask_b32 v40, v40, v29, vcc
v_cmp_gt_i32 vcc, 1, v84
s_nop 1
v_cndmask_b32 v41, v41, v29, vcc
v_cmp_gt_i32 vcc, 2, v84
s_nop 1
v_cndmask_b32 v42, v42, v29, vcc
v_cmp_gt_i32 vcc, 3, v84
s_nop 1
v_cndmask_b32 v43, v43, v29, vcc
v_cmp_gt_i32 vcc, 16, v84
s_nop 1
v_cndmask_b32 v44, v44, v29, vcc
v_cmp_gt_i32 vcc, 17, v84
s_nop 1
v_cndmask_b32 v45, v45, v29, vcc
v_cmp_gt_i32 vcc, 18, v84
s_nop 1
v_cndmask_b32 v46, v46, v29, vcc
v_cmp_gt_i32 vcc, 19, v84
s_nop 1
v_cndmask_b32 v47, v47, v29, vcc
v_mov_b32 v102, v100
v_max_f32 v102, v102, v40
v_max_f32 v102, v102, v41
v_max_f32 v102, v102, v42
v_max_f32 v102, v102, v43
v_max_f32 v102, v102, v44
v_max_f32 v102, v102, v45
v_max_f32 v102, v102, v46
v_max_f32 v102, v102, v47
v_mov_b32 v103, v102
s_nop 1
v_permlane16_swap_b32 v102, v103
s_nop 1
v_max_f32 v102, v102, v103
v_mov_b32 v103, v102
s_nop 1
v_permlane32_swap_b32 v102, v103
s_nop 1
v_max_f32 v102, v102, v103
v_sub_f32 v103, v100, v102
v_mov_b32 v100, v102
v_exp_f32 v103, v103
v_sub_f32 v40, v40, v100
v_exp_f32 v40, v40
v_sub_f32 v41, v41, v100
v_exp_f32 v41, v41
v_sub_f32 v42, v42, v100
v_exp_f32 v42, v42
v_sub_f32 v43, v43, v100
v_exp_f32 v43, v43
v_sub_f32 v44, v44, v100
v_exp_f32 v44, v44
v_sub_f32 v45, v45, v100
v_exp_f32 v45, v45
v_sub_f32 v46, v46, v100
v_exp_f32 v46, v46
v_sub_f32 v47, v47, v100
v_exp_f32 v47, v47
v_mul_f32 v101, v101, v103
v_add_f32 v101, v101, v40
v_add_f32 v101, v101, v41
v_add_f32 v101, v101, v42
v_add_f32 v101, v101, v43
v_add_f32 v101, v101, v44
v_add_f32 v101, v101, v45
v_add_f32 v101, v101, v46
v_add_f32 v101, v101, v47
v_cvt_pk_bf16_f32 v68, v40, v41
v_cvt_pk_bf16_f32 v69, v42, v43
v_cvt_pk_bf16_f32 v70, v44, v45
v_cvt_pk_bf16_f32 v71, v46, v47
v_mul_f32 v160, v103, v160
v_mul_f32 v161, v103, v161
v_mul_f32 v162, v103, v162
v_mul_f32 v163, v103, v163
v_mul_f32 v164, v103, v164
v_mul_f32 v165, v103, v165
v_mul_f32 v166, v103, v166
v_mul_f32 v167, v103, v167
v_mul_f32 v168, v103, v168
v_mul_f32 v169, v103, v169
v_mul_f32 v170, v103, v170
v_mul_f32 v171, v103, v171
v_mul_f32 v172, v103, v172
v_mul_f32 v173, v103, v173
v_mul_f32 v174, v103, v174
v_mul_f32 v175, v103, v175
v_mul_f32 v176, v103, v176
v_mul_f32 v177, v103, v177
v_mul_f32 v178, v103, v178
v_mul_f32 v179, v103, v179
v_mul_f32 v180, v103, v180
v_mul_f32 v181, v103, v181
v_mul_f32 v182, v103, v182
v_mul_f32 v183, v103, v183
v_mul_f32 v184, v103, v184
v_mul_f32 v185, v103, v185
v_mul_f32 v186, v103, v186
v_mul_f32 v187, v103, v187
v_mul_f32 v188, v103, v188
v_mul_f32 v189, v103, v189
v_mul_f32 v190, v103, v190
v_mul_f32 v191, v103, v191
v_subrev_u32 v84, 32, v84
s_nop 1
v_mfma_f32_16x16x32_bf16 v[160:163], a[180:183], v[68:71], v[160:163]
v_mfma_f32_16x16x32_bf16 v[164:167], a[184:187], v[68:71], v[164:167]
v_mfma_f32_16x16x32_bf16 v[168:171], a[188:191], v[68:71], v[168:171]
v_mfma_f32_16x16x32_bf16 v[172:175], a[192:195], v[68:71], v[172:175]
v_mfma_f32_16x16x32_bf16 v[176:179], a[200:203], v[68:71], v[176:179]
v_mfma_f32_16x16x32_bf16 v[180:183], a[208:211], v[68:71], v[180:183]
v_mfma_f32_16x16x32_bf16 v[184:187], a[216:219], v[68:71], v[184:187]
v_mfma_f32_16x16x32_bf16 v[188:191], a[224:227], v[68:71], v[188:191]
s_nop 7
s_nop 3
s_add_u32 s94, s94, 1
s_cmp_lt_u32 s94, s76
s_cbranch_scc1 L_slow1X_loop
v_mov_b32 v103, v101
s_nop 1
v_permlane16_swap_b32 v101, v103
s_nop 1
v_add_f32 v101, v101, v103
v_mov_b32 v103, v101
s_nop 1
v_permlane32_swap_b32 v101, v103
s_nop 1
v_add_f32 v101, v101, v103
v_accvgpr_write_b32 a132, v101
s_nop 3
s_branch L_back_slow1X
L_spin_fv7:
s_mov_b32 s93, 0x8000
L_spinloop_fv7:
buffer_load_dword v19, v3, s[4:7], s77 offen sc1
s_waitcnt vmcnt(0)
v_cmp_ne_u32 vcc, v19, v18
s_nop 1
s_cbranch_vccz L_back_fv7
s_sub_u32 s93, s93, 1
s_cmp_lg_u32 s93, 0
s_cbranch_scc1 L_spinloop_fv7
v_mov_b32 v19, 9
buffer_store_dword v19, v20, s[44:47], 0 offen offset:4
s_branch L_back_fv7
L_spin_fv8:
s_mov_b32 s93, 0x8000
L_spinloop_fv8:
buffer_load_dword v19, v3, s[4:7], s77 offen sc1
s_waitcnt vmcnt(0)
v_cmp_ne_u32 vcc, v19, v18
s_nop 1
s_cbranch_vccz L_back_fv8
s_sub_u32 s93, s93, 1
s_cmp_lg_u32 s93, 0
s_cbranch_scc1 L_spinloop_fv8
v_mov_b32 v19, 9
buffer_store_dword v19, v20, s[44:47], 0 offen offset:4
s_branch L_back_fv8
L_slow0Y:
s_waitcnt vmcnt(0)
s_nop 7
s_lshl_b32 s76, s50, 2
s_add_u32 s76, s76, 4
s_lshl_b32 s77, s49, 19
s_mov_b32 s94, 0
v_mov_b32 v96, v29
v_mov_b32 v97, 0
v_mov_b32 v128, 0
v_mov_b32 v129, 0
v_mov_b32 v130, 0
v_mov_b32 v131, 0
v_mov_b32 v132, 0
v_mov_b32 v133, 0
v_mov_b32 v134, 0
v_mov_b32 v135, 0
v_mov_b32 v136, 0
v_mov_b32 v137, 0
v_mov_b32 v138, 0
v_mov_b32 v139, 0
v_mov_b32 v140, 0
v_mov_b32 v141, 0
v_mov_b32 v142, 0
v_mov_b32 v143, 0
v_mov_b32 v144, 0
v_mov_b32 v145, 0
v_mov_b32 v146, 0
v_mov_b32 v147, 0
v_mov_b32 v148, 0
v_mov_b32 v149, 0
v_mov_b32 v150, 0
v_mov_b32 v151, 0
v_mov_b32 v152, 0
v_mov_b32 v153, 0
v_mov_b32 v154, 0
v_mov_b32 v155, 0
v_mov_b32 v156, 0
v_mov_b32 v157, 0
v_mov_b32 v158, 0
v_mov_b32 v159, 0
s_sub_u32 s78, s55, 33554432
s_lshr_b32 s78, s78, 17
s_lshl_b32 s78, s78, 4
v_and_b32 v80, 15, v0
v_lshrrev_b32 v98, 4, v0
v_lshlrev_b32 v98, 2, v98
v_sub_u32 v80, v80, v98
v_add_u32 v80, s78, v80
L_slow0Y_loop:
s_add_u32 s78, s77, 16777216
buffer_load_dwordx4 a[148:151], v1, s[4:7], s77 offen offset:0 sc1
buffer_load_dwordx4 a[180:183], v1, s[4:7], s78 offen offset:0 sc1
buffer_load_dwordx4 a[152:155], v1, s[4:7], s77 offen offset:1024 sc1
buffer_load_dwordx4 a[184:187], v1, s[4:7], s78 offen offset:1024 sc1
buffer_load_dwordx4 a[156:159], v1, s[4:7], s77 offen offset:2048 sc1
buffer_load_dwordx4 a[188:191], v1, s[4:7], s78 offen offset:2048 sc1
buffer_load_dwordx4 a[160:163], v1, s[4:7], s77 offen offset:3072 sc1
buffer_load_dwordx4 a[192:195], v1, s[4:7], s78 offen offset:3072 sc1
s_add_u32 s77, s77, 4096
s_add_u32 s78, s78, 4096
buffer_load_dwordx4 a[164:167], v1, s[4:7], s77 offen offset:0 sc1
buffer_load_dwordx4 a[200:203], v1, s[4:7], s78 offen offset:0 sc1
buffer_load_dwordx4 a[168:171], v1, s[4:7], s77 offen offset:1024 sc1
buffer_load_dwordx4 a[208:211], v1, s[4:7], s78 offen offset:1024 sc1
buffer_load_dwordx4 a[172:175], v1, s[4:7], s77 offen offset:2048 sc1
buffer_load_dwordx4 a[216:219], v1, s[4:7], s78 offen offset:2048 sc1
buffer_load_dwordx4 a[176:179], v1, s[4:7], s77 offen offset:3072 sc1
buffer_load_dwordx4 a[224:227], v1, s[4:7], s78 offen offset:3072 sc1
s_add_u32 s77, s77, 4096
s_waitcnt vmcnt(0)
v_mfma_f32_16x16x32_bf16 v[32:35], a[148:151], a[0:3], 0
v_mfma_f32_16x16x32_bf16 v[32:35], a[152:155], a[4:7], v[32:35]
v_mfma_f32_16x16x32_bf16 v[32:35], a[156:159], a[8:11], v[32:35]
v_mfma_f32_16x16x32_bf16 v[32:35], a[160:163], a[12:15], v[32:35]
v_mfma_f32_16x16x32_bf16 v[36:39], a[164:167], a[0:3], 0
v_mfma_f32_16x16x32_bf16 v[36:39], a[168:171], a[4:7], v[36:39]
v_mfma_f32_16x16x32_bf16 v[36:39], a[172:175], a[8:11], v[36:39]
v_mfma_f32_16x16x32_bf16 v[36:39], a[176:179], a[12:15], v[36:39]
s_nop 7
s_nop 3
v_cmp_gt_i32 vcc, 0, v80
s_nop 1
v_cndmask_b32 v32, v32, v29, vcc
v_cmp_gt_i32 vcc, 1, v80
s_nop 1
v_cndmask_b32 v33, v33, v29, vcc
v_cmp_gt_i32 vcc, 2, v80
s_nop 1
v_cndmask_b32 v34, v34, v29, vcc
v_cmp_gt_i32 vcc, 3, v80
s_nop 1
v_cndmask_b32 v35, v35, v29, vcc
v_cmp_gt_i32 vcc, 16, v80
s_nop 1
v_cndmask_b32 v36, v36, v29, vcc
v_cmp_gt_i32 vcc, 17, v80
s_nop 1
v_cndmask_b32 v37, v37, v29, vcc
v_cmp_gt_i32 vcc, 18, v80
s_nop 1
v_cndmask_b32 v38, v38, v29, vcc
v_cmp_gt_i32 vcc, 19, v80
s_nop 1
v_cndmask_b32 v39, v39, v29, vcc
v_mov_b32 v98, v96
v_max_f32 v98, v98, v32
v_max_f32 v98, v98, v33
v_max_f32 v98, v98, v34
v_max_f32 v98, v98, v35
v_max_f32 v98, v98, v36
v_max_f32 v98, v98, v37
v_max_f32 v98, v98, v38
v_max_f32 v98, v98, v39
v_mov_b32 v99, v98
s_nop 1
v_permlane16_swap_b32 v98, v99
s_nop 1
v_max_f32 v98, v98, v99
v_mov_b32 v99, v98
s_nop 1
v_permlane32_swap_b32 v98, v99
s_nop 1
v_max_f32 v98, v98, v99
v_sub_f32 v99, v96, v98
v_mov_b32 v96, v98
v_exp_f32 v99, v99
v_sub_f32 v32, v32, v96
v_exp_f32 v32, v32
v_sub_f32 v33, v33, v96
v_exp_f32 v33, v33
v_sub_f32 v34, v34, v96
v_exp_f32 v34, v34
v_sub_f32 v35, v35, v96
v_exp_f32 v35, v35
v_sub_f32 v36, v36, v96
v_exp_f32 v36, v36
v_sub_f32 v37, v37, v96
v_exp_f32 v37, v37
v_sub_f32 v38, v38, v96
v_exp_f32 v38, v38
v_sub_f32 v39, v39, v96
v_exp_f32 v39, v39
v_mul_f32 v97, v97, v99
v_add_f32 v97, v97, v32
v_add_f32 v97, v97, v33
v_add_f32 v97, v97, v34
v_add_f32 v97, v97, v35
v_add_f32 v97, v97, v36
v_add_f32 v97, v97, v37
v_add_f32 v97, v97, v38
v_add_f32 v97, v97, v39
v_cvt_pk_bf16_f32 v64, v32, v33
v_cvt_pk_bf16_f32 v65, v34, v35
v_cvt_pk_bf16_f32 v66, v36, v37
v_cvt_pk_bf16_f32 v67, v38, v39
v_mul_f32 v128, v99, v128
v_mul_f32 v129, v99, v129
v_mul_f32 v130, v99, v130
v_mul_f32 v131, v99, v131
v_mul_f32 v132, v99, v132
v_mul_f32 v133, v99, v133
v_mul_f32 v134, v99, v134
v_mul_f32 v135, v99, v135
v_mul_f32 v136, v99, v136
v_mul_f32 v137, v99, v137
v_mul_f32 v138, v99, v138
v_mul_f32 v139, v99, v139
v_mul_f32 v140, v99, v140
v_mul_f32 v141, v99, v141
v_mul_f32 v142, v99, v142
v_mul_f32 v143, v99, v143
v_mul_f32 v144, v99, v144
v_mul_f32 v145, v99, v145
v_mul_f32 v146, v99, v146
v_mul_f32 v147, v99, v147
v_mul_f32 v148, v99, v148
v_mul_f32 v149, v99, v149
v_mul_f32 v150, v99, v150
v_mul_f32 v151, v99, v151
v_mul_f32 v152, v99, v152
v_mul_f32 v153, v99, v153
v_mul_f32 v154, v99, v154
v_mul_f32 v155, v99, v155
v_mul_f32 v156, v99, v156
v_mul_f32 v157, v99, v157
v_mul_f32 v158, v99, v158
v_mul_f32 v159, v99, v159
v_subrev_u32 v80, 32, v80
s_nop 1
v_mfma_f32_16x16x32_bf16 v[128:131], a[180:183], v[64:67], v[128:131]
v_mfma_f32_16x16x32_bf16 v[132:135], a[184:187], v[64:67], v[132:135]
v_mfma_f32_16x16x32_bf16 v[136:139], a[188:191], v[64:67], v[136:139]
v_mfma_f32_16x16x32_bf16 v[140:143], a[192:195], v[64:67], v[140:143]
v_mfma_f32_16x16x32_bf16 v[144:147], a[200:203], v[64:67], v[144:147]
v_mfma_f32_16x16x32_bf16 v[148:151], a[208:211], v[64:67], v[148:151]
v_mfma_f32_16x16x32_bf16 v[152:155], a[216:219], v[64:67], v[152:155]
v_mfma_f32_16x16x32_bf16 v[156:159], a[224:227], v[64:67], v[156:159]
s_nop 7
s_nop 3
s_add_u32 s94, s94, 1
s_cmp_lt_u32 s94, s76
s_cbranch_scc1 L_slow0Y_loop
v_mov_b32 v99, v97
s_nop 1
v_permlane16_swap_b32 v97, v99
s_nop 1
v_add_f32 v97, v97, v99
v_mov_b32 v99, v97
s_nop 1
v_permlane32_swap_b32 v97, v99
s_nop 1
v_add_f32 v97, v97, v99
v_accvgpr_write_b32 a128, v97
s_nop 3
s_branch L_back_slow0Y
L_slow1Y:
s_waitcnt vmcnt(0)
s_nop 7
s_lshl_b32 s76, s50, 2
s_add_u32 s76, s76, 4
s_lshl_b32 s77, s49, 19
s_mov_b32 s94, 0
v_mov_b32 v100, v29
v_mov_b32 v101, 0
v_mov_b32 v160, 0
v_mov_b32 v161, 0
v_mov_b32 v162, 0
v_mov_b32 v163, 0
v_mov_b32 v164, 0
v_mov_b32 v165, 0
v_mov_b32 v166, 0
v_mov_b32 v167, 0
v_mov_b32 v168, 0
v_mov_b32 v169, 0
v_mov_b32 v170, 0
v_mov_b32 v171, 0
v_mov_b32 v172, 0
v_mov_b32 v173, 0
v_mov_b32 v174, 0
v_mov_b32 v175, 0
v_mov_b32 v176, 0
v_mov_b32 v177, 0
v_mov_b32 v178, 0
v_mov_b32 v179, 0
v_mov_b32 v180, 0
v_mov_b32 v181, 0
v_mov_b32 v182, 0
v_mov_b32 v183, 0
v_mov_b32 v184, 0
v_mov_b32 v185, 0
v_mov_b32 v186, 0
v_mov_b32 v187, 0
v_mov_b32 v188, 0
v_mov_b32 v189, 0
v_mov_b32 v190, 0
v_mov_b32 v191, 0
s_sub_u32 s78, s56, 33554432
s_lshr_b32 s78, s78, 17
s_lshl_b32 s78, s78, 4
v_and_b32 v84, 15, v0
v_lshrrev_b32 v102, 4, v0
v_lshlrev_b32 v102, 2, v102
v_sub_u32 v84, v84, v102
v_add_u32 v84, s78, v84
L_slow1Y_loop:
s_add_u32 s78, s77, 16777216
buffer_load_dwordx4 a[148:151], v1, s[4:7], s77 offen offset:0 sc1
buffer_load_dwordx4 a[180:183], v1, s[4:7], s78 offen offset:0 sc1
buffer_load_dwordx4 a[152:155], v1, s[4:7], s77 offen offset:1024 sc1
buffer_load_dwordx4 a[184:187], v1, s[4:7], s78 offen offset:1024 sc1
buffer_load_dwordx4 a[156:159], v1, s[4:7], s77 offen offset:2048 sc1
buffer_load_dwordx4 a[188:191], v1, s[4:7], s78 offen offset:2048 sc1
buffer_load_dwordx4 a[160:163], v1, s[4:7], s77 offen offset:3072 sc1
buffer_load_dwordx4 a[192:195], v1, s[4:7], s78 offen offset:3072 sc1
s_add_u32 s77, s77, 4096
s_add_u32 s78, s78, 4096
buffer_load_dwordx4 a[164:167], v1, s[4:7], s77 offen offset:0 sc1
buffer_load_dwordx4 a[200:203], v1, s[4:7], s78 offen offset:0 sc1
buffer_load_dwordx4 a[168:171], v1, s[4:7], s77 offen offset:1024 sc1
buffer_load_dwordx4 a[208:211], v1, s[4:7], s78 offen offset:1024 sc1
buffer_load_dwordx4 a[172:175], v1, s[4:7], s77 offen offset:2048 sc1
buffer_load_dwordx4 a[216:219], v1, s[4:7], s78 offen offset:2048 sc1
buffer_load_dwordx4 a[176:179], v1, s[4:7], s77 offen offset:3072 sc1
buffer_load_dwordx4 a[224:227], v1, s[4:7], s78 offen offset:3072 sc1
s_add_u32 s77, s77, 4096
s_waitcnt vmcnt(0)
v_mfma_f32_16x16x32_bf16 v[40:43], a[148:151], a[16:19], 0
v_mfma_f32_16x16x32_bf16 v[40:43], a[152:155], a[20:23], v[40:43]
v_mfma_f32_16x16x32_bf16 v[40:43], a[156:159], a[24:27], v[40:43]
v_mfma_f32_16x16x32_bf16 v[40:43], a[160:163], a[28:31], v[40:43]
v_mfma_f32_16x16x32_bf16 v[44:47], a[164:167], a[16:19], 0
v_mfma_f32_16x16x32_bf16 v[44:47], a[168:171], a[20:23], v[44:47]
v_mfma_f32_16x16x32_bf16 v[44:47], a[172:175], a[24:27], v[44:47]
v_mfma_f32_16x16x32_bf16 v[44:47], a[176:179], a[28:31], v[44:47]
s_nop 7
s_nop 3
v_cmp_gt_i32 vcc, 0, v84
s_nop 1
v_cndmask_b32 v40, v40, v29, vcc
v_cmp_gt_i32 vcc, 1, v84
s_nop 1
v_cndmask_b32 v41, v41, v29, vcc
v_cmp_gt_i32 vcc, 2, v84
s_nop 1
v_cndmask_b32 v42, v42, v29, vcc
v_cmp_gt_i32 vcc, 3, v84
s_nop 1
v_cndmask_b32 v43, v43, v29, vcc
v_cmp_gt_i32 vcc, 16, v84
s_nop 1
v_cndmask_b32 v44, v44, v29, vcc
v_cmp_gt_i32 vcc, 17, v84
s_nop 1
v_cndmask_b32 v45, v45, v29, vcc
v_cmp_gt_i32 vcc, 18, v84
s_nop 1
v_cndmask_b32 v46, v46, v29, vcc
v_cmp_gt_i32 vcc, 19, v84
s_nop 1
v_cndmask_b32 v47, v47, v29, vcc
v_mov_b32 v102, v100
v_max_f32 v102, v102, v40
v_max_f32 v102, v102, v41
v_max_f32 v102, v102, v42
v_max_f32 v102, v102, v43
v_max_f32 v102, v102, v44
v_max_f32 v102, v102, v45
v_max_f32 v102, v102, v46
v_max_f32 v102, v102, v47
v_mov_b32 v103, v102
s_nop 1
v_permlane16_swap_b32 v102, v103
s_nop 1
v_max_f32 v102, v102, v103
v_mov_b32 v103, v102
s_nop 1
v_permlane32_swap_b32 v102, v103
s_nop 1
v_max_f32 v102, v102, v103
v_sub_f32 v103, v100, v102
v_mov_b32 v100, v102
v_exp_f32 v103, v103
v_sub_f32 v40, v40, v100
v_exp_f32 v40, v40
v_sub_f32 v41, v41, v100
v_exp_f32 v41, v41
v_sub_f32 v42, v42, v100
v_exp_f32 v42, v42
v_sub_f32 v43, v43, v100
v_exp_f32 v43, v43
v_sub_f32 v44, v44, v100
v_exp_f32 v44, v44
v_sub_f32 v45, v45, v100
v_exp_f32 v45, v45
v_sub_f32 v46, v46, v100
v_exp_f32 v46, v46
v_sub_f32 v47, v47, v100
v_exp_f32 v47, v47
v_mul_f32 v101, v101, v103
v_add_f32 v101, v101, v40
v_add_f32 v101, v101, v41
v_add_f32 v101, v101, v42
v_add_f32 v101, v101, v43
v_add_f32 v101, v101, v44
v_add_f32 v101, v101, v45
v_add_f32 v101, v101, v46
v_add_f32 v101, v101, v47
v_cvt_pk_bf16_f32 v68, v40, v41
v_cvt_pk_bf16_f32 v69, v42, v43
v_cvt_pk_bf16_f32 v70, v44, v45
v_cvt_pk_bf16_f32 v71, v46, v47
v_mul_f32 v160, v103, v160
v_mul_f32 v161, v103, v161
v_mul_f32 v162, v103, v162
v_mul_f32 v163, v103, v163
v_mul_f32 v164, v103, v164
v_mul_f32 v165, v103, v165
v_mul_f32 v166, v103, v166
v_mul_f32 v167, v103, v167
v_mul_f32 v168, v103, v168
v_mul_f32 v169, v103, v169
v_mul_f32 v170, v103, v170
v_mul_f32 v171, v103, v171
v_mul_f32 v172, v103, v172
v_mul_f32 v173, v103, v173
v_mul_f32 v174, v103, v174
v_mul_f32 v175, v103, v175
v_mul_f32 v176, v103, v176
v_mul_f32 v177, v103, v177
v_mul_f32 v178, v103, v178
v_mul_f32 v179, v103, v179
v_mul_f32 v180, v103, v180
v_mul_f32 v181, v103, v181
v_mul_f32 v182, v103, v182
v_mul_f32 v183, v103, v183
v_mul_f32 v184, v103, v184
v_mul_f32 v185, v103, v185
v_mul_f32 v186, v103, v186
v_mul_f32 v187, v103, v187
v_mul_f32 v188, v103, v188
v_mul_f32 v189, v103, v189
v_mul_f32 v190, v103, v190
v_mul_f32 v191, v103, v191
v_subrev_u32 v84, 32, v84
s_nop 1
v_mfma_f32_16x16x32_bf16 v[160:163], a[180:183], v[68:71], v[160:163]
v_mfma_f32_16x16x32_bf16 v[164:167], a[184:187], v[68:71], v[164:167]
v_mfma_f32_16x16x32_bf16 v[168:171], a[188:191], v[68:71], v[168:171]
v_mfma_f32_16x16x32_bf16 v[172:175], a[192:195], v[68:71], v[172:175]
v_mfma_f32_16x16x32_bf16 v[176:179], a[200:203], v[68:71], v[176:179]
v_mfma_f32_16x16x32_bf16 v[180:183], a[208:211], v[68:71], v[180:183]
v_mfma_f32_16x16x32_bf16 v[184:187], a[216:219], v[68:71], v[184:187]
v_mfma_f32_16x16x32_bf16 v[188:191], a[224:227], v[68:71], v[188:191]
s_nop 7
s_nop 3
s_add_u32 s94, s94, 1
s_cmp_lt_u32 s94, s76
s_cbranch_scc1 L_slow1Y_loop
v_mov_b32 v103, v101
s_nop 1
v_permlane16_swap_b32 v101, v103
s_nop 1
v_add_f32 v101, v101, v103
v_mov_b32 v103, v101
s_nop 1
v_permlane32_swap_b32 v101, v103
s_nop 1
v_add_f32 v101, v101, v103
v_accvgpr_write_b32 a132, v101
s_nop 3
s_branch L_back_slow1Y
L_spin_fv9:
s_mov_b32 s93, 0x8000
L_spinloop_fv9:
buffer_load_dword v19, v3, s[4:7], s77 offen sc1
s_waitcnt vmcnt(0)
v_cmp_ne_u32 vcc, v19, v18
s_nop 1
s_cbranch_vccz L_back_fv9
s_sub_u32 s93, s93, 1
s_cmp_lg_u32 s93, 0
s_cbranch_scc1 L_spinloop_fv9
v_mov_b32 v19, 9
buffer_store_dword v19, v20, s[44:47], 0 offen offset:4
s_branch L_back_fv9
L_spin_fv10:
s_mov_b32 s93, 0x8000
L_spinloop_fv10:
buffer_load_dword v19, v3, s[4:7], s77 offen sc1
s_waitcnt vmcnt(0)
v_cmp_ne_u32 vcc, v19, v18
s_nop 1
s_cbranch_vccz L_back_fv10
s_sub_u32 s93, s93, 1
s_cmp_lg_u32 s93, 0
s_cbranch_scc1 L_spinloop_fv10
v_mov_b32 v19, 9
buffer_store_dword v19, v20, s[44:47], 0 offen offset:4
s_branch L_back_fv10
L_slow0X0:
s_waitcnt vmcnt(0)
s_nop 7
s_lshl_b32 s76, s50, 2
s_add_u32 s76, s76, 4
s_lshl_b32 s77, s49, 19
s_mov_b32 s94, 0
v_mov_b32 v96, v29
v_mov_b32 v97, 0
v_mov_b32 v128, 0
v_mov_b32 v129, 0
v_mov_b32 v130, 0
v_mov_b32 v131, 0
v_mov_b32 v132, 0
v_mov_b32 v133, 0
v_mov_b32 v134, 0
v_mov_b32 v135, 0
v_mov_b32 v136, 0
v_mov_b32 v137, 0
v_mov_b32 v138, 0
v_mov_b32 v139, 0
v_mov_b32 v140, 0
v_mov_b32 v141, 0
v_mov_b32 v142, 0
v_mov_b32 v143, 0
v_mov_b32 v144, 0
v_mov_b32 v145, 0
v_mov_b32 v146, 0
v_mov_b32 v147, 0
v_mov_b32 v148, 0
v_mov_b32 v149, 0
v_mov_b32 v150, 0
v_mov_b32 v151, 0
v_mov_b32 v152, 0
v_mov_b32 v153, 0
v_mov_b32 v154, 0
v_mov_b32 v155, 0
v_mov_b32 v156, 0
v_mov_b32 v157, 0
v_mov_b32 v158, 0
v_mov_b32 v159, 0
s_sub_u32 s78, s55, 33554432
s_lshr_b32 s78, s78, 17
s_lshl_b32 s78, s78, 4
v_and_b32 v80, 15, v0
v_lshrrev_b32 v98, 4, v0
v_lshlrev_b32 v98, 2, v98
v_sub_u32 v80, v80, v98
v_add_u32 v80, s78, v80
L_slow0X0_loop:
s_add_u32 s78, s77, 16777216
buffer_load_dwordx4 a[148:151], v1, s[4:7], s77 offen offset:0 sc1
buffer_load_dwordx4 a[180:183], v1, s[4:7], s78 offen offset:0 sc1
buffer_load_dwordx4 a[152:155], v1, s[4:7], s77 offen offset:1024 sc1
buffer_load_dwordx4 a[184:187], v1, s[4:7], s78 offen offset:1024 sc1
buffer_load_dwordx4 a[156:159], v1, s[4:7], s77 offen offset:2048 sc1
buffer_load_dwordx4 a[188:191], v1, s[4:7], s78 offen offset:2048 sc1
buffer_load_dwordx4 a[160:163], v1, s[4:7], s77 offen offset:3072 sc1
buffer_load_dwordx4 a[192:195], v1, s[4:7], s78 offen offset:3072 sc1
s_add_u32 s77, s77, 4096
s_add_u32 s78, s78, 4096
buffer_load_dwordx4 a[164:167], v1, s[4:7], s77 offen offset:0 sc1
buffer_load_dwordx4 a[200:203], v1, s[4:7], s78 offen offset:0 sc1
buffer_load_dwordx4 a[168:171], v1, s[4:7], s77 offen offset:1024 sc1
buffer_load_dwordx4 a[208:211], v1, s[4:7], s78 offen offset:1024 sc1
buffer_load_dwordx4 a[172:175], v1, s[4:7], s77 offen offset:2048 sc1
buffer_load_dwordx4 a[216:219], v1, s[4:7], s78 offen offset:2048 sc1
buffer_load_dwordx4 a[176:179], v1, s[4:7], s77 offen offset:3072 sc1
buffer_load_dwordx4 a[224:227], v1, s[4:7], s78 offen offset:3072 sc1
s_add_u32 s77, s77, 4096
s_waitcnt vmcnt(0)
v_mfma_f32_16x16x32_bf16 v[32:35], a[148:151], a[0:3], 0
v_mfma_f32_16x16x32_bf16 v[32:35], a[152:155], a[4:7], v[32:35]
v_mfma_f32_16x16x32_bf16 v[32:35], a[156:159], a[8:11], v[32:35]
v_mfma_f32_16x16x32_bf16 v[32:35], a[160:163], a[12:15], v[32:35]
v_mfma_f32_16x16x32_bf16 v[36:39], a[164:167], a[0:3], 0
v_mfma_f32_16x16x32_bf16 v[36:39], a[168:171], a[4:7], v[36:39]
v_mfma_f32_16x16x32_bf16 v[36:39], a[172:175], a[8:11], v[36:39]
v_mfma_f32_16x16x32_bf16 v[36:39], a[176:179], a[12:15], v[36:39]
s_nop 7
s_nop 3
v_cmp_gt_i32 vcc, 0, v80
s_nop 1
v_cndmask_b32 v32, v32, v29, vcc
v_cmp_gt_i32 vcc, 1, v80
s_nop 1
v_cndmask_b32 v33, v33, v29, vcc
v_cmp_gt_i32 vcc, 2, v80
s_nop 1
v_cndmask_b32 v34, v34, v29, vcc
v_cmp_gt_i32 vcc, 3, v80
s_nop 1
v_cndmask_b32 v35, v35, v29, vcc
v_cmp_gt_i32 vcc, 16, v80
s_nop 1
v_cndmask_b32 v36, v36, v29, vcc
v_cmp_gt_i32 vcc, 17, v80
s_nop 1
v_cndmask_b32 v37, v37, v29, vcc
v_cmp_gt_i32 vcc, 18, v80
s_nop 1
v_cndmask_b32 v38, v38, v29, vcc
v_cmp_gt_i32 vcc, 19, v80
s_nop 1
v_cndmask_b32 v39, v39, v29, vcc
v_mov_b32 v98, v96
v_max_f32 v98, v98, v32
v_max_f32 v98, v98, v33
v_max_f32 v98, v98, v34
v_max_f32 v98, v98, v35
v_max_f32 v98, v98, v36
v_max_f32 v98, v98, v37
v_max_f32 v98, v98, v38
v_max_f32 v98, v98, v39
v_mov_b32 v99, v98
s_nop 1
v_permlane16_swap_b32 v98, v99
s_nop 1
v_max_f32 v98, v98, v99
v_mov_b32 v99, v98
s_nop 1
v_permlane32_swap_b32 v98, v99
s_nop 1
v_max_f32 v98, v98, v99
v_sub_f32 v99, v96, v98
v_mov_b32 v96, v98
v_exp_f32 v99, v99
v_sub_f32 v32, v32, v96
v_exp_f32 v32, v32
v_sub_f32 v33, v33, v96
v_exp_f32 v33, v33
v_sub_f32 v34, v34, v96
v_exp_f32 v34, v34
v_sub_f32 v35, v35, v96
v_exp_f32 v35, v35
v_sub_f32 v36, v36, v96
v_exp_f32 v36, v36
v_sub_f32 v37, v37, v96
v_exp_f32 v37, v37
v_sub_f32 v38, v38, v96
v_exp_f32 v38, v38
v_sub_f32 v39, v39, v96
v_exp_f32 v39, v39
v_mul_f32 v97, v97, v99
v_add_f32 v97, v97, v32
v_add_f32 v97, v97, v33
v_add_f32 v97, v97, v34
v_add_f32 v97, v97, v35
v_add_f32 v97, v97, v36
v_add_f32 v97, v97, v37
v_add_f32 v97, v97, v38
v_add_f32 v97, v97, v39
v_cvt_pk_bf16_f32 v64, v32, v33
v_cvt_pk_bf16_f32 v65, v34, v35
v_cvt_pk_bf16_f32 v66, v36, v37
v_cvt_pk_bf16_f32 v67, v38, v39
v_mul_f32 v128, v99, v128
v_mul_f32 v129, v99, v129
v_mul_f32 v130, v99, v130
v_mul_f32 v131, v99, v131
v_mul_f32 v132, v99, v132
v_mul_f32 v133, v99, v133
v_mul_f32 v134, v99, v134
v_mul_f32 v135, v99, v135
v_mul_f32 v136, v99, v136
v_mul_f32 v137, v99, v137
v_mul_f32 v138, v99, v138
v_mul_f32 v139, v99, v139
v_mul_f32 v140, v99, v140
v_mul_f32 v141, v99, v141
v_mul_f32 v142, v99, v142
v_mul_f32 v143, v99, v143
v_mul_f32 v144, v99, v144
v_mul_f32 v145, v99, v145
v_mul_f32 v146, v99, v146
v_mul_f32 v147, v99, v147
v_mul_f32 v148, v99, v148
v_mul_f32 v149, v99, v149
v_mul_f32 v150, v99, v150
v_mul_f32 v151, v99, v151
v_mul_f32 v152, v99, v152
v_mul_f32 v153, v99, v153
v_mul_f32 v154, v99, v154
v_mul_f32 v155, v99, v155
v_mul_f32 v156, v99, v156
v_mul_f32 v157, v99, v157
v_mul_f32 v158, v99, v158
v_mul_f32 v159, v99, v159
v_subrev_u32 v80, 32, v80
s_nop 1
v_mfma_f32_16x16x32_bf16 v[128:131], a[180:183], v[64:67], v[128:131]
v_mfma_f32_16x16x32_bf16 v[132:135], a[184:187], v[64:67], v[132:135]
v_mfma_f32_16x16x32_bf16 v[136:139], a[188:191], v[64:67], v[136:139]
v_mfma_f32_16x16x32_bf16 v[140:143], a[192:195], v[64:67], v[140:143]
v_mfma_f32_16x16x32_bf16 v[144:147], a[200:203], v[64:67], v[144:147]
v_mfma_f32_16x16x32_bf16 v[148:151], a[208:211], v[64:67], v[148:151]
v_mfma_f32_16x16x32_bf16 v[152:155], a[216:219], v[64:67], v[152:155]
v_mfma_f32_16x16x32_bf16 v[156:159], a[224:227], v[64:67], v[156:159]
s_nop 7
s_nop 3
s_add_u32 s94, s94, 1
s_cmp_lt_u32 s94, s76
s_cbranch_scc1 L_slow0X0_loop
v_mov_b32 v99, v97
s_nop 1
v_permlane16_swap_b32 v97, v99
s_nop 1
v_add_f32 v97, v97, v99
v_mov_b32 v99, v97
s_nop 1
v_permlane32_swap_b32 v97, v99
s_nop 1
v_add_f32 v97, v97, v99
v_accvgpr_write_b32 a128, v97
s_nop 3
s_branch L_back_slow0X0
L_slow1X0:
s_waitcnt vmcnt(0)
s_nop 7
s_lshl_b32 s76, s50, 2
s_add_u32 s76, s76, 4
s_lshl_b32 s77, s49, 19
s_mov_b32 s94, 0
v_mov_b32 v100, v29
v_mov_b32 v101, 0
v_mov_b32 v160, 0
v_mov_b32 v161, 0
v_mov_b32 v162, 0
v_mov_b32 v163, 0
v_mov_b32 v164, 0
v_mov_b32 v165, 0
v_mov_b32 v166, 0
v_mov_b32 v167, 0
v_mov_b32 v168, 0
v_mov_b32 v169, 0
v_mov_b32 v170, 0
v_mov_b32 v171, 0
v_mov_b32 v172, 0
v_mov_b32 v173, 0
v_mov_b32 v174, 0
v_mov_b32 v175, 0
v_mov_b32 v176, 0
v_mov_b32 v177, 0
v_mov_b32 v178, 0
v_mov_b32 v179, 0
v_mov_b32 v180, 0
v_mov_b32 v181, 0
v_mov_b32 v182, 0
v_mov_b32 v183, 0
v_mov_b32 v184, 0
v_mov_b32 v185, 0
v_mov_b32 v186, 0
v_mov_b32 v187, 0
v_mov_b32 v188, 0
v_mov_b32 v189, 0
v_mov_b32 v190, 0
v_mov_b32 v191, 0
s_sub_u32 s78, s56, 33554432
s_lshr_b32 s78, s78, 17
s_lshl_b32 s78, s78, 4
v_and_b32 v84, 15, v0
v_lshrrev_b32 v102, 4, v0
v_lshlrev_b32 v102, 2, v102
v_sub_u32 v84, v84, v102
v_add_u32 v84, s78, v84
L_slow1X0_loop:
s_add_u32 s78, s77, 16777216
buffer_load_dwordx4 a[148:151], v1, s[4:7], s77 offen offset:0 sc1
buffer_load_dwordx4 a[180:183], v1, s[4:7], s78 offen offset:0 sc1
buffer_load_dwordx4 a[152:155], v1, s[4:7], s77 offen offset:1024 sc1
buffer_load_dwordx4 a[184:187], v1, s[4:7], s78 offen offset:1024 sc1
buffer_load_dwordx4 a[156:159], v1, s[4:7], s77 offen offset:2048 sc1
buffer_load_dwordx4 a[188:191], v1, s[4:7], s78 offen offset:2048 sc1
buffer_load_dwordx4 a[160:163], v1, s[4:7], s77 offen offset:3072 sc1
buffer_load_dwordx4 a[192:195], v1, s[4:7], s78 offen offset:3072 sc1
s_add_u32 s77, s77, 4096
s_add_u32 s78, s78, 4096
buffer_load_dwordx4 a[164:167], v1, s[4:7], s77 offen offset:0 sc1
buffer_load_dwordx4 a[200:203], v1, s[4:7], s78 offen offset:0 sc1
buffer_load_dwordx4 a[168:171], v1, s[4:7], s77 offen offset:1024 sc1
buffer_load_dwordx4 a[208:211], v1, s[4:7], s78 offen offset:1024 sc1
buffer_load_dwordx4 a[172:175], v1, s[4:7], s77 offen offset:2048 sc1
buffer_load_dwordx4 a[216:219], v1, s[4:7], s78 offen offset:2048 sc1
buffer_load_dwordx4 a[176:179], v1, s[4:7], s77 offen offset:3072 sc1
buffer_load_dwordx4 a[224:227], v1, s[4:7], s78 offen offset:3072 sc1
s_add_u32 s77, s77, 4096
s_waitcnt vmcnt(0)
v_mfma_f32_16x16x32_bf16 v[40:43], a[148:151], a[16:19], 0
v_mfma_f32_16x16x32_bf16 v[40:43], a[152:155], a[20:23], v[40:43]
v_mfma_f32_16x16x32_bf16 v[40:43], a[156:159], a[24:27], v[40:43]
v_mfma_f32_16x16x32_bf16 v[40:43], a[160:163], a[28:31], v[40:43]
v_mfma_f32_16x16x32_bf16 v[44:47], a[164:167], a[16:19], 0
v_mfma_f32_16x16x32_bf16 v[44:47], a[168:171], a[20:23], v[44:47]
v_mfma_f32_16x16x32_bf16 v[44:47], a[172:175], a[24:27], v[44:47]
v_mfma_f32_16x16x32_bf16 v[44:47], a[176:179], a[28:31], v[44:47]
s_nop 7
s_nop 3
v_cmp_gt_i32 vcc, 0, v84
s_nop 1
v_cndmask_b32 v40, v40, v29, vcc
v_cmp_gt_i32 vcc, 1, v84
s_nop 1
v_cndmask_b32 v41, v41, v29, vcc
v_cmp_gt_i32 vcc, 2, v84
s_nop 1
v_cndmask_b32 v42, v42, v29, vcc
v_cmp_gt_i32 vcc, 3, v84
s_nop 1
v_cndmask_b32 v43, v43, v29, vcc
v_cmp_gt_i32 vcc, 16, v84
s_nop 1
v_cndmask_b32 v44, v44, v29, vcc
v_cmp_gt_i32 vcc, 17, v84
s_nop 1
v_cndmask_b32 v45, v45, v29, vcc
v_cmp_gt_i32 vcc, 18, v84
s_nop 1
v_cndmask_b32 v46, v46, v29, vcc
v_cmp_gt_i32 vcc, 19, v84
s_nop 1
v_cndmask_b32 v47, v47, v29, vcc
v_mov_b32 v102, v100
v_max_f32 v102, v102, v40
v_max_f32 v102, v102, v41
v_max_f32 v102, v102, v42
v_max_f32 v102, v102, v43
v_max_f32 v102, v102, v44
v_max_f32 v102, v102, v45
v_max_f32 v102, v102, v46
v_max_f32 v102, v102, v47
v_mov_b32 v103, v102
s_nop 1
v_permlane16_swap_b32 v102, v103
s_nop 1
v_max_f32 v102, v102, v103
v_mov_b32 v103, v102
s_nop 1
v_permlane32_swap_b32 v102, v103
s_nop 1
v_max_f32 v102, v102, v103
v_sub_f32 v103, v100, v102
v_mov_b32 v100, v102
v_exp_f32 v103, v103
v_sub_f32 v40, v40, v100
v_exp_f32 v40, v40
v_sub_f32 v41, v41, v100
v_exp_f32 v41, v41
v_sub_f32 v42, v42, v100
v_exp_f32 v42, v42
v_sub_f32 v43, v43, v100
v_exp_f32 v43, v43
v_sub_f32 v44, v44, v100
v_exp_f32 v44, v44
v_sub_f32 v45, v45, v100
v_exp_f32 v45, v45
v_sub_f32 v46, v46, v100
v_exp_f32 v46, v46
v_sub_f32 v47, v47, v100
v_exp_f32 v47, v47
v_mul_f32 v101, v101, v103
v_add_f32 v101, v101, v40
v_add_f32 v101, v101, v41
v_add_f32 v101, v101, v42
v_add_f32 v101, v101, v43
v_add_f32 v101, v101, v44
v_add_f32 v101, v101, v45
v_add_f32 v101, v101, v46
v_add_f32 v101, v101, v47
v_cvt_pk_bf16_f32 v68, v40, v41
v_cvt_pk_bf16_f32 v69, v42, v43
v_cvt_pk_bf16_f32 v70, v44, v45
v_cvt_pk_bf16_f32 v71, v46, v47
v_mul_f32 v160, v103, v160
v_mul_f32 v161, v103, v161
v_mul_f32 v162, v103, v162
v_mul_f32 v163, v103, v163
v_mul_f32 v164, v103, v164
v_mul_f32 v165, v103, v165
v_mul_f32 v166, v103, v166
v_mul_f32 v167, v103, v167
v_mul_f32 v168, v103, v168
v_mul_f32 v169, v103, v169
v_mul_f32 v170, v103, v170
v_mul_f32 v171, v103, v171
v_mul_f32 v172, v103, v172
v_mul_f32 v173, v103, v173
v_mul_f32 v174, v103, v174
v_mul_f32 v175, v103, v175
v_mul_f32 v176, v103, v176
v_mul_f32 v177, v103, v177
v_mul_f32 v178, v103, v178
v_mul_f32 v179, v103, v179
v_mul_f32 v180, v103, v180
v_mul_f32 v181, v103, v181
v_mul_f32 v182, v103, v182
v_mul_f32 v183, v103, v183
v_mul_f32 v184, v103, v184
v_mul_f32 v185, v103, v185
v_mul_f32 v186, v103, v186
v_mul_f32 v187, v103, v187
v_mul_f32 v188, v103, v188
v_mul_f32 v189, v103, v189
v_mul_f32 v190, v103, v190
v_mul_f32 v191, v103, v191
v_subrev_u32 v84, 32, v84
s_nop 1
v_mfma_f32_16x16x32_bf16 v[160:163], a[180:183], v[68:71], v[160:163]
v_mfma_f32_16x16x32_bf16 v[164:167], a[184:187], v[68:71], v[164:167]
v_mfma_f32_16x16x32_bf16 v[168:171], a[188:191], v[68:71], v[168:171]
v_mfma_f32_16x16x32_bf16 v[172:175], a[192:195], v[68:71], v[172:175]
v_mfma_f32_16x16x32_bf16 v[176:179], a[200:203], v[68:71], v[176:179]
v_mfma_f32_16x16x32_bf16 v[180:183], a[208:211], v[68:71], v[180:183]
v_mfma_f32_16x16x32_bf16 v[184:187], a[216:219], v[68:71], v[184:187]
v_mfma_f32_16x16x32_bf16 v[188:191], a[224:227], v[68:71], v[188:191]
s_nop 7
s_nop 3
s_add_u32 s94, s94, 1
s_cmp_lt_u32 s94, s76
s_cbranch_scc1 L_slow1X0_loop
v_mov_b32 v103, v101
s_nop 1
v_permlane16_swap_b32 v101, v103
s_nop 1
v_add_f32 v101, v101, v103
v_mov_b32 v103, v101
s_nop 1
v_permlane32_swap_b32 v101, v103
s_nop 1
v_add_f32 v101, v101, v103
v_accvgpr_write_b32 a132, v101
s_nop 3
s_branch L_back_slow1X0
L_spin_fv11:
s_mov_b32 s93, 0x8000
L_spinloop_fv11:
buffer_load_dword v19, v3, s[4:7], s77 offen sc1
s_waitcnt vmcnt(0)
v_cmp_ne_u32 vcc, v19, v18
s_nop 1
s_cbranch_vccz L_back_fv11
s_sub_u32 s93, s93, 1
s_cmp_lg_u32 s93, 0
s_cbranch_scc1 L_spinloop_fv11
v_mov_b32 v19, 9
buffer_store_dword v19, v20, s[44:47], 0 offen offset:4
s_branch L_back_fv11
L_spin_fv12:
s_mov_b32 s93, 0x8000
L_spinloop_fv12:
buffer_load_dword v19, v3, s[4:7], s77 offen sc1
s_waitcnt vmcnt(0)
v_cmp_ne_u32 vcc, v19, v18
s_nop 1
s_cbranch_vccz L_back_fv12
s_sub_u32 s93, s93, 1
s_cmp_lg_u32 s93, 0
s_cbranch_scc1 L_spinloop_fv12
v_mov_b32 v19, 9
buffer_store_dword v19, v20, s[44:47], 0 offen offset:4
s_branch L_back_fv12
L_slow0Y0:
s_waitcnt vmcnt(0)
s_nop 7
s_lshl_b32 s76, s50, 2
s_add_u32 s76, s76, 4
s_lshl_b32 s77, s49, 19
s_mov_b32 s94, 0
v_mov_b32 v96, v29
v_mov_b32 v97, 0
v_mov_b32 v128, 0
v_mov_b32 v129, 0
v_mov_b32 v130, 0
v_mov_b32 v131, 0
v_mov_b32 v132, 0
v_mov_b32 v133, 0
v_mov_b32 v134, 0
v_mov_b32 v135, 0
v_mov_b32 v136, 0
v_mov_b32 v137, 0
v_mov_b32 v138, 0
v_mov_b32 v139, 0
v_mov_b32 v140, 0
v_mov_b32 v141, 0
v_mov_b32 v142, 0
v_mov_b32 v143, 0
v_mov_b32 v144, 0
v_mov_b32 v145, 0
v_mov_b32 v146, 0
v_mov_b32 v147, 0
v_mov_b32 v148, 0
v_mov_b32 v149, 0
v_mov_b32 v150, 0
v_mov_b32 v151, 0
v_mov_b32 v152, 0
v_mov_b32 v153, 0
v_mov_b32 v154, 0
v_mov_b32 v155, 0
v_mov_b32 v156, 0
v_mov_b32 v157, 0
v_mov_b32 v158, 0
v_mov_b32 v159, 0
s_sub_u32 s78, s55, 33554432
s_lshr_b32 s78, s78, 17
s_lshl_b32 s78, s78, 4
v_and_b32 v80, 15, v0
v_lshrrev_b32 v98, 4, v0
v_lshlrev_b32 v98, 2, v98
v_sub_u32 v80, v80, v98
v_add_u32 v80, s78, v80
L_slow0Y0_loop:
s_add_u32 s78, s77, 16777216
buffer_load_dwordx4 a[148:151], v1, s[4:7], s77 offen offset:0 sc1
buffer_load_dwordx4 a[180:183], v1, s[4:7], s78 offen offset:0 sc1
buffer_load_dwordx4 a[152:155], v1, s[4:7], s77 offen offset:1024 sc1
buffer_load_dwordx4 a[184:187], v1, s[4:7], s78 offen offset:1024 sc1
buffer_load_dwordx4 a[156:159], v1, s[4:7], s77 offen offset:2048 sc1
buffer_load_dwordx4 a[188:191], v1, s[4:7], s78 offen offset:2048 sc1
buffer_load_dwordx4 a[160:163], v1, s[4:7], s77 offen offset:3072 sc1
buffer_load_dwordx4 a[192:195], v1, s[4:7], s78 offen offset:3072 sc1
s_add_u32 s77, s77, 4096
s_add_u32 s78, s78, 4096
buffer_load_dwordx4 a[164:167], v1, s[4:7], s77 offen offset:0 sc1
buffer_load_dwordx4 a[200:203], v1, s[4:7], s78 offen offset:0 sc1
buffer_load_dwordx4 a[168:171], v1, s[4:7], s77 offen offset:1024 sc1
buffer_load_dwordx4 a[208:211], v1, s[4:7], s78 offen offset:1024 sc1
buffer_load_dwordx4 a[172:175], v1, s[4:7], s77 offen offset:2048 sc1
buffer_load_dwordx4 a[216:219], v1, s[4:7], s78 offen offset:2048 sc1
buffer_load_dwordx4 a[176:179], v1, s[4:7], s77 offen offset:3072 sc1
buffer_load_dwordx4 a[224:227], v1, s[4:7], s78 offen offset:3072 sc1
s_add_u32 s77, s77, 4096
s_waitcnt vmcnt(0)
v_mfma_f32_16x16x32_bf16 v[32:35], a[148:151], a[0:3], 0
v_mfma_f32_16x16x32_bf16 v[32:35], a[152:155], a[4:7], v[32:35]
v_mfma_f32_16x16x32_bf16 v[32:35], a[156:159], a[8:11], v[32:35]
v_mfma_f32_16x16x32_bf16 v[32:35], a[160:163], a[12:15], v[32:35]
v_mfma_f32_16x16x32_bf16 v[36:39], a[164:167], a[0:3], 0
v_mfma_f32_16x16x32_bf16 v[36:39], a[168:171], a[4:7], v[36:39]
v_mfma_f32_16x16x32_bf16 v[36:39], a[172:175], a[8:11], v[36:39]
v_mfma_f32_16x16x32_bf16 v[36:39], a[176:179], a[12:15], v[36:39]
s_nop 7
s_nop 3
v_cmp_gt_i32 vcc, 0, v80
s_nop 1
v_cndmask_b32 v32, v32, v29, vcc
v_cmp_gt_i32 vcc, 1, v80
s_nop 1
v_cndmask_b32 v33, v33, v29, vcc
v_cmp_gt_i32 vcc, 2, v80
s_nop 1
v_cndmask_b32 v34, v34, v29, vcc
v_cmp_gt_i32 vcc, 3, v80
s_nop 1
v_cndmask_b32 v35, v35, v29, vcc
v_cmp_gt_i32 vcc, 16, v80
s_nop 1
v_cndmask_b32 v36, v36, v29, vcc
v_cmp_gt_i32 vcc, 17, v80
s_nop 1
v_cndmask_b32 v37, v37, v29, vcc
v_cmp_gt_i32 vcc, 18, v80
s_nop 1
v_cndmask_b32 v38, v38, v29, vcc
v_cmp_gt_i32 vcc, 19, v80
s_nop 1
v_cndmask_b32 v39, v39, v29, vcc
v_mov_b32 v98, v96
v_max_f32 v98, v98, v32
v_max_f32 v98, v98, v33
v_max_f32 v98, v98, v34
v_max_f32 v98, v98, v35
v_max_f32 v98, v98, v36
v_max_f32 v98, v98, v37
v_max_f32 v98, v98, v38
v_max_f32 v98, v98, v39
v_mov_b32 v99, v98
s_nop 1
v_permlane16_swap_b32 v98, v99
s_nop 1
v_max_f32 v98, v98, v99
v_mov_b32 v99, v98
s_nop 1
v_permlane32_swap_b32 v98, v99
s_nop 1
v_max_f32 v98, v98, v99
v_sub_f32 v99, v96, v98
v_mov_b32 v96, v98
v_exp_f32 v99, v99
v_sub_f32 v32, v32, v96
v_exp_f32 v32, v32
v_sub_f32 v33, v33, v96
v_exp_f32 v33, v33
v_sub_f32 v34, v34, v96
v_exp_f32 v34, v34
v_sub_f32 v35, v35, v96
v_exp_f32 v35, v35
v_sub_f32 v36, v36, v96
v_exp_f32 v36, v36
v_sub_f32 v37, v37, v96
v_exp_f32 v37, v37
v_sub_f32 v38, v38, v96
v_exp_f32 v38, v38
v_sub_f32 v39, v39, v96
v_exp_f32 v39, v39
v_mul_f32 v97, v97, v99
v_add_f32 v97, v97, v32
v_add_f32 v97, v97, v33
v_add_f32 v97, v97, v34
v_add_f32 v97, v97, v35
v_add_f32 v97, v97, v36
v_add_f32 v97, v97, v37
v_add_f32 v97, v97, v38
v_add_f32 v97, v97, v39
v_cvt_pk_bf16_f32 v64, v32, v33
v_cvt_pk_bf16_f32 v65, v34, v35
v_cvt_pk_bf16_f32 v66, v36, v37
v_cvt_pk_bf16_f32 v67, v38, v39
v_mul_f32 v128, v99, v128
v_mul_f32 v129, v99, v129
v_mul_f32 v130, v99, v130
v_mul_f32 v131, v99, v131
v_mul_f32 v132, v99, v132
v_mul_f32 v133, v99, v133
v_mul_f32 v134, v99, v134
v_mul_f32 v135, v99, v135
v_mul_f32 v136, v99, v136
v_mul_f32 v137, v99, v137
v_mul_f32 v138, v99, v138
v_mul_f32 v139, v99, v139
v_mul_f32 v140, v99, v140
v_mul_f32 v141, v99, v141
v_mul_f32 v142, v99, v142
v_mul_f32 v143, v99, v143
v_mul_f32 v144, v99, v144
v_mul_f32 v145, v99, v145
v_mul_f32 v146, v99, v146
v_mul_f32 v147, v99, v147
v_mul_f32 v148, v99, v148
v_mul_f32 v149, v99, v149
v_mul_f32 v150, v99, v150
v_mul_f32 v151, v99, v151
v_mul_f32 v152, v99, v152
v_mul_f32 v153, v99, v153
v_mul_f32 v154, v99, v154
v_mul_f32 v155, v99, v155
v_mul_f32 v156, v99, v156
v_mul_f32 v157, v99, v157
v_mul_f32 v158, v99, v158
v_mul_f32 v159, v99, v159
v_subrev_u32 v80, 32, v80
s_nop 1
v_mfma_f32_16x16x32_bf16 v[128:131], a[180:183], v[64:67], v[128:131]
v_mfma_f32_16x16x32_bf16 v[132:135], a[184:187], v[64:67], v[132:135]
v_mfma_f32_16x16x32_bf16 v[136:139], a[188:191], v[64:67], v[136:139]
v_mfma_f32_16x16x32_bf16 v[140:143], a[192:195], v[64:67], v[140:143]
v_mfma_f32_16x16x32_bf16 v[144:147], a[200:203], v[64:67], v[144:147]
v_mfma_f32_16x16x32_bf16 v[148:151], a[208:211], v[64:67], v[148:151]
v_mfma_f32_16x16x32_bf16 v[152:155], a[216:219], v[64:67], v[152:155]
v_mfma_f32_16x16x32_bf16 v[156:159], a[224:227], v[64:67], v[156:159]
s_nop 7
s_nop 3
s_add_u32 s94, s94, 1
s_cmp_lt_u32 s94, s76
s_cbranch_scc1 L_slow0Y0_loop
v_mov_b32 v99, v97
s_nop 1
v_permlane16_swap_b32 v97, v99
s_nop 1
v_add_f32 v97, v97, v99
v_mov_b32 v99, v97
s_nop 1
v_permlane32_swap_b32 v97, v99
s_nop 1
v_add_f32 v97, v97, v99
v_accvgpr_write_b32 a128, v97
s_nop 3
s_branch L_back_slow0Y0
L_slow1Y0:
s_waitcnt vmcnt(0)
s_nop 7
s_lshl_b32 s76, s50, 2
s_add_u32 s76, s76, 4
s_lshl_b32 s77, s49, 19
s_mov_b32 s94, 0
v_mov_b32 v100, v29
v_mov_b32 v101, 0
v_mov_b32 v160, 0
v_mov_b32 v161, 0
v_mov_b32 v162, 0
v_mov_b32 v163, 0
v_mov_b32 v164, 0
v_mov_b32 v165, 0
v_mov_b32 v166, 0
v_mov_b32 v167, 0
v_mov_b32 v168, 0
v_mov_b32 v169, 0
v_mov_b32 v170, 0
v_mov_b32 v171, 0
v_mov_b32 v172, 0
v_mov_b32 v173, 0
v_mov_b32 v174, 0
v_mov_b32 v175, 0
v_mov_b32 v176, 0
v_mov_b32 v177, 0
v_mov_b32 v178, 0
v_mov_b32 v179, 0
v_mov_b32 v180, 0
v_mov_b32 v181, 0
v_mov_b32 v182, 0
v_mov_b32 v183, 0
v_mov_b32 v184, 0
v_mov_b32 v185, 0
v_mov_b32 v186, 0
v_mov_b32 v187, 0
v_mov_b32 v188, 0
v_mov_b32 v189, 0
v_mov_b32 v190, 0
v_mov_b32 v191, 0
s_sub_u32 s78, s56, 33554432
s_lshr_b32 s78, s78, 17
s_lshl_b32 s78, s78, 4
v_and_b32 v84, 15, v0
v_lshrrev_b32 v102, 4, v0
v_lshlrev_b32 v102, 2, v102
v_sub_u32 v84, v84, v102
v_add_u32 v84, s78, v84
L_slow1Y0_loop:
s_add_u32 s78, s77, 16777216
buffer_load_dwordx4 a[148:151], v1, s[4:7], s77 offen offset:0 sc1
buffer_load_dwordx4 a[180:183], v1, s[4:7], s78 offen offset:0 sc1
buffer_load_dwordx4 a[152:155], v1, s[4:7], s77 offen offset:1024 sc1
buffer_load_dwordx4 a[184:187], v1, s[4:7], s78 offen offset:1024 sc1
buffer_load_dwordx4 a[156:159], v1, s[4:7], s77 offen offset:2048 sc1
buffer_load_dwordx4 a[188:191], v1, s[4:7], s78 offen offset:2048 sc1
buffer_load_dwordx4 a[160:163], v1, s[4:7], s77 offen offset:3072 sc1
buffer_load_dwordx4 a[192:195], v1, s[4:7], s78 offen offset:3072 sc1
s_add_u32 s77, s77, 4096
s_add_u32 s78, s78, 4096
buffer_load_dwordx4 a[164:167], v1, s[4:7], s77 offen offset:0 sc1
buffer_load_dwordx4 a[200:203], v1, s[4:7], s78 offen offset:0 sc1
buffer_load_dwordx4 a[168:171], v1, s[4:7], s77 offen offset:1024 sc1
buffer_load_dwordx4 a[208:211], v1, s[4:7], s78 offen offset:1024 sc1
buffer_load_dwordx4 a[172:175], v1, s[4:7], s77 offen offset:2048 sc1
buffer_load_dwordx4 a[216:219], v1, s[4:7], s78 offen offset:2048 sc1
buffer_load_dwordx4 a[176:179], v1, s[4:7], s77 offen offset:3072 sc1
buffer_load_dwordx4 a[224:227], v1, s[4:7], s78 offen offset:3072 sc1
s_add_u32 s77, s77, 4096
s_waitcnt vmcnt(0)
v_mfma_f32_16x16x32_bf16 v[40:43], a[148:151], a[16:19], 0
v_mfma_f32_16x16x32_bf16 v[40:43], a[152:155], a[20:23], v[40:43]
v_mfma_f32_16x16x32_bf16 v[40:43], a[156:159], a[24:27], v[40:43]
v_mfma_f32_16x16x32_bf16 v[40:43], a[160:163], a[28:31], v[40:43]
v_mfma_f32_16x16x32_bf16 v[44:47], a[164:167], a[16:19], 0
v_mfma_f32_16x16x32_bf16 v[44:47], a[168:171], a[20:23], v[44:47]
v_mfma_f32_16x16x32_bf16 v[44:47], a[172:175], a[24:27], v[44:47]
v_mfma_f32_16x16x32_bf16 v[44:47], a[176:179], a[28:31], v[44:47]
s_nop 7
s_nop 3
v_cmp_gt_i32 vcc, 0, v84
s_nop 1
v_cndmask_b32 v40, v40, v29, vcc
v_cmp_gt_i32 vcc, 1, v84
s_nop 1
v_cndmask_b32 v41, v41, v29, vcc
v_cmp_gt_i32 vcc, 2, v84
s_nop 1
v_cndmask_b32 v42, v42, v29, vcc
v_cmp_gt_i32 vcc, 3, v84
s_nop 1
v_cndmask_b32 v43, v43, v29, vcc
v_cmp_gt_i32 vcc, 16, v84
s_nop 1
v_cndmask_b32 v44, v44, v29, vcc
v_cmp_gt_i32 vcc, 17, v84
s_nop 1
v_cndmask_b32 v45, v45, v29, vcc
v_cmp_gt_i32 vcc, 18, v84
s_nop 1
v_cndmask_b32 v46, v46, v29, vcc
v_cmp_gt_i32 vcc, 19, v84
s_nop 1
v_cndmask_b32 v47, v47, v29, vcc
v_mov_b32 v102, v100
v_max_f32 v102, v102, v40
v_max_f32 v102, v102, v41
v_max_f32 v102, v102, v42
v_max_f32 v102, v102, v43
v_max_f32 v102, v102, v44
v_max_f32 v102, v102, v45
v_max_f32 v102, v102, v46
v_max_f32 v102, v102, v47
v_mov_b32 v103, v102
s_nop 1
v_permlane16_swap_b32 v102, v103
s_nop 1
v_max_f32 v102, v102, v103
v_mov_b32 v103, v102
s_nop 1
v_permlane32_swap_b32 v102, v103
s_nop 1
v_max_f32 v102, v102, v103
v_sub_f32 v103, v100, v102
v_mov_b32 v100, v102
v_exp_f32 v103, v103
v_sub_f32 v40, v40, v100
v_exp_f32 v40, v40
v_sub_f32 v41, v41, v100
v_exp_f32 v41, v41
v_sub_f32 v42, v42, v100
v_exp_f32 v42, v42
v_sub_f32 v43, v43, v100
v_exp_f32 v43, v43
v_sub_f32 v44, v44, v100
v_exp_f32 v44, v44
v_sub_f32 v45, v45, v100
v_exp_f32 v45, v45
v_sub_f32 v46, v46, v100
v_exp_f32 v46, v46
v_sub_f32 v47, v47, v100
v_exp_f32 v47, v47
v_mul_f32 v101, v101, v103
v_add_f32 v101, v101, v40
v_add_f32 v101, v101, v41
v_add_f32 v101, v101, v42
v_add_f32 v101, v101, v43
v_add_f32 v101, v101, v44
v_add_f32 v101, v101, v45
v_add_f32 v101, v101, v46
v_add_f32 v101, v101, v47
v_cvt_pk_bf16_f32 v68, v40, v41
v_cvt_pk_bf16_f32 v69, v42, v43
v_cvt_pk_bf16_f32 v70, v44, v45
v_cvt_pk_bf16_f32 v71, v46, v47
v_mul_f32 v160, v103, v160
v_mul_f32 v161, v103, v161
v_mul_f32 v162, v103, v162
v_mul_f32 v163, v103, v163
v_mul_f32 v164, v103, v164
v_mul_f32 v165, v103, v165
v_mul_f32 v166, v103, v166
v_mul_f32 v167, v103, v167
v_mul_f32 v168, v103, v168
v_mul_f32 v169, v103, v169
v_mul_f32 v170, v103, v170
v_mul_f32 v171, v103, v171
v_mul_f32 v172, v103, v172
v_mul_f32 v173, v103, v173
v_mul_f32 v174, v103, v174
v_mul_f32 v175, v103, v175
v_mul_f32 v176, v103, v176
v_mul_f32 v177, v103, v177
v_mul_f32 v178, v103, v178
v_mul_f32 v179, v103, v179
v_mul_f32 v180, v103, v180
v_mul_f32 v181, v103, v181
v_mul_f32 v182, v103, v182
v_mul_f32 v183, v103, v183
v_mul_f32 v184, v103, v184
v_mul_f32 v185, v103, v185
v_mul_f32 v186, v103, v186
v_mul_f32 v187, v103, v187
v_mul_f32 v188, v103, v188
v_mul_f32 v189, v103, v189
v_mul_f32 v190, v103, v190
v_mul_f32 v191, v103, v191
v_subrev_u32 v84, 32, v84
s_nop 1
v_mfma_f32_16x16x32_bf16 v[160:163], a[180:183], v[68:71], v[160:163]
v_mfma_f32_16x16x32_bf16 v[164:167], a[184:187], v[68:71], v[164:167]
v_mfma_f32_16x16x32_bf16 v[168:171], a[188:191], v[68:71], v[168:171]
v_mfma_f32_16x16x32_bf16 v[172:175], a[192:195], v[68:71], v[172:175]
v_mfma_f32_16x16x32_bf16 v[176:179], a[200:203], v[68:71], v[176:179]
v_mfma_f32_16x16x32_bf16 v[180:183], a[208:211], v[68:71], v[180:183]
v_mfma_f32_16x16x32_bf16 v[184:187], a[216:219], v[68:71], v[184:187]
v_mfma_f32_16x16x32_bf16 v[188:191], a[224:227], v[68:71], v[188:191]
s_nop 7
s_nop 3
s_add_u32 s94, s94, 1
s_cmp_lt_u32 s94, s76
s_cbranch_scc1 L_slow1Y0_loop
v_mov_b32 v103, v101
s_nop 1
v_permlane16_swap_b32 v101, v103
s_nop 1
v_add_f32 v101, v101, v103
v_mov_b32 v103, v101
s_nop 1
v_permlane32_swap_b32 v101, v103
s_nop 1
v_add_f32 v101, v101, v103
v_accvgpr_write_b32 a132, v101
s_nop 3
s_branch L_back_slow1Y0
L_spin_fv13:
s_mov_b32 s93, 0x8000
L_spinloop_fv13:
buffer_load_dword v19, v3, s[4:7], s77 offen sc1
s_waitcnt vmcnt(0)
v_cmp_ne_u32 vcc, v19, v18
s_nop 1
s_cbranch_vccz L_back_fv13
s_sub_u32 s93, s93, 1
s_cmp_lg_u32 s93, 0
s_cbranch_scc1 L_spinloop_fv13
v_mov_b32 v19, 9
buffer_store_dword v19, v20, s[44:47], 0 offen offset:4
s_branch L_back_fv13
L_spin_fv14:
s_mov_b32 s93, 0x8000
L_spinloop_fv14:
buffer_load_dword v19, v3, s[4:7], s77 offen sc1
s_waitcnt vmcnt(0)
v_cmp_ne_u32 vcc, v19, v18
s_nop 1
s_cbranch_vccz L_back_fv14
s_sub_u32 s93, s93, 1
s_cmp_lg_u32 s93, 0
s_cbranch_scc1 L_spinloop_fv14
v_mov_b32 v19, 9
buffer_store_dword v19, v20, s[44:47], 0 offen offset:4
s_branch L_back_fv14
L_spin_fv15:
s_mov_b32 s93, 0x8000
L_spinloop_fv15:
buffer_load_dword v19, v3, s[4:7], s77 offen sc1
s_waitcnt vmcnt(0)
v_cmp_ne_u32 vcc, v19, v18
s_nop 1
s_cbranch_vccz L_back_fv15
s_sub_u32 s93, s93, 1
s_cmp_lg_u32 s93, 0
s_cbranch_scc1 L_spinloop_fv15
v_mov_b32 v19, 9
buffer_store_dword v19, v20, s[44:47], 0 offen offset:4
s_branch L_back_fv15
L_spin_fv16:
s_mov_b32 s93, 0x8000
L_spinloop_fv16:
buffer_load_dword v19, v3, s[4:7], s77 offen sc1
s_waitcnt vmcnt(0)
v_cmp_ne_u32 vcc, v19, v18
s_nop 1
s_cbranch_vccz L_back_fv16
s_sub_u32 s93, s93, 1
s_cmp_lg_u32 s93, 0
s_cbranch_scc1 L_spinloop_fv16
v_mov_b32 v19, 9
buffer_store_dword v19, v20, s[44:47], 0 offen offset:4
s_branch L_back_fv16
L_spin_fv17:
s_mov_b32 s93, 0x8000
L_spinloop_fv17:
buffer_load_dword v19, v3, s[4:7], s77 offen sc1
s_waitcnt vmcnt(0)
v_cmp_ne_u32 vcc, v19, v18
s_nop 1
s_cbranch_vccz L_back_fv17
s_sub_u32 s93, s93, 1
s_cmp_lg_u32 s93, 0
s_cbranch_scc1 L_spinloop_fv17
v_mov_b32 v19, 9
buffer_store_dword v19, v20, s[44:47], 0 offen offset:4
s_branch L_back_fv17
L_spin_fv18:
s_mov_b32 s93, 0x8000
L_spinloop_fv18:
buffer_load_dword v19, v3, s[4:7], s77 offen sc1
s_waitcnt vmcnt(0)
v_cmp_ne_u32 vcc, v19, v18
s_nop 1
s_cbranch_vccz L_back_fv18
s_sub_u32 s93, s93, 1
s_cmp_lg_u32 s93, 0
s_cbranch_scc1 L_spinloop_fv18
v_mov_b32 v19, 9
buffer_store_dword v19, v20, s[44:47], 0 offen offset:4
s_branch L_back_fv18
L_spin_fb2P:
s_mov_b32 s93, 0x8000
L_spinloop_fb2P:
buffer_load_dword v23, v21, s[4:7], s78 offen sc1
s_waitcnt vmcnt(0)
v_cmp_ne_u32 vcc, v23, v18
s_nop 1
s_cbranch_vccz L_back_fb2P
s_sub_u32 s93, s93, 1
s_cmp_lg_u32 s93, 0
s_cbranch_scc1 L_spinloop_fb2P
v_mov_b32 v19, 5
buffer_store_dword v19, v20, s[44:47], 0 offen offset:4
s_branch L_back_fb2P
L_spin_fb2C:
s_mov_b32 s93, 0x8000
L_spinloop_fb2C:
buffer_load_dword v19, v21, s[4:7], s78 offen sc1
s_waitcnt vmcnt(0)
v_cmp_ne_u32 vcc, v19, v18
s_nop 1
s_cbranch_vccz L_back_fb2C
s_sub_u32 s93, s93, 1
s_cmp_lg_u32 s93, 0
s_cbranch_scc1 L_spinloop_fb2C
v_mov_b32 v19, 5
buffer_store_dword v19, v20, s[44:47], 0 offen offset:4
s_branch L_back_fb2C
L_slow2X:
s_waitcnt vmcnt(0)
s_nop 7
s_lshl_b32 s76, s50, 2
s_sub_u32 s76, 64, s76
s_lshl_b32 s77, s49, 19
s_mov_b32 s94, 0
v_mov_b32 v96, v29
v_mov_b32 v97, 0
v_mov_b32 v192, 0
v_mov_b32 v193, 0
v_mov_b32 v194, 0
v_mov_b32 v195, 0
v_mov_b32 v196, 0
v_mov_b32 v197, 0
v_mov_b32 v198, 0
v_mov_b32 v199, 0
v_mov_b32 v200, 0
v_mov_b32 v201, 0
v_mov_b32 v202, 0
v_mov_b32 v203, 0
v_mov_b32 v204, 0
v_mov_b32 v205, 0
v_mov_b32 v206, 0
v_mov_b32 v207, 0
v_mov_b32 v208, 0
v_mov_b32 v209, 0
v_mov_b32 v210, 0
v_mov_b32 v211, 0
v_mov_b32 v212, 0
v_mov_b32 v213, 0
v_mov_b32 v214, 0
v_mov_b32 v215, 0
v_mov_b32 v216, 0
v_mov_b32 v217, 0
v_mov_b32 v218, 0
v_mov_b32 v219, 0
v_mov_b32 v220, 0
v_mov_b32 v221, 0
v_mov_b32 v222, 0
v_mov_b32 v223, 0
s_sub_u32 s78, s57, 33554432
s_lshr_b32 s78, s78, 17
s_lshl_b32 s78, s78, 4
v_and_b32 v100, 15, v0
v_lshrrev_b32 v98, 4, v0
v_lshlrev_b32 v98, 2, v98
v_sub_u32 v100, v100, v98
v_add_u32 v100, s78, v100
L_slow2X_loop:
s_add_u32 s78, s77, 16777216
buffer_load_dwordx4 a[0:3], v1, s[4:7], s77 offen offset:0 sc1
buffer_load_dwordx4 a[200:203], v1, s[4:7], s78 offen offset:0 sc1
buffer_load_dwordx4 a[4:7], v1, s[4:7], s77 offen offset:1024 sc1
buffer_load_dwordx4 a[208:211], v1, s[4:7], s78 offen offset:1024 sc1
buffer_load_dwordx4 a[8:11], v1, s[4:7], s77 offen offset:2048 sc1
buffer_load_dwordx4 a[216:219], v1, s[4:7], s78 offen offset:2048 sc1
buffer_load_dwordx4 a[12:15], v1, s[4:7], s77 offen offset:3072 sc1
buffer_load_dwordx4 a[224:227], v1, s[4:7], s78 offen offset:3072 sc1
s_add_u32 s77, s77, 4096
s_add_u32 s78, s78, 4096
buffer_load_dwordx4 a[16:19], v1, s[4:7], s77 offen offset:0 sc1
buffer_load_dwordx4 a[232:235], v1, s[4:7], s78 offen offset:0 sc1
buffer_load_dwordx4 a[20:23], v1, s[4:7], s77 offen offset:1024 sc1
buffer_load_dwordx4 a[240:243], v1, s[4:7], s78 offen offset:1024 sc1
buffer_load_dwordx4 a[24:27], v1, s[4:7], s77 offen offset:2048 sc1
buffer_load_dwordx4 a[248:251], v1, s[4:7], s78 offen offset:2048 sc1
buffer_load_dwordx4 a[28:31], v1, s[4:7], s77 offen offset:3072 sc1
buffer_load_dwordx4 a[196:199], v1, s[4:7], s78 offen offset:3072 sc1
s_add_u32 s77, s77, 4096
s_waitcnt vmcnt(0)
v_mfma_f32_16x16x32_bf16 v[32:35], a[0:3], a[32:35], 0
v_mfma_f32_16x16x32_bf16 v[32:35], a[4:7], a[36:39], v[32:35]
v_mfma_f32_16x16x32_bf16 v[32:35], a[8:11], a[40:43], v[32:35]
v_mfma_f32_16x16x32_bf16 v[32:35], a[12:15], a[44:47], v[32:35]
v_mfma_f32_16x16x32_bf16 v[36:39], a[16:19], a[32:35], 0
v_mfma_f32_16x16x32_bf16 v[36:39], a[20:23], a[36:39], v[36:39]
v_mfma_f32_16x16x32_bf16 v[36:39], a[24:27], a[40:43], v[36:39]
v_mfma_f32_16x16x32_bf16 v[36:39], a[28:31], a[44:47], v[36:39]
s_nop 7
s_nop 3
v_cmp_gt_i32 vcc, 0, v100
s_nop 1
v_cndmask_b32 v32, v32, v29, vcc
v_cmp_gt_i32 vcc, 1, v100
s_nop 1
v_cndmask_b32 v33, v33, v29, vcc
v_cmp_gt_i32 vcc, 2, v100
s_nop 1
v_cndmask_b32 v34, v34, v29, vcc
v_cmp_gt_i32 vcc, 3, v100
s_nop 1
v_cndmask_b32 v35, v35, v29, vcc
v_cmp_gt_i32 vcc, 16, v100
s_nop 1
v_cndmask_b32 v36, v36, v29, vcc
v_cmp_gt_i32 vcc, 17, v100
s_nop 1
v_cndmask_b32 v37, v37, v29, vcc
v_cmp_gt_i32 vcc, 18, v100
s_nop 1
v_cndmask_b32 v38, v38, v29, vcc
v_cmp_gt_i32 vcc, 19, v100
s_nop 1
v_cndmask_b32 v39, v39, v29, vcc
v_mov_b32 v98, v96
v_max_f32 v98, v98, v32
v_max_f32 v98, v98, v33
v_max_f32 v98, v98, v34
v_max_f32 v98, v98, v35
v_max_f32 v98, v98, v36
v_max_f32 v98, v98, v37
v_max_f32 v98, v98, v38
v_max_f32 v98, v98, v39
v_mov_b32 v99, v98
s_nop 1
v_permlane16_swap_b32 v98, v99
s_nop 1
v_max_f32 v98, v98, v99
v_mov_b32 v99, v98
s_nop 1
v_permlane32_swap_b32 v98, v99
s_nop 1
v_max_f32 v98, v98, v99
v_sub_f32 v99, v96, v98
v_mov_b32 v96, v98
v_exp_f32 v99, v99
v_sub_f32 v32, v32, v96
v_exp_f32 v32, v32
v_sub_f32 v33, v33, v96
v_exp_f32 v33, v33
v_sub_f32 v34, v34, v96
v_exp_f32 v34, v34
v_sub_f32 v35, v35, v96
v_exp_f32 v35, v35
v_sub_f32 v36, v36, v96
v_exp_f32 v36, v36
v_sub_f32 v37, v37, v96
v_exp_f32 v37, v37
v_sub_f32 v38, v38, v96
v_exp_f32 v38, v38
v_sub_f32 v39, v39, v96
v_exp_f32 v39, v39
v_mul_f32 v97, v97, v99
v_add_f32 v97, v97, v32
v_add_f32 v97, v97, v33
v_add_f32 v97, v97, v34
v_add_f32 v97, v97, v35
v_add_f32 v97, v97, v36
v_add_f32 v97, v97, v37
v_add_f32 v97, v97, v38
v_add_f32 v97, v97, v39
v_cvt_pk_bf16_f32 v84, v32, v33
v_cvt_pk_bf16_f32 v85, v34, v35
v_cvt_pk_bf16_f32 v86, v36, v37
v_cvt_pk_bf16_f32 v87, v38, v39
v_mul_f32 v192, v99, v192
v_mul_f32 v193, v99, v193
v_mul_f32 v194, v99, v194
v_mul_f32 v195, v99, v195
v_mul_f32 v196, v99, v196
v_mul_f32 v197, v99, v197
v_mul_f32 v198, v99, v198
v_mul_f32 v199, v99, v199
v_mul_f32 v200, v99, v200
v_mul_f32 v201, v99, v201
v_mul_f32 v202, v99, v202
v_mul_f32 v203, v99, v203
v_mul_f32 v204, v99, v204
v_mul_f32 v205, v99, v205
v_mul_f32 v206, v99, v206
v_mul_f32 v207, v99, v207
v_mul_f32 v208, v99, v208
v_mul_f32 v209, v99, v209
v_mul_f32 v210, v99, v210
v_mul_f32 v211, v99, v211
v_mul_f32 v212, v99, v212
v_mul_f32 v213, v99, v213
v_mul_f32 v214, v99, v214
v_mul_f32 v215, v99, v215
v_mul_f32 v216, v99, v216
v_mul_f32 v217, v99, v217
v_mul_f32 v218, v99, v218
v_mul_f32 v219, v99, v219
v_mul_f32 v220, v99, v220
v_mul_f32 v221, v99, v221
v_mul_f32 v222, v99, v222
v_mul_f32 v223, v99, v223
v_subrev_u32 v100, 32, v100
s_nop 1
v_mfma_f32_16x16x32_bf16 v[192:195], a[200:203], v[84:87], v[192:195]
v_mfma_f32_16x16x32_bf16 v[196:199], a[208:211], v[84:87], v[196:199]
v_mfma_f32_16x16x32_bf16 v[200:203], a[216:219], v[84:87], v[200:203]
v_mfma_f32_16x16x32_bf16 v[204:207], a[224:227], v[84:87], v[204:207]
v_mfma_f32_16x16x32_bf16 v[208:211], a[232:235], v[84:87], v[208:211]
v_mfma_f32_16x16x32_bf16 v[212:215], a[240:243], v[84:87], v[212:215]
v_mfma_f32_16x16x32_bf16 v[216:219], a[248:251], v[84:87], v[216:219]
v_mfma_f32_16x16x32_bf16 v[220:223], a[196:199], v[84:87], v[220:223]
s_nop 7
s_nop 3
s_add_u32 s94, s94, 1
s_cmp_lt_u32 s94, s76
s_cbranch_scc1 L_slow2X_loop
v_mov_b32 v99, v97
s_nop 1
v_permlane16_swap_b32 v97, v99
s_nop 1
v_add_f32 v97, v97, v99
v_mov_b32 v99, v97
s_nop 1
v_permlane32_swap_b32 v97, v99
s_nop 1
v_add_f32 v97, v97, v99
v_accvgpr_write_b32 a136, v97
s_nop 3
s_branch L_back_slow2X
L_slow2Y:
s_waitcnt vmcnt(0)
s_nop 7
s_lshl_b32 s76, s50, 2
s_sub_u32 s76, 64, s76
s_lshl_b32 s77, s49, 19
s_mov_b32 s94, 0
v_mov_b32 v96, v29
v_mov_b32 v97, 0
v_mov_b32 v192, 0
v_mov_b32 v193, 0
v_mov_b32 v194, 0
v_mov_b32 v195, 0
v_mov_b32 v196, 0
v_mov_b32 v197, 0
v_mov_b32 v198, 0
v_mov_b32 v199, 0
v_mov_b32 v200, 0
v_mov_b32 v201, 0
v_mov_b32 v202, 0
v_mov_b32 v203, 0
v_mov_b32 v204, 0
v_mov_b32 v205, 0
v_mov_b32 v206, 0
v_mov_b32 v207, 0
v_mov_b32 v208, 0
v_mov_b32 v209, 0
v_mov_b32 v210, 0
v_mov_b32 v211, 0
v_mov_b32 v212, 0
v_mov_b32 v213, 0
v_mov_b32 v214, 0
v_mov_b32 v215, 0
v_mov_b32 v216, 0
v_mov_b32 v217, 0
v_mov_b32 v218, 0
v_mov_b32 v219, 0
v_mov_b32 v220, 0
v_mov_b32 v221, 0
v_mov_b32 v222, 0
v_mov_b32 v223, 0
s_sub_u32 s78, s57, 33554432
s_lshr_b32 s78, s78, 17
s_lshl_b32 s78, s78, 4
v_and_b32 v100, 15, v0
v_lshrrev_b32 v98, 4, v0
v_lshlrev_b32 v98, 2, v98
v_sub_u32 v100, v100, v98
v_add_u32 v100, s78, v100
L_slow2Y_loop:
s_add_u32 s78, s77, 16777216
buffer_load_dwordx4 a[0:3], v1, s[4:7], s77 offen offset:0 sc1
buffer_load_dwordx4 a[200:203], v1, s[4:7], s78 offen offset:0 sc1
buffer_load_dwordx4 a[4:7], v1, s[4:7], s77 offen offset:1024 sc1
buffer_load_dwordx4 a[208:211], v1, s[4:7], s78 offen offset:1024 sc1
buffer_load_dwordx4 a[8:11], v1, s[4:7], s77 offen offset:2048 sc1
buffer_load_dwordx4 a[216:219], v1, s[4:7], s78 offen offset:2048 sc1
buffer_load_dwordx4 a[12:15], v1, s[4:7], s77 offen offset:3072 sc1
buffer_load_dwordx4 a[224:227], v1, s[4:7], s78 offen offset:3072 sc1
s_add_u32 s77, s77, 4096
s_add_u32 s78, s78, 4096
buffer_load_dwordx4 a[16:19], v1, s[4:7], s77 offen offset:0 sc1
buffer_load_dwordx4 a[232:235], v1, s[4:7], s78 offen offset:0 sc1
buffer_load_dwordx4 a[20:23], v1, s[4:7], s77 offen offset:1024 sc1
buffer_load_dwordx4 a[240:243], v1, s[4:7], s78 offen offset:1024 sc1
buffer_load_dwordx4 a[24:27], v1, s[4:7], s77 offen offset:2048 sc1
buffer_load_dwordx4 a[248:251], v1, s[4:7], s78 offen offset:2048 sc1
buffer_load_dwordx4 a[28:31], v1, s[4:7], s77 offen offset:3072 sc1
buffer_load_dwordx4 a[196:199], v1, s[4:7], s78 offen offset:3072 sc1
s_add_u32 s77, s77, 4096
s_waitcnt vmcnt(0)
v_mfma_f32_16x16x32_bf16 v[32:35], a[0:3], a[32:35], 0
v_mfma_f32_16x16x32_bf16 v[32:35], a[4:7], a[36:39], v[32:35]
v_mfma_f32_16x16x32_bf16 v[32:35], a[8:11], a[40:43], v[32:35]
v_mfma_f32_16x16x32_bf16 v[32:35], a[12:15], a[44:47], v[32:35]
v_mfma_f32_16x16x32_bf16 v[36:39], a[16:19], a[32:35], 0
v_mfma_f32_16x16x32_bf16 v[36:39], a[20:23], a[36:39], v[36:39]
v_mfma_f32_16x16x32_bf16 v[36:39], a[24:27], a[40:43], v[36:39]
v_mfma_f32_16x16x32_bf16 v[36:39], a[28:31], a[44:47], v[36:39]
s_nop 7
s_nop 3
v_cmp_gt_i32 vcc, 0, v100
s_nop 1
v_cndmask_b32 v32, v32, v29, vcc
v_cmp_gt_i32 vcc, 1, v100
s_nop 1
v_cndmask_b32 v33, v33, v29, vcc
v_cmp_gt_i32 vcc, 2, v100
s_nop 1
v_cndmask_b32 v34, v34, v29, vcc
v_cmp_gt_i32 vcc, 3, v100
s_nop 1
v_cndmask_b32 v35, v35, v29, vcc
v_cmp_gt_i32 vcc, 16, v100
s_nop 1
v_cndmask_b32 v36, v36, v29, vcc
v_cmp_gt_i32 vcc, 17, v100
s_nop 1
v_cndmask_b32 v37, v37, v29, vcc
v_cmp_gt_i32 vcc, 18, v100
s_nop 1
v_cndmask_b32 v38, v38, v29, vcc
v_cmp_gt_i32 vcc, 19, v100
s_nop 1
v_cndmask_b32 v39, v39, v29, vcc
v_mov_b32 v98, v96
v_max_f32 v98, v98, v32
v_max_f32 v98, v98, v33
v_max_f32 v98, v98, v34
v_max_f32 v98, v98, v35
v_max_f32 v98, v98, v36
v_max_f32 v98, v98, v37
v_max_f32 v98, v98, v38
v_max_f32 v98, v98, v39
v_mov_b32 v99, v98
s_nop 1
v_permlane16_swap_b32 v98, v99
s_nop 1
v_max_f32 v98, v98, v99
v_mov_b32 v99, v98
s_nop 1
v_permlane32_swap_b32 v98, v99
s_nop 1
v_max_f32 v98, v98, v99
v_sub_f32 v99, v96, v98
v_mov_b32 v96, v98
v_exp_f32 v99, v99
v_sub_f32 v32, v32, v96
v_exp_f32 v32, v32
v_sub_f32 v33, v33, v96
v_exp_f32 v33, v33
v_sub_f32 v34, v34, v96
v_exp_f32 v34, v34
v_sub_f32 v35, v35, v96
v_exp_f32 v35, v35
v_sub_f32 v36, v36, v96
v_exp_f32 v36, v36
v_sub_f32 v37, v37, v96
v_exp_f32 v37, v37
v_sub_f32 v38, v38, v96
v_exp_f32 v38, v38
v_sub_f32 v39, v39, v96
v_exp_f32 v39, v39
v_mul_f32 v97, v97, v99
v_add_f32 v97, v97, v32
v_add_f32 v97, v97, v33
v_add_f32 v97, v97, v34
v_add_f32 v97, v97, v35
v_add_f32 v97, v97, v36
v_add_f32 v97, v97, v37
v_add_f32 v97, v97, v38
v_add_f32 v97, v97, v39
v_cvt_pk_bf16_f32 v84, v32, v33
v_cvt_pk_bf16_f32 v85, v34, v35
v_cvt_pk_bf16_f32 v86, v36, v37
v_cvt_pk_bf16_f32 v87, v38, v39
v_mul_f32 v192, v99, v192
v_mul_f32 v193, v99, v193
v_mul_f32 v194, v99, v194
v_mul_f32 v195, v99, v195
v_mul_f32 v196, v99, v196
v_mul_f32 v197, v99, v197
v_mul_f32 v198, v99, v198
v_mul_f32 v199, v99, v199
v_mul_f32 v200, v99, v200
v_mul_f32 v201, v99, v201
v_mul_f32 v202, v99, v202
v_mul_f32 v203, v99, v203
v_mul_f32 v204, v99, v204
v_mul_f32 v205, v99, v205
v_mul_f32 v206, v99, v206
v_mul_f32 v207, v99, v207
v_mul_f32 v208, v99, v208
v_mul_f32 v209, v99, v209
v_mul_f32 v210, v99, v210
v_mul_f32 v211, v99, v211
v_mul_f32 v212, v99, v212
v_mul_f32 v213, v99, v213
v_mul_f32 v214, v99, v214
v_mul_f32 v215, v99, v215
v_mul_f32 v216, v99, v216
v_mul_f32 v217, v99, v217
v_mul_f32 v218, v99, v218
v_mul_f32 v219, v99, v219
v_mul_f32 v220, v99, v220
v_mul_f32 v221, v99, v221
v_mul_f32 v222, v99, v222
v_mul_f32 v223, v99, v223
v_subrev_u32 v100, 32, v100
s_nop 1
v_mfma_f32_16x16x32_bf16 v[192:195], a[200:203], v[84:87], v[192:195]
v_mfma_f32_16x16x32_bf16 v[196:199], a[208:211], v[84:87], v[196:199]
v_mfma_f32_16x16x32_bf16 v[200:203], a[216:219], v[84:87], v[200:203]
v_mfma_f32_16x16x32_bf16 v[204:207], a[224:227], v[84:87], v[204:207]
v_mfma_f32_16x16x32_bf16 v[208:211], a[232:235], v[84:87], v[208:211]
v_mfma_f32_16x16x32_bf16 v[212:215], a[240:243], v[84:87], v[212:215]
v_mfma_f32_16x16x32_bf16 v[216:219], a[248:251], v[84:87], v[216:219]
v_mfma_f32_16x16x32_bf16 v[220:223], a[196:199], v[84:87], v[220:223]
s_nop 7
s_nop 3
s_add_u32 s94, s94, 1
s_cmp_lt_u32 s94, s76
s_cbranch_scc1 L_slow2Y_loop
v_mov_b32 v99, v97
s_nop 1
v_permlane16_swap_b32 v97, v99
s_nop 1
v_add_f32 v97, v97, v99
v_mov_b32 v99, v97
s_nop 1
v_permlane32_swap_b32 v97, v99
s_nop 1
v_add_f32 v97, v97, v99
v_accvgpr_write_b32 a136, v97
s_nop 3
s_branch L_back_slow2Y
L_slow3:
s_waitcnt vmcnt(0)
s_nop 7
s_lshl_b32 s76, s50, 2
s_sub_u32 s76, 64, s76
s_lshl_b32 s77, s49, 19
s_mov_b32 s94, 0
v_mov_b32 v96, v29
v_mov_b32 v97, 0
v_mov_b32 v224, 0
v_mov_b32 v225, 0
v_mov_b32 v226, 0
v_mov_b32 v227, 0
v_mov_b32 v228, 0
v_mov_b32 v229, 0
v_mov_b32 v230, 0
v_mov_b32 v231, 0
v_mov_b32 v232, 0
v_mov_b32 v233, 0
v_mov_b32 v234, 0
v_mov_b32 v235, 0
v_mov_b32 v236, 0
v_mov_b32 v237, 0
v_mov_b32 v238, 0
v_mov_b32 v239, 0
v_mov_b32 v240, 0
v_mov_b32 v241, 0
v_mov_b32 v242, 0
v_mov_b32 v243, 0
v_mov_b32 v244, 0
v_mov_b32 v245, 0
v_mov_b32 v246, 0
v_mov_b32 v247, 0
v_mov_b32 v248, 0
v_mov_b32 v249, 0
v_mov_b32 v250, 0
v_mov_b32 v251, 0
v_mov_b32 v252, 0
v_mov_b32 v253, 0
v_mov_b32 v254, 0
v_mov_b32 v255, 0
s_sub_u32 s78, s58, 33554432
s_lshr_b32 s78, s78, 17
s_lshl_b32 s78, s78, 4
v_and_b32 v100, 15, v0
v_lshrrev_b32 v98, 4, v0
v_lshlrev_b32 v98, 2, v98
v_sub_u32 v100, v100, v98
v_add_u32 v100, s78, v100
L_slow3_loop:
s_add_u32 s78, s77, 16777216
buffer_load_dwordx4 a[0:3], v1, s[4:7], s77 offen offset:0 sc1
buffer_load_dwordx4 a[200:203], v1, s[4:7], s78 offen offset:0 sc1
buffer_load_dwordx4 a[4:7], v1, s[4:7], s77 offen offset:1024 sc1
buffer_load_dwordx4 a[208:211], v1, s[4:7], s78 offen offset:1024 sc1
buffer_load_dwordx4 a[8:11], v1, s[4:7], s77 offen offset:2048 sc1
buffer_load_dwordx4 a[216:219], v1, s[4:7], s78 offen offset:2048 sc1
buffer_load_dwordx4 a[12:15], v1, s[4:7], s77 offen offset:3072 sc1
buffer_load_dwordx4 a[224:227], v1, s[4:7], s78 offen offset:3072 sc1
s_add_u32 s77, s77, 4096
s_add_u32 s78, s78, 4096
buffer_load_dwordx4 a[16:19], v1, s[4:7], s77 offen offset:0 sc1
buffer_load_dwordx4 a[232:235], v1, s[4:7], s78 offen offset:0 sc1
buffer_load_dwordx4 a[20:23], v1, s[4:7], s77 offen offset:1024 sc1
buffer_load_dwordx4 a[240:243], v1, s[4:7], s78 offen offset:1024 sc1
buffer_load_dwordx4 a[24:27], v1, s[4:7], s77 offen offset:2048 sc1
buffer_load_dwordx4 a[248:251], v1, s[4:7], s78 offen offset:2048 sc1
buffer_load_dwordx4 a[28:31], v1, s[4:7], s77 offen offset:3072 sc1
buffer_load_dwordx4 a[196:199], v1, s[4:7], s78 offen offset:3072 sc1
s_add_u32 s77, s77, 4096
s_waitcnt vmcnt(0)
v_mfma_f32_16x16x32_bf16 v[32:35], a[0:3], a[48:51], 0
v_mfma_f32_16x16x32_bf16 v[32:35], a[4:7], a[52:55], v[32:35]
v_mfma_f32_16x16x32_bf16 v[32:35], a[8:11], a[56:59], v[32:35]
v_mfma_f32_16x16x32_bf16 v[32:35], a[12:15], a[60:63], v[32:35]
v_mfma_f32_16x16x32_bf16 v[36:39], a[16:19], a[48:51], 0
v_mfma_f32_16x16x32_bf16 v[36:39], a[20:23], a[52:55], v[36:39]
v_mfma_f32_16x16x32_bf16 v[36:39], a[24:27], a[56:59], v[36:39]
v_mfma_f32_16x16x32_bf16 v[36:39], a[28:31], a[60:63], v[36:39]
s_nop 7
s_nop 3
v_cmp_gt_i32 vcc, 0, v100
s_nop 1
v_cndmask_b32 v32, v32, v29, vcc
v_cmp_gt_i32 vcc, 1, v100
s_nop 1
v_cndmask_b32 v33, v33, v29, vcc
v_cmp_gt_i32 vcc, 2, v100
s_nop 1
v_cndmask_b32 v34, v34, v29, vcc
v_cmp_gt_i32 vcc, 3, v100
s_nop 1
v_cndmask_b32 v35, v35, v29, vcc
v_cmp_gt_i32 vcc, 16, v100
s_nop 1
v_cndmask_b32 v36, v36, v29, vcc
v_cmp_gt_i32 vcc, 17, v100
s_nop 1
v_cndmask_b32 v37, v37, v29, vcc
v_cmp_gt_i32 vcc, 18, v100
s_nop 1
v_cndmask_b32 v38, v38, v29, vcc
v_cmp_gt_i32 vcc, 19, v100
s_nop 1
v_cndmask_b32 v39, v39, v29, vcc
v_mov_b32 v98, v96
v_max_f32 v98, v98, v32
v_max_f32 v98, v98, v33
v_max_f32 v98, v98, v34
v_max_f32 v98, v98, v35
v_max_f32 v98, v98, v36
v_max_f32 v98, v98, v37
v_max_f32 v98, v98, v38
v_max_f32 v98, v98, v39
v_mov_b32 v99, v98
s_nop 1
v_permlane16_swap_b32 v98, v99
s_nop 1
v_max_f32 v98, v98, v99
v_mov_b32 v99, v98
s_nop 1
v_permlane32_swap_b32 v98, v99
s_nop 1
v_max_f32 v98, v98, v99
v_sub_f32 v99, v96, v98
v_mov_b32 v96, v98
v_exp_f32 v99, v99
v_sub_f32 v32, v32, v96
v_exp_f32 v32, v32
v_sub_f32 v33, v33, v96
v_exp_f32 v33, v33
v_sub_f32 v34, v34, v96
v_exp_f32 v34, v34
v_sub_f32 v35, v35, v96
v_exp_f32 v35, v35
v_sub_f32 v36, v36, v96
v_exp_f32 v36, v36
v_sub_f32 v37, v37, v96
v_exp_f32 v37, v37
v_sub_f32 v38, v38, v96
v_exp_f32 v38, v38
v_sub_f32 v39, v39, v96
v_exp_f32 v39, v39
v_mul_f32 v97, v97, v99
v_add_f32 v97, v97, v32
v_add_f32 v97, v97, v33
v_add_f32 v97, v97, v34
v_add_f32 v97, v97, v35
v_add_f32 v97, v97, v36
v_add_f32 v97, v97, v37
v_add_f32 v97, v97, v38
v_add_f32 v97, v97, v39
v_cvt_pk_bf16_f32 v84, v32, v33
v_cvt_pk_bf16_f32 v85, v34, v35
v_cvt_pk_bf16_f32 v86, v36, v37
v_cvt_pk_bf16_f32 v87, v38, v39
v_mul_f32 v224, v99, v224
v_mul_f32 v225, v99, v225
v_mul_f32 v226, v99, v226
v_mul_f32 v227, v99, v227
v_mul_f32 v228, v99, v228
v_mul_f32 v229, v99, v229
v_mul_f32 v230, v99, v230
v_mul_f32 v231, v99, v231
v_mul_f32 v232, v99, v232
v_mul_f32 v233, v99, v233
v_mul_f32 v234, v99, v234
v_mul_f32 v235, v99, v235
v_mul_f32 v236, v99, v236
v_mul_f32 v237, v99, v237
v_mul_f32 v238, v99, v238
v_mul_f32 v239, v99, v239
v_mul_f32 v240, v99, v240
v_mul_f32 v241, v99, v241
v_mul_f32 v242, v99, v242
v_mul_f32 v243, v99, v243
v_mul_f32 v244, v99, v244
v_mul_f32 v245, v99, v245
v_mul_f32 v246, v99, v246
v_mul_f32 v247, v99, v247
v_mul_f32 v248, v99, v248
v_mul_f32 v249, v99, v249
v_mul_f32 v250, v99, v250
v_mul_f32 v251, v99, v251
v_mul_f32 v252, v99, v252
v_mul_f32 v253, v99, v253
v_mul_f32 v254, v99, v254
v_mul_f32 v255, v99, v255
v_subrev_u32 v100, 32, v100
s_nop 1
v_mfma_f32_16x16x32_bf16 v[224:227], a[200:203], v[84:87], v[224:227]
v_mfma_f32_16x16x32_bf16 v[228:231], a[208:211], v[84:87], v[228:231]
v_mfma_f32_16x16x32_bf16 v[232:235], a[216:219], v[84:87], v[232:235]
v_mfma_f32_16x16x32_bf16 v[236:239], a[224:227], v[84:87], v[236:239]
v_mfma_f32_16x16x32_bf16 v[240:243], a[232:235], v[84:87], v[240:243]
v_mfma_f32_16x16x32_bf16 v[244:247], a[240:243], v[84:87], v[244:247]
v_mfma_f32_16x16x32_bf16 v[248:251], a[248:251], v[84:87], v[248:251]
v_mfma_f32_16x16x32_bf16 v[252:255], a[196:199], v[84:87], v[252:255]
s_nop 7
s_nop 3
s_add_u32 s94, s94, 1
s_cmp_lt_u32 s94, s76
s_cbranch_scc1 L_slow3_loop
v_mov_b32 v99, v97
s_nop 1
v_permlane16_swap_b32 v97, v99
s_nop 1
v_add_f32 v97, v97, v99
v_mov_b32 v99, v97
s_nop 1
v_permlane32_swap_b32 v97, v99
s_nop 1
v_add_f32 v97, v97, v99
v_accvgpr_write_b32 a140, v97
s_nop 3
s_branch L_back_slow3
.p2align 6
.type L_table,@object
L_table:
.long 0,2592,6048,8640,16,2608,6064,8656,32,2624,6080,8672,48,2640,6096,8688
.long 64,2656,6112,8704,80,2672,6128,8720,96,2688,6144,9600,112,2704,6160,9616
.long 128,3584,6176,9632,144,3600,6192,9648,160,3616,6208,9664,176,3632,6224,9680
.long 192,3648,6240,9696,208,3664,6256,9712,224,3680,6272,9728,240,3696,6288,9744
.long 256,3712,7168,9760,272,3728,7184,9776,1152,3744,7200,9792,1168,3760,7216,9808
.long 1184,3776,7232,9824,1200,3792,7248,9840,1216,3808,7264,9856,1232,3824,7280,9872
.long 1248,3840,7296,10752,1264,3856,7312,10768,1280,4736,7328,10784,1296,4752,7344,10800
.long 1312,4768,7360,10816,1328,4784,7376,10832,1344,4800,7392,10848,1360,4816,7408,10864
.long 1376,4832,7424,10880,1392,4848,7440,10896,1408,4864,8320,10912,1424,4880,8336,10928
.long 2304,4896,8352,10944,2320,4912,8368,10960,2336,4928,8384,10976,2352,4944,8400,10992
.long 2368,4960,8416,11008,2384,4976,8432,11024,2400,4992,8448,11904,2416,5008,8464,11920
.long 2432,5888,8480,11936,2448,5904,8496,11952,2464,5920,8512,11968,2480,5936,8528,11984
.long 2496,5952,8544,12000,2512,5968,8560,12016,2528,5984,8576,12032,2544,6000,8592,12048
.long 2560,6016,9472,12064,2576,6032,9488,12080,3456,6048,9504,12096,3472,6064,9520,12112
.long 3488,6080,9536,12128,3504,6096,9552,12144,3520,6112,9568,12160,3536,6128,9584,12176
.long 3552,6144,9600,13056,3568,6160,9616,13072,3584,7040,9632,13088,3600,7056,9648,13104
.long 16192,18784,22240,24832,16208,18800,22256,24848,16224,18816,22272,25728,16240,18832,22288,25744
.long 16256,19712,22304,25760,16272,19728,22320,25776,16288,19744,22336,25792,16304,19760,22352,25808
.long 16320,19776,22368,25824,16336,19792,22384,25840,16352,19808,22400,25856,16368,19824,22416,25872
.long 16384,19840,23296,25888,16400,19856,23312,25904,17280,19872,23328,25920,17296,19888,23344,25936
.long 17312,19904,23360,25952,17328,19920,23376,25968,17344,19936,23392,25984,17360,19952,23408,26000
.long 17376,19968,23424,26880,17392,19984,23440,26896,17408,20864,23456,26912,17424,20880,23472,26928
.long 17440,20896,23488,26944,17456,20912,23504,26960,17472,20928,23520,26976,17488,20944,23536,26992
.long 17504,20960,23552,27008,17520,20976,23568,27024,17536,20992,24448,27040,17552,21008,24464,27056
.long 18432,21024,24480,27072,18448,21040,24496,27088,18464,21056,24512,27104,18480,21072,24528,27120
.long 18496,21088,24544,27136,18512,21104,24560,27152,18528,21120,24576,28032,18544,21136,24592,28048
.long 18560,22016,24608,28064,18576,22032,24624,28080,18592,22048,24640,28096,18608,22064,24656,28112
.long 18624,22080,24672,28128,18640,22096,24688,28144,18656,22112,24704,28160,18672,22128,24720,28176
.long 18688,22144,25600,28192,18704,22160,25616,28208,19584,22176,25632,28224,19600,22192,25648,28240
.long 19616,22208,25664,28256,19632,22224,25680,28272,19648,22240,25696,28288,19664,22256,25712,28304
.long 19680,22272,25728,29184,19696,22288,25744,29200,19712,23168,25760,29216,19728,23184,25776,29232
.long 19744,23200,25792,29248,19760,23216,25808,29264,19776,23232,25824,29280,19792,23248,25840,29296
.long 32384,0,0,0,32400,8,8,64,32416,16,16,128,32432,24,24,192
.long 32448,288,32,4,32464,296,40,68,32480,304,48,132,32496,312,56,196
.long 32512,576,64,8,32528,584,72,72,33408,592,80,136,33424,600,88,200
.long 33440,864,96,12,33456,872,104,76,33472,880,112,140,33488,888,120,204
.long 33504,1152,128,16,33520,1160,136,80,33536,1168,144,144,33552,1176,152,208
.long 33568,1440,160,20,33584,1448,168,84,33600,1456,176,148,33616,1464,184,212
.long 33632,1728,192,24,33648,1736,200,88,33664,1744,208,152,33680,1752,216,216
.long 34560,2016,224,28,34576,2024,232,92,34592,2032,240,156,34608,2040,248,220
.long 34624,2304,256,32,34640,2312,264,96,34656,2320,272,160,34672,2328,280,224
.long 34688,2592,288,36,34704,2600,296,100,34720,2608,304,164,34736,2616,312,228
.long 34752,2880,320,40,34768,2888,328,104,34784,2896,336,168,34800,2904,344,232
.long 34816,3168,352,44,34832,3176,360,108,35712,3184,368,172,35728,3192,376,236
.long 35744,3456,384,48,35760,3464,392,112,35776,3472,400,176,35792,3480,408,240
.long 35808,3744,416,52,35824,3752,424,116,35840,3760,432,180,35856,3768,440,244
.long 35872,4032,448,56,35888,4040,456,120,35904,4048,464,184,35920,4056,472,248
.long 35936,4320,480,60,35952,4328,488,124,35968,4336,496,188,35984,4344,504,252
.long 0,0,0,0,8,0,0,0,16,0,0,0,24,0,0,0
.long 2304,0,0,0,2312,0,0,0,2320,0,0,0,2328,0,0,0
.long 4608,0,0,0,4616,0,0,0,4624,0,0,0,4632,0,0,0
.long 6912,0,0,0,6920,0,0,0,6928,0,0,0,6936,0,0,0
.long 9216,0,0,0,9224,0,0,0,9232,0,0,0,9240,0,0,0
.long 11520,0,0,0,11528,0,0,0,11536,0,0,0,11544,0,0,0
.long 13824,0,0,0,13832,0,0,0,13840,0,0,0,13848,0,0,0
.long 16128,0,0,0,16136,0,0,0,16144,0,0,0,16152,0,0,0
.long 18432,0,0,0,18440,0,0,0,18448,0,0,0,18456,0,0,0
.long 20736,0,0,0,20744,0,0,0,20752,0,0,0,20760,0,0,0
.long 23040,0,0,0,23048,0,0,0,23056,0,0,0,23064,0,0,0
.long 25344,0,0,0,25352,0,0,0,25360,0,0,0,25368,0,0,0
.long 27648,0,0,0,27656,0,0,0,27664,0,0,0,27672,0,0,0
.long 29952,0,0,0,29960,0,0,0,29968,0,0,0,29976,0,0,0
.long 32256,0,0,0,32264,0,0,0,32272,0,0,0,32280,0,0,0
.long 34560,0,0,0,34568,0,0,0,34576,0,0,0,34584,0,0,0
.size L_table, .-L_table
L_codeend:
.section .rodata,"a"
.p2align 6
.amdhsa_kernel concat_heads__compressed_kv_cla__linear_attn_block__prompt_kernel
  .amdhsa_next_free_vgpr 512
  .amdhsa_next_free_sgpr 102
  .amdhsa_accum_offset 256
  .amdhsa_group_segment_fixed_size 0
  .amdhsa_kernarg_size 96
  .amdhsa_user_sgpr_count 2
  .amdhsa_user_sgpr_kernarg_segment_ptr 1
  .amdhsa_system_sgpr_workgroup_id_x 1
  .amdhsa_float_denorm_mode_32 3
.end_amdhsa_kernel
```
